```python
import torch

def _softmax(x, axis=-1):
    return torch.softmax(x, dim=axis)
def _gelu(x):
    return torch.nn.functional.gelu(x, approximate="tanh")
def _silu(x):
    return torch.nn.functional.silu(x)
def _sigmoid(x):
    return torch.sigmoid(x)
def _layernorm(x, axis=-1, eps=1e-5):
    m = x.mean(dim=axis, keepdim=True)
    v = x.var(dim=axis, keepdim=True, unbiased=False)
    return (x - m) / torch.sqrt(v + eps)
def _scatter_add(tgt, idx, src, axis=0):
    return tgt.clone().index_add_(axis, idx, src)
def _segment_sum(src, seg, n):
    out = torch.zeros((n,) + src.shape[1:], dtype=src.dtype)
    return out.index_add_(0, seg, src)
def _pad(x, pw):
    flat = tuple(v for pair in reversed(pw) for v in pair)
    return torch.nn.functional.pad(x, flat)

kernel_name = 'concat_heads__spectral_gfnet__ssm_conv_s5__prompt'

def setup_inputs():

    _w = (lambda a: (lambda t: t.to(torch.bfloat16) if t.is_floating_point() else t)(torch.as_tensor(a)))
    def _A_setup():
        B, S, D = 1, 2048, 1024
        Df = D // 2 + 1
        return {
            "x": _w((lambda *s: torch.randn(*s, dtype=torch.bfloat16) * 0.05)(B, S, D)),
            "w_r": _w((lambda *s: torch.randn(*s, dtype=torch.bfloat16) * 0.8)(S, Df) * 0.02),
            "w_i": _w((lambda *s: torch.randn(*s, dtype=torch.bfloat16) * 0.8)(S, Df) * 0.02),
        }
    _A_in = _A_setup()

    def _B_setup():
        B, S, D = 1, 2048, 1024
        P = D
        Lambda_re = -0.5 * (lambda _x: torch.exp(torch.as_tensor(_x)))((lambda *s: torch.randn(*s, dtype=torch.bfloat16) * 0.2)(P))
        Lambda_im = (lambda *s: torch.randn(*s, dtype=torch.bfloat16) * 0.4)(P) * 1.0
        B_re = (lambda *s: torch.randn(*s, dtype=torch.bfloat16) * 0.2)(P, D) * (D ** -0.5)
        B_im = (lambda *s: torch.randn(*s, dtype=torch.bfloat16) * 0.2)(P, D) * (D ** -0.5)
        C_re = (lambda *s: torch.randn(*s, dtype=torch.bfloat16) * 0.2)(D, P) * (P ** -0.5)
        C_im = (lambda *s: torch.randn(*s, dtype=torch.bfloat16) * 0.2)(D, P) * (P ** -0.5)
        log_dt = (lambda *s: torch.randn(*s, dtype=torch.bfloat16) * 0.2)(P) * 0.3 - 2.0
        Dskip = (lambda *s: torch.randn(*s, dtype=torch.bfloat16) * 0.05)(D)
        return {
            "x": _w((lambda *s: torch.randn(*s, dtype=torch.bfloat16) * 0.05)(B, S, D)),
            "Lambda_re": _w(Lambda_re),
            "Lambda_im": _w(Lambda_im),
            "B_re": _w(B_re),
            "B_im": _w(B_im),
            "C_re": _w(C_re),
            "C_im": _w(C_im),
            "log_dt": _w(log_dt),
            "Dskip": _w(Dskip),
        }
    _B_in = _B_setup()

    return {
        "A_x": _A_in["x"],
        "A_w_r": _A_in["w_r"],
        "A_w_i": _A_in["w_i"],
        "B_x": _B_in["x"],
        "B_Lambda_re": _B_in["Lambda_re"],
        "B_Lambda_im": _B_in["Lambda_im"],
        "B_B_re": _B_in["B_re"],
        "B_B_im": _B_in["B_im"],
        "B_C_re": _B_in["C_re"],
        "B_C_im": _B_in["C_im"],
        "B_log_dt": _B_in["log_dt"],
        "B_Dskip": _B_in["Dskip"],
    }

def reference(A_x, A_w_r, A_w_i, B_x, B_Lambda_re, B_Lambda_im, B_B_re, B_B_im, B_C_re, B_C_im, B_log_dt, B_Dskip):
    def _A_ref(x, w_r, w_i):
        B, S, D = x.shape
        X = (lambda x, axes=(-2,-1): torch.fft.rfft2(x.float(), dim=axes))(x, axes=(-2, -1))
        W = w_r + 1j * w_i
        X = X * W
        y = (lambda x, s, axes=(-2,-1): torch.fft.irfft2(x, s=s, dim=axes).to(torch.bfloat16))(X, (S, D), axes=(-2, -1))
        return y

    def _B_ref(x, Lambda_re, Lambda_im, B_re, B_im, C_re, C_im, log_dt, Dskip):
        Bsz, L, H = x.shape
        Lam = Lambda_re + 1j * Lambda_im
        Bmat = B_re + 1j * B_im
        Cmat = C_re + 1j * C_im
        dt = torch.exp(log_dt)
        Lam_bar = torch.exp(dt * Lam)
        B_bar = ((Lam_bar - 1.0) / Lam)[:, None] * Bmat
        Bu = torch.einsum("bld,pd->blp", x + 0j, B_bar)
        h = torch.zeros_like(Bu[:, 0, :])
        hs = []
        for t in range(L):
            h = Lam_bar[None, :] * h + Bu[:, t, :]
            hs.append(h)
        hseq = torch.stack(hs, 1)
        y = 2.0 * torch.einsum("blp,dp->bld", hseq, Cmat).real + x * Dskip[None, None, :]
        return y

    a = _A_ref(A_x, A_w_r, A_w_i)
    b = _B_ref(B_x, B_Lambda_re, B_Lambda_im, B_B_re, B_B_im, B_C_re, B_C_im, B_log_dt, B_Dskip)
    return torch.concatenate([a, b], axis=-1)
```

```asm
; @launch grid=(256,1,1) block=(512,1,1) lds=163840
.amdgcn_target "amdgcn-amd-amdhsa--gfx950"
.text
.globl concat_heads__spectral_gfnet__ssm_conv_s5__prompt_kernel
.p2align 8
.type concat_heads__spectral_gfnet__ssm_conv_s5__prompt_kernel,@function
concat_heads__spectral_gfnet__ssm_conv_s5__prompt_kernel:
s_cmp_ge_u32 s2, 256
s_cbranch_scc1 L_concat_heads__spectral_gfnet__ssm_conv_s5__prompt_kernel_end
s_load_dwordx16 s[4:19], s[0:1], 0
s_load_dwordx8 s[20:27], s[0:1], 64
s_load_dwordx4 s[28:31], s[0:1], 96
s_load_dwordx2 s[32:33], s[0:1], 112
v_lshrrev_b32 v2, 6, v0
v_and_b32 v1, 63, v0
v_readfirstlane_b32 s34, v2
s_and_b32 s60, s2, 7
s_lshr_b32 s61, s2, 3
s_lshr_b32 s35, s60, 1
s_lshl_b32 s35, s35, 2
s_lshr_b32 s62, s61, 3
s_add_u32 s35, s35, s62
s_and_b32 s36, s60, 1
s_lshl_b32 s36, s36, 3
s_and_b32 s62, s61, 7
s_add_u32 s36, s36, s62
s_xor_b32 s34, s34, 4
s_cmp_ge_u32 s34, 4
s_cbranch_scc0 L_concat_heads__spectral_gfnet__ssm_conv_s5__prompt_kernel_gemm
s_sub_u32 s66, s34, 4
s_setprio 0
s_waitcnt lgkmcnt(0)
s_mov_b32 s100, s20
s_mov_b32 s101, s21
s_bitcmp1_b32 s66, 0
s_cselect_b32 s100, s22, s20
s_cselect_b32 s101, s23, s21
s_cmp_lg_u32 s66, 1
s_cbranch_scc1 L_pf1
s_lshr_b32 s60, s2, 3
s_lshl_b32 s60, s60, 11
v_and_b32 v12, 15, v1
v_lshl_add_u32 v12, v12, 7, s60
v_min_u32 v12, L_concat_heads__spectral_gfnet__ssm_conv_s5__prompt_kernel_end-concat_heads__spectral_gfnet__ssm_conv_s5__prompt_kernel, v12
s_getpc_b64 s[60:61]
L_pc2:
s_sub_u32 s60, s60, L_pc2-concat_heads__spectral_gfnet__ssm_conv_s5__prompt_kernel
s_subb_u32 s61, s61, 0
global_load_dword v23, v12, s[60:61]
L_pf1:
s_lshl_b32 s60, s2, 3
s_add_u32 s60, s60, s34
s_cmp_lg_u32 s60, 4
s_cbranch_scc1 L_nn3
s_load_dword s3, s[32:33], 0
v_mov_b32 v22, 0
v_lshlrev_b32 v23, 7, v1
v_add_u32 v23, 4096, v23
global_store_dword v23, v22, s[32:33] sc1
L_nn3:
s_mov_b32 s48, s6
s_mov_b32 s49, s7
s_mov_b32 s50, 2101248
s_mov_b32 s51, 0x20000
s_mov_b32 s52, s8
s_mov_b32 s53, s9
s_mov_b32 s54, 2101248
s_mov_b32 s55, 0x20000
s_and_b32 s60, s2, 31
s_lshr_b32 s61, s2, 5
s_lshl_b32 s61, s61, 7
s_add_u32 s60, s60, s61
s_lshl_b32 s61, s66, 5
s_add_u32 s67, s60, s61
s_lshl_b32 s60, s67, 12
s_add_u32 s4, s4, s60
s_addc_u32 s5, s5, 0
s_mov_b32 s6, 4096
s_mov_b32 s7, 0x20000
v_lshlrev_b32 v2, 4, v1
v_xor_b32 v3, 128, v2
s_lshl_b32 s68, s66, 12
s_add_u32 s68, s68, 131072
s_add_u32 m0, s68, 0
s_mov_b32 s92, 0
buffer_load_dwordx4 v2, s[4:7], s92 offen offset:0 nt lds
buffer_load_dwordx4 v2, s[4:7], s92 offen offset:1024 nt lds
s_add_u32 m0, s68, 2048
s_mov_b32 s92, 2048
buffer_load_dwordx4 v3, s[4:7], s92 offen offset:0 nt lds
buffer_load_dwordx4 v3, s[4:7], s92 offen offset:1024 nt lds
s_and_b32 s60, s2, 7
s_bfe_u32 s61, s2, 0x10003
s_bfe_u32 s62, s2, 0x20004
s_lshr_b32 s63, s2, 6
s_lshr_b32 s64, s60, 1
s_lshl_b32 s64, s64, 3
s_lshl_b32 s65, s61, 2
s_add_u32 s64, s64, s65
s_and_b32 s65, s60, 1
s_lshl_b32 s65, s65, 1
s_add_u32 s64, s64, s65
s_lshl_b32 s64, s64, 5
s_lshl_b32 s65, s62, 3
s_add_u32 s64, s64, s65
s_lshl_b32 s65, s66, 1
s_add_u32 s64, s64, s65
s_mul_i32 s64, s64, 1026
s_lshl_b32 s65, s63, 8
s_add_u32 s69, s64, s65
v_bfe_u32 v8, v1, 4, 1
v_mul_u32_u24 v8, 32832, v8
v_lshrrev_b32 v9, 5, v1
s_mov_b32 s65, 1050624
v_mul_lo_u32 v9, s65, v9
v_add_u32 v8, v8, v9
v_and_b32 v9, 15, v1
s_lshl_b32 s65, s66, 1
v_xor_b32 v9, s65, v9
v_lshl_add_u32 v18, v9, 4, v8
v_xor_b32 v9, 1, v9
v_lshl_add_u32 v19, v9, 4, v8
v_add_u32 v19, 1026, v19
s_bfe_u32 s64, s2, 0x20005
s_lshl_b32 s64, s64, 8
s_bfe_u32 s65, s2, 0x10004
s_lshl_b32 s65, s65, 6
s_add_u32 s64, s64, s65
s_bfe_u32 s65, s2, 0x10003
s_lshl_b32 s65, s65, 7
s_add_u32 s64, s64, s65
s_and_b32 s65, s2, 7
s_lshl_b32 s65, s65, 2
s_add_u32 s64, s64, s65
v_bfe_u32 v8, v1, 3, 2
v_add_u32 v8, s64, v8
v_bfe_u32 v9, v1, 2, 1
v_lshl_add_u32 v8, v9, 5, v8
v_bfe_u32 v9, v1, 1, 1
v_lshl_add_u32 v8, v9, 10, v8
v_sub_u32 v9, 2048, v8
v_and_b32 v9, 2047, v9
v_and_b32 v10, 1, v1
v_cmp_eq_u32 vcc, 1, v10
s_nop 1
v_cndmask_b32 v8, v8, v9, vcc
v_mul_u32_u24 v17, 1026, v8
s_lshr_b32 s64, s2, 7
s_lshl_b32 s64, s64, 10
v_add_u32 v17, s64, v17
s_add_u32 m0, s68, 16384
s_nop 0
buffer_load_dwordx4 v18, s[48:51], s69 offen nt lds
s_add_u32 m0, s68, 17408
s_nop 0
buffer_load_dwordx4 v18, s[52:55], s69 offen nt lds
s_add_u32 m0, s68, 18432
s_nop 0
buffer_load_dwordx4 v19, s[48:51], s69 offen nt lds
s_add_u32 m0, s68, 19456
s_nop 0
buffer_load_dwordx4 v19, s[52:55], s69 offen nt lds
s_cmp_lg_u32 s66, 3
s_cbranch_scc1 L_nw4
s_mov_b32 exec_hi, 0
buffer_load_ushort v88, v17, s[48:51], 0 offen nt
buffer_load_ushort v89, v17, s[52:55], 0 offen nt
s_mov_b64 exec, -1
L_nw4:
s_barrier
v_and_b32 v92, 31, v1
v_cvt_f32_u32 v92, v92
v_lshrrev_b32 v93, 5, v1
v_lshlrev_b32 v93, 2, v93
v_cvt_f32_u32 v93, v93
v_mul_f32 v93, v92, v93
v_mul_f32 v93, 0x3d000000, v93
v_fmamk_f32 v94, v92, 0x0, v93
v_fract_f32 v94, v94
v_cos_f32 v95, v94
v_sin_f32 v96, v94
s_nop 0
v_cvt_pk_bf16_f32 v192, v95, v96
v_cvt_pk_bf16_f32 v208, -v96, v95
v_fmamk_f32 v97, v92, 0x3d000000, v93
v_fract_f32 v97, v97
v_cos_f32 v98, v97
v_sin_f32 v99, v97
s_nop 0
v_cvt_pk_bf16_f32 v193, v98, v99
v_cvt_pk_bf16_f32 v209, -v99, v98
v_fmamk_f32 v94, v92, 0x3d800000, v93
v_fract_f32 v94, v94
v_cos_f32 v95, v94
v_sin_f32 v96, v94
s_nop 0
v_cvt_pk_bf16_f32 v194, v95, v96
v_cvt_pk_bf16_f32 v210, -v96, v95
v_fmamk_f32 v97, v92, 0x3dc00000, v93
v_fract_f32 v97, v97
v_cos_f32 v98, v97
v_sin_f32 v99, v97
s_nop 0
v_cvt_pk_bf16_f32 v195, v98, v99
v_cvt_pk_bf16_f32 v211, -v99, v98
v_fmamk_f32 v94, v92, 0x3e800000, v93
v_fract_f32 v94, v94
v_cos_f32 v95, v94
v_sin_f32 v96, v94
s_nop 0
v_cvt_pk_bf16_f32 v196, v95, v96
v_cvt_pk_bf16_f32 v212, -v96, v95
v_fmamk_f32 v97, v92, 0x3e900000, v93
v_fract_f32 v97, v97
v_cos_f32 v98, v97
v_sin_f32 v99, v97
s_nop 0
v_cvt_pk_bf16_f32 v197, v98, v99
v_cvt_pk_bf16_f32 v213, -v99, v98
v_fmamk_f32 v94, v92, 0x3ea00000, v93
v_fract_f32 v94, v94
v_cos_f32 v95, v94
v_sin_f32 v96, v94
s_nop 0
v_cvt_pk_bf16_f32 v198, v95, v96
v_cvt_pk_bf16_f32 v214, -v96, v95
v_fmamk_f32 v97, v92, 0x3eb00000, v93
v_fract_f32 v97, v97
v_cos_f32 v98, v97
v_sin_f32 v99, v97
s_nop 0
v_cvt_pk_bf16_f32 v199, v98, v99
v_cvt_pk_bf16_f32 v215, -v99, v98
v_fmamk_f32 v94, v92, 0x3f000000, v93
v_fract_f32 v94, v94
v_cos_f32 v95, v94
v_sin_f32 v96, v94
s_nop 0
v_cvt_pk_bf16_f32 v200, v95, v96
v_cvt_pk_bf16_f32 v216, -v96, v95
v_fmamk_f32 v97, v92, 0x3f080000, v93
v_fract_f32 v97, v97
v_cos_f32 v98, v97
v_sin_f32 v99, v97
s_nop 0
v_cvt_pk_bf16_f32 v201, v98, v99
v_cvt_pk_bf16_f32 v217, -v99, v98
v_fmamk_f32 v94, v92, 0x3f100000, v93
v_fract_f32 v94, v94
v_cos_f32 v95, v94
v_sin_f32 v96, v94
s_nop 0
v_cvt_pk_bf16_f32 v202, v95, v96
v_cvt_pk_bf16_f32 v218, -v96, v95
v_fmamk_f32 v97, v92, 0x3f180000, v93
v_fract_f32 v97, v97
v_cos_f32 v98, v97
v_sin_f32 v99, v97
s_nop 0
v_cvt_pk_bf16_f32 v203, v98, v99
v_cvt_pk_bf16_f32 v219, -v99, v98
v_fmamk_f32 v94, v92, 0x3f400000, v93
v_fract_f32 v94, v94
v_cos_f32 v95, v94
v_sin_f32 v96, v94
s_nop 0
v_cvt_pk_bf16_f32 v204, v95, v96
v_cvt_pk_bf16_f32 v220, -v96, v95
v_fmamk_f32 v97, v92, 0x3f480000, v93
v_fract_f32 v97, v97
v_cos_f32 v98, v97
v_sin_f32 v99, v97
s_nop 0
v_cvt_pk_bf16_f32 v205, v98, v99
v_cvt_pk_bf16_f32 v221, -v99, v98
v_fmamk_f32 v94, v92, 0x3f500000, v93
v_fract_f32 v94, v94
v_cos_f32 v95, v94
v_sin_f32 v96, v94
s_nop 0
v_cvt_pk_bf16_f32 v206, v95, v96
v_cvt_pk_bf16_f32 v222, -v96, v95
v_fmamk_f32 v97, v92, 0x3f580000, v93
v_fract_f32 v97, v97
v_cos_f32 v98, v97
v_sin_f32 v99, v97
s_nop 0
v_cvt_pk_bf16_f32 v207, v98, v99
v_cvt_pk_bf16_f32 v223, -v99, v98
v_and_b32 v92, 31, v1
v_cvt_f32_u32 v92, v92
v_lshrrev_b32 v93, 5, v1
v_lshlrev_b32 v93, 2, v93
v_cvt_f32_u32 v93, v93
v_mul_f32 v93, v92, v93
v_mul_f32 v93, 0x3a800000, v93
v_fmamk_f32 v94, v92, 0x0, v93
v_cos_f32 v224, v94
v_sin_f32 v240, -v94
v_fmamk_f32 v95, v92, 0x3a800000, v93
v_cos_f32 v225, v95
v_sin_f32 v241, -v95
v_fmamk_f32 v94, v92, 0x3b000000, v93
v_cos_f32 v226, v94
v_sin_f32 v242, -v94
v_fmamk_f32 v95, v92, 0x3b400000, v93
v_cos_f32 v227, v95
v_sin_f32 v243, -v95
v_fmamk_f32 v94, v92, 0x3c000000, v93
v_cos_f32 v228, v94
v_sin_f32 v244, -v94
v_fmamk_f32 v95, v92, 0x3c100000, v93
v_cos_f32 v229, v95
v_sin_f32 v245, -v95
v_fmamk_f32 v94, v92, 0x3c200000, v93
v_cos_f32 v230, v94
v_sin_f32 v246, -v94
v_fmamk_f32 v95, v92, 0x3c300000, v93
v_cos_f32 v231, v95
v_sin_f32 v247, -v95
v_fmamk_f32 v94, v92, 0x3c800000, v93
v_cos_f32 v232, v94
v_sin_f32 v248, -v94
v_fmamk_f32 v95, v92, 0x3c880000, v93
v_cos_f32 v233, v95
v_sin_f32 v249, -v95
v_fmamk_f32 v94, v92, 0x3c900000, v93
v_cos_f32 v234, v94
v_sin_f32 v250, -v94
v_fmamk_f32 v95, v92, 0x3c980000, v93
v_cos_f32 v235, v95
v_sin_f32 v251, -v95
v_fmamk_f32 v94, v92, 0x3cc00000, v93
v_cos_f32 v236, v94
v_sin_f32 v252, -v94
v_fmamk_f32 v95, v92, 0x3cc80000, v93
v_cos_f32 v237, v95
v_sin_f32 v253, -v95
v_fmamk_f32 v94, v92, 0x3cd00000, v93
v_cos_f32 v238, v94
v_sin_f32 v254, -v94
v_fmamk_f32 v95, v92, 0x3cd80000, v93
v_cos_f32 v239, v95
v_sin_f32 v255, -v95
v_mov_b32 v184, 126992
s_lshl_b32 s64, s66, 2
v_add_u32 v185, s64, v184
v_and_b32 v8, 31, v1
v_lshrrev_b32 v9, 5, v1
v_and_b32 v10, 1, v1
v_lshrrev_b32 v11, 1, v8
v_lshlrev_b32 v4, 6, v11
v_lshl_add_u32 v4, v10, 4, v4
v_lshl_add_u32 v4, v9, 12, v4
v_add_u32 v11, v11, v10
v_lshlrev_b32 v11, 6, v11
v_lshl_add_u32 v11, v10, 4, v11
v_lshl_add_u32 v11, v9, 12, v11
v_sub_u32 v5, 5168, v11
v_bfe_u32 v11, v4, 7, 1
v_lshlrev_b32 v11, 5, v11
v_xor_b32 v4, v4, v11
v_bfe_u32 v11, v5, 7, 1
v_lshlrev_b32 v11, 5, v11
v_xor_b32 v5, v5, v11
v_add_u32 v6, 11264, v5
v_and_b32 v6, 0x3fff, v6
s_add_u32 s64, s64, 98304
v_add_u32 v4, s64, v4
v_add_u32 v5, s64, v5
v_add_u32 v6, s64, v6
v_bfe_u32 v11, v1, 3, 1
v_lshlrev_b32 v11, 5, v11
v_xor_b32 v7, v2, v11
v_bfe_u32 v12, v1, 2, 1
v_mul_u32_u24 v12, 2176, v12
v_bfe_u32 v13, v1, 3, 1
v_lshl_add_u32 v12, v13, 6, v12
v_lshl_add_u32 v12, v9, 8, v12
v_bfe_u32 v13, v1, 4, 1
v_lshl_add_u32 v12, v13, 5, v12
v_and_b32 v13, 3, v1
v_lshl_add_u32 v12, v13, 3, v12
v_add_u32 v12, s68, v12
v_xor_b32 v13, 128, v12
s_lshl_b32 s64, s2, 14
s_lshl_b32 s65, s66, 12
s_add_u32 s64, s64, s65
s_add_u32 s42, s64, 16777216
s_add_u32 s40, s32, s42
s_addc_u32 s41, s33, 0
s_mov_b32 s42, 4096
s_mov_b32 s43, 0x20000
s_add_u32 s46, s64, 16777216
s_add_u32 s44, s32, s46
s_addc_u32 s45, s33, 0
s_mov_b32 s46, 4096
s_mov_b32 s47, 0x20000
v_and_b32 v14, 7, v1
v_lshrrev_b32 v15, 3, v1
v_xor_b32 v16, v14, v15
v_lshlrev_b32 v16, 4, v16
v_lshl_add_u32 v16, v14, 11, v16
s_lshr_b32 s64, s66, 1
s_lshl_b32 s64, s64, 7
s_and_b32 s65, s66, 1
s_lshl_b32 s65, s65, 3
s_add_u32 s64, s64, s65
s_add_u32 s64, s64, 147456
v_add_u32 v16, s64, v16
v_lshlrev_b32 v15, 16, v15
v_lshl_add_u32 v15, v14, 4, v15
s_lshl_b32 s64, s63, 7
s_lshr_b32 s65, s66, 1
s_lshl_b32 s65, s65, 6
s_add_u32 s64, s64, s65
s_and_b32 s65, s66, 1
s_lshl_b32 s65, s65, 2
s_add_u32 s64, s64, s65
s_mul_i32 s64, s64, 8192
s_lshr_b32 s65, s60, 2
s_mul_i32 s65, s65, 0
s_add_u32 s64, s64, s65
s_lshl_b32 s65, s60, 10
s_add_u32 s64, s64, s65
s_lshl_b32 s65, s61, 9
s_add_u32 s64, s64, s65
s_lshl_b32 s65, s62, 7
s_add_u32 s64, s64, s65
s_add_u32 s58, s64, 25182208
s_add_u32 s56, s32, s58
s_addc_u32 s57, s33, 0
s_sub_u32 s58, 4194304, s64
s_mov_b32 s59, 0x20000
s_lshl_b32 s64, s35, 18
s_lshl_b32 s65, s36, 17
s_add_u32 s12, s10, s64
s_addc_u32 s13, s11, 0
s_mov_b32 s14, 262144
s_mov_b32 s15, 0x20000
s_bitcmp1_b32 s66, 0
s_cselect_b32 s8, s18, s16
s_cselect_b32 s9, s19, s17
s_add_u32 s20, s8, s65
s_addc_u32 s21, s9, 0
s_mov_b32 s22, 131072
s_mov_b32 s23, 0x20000
s_mul_i32 s16, s35, 128
s_mul_i32 s64, s36, 128
s_add_u32 s16, s16, s64
s_lshl_b32 s17, s66, 12
s_lshr_b32 s64, s66, 1
s_and_b32 s65, s66, 1
v_lshrrev_b32 v96, 5, v1
v_bfe_u32 v97, v1, 3, 2
v_and_b32 v98, 1, v97
v_lshrrev_b32 v99, 1, v97
v_lshlrev_b32 v100, 4, v96
v_lshl_add_u32 v100, v98, 3, v100
v_add_u32 v100, v100, v99
s_lshl_b32 s92, s64, 6
s_lshl_b32 s19, s65, 2
s_add_u32 s92, s92, s19
v_add_u32 v100, s92, v100
v_lshlrev_b32 v100, 11, v100
s_lshl_b32 s92, s64, 5
v_lshl_add_u32 v101, v96, 3, v97
v_add_u32 v101, s92, v101
v_lshlrev_b32 v101, 11, v101
v_and_b32 v98, 7, v1
v_lshrrev_b32 v99, 4, v1
v_xor_b32 v98, v98, v99
v_lshlrev_b32 v98, 4, v98
v_xor_b32 v99, 64, v98
v_add_u32 v176, v100, v98
v_add_u32 v177, v100, v99
v_add_u32 v177, 64512, v177
v_add_u32 v178, v101, v98
v_add_u32 v179, v101, v99
v_add_u32 v179, 31744, v179
s_lshl_b32 s92, s2, 3
s_add_u32 s92, s92, s34
s_cmp_lg_u32 s92, 4
s_cbranch_scc1 L_nn5
s_waitcnt vmcnt(8) lgkmcnt(0)
s_add_u32 s3, s3, 1
s_cmp_eq_u32 s3, 0
s_cselect_b32 s3, 1, s3
v_mov_b32 v23, s3
v_mov_b32 v22, 0
s_mov_b64 exec, 1
global_store_dword v22, v23, s[30:31] sc1
global_store_dword v22, v23, s[32:33] offset:0
s_mov_b64 exec, -1
L_nn5:
s_waitcnt vmcnt(4)
ds_read_b64_tr_b16 v[24:25], v12 offset:0
ds_read_b64_tr_b16 v[26:27], v13 offset:0
ds_read_b64_tr_b16 v[28:29], v12 offset:512
ds_read_b64_tr_b16 v[30:31], v13 offset:512
ds_read_b64_tr_b16 v[32:33], v12 offset:1024
ds_read_b64_tr_b16 v[34:35], v13 offset:1024
ds_read_b64_tr_b16 v[36:37], v12 offset:1536
ds_read_b64_tr_b16 v[38:39], v13 offset:1536
s_waitcnt lgkmcnt(0)
v_mfma_f32_32x32x16_bf16 v[40:55], v[24:27], v[192:195], 0
v_mfma_f32_32x32x16_bf16 v[40:55], v[28:31], v[196:199], v[40:55]
v_mfma_f32_32x32x16_bf16 v[40:55], v[32:35], v[200:203], v[40:55]
v_mfma_f32_32x32x16_bf16 v[40:55], v[36:39], v[204:207], v[40:55]
v_mfma_f32_32x32x16_bf16 v[56:71], v[24:27], v[208:211], 0
v_mfma_f32_32x32x16_bf16 v[56:71], v[28:31], v[212:215], v[56:71]
v_mfma_f32_32x32x16_bf16 v[56:71], v[32:35], v[216:219], v[56:71]
v_mfma_f32_32x32x16_bf16 v[56:71], v[36:39], v[220:223], v[56:71]
s_nop 7
v_mul_f32 v168, v40, v224
v_mul_f32 v169, v40, v240
s_nop 1
v_fma_f32 v168, -v56, v240, v168
v_fmac_f32 v169, v56, v224
v_cvt_pk_bf16_f32 v72, v168, v169
v_mul_f32 v170, v41, v225
v_mul_f32 v171, v41, v241
v_fma_f32 v170, -v57, v241, v170
v_fmac_f32 v171, v57, v225
v_cvt_pk_bf16_f32 v73, v170, v171
v_mul_f32 v172, v42, v226
v_mul_f32 v173, v42, v242
v_fma_f32 v172, -v58, v242, v172
v_fmac_f32 v173, v58, v226
v_cvt_pk_bf16_f32 v74, v172, v173
v_mul_f32 v174, v43, v227
v_mul_f32 v175, v43, v243
v_fma_f32 v174, -v59, v243, v174
v_fmac_f32 v175, v59, v227
v_cvt_pk_bf16_f32 v75, v174, v175
v_mul_f32 v168, v44, v228
v_mul_f32 v169, v44, v244
v_fma_f32 v168, -v60, v244, v168
v_fmac_f32 v169, v60, v228
v_cvt_pk_bf16_f32 v76, v168, v169
v_mul_f32 v170, v45, v229
v_mul_f32 v171, v45, v245
v_fma_f32 v170, -v61, v245, v170
v_fmac_f32 v171, v61, v229
v_cvt_pk_bf16_f32 v77, v170, v171
v_mul_f32 v172, v46, v230
v_mul_f32 v173, v46, v246
v_fma_f32 v172, -v62, v246, v172
v_fmac_f32 v173, v62, v230
v_cvt_pk_bf16_f32 v78, v172, v173
v_mul_f32 v174, v47, v231
v_mul_f32 v175, v47, v247
v_fma_f32 v174, -v63, v247, v174
v_fmac_f32 v175, v63, v231
v_cvt_pk_bf16_f32 v79, v174, v175
v_mul_f32 v168, v48, v232
v_mul_f32 v169, v48, v248
v_fma_f32 v168, -v64, v248, v168
v_fmac_f32 v169, v64, v232
v_cvt_pk_bf16_f32 v80, v168, v169
v_mul_f32 v170, v49, v233
v_mul_f32 v171, v49, v249
v_fma_f32 v170, -v65, v249, v170
v_fmac_f32 v171, v65, v233
v_cvt_pk_bf16_f32 v81, v170, v171
v_mul_f32 v172, v50, v234
v_mul_f32 v173, v50, v250
v_fma_f32 v172, -v66, v250, v172
v_fmac_f32 v173, v66, v234
v_cvt_pk_bf16_f32 v82, v172, v173
v_mul_f32 v174, v51, v235
v_mul_f32 v175, v51, v251
v_fma_f32 v174, -v67, v251, v174
v_fmac_f32 v175, v67, v235
v_cvt_pk_bf16_f32 v83, v174, v175
v_mul_f32 v168, v52, v236
v_mul_f32 v169, v52, v252
v_fma_f32 v168, -v68, v252, v168
v_fmac_f32 v169, v68, v236
v_cvt_pk_bf16_f32 v84, v168, v169
v_mul_f32 v170, v53, v237
v_mul_f32 v171, v53, v253
v_fma_f32 v170, -v69, v253, v170
v_fmac_f32 v171, v69, v237
v_cvt_pk_bf16_f32 v85, v170, v171
v_mul_f32 v172, v54, v238
v_mul_f32 v173, v54, v254
v_fma_f32 v172, -v70, v254, v172
v_fmac_f32 v173, v70, v238
v_cvt_pk_bf16_f32 v86, v172, v173
v_mul_f32 v174, v55, v239
v_mul_f32 v175, v55, v255
v_fma_f32 v174, -v71, v255, v174
v_fmac_f32 v175, v71, v239
v_cvt_pk_bf16_f32 v87, v174, v175
v_mfma_f32_32x32x16_bf16 v[40:55], v[192:195], v[72:75], 0
v_mfma_f32_32x32x16_bf16 v[40:55], v[196:199], v[76:79], v[40:55]
v_mfma_f32_32x32x16_bf16 v[40:55], v[200:203], v[80:83], v[40:55]
v_mfma_f32_32x32x16_bf16 v[40:55], v[204:207], v[84:87], v[40:55]
v_mfma_f32_32x32x16_bf16 v[56:71], v[208:211], v[72:75], 0
v_mfma_f32_32x32x16_bf16 v[56:71], v[212:215], v[76:79], v[56:71]
v_mfma_f32_32x32x16_bf16 v[56:71], v[216:219], v[80:83], v[56:71]
v_mfma_f32_32x32x16_bf16 v[56:71], v[220:223], v[84:87], v[56:71]
s_lshl_b32 s92, s66, 12
s_add_u32 s92, s92, 98304
v_add_u32 v8, s92, v7
s_nop 8
v_cvt_pk_bf16_f32 v72, v40, v56
ds_write_b32 v4, v72 offset:0
v_cvt_pk_bf16_f32 v73, v41, v57
ds_write_b32 v4, v73 offset:1024
v_cvt_pk_bf16_f32 v74, v42, v58
ds_write_b32 v4, v74 offset:2048
v_cvt_pk_bf16_f32 v75, v43, v59
ds_write_b32 v4, v75 offset:3072
v_cvt_pk_bf16_f32 v76, v44, v60
ds_write_b32 v4, v76 offset:8192
v_cvt_pk_bf16_f32 v77, v45, v61
ds_write_b32 v4, v77 offset:9216
v_cvt_pk_bf16_f32 v78, v46, v62
ds_write_b32 v4, v78 offset:10240
v_cvt_pk_bf16_f32 v79, v47, v63
ds_write_b32 v4, v79 offset:11264
v_cvt_pk_bf16_f32 v80, v48, v64
ds_write_b32 v6, v80 offset:0
v_cvt_pk_bf16_f32 v81, v49, v65
ds_write_b32 v5, v81 offset:10240
v_cvt_pk_bf16_f32 v82, v50, v66
ds_write_b32 v5, v82 offset:9216
v_cvt_pk_bf16_f32 v83, v51, v67
ds_write_b32 v5, v83 offset:8192
v_cvt_pk_bf16_f32 v84, v52, v68
ds_write_b32 v5, v84 offset:3072
v_cvt_pk_bf16_f32 v85, v53, v69
ds_write_b32 v5, v85 offset:2048
v_cvt_pk_bf16_f32 v86, v54, v70
ds_write_b32 v5, v86 offset:1024
v_cvt_pk_bf16_f32 v87, v55, v71
ds_write_b32 v5, v87 offset:0
s_waitcnt vmcnt(0)
s_waitcnt lgkmcnt(0)
v_mov_b32 v190, 1
s_mov_b64 exec, 1
ds_write_b32 v185, v190
s_mov_b64 exec, -1
L_lc6:
ds_read_b128 v[186:189], v184
s_waitcnt lgkmcnt(0)
v_min3_u32 v186, v186, v187, v188
v_min_u32 v186, v186, v189
s_nop 0
v_readfirstlane_b32 s92, v186
s_nop 0
s_cmp_ge_u32 s92, 1
s_cbranch_scc1 L_lcd7
s_sleep 1
s_branch L_lc6
L_lcd7:
ds_read_b128 v[72:75], v8 offset:0
ds_read_b128 v[76:79], v8 offset:1024
ds_read_b128 v[80:83], v8 offset:2048
ds_read_b128 v[84:87], v8 offset:3072
ds_read_b64 v[104:105], v16 offset:0
ds_read_b64 v[106:107], v16 offset:256
ds_read_b64 v[108:109], v16 offset:512
ds_read_b64 v[110:111], v16 offset:768
ds_read_b64 v[112:113], v16 offset:1024
ds_read_b64 v[114:115], v16 offset:1280
ds_read_b64 v[116:117], v16 offset:1536
ds_read_b64 v[118:119], v16 offset:1792
v_add_u32 v4, 32768, v4
v_add_u32 v5, 32768, v5
v_add_u32 v6, 32768, v6
s_waitcnt lgkmcnt(0)
v_mov_b32 v190, 2
s_mov_b64 exec, 1
ds_write_b32 v185, v190
s_mov_b64 exec, -1
s_mov_b32 s64, 0x05040100
s_mov_b32 s65, 0x07060302
v_lshlrev_b32 v88, 16, v88
v_lshlrev_b32 v89, 16, v89
v_lshlrev_b32 v9, 1, v1
v_add_f32_dpp v90, v88, v88 quad_perm:[1,0,3,2] row_mask:0xf bank_mask:0xf
v_subrev_f32_dpp v91, v89, v89 quad_perm:[1,0,3,2] row_mask:0xf bank_mask:0xf
v_mul_f32 v90, 0.5, v90
v_mul_f32 v91, 0.5, v91
v_cvt_pk_bf16_f32 v88, v90, v91
v_perm_b32 v120, v112, v104, s64
v_perm_b32 v121, v116, v108, s64
v_perm_b32 v122, v114, v106, s64
v_perm_b32 v123, v118, v110, s64
v_perm_b32 v124, v112, v104, s65
v_perm_b32 v125, v116, v108, s65
v_perm_b32 v126, v114, v106, s65
v_perm_b32 v127, v118, v110, s65
v_perm_b32 v128, v113, v105, s64
v_perm_b32 v129, v117, v109, s64
v_perm_b32 v130, v115, v107, s64
v_perm_b32 v131, v119, v111, s64
v_perm_b32 v132, v113, v105, s65
v_perm_b32 v133, v117, v109, s65
v_perm_b32 v134, v115, v107, s65
v_perm_b32 v135, v119, v111, s65
s_setprio 3
s_barrier
s_add_u32 s8, s16, 256
s_and_b32 s8, s8, 0x7ff
s_add_u32 s9, s8, 2048
s_add_u32 s10, s8, 6144
s_add_u32 m0, s17, 65536
s_nop 0
buffer_load_dwordx4 v176, s[12:15], s8 offen offset:0 lds
buffer_load_dwordx4 v177, s[12:15], s8 offen offset:1024 lds
buffer_load_dwordx4 v176, s[12:15], s9 offen offset:2048 lds
buffer_load_dwordx4 v177, s[12:15], s9 offen offset:3072 lds
s_add_u32 m0, s17, 81920
s_nop 0
buffer_load_dwordx4 v178, s[20:23], s8 offen offset:0 lds
buffer_load_dwordx4 v179, s[20:23], s8 offen offset:1024 lds
buffer_load_dwordx4 v178, s[20:23], s10 offen offset:2048 lds
buffer_load_dwordx4 v179, s[20:23], s10 offen offset:3072 lds
v_and_b32 v92, 31, v1
v_cvt_f32_u32 v92, v92
v_lshrrev_b32 v93, 5, v1
v_lshlrev_b32 v93, 2, v93
v_cvt_f32_u32 v93, v93
v_mul_f32 v92, 0x3a000000, v92
v_fmamk_f32 v93, v93, 0x3c800000, v92
v_add_f32 v94, 0x0, v93
v_cos_f32 v136, v94
v_sin_f32 v152, -v94
v_add_f32 v95, 0x3c800000, v93
v_cos_f32 v137, v95
v_sin_f32 v153, -v95
v_add_f32 v94, 0x3d000000, v93
s_barrier
s_add_u32 s8, s16, 384
s_and_b32 s8, s8, 0x7ff
s_add_u32 s9, s8, 2048
s_add_u32 s10, s8, 6144
s_add_u32 m0, s17, 0
s_nop 0
buffer_load_dwordx4 v176, s[12:15], s8 offen offset:0 lds
buffer_load_dwordx4 v177, s[12:15], s8 offen offset:1024 lds
buffer_load_dwordx4 v176, s[12:15], s9 offen offset:2048 lds
buffer_load_dwordx4 v177, s[12:15], s9 offen offset:3072 lds
s_add_u32 m0, s17, 16384
s_nop 0
buffer_load_dwordx4 v178, s[20:23], s8 offen offset:0 lds
buffer_load_dwordx4 v179, s[20:23], s8 offen offset:1024 lds
buffer_load_dwordx4 v178, s[20:23], s10 offen offset:2048 lds
buffer_load_dwordx4 v179, s[20:23], s10 offen offset:3072 lds
buffer_store_dwordx4 v[72:75], v2, s[40:43], 0 offen offset:0 sc1
buffer_store_dwordx4 v[76:79], v2, s[40:43], 0 offen offset:1024 sc1
buffer_store_dwordx4 v[80:83], v2, s[40:43], 0 offen offset:2048 sc1
buffer_store_dwordx4 v[84:87], v2, s[40:43], 0 offen offset:3072 sc1
s_cmp_lg_u32 s66, 3
s_cbranch_scc1 L_nw8
s_lshr_b32 s64, s2, 7
s_mul_i32 s64, s64, 8192
s_bfe_u32 s65, s2, 0x10006
s_mul_i32 s65, s65, 4096
s_add_u32 s64, s64, s65
s_and_b32 s65, s2, 63
s_lshl_b32 s65, s65, 6
s_add_u32 s64, s64, s65
s_add_u32 s54, s64, 25165824
s_add_u32 s52, s32, s54
s_addc_u32 s53, s33, 0
s_mov_b32 s54, 64
s_mov_b32 s55, 0x20000
s_mov_b32 exec_lo, 0x55555555
s_mov_b32 exec_hi, 0
buffer_store_dword v88, v9, s[52:55], 0 offen sc1
s_mov_b64 exec, -1
L_nw8:
s_mov_b32 s92, 0
buffer_store_dwordx4 v[120:123], v15, s[56:59], s92 offen sc1
s_mov_b32 s92, 8192
buffer_store_dwordx4 v[124:127], v15, s[56:59], s92 offen sc1
s_mov_b32 s92, 16384
buffer_store_dwordx4 v[128:131], v15, s[56:59], s92 offen sc1
s_mov_b32 s92, 24576
buffer_store_dwordx4 v[132:135], v15, s[56:59], s92 offen sc1
v_cos_f32 v138, v94
v_sin_f32 v154, -v94
v_add_f32 v95, 0x3d400000, v93
v_cos_f32 v139, v95
v_sin_f32 v155, -v95
v_add_f32 v94, 0x3e000000, v93
v_cos_f32 v140, v94
v_sin_f32 v156, -v94
v_add_f32 v95, 0x3e100000, v93
v_cos_f32 v141, v95
v_sin_f32 v157, -v95
v_add_f32 v94, 0x3e200000, v93
v_cos_f32 v142, v94
v_sin_f32 v158, -v94
s_waitcnt vmcnt(16)
s_barrier
s_add_u32 s8, s16, 512
s_and_b32 s8, s8, 0x7ff
s_add_u32 s9, s8, 2048
s_add_u32 s10, s8, 6144
s_add_u32 m0, s17, 32768
s_nop 0
buffer_load_dwordx4 v176, s[12:15], s8 offen offset:0 lds
buffer_load_dwordx4 v177, s[12:15], s8 offen offset:1024 lds
buffer_load_dwordx4 v176, s[12:15], s9 offen offset:2048 lds
buffer_load_dwordx4 v177, s[12:15], s9 offen offset:3072 lds
s_add_u32 m0, s17, 49152
s_nop 0
buffer_load_dwordx4 v178, s[20:23], s8 offen offset:0 lds
buffer_load_dwordx4 v179, s[20:23], s8 offen offset:1024 lds
buffer_load_dwordx4 v178, s[20:23], s10 offen offset:2048 lds
buffer_load_dwordx4 v179, s[20:23], s10 offen offset:3072 lds
v_mov_b32 v20, 0
global_load_dword v21, v20, s[30:31] sc1
v_add_f32 v95, 0x3e300000, v93
v_cos_f32 v143, v95
v_sin_f32 v159, -v95
v_add_f32 v94, 0x3e800000, v93
v_cos_f32 v144, v94
v_sin_f32 v160, -v94
v_add_f32 v95, 0x3e880000, v93
v_cos_f32 v145, v95
v_sin_f32 v161, -v95
v_add_f32 v94, 0x3e900000, v93
v_cos_f32 v146, v94
v_sin_f32 v162, -v94
v_add_f32 v95, 0x3e980000, v93
v_cos_f32 v147, v95
s_waitcnt vmcnt(17)
s_barrier
s_add_u32 s8, s16, 640
s_and_b32 s8, s8, 0x7ff
s_add_u32 s9, s8, 2048
s_add_u32 s10, s8, 6144
s_add_u32 m0, s17, 65536
s_nop 0
buffer_load_dwordx4 v176, s[12:15], s8 offen offset:0 lds
buffer_load_dwordx4 v177, s[12:15], s8 offen offset:1024 lds
buffer_load_dwordx4 v176, s[12:15], s9 offen offset:2048 lds
buffer_load_dwordx4 v177, s[12:15], s9 offen offset:3072 lds
s_add_u32 m0, s17, 81920
s_nop 0
buffer_load_dwordx4 v178, s[20:23], s8 offen offset:0 lds
buffer_load_dwordx4 v179, s[20:23], s8 offen offset:1024 lds
buffer_load_dwordx4 v178, s[20:23], s10 offen offset:2048 lds
buffer_load_dwordx4 v179, s[20:23], s10 offen offset:3072 lds
v_sin_f32 v163, -v95
v_add_f32 v94, 0x3ec00000, v93
v_cos_f32 v148, v94
v_sin_f32 v164, -v94
v_add_f32 v95, 0x3ec80000, v93
v_cos_f32 v149, v95
v_sin_f32 v165, -v95
v_add_f32 v94, 0x3ed00000, v93
v_cos_f32 v150, v94
v_sin_f32 v166, -v94
v_add_f32 v95, 0x3ed80000, v93
v_cos_f32 v151, v95
v_sin_f32 v167, -v95
s_waitcnt vmcnt(9)
s_barrier
s_add_u32 s8, s16, 768
s_and_b32 s8, s8, 0x7ff
s_add_u32 s9, s8, 2048
s_add_u32 s10, s8, 6144
s_add_u32 m0, s17, 0
s_nop 0
buffer_load_dwordx4 v176, s[12:15], s8 offen offset:0 lds
buffer_load_dwordx4 v177, s[12:15], s8 offen offset:1024 lds
buffer_load_dwordx4 v176, s[12:15], s9 offen offset:2048 lds
buffer_load_dwordx4 v177, s[12:15], s9 offen offset:3072 lds
s_add_u32 m0, s17, 16384
s_nop 0
buffer_load_dwordx4 v178, s[20:23], s8 offen offset:0 lds
buffer_load_dwordx4 v179, s[20:23], s8 offen offset:1024 lds
buffer_load_dwordx4 v178, s[20:23], s10 offen offset:2048 lds
buffer_load_dwordx4 v179, s[20:23], s10 offen offset:3072 lds
s_and_b32 s60, s2, 7
s_lshl_b32 s60, s60, 5
s_lshr_b32 s64, s2, 3
s_add_u32 s60, s60, s64
s_lshr_b32 s64, s66, 1
s_xor_b32 s64, s64, s66
s_and_b32 s64, s64, 1
s_or_b32 s65, s64, s60
s_cmp_eq_u32 s65, 0
s_cselect_b32 s61, 1, 0
s_lshl_b32 s65, s60, 1
s_add_u32 s64, s64, s65
s_mul_i32 s64, s64, 8192
s_add_u32 s64, s64, 25182208
s_lshr_b32 s65, s66, 1
s_mul_i32 s69, s65, 8192
s_add_u32 s69, s69, 25165824
s_cmp_eq_u32 s61, 1
s_cselect_b32 s64, s69, s64
s_cselect_b32 s65, 0, s65
s_cselect_b32 s90, s32, s32
s_cselect_b32 s91, s33, s33
s_lshl_b32 s62, s65, 31
s_or_b32 s63, s62, 0x3f800000
s_add_u32 s48, s90, s64
s_addc_u32 s49, s91, 0
s_mov_b32 s50, 8192
s_mov_b32 s51, 0x20000
s_lshl_b32 s64, s66, 20
s_lshl_b32 s65, s60, 6
s_add_u32 s64, s64, s65
s_add_u32 s54, s64, 16777216
s_add_u32 s52, s32, s54
s_addc_u32 s53, s33, 0
s_sub_u32 s54, 1048576, s65
s_mov_b32 s55, 0x20000
s_add_u32 s58, s64, 16777216
s_add_u32 s56, s32, s58
s_addc_u32 s57, s33, 0
s_sub_u32 s58, 1048576, s65
s_mov_b32 s59, 0x20000
v_lshrrev_b32 v8, 2, v1
v_lshlrev_b32 v8, 14, v8
v_and_b32 v9, 3, v1
v_lshrrev_b32 v10, 4, v1
v_xor_b32 v9, v9, v10
v_lshl_add_u32 v14, v9, 4, v8
v_and_b32 v8, 31, v1
v_bfe_u32 v9, v1, 2, 2
v_xor_b32 v9, s66, v9
v_lshlrev_b32 v9, 4, v9
v_lshl_add_u32 v9, v8, 6, v9
v_lshrrev_b32 v8, 5, v1
v_lshl_add_u32 v9, v8, 11, v9
v_add_u32 v15, 131072, v9
s_lshl_b32 s64, s66, 13
s_add_u32 s64, s64, 131072
v_add_u32 v16, s64, v2
s_xor_b32 s65, s64, 24576
s_cmp_eq_u32 s61, 1
s_cselect_b32 s65, s64, s65
v_add_u32 v17, s65, v2
v_add_u32 v18, s68, v2
s_lshr_b32 s64, s66, 1
s_xor_b32 s64, s64, s66
s_and_b32 s64, s64, 1
s_lshl_b32 s69, s64, 13
s_add_u32 s69, s69, 147456
v_add_u32 v19, s69, v2
v_mul_f32 v136, s63, v136
v_mul_f32 v137, s63, v137
v_mul_f32 v138, s63, v138
v_mul_f32 v139, s63, v139
v_mul_f32 v140, s63, v140
v_mul_f32 v141, s63, v141
v_mul_f32 v142, s63, v142
v_mul_f32 v143, s63, v143
v_mul_f32 v144, s63, v144
v_mul_f32 v145, s63, v145
v_mul_f32 v146, s63, v146
v_mul_f32 v147, s63, v147
v_mul_f32 v148, s63, v148
v_mul_f32 v149, s63, v149
v_mul_f32 v150, s63, v150
v_mul_f32 v151, s63, v151
v_mul_f32 v152, s63, v152
v_mul_f32 v153, s63, v153
v_mul_f32 v154, s63, v154
v_mul_f32 v155, s63, v155
v_mul_f32 v156, s63, v156
v_mul_f32 v157, s63, v157
v_mul_f32 v158, s63, v158
v_mul_f32 v159, s63, v159
v_mul_f32 v160, s63, v160
v_mul_f32 v161, s63, v161
v_mul_f32 v162, s63, v162
v_mul_f32 v163, s63, v163
v_mul_f32 v164, s63, v164
v_mul_f32 v165, s63, v165
v_mul_f32 v166, s63, v166
v_mul_f32 v167, s63, v167
s_waitcnt vmcnt(8)
s_barrier
s_add_u32 s8, s16, 896
s_and_b32 s8, s8, 0x7ff
s_add_u32 s9, s8, 2048
s_add_u32 s10, s8, 6144
s_add_u32 m0, s17, 32768
s_nop 0
buffer_load_dwordx4 v176, s[12:15], s8 offen offset:0 lds
buffer_load_dwordx4 v177, s[12:15], s8 offen offset:1024 lds
buffer_load_dwordx4 v176, s[12:15], s9 offen offset:2048 lds
buffer_load_dwordx4 v177, s[12:15], s9 offen offset:3072 lds
s_add_u32 m0, s17, 49152
s_nop 0
buffer_load_dwordx4 v178, s[20:23], s8 offen offset:0 lds
buffer_load_dwordx4 v179, s[20:23], s8 offen offset:1024 lds
buffer_load_dwordx4 v178, s[20:23], s10 offen offset:2048 lds
buffer_load_dwordx4 v179, s[20:23], s10 offen offset:3072 lds
v_readfirstlane_b32 s37, v21
s_nop 0
s_cmp_lg_u32 s37, 0
s_cbranch_scc1 L_sg10
v_mov_b32 v20, 0
L_n11:
global_load_dword v21, v20, s[30:31] sc1
s_waitcnt vmcnt(0)
v_readfirstlane_b32 s37, v21
s_nop 0
s_cmp_eq_u32 s37, 0
s_cbranch_scc1 L_n11
L_sg10:
s_cmp_lg_u32 s66, 0
s_cbranch_scc1 L_sg9
s_and_b32 s64, s2, 15
s_lshl_b32 s65, s64, 7
s_add_u32 s65, s65, 4096
s_add_u32 s90, s32, s65
s_addc_u32 s91, s33, 0
s_mov_b32 s18, 1
s_atomic_add s18, s[90:91], 0x0 glc
L_sg9:
s_waitcnt vmcnt(8)
s_barrier
s_add_u32 s8, s16, 1024
s_and_b32 s8, s8, 0x7ff
s_add_u32 s9, s8, 2048
s_add_u32 s10, s8, 6144
s_add_u32 m0, s17, 65536
s_nop 0
buffer_load_dwordx4 v176, s[12:15], s8 offen offset:0 lds
buffer_load_dwordx4 v177, s[12:15], s8 offen offset:1024 lds
buffer_load_dwordx4 v176, s[12:15], s9 offen offset:2048 lds
buffer_load_dwordx4 v177, s[12:15], s9 offen offset:3072 lds
s_add_u32 m0, s17, 81920
s_nop 0
buffer_load_dwordx4 v178, s[20:23], s8 offen offset:0 lds
buffer_load_dwordx4 v179, s[20:23], s8 offen offset:1024 lds
buffer_load_dwordx4 v178, s[20:23], s10 offen offset:2048 lds
buffer_load_dwordx4 v179, s[20:23], s10 offen offset:3072 lds
s_waitcnt vmcnt(8)
s_barrier
s_add_u32 s8, s16, 1152
s_and_b32 s8, s8, 0x7ff
s_add_u32 s9, s8, 2048
s_add_u32 s10, s8, 6144
s_add_u32 m0, s17, 0
s_nop 0
buffer_load_dwordx4 v176, s[12:15], s8 offen offset:0 lds
buffer_load_dwordx4 v177, s[12:15], s8 offen offset:1024 lds
buffer_load_dwordx4 v176, s[12:15], s9 offen offset:2048 lds
buffer_load_dwordx4 v177, s[12:15], s9 offen offset:3072 lds
s_add_u32 m0, s17, 16384
s_nop 0
buffer_load_dwordx4 v178, s[20:23], s8 offen offset:0 lds
buffer_load_dwordx4 v179, s[20:23], s8 offen offset:1024 lds
buffer_load_dwordx4 v178, s[20:23], s10 offen offset:2048 lds
buffer_load_dwordx4 v179, s[20:23], s10 offen offset:3072 lds
s_cmp_lg_u32 s66, 0
s_cbranch_scc1 L_sg13
s_waitcnt lgkmcnt(0)
s_cmp_lg_u32 s18, 15
s_cbranch_scc1 L_sg13
s_and_b32 s64, s2, 15
s_lshl_b32 s64, s64, 2
s_add_u32 s64, s64, 540672
v_lshl_add_u32 v22, v1, 7, s64
v_mov_b32 v23, s37
global_store_dword v22, v23, s[32:33] sc1
L_sg13:
s_waitcnt vmcnt(8)
s_barrier
s_add_u32 s8, s16, 1280
s_and_b32 s8, s8, 0x7ff
s_add_u32 s9, s8, 2048
s_add_u32 s10, s8, 6144
s_add_u32 m0, s17, 32768
s_nop 0
buffer_load_dwordx4 v176, s[12:15], s8 offen offset:0 lds
buffer_load_dwordx4 v177, s[12:15], s8 offen offset:1024 lds
buffer_load_dwordx4 v176, s[12:15], s9 offen offset:2048 lds
buffer_load_dwordx4 v177, s[12:15], s9 offen offset:3072 lds
s_add_u32 m0, s17, 49152
s_nop 0
buffer_load_dwordx4 v178, s[20:23], s8 offen offset:0 lds
buffer_load_dwordx4 v179, s[20:23], s8 offen offset:1024 lds
buffer_load_dwordx4 v178, s[20:23], s10 offen offset:2048 lds
buffer_load_dwordx4 v179, s[20:23], s10 offen offset:3072 lds
s_waitcnt vmcnt(8)
s_barrier
s_add_u32 s8, s16, 1408
s_and_b32 s8, s8, 0x7ff
s_add_u32 s9, s8, 2048
s_add_u32 s10, s8, 6144
s_add_u32 m0, s17, 65536
s_nop 0
buffer_load_dwordx4 v176, s[12:15], s8 offen offset:0 lds
buffer_load_dwordx4 v177, s[12:15], s8 offen offset:1024 lds
buffer_load_dwordx4 v176, s[12:15], s9 offen offset:2048 lds
buffer_load_dwordx4 v177, s[12:15], s9 offen offset:3072 lds
s_add_u32 m0, s17, 81920
s_nop 0
buffer_load_dwordx4 v178, s[20:23], s8 offen offset:0 lds
buffer_load_dwordx4 v179, s[20:23], s8 offen offset:1024 lds
buffer_load_dwordx4 v178, s[20:23], s10 offen offset:2048 lds
buffer_load_dwordx4 v179, s[20:23], s10 offen offset:3072 lds
s_waitcnt vmcnt(8)
s_barrier
s_add_u32 s8, s16, 1536
s_and_b32 s8, s8, 0x7ff
s_add_u32 s9, s8, 2048
s_add_u32 s10, s8, 6144
s_add_u32 m0, s17, 0
s_nop 0
buffer_load_dwordx4 v176, s[12:15], s8 offen offset:0 lds
buffer_load_dwordx4 v177, s[12:15], s8 offen offset:1024 lds
buffer_load_dwordx4 v176, s[12:15], s9 offen offset:2048 lds
buffer_load_dwordx4 v177, s[12:15], s9 offen offset:3072 lds
s_add_u32 m0, s17, 16384
s_nop 0
buffer_load_dwordx4 v178, s[20:23], s8 offen offset:0 lds
buffer_load_dwordx4 v179, s[20:23], s8 offen offset:1024 lds
buffer_load_dwordx4 v178, s[20:23], s10 offen offset:2048 lds
buffer_load_dwordx4 v179, s[20:23], s10 offen offset:3072 lds
s_waitcnt vmcnt(8)
s_barrier
s_add_u32 s8, s16, 1664
s_and_b32 s8, s8, 0x7ff
s_add_u32 s9, s8, 2048
s_add_u32 s10, s8, 6144
s_add_u32 m0, s17, 32768
s_nop 0
buffer_load_dwordx4 v176, s[12:15], s8 offen offset:0 lds
buffer_load_dwordx4 v177, s[12:15], s8 offen offset:1024 lds
buffer_load_dwordx4 v176, s[12:15], s9 offen offset:2048 lds
buffer_load_dwordx4 v177, s[12:15], s9 offen offset:3072 lds
s_add_u32 m0, s17, 49152
s_nop 0
buffer_load_dwordx4 v178, s[20:23], s8 offen offset:0 lds
buffer_load_dwordx4 v179, s[20:23], s8 offen offset:1024 lds
buffer_load_dwordx4 v178, s[20:23], s10 offen offset:2048 lds
buffer_load_dwordx4 v179, s[20:23], s10 offen offset:3072 lds
s_waitcnt vmcnt(8)
s_barrier
s_add_u32 s8, s16, 1792
s_and_b32 s8, s8, 0x7ff
s_add_u32 s9, s8, 2048
s_add_u32 s10, s8, 6144
s_add_u32 m0, s17, 65536
s_nop 0
buffer_load_dwordx4 v176, s[12:15], s8 offen offset:0 lds
buffer_load_dwordx4 v177, s[12:15], s8 offen offset:1024 lds
buffer_load_dwordx4 v176, s[12:15], s9 offen offset:2048 lds
buffer_load_dwordx4 v177, s[12:15], s9 offen offset:3072 lds
s_add_u32 m0, s17, 81920
s_nop 0
buffer_load_dwordx4 v178, s[20:23], s8 offen offset:0 lds
buffer_load_dwordx4 v179, s[20:23], s8 offen offset:1024 lds
buffer_load_dwordx4 v178, s[20:23], s10 offen offset:2048 lds
buffer_load_dwordx4 v179, s[20:23], s10 offen offset:3072 lds
s_waitcnt vmcnt(8)
s_barrier
s_add_u32 s8, s16, 1920
s_and_b32 s8, s8, 0x7ff
s_add_u32 s9, s8, 2048
s_add_u32 s10, s8, 6144
s_add_u32 m0, s17, 0
s_nop 0
buffer_load_dwordx4 v176, s[12:15], s8 offen offset:0 lds
buffer_load_dwordx4 v177, s[12:15], s8 offen offset:1024 lds
buffer_load_dwordx4 v176, s[12:15], s9 offen offset:2048 lds
buffer_load_dwordx4 v177, s[12:15], s9 offen offset:3072 lds
s_add_u32 m0, s17, 16384
s_nop 0
buffer_load_dwordx4 v178, s[20:23], s8 offen offset:0 lds
buffer_load_dwordx4 v179, s[20:23], s8 offen offset:1024 lds
buffer_load_dwordx4 v178, s[20:23], s10 offen offset:2048 lds
buffer_load_dwordx4 v179, s[20:23], s10 offen offset:3072 lds
s_and_b32 s64, s2, 1
s_lshl_b32 s64, s64, 10
s_bfe_u32 s92, s2, 0x20001
s_lshl_b32 s92, s92, 19
s_add_u32 s64, s64, s92
s_lshr_b32 s92, s2, 3
s_lshl_b32 s92, s92, 14
s_add_u32 s64, s64, s92
s_lshr_b32 s92, s66, 1
s_lshl_b32 s92, s92, 13
s_add_u32 s64, s64, s92
v_bfe_u32 v22, v1, 3, 2
v_lshlrev_b32 v22, 11, v22
v_and_b32 v23, 7, v1
v_lshl_add_u32 v22, v23, 7, v22
v_add_u32 v22, s64, v22
s_mov_b32 exec_hi, 0
global_load_dword v23, v22, s[100:101]
s_mov_b64 exec, -1
s_waitcnt vmcnt(9)
s_barrier
s_waitcnt vmcnt(1)
s_barrier
s_setprio 0
s_cmp_lg_u32 s66, 0
s_cbranch_scc1 L_ph14
s_and_b32 s64, s2, 63
s_lshl_b32 s64, s64, 7
s_add_u32 s64, s64, 540672
s_add_u32 s90, s32, s64
s_addc_u32 s91, s33, 0
s_mov_b32 s64, s37
s_mov_b32 s65, s37
s_mov_b32 s92, 0
s_branch L_sp15
L_nok16:
s_add_u32 s92, s92, 1
s_cmp_ge_u32 s92, 200000
s_cbranch_scc1 L_ph14
s_sleep 10
L_sp15:
s_load_dwordx16 s[4:19], s[90:91], 0x0 glc
s_waitcnt lgkmcnt(0)
s_cmp_eq_u64 s[4:5], s[64:65]
s_cbranch_scc0 L_nok16
s_cmp_eq_u64 s[6:7], s[64:65]
s_cbranch_scc0 L_nok16
s_cmp_eq_u64 s[8:9], s[64:65]
s_cbranch_scc0 L_nok16
s_cmp_eq_u64 s[10:11], s[64:65]
s_cbranch_scc0 L_nok16
s_cmp_eq_u64 s[12:13], s[64:65]
s_cbranch_scc0 L_nok16
s_cmp_eq_u64 s[14:15], s[64:65]
s_cbranch_scc0 L_nok16
s_cmp_eq_u64 s[16:17], s[64:65]
s_cbranch_scc0 L_nok16
s_cmp_eq_u64 s[18:19], s[64:65]
s_cbranch_scc0 L_nok16
L_ph14:
v_mov_b32 v190, 3
s_mov_b64 exec, 1
ds_write_b32 v185, v190
s_mov_b64 exec, -1
L_lc17:
ds_read_b128 v[186:189], v184
s_waitcnt lgkmcnt(0)
v_min3_u32 v186, v186, v187, v188
v_min_u32 v186, v186, v189
s_nop 0
v_readfirstlane_b32 s92, v186
s_nop 0
s_cmp_ge_u32 s92, 3
s_cbranch_scc1 L_lcd18
s_sleep 1
s_branch L_lc17
L_lcd18:
s_setprio 0
s_add_u32 m0, s68, 0
s_mov_b32 s64, 0
buffer_load_dwordx4 v14, s[52:55], s64 offen sc1 lds
s_add_u32 m0, s68, 1024
s_mov_b32 s64, 262144
buffer_load_dwordx4 v14, s[52:55], s64 offen sc1 lds
s_add_u32 m0, s68, 2048
s_mov_b32 s64, 524288
buffer_load_dwordx4 v14, s[52:55], s64 offen sc1 lds
s_add_u32 m0, s68, 3072
s_mov_b32 s64, 786432
buffer_load_dwordx4 v14, s[52:55], s64 offen sc1 lds
s_cmp_eq_u32 s61, 1
s_cbranch_scc1 L_ws19
s_lshr_b32 s64, s66, 1
s_lshl_b32 s65, s64, 12
s_mul_i32 s64, s64, 4096
s_add_u32 m0, s69, s65
s_nop 0
buffer_load_dwordx4 v2, s[48:51], s64 offen offset:0 sc1 lds
buffer_load_dwordx4 v2, s[48:51], s64 offen offset:1024 sc1 lds
buffer_load_dwordx4 v2, s[48:51], s64 offen offset:2048 sc1 lds
buffer_load_dwordx4 v2, s[48:51], s64 offen offset:3072 sc1 lds
s_waitcnt vmcnt(0)
s_branch L_wd20
L_ws19:
s_movk_i32 s64, 4096
buffer_load_dwordx4 v[104:107], v2, s[48:51], 0 offen offset:0 sc1
buffer_load_dwordx4 v[108:111], v2, s[48:51], 0 offen offset:1024 sc1
buffer_load_dwordx4 v[112:115], v2, s[48:51], 0 offen offset:2048 sc1
buffer_load_dwordx4 v[116:119], v2, s[48:51], 0 offen offset:3072 sc1
buffer_load_dwordx4 v[120:123], v2, s[48:51], s64 offen offset:0 sc1
buffer_load_dwordx4 v[124:127], v2, s[48:51], s64 offen offset:1024 sc1
buffer_load_dwordx4 v[128:131], v2, s[48:51], s64 offen offset:2048 sc1
buffer_load_dwordx4 v[132:135], v2, s[48:51], s64 offen offset:3072 sc1
L_wd20:
s_waitcnt vmcnt(8)
v_mov_b32 v190, 4
s_mov_b64 exec, 1
ds_write_b32 v185, v190
s_mov_b64 exec, -1
L_lc21:
ds_read_b128 v[186:189], v184
s_waitcnt lgkmcnt(0)
v_min3_u32 v186, v186, v187, v188
v_min_u32 v186, v186, v189
s_nop 0
v_readfirstlane_b32 s92, v186
s_nop 0
s_cmp_ge_u32 s92, 4
s_cbranch_scc1 L_lcd22
s_sleep 1
s_branch L_lc21
L_lcd22:
ds_read_b128 v[72:75], v15 offset:0
ds_read_b128 v[76:79], v15 offset:4096
ds_read_b128 v[80:83], v15 offset:8192
ds_read_b128 v[84:87], v15 offset:12288
s_cmp_eq_u32 s61, 1
s_cbranch_scc1 L_wr23
ds_read_b128 v[104:107], v19 offset:0
ds_read_b128 v[108:111], v19 offset:1024
ds_read_b128 v[112:115], v19 offset:2048
ds_read_b128 v[116:119], v19 offset:3072
ds_read_b128 v[120:123], v19 offset:4096
ds_read_b128 v[124:127], v19 offset:5120
ds_read_b128 v[128:131], v19 offset:6144
ds_read_b128 v[132:135], v19 offset:7168
L_wr23:
s_waitcnt lgkmcnt(0)
v_mov_b32 v190, 5
s_mov_b64 exec, 1
ds_write_b32 v185, v190
s_mov_b64 exec, -1
s_lshl_b32 s64, s61, 31
s_or_b32 s64, s64, s62
L_fft24:
v_xor_b32 v24, s64, v72
v_xor_b32 v25, s64, v73
v_xor_b32 v26, s64, v74
v_xor_b32 v27, s64, v75
v_xor_b32 v28, s64, v76
v_xor_b32 v29, s64, v77
v_xor_b32 v30, s64, v78
v_xor_b32 v31, s64, v79
v_xor_b32 v32, s64, v80
v_xor_b32 v33, s64, v81
v_xor_b32 v34, s64, v82
v_xor_b32 v35, s64, v83
v_xor_b32 v36, s64, v84
v_xor_b32 v37, s64, v85
v_xor_b32 v38, s64, v86
v_xor_b32 v39, s64, v87
v_mfma_f32_32x32x16_bf16 v[40:55], v[24:27], v[192:195], 0
v_mfma_f32_32x32x16_bf16 v[40:55], v[28:31], v[196:199], v[40:55]
v_mfma_f32_32x32x16_bf16 v[40:55], v[32:35], v[200:203], v[40:55]
v_mfma_f32_32x32x16_bf16 v[40:55], v[36:39], v[204:207], v[40:55]
v_mfma_f32_32x32x16_bf16 v[56:71], v[24:27], v[208:211], 0
v_mfma_f32_32x32x16_bf16 v[56:71], v[28:31], v[212:215], v[56:71]
v_mfma_f32_32x32x16_bf16 v[56:71], v[32:35], v[216:219], v[56:71]
v_mfma_f32_32x32x16_bf16 v[56:71], v[36:39], v[220:223], v[56:71]
s_cmp_eq_u32 s61, 2
s_cbranch_scc1 L_once26
s_waitcnt vmcnt(0)
v_lshlrev_b32 v176, 16, v104
v_and_b32 v177, 0xffff0000, v104
v_lshlrev_b32 v178, 16, v105
v_and_b32 v179, 0xffff0000, v105
v_add_f32 v180, v176, v178
v_add_f32 v181, v177, v179
v_sub_f32 v176, v176, v178
v_sub_f32 v177, v177, v179
v_mul_f32 v104, v136, v176
v_mul_f32 v105, v136, v177
v_fma_f32 v136, v152, v176, v180
v_fma_f32 v152, v152, v177, v181
v_lshlrev_b32 v176, 16, v106
v_and_b32 v177, 0xffff0000, v106
v_lshlrev_b32 v178, 16, v107
v_and_b32 v179, 0xffff0000, v107
v_add_f32 v180, v176, v178
v_add_f32 v181, v177, v179
v_sub_f32 v176, v176, v178
v_sub_f32 v177, v177, v179
v_mul_f32 v106, v137, v176
v_mul_f32 v107, v137, v177
v_fma_f32 v137, v153, v176, v180
v_fma_f32 v153, v153, v177, v181
v_lshlrev_b32 v176, 16, v108
v_and_b32 v177, 0xffff0000, v108
v_lshlrev_b32 v178, 16, v109
v_and_b32 v179, 0xffff0000, v109
v_add_f32 v180, v176, v178
v_add_f32 v181, v177, v179
v_sub_f32 v176, v176, v178
v_sub_f32 v177, v177, v179
v_mul_f32 v108, v138, v176
v_mul_f32 v109, v138, v177
v_fma_f32 v138, v154, v176, v180
v_fma_f32 v154, v154, v177, v181
v_lshlrev_b32 v176, 16, v110
v_and_b32 v177, 0xffff0000, v110
v_lshlrev_b32 v178, 16, v111
v_and_b32 v179, 0xffff0000, v111
v_add_f32 v180, v176, v178
v_add_f32 v181, v177, v179
v_sub_f32 v176, v176, v178
v_sub_f32 v177, v177, v179
v_mul_f32 v110, v139, v176
v_mul_f32 v111, v139, v177
v_fma_f32 v139, v155, v176, v180
v_fma_f32 v155, v155, v177, v181
v_lshlrev_b32 v176, 16, v112
v_and_b32 v177, 0xffff0000, v112
v_lshlrev_b32 v178, 16, v113
v_and_b32 v179, 0xffff0000, v113
v_add_f32 v180, v176, v178
v_add_f32 v181, v177, v179
v_sub_f32 v176, v176, v178
v_sub_f32 v177, v177, v179
v_mul_f32 v112, v140, v176
v_mul_f32 v113, v140, v177
v_fma_f32 v140, v156, v176, v180
v_fma_f32 v156, v156, v177, v181
v_lshlrev_b32 v176, 16, v114
v_and_b32 v177, 0xffff0000, v114
v_lshlrev_b32 v178, 16, v115
v_and_b32 v179, 0xffff0000, v115
v_add_f32 v180, v176, v178
v_add_f32 v181, v177, v179
v_sub_f32 v176, v176, v178
v_sub_f32 v177, v177, v179
v_mul_f32 v114, v141, v176
v_mul_f32 v115, v141, v177
v_fma_f32 v141, v157, v176, v180
v_fma_f32 v157, v157, v177, v181
L_once26:
s_nop 5
v_mul_f32 v168, v40, v224
v_mul_f32 v169, v40, v240
s_nop 1
v_fma_f32 v168, -v56, v240, v168
v_fmac_f32 v169, v56, v224
v_cvt_pk_bf16_f32 v24, v168, v169
v_mul_f32 v170, v41, v225
v_mul_f32 v171, v41, v241
v_fma_f32 v170, -v57, v241, v170
v_fmac_f32 v171, v57, v225
v_cvt_pk_bf16_f32 v25, v170, v171
v_mul_f32 v172, v42, v226
v_mul_f32 v173, v42, v242
v_fma_f32 v172, -v58, v242, v172
v_fmac_f32 v173, v58, v226
v_cvt_pk_bf16_f32 v26, v172, v173
v_mul_f32 v174, v43, v227
v_mul_f32 v175, v43, v243
v_fma_f32 v174, -v59, v243, v174
v_fmac_f32 v175, v59, v227
v_cvt_pk_bf16_f32 v27, v174, v175
v_mul_f32 v168, v44, v228
v_mul_f32 v169, v44, v244
v_fma_f32 v168, -v60, v244, v168
v_fmac_f32 v169, v60, v228
v_cvt_pk_bf16_f32 v28, v168, v169
v_mul_f32 v170, v45, v229
v_mul_f32 v171, v45, v245
v_fma_f32 v170, -v61, v245, v170
v_fmac_f32 v171, v61, v229
v_cvt_pk_bf16_f32 v29, v170, v171
v_mul_f32 v172, v46, v230
v_mul_f32 v173, v46, v246
v_fma_f32 v172, -v62, v246, v172
v_fmac_f32 v173, v62, v230
v_cvt_pk_bf16_f32 v30, v172, v173
v_mul_f32 v174, v47, v231
v_mul_f32 v175, v47, v247
v_fma_f32 v174, -v63, v247, v174
v_fmac_f32 v175, v63, v231
v_cvt_pk_bf16_f32 v31, v174, v175
v_mul_f32 v168, v48, v232
v_mul_f32 v169, v48, v248
v_fma_f32 v168, -v64, v248, v168
v_fmac_f32 v169, v64, v232
v_cvt_pk_bf16_f32 v32, v168, v169
v_mul_f32 v170, v49, v233
v_mul_f32 v171, v49, v249
v_fma_f32 v170, -v65, v249, v170
v_fmac_f32 v171, v65, v233
v_cvt_pk_bf16_f32 v33, v170, v171
v_mul_f32 v172, v50, v234
v_mul_f32 v173, v50, v250
v_fma_f32 v172, -v66, v250, v172
v_fmac_f32 v173, v66, v234
v_cvt_pk_bf16_f32 v34, v172, v173
v_mul_f32 v174, v51, v235
v_mul_f32 v175, v51, v251
v_fma_f32 v174, -v67, v251, v174
v_fmac_f32 v175, v67, v235
v_cvt_pk_bf16_f32 v35, v174, v175
v_mul_f32 v168, v52, v236
v_mul_f32 v169, v52, v252
v_fma_f32 v168, -v68, v252, v168
v_fmac_f32 v169, v68, v236
v_cvt_pk_bf16_f32 v36, v168, v169
v_mul_f32 v170, v53, v237
v_mul_f32 v171, v53, v253
v_fma_f32 v170, -v69, v253, v170
v_fmac_f32 v171, v69, v237
v_cvt_pk_bf16_f32 v37, v170, v171
v_mul_f32 v172, v54, v238
v_mul_f32 v173, v54, v254
v_fma_f32 v172, -v70, v254, v172
v_fmac_f32 v173, v70, v238
v_cvt_pk_bf16_f32 v38, v172, v173
v_mul_f32 v174, v55, v239
v_mul_f32 v175, v55, v255
v_fma_f32 v174, -v71, v255, v174
v_fmac_f32 v175, v71, v239
v_cvt_pk_bf16_f32 v39, v174, v175
v_mfma_f32_32x32x16_bf16 v[40:55], v[192:195], v[24:27], 0
v_mfma_f32_32x32x16_bf16 v[40:55], v[196:199], v[28:31], v[40:55]
v_mfma_f32_32x32x16_bf16 v[40:55], v[200:203], v[32:35], v[40:55]
v_mfma_f32_32x32x16_bf16 v[40:55], v[204:207], v[36:39], v[40:55]
v_mfma_f32_32x32x16_bf16 v[56:71], v[208:211], v[24:27], 0
v_mfma_f32_32x32x16_bf16 v[56:71], v[212:215], v[28:31], v[56:71]
v_mfma_f32_32x32x16_bf16 v[56:71], v[216:219], v[32:35], v[56:71]
v_mfma_f32_32x32x16_bf16 v[56:71], v[220:223], v[36:39], v[56:71]
s_cmp_eq_u32 s61, 2
s_cbranch_scc1 L_once27
s_waitcnt vmcnt(0)
v_lshlrev_b32 v176, 16, v116
v_and_b32 v177, 0xffff0000, v116
v_lshlrev_b32 v178, 16, v117
v_and_b32 v179, 0xffff0000, v117
v_add_f32 v180, v176, v178
v_add_f32 v181, v177, v179
v_sub_f32 v176, v176, v178
v_sub_f32 v177, v177, v179
v_mul_f32 v116, v142, v176
v_mul_f32 v117, v142, v177
v_fma_f32 v142, v158, v176, v180
v_fma_f32 v158, v158, v177, v181
v_lshlrev_b32 v176, 16, v118
v_and_b32 v177, 0xffff0000, v118
v_lshlrev_b32 v178, 16, v119
v_and_b32 v179, 0xffff0000, v119
v_add_f32 v180, v176, v178
v_add_f32 v181, v177, v179
v_sub_f32 v176, v176, v178
v_sub_f32 v177, v177, v179
v_mul_f32 v118, v143, v176
v_mul_f32 v119, v143, v177
v_fma_f32 v143, v159, v176, v180
v_fma_f32 v159, v159, v177, v181
v_lshlrev_b32 v176, 16, v120
v_and_b32 v177, 0xffff0000, v120
v_lshlrev_b32 v178, 16, v121
v_and_b32 v179, 0xffff0000, v121
v_add_f32 v180, v176, v178
v_add_f32 v181, v177, v179
v_sub_f32 v176, v176, v178
v_sub_f32 v177, v177, v179
v_mul_f32 v120, v144, v176
v_mul_f32 v121, v144, v177
v_fma_f32 v144, v160, v176, v180
v_fma_f32 v160, v160, v177, v181
v_lshlrev_b32 v176, 16, v122
v_and_b32 v177, 0xffff0000, v122
v_lshlrev_b32 v178, 16, v123
v_and_b32 v179, 0xffff0000, v123
v_add_f32 v180, v176, v178
v_add_f32 v181, v177, v179
v_sub_f32 v176, v176, v178
v_sub_f32 v177, v177, v179
v_mul_f32 v122, v145, v176
v_mul_f32 v123, v145, v177
v_fma_f32 v145, v161, v176, v180
v_fma_f32 v161, v161, v177, v181
v_lshlrev_b32 v176, 16, v124
v_and_b32 v177, 0xffff0000, v124
v_lshlrev_b32 v178, 16, v125
v_and_b32 v179, 0xffff0000, v125
v_add_f32 v180, v176, v178
v_add_f32 v181, v177, v179
v_sub_f32 v176, v176, v178
v_sub_f32 v177, v177, v179
v_mul_f32 v124, v146, v176
v_mul_f32 v125, v146, v177
v_fma_f32 v146, v162, v176, v180
v_fma_f32 v162, v162, v177, v181
v_lshlrev_b32 v176, 16, v126
v_and_b32 v177, 0xffff0000, v126
v_lshlrev_b32 v178, 16, v127
v_and_b32 v179, 0xffff0000, v127
v_add_f32 v180, v176, v178
v_add_f32 v181, v177, v179
v_sub_f32 v176, v176, v178
v_sub_f32 v177, v177, v179
v_mul_f32 v126, v147, v176
v_mul_f32 v127, v147, v177
v_fma_f32 v147, v163, v176, v180
v_fma_f32 v163, v163, v177, v181
L_once27:
L_lc28:
ds_read_b128 v[186:189], v184
s_waitcnt lgkmcnt(0)
v_min3_u32 v186, v186, v187, v188
v_min_u32 v186, v186, v189
s_nop 0
v_readfirstlane_b32 s92, v186
s_nop 0
s_cmp_ge_u32 s92, 5
s_cbranch_scc1 L_lcd29
s_sleep 1
s_branch L_lc28
L_lcd29:
s_cmp_eq_u32 s61, 2
s_cbranch_scc1 L_nwr25
ds_write_b128 v16, v[40:43] offset:0
ds_write_b128 v16, v[44:47] offset:1024
ds_write_b128 v16, v[48:51] offset:2048
ds_write_b128 v16, v[52:55] offset:3072
ds_write_b128 v16, v[56:59] offset:4096
ds_write_b128 v16, v[60:63] offset:5120
ds_write_b128 v16, v[64:67] offset:6144
ds_write_b128 v16, v[68:71] offset:7168
s_cmp_eq_u32 s61, 0
s_cbranch_scc1 L_nwr25
s_mov_b32 s61, 2
s_mov_b32 s64, 0
s_branch L_fft24
L_nwr25:
v_lshlrev_b32 v176, 16, v128
v_and_b32 v177, 0xffff0000, v128
v_lshlrev_b32 v178, 16, v129
v_and_b32 v179, 0xffff0000, v129
v_add_f32 v180, v176, v178
v_add_f32 v181, v177, v179
v_sub_f32 v176, v176, v178
v_sub_f32 v177, v177, v179
v_mul_f32 v128, v148, v176
v_mul_f32 v129, v148, v177
v_fma_f32 v148, v164, v176, v180
v_fma_f32 v164, v164, v177, v181
v_lshlrev_b32 v176, 16, v130
v_and_b32 v177, 0xffff0000, v130
v_lshlrev_b32 v178, 16, v131
v_and_b32 v179, 0xffff0000, v131
v_add_f32 v180, v176, v178
v_add_f32 v181, v177, v179
v_sub_f32 v176, v176, v178
v_sub_f32 v177, v177, v179
v_mul_f32 v130, v149, v176
v_mul_f32 v131, v149, v177
v_fma_f32 v149, v165, v176, v180
v_fma_f32 v165, v165, v177, v181
s_waitcnt lgkmcnt(0)
v_mov_b32 v190, 6
s_mov_b64 exec, 1
ds_write_b32 v185, v190
s_mov_b64 exec, -1
v_lshlrev_b32 v176, 16, v132
v_and_b32 v177, 0xffff0000, v132
v_lshlrev_b32 v178, 16, v133
v_and_b32 v179, 0xffff0000, v133
v_add_f32 v180, v176, v178
v_add_f32 v181, v177, v179
v_sub_f32 v176, v176, v178
v_sub_f32 v177, v177, v179
v_mul_f32 v132, v150, v176
v_mul_f32 v133, v150, v177
v_fma_f32 v150, v166, v176, v180
v_fma_f32 v166, v166, v177, v181
v_lshlrev_b32 v176, 16, v134
v_and_b32 v177, 0xffff0000, v134
v_lshlrev_b32 v178, 16, v135
v_and_b32 v179, 0xffff0000, v135
v_add_f32 v180, v176, v178
v_add_f32 v181, v177, v179
v_sub_f32 v176, v176, v178
v_sub_f32 v177, v177, v179
v_mul_f32 v134, v151, v176
v_mul_f32 v135, v151, v177
v_fma_f32 v151, v167, v176, v180
v_fma_f32 v167, v167, v177, v181
v_mul_f32 v168, v152, v56
v_mul_f32 v56, v136, v56
v_fmac_f32 v56, v152, v40
v_fma_f32 v40, v136, v40, -v168
v_mul_f32 v169, v153, v57
v_mul_f32 v57, v137, v57
v_fmac_f32 v57, v153, v41
v_fma_f32 v41, v137, v41, -v169
v_mul_f32 v168, v154, v58
v_mul_f32 v58, v138, v58
v_fmac_f32 v58, v154, v42
v_fma_f32 v42, v138, v42, -v168
v_mul_f32 v169, v155, v59
v_mul_f32 v59, v139, v59
v_fmac_f32 v59, v155, v43
v_fma_f32 v43, v139, v43, -v169
v_mul_f32 v168, v156, v60
v_mul_f32 v60, v140, v60
v_fmac_f32 v60, v156, v44
v_fma_f32 v44, v140, v44, -v168
v_mul_f32 v169, v157, v61
v_mul_f32 v61, v141, v61
v_fmac_f32 v61, v157, v45
v_fma_f32 v45, v141, v45, -v169
L_lc30:
ds_read_b128 v[186:189], v184
s_waitcnt lgkmcnt(0)
v_min3_u32 v186, v186, v187, v188
v_min_u32 v186, v186, v189
s_nop 0
v_readfirstlane_b32 s92, v186
s_nop 0
s_cmp_ge_u32 s92, 6
s_cbranch_scc1 L_lcd31
s_sleep 1
s_branch L_lc30
L_lcd31:
ds_read_b128 v[72:75], v17 offset:0
ds_read_b128 v[76:79], v17 offset:1024
ds_read_b128 v[80:83], v17 offset:2048
ds_read_b128 v[84:87], v17 offset:3072
ds_read_b128 v[88:91], v17 offset:4096
ds_read_b128 v[92:95], v17 offset:5120
ds_read_b128 v[96:99], v17 offset:6144
ds_read_b128 v[100:103], v17 offset:7168
v_mul_f32 v168, v158, v62
v_mul_f32 v62, v142, v62
v_fmac_f32 v62, v158, v46
v_fma_f32 v46, v142, v46, -v168
v_mul_f32 v169, v159, v63
v_mul_f32 v63, v143, v63
v_fmac_f32 v63, v159, v47
v_fma_f32 v47, v143, v47, -v169
v_mul_f32 v168, v160, v64
v_mul_f32 v64, v144, v64
v_fmac_f32 v64, v160, v48
v_fma_f32 v48, v144, v48, -v168
v_mul_f32 v169, v161, v65
v_mul_f32 v65, v145, v65
v_fmac_f32 v65, v161, v49
v_fma_f32 v49, v145, v49, -v169
v_mul_f32 v168, v162, v66
v_mul_f32 v66, v146, v66
v_fmac_f32 v66, v162, v50
v_fma_f32 v50, v146, v50, -v168
v_mul_f32 v169, v163, v67
v_mul_f32 v67, v147, v67
v_fmac_f32 v67, v163, v51
v_fma_f32 v51, v147, v51, -v169
v_mul_f32 v168, v164, v68
v_mul_f32 v68, v148, v68
v_fmac_f32 v68, v164, v52
v_fma_f32 v52, v148, v52, -v168
v_mul_f32 v169, v165, v69
v_mul_f32 v69, v149, v69
v_fmac_f32 v69, v165, v53
v_fma_f32 v53, v149, v53, -v169
v_mul_f32 v168, v166, v70
v_mul_f32 v70, v150, v70
v_fmac_f32 v70, v166, v54
v_fma_f32 v54, v150, v54, -v168
v_mul_f32 v169, v167, v71
v_mul_f32 v71, v151, v71
v_fmac_f32 v71, v167, v55
v_fma_f32 v55, v151, v55, -v169
s_waitcnt lgkmcnt(0)
v_mov_b32 v190, 7
s_mov_b64 exec, 1
ds_write_b32 v185, v190
s_mov_b64 exec, -1
v_fma_f32 v40, -v104, v88, v40
v_fmac_f32 v56, v104, v72
v_fma_f32 v40, -v105, v72, v40
v_fma_f32 v56, -v105, v88, v56
v_cvt_pk_bf16_f32 v24, v56, v40
v_fma_f32 v41, -v106, v89, v41
v_fmac_f32 v57, v106, v73
v_fma_f32 v41, -v107, v73, v41
v_fma_f32 v57, -v107, v89, v57
v_cvt_pk_bf16_f32 v25, v57, v41
v_fma_f32 v42, -v108, v90, v42
v_fmac_f32 v58, v108, v74
v_fma_f32 v42, -v109, v74, v42
v_fma_f32 v58, -v109, v90, v58
v_cvt_pk_bf16_f32 v26, v58, v42
v_fma_f32 v43, -v110, v91, v43
v_fmac_f32 v59, v110, v75
v_fma_f32 v43, -v111, v75, v43
v_fma_f32 v59, -v111, v91, v59
v_cvt_pk_bf16_f32 v27, v59, v43
v_fma_f32 v44, -v112, v92, v44
v_fmac_f32 v60, v112, v76
v_fma_f32 v44, -v113, v76, v44
v_fma_f32 v60, -v113, v92, v60
v_cvt_pk_bf16_f32 v28, v60, v44
v_fma_f32 v45, -v114, v93, v45
v_fmac_f32 v61, v114, v77
v_fma_f32 v45, -v115, v77, v45
v_fma_f32 v61, -v115, v93, v61
v_cvt_pk_bf16_f32 v29, v61, v45
v_fma_f32 v46, -v116, v94, v46
v_fmac_f32 v62, v116, v78
v_fma_f32 v46, -v117, v78, v46
v_fma_f32 v62, -v117, v94, v62
v_cvt_pk_bf16_f32 v30, v62, v46
v_fma_f32 v47, -v118, v95, v47
v_fmac_f32 v63, v118, v79
v_fma_f32 v47, -v119, v79, v47
v_fma_f32 v63, -v119, v95, v63
v_cvt_pk_bf16_f32 v31, v63, v47
v_fma_f32 v48, -v120, v96, v48
v_fmac_f32 v64, v120, v80
v_fma_f32 v48, -v121, v80, v48
v_fma_f32 v64, -v121, v96, v64
v_cvt_pk_bf16_f32 v32, v64, v48
v_fma_f32 v49, -v122, v97, v49
v_fmac_f32 v65, v122, v81
v_fma_f32 v49, -v123, v81, v49
v_fma_f32 v65, -v123, v97, v65
v_cvt_pk_bf16_f32 v33, v65, v49
v_fma_f32 v50, -v124, v98, v50
v_fmac_f32 v66, v124, v82
v_fma_f32 v50, -v125, v82, v50
v_fma_f32 v66, -v125, v98, v66
v_cvt_pk_bf16_f32 v34, v66, v50
v_fma_f32 v51, -v126, v99, v51
v_fmac_f32 v67, v126, v83
v_fma_f32 v51, -v127, v83, v51
v_fma_f32 v67, -v127, v99, v67
v_cvt_pk_bf16_f32 v35, v67, v51
v_fma_f32 v52, -v128, v100, v52
v_fmac_f32 v68, v128, v84
v_fma_f32 v52, -v129, v84, v52
v_fma_f32 v68, -v129, v100, v68
v_cvt_pk_bf16_f32 v36, v68, v52
v_fma_f32 v53, -v130, v101, v53
v_fmac_f32 v69, v130, v85
v_fma_f32 v53, -v131, v85, v53
v_fma_f32 v69, -v131, v101, v69
v_cvt_pk_bf16_f32 v37, v69, v53
v_fma_f32 v54, -v132, v102, v54
v_fmac_f32 v70, v132, v86
v_fma_f32 v54, -v133, v86, v54
v_fma_f32 v70, -v133, v102, v70
v_cvt_pk_bf16_f32 v38, v70, v54
v_fma_f32 v55, -v134, v103, v55
v_fmac_f32 v71, v134, v87
v_fma_f32 v55, -v135, v87, v55
v_fma_f32 v71, -v135, v103, v71
v_cvt_pk_bf16_f32 v39, v71, v55
v_mfma_f32_32x32x16_bf16 v[40:55], v[24:27], v[192:195], 0
v_mfma_f32_32x32x16_bf16 v[40:55], v[28:31], v[196:199], v[40:55]
v_mfma_f32_32x32x16_bf16 v[40:55], v[32:35], v[200:203], v[40:55]
v_mfma_f32_32x32x16_bf16 v[40:55], v[36:39], v[204:207], v[40:55]
v_mfma_f32_32x32x16_bf16 v[56:71], v[24:27], v[208:211], 0
v_mfma_f32_32x32x16_bf16 v[56:71], v[28:31], v[212:215], v[56:71]
v_mfma_f32_32x32x16_bf16 v[56:71], v[32:35], v[216:219], v[56:71]
v_mfma_f32_32x32x16_bf16 v[56:71], v[36:39], v[220:223], v[56:71]
s_nop 7
v_mul_f32 v168, v40, v224
v_mul_f32 v169, v40, v240
s_nop 1
v_fma_f32 v168, -v56, v240, v168
v_fmac_f32 v169, v56, v224
v_cvt_pk_bf16_f32 v24, v168, v169
v_mul_f32 v170, v41, v225
v_mul_f32 v171, v41, v241
v_fma_f32 v170, -v57, v241, v170
v_fmac_f32 v171, v57, v225
v_cvt_pk_bf16_f32 v25, v170, v171
v_mul_f32 v172, v42, v226
v_mul_f32 v173, v42, v242
v_fma_f32 v172, -v58, v242, v172
v_fmac_f32 v173, v58, v226
v_cvt_pk_bf16_f32 v26, v172, v173
v_mul_f32 v174, v43, v227
v_mul_f32 v175, v43, v243
v_fma_f32 v174, -v59, v243, v174
v_fmac_f32 v175, v59, v227
v_cvt_pk_bf16_f32 v27, v174, v175
v_mul_f32 v168, v44, v228
v_mul_f32 v169, v44, v244
v_fma_f32 v168, -v60, v244, v168
v_fmac_f32 v169, v60, v228
v_cvt_pk_bf16_f32 v28, v168, v169
v_mul_f32 v170, v45, v229
v_mul_f32 v171, v45, v245
v_fma_f32 v170, -v61, v245, v170
v_fmac_f32 v171, v61, v229
v_cvt_pk_bf16_f32 v29, v170, v171
v_mul_f32 v172, v46, v230
v_mul_f32 v173, v46, v246
v_fma_f32 v172, -v62, v246, v172
v_fmac_f32 v173, v62, v230
v_cvt_pk_bf16_f32 v30, v172, v173
v_mul_f32 v174, v47, v231
v_mul_f32 v175, v47, v247
v_fma_f32 v174, -v63, v247, v174
v_fmac_f32 v175, v63, v231
v_cvt_pk_bf16_f32 v31, v174, v175
v_mul_f32 v168, v48, v232
v_mul_f32 v169, v48, v248
v_fma_f32 v168, -v64, v248, v168
v_fmac_f32 v169, v64, v232
v_cvt_pk_bf16_f32 v32, v168, v169
v_mul_f32 v170, v49, v233
v_mul_f32 v171, v49, v249
v_fma_f32 v170, -v65, v249, v170
v_fmac_f32 v171, v65, v233
v_cvt_pk_bf16_f32 v33, v170, v171
v_mul_f32 v172, v50, v234
v_mul_f32 v173, v50, v250
v_fma_f32 v172, -v66, v250, v172
v_fmac_f32 v173, v66, v234
v_cvt_pk_bf16_f32 v34, v172, v173
v_mul_f32 v174, v51, v235
v_mul_f32 v175, v51, v251
v_fma_f32 v174, -v67, v251, v174
v_fmac_f32 v175, v67, v235
v_cvt_pk_bf16_f32 v35, v174, v175
v_mul_f32 v168, v52, v236
v_mul_f32 v169, v52, v252
v_fma_f32 v168, -v68, v252, v168
v_fmac_f32 v169, v68, v236
v_cvt_pk_bf16_f32 v36, v168, v169
v_mul_f32 v170, v53, v237
v_mul_f32 v171, v53, v253
v_fma_f32 v170, -v69, v253, v170
v_fmac_f32 v171, v69, v237
v_cvt_pk_bf16_f32 v37, v170, v171
v_mul_f32 v172, v54, v238
v_mul_f32 v173, v54, v254
v_fma_f32 v172, -v70, v254, v172
v_fmac_f32 v173, v70, v238
v_cvt_pk_bf16_f32 v38, v172, v173
v_mul_f32 v174, v55, v239
v_mul_f32 v175, v55, v255
v_fma_f32 v174, -v71, v255, v174
v_fmac_f32 v175, v71, v239
v_cvt_pk_bf16_f32 v39, v174, v175
v_mfma_f32_32x32x16_bf16 v[40:55], v[192:195], v[24:27], 0
v_mfma_f32_32x32x16_bf16 v[40:55], v[196:199], v[28:31], v[40:55]
v_mfma_f32_32x32x16_bf16 v[40:55], v[200:203], v[32:35], v[40:55]
v_mfma_f32_32x32x16_bf16 v[40:55], v[204:207], v[36:39], v[40:55]
v_mfma_f32_32x32x16_bf16 v[56:71], v[208:211], v[24:27], 0
v_mfma_f32_32x32x16_bf16 v[56:71], v[212:215], v[28:31], v[56:71]
v_mfma_f32_32x32x16_bf16 v[56:71], v[216:219], v[32:35], v[56:71]
v_mfma_f32_32x32x16_bf16 v[56:71], v[220:223], v[36:39], v[56:71]
s_lshr_b32 s64, s62, 16
L_lc32:
ds_read_b128 v[186:189], v184
s_waitcnt lgkmcnt(0)
v_min3_u32 v186, v186, v187, v188
v_min_u32 v186, v186, v189
s_nop 0
v_readfirstlane_b32 s92, v186
s_nop 0
s_cmp_ge_u32 s92, 7
s_cbranch_scc1 L_lcd33
s_sleep 1
s_branch L_lc32
L_lcd33:
s_nop 1
v_cvt_pk_bf16_f32 v24, v40, v56
v_xor_b32 v24, s64, v24
v_cvt_pk_bf16_f32 v25, v41, v57
v_xor_b32 v25, s64, v25
v_cvt_pk_bf16_f32 v26, v42, v58
v_xor_b32 v26, s64, v26
v_cvt_pk_bf16_f32 v27, v43, v59
v_xor_b32 v27, s64, v27
ds_write_b128 v15, v[24:27] offset:0
v_cvt_pk_bf16_f32 v28, v44, v60
v_xor_b32 v28, s64, v28
v_cvt_pk_bf16_f32 v29, v45, v61
v_xor_b32 v29, s64, v29
v_cvt_pk_bf16_f32 v30, v46, v62
v_xor_b32 v30, s64, v30
v_cvt_pk_bf16_f32 v31, v47, v63
v_xor_b32 v31, s64, v31
ds_write_b128 v15, v[28:31] offset:4096
v_cvt_pk_bf16_f32 v32, v48, v64
v_xor_b32 v32, s64, v32
v_cvt_pk_bf16_f32 v33, v49, v65
v_xor_b32 v33, s64, v33
v_cvt_pk_bf16_f32 v34, v50, v66
v_xor_b32 v34, s64, v34
v_cvt_pk_bf16_f32 v35, v51, v67
v_xor_b32 v35, s64, v35
ds_write_b128 v15, v[32:35] offset:8192
v_cvt_pk_bf16_f32 v36, v52, v68
v_xor_b32 v36, s64, v36
v_cvt_pk_bf16_f32 v37, v53, v69
v_xor_b32 v37, s64, v37
v_cvt_pk_bf16_f32 v38, v54, v70
v_xor_b32 v38, s64, v38
v_cvt_pk_bf16_f32 v39, v55, v71
v_xor_b32 v39, s64, v39
ds_write_b128 v15, v[36:39] offset:12288
s_waitcnt lgkmcnt(0)
v_mov_b32 v190, 8
s_mov_b64 exec, 1
ds_write_b32 v185, v190
s_mov_b64 exec, -1
L_lc34:
ds_read_b128 v[186:189], v184
s_waitcnt lgkmcnt(0)
v_min3_u32 v186, v186, v187, v188
v_min_u32 v186, v186, v189
s_nop 0
v_readfirstlane_b32 s92, v186
s_nop 0
s_cmp_ge_u32 s92, 8
s_cbranch_scc1 L_lcd35
s_sleep 1
s_branch L_lc34
L_lcd35:
ds_read_b128 v[24:27], v18 offset:0
ds_read_b128 v[28:31], v18 offset:1024
ds_read_b128 v[32:35], v18 offset:2048
ds_read_b128 v[36:39], v18 offset:3072
s_mov_b32 s64, 0
s_waitcnt lgkmcnt(3)
buffer_store_dwordx4 v[24:27], v14, s[56:59], s64 offen sc1
s_mov_b32 s64, 262144
s_waitcnt lgkmcnt(2)
buffer_store_dwordx4 v[28:31], v14, s[56:59], s64 offen sc1
s_mov_b32 s64, 524288
s_waitcnt lgkmcnt(1)
buffer_store_dwordx4 v[32:35], v14, s[56:59], s64 offen sc1
s_mov_b32 s64, 786432
s_waitcnt lgkmcnt(0)
buffer_store_dwordx4 v[36:39], v14, s[56:59], s64 offen sc1
s_lshl_b32 s64, s67, 14
s_add_u32 s40, s28, s64
s_addc_u32 s41, s29, 0
s_mov_b32 s42, 16384
s_mov_b32 s43, 0x20000
v_and_b32 v8, 31, v1
v_lshrrev_b32 v9, 5, v1
v_lshlrev_b32 v14, 2, v8
v_lshl_add_u32 v14, v9, 9, v14
s_mov_b32 s64, 0x35000000
v_mul_f32 v224, s64, v224
v_mul_f32 v225, s64, v225
v_mul_f32 v226, s64, v226
v_mul_f32 v227, s64, v227
v_mul_f32 v228, s64, v228
v_mul_f32 v229, s64, v229
v_mul_f32 v230, s64, v230
v_mul_f32 v231, s64, v231
v_mul_f32 v232, s64, v232
v_mul_f32 v233, s64, v233
v_mul_f32 v234, s64, v234
v_mul_f32 v235, s64, v235
v_mul_f32 v236, s64, v236
v_mul_f32 v237, s64, v237
v_mul_f32 v238, s64, v238
v_mul_f32 v239, s64, v239
v_mul_f32 v240, s64, v240
v_mul_f32 v241, s64, v241
v_mul_f32 v242, s64, v242
v_mul_f32 v243, s64, v243
v_mul_f32 v244, s64, v244
v_mul_f32 v245, s64, v245
v_mul_f32 v246, s64, v246
v_mul_f32 v247, s64, v247
v_mul_f32 v248, s64, v248
v_mul_f32 v249, s64, v249
v_mul_f32 v250, s64, v250
v_mul_f32 v251, s64, v251
v_mul_f32 v252, s64, v252
v_mul_f32 v253, s64, v253
v_mul_f32 v254, s64, v254
v_mul_f32 v255, s64, v255
s_waitcnt vmcnt(0)
v_mov_b32 v190, 9
s_mov_b64 exec, 1
ds_write_b32 v185, v190
s_mov_b64 exec, -1
s_cmp_lg_u32 s66, 0
s_cbranch_scc1 L_ph36
L_lc37:
ds_read_b128 v[186:189], v184
s_waitcnt lgkmcnt(0)
v_min3_u32 v186, v186, v187, v188
v_min_u32 v186, v186, v189
s_nop 0
v_readfirstlane_b32 s92, v186
s_nop 0
s_cmp_ge_u32 s92, 9
s_cbranch_scc1 L_lcd38
s_sleep 1
s_branch L_lc37
L_lcd38:
s_and_b32 s64, s2, 15
s_lshl_b32 s65, s64, 7
s_add_u32 s65, s65, 6144
s_add_u32 s90, s32, s65
s_addc_u32 s91, s33, 0
s_mov_b32 s18, 1
s_atomic_add s18, s[90:91], 0x0 glc
L_ph36:
s_cmp_lg_u32 s66, 0
s_cbranch_scc1 L_sg39
s_and_b32 s64, s2, 15
s_lshl_b32 s64, s64, 2
s_add_u32 s64, s64, 548864
s_add_u32 s4, s32, s64
s_addc_u32 s5, s33, 0
s_waitcnt lgkmcnt(0)
s_cmp_lg_u32 s18, 15
s_cbranch_scc1 L_sg39
s_atomic_swap s37, s[4:5], 0x0
s_atomic_swap s37, s[4:5], 0x80
s_atomic_swap s37, s[4:5], 0x100
s_atomic_swap s37, s[4:5], 0x180
s_atomic_swap s37, s[4:5], 0x200
s_atomic_swap s37, s[4:5], 0x280
s_atomic_swap s37, s[4:5], 0x300
s_atomic_swap s37, s[4:5], 0x380
s_atomic_swap s37, s[4:5], 0x400
s_atomic_swap s37, s[4:5], 0x480
s_atomic_swap s37, s[4:5], 0x500
s_atomic_swap s37, s[4:5], 0x580
s_atomic_swap s37, s[4:5], 0x600
s_atomic_swap s37, s[4:5], 0x680
s_atomic_swap s37, s[4:5], 0x700
s_atomic_swap s37, s[4:5], 0x780
s_atomic_swap s37, s[4:5], 0x800
s_atomic_swap s37, s[4:5], 0x880
s_atomic_swap s37, s[4:5], 0x900
s_atomic_swap s37, s[4:5], 0x980
s_atomic_swap s37, s[4:5], 0xa00
s_atomic_swap s37, s[4:5], 0xa80
s_atomic_swap s37, s[4:5], 0xb00
s_atomic_swap s37, s[4:5], 0xb80
s_atomic_swap s37, s[4:5], 0xc00
s_atomic_swap s37, s[4:5], 0xc80
s_atomic_swap s37, s[4:5], 0xd00
s_atomic_swap s37, s[4:5], 0xd80
s_atomic_swap s37, s[4:5], 0xe00
s_atomic_swap s37, s[4:5], 0xe80
s_atomic_swap s37, s[4:5], 0xf00
s_atomic_swap s37, s[4:5], 0xf80
s_waitcnt lgkmcnt(0)
L_sg39:
s_cmp_lg_u32 s66, 0
s_cbranch_scc1 L_ph40
s_and_b32 s64, s2, 31
s_lshl_b32 s64, s64, 7
s_add_u32 s64, s64, 548864
s_add_u32 s90, s32, s64
s_addc_u32 s91, s33, 0
s_mov_b32 s64, s37
s_mov_b32 s65, s37
s_mov_b32 s92, 0
s_branch L_sp41
L_nok42:
s_add_u32 s92, s92, 1
s_cmp_ge_u32 s92, 200000
s_cbranch_scc1 L_ph40
s_sleep 10
L_sp41:
s_load_dwordx16 s[4:19], s[90:91], 0x0 glc
s_waitcnt lgkmcnt(0)
s_cmp_eq_u64 s[4:5], s[64:65]
s_cbranch_scc0 L_nok42
s_cmp_eq_u64 s[6:7], s[64:65]
s_cbranch_scc0 L_nok42
s_cmp_eq_u64 s[8:9], s[64:65]
s_cbranch_scc0 L_nok42
s_cmp_eq_u64 s[10:11], s[64:65]
s_cbranch_scc0 L_nok42
s_cmp_eq_u64 s[12:13], s[64:65]
s_cbranch_scc0 L_nok42
s_cmp_eq_u64 s[14:15], s[64:65]
s_cbranch_scc0 L_nok42
s_cmp_eq_u64 s[16:17], s[64:65]
s_cbranch_scc0 L_nok42
s_cmp_eq_u64 s[18:19], s[64:65]
s_cbranch_scc0 L_nok42
L_ph40:
v_mov_b32 v190, 10
s_mov_b64 exec, 1
ds_write_b32 v185, v190
s_mov_b64 exec, -1
L_lc43:
ds_read_b128 v[186:189], v184
s_waitcnt lgkmcnt(0)
v_min3_u32 v186, v186, v187, v188
v_min_u32 v186, v186, v189
s_nop 0
v_readfirstlane_b32 s92, v186
s_nop 0
s_cmp_ge_u32 s92, 10
s_cbranch_scc1 L_lcd44
s_sleep 1
s_branch L_lc43
L_lcd44:
s_setprio 0
s_mov_b32 m0, s68
s_nop 0
buffer_load_dwordx4 v7, s[44:47], 0 offen offset:0 sc1 lds
buffer_load_dwordx4 v7, s[44:47], 0 offen offset:1024 sc1 lds
buffer_load_dwordx4 v7, s[44:47], 0 offen offset:2048 sc1 lds
buffer_load_dwordx4 v7, s[44:47], 0 offen offset:3072 sc1 lds
s_waitcnt vmcnt(0)
v_mov_b32 v190, 11
s_mov_b64 exec, 1
ds_write_b32 v185, v190
s_mov_b64 exec, -1
L_lc45:
ds_read_b128 v[186:189], v184
s_waitcnt lgkmcnt(0)
v_min3_u32 v186, v186, v187, v188
v_min_u32 v186, v186, v189
s_nop 0
v_readfirstlane_b32 s92, v186
s_nop 0
s_cmp_ge_u32 s92, 11
s_cbranch_scc1 L_lcd46
s_sleep 1
s_branch L_lc45
L_lcd46:
ds_read_b32 v24, v4 offset:0
ds_read_b32 v25, v4 offset:1024
ds_read_b32 v26, v4 offset:2048
ds_read_b32 v27, v4 offset:3072
ds_read_b32 v28, v4 offset:8192
ds_read_b32 v29, v4 offset:9216
ds_read_b32 v30, v4 offset:10240
ds_read_b32 v31, v4 offset:11264
ds_read_b32 v32, v6 offset:0
ds_read_b32 v33, v5 offset:10240
ds_read_b32 v34, v5 offset:9216
ds_read_b32 v35, v5 offset:8192
ds_read_b32 v36, v5 offset:3072
ds_read_b32 v37, v5 offset:2048
ds_read_b32 v38, v5 offset:1024
ds_read_b32 v39, v5 offset:0
s_waitcnt lgkmcnt(0)
v_mfma_f32_32x32x16_bf16 v[40:55], v[24:27], v[192:195], 0
v_mfma_f32_32x32x16_bf16 v[40:55], v[28:31], v[196:199], v[40:55]
v_mfma_f32_32x32x16_bf16 v[40:55], v[32:35], v[200:203], v[40:55]
v_mfma_f32_32x32x16_bf16 v[40:55], v[36:39], v[204:207], v[40:55]
v_mfma_f32_32x32x16_bf16 v[56:71], v[24:27], v[208:211], 0
v_mfma_f32_32x32x16_bf16 v[56:71], v[28:31], v[212:215], v[56:71]
v_mfma_f32_32x32x16_bf16 v[56:71], v[32:35], v[216:219], v[56:71]
v_mfma_f32_32x32x16_bf16 v[56:71], v[36:39], v[220:223], v[56:71]
s_nop 7
v_mul_f32 v168, v40, v224
v_mul_f32 v169, v40, v240
s_nop 1
v_fma_f32 v168, -v56, v240, v168
v_fmac_f32 v169, v56, v224
v_cvt_pk_bf16_f32 v24, v168, v169
v_mul_f32 v170, v41, v225
v_mul_f32 v171, v41, v241
v_fma_f32 v170, -v57, v241, v170
v_fmac_f32 v171, v57, v225
v_cvt_pk_bf16_f32 v25, v170, v171
v_mul_f32 v172, v42, v226
v_mul_f32 v173, v42, v242
v_fma_f32 v172, -v58, v242, v172
v_fmac_f32 v173, v58, v226
v_cvt_pk_bf16_f32 v26, v172, v173
v_mul_f32 v174, v43, v227
v_mul_f32 v175, v43, v243
v_fma_f32 v174, -v59, v243, v174
v_fmac_f32 v175, v59, v227
v_cvt_pk_bf16_f32 v27, v174, v175
v_mul_f32 v168, v44, v228
v_mul_f32 v169, v44, v244
v_fma_f32 v168, -v60, v244, v168
v_fmac_f32 v169, v60, v228
v_cvt_pk_bf16_f32 v28, v168, v169
v_mul_f32 v170, v45, v229
v_mul_f32 v171, v45, v245
v_fma_f32 v170, -v61, v245, v170
v_fmac_f32 v171, v61, v229
v_cvt_pk_bf16_f32 v29, v170, v171
v_mul_f32 v172, v46, v230
v_mul_f32 v173, v46, v246
v_fma_f32 v172, -v62, v246, v172
v_fmac_f32 v173, v62, v230
v_cvt_pk_bf16_f32 v30, v172, v173
v_mul_f32 v174, v47, v231
v_mul_f32 v175, v47, v247
v_fma_f32 v174, -v63, v247, v174
v_fmac_f32 v175, v63, v231
v_cvt_pk_bf16_f32 v31, v174, v175
v_mul_f32 v168, v48, v232
v_mul_f32 v169, v48, v248
v_fma_f32 v168, -v64, v248, v168
v_fmac_f32 v169, v64, v232
v_cvt_pk_bf16_f32 v32, v168, v169
v_mul_f32 v170, v49, v233
v_mul_f32 v171, v49, v249
v_fma_f32 v170, -v65, v249, v170
v_fmac_f32 v171, v65, v233
v_cvt_pk_bf16_f32 v33, v170, v171
v_mul_f32 v172, v50, v234
v_mul_f32 v173, v50, v250
v_fma_f32 v172, -v66, v250, v172
v_fmac_f32 v173, v66, v234
v_cvt_pk_bf16_f32 v34, v172, v173
v_mul_f32 v174, v51, v235
v_mul_f32 v175, v51, v251
v_fma_f32 v174, -v67, v251, v174
v_fmac_f32 v175, v67, v235
v_cvt_pk_bf16_f32 v35, v174, v175
v_mul_f32 v168, v52, v236
v_mul_f32 v169, v52, v252
v_fma_f32 v168, -v68, v252, v168
v_fmac_f32 v169, v68, v236
v_cvt_pk_bf16_f32 v36, v168, v169
v_mul_f32 v170, v53, v237
v_mul_f32 v171, v53, v253
v_fma_f32 v170, -v69, v253, v170
v_fmac_f32 v171, v69, v237
v_cvt_pk_bf16_f32 v37, v170, v171
v_mul_f32 v172, v54, v238
v_mul_f32 v173, v54, v254
v_fma_f32 v172, -v70, v254, v172
v_fmac_f32 v173, v70, v238
v_cvt_pk_bf16_f32 v38, v172, v173
v_mul_f32 v174, v55, v239
v_mul_f32 v175, v55, v255
v_fma_f32 v174, -v71, v255, v174
v_fmac_f32 v175, v71, v239
v_cvt_pk_bf16_f32 v39, v174, v175
v_mfma_f32_32x32x16_bf16 v[40:55], v[192:195], v[24:27], 0
v_mfma_f32_32x32x16_bf16 v[40:55], v[196:199], v[28:31], v[40:55]
v_mfma_f32_32x32x16_bf16 v[40:55], v[200:203], v[32:35], v[40:55]
v_mfma_f32_32x32x16_bf16 v[40:55], v[204:207], v[36:39], v[40:55]
v_mfma_f32_32x32x16_bf16 v[56:71], v[208:211], v[24:27], 0
v_mfma_f32_32x32x16_bf16 v[56:71], v[212:215], v[28:31], v[56:71]
v_mfma_f32_32x32x16_bf16 v[56:71], v[216:219], v[32:35], v[56:71]
v_mfma_f32_32x32x16_bf16 v[56:71], v[220:223], v[36:39], v[56:71]
s_movk_i32 s64, 0x2000
s_nop 10
v_cvt_pk_bf16_f32 v73, v56, v40
v_lshlrev_b32 v72, 16, v73
v_and_b32 v73, 0xffff0000, v73
buffer_store_dword v72, v14, s[40:43], 0 offen offset:0 nt
buffer_store_dword v73, v14, s[40:43], s64 offen offset:0 nt
v_cvt_pk_bf16_f32 v75, v57, v41
v_lshlrev_b32 v74, 16, v75
v_and_b32 v75, 0xffff0000, v75
buffer_store_dword v74, v14, s[40:43], 0 offen offset:128 nt
buffer_store_dword v75, v14, s[40:43], s64 offen offset:128 nt
v_cvt_pk_bf16_f32 v77, v58, v42
v_lshlrev_b32 v76, 16, v77
v_and_b32 v77, 0xffff0000, v77
buffer_store_dword v76, v14, s[40:43], 0 offen offset:256 nt
buffer_store_dword v77, v14, s[40:43], s64 offen offset:256 nt
v_cvt_pk_bf16_f32 v79, v59, v43
v_lshlrev_b32 v78, 16, v79
v_and_b32 v79, 0xffff0000, v79
buffer_store_dword v78, v14, s[40:43], 0 offen offset:384 nt
buffer_store_dword v79, v14, s[40:43], s64 offen offset:384 nt
v_cvt_pk_bf16_f32 v81, v60, v44
v_lshlrev_b32 v80, 16, v81
v_and_b32 v81, 0xffff0000, v81
buffer_store_dword v80, v14, s[40:43], 0 offen offset:1024 nt
buffer_store_dword v81, v14, s[40:43], s64 offen offset:1024 nt
v_cvt_pk_bf16_f32 v83, v61, v45
v_lshlrev_b32 v82, 16, v83
v_and_b32 v83, 0xffff0000, v83
buffer_store_dword v82, v14, s[40:43], 0 offen offset:1152 nt
buffer_store_dword v83, v14, s[40:43], s64 offen offset:1152 nt
v_cvt_pk_bf16_f32 v85, v62, v46
v_lshlrev_b32 v84, 16, v85
v_and_b32 v85, 0xffff0000, v85
buffer_store_dword v84, v14, s[40:43], 0 offen offset:1280 nt
buffer_store_dword v85, v14, s[40:43], s64 offen offset:1280 nt
v_cvt_pk_bf16_f32 v87, v63, v47
v_lshlrev_b32 v86, 16, v87
v_and_b32 v87, 0xffff0000, v87
buffer_store_dword v86, v14, s[40:43], 0 offen offset:1408 nt
buffer_store_dword v87, v14, s[40:43], s64 offen offset:1408 nt
v_cvt_pk_bf16_f32 v89, v64, v48
v_lshlrev_b32 v88, 16, v89
v_and_b32 v89, 0xffff0000, v89
buffer_store_dword v88, v14, s[40:43], 0 offen offset:2048 nt
buffer_store_dword v89, v14, s[40:43], s64 offen offset:2048 nt
v_cvt_pk_bf16_f32 v91, v65, v49
v_lshlrev_b32 v90, 16, v91
v_and_b32 v91, 0xffff0000, v91
buffer_store_dword v90, v14, s[40:43], 0 offen offset:2176 nt
buffer_store_dword v91, v14, s[40:43], s64 offen offset:2176 nt
v_cvt_pk_bf16_f32 v93, v66, v50
v_lshlrev_b32 v92, 16, v93
v_and_b32 v93, 0xffff0000, v93
buffer_store_dword v92, v14, s[40:43], 0 offen offset:2304 nt
buffer_store_dword v93, v14, s[40:43], s64 offen offset:2304 nt
v_cvt_pk_bf16_f32 v95, v67, v51
v_lshlrev_b32 v94, 16, v95
v_and_b32 v95, 0xffff0000, v95
buffer_store_dword v94, v14, s[40:43], 0 offen offset:2432 nt
buffer_store_dword v95, v14, s[40:43], s64 offen offset:2432 nt
v_cvt_pk_bf16_f32 v97, v68, v52
v_lshlrev_b32 v96, 16, v97
v_and_b32 v97, 0xffff0000, v97
buffer_store_dword v96, v14, s[40:43], 0 offen offset:3072 nt
buffer_store_dword v97, v14, s[40:43], s64 offen offset:3072 nt
v_cvt_pk_bf16_f32 v99, v69, v53
v_lshlrev_b32 v98, 16, v99
v_and_b32 v99, 0xffff0000, v99
buffer_store_dword v98, v14, s[40:43], 0 offen offset:3200 nt
buffer_store_dword v99, v14, s[40:43], s64 offen offset:3200 nt
v_cvt_pk_bf16_f32 v101, v70, v54
v_lshlrev_b32 v100, 16, v101
v_and_b32 v101, 0xffff0000, v101
buffer_store_dword v100, v14, s[40:43], 0 offen offset:3328 nt
buffer_store_dword v101, v14, s[40:43], s64 offen offset:3328 nt
v_cvt_pk_bf16_f32 v103, v71, v55
v_lshlrev_b32 v102, 16, v103
v_and_b32 v103, 0xffff0000, v103
buffer_store_dword v102, v14, s[40:43], 0 offen offset:3456 nt
buffer_store_dword v103, v14, s[40:43], s64 offen offset:3456 nt
s_endpgm
L_concat_heads__spectral_gfnet__ssm_conv_s5__prompt_kernel_gemm:
s_lshr_b32 s68, s34, 1
s_and_b32 s66, s34, 1
s_lshr_b32 s101, s36, 3
v_and_b32 v6, 31, v1
v_lshrrev_b32 v5, 5, v1
v_lshlrev_b32 v11, 4, v1
v_mov_b64 v[64:65], 0
v_mov_b64 v[66:67], 0
s_mul_i32 s60, s34, 2304
s_add_u32 s60, s60, 114688
v_add_u32 v13, s60, v11
v_mov_b32 v12, 126976
ds_write_b128 v13, v[64:67]
ds_write_b128 v13, v[64:67] offset:1024
ds_write_b128 v13, v[64:67] offset:2048
s_mov_b64 exec, 1
ds_write_b128 v12, v[64:67]
ds_write_b128 v12, v[64:67] offset:16
ds_write_b128 v12, v[64:67] offset:32
ds_write_b128 v12, v[64:67] offset:48
ds_write_b128 v12, v[64:67] offset:64
s_mov_b64 exec, -1
s_lshl_b32 s60, s34, 2
v_add_u32 v13, s60, v12
s_waitcnt lgkmcnt(0)
s_barrier
v_bfe_u32 v4, v1, 2, 2
v_lshlrev_b32 v4, 3, v4
v_and_b32 v7, 3, v1
v_add_u32 v4, v4, v7
s_lshl_b32 s60, s36, 6
s_lshl_b32 s61, s66, 5
s_add_u32 s60, s60, s61
v_add_u32 v4, s60, v4
v_lshlrev_b32 v7, 1, v4
v_lshrrev_b32 v14, 5, v1
v_bfe_u32 v15, v1, 3, 2
v_and_b32 v16, 1, v15
v_lshrrev_b32 v17, 1, v15
v_lshlrev_b32 v18, 4, v14
v_lshl_add_u32 v18, v16, 3, v18
v_add_u32 v18, v18, v17
s_lshl_b32 s61, s68, 6
s_lshl_b32 s62, s66, 2
s_add_u32 s61, s61, s62
v_add_u32 v18, s61, v18
v_lshlrev_b32 v18, 11, v18
s_lshl_b32 s61, s68, 5
v_lshl_add_u32 v19, v14, 3, v15
v_add_u32 v19, s61, v19
v_lshlrev_b32 v19, 11, v19
v_and_b32 v16, 7, v1
v_lshrrev_b32 v17, 4, v1
v_xor_b32 v16, v16, v17
v_lshlrev_b32 v16, 4, v16
v_xor_b32 v17, 64, v16
v_add_u32 v244, v18, v16
v_add_u32 v245, v18, v17
v_add_u32 v245, 64512, v245
v_add_u32 v246, v19, v16
v_add_u32 v247, v19, v17
v_add_u32 v247, 31744, v247
s_mul_i32 s38, s35, 128
s_mul_i32 s60, s36, 128
s_add_u32 s38, s38, s60
s_lshl_b32 s60, s35, 18
s_lshl_b32 s61, s36, 17
s_lshl_b32 s39, s34, 12
s_waitcnt lgkmcnt(0)
global_load_ushort v248, v7, s[12:13] offset:0
global_load_ushort v249, v7, s[14:15] offset:0
global_load_ushort v250, v7, s[24:25] offset:0
global_load_ushort v251, v7, s[12:13] offset:8
global_load_ushort v252, v7, s[14:15] offset:8
global_load_ushort v253, v7, s[24:25] offset:8
s_add_u32 s48, s10, s60
s_addc_u32 s49, s11, 0
s_mov_b32 s50, 262144
s_mov_b32 s51, 0x20000
s_cmp_eq_u32 s66, 1
s_cselect_b32 s62, s18, s16
s_cselect_b32 s63, s19, s17
s_add_u32 s52, s62, s61
s_addc_u32 s53, s63, 0
s_mov_b32 s54, 131072
s_mov_b32 s55, 0x20000
s_add_u32 s62, s38, 0
s_and_b32 s62, s62, 0x7ff
s_add_u32 s63, s62, 2048
s_add_u32 s64, s62, 6144
s_add_u32 m0, s39, 0
s_nop 0
buffer_load_dwordx4 v244, s[48:51], s62 offen offset:0 lds
buffer_load_dwordx4 v245, s[48:51], s62 offen offset:1024 lds
buffer_load_dwordx4 v244, s[48:51], s63 offen offset:2048 lds
buffer_load_dwordx4 v245, s[48:51], s63 offen offset:3072 lds
s_add_u32 m0, s39, 16384
s_nop 0
buffer_load_dwordx4 v246, s[52:55], s62 offen offset:0 lds
buffer_load_dwordx4 v247, s[52:55], s62 offen offset:1024 lds
buffer_load_dwordx4 v246, s[52:55], s64 offen offset:2048 lds
buffer_load_dwordx4 v247, s[52:55], s64 offen offset:3072 lds
v_bfe_u32 v7, v1, 4, 1
v_lshl_add_u32 v4, v7, 2, v4
v_bfe_u32 v7, v6, 1, 3
v_xor_b32 v7, v7, v5
v_lshlrev_b32 v7, 4, v7
v_lshl_add_u32 v7, v6, 7, v7
v_and_b32 v8, 15, v1
v_lshrrev_b32 v9, 4, v1
v_lshrrev_b32 v14, 1, v8
v_xor_b32 v14, v14, v9
v_lshlrev_b32 v14, 4, v14
v_lshl_add_u32 v14, v8, 7, v14
s_lshl_b32 s60, s68, 13
s_lshl_b32 s61, s66, 13
s_add_u32 s61, s61, 16384
v_xor_b32 v15, 0, v14
v_add_u32 v128, s60, v15
v_add_u32 v130, s61, v15
v_add_u32 v132, 0x10000, v128
v_add_u32 v134, 0x10000, v130
v_xor_b32 v15, 64, v14
v_add_u32 v129, s60, v15
v_add_u32 v131, s61, v15
v_add_u32 v133, 0x10000, v129
v_add_u32 v135, 0x10000, v131
s_add_u32 s40, s32, 65536
s_addc_u32 s41, s33, 0
s_mov_b32 s42, 262144
s_mov_b32 s43, 0x20000
s_add_u32 s44, s32, 1048576
s_addc_u32 s45, s33, 0
s_mov_b32 s46, 8388608
s_mov_b32 s47, 0x20000
s_mul_i32 s60, s66, 4608
s_add_u32 s60, s60, 114752
s_lshl_b32 s61, s68, 5
s_add_u32 s61, s61, s60
v_mul_u32_u24 v14, 144, v6
v_add_u32 v14, s60, v14
v_lshl_add_u32 v14, v5, 5, v14
v_mul_u32_u24 v15, 144, v8
v_add_u32 v15, s61, v15
v_lshl_add_u32 v15, v9, 3, v15
s_lshl_b32 s60, s35, 14
v_lshl_add_u32 v16, v4, 4, s60
v_mov_b32 v17, 0x40000000
v_lshlrev_b32 v10, 14, v5
v_sub_u32 v10, v16, v10
v_subrev_u32 v136, 16384, v10
v_cmp_le_i32 vcc, 0, v136
s_nop 1
v_cndmask_b32 v136, v17, v136, vcc
v_subrev_u32 v137, 49152, v10
v_cmp_le_i32 vcc, 0, v137
s_nop 1
v_cndmask_b32 v137, v17, v137, vcc
v_subrev_u32 v138, 81920, v10
v_cmp_le_i32 vcc, 0, v138
s_nop 1
v_cndmask_b32 v138, v17, v138, vcc
v_subrev_u32 v139, 114688, v10
v_cmp_le_i32 vcc, 0, v139
s_nop 1
v_cndmask_b32 v139, v17, v139, vcc
v_subrev_u32 v140, 147456, v10
v_cmp_le_i32 vcc, 0, v140
s_nop 1
v_cndmask_b32 v140, v17, v140, vcc
v_subrev_u32 v141, 180224, v10
v_cmp_le_i32 vcc, 0, v141
s_nop 1
v_cndmask_b32 v141, v17, v141, vcc
v_subrev_u32 v142, 212992, v10
v_cmp_le_i32 vcc, 0, v142
s_nop 1
v_cndmask_b32 v142, v17, v142, vcc
v_subrev_u32 v143, 245760, v10
v_cmp_le_i32 vcc, 0, v143
s_nop 1
v_cndmask_b32 v143, v17, v143, vcc
v_lshlrev_b32 v17, 30, v5
v_or_b32 v16, v16, v17
s_lshl_b32 s60, s35, 11
s_add_u32 s60, s60, 32768
s_lshl_b32 s61, s36, 7
s_add_u32 s61, s61, s60
v_mov_b32 v195, s61
s_lshl_b32 s61, s101, 10
s_add_u32 s60, s60, s61
v_and_b32 v196, 7, v1
v_lshl_add_u32 v196, v196, 7, s60
s_lshl_b32 s60, s35, 1
s_add_u32 s60, s60, s68
s_lshl_b32 s60, s60, 12
s_add_u32 s60, s60, 393216
s_lshl_b32 s61, s101, 11
s_add_u32 s61, s61, s60
v_lshl_add_u32 v18, v8, 7, s61
s_lshl_b32 s61, s36, 8
s_add_u32 s60, s60, s61
s_lshl_b32 s61, s66, 7
s_add_u32 s60, s60, s61
v_mov_b32 v19, s60
v_lshrrev_b32 v10, 1, v9
v_lshlrev_b32 v10, 10, v10
v_and_b32 v17, 1, v9
v_lshl_add_u32 v10, v17, 9, v10
v_lshl_add_u32 v10, v8, 4, v10
s_lshl_b32 s60, s68, 2
v_add_u32 v9, s60, v9
v_cvt_f32_u32 v9, v9
v_mul_f32 v9, 0x41800000, v9
v_add_f32 v8, 0x41000000, v9
s_add_u32 s62, s38, 128
s_and_b32 s62, s62, 0x7ff
s_add_u32 s63, s62, 2048
s_add_u32 s64, s62, 6144
s_add_u32 m0, s39, 32768
s_nop 0
buffer_load_dwordx4 v244, s[48:51], s62 offen offset:0 lds
buffer_load_dwordx4 v245, s[48:51], s62 offen offset:1024 lds
buffer_load_dwordx4 v244, s[48:51], s63 offen offset:2048 lds
buffer_load_dwordx4 v245, s[48:51], s63 offen offset:3072 lds
s_add_u32 m0, s39, 49152
s_nop 0
buffer_load_dwordx4 v246, s[52:55], s62 offen offset:0 lds
buffer_load_dwordx4 v247, s[52:55], s62 offen offset:1024 lds
buffer_load_dwordx4 v246, s[52:55], s64 offen offset:2048 lds
buffer_load_dwordx4 v247, s[52:55], s64 offen offset:3072 lds
s_setprio 0
s_waitcnt vmcnt(8)
s_barrier
ds_read_b128 v[32:35], v128 offset:0
ds_read_b128 v[48:51], v130 offset:0
ds_read_b128 v[52:55], v130 offset:2048
ds_read_b128 v[56:59], v130 offset:4096
ds_read_b128 v[60:63], v130 offset:6144
ds_read_b128 v[36:39], v128 offset:2048
ds_read_b128 v[40:43], v128 offset:4096
ds_read_b128 v[44:47], v128 offset:6144
s_waitcnt lgkmcnt(6)
v_mfma_f32_16x16x32_bf16 v[64:67], v[32:35], v[48:51], 0
ds_read_b128 v[144:147], v129 offset:0
s_waitcnt lgkmcnt(6)
v_mfma_f32_16x16x32_bf16 v[96:99], v[32:35], v[52:55], 0
ds_read_b128 v[160:163], v131 offset:0
s_waitcnt lgkmcnt(6)
v_mfma_f32_16x16x32_bf16 v[80:83], v[32:35], v[56:59], 0
ds_read_b128 v[164:167], v131 offset:2048
s_waitcnt lgkmcnt(6)
v_mfma_f32_16x16x32_bf16 v[112:115], v[32:35], v[60:63], 0
ds_read_b128 v[168:171], v131 offset:4096
s_waitcnt lgkmcnt(6)
v_mfma_f32_16x16x32_bf16 v[68:71], v[36:39], v[48:51], 0
ds_read_b128 v[172:175], v131 offset:6144
v_mfma_f32_16x16x32_bf16 v[100:103], v[36:39], v[52:55], 0
ds_read_b128 v[148:151], v129 offset:2048
v_mfma_f32_16x16x32_bf16 v[84:87], v[36:39], v[56:59], 0
ds_read_b128 v[152:155], v129 offset:4096
v_mfma_f32_16x16x32_bf16 v[116:119], v[36:39], v[60:63], 0
ds_read_b128 v[156:159], v129 offset:6144
s_waitcnt lgkmcnt(9)
v_mfma_f32_16x16x32_bf16 v[72:75], v[40:43], v[48:51], 0
v_lshlrev_b32 v248, 16, v248
v_lshlrev_b32 v249, 16, v249
v_mfma_f32_16x16x32_bf16 v[104:107], v[40:43], v[52:55], 0
v_lshlrev_b32 v250, 16, v250
v_mul_f32 v250, 0x3fb8aa3b, v250
v_mfma_f32_16x16x32_bf16 v[88:91], v[40:43], v[56:59], 0
v_exp_f32 v250, v250
s_nop 0
v_cvt_pk_bf16_f32 v250, v250, v250
v_mfma_f32_16x16x32_bf16 v[120:123], v[40:43], v[60:63], 0
v_lshlrev_b32 v250, 16, v250
v_mul_f32 v204, v250, v248
s_waitcnt lgkmcnt(8)
v_mfma_f32_16x16x32_bf16 v[76:79], v[44:47], v[48:51], 0
v_mul_f32 v206, v250, v249
v_mul_f32 v204, 0x3fb8aa3b, v204
v_mfma_f32_16x16x32_bf16 v[108:111], v[44:47], v[52:55], 0
v_mul_f32 v206, 0.15915494, v206
v_mul_f32 v197, 0x3f800000, v204
v_mfma_f32_16x16x32_bf16 v[92:95], v[44:47], v[56:59], 0
v_mul_f32 v198, 0x3f800000, v206
v_exp_f32 v197, v197
v_mfma_f32_16x16x32_bf16 v[124:127], v[44:47], v[60:63], 0
v_rndne_f32 v199, v198
v_sub_f32 v198, v198, v199
s_waitcnt vmcnt(0) lgkmcnt(0)
s_barrier
v_mfma_f32_16x16x32_bf16 v[64:67], v[144:147], v[160:163], v[64:67]
ds_read_b128 v[32:35], v128 offset:32768
v_mfma_f32_16x16x32_bf16 v[96:99], v[144:147], v[164:167], v[96:99]
ds_read_b128 v[48:51], v130 offset:32768
v_mfma_f32_16x16x32_bf16 v[80:83], v[144:147], v[168:171], v[80:83]
ds_read_b128 v[52:55], v130 offset:34816
v_mfma_f32_16x16x32_bf16 v[112:115], v[144:147], v[172:175], v[112:115]
ds_read_b128 v[56:59], v130 offset:36864
v_mfma_f32_16x16x32_bf16 v[68:71], v[148:151], v[160:163], v[68:71]
ds_read_b128 v[60:63], v130 offset:38912
v_mfma_f32_16x16x32_bf16 v[100:103], v[148:151], v[164:167], v[100:103]
ds_read_b128 v[36:39], v128 offset:34816
v_mfma_f32_16x16x32_bf16 v[84:87], v[148:151], v[168:171], v[84:87]
ds_read_b128 v[40:43], v128 offset:36864
v_mfma_f32_16x16x32_bf16 v[116:119], v[148:151], v[172:175], v[116:119]
ds_read_b128 v[44:47], v128 offset:38912
v_mfma_f32_16x16x32_bf16 v[72:75], v[152:155], v[160:163], v[72:75]
v_cos_f32 v199, v198
v_sin_f32 v198, v198
v_mfma_f32_16x16x32_bf16 v[104:107], v[152:155], v[164:167], v[104:107]
v_mul_f32 v20, v197, v199
v_mul_f32 v21, v197, v198
v_mfma_f32_16x16x32_bf16 v[88:91], v[152:155], v[168:171], v[88:91]
v_add_f32 v197, -1.0, v20
v_mul_f32 v198, v248, v248
v_mfma_f32_16x16x32_bf16 v[120:123], v[152:155], v[172:175], v[120:123]
v_fma_f32 v198, v249, v249, v198
v_rcp_f32 v198, v198
v_mfma_f32_16x16x32_bf16 v[76:79], v[156:159], v[160:163], v[76:79]
v_add_f32 v198, v198, v198
v_mul_f32 v199, v197, v248
v_mfma_f32_16x16x32_bf16 v[108:111], v[156:159], v[164:167], v[108:111]
v_fma_f32 v199, v21, v249, v199
v_mul_f32 v24, v199, v198
v_mfma_f32_16x16x32_bf16 v[92:95], v[156:159], v[168:171], v[92:95]
v_mul_f32 v199, v21, v248
v_fma_f32 v199, -v197, v249, v199
v_mfma_f32_16x16x32_bf16 v[124:127], v[156:159], v[172:175], v[124:127]
v_mul_f32 v25, v199, v198
v_mul_f32 v197, 0x41000000, v204
s_waitcnt lgkmcnt(6)
v_mfma_f32_16x16x32_bf16 v[64:67], v[32:35], v[48:51], v[64:67]
ds_read_b128 v[144:147], v129 offset:32768
s_waitcnt lgkmcnt(6)
v_mfma_f32_16x16x32_bf16 v[96:99], v[32:35], v[52:55], v[96:99]
ds_read_b128 v[160:163], v131 offset:32768
s_waitcnt lgkmcnt(6)
v_mfma_f32_16x16x32_bf16 v[80:83], v[32:35], v[56:59], v[80:83]
ds_read_b128 v[164:167], v131 offset:34816
s_waitcnt lgkmcnt(6)
v_mfma_f32_16x16x32_bf16 v[112:115], v[32:35], v[60:63], v[112:115]
ds_read_b128 v[168:171], v131 offset:36864
s_waitcnt lgkmcnt(6)
v_mfma_f32_16x16x32_bf16 v[68:71], v[36:39], v[48:51], v[68:71]
ds_read_b128 v[172:175], v131 offset:38912
v_mfma_f32_16x16x32_bf16 v[100:103], v[36:39], v[52:55], v[100:103]
ds_read_b128 v[148:151], v129 offset:34816
v_mfma_f32_16x16x32_bf16 v[84:87], v[36:39], v[56:59], v[84:87]
ds_read_b128 v[152:155], v129 offset:36864
v_mfma_f32_16x16x32_bf16 v[116:119], v[36:39], v[60:63], v[116:119]
ds_read_b128 v[156:159], v129 offset:38912
s_waitcnt lgkmcnt(9)
v_mfma_f32_16x16x32_bf16 v[72:75], v[40:43], v[48:51], v[72:75]
v_mul_f32 v198, 0x41000000, v206
v_exp_f32 v197, v197
v_mfma_f32_16x16x32_bf16 v[104:107], v[40:43], v[52:55], v[104:107]
v_rndne_f32 v199, v198
v_sub_f32 v198, v198, v199
v_mfma_f32_16x16x32_bf16 v[88:91], v[40:43], v[56:59], v[88:91]
v_cos_f32 v199, v198
v_sin_f32 v198, v198
v_mfma_f32_16x16x32_bf16 v[120:123], v[40:43], v[60:63], v[120:123]
v_mul_f32 v176, v197, v199
v_mul_f32 v177, v197, v198
s_waitcnt lgkmcnt(8)
v_mfma_f32_16x16x32_bf16 v[76:79], v[44:47], v[48:51], v[76:79]
v_mul_f32 v197, 0x41800000, v204
v_mul_f32 v198, 0x41800000, v206
v_mfma_f32_16x16x32_bf16 v[108:111], v[44:47], v[52:55], v[108:111]
v_exp_f32 v197, v197
v_rndne_f32 v199, v198
v_mfma_f32_16x16x32_bf16 v[92:95], v[44:47], v[56:59], v[92:95]
v_sub_f32 v198, v198, v199
v_cos_f32 v199, v198
v_mfma_f32_16x16x32_bf16 v[124:127], v[44:47], v[60:63], v[124:127]
v_sin_f32 v198, v198
v_mul_f32 v180, v197, v199
s_waitcnt lgkmcnt(0)
s_barrier
v_mfma_f32_16x16x32_bf16 v[64:67], v[144:147], v[160:163], v[64:67]
ds_read_b128 v[32:35], v132 offset:0
v_mfma_f32_16x16x32_bf16 v[96:99], v[144:147], v[164:167], v[96:99]
ds_read_b128 v[48:51], v134 offset:0
v_mfma_f32_16x16x32_bf16 v[80:83], v[144:147], v[168:171], v[80:83]
ds_read_b128 v[52:55], v134 offset:2048
v_mfma_f32_16x16x32_bf16 v[112:115], v[144:147], v[172:175], v[112:115]
ds_read_b128 v[56:59], v134 offset:4096
v_mfma_f32_16x16x32_bf16 v[68:71], v[148:151], v[160:163], v[68:71]
ds_read_b128 v[60:63], v134 offset:6144
v_mfma_f32_16x16x32_bf16 v[100:103], v[148:151], v[164:167], v[100:103]
ds_read_b128 v[36:39], v132 offset:2048
v_mfma_f32_16x16x32_bf16 v[84:87], v[148:151], v[168:171], v[84:87]
ds_read_b128 v[40:43], v132 offset:4096
v_mfma_f32_16x16x32_bf16 v[116:119], v[148:151], v[172:175], v[116:119]
ds_read_b128 v[44:47], v132 offset:6144
v_mfma_f32_16x16x32_bf16 v[72:75], v[152:155], v[160:163], v[72:75]
v_mul_f32 v181, v197, v198
v_mul_f32 v197, v9, v204
v_mfma_f32_16x16x32_bf16 v[104:107], v[152:155], v[164:167], v[104:107]
v_mul_f32 v198, v9, v206
v_exp_f32 v197, v197
v_mfma_f32_16x16x32_bf16 v[88:91], v[152:155], v[168:171], v[88:91]
v_rndne_f32 v199, v198
v_sub_f32 v198, v198, v199
v_mfma_f32_16x16x32_bf16 v[120:123], v[152:155], v[172:175], v[120:123]
v_cos_f32 v199, v198
v_sin_f32 v198, v198
v_mfma_f32_16x16x32_bf16 v[76:79], v[156:159], v[160:163], v[76:79]
v_mul_f32 v200, v197, v199
v_mul_f32 v201, v197, v198
v_mfma_f32_16x16x32_bf16 v[108:111], v[156:159], v[164:167], v[108:111]
v_mov_b32 v184, v200
v_mov_b32 v186, v201
v_mfma_f32_16x16x32_bf16 v[92:95], v[156:159], v[168:171], v[92:95]
v_mul_f32 v197, v8, v204
v_mul_f32 v198, v8, v206
v_mfma_f32_16x16x32_bf16 v[124:127], v[156:159], v[172:175], v[124:127]
v_exp_f32 v197, v197
v_rndne_f32 v199, v198
s_waitcnt lgkmcnt(6)
v_mfma_f32_16x16x32_bf16 v[64:67], v[32:35], v[48:51], v[64:67]
ds_read_b128 v[144:147], v133 offset:0
s_waitcnt lgkmcnt(6)
v_mfma_f32_16x16x32_bf16 v[96:99], v[32:35], v[52:55], v[96:99]
ds_read_b128 v[160:163], v135 offset:0
s_waitcnt lgkmcnt(6)
v_mfma_f32_16x16x32_bf16 v[80:83], v[32:35], v[56:59], v[80:83]
ds_read_b128 v[164:167], v135 offset:2048
s_waitcnt lgkmcnt(6)
v_mfma_f32_16x16x32_bf16 v[112:115], v[32:35], v[60:63], v[112:115]
ds_read_b128 v[168:171], v135 offset:4096
s_waitcnt lgkmcnt(6)
v_mfma_f32_16x16x32_bf16 v[68:71], v[36:39], v[48:51], v[68:71]
ds_read_b128 v[172:175], v135 offset:6144
v_mfma_f32_16x16x32_bf16 v[100:103], v[36:39], v[52:55], v[100:103]
ds_read_b128 v[148:151], v133 offset:2048
v_mfma_f32_16x16x32_bf16 v[84:87], v[36:39], v[56:59], v[84:87]
ds_read_b128 v[152:155], v133 offset:4096
v_mfma_f32_16x16x32_bf16 v[116:119], v[36:39], v[60:63], v[116:119]
ds_read_b128 v[156:159], v133 offset:6144
s_waitcnt lgkmcnt(9)
v_mfma_f32_16x16x32_bf16 v[72:75], v[40:43], v[48:51], v[72:75]
v_sub_f32 v198, v198, v199
v_cos_f32 v199, v198
v_mfma_f32_16x16x32_bf16 v[104:107], v[40:43], v[52:55], v[104:107]
v_sin_f32 v198, v198
v_mul_f32 v200, v197, v199
v_mfma_f32_16x16x32_bf16 v[88:91], v[40:43], v[56:59], v[88:91]
v_mul_f32 v201, v197, v198
v_mov_b32 v185, v200
v_mfma_f32_16x16x32_bf16 v[120:123], v[40:43], v[60:63], v[120:123]
v_mov_b32 v187, v201
v_mul_f32 v197, v25, v21
s_waitcnt lgkmcnt(8)
v_mfma_f32_16x16x32_bf16 v[76:79], v[44:47], v[48:51], v[76:79]
v_mul_f32 v198, v25, v20
v_fma_f32 v208, v24, v20, -v197
v_mfma_f32_16x16x32_bf16 v[108:111], v[44:47], v[52:55], v[108:111]
v_fma_f32 v209, v24, v21, v198
v_mul_f32 v197, v209, v21
v_mfma_f32_16x16x32_bf16 v[92:95], v[44:47], v[56:59], v[92:95]
v_mul_f32 v198, v209, v20
v_fma_f32 v210, v208, v20, -v197
v_mfma_f32_16x16x32_bf16 v[124:127], v[44:47], v[60:63], v[124:127]
v_fma_f32 v211, v208, v21, v198
v_mul_f32 v197, v211, v21
s_waitcnt lgkmcnt(0)
s_barrier
v_mfma_f32_16x16x32_bf16 v[64:67], v[144:147], v[160:163], v[64:67]
ds_read_b128 v[32:35], v128 offset:0
v_mfma_f32_16x16x32_bf16 v[96:99], v[144:147], v[164:167], v[96:99]
ds_read_b128 v[48:51], v130 offset:0
v_mfma_f32_16x16x32_bf16 v[80:83], v[144:147], v[168:171], v[80:83]
ds_read_b128 v[52:55], v130 offset:2048
v_mfma_f32_16x16x32_bf16 v[112:115], v[144:147], v[172:175], v[112:115]
ds_read_b128 v[56:59], v130 offset:4096
v_mfma_f32_16x16x32_bf16 v[68:71], v[148:151], v[160:163], v[68:71]
ds_read_b128 v[60:63], v130 offset:6144
v_mfma_f32_16x16x32_bf16 v[100:103], v[148:151], v[164:167], v[100:103]
ds_read_b128 v[36:39], v128 offset:2048
v_mfma_f32_16x16x32_bf16 v[84:87], v[148:151], v[168:171], v[84:87]
ds_read_b128 v[40:43], v128 offset:4096
v_mfma_f32_16x16x32_bf16 v[116:119], v[148:151], v[172:175], v[116:119]
ds_read_b128 v[44:47], v128 offset:6144
v_mfma_f32_16x16x32_bf16 v[72:75], v[152:155], v[160:163], v[72:75]
v_mul_f32 v198, v211, v20
v_fma_f32 v212, v210, v20, -v197
v_mfma_f32_16x16x32_bf16 v[104:107], v[152:155], v[164:167], v[104:107]
v_fma_f32 v213, v210, v21, v198
v_mul_f32 v197, v213, v21
v_mfma_f32_16x16x32_bf16 v[88:91], v[152:155], v[168:171], v[88:91]
v_mul_f32 v198, v213, v20
v_fma_f32 v214, v212, v20, -v197
v_mfma_f32_16x16x32_bf16 v[120:123], v[152:155], v[172:175], v[120:123]
v_fma_f32 v215, v212, v21, v198
v_mul_f32 v197, v215, v21
v_mfma_f32_16x16x32_bf16 v[76:79], v[156:159], v[160:163], v[76:79]
v_mul_f32 v198, v215, v20
v_fma_f32 v216, v214, v20, -v197
v_mfma_f32_16x16x32_bf16 v[108:111], v[156:159], v[164:167], v[108:111]
v_fma_f32 v217, v214, v21, v198
v_mul_f32 v197, v217, v21
v_mfma_f32_16x16x32_bf16 v[92:95], v[156:159], v[168:171], v[92:95]
v_mul_f32 v198, v217, v20
v_fma_f32 v218, v216, v20, -v197
v_mfma_f32_16x16x32_bf16 v[124:127], v[156:159], v[172:175], v[124:127]
v_fma_f32 v219, v216, v21, v198
v_mul_f32 v197, v219, v21
s_waitcnt lgkmcnt(6)
v_mfma_f32_16x16x32_bf16 v[64:67], v[32:35], v[48:51], v[64:67]
ds_read_b128 v[144:147], v129 offset:0
s_waitcnt lgkmcnt(6)
v_mfma_f32_16x16x32_bf16 v[96:99], v[32:35], v[52:55], v[96:99]
ds_read_b128 v[160:163], v131 offset:0
s_waitcnt lgkmcnt(6)
v_mfma_f32_16x16x32_bf16 v[80:83], v[32:35], v[56:59], v[80:83]
ds_read_b128 v[164:167], v131 offset:2048
s_waitcnt lgkmcnt(6)
v_mfma_f32_16x16x32_bf16 v[112:115], v[32:35], v[60:63], v[112:115]
ds_read_b128 v[168:171], v131 offset:4096
s_waitcnt lgkmcnt(6)
v_mfma_f32_16x16x32_bf16 v[68:71], v[36:39], v[48:51], v[68:71]
ds_read_b128 v[172:175], v131 offset:6144
v_mfma_f32_16x16x32_bf16 v[100:103], v[36:39], v[52:55], v[100:103]
ds_read_b128 v[148:151], v129 offset:2048
v_mfma_f32_16x16x32_bf16 v[84:87], v[36:39], v[56:59], v[84:87]
ds_read_b128 v[152:155], v129 offset:4096
v_mfma_f32_16x16x32_bf16 v[116:119], v[36:39], v[60:63], v[116:119]
ds_read_b128 v[156:159], v129 offset:6144
s_waitcnt lgkmcnt(9)
v_mfma_f32_16x16x32_bf16 v[72:75], v[40:43], v[48:51], v[72:75]
v_mul_f32 v198, v219, v20
v_fma_f32 v220, v218, v20, -v197
v_mfma_f32_16x16x32_bf16 v[104:107], v[40:43], v[52:55], v[104:107]
v_fma_f32 v221, v218, v21, v198
v_mul_f32 v197, v221, v21
v_mfma_f32_16x16x32_bf16 v[88:91], v[40:43], v[56:59], v[88:91]
v_mul_f32 v198, v221, v20
v_fma_f32 v222, v220, v20, -v197
v_mfma_f32_16x16x32_bf16 v[120:123], v[40:43], v[60:63], v[120:123]
v_fma_f32 v223, v220, v21, v198
v_lshlrev_b32 v251, 16, v251
s_waitcnt lgkmcnt(8)
v_mfma_f32_16x16x32_bf16 v[76:79], v[44:47], v[48:51], v[76:79]
v_lshlrev_b32 v252, 16, v252
v_lshlrev_b32 v253, 16, v253
v_mfma_f32_16x16x32_bf16 v[108:111], v[44:47], v[52:55], v[108:111]
v_mul_f32 v253, 0x3fb8aa3b, v253
v_exp_f32 v253, v253
v_mfma_f32_16x16x32_bf16 v[92:95], v[44:47], v[56:59], v[92:95]
v_cvt_pk_bf16_f32 v253, v253, v253
v_lshlrev_b32 v253, 16, v253
v_mfma_f32_16x16x32_bf16 v[124:127], v[44:47], v[60:63], v[124:127]
v_mul_f32 v205, v253, v251
v_mul_f32 v207, v253, v252
s_waitcnt lgkmcnt(0)
s_barrier
v_mfma_f32_16x16x32_bf16 v[64:67], v[144:147], v[160:163], v[64:67]
ds_read_b128 v[32:35], v128 offset:32768
v_mfma_f32_16x16x32_bf16 v[96:99], v[144:147], v[164:167], v[96:99]
ds_read_b128 v[48:51], v130 offset:32768
v_mfma_f32_16x16x32_bf16 v[80:83], v[144:147], v[168:171], v[80:83]
ds_read_b128 v[52:55], v130 offset:34816
v_mfma_f32_16x16x32_bf16 v[112:115], v[144:147], v[172:175], v[112:115]
ds_read_b128 v[56:59], v130 offset:36864
v_mfma_f32_16x16x32_bf16 v[68:71], v[148:151], v[160:163], v[68:71]
ds_read_b128 v[60:63], v130 offset:38912
v_mfma_f32_16x16x32_bf16 v[100:103], v[148:151], v[164:167], v[100:103]
ds_read_b128 v[36:39], v128 offset:34816
v_mfma_f32_16x16x32_bf16 v[84:87], v[148:151], v[168:171], v[84:87]
ds_read_b128 v[40:43], v128 offset:36864
v_mfma_f32_16x16x32_bf16 v[116:119], v[148:151], v[172:175], v[116:119]
ds_read_b128 v[44:47], v128 offset:38912
v_mfma_f32_16x16x32_bf16 v[72:75], v[152:155], v[160:163], v[72:75]
v_mul_f32 v205, 0x3fb8aa3b, v205
v_mul_f32 v207, 0.15915494, v207
v_mfma_f32_16x16x32_bf16 v[104:107], v[152:155], v[164:167], v[104:107]
v_mul_f32 v197, 0x3f800000, v205
v_mul_f32 v198, 0x3f800000, v207
v_mfma_f32_16x16x32_bf16 v[88:91], v[152:155], v[168:171], v[88:91]
v_exp_f32 v197, v197
v_rndne_f32 v199, v198
v_mfma_f32_16x16x32_bf16 v[120:123], v[152:155], v[172:175], v[120:123]
v_sub_f32 v198, v198, v199
v_cos_f32 v199, v198
v_mfma_f32_16x16x32_bf16 v[76:79], v[156:159], v[160:163], v[76:79]
v_sin_f32 v198, v198
v_mul_f32 v22, v197, v199
v_mfma_f32_16x16x32_bf16 v[108:111], v[156:159], v[164:167], v[108:111]
v_mul_f32 v23, v197, v198
v_add_f32 v197, -1.0, v22
v_mfma_f32_16x16x32_bf16 v[92:95], v[156:159], v[168:171], v[92:95]
v_mul_f32 v198, v251, v251
v_fma_f32 v198, v252, v252, v198
v_mfma_f32_16x16x32_bf16 v[124:127], v[156:159], v[172:175], v[124:127]
v_rcp_f32 v198, v198
s_nop 0
v_add_f32 v198, v198, v198
s_waitcnt lgkmcnt(6)
v_mfma_f32_16x16x32_bf16 v[64:67], v[32:35], v[48:51], v[64:67]
ds_read_b128 v[144:147], v129 offset:32768
s_waitcnt lgkmcnt(6)
v_mfma_f32_16x16x32_bf16 v[96:99], v[32:35], v[52:55], v[96:99]
ds_read_b128 v[160:163], v131 offset:32768
s_waitcnt lgkmcnt(6)
v_mfma_f32_16x16x32_bf16 v[80:83], v[32:35], v[56:59], v[80:83]
ds_read_b128 v[164:167], v131 offset:34816
s_waitcnt lgkmcnt(6)
v_mfma_f32_16x16x32_bf16 v[112:115], v[32:35], v[60:63], v[112:115]
ds_read_b128 v[168:171], v131 offset:36864
s_waitcnt lgkmcnt(6)
v_mfma_f32_16x16x32_bf16 v[68:71], v[36:39], v[48:51], v[68:71]
ds_read_b128 v[172:175], v131 offset:38912
v_mfma_f32_16x16x32_bf16 v[100:103], v[36:39], v[52:55], v[100:103]
ds_read_b128 v[148:151], v129 offset:34816
v_mfma_f32_16x16x32_bf16 v[84:87], v[36:39], v[56:59], v[84:87]
ds_read_b128 v[152:155], v129 offset:36864
v_mfma_f32_16x16x32_bf16 v[116:119], v[36:39], v[60:63], v[116:119]
ds_read_b128 v[156:159], v129 offset:38912
s_waitcnt lgkmcnt(9)
v_mfma_f32_16x16x32_bf16 v[72:75], v[40:43], v[48:51], v[72:75]
v_mul_f32 v199, v197, v251
v_fma_f32 v199, v23, v252, v199
v_mfma_f32_16x16x32_bf16 v[104:107], v[40:43], v[52:55], v[104:107]
v_mul_f32 v26, v199, v198
v_mul_f32 v199, v23, v251
v_mfma_f32_16x16x32_bf16 v[88:91], v[40:43], v[56:59], v[88:91]
v_fma_f32 v199, -v197, v252, v199
v_mul_f32 v27, v199, v198
v_mfma_f32_16x16x32_bf16 v[120:123], v[40:43], v[60:63], v[120:123]
v_mul_f32 v197, 0x41000000, v205
v_mul_f32 v198, 0x41000000, v207
s_waitcnt lgkmcnt(8)
v_mfma_f32_16x16x32_bf16 v[76:79], v[44:47], v[48:51], v[76:79]
v_exp_f32 v197, v197
v_rndne_f32 v199, v198
v_mfma_f32_16x16x32_bf16 v[108:111], v[44:47], v[52:55], v[108:111]
v_sub_f32 v198, v198, v199
v_cos_f32 v199, v198
v_mfma_f32_16x16x32_bf16 v[92:95], v[44:47], v[56:59], v[92:95]
v_sin_f32 v198, v198
v_mul_f32 v178, v197, v199
v_mfma_f32_16x16x32_bf16 v[124:127], v[44:47], v[60:63], v[124:127]
v_mul_f32 v179, v197, v198
v_mul_f32 v197, 0x41800000, v205
s_waitcnt lgkmcnt(0)
s_barrier
v_mfma_f32_16x16x32_bf16 v[64:67], v[144:147], v[160:163], v[64:67]
ds_read_b128 v[32:35], v132 offset:0
v_mfma_f32_16x16x32_bf16 v[96:99], v[144:147], v[164:167], v[96:99]
ds_read_b128 v[48:51], v134 offset:0
v_mfma_f32_16x16x32_bf16 v[80:83], v[144:147], v[168:171], v[80:83]
ds_read_b128 v[52:55], v134 offset:2048
v_mfma_f32_16x16x32_bf16 v[112:115], v[144:147], v[172:175], v[112:115]
ds_read_b128 v[56:59], v134 offset:4096
v_mfma_f32_16x16x32_bf16 v[68:71], v[148:151], v[160:163], v[68:71]
ds_read_b128 v[60:63], v134 offset:6144
v_mfma_f32_16x16x32_bf16 v[100:103], v[148:151], v[164:167], v[100:103]
ds_read_b128 v[36:39], v132 offset:2048
v_mfma_f32_16x16x32_bf16 v[84:87], v[148:151], v[168:171], v[84:87]
ds_read_b128 v[40:43], v132 offset:4096
v_mfma_f32_16x16x32_bf16 v[116:119], v[148:151], v[172:175], v[116:119]
ds_read_b128 v[44:47], v132 offset:6144
v_mfma_f32_16x16x32_bf16 v[72:75], v[152:155], v[160:163], v[72:75]
v_mul_f32 v198, 0x41800000, v207
v_exp_f32 v197, v197
v_mfma_f32_16x16x32_bf16 v[104:107], v[152:155], v[164:167], v[104:107]
v_rndne_f32 v199, v198
v_sub_f32 v198, v198, v199
v_mfma_f32_16x16x32_bf16 v[88:91], v[152:155], v[168:171], v[88:91]
v_cos_f32 v199, v198
v_sin_f32 v198, v198
v_mfma_f32_16x16x32_bf16 v[120:123], v[152:155], v[172:175], v[120:123]
v_mul_f32 v182, v197, v199
v_mul_f32 v183, v197, v198
v_mfma_f32_16x16x32_bf16 v[76:79], v[156:159], v[160:163], v[76:79]
v_mul_f32 v197, v9, v205
v_mul_f32 v198, v9, v207
v_mfma_f32_16x16x32_bf16 v[108:111], v[156:159], v[164:167], v[108:111]
v_exp_f32 v197, v197
v_rndne_f32 v199, v198
v_mfma_f32_16x16x32_bf16 v[92:95], v[156:159], v[168:171], v[92:95]
v_sub_f32 v198, v198, v199
v_cos_f32 v199, v198
v_mfma_f32_16x16x32_bf16 v[124:127], v[156:159], v[172:175], v[124:127]
v_sin_f32 v198, v198
v_mul_f32 v200, v197, v199
s_waitcnt lgkmcnt(6)
v_mfma_f32_16x16x32_bf16 v[64:67], v[32:35], v[48:51], v[64:67]
ds_read_b128 v[144:147], v133 offset:0
s_waitcnt lgkmcnt(6)
v_mfma_f32_16x16x32_bf16 v[96:99], v[32:35], v[52:55], v[96:99]
ds_read_b128 v[160:163], v135 offset:0
s_waitcnt lgkmcnt(6)
v_mfma_f32_16x16x32_bf16 v[80:83], v[32:35], v[56:59], v[80:83]
ds_read_b128 v[164:167], v135 offset:2048
s_waitcnt lgkmcnt(6)
v_mfma_f32_16x16x32_bf16 v[112:115], v[32:35], v[60:63], v[112:115]
ds_read_b128 v[168:171], v135 offset:4096
s_waitcnt lgkmcnt(6)
v_mfma_f32_16x16x32_bf16 v[68:71], v[36:39], v[48:51], v[68:71]
ds_read_b128 v[172:175], v135 offset:6144
v_mfma_f32_16x16x32_bf16 v[100:103], v[36:39], v[52:55], v[100:103]
ds_read_b128 v[148:151], v133 offset:2048
v_mfma_f32_16x16x32_bf16 v[84:87], v[36:39], v[56:59], v[84:87]
ds_read_b128 v[152:155], v133 offset:4096
v_mfma_f32_16x16x32_bf16 v[116:119], v[36:39], v[60:63], v[116:119]
ds_read_b128 v[156:159], v133 offset:6144
s_waitcnt lgkmcnt(9)
v_mfma_f32_16x16x32_bf16 v[72:75], v[40:43], v[48:51], v[72:75]
v_mul_f32 v201, v197, v198
v_mov_b32 v188, v200
v_mfma_f32_16x16x32_bf16 v[104:107], v[40:43], v[52:55], v[104:107]
v_mov_b32 v190, v201
v_mul_f32 v197, v8, v205
v_mfma_f32_16x16x32_bf16 v[88:91], v[40:43], v[56:59], v[88:91]
v_mul_f32 v198, v8, v207
v_exp_f32 v197, v197
v_mfma_f32_16x16x32_bf16 v[120:123], v[40:43], v[60:63], v[120:123]
v_rndne_f32 v199, v198
v_sub_f32 v198, v198, v199
s_waitcnt lgkmcnt(8)
v_mfma_f32_16x16x32_bf16 v[76:79], v[44:47], v[48:51], v[76:79]
v_cos_f32 v199, v198
v_sin_f32 v198, v198
v_mfma_f32_16x16x32_bf16 v[108:111], v[44:47], v[52:55], v[108:111]
v_mul_f32 v200, v197, v199
v_mul_f32 v201, v197, v198
v_mfma_f32_16x16x32_bf16 v[92:95], v[44:47], v[56:59], v[92:95]
v_mov_b32 v189, v200
v_mov_b32 v191, v201
v_mfma_f32_16x16x32_bf16 v[124:127], v[44:47], v[60:63], v[124:127]
v_mul_f32 v197, v27, v23
v_mul_f32 v198, v27, v22
s_waitcnt lgkmcnt(0)
s_barrier
v_mfma_f32_16x16x32_bf16 v[64:67], v[144:147], v[160:163], v[64:67]
ds_read_b128 v[32:35], v128 offset:0
v_mfma_f32_16x16x32_bf16 v[96:99], v[144:147], v[164:167], v[96:99]
ds_read_b128 v[48:51], v130 offset:0
v_mfma_f32_16x16x32_bf16 v[80:83], v[144:147], v[168:171], v[80:83]
ds_read_b128 v[52:55], v130 offset:2048
v_mfma_f32_16x16x32_bf16 v[112:115], v[144:147], v[172:175], v[112:115]
ds_read_b128 v[56:59], v130 offset:4096
v_mfma_f32_16x16x32_bf16 v[68:71], v[148:151], v[160:163], v[68:71]
ds_read_b128 v[60:63], v130 offset:6144
v_mfma_f32_16x16x32_bf16 v[100:103], v[148:151], v[164:167], v[100:103]
ds_read_b128 v[36:39], v128 offset:2048
v_mfma_f32_16x16x32_bf16 v[84:87], v[148:151], v[168:171], v[84:87]
ds_read_b128 v[40:43], v128 offset:4096
v_mfma_f32_16x16x32_bf16 v[116:119], v[148:151], v[172:175], v[116:119]
ds_read_b128 v[44:47], v128 offset:6144
v_mfma_f32_16x16x32_bf16 v[72:75], v[152:155], v[160:163], v[72:75]
v_fma_f32 v224, v26, v22, -v197
v_fma_f32 v225, v26, v23, v198
v_mfma_f32_16x16x32_bf16 v[104:107], v[152:155], v[164:167], v[104:107]
v_mul_f32 v197, v225, v23
v_mul_f32 v198, v225, v22
v_mfma_f32_16x16x32_bf16 v[88:91], v[152:155], v[168:171], v[88:91]
v_fma_f32 v226, v224, v22, -v197
v_fma_f32 v227, v224, v23, v198
v_mfma_f32_16x16x32_bf16 v[120:123], v[152:155], v[172:175], v[120:123]
v_mul_f32 v197, v227, v23
v_mul_f32 v198, v227, v22
v_mfma_f32_16x16x32_bf16 v[76:79], v[156:159], v[160:163], v[76:79]
v_fma_f32 v228, v226, v22, -v197
v_fma_f32 v229, v226, v23, v198
v_mfma_f32_16x16x32_bf16 v[108:111], v[156:159], v[164:167], v[108:111]
v_mul_f32 v197, v229, v23
v_mul_f32 v198, v229, v22
v_mfma_f32_16x16x32_bf16 v[92:95], v[156:159], v[168:171], v[92:95]
v_fma_f32 v230, v228, v22, -v197
v_fma_f32 v231, v228, v23, v198
v_mfma_f32_16x16x32_bf16 v[124:127], v[156:159], v[172:175], v[124:127]
v_mul_f32 v197, v231, v23
v_mul_f32 v198, v231, v22
s_waitcnt lgkmcnt(6)
v_mfma_f32_16x16x32_bf16 v[64:67], v[32:35], v[48:51], v[64:67]
ds_read_b128 v[144:147], v129 offset:0
s_waitcnt lgkmcnt(6)
v_mfma_f32_16x16x32_bf16 v[96:99], v[32:35], v[52:55], v[96:99]
ds_read_b128 v[160:163], v131 offset:0
s_waitcnt lgkmcnt(6)
v_mfma_f32_16x16x32_bf16 v[80:83], v[32:35], v[56:59], v[80:83]
ds_read_b128 v[164:167], v131 offset:2048
s_waitcnt lgkmcnt(6)
v_mfma_f32_16x16x32_bf16 v[112:115], v[32:35], v[60:63], v[112:115]
ds_read_b128 v[168:171], v131 offset:4096
s_waitcnt lgkmcnt(6)
v_mfma_f32_16x16x32_bf16 v[68:71], v[36:39], v[48:51], v[68:71]
ds_read_b128 v[172:175], v131 offset:6144
v_mfma_f32_16x16x32_bf16 v[100:103], v[36:39], v[52:55], v[100:103]
ds_read_b128 v[148:151], v129 offset:2048
v_mfma_f32_16x16x32_bf16 v[84:87], v[36:39], v[56:59], v[84:87]
ds_read_b128 v[152:155], v129 offset:4096
v_mfma_f32_16x16x32_bf16 v[116:119], v[36:39], v[60:63], v[116:119]
ds_read_b128 v[156:159], v129 offset:6144
s_waitcnt lgkmcnt(9)
v_mfma_f32_16x16x32_bf16 v[72:75], v[40:43], v[48:51], v[72:75]
v_fma_f32 v232, v230, v22, -v197
v_fma_f32 v233, v230, v23, v198
v_mfma_f32_16x16x32_bf16 v[104:107], v[40:43], v[52:55], v[104:107]
v_mul_f32 v197, v233, v23
v_mul_f32 v198, v233, v22
v_mfma_f32_16x16x32_bf16 v[88:91], v[40:43], v[56:59], v[88:91]
v_fma_f32 v234, v232, v22, -v197
v_fma_f32 v235, v232, v23, v198
v_mfma_f32_16x16x32_bf16 v[120:123], v[40:43], v[60:63], v[120:123]
v_mul_f32 v197, v235, v23
v_mul_f32 v198, v235, v22
s_waitcnt lgkmcnt(8)
v_mfma_f32_16x16x32_bf16 v[76:79], v[44:47], v[48:51], v[76:79]
v_fma_f32 v236, v234, v22, -v197
v_fma_f32 v237, v234, v23, v198
v_mfma_f32_16x16x32_bf16 v[108:111], v[44:47], v[52:55], v[108:111]
v_mul_f32 v197, v237, v23
v_mul_f32 v198, v237, v22
v_mfma_f32_16x16x32_bf16 v[92:95], v[44:47], v[56:59], v[92:95]
v_fma_f32 v238, v236, v22, -v197
v_fma_f32 v239, v236, v23, v198
v_mfma_f32_16x16x32_bf16 v[124:127], v[44:47], v[60:63], v[124:127]
v_and_b32 v197, 16, v1
v_cmp_ne_u32 vcc, 0, v197
s_waitcnt lgkmcnt(0)
s_barrier
v_mfma_f32_16x16x32_bf16 v[64:67], v[144:147], v[160:163], v[64:67]
ds_read_b128 v[32:35], v128 offset:32768
v_mfma_f32_16x16x32_bf16 v[96:99], v[144:147], v[164:167], v[96:99]
ds_read_b128 v[48:51], v130 offset:32768
v_mfma_f32_16x16x32_bf16 v[80:83], v[144:147], v[168:171], v[80:83]
ds_read_b128 v[52:55], v130 offset:34816
v_mfma_f32_16x16x32_bf16 v[112:115], v[144:147], v[172:175], v[112:115]
ds_read_b128 v[56:59], v130 offset:36864
v_mfma_f32_16x16x32_bf16 v[68:71], v[148:151], v[160:163], v[68:71]
ds_read_b128 v[60:63], v130 offset:38912
v_mfma_f32_16x16x32_bf16 v[100:103], v[148:151], v[164:167], v[100:103]
ds_read_b128 v[36:39], v128 offset:34816
v_mfma_f32_16x16x32_bf16 v[84:87], v[148:151], v[168:171], v[84:87]
ds_read_b128 v[40:43], v128 offset:36864
v_mfma_f32_16x16x32_bf16 v[116:119], v[148:151], v[172:175], v[116:119]
ds_read_b128 v[44:47], v128 offset:38912
v_mfma_f32_16x16x32_bf16 v[72:75], v[152:155], v[160:163], v[72:75]
v_cndmask_b32 v204, v204, v205, vcc
v_cndmask_b32 v206, v206, v207, vcc
v_mfma_f32_16x16x32_bf16 v[104:107], v[152:155], v[164:167], v[104:107]
v_mul_f32 v197, 0x41800000, v204
v_mul_f32 v198, 0x41800000, v206
v_mfma_f32_16x16x32_bf16 v[88:91], v[152:155], v[168:171], v[88:91]
v_exp_f32 v197, v197
v_rndne_f32 v199, v198
v_mfma_f32_16x16x32_bf16 v[120:123], v[152:155], v[172:175], v[120:123]
v_sub_f32 v198, v198, v199
v_cos_f32 v199, v198
v_mfma_f32_16x16x32_bf16 v[76:79], v[156:159], v[160:163], v[76:79]
v_sin_f32 v198, v198
v_mul_f32 v28, v197, v199
v_mfma_f32_16x16x32_bf16 v[108:111], v[156:159], v[164:167], v[108:111]
v_mul_f32 v29, v197, v198
v_mul_f32 v197, 0x42800000, v204
v_mfma_f32_16x16x32_bf16 v[92:95], v[156:159], v[168:171], v[92:95]
v_mul_f32 v198, 0x42800000, v206
v_exp_f32 v197, v197
v_mfma_f32_16x16x32_bf16 v[124:127], v[156:159], v[172:175], v[124:127]
v_rndne_f32 v199, v198
v_sub_f32 v198, v198, v199
s_waitcnt lgkmcnt(6)
v_mfma_f32_16x16x32_bf16 v[64:67], v[32:35], v[48:51], v[64:67]
ds_read_b128 v[144:147], v129 offset:32768
s_waitcnt lgkmcnt(6)
v_mfma_f32_16x16x32_bf16 v[96:99], v[32:35], v[52:55], v[96:99]
ds_read_b128 v[160:163], v131 offset:32768
s_waitcnt lgkmcnt(6)
v_mfma_f32_16x16x32_bf16 v[80:83], v[32:35], v[56:59], v[80:83]
ds_read_b128 v[164:167], v131 offset:34816
s_waitcnt lgkmcnt(6)
v_mfma_f32_16x16x32_bf16 v[112:115], v[32:35], v[60:63], v[112:115]
ds_read_b128 v[168:171], v131 offset:36864
s_waitcnt lgkmcnt(6)
v_mfma_f32_16x16x32_bf16 v[68:71], v[36:39], v[48:51], v[68:71]
ds_read_b128 v[172:175], v131 offset:38912
v_mfma_f32_16x16x32_bf16 v[100:103], v[36:39], v[52:55], v[100:103]
ds_read_b128 v[148:151], v129 offset:34816
v_mfma_f32_16x16x32_bf16 v[84:87], v[36:39], v[56:59], v[84:87]
ds_read_b128 v[152:155], v129 offset:36864
v_mfma_f32_16x16x32_bf16 v[116:119], v[36:39], v[60:63], v[116:119]
ds_read_b128 v[156:159], v129 offset:38912
s_waitcnt lgkmcnt(9)
v_mfma_f32_16x16x32_bf16 v[72:75], v[40:43], v[48:51], v[72:75]
v_cos_f32 v199, v198
v_sin_f32 v198, v198
v_mfma_f32_16x16x32_bf16 v[104:107], v[40:43], v[52:55], v[104:107]
v_mul_f32 v192, v197, v199
v_mul_f32 v193, v197, v198
v_mfma_f32_16x16x32_bf16 v[88:91], v[40:43], v[56:59], v[88:91]
v_mul_f32 v197, 0x43000000, v204
v_mul_f32 v198, 0x43000000, v206
v_mfma_f32_16x16x32_bf16 v[120:123], v[40:43], v[60:63], v[120:123]
v_exp_f32 v197, v197
v_rndne_f32 v199, v198
s_waitcnt lgkmcnt(8)
v_mfma_f32_16x16x32_bf16 v[76:79], v[44:47], v[48:51], v[76:79]
v_sub_f32 v198, v198, v199
v_cos_f32 v199, v198
v_mfma_f32_16x16x32_bf16 v[108:111], v[44:47], v[52:55], v[108:111]
v_sin_f32 v198, v198
v_mul_f32 v30, v197, v199
v_mfma_f32_16x16x32_bf16 v[92:95], v[44:47], v[56:59], v[92:95]
v_mul_f32 v31, v197, v198
v_mul_f32 v197, 0x43800000, v204
v_mfma_f32_16x16x32_bf16 v[124:127], v[44:47], v[60:63], v[124:127]
v_mul_f32 v198, 0x43800000, v206
v_exp_f32 v197, v197
s_waitcnt lgkmcnt(0)
s_barrier
v_mfma_f32_16x16x32_bf16 v[64:67], v[144:147], v[160:163], v[64:67]
ds_read_b128 v[32:35], v132 offset:0
v_mfma_f32_16x16x32_bf16 v[96:99], v[144:147], v[164:167], v[96:99]
ds_read_b128 v[48:51], v134 offset:0
v_mfma_f32_16x16x32_bf16 v[80:83], v[144:147], v[168:171], v[80:83]
ds_read_b128 v[52:55], v134 offset:2048
v_mfma_f32_16x16x32_bf16 v[112:115], v[144:147], v[172:175], v[112:115]
ds_read_b128 v[56:59], v134 offset:4096
v_mfma_f32_16x16x32_bf16 v[68:71], v[148:151], v[160:163], v[68:71]
ds_read_b128 v[60:63], v134 offset:6144
v_mfma_f32_16x16x32_bf16 v[100:103], v[148:151], v[164:167], v[100:103]
ds_read_b128 v[36:39], v132 offset:2048
v_mfma_f32_16x16x32_bf16 v[84:87], v[148:151], v[168:171], v[84:87]
ds_read_b128 v[40:43], v132 offset:4096
v_mfma_f32_16x16x32_bf16 v[116:119], v[148:151], v[172:175], v[116:119]
ds_read_b128 v[44:47], v132 offset:6144
v_mfma_f32_16x16x32_bf16 v[72:75], v[152:155], v[160:163], v[72:75]
v_rndne_f32 v199, v198
v_sub_f32 v198, v198, v199
v_mfma_f32_16x16x32_bf16 v[104:107], v[152:155], v[164:167], v[104:107]
v_cos_f32 v199, v198
v_sin_f32 v198, v198
v_mfma_f32_16x16x32_bf16 v[88:91], v[152:155], v[168:171], v[88:91]
v_mul_f32 v2, v197, v199
v_mul_f32 v3, v197, v198
v_mfma_f32_16x16x32_bf16 v[120:123], v[152:155], v[172:175], v[120:123]
v_lshrrev_b32 v197, 4, v1
v_lshlrev_b32 v197, 2, v197
v_mfma_f32_16x16x32_bf16 v[76:79], v[156:159], v[160:163], v[76:79]
v_and_b32 v198, 15, v1
v_sub_u32 v197, v198, v197
v_mfma_f32_16x16x32_bf16 v[108:111], v[156:159], v[164:167], v[108:111]
v_mov_b32 v198, 0x3f80
v_mov_b32 v199, 1.0
v_mfma_f32_16x16x32_bf16 v[92:95], v[156:159], v[168:171], v[92:95]
v_cmp_eq_u32 vcc, 0, v197
s_nop 1
v_cndmask_b32 v248, 0, v198, vcc
v_mfma_f32_16x16x32_bf16 v[124:127], v[156:159], v[172:175], v[124:127]
v_cndmask_b32 v252, 0, v199, vcc
v_cmp_eq_u32 vcc, 1, v197
s_waitcnt lgkmcnt(6)
v_mfma_f32_16x16x32_bf16 v[64:67], v[32:35], v[48:51], v[64:67]
ds_read_b128 v[144:147], v133 offset:0
s_waitcnt lgkmcnt(6)
v_mfma_f32_16x16x32_bf16 v[96:99], v[32:35], v[52:55], v[96:99]
ds_read_b128 v[160:163], v135 offset:0
s_waitcnt lgkmcnt(6)
v_mfma_f32_16x16x32_bf16 v[80:83], v[32:35], v[56:59], v[80:83]
ds_read_b128 v[164:167], v135 offset:2048
s_waitcnt lgkmcnt(6)
v_mfma_f32_16x16x32_bf16 v[112:115], v[32:35], v[60:63], v[112:115]
ds_read_b128 v[168:171], v135 offset:4096
s_waitcnt lgkmcnt(6)
v_mfma_f32_16x16x32_bf16 v[68:71], v[36:39], v[48:51], v[68:71]
ds_read_b128 v[172:175], v135 offset:6144
v_mfma_f32_16x16x32_bf16 v[100:103], v[36:39], v[52:55], v[100:103]
ds_read_b128 v[148:151], v133 offset:2048
v_mfma_f32_16x16x32_bf16 v[84:87], v[36:39], v[56:59], v[84:87]
ds_read_b128 v[152:155], v133 offset:4096
v_mfma_f32_16x16x32_bf16 v[116:119], v[36:39], v[60:63], v[116:119]
ds_read_b128 v[156:159], v133 offset:6144
s_waitcnt lgkmcnt(9)
v_mfma_f32_16x16x32_bf16 v[72:75], v[40:43], v[48:51], v[72:75]
v_cndmask_b32 v249, 0, v198, vcc
v_cndmask_b32 v253, 0, v199, vcc
v_mfma_f32_16x16x32_bf16 v[104:107], v[40:43], v[52:55], v[104:107]
v_cmp_eq_u32 vcc, 2, v197
s_nop 1
v_cndmask_b32 v250, 0, v198, vcc
v_mfma_f32_16x16x32_bf16 v[88:91], v[40:43], v[56:59], v[88:91]
v_cndmask_b32 v254, 0, v199, vcc
v_cmp_eq_u32 vcc, 3, v197
v_mfma_f32_16x16x32_bf16 v[120:123], v[40:43], v[60:63], v[120:123]
s_nop 0
v_cndmask_b32 v251, 0, v198, vcc
v_cndmask_b32 v255, 0, v199, vcc
s_waitcnt lgkmcnt(8)
v_mfma_f32_16x16x32_bf16 v[76:79], v[44:47], v[48:51], v[76:79]
v_mfma_f32_16x16x32_bf16 v[108:111], v[44:47], v[52:55], v[108:111]
v_mfma_f32_16x16x32_bf16 v[92:95], v[44:47], v[56:59], v[92:95]
v_mfma_f32_16x16x32_bf16 v[124:127], v[44:47], v[60:63], v[124:127]
s_waitcnt lgkmcnt(0)
s_barrier
v_mfma_f32_16x16x32_bf16 v[64:67], v[144:147], v[160:163], v[64:67]
ds_read_b128 v[32:35], v128 offset:0
v_mfma_f32_16x16x32_bf16 v[96:99], v[144:147], v[164:167], v[96:99]
ds_read_b128 v[48:51], v130 offset:0
v_mfma_f32_16x16x32_bf16 v[80:83], v[144:147], v[168:171], v[80:83]
ds_read_b128 v[52:55], v130 offset:2048
v_mfma_f32_16x16x32_bf16 v[112:115], v[144:147], v[172:175], v[112:115]
ds_read_b128 v[56:59], v130 offset:4096
v_mfma_f32_16x16x32_bf16 v[68:71], v[148:151], v[160:163], v[68:71]
ds_read_b128 v[60:63], v130 offset:6144
v_mfma_f32_16x16x32_bf16 v[100:103], v[148:151], v[164:167], v[100:103]
ds_read_b128 v[36:39], v128 offset:2048
v_mfma_f32_16x16x32_bf16 v[84:87], v[148:151], v[168:171], v[84:87]
ds_read_b128 v[40:43], v128 offset:4096
v_mfma_f32_16x16x32_bf16 v[116:119], v[148:151], v[172:175], v[116:119]
ds_read_b128 v[44:47], v128 offset:6144
v_mfma_f32_16x16x32_bf16 v[72:75], v[152:155], v[160:163], v[72:75]
v_mfma_f32_16x16x32_bf16 v[104:107], v[152:155], v[164:167], v[104:107]
v_mfma_f32_16x16x32_bf16 v[88:91], v[152:155], v[168:171], v[88:91]
v_mfma_f32_16x16x32_bf16 v[120:123], v[152:155], v[172:175], v[120:123]
v_mfma_f32_16x16x32_bf16 v[76:79], v[156:159], v[160:163], v[76:79]
v_mfma_f32_16x16x32_bf16 v[108:111], v[156:159], v[164:167], v[108:111]
v_mfma_f32_16x16x32_bf16 v[92:95], v[156:159], v[168:171], v[92:95]
v_mfma_f32_16x16x32_bf16 v[124:127], v[156:159], v[172:175], v[124:127]
s_waitcnt lgkmcnt(6)
v_mfma_f32_16x16x32_bf16 v[64:67], v[32:35], v[48:51], v[64:67]
ds_read_b128 v[144:147], v129 offset:0
s_waitcnt lgkmcnt(6)
v_mfma_f32_16x16x32_bf16 v[96:99], v[32:35], v[52:55], v[96:99]
ds_read_b128 v[160:163], v131 offset:0
s_waitcnt lgkmcnt(6)
v_mfma_f32_16x16x32_bf16 v[80:83], v[32:35], v[56:59], v[80:83]
ds_read_b128 v[164:167], v131 offset:2048
s_waitcnt lgkmcnt(6)
v_mfma_f32_16x16x32_bf16 v[112:115], v[32:35], v[60:63], v[112:115]
ds_read_b128 v[168:171], v131 offset:4096
s_waitcnt lgkmcnt(6)
v_mfma_f32_16x16x32_bf16 v[68:71], v[36:39], v[48:51], v[68:71]
ds_read_b128 v[172:175], v131 offset:6144
v_mfma_f32_16x16x32_bf16 v[100:103], v[36:39], v[52:55], v[100:103]
ds_read_b128 v[148:151], v129 offset:2048
v_mfma_f32_16x16x32_bf16 v[84:87], v[36:39], v[56:59], v[84:87]
ds_read_b128 v[152:155], v129 offset:4096
v_mfma_f32_16x16x32_bf16 v[116:119], v[36:39], v[60:63], v[116:119]
ds_read_b128 v[156:159], v129 offset:6144
s_waitcnt lgkmcnt(9)
v_mfma_f32_16x16x32_bf16 v[72:75], v[40:43], v[48:51], v[72:75]
v_mfma_f32_16x16x32_bf16 v[104:107], v[40:43], v[52:55], v[104:107]
v_mfma_f32_16x16x32_bf16 v[88:91], v[40:43], v[56:59], v[88:91]
v_mfma_f32_16x16x32_bf16 v[120:123], v[40:43], v[60:63], v[120:123]
s_waitcnt lgkmcnt(8)
v_mfma_f32_16x16x32_bf16 v[76:79], v[44:47], v[48:51], v[76:79]
v_mfma_f32_16x16x32_bf16 v[108:111], v[44:47], v[52:55], v[108:111]
v_mfma_f32_16x16x32_bf16 v[92:95], v[44:47], v[56:59], v[92:95]
v_mfma_f32_16x16x32_bf16 v[124:127], v[44:47], v[60:63], v[124:127]
s_waitcnt lgkmcnt(0)
s_barrier
v_mfma_f32_16x16x32_bf16 v[64:67], v[144:147], v[160:163], v[64:67]
ds_read_b128 v[32:35], v128 offset:32768
v_mfma_f32_16x16x32_bf16 v[96:99], v[144:147], v[164:167], v[96:99]
ds_read_b128 v[48:51], v130 offset:32768
v_mfma_f32_16x16x32_bf16 v[80:83], v[144:147], v[168:171], v[80:83]
ds_read_b128 v[52:55], v130 offset:34816
v_mfma_f32_16x16x32_bf16 v[112:115], v[144:147], v[172:175], v[112:115]
ds_read_b128 v[56:59], v130 offset:36864
v_mfma_f32_16x16x32_bf16 v[68:71], v[148:151], v[160:163], v[68:71]
ds_read_b128 v[60:63], v130 offset:38912
v_mfma_f32_16x16x32_bf16 v[100:103], v[148:151], v[164:167], v[100:103]
ds_read_b128 v[36:39], v128 offset:34816
v_mfma_f32_16x16x32_bf16 v[84:87], v[148:151], v[168:171], v[84:87]
ds_read_b128 v[40:43], v128 offset:36864
v_mfma_f32_16x16x32_bf16 v[116:119], v[148:151], v[172:175], v[116:119]
ds_read_b128 v[44:47], v128 offset:38912
v_mfma_f32_16x16x32_bf16 v[72:75], v[152:155], v[160:163], v[72:75]
v_mfma_f32_16x16x32_bf16 v[104:107], v[152:155], v[164:167], v[104:107]
v_mfma_f32_16x16x32_bf16 v[88:91], v[152:155], v[168:171], v[88:91]
v_mfma_f32_16x16x32_bf16 v[120:123], v[152:155], v[172:175], v[120:123]
v_mfma_f32_16x16x32_bf16 v[76:79], v[156:159], v[160:163], v[76:79]
v_mfma_f32_16x16x32_bf16 v[108:111], v[156:159], v[164:167], v[108:111]
v_mfma_f32_16x16x32_bf16 v[92:95], v[156:159], v[168:171], v[92:95]
v_mfma_f32_16x16x32_bf16 v[124:127], v[156:159], v[172:175], v[124:127]
s_waitcnt lgkmcnt(6)
v_mfma_f32_16x16x32_bf16 v[64:67], v[32:35], v[48:51], v[64:67]
ds_read_b128 v[144:147], v129 offset:32768
s_waitcnt lgkmcnt(6)
v_mfma_f32_16x16x32_bf16 v[96:99], v[32:35], v[52:55], v[96:99]
ds_read_b128 v[160:163], v131 offset:32768
s_waitcnt lgkmcnt(6)
v_mfma_f32_16x16x32_bf16 v[80:83], v[32:35], v[56:59], v[80:83]
ds_read_b128 v[164:167], v131 offset:34816
s_waitcnt lgkmcnt(6)
v_mfma_f32_16x16x32_bf16 v[112:115], v[32:35], v[60:63], v[112:115]
ds_read_b128 v[168:171], v131 offset:36864
s_waitcnt lgkmcnt(6)
v_mfma_f32_16x16x32_bf16 v[68:71], v[36:39], v[48:51], v[68:71]
ds_read_b128 v[172:175], v131 offset:38912
v_mfma_f32_16x16x32_bf16 v[100:103], v[36:39], v[52:55], v[100:103]
ds_read_b128 v[148:151], v129 offset:34816
v_mfma_f32_16x16x32_bf16 v[84:87], v[36:39], v[56:59], v[84:87]
ds_read_b128 v[152:155], v129 offset:36864
v_mfma_f32_16x16x32_bf16 v[116:119], v[36:39], v[60:63], v[116:119]
ds_read_b128 v[156:159], v129 offset:38912
s_waitcnt lgkmcnt(9)
v_mfma_f32_16x16x32_bf16 v[72:75], v[40:43], v[48:51], v[72:75]
v_mfma_f32_16x16x32_bf16 v[104:107], v[40:43], v[52:55], v[104:107]
v_mfma_f32_16x16x32_bf16 v[88:91], v[40:43], v[56:59], v[88:91]
v_mfma_f32_16x16x32_bf16 v[120:123], v[40:43], v[60:63], v[120:123]
s_waitcnt lgkmcnt(8)
v_mfma_f32_16x16x32_bf16 v[76:79], v[44:47], v[48:51], v[76:79]
v_mfma_f32_16x16x32_bf16 v[108:111], v[44:47], v[52:55], v[108:111]
v_mfma_f32_16x16x32_bf16 v[92:95], v[44:47], v[56:59], v[92:95]
v_mfma_f32_16x16x32_bf16 v[124:127], v[44:47], v[60:63], v[124:127]
s_waitcnt lgkmcnt(0)
s_barrier
v_mfma_f32_16x16x32_bf16 v[64:67], v[144:147], v[160:163], v[64:67]
ds_read_b128 v[32:35], v132 offset:0
v_mfma_f32_16x16x32_bf16 v[96:99], v[144:147], v[164:167], v[96:99]
ds_read_b128 v[48:51], v134 offset:0
v_mfma_f32_16x16x32_bf16 v[80:83], v[144:147], v[168:171], v[80:83]
ds_read_b128 v[52:55], v134 offset:2048
v_mfma_f32_16x16x32_bf16 v[112:115], v[144:147], v[172:175], v[112:115]
ds_read_b128 v[56:59], v134 offset:4096
v_mfma_f32_16x16x32_bf16 v[68:71], v[148:151], v[160:163], v[68:71]
ds_read_b128 v[60:63], v134 offset:6144
v_mfma_f32_16x16x32_bf16 v[100:103], v[148:151], v[164:167], v[100:103]
ds_read_b128 v[36:39], v132 offset:2048
v_mfma_f32_16x16x32_bf16 v[84:87], v[148:151], v[168:171], v[84:87]
ds_read_b128 v[40:43], v132 offset:4096
v_mfma_f32_16x16x32_bf16 v[116:119], v[148:151], v[172:175], v[116:119]
ds_read_b128 v[44:47], v132 offset:6144
v_mfma_f32_16x16x32_bf16 v[72:75], v[152:155], v[160:163], v[72:75]
v_mfma_f32_16x16x32_bf16 v[104:107], v[152:155], v[164:167], v[104:107]
v_mfma_f32_16x16x32_bf16 v[88:91], v[152:155], v[168:171], v[88:91]
v_mfma_f32_16x16x32_bf16 v[120:123], v[152:155], v[172:175], v[120:123]
v_mfma_f32_16x16x32_bf16 v[76:79], v[156:159], v[160:163], v[76:79]
v_mfma_f32_16x16x32_bf16 v[108:111], v[156:159], v[164:167], v[108:111]
v_mfma_f32_16x16x32_bf16 v[92:95], v[156:159], v[168:171], v[92:95]
v_mfma_f32_16x16x32_bf16 v[124:127], v[156:159], v[172:175], v[124:127]
s_waitcnt lgkmcnt(6)
v_mfma_f32_16x16x32_bf16 v[64:67], v[32:35], v[48:51], v[64:67]
ds_read_b128 v[144:147], v133 offset:0
s_waitcnt lgkmcnt(6)
v_mfma_f32_16x16x32_bf16 v[96:99], v[32:35], v[52:55], v[96:99]
ds_read_b128 v[160:163], v135 offset:0
s_waitcnt lgkmcnt(6)
v_mfma_f32_16x16x32_bf16 v[80:83], v[32:35], v[56:59], v[80:83]
ds_read_b128 v[164:167], v135 offset:2048
s_waitcnt lgkmcnt(6)
v_mfma_f32_16x16x32_bf16 v[112:115], v[32:35], v[60:63], v[112:115]
ds_read_b128 v[168:171], v135 offset:4096
s_waitcnt lgkmcnt(6)
v_mfma_f32_16x16x32_bf16 v[68:71], v[36:39], v[48:51], v[68:71]
ds_read_b128 v[172:175], v135 offset:6144
v_mfma_f32_16x16x32_bf16 v[100:103], v[36:39], v[52:55], v[100:103]
ds_read_b128 v[148:151], v133 offset:2048
v_mfma_f32_16x16x32_bf16 v[84:87], v[36:39], v[56:59], v[84:87]
ds_read_b128 v[152:155], v133 offset:4096
v_mfma_f32_16x16x32_bf16 v[116:119], v[36:39], v[60:63], v[116:119]
ds_read_b128 v[156:159], v133 offset:6144
s_waitcnt lgkmcnt(9)
v_mfma_f32_16x16x32_bf16 v[72:75], v[40:43], v[48:51], v[72:75]
v_mfma_f32_16x16x32_bf16 v[104:107], v[40:43], v[52:55], v[104:107]
v_mfma_f32_16x16x32_bf16 v[88:91], v[40:43], v[56:59], v[88:91]
v_mfma_f32_16x16x32_bf16 v[120:123], v[40:43], v[60:63], v[120:123]
s_waitcnt lgkmcnt(8)
v_mfma_f32_16x16x32_bf16 v[76:79], v[44:47], v[48:51], v[76:79]
v_mfma_f32_16x16x32_bf16 v[108:111], v[44:47], v[52:55], v[108:111]
v_mfma_f32_16x16x32_bf16 v[92:95], v[44:47], v[56:59], v[92:95]
v_mfma_f32_16x16x32_bf16 v[124:127], v[44:47], v[60:63], v[124:127]
s_waitcnt lgkmcnt(0)
s_barrier
v_mfma_f32_16x16x32_bf16 v[64:67], v[144:147], v[160:163], v[64:67]
ds_read_b128 v[32:35], v128 offset:0
v_mfma_f32_16x16x32_bf16 v[96:99], v[144:147], v[164:167], v[96:99]
ds_read_b128 v[48:51], v130 offset:0
v_mfma_f32_16x16x32_bf16 v[80:83], v[144:147], v[168:171], v[80:83]
ds_read_b128 v[52:55], v130 offset:2048
v_mfma_f32_16x16x32_bf16 v[112:115], v[144:147], v[172:175], v[112:115]
ds_read_b128 v[56:59], v130 offset:4096
v_mfma_f32_16x16x32_bf16 v[68:71], v[148:151], v[160:163], v[68:71]
ds_read_b128 v[60:63], v130 offset:6144
v_mfma_f32_16x16x32_bf16 v[100:103], v[148:151], v[164:167], v[100:103]
ds_read_b128 v[36:39], v128 offset:2048
v_mfma_f32_16x16x32_bf16 v[84:87], v[148:151], v[168:171], v[84:87]
ds_read_b128 v[40:43], v128 offset:4096
v_mfma_f32_16x16x32_bf16 v[116:119], v[148:151], v[172:175], v[116:119]
ds_read_b128 v[44:47], v128 offset:6144
v_mfma_f32_16x16x32_bf16 v[72:75], v[152:155], v[160:163], v[72:75]
v_mfma_f32_16x16x32_bf16 v[104:107], v[152:155], v[164:167], v[104:107]
v_mfma_f32_16x16x32_bf16 v[88:91], v[152:155], v[168:171], v[88:91]
v_mfma_f32_16x16x32_bf16 v[120:123], v[152:155], v[172:175], v[120:123]
v_mfma_f32_16x16x32_bf16 v[76:79], v[156:159], v[160:163], v[76:79]
v_mfma_f32_16x16x32_bf16 v[108:111], v[156:159], v[164:167], v[108:111]
v_mfma_f32_16x16x32_bf16 v[92:95], v[156:159], v[168:171], v[92:95]
v_mfma_f32_16x16x32_bf16 v[124:127], v[156:159], v[172:175], v[124:127]
s_waitcnt lgkmcnt(6)
v_mfma_f32_16x16x32_bf16 v[64:67], v[32:35], v[48:51], v[64:67]
ds_read_b128 v[144:147], v129 offset:0
s_waitcnt lgkmcnt(6)
v_mfma_f32_16x16x32_bf16 v[96:99], v[32:35], v[52:55], v[96:99]
ds_read_b128 v[160:163], v131 offset:0
s_waitcnt lgkmcnt(6)
v_mfma_f32_16x16x32_bf16 v[80:83], v[32:35], v[56:59], v[80:83]
ds_read_b128 v[164:167], v131 offset:2048
s_waitcnt lgkmcnt(6)
v_mfma_f32_16x16x32_bf16 v[112:115], v[32:35], v[60:63], v[112:115]
ds_read_b128 v[168:171], v131 offset:4096
s_waitcnt lgkmcnt(6)
v_mfma_f32_16x16x32_bf16 v[68:71], v[36:39], v[48:51], v[68:71]
ds_read_b128 v[172:175], v131 offset:6144
v_mfma_f32_16x16x32_bf16 v[100:103], v[36:39], v[52:55], v[100:103]
ds_read_b128 v[148:151], v129 offset:2048
v_mfma_f32_16x16x32_bf16 v[84:87], v[36:39], v[56:59], v[84:87]
ds_read_b128 v[152:155], v129 offset:4096
v_mfma_f32_16x16x32_bf16 v[116:119], v[36:39], v[60:63], v[116:119]
ds_read_b128 v[156:159], v129 offset:6144
s_waitcnt lgkmcnt(9)
v_mfma_f32_16x16x32_bf16 v[72:75], v[40:43], v[48:51], v[72:75]
v_mfma_f32_16x16x32_bf16 v[104:107], v[40:43], v[52:55], v[104:107]
v_mfma_f32_16x16x32_bf16 v[88:91], v[40:43], v[56:59], v[88:91]
v_mfma_f32_16x16x32_bf16 v[120:123], v[40:43], v[60:63], v[120:123]
s_waitcnt lgkmcnt(8)
v_mfma_f32_16x16x32_bf16 v[76:79], v[44:47], v[48:51], v[76:79]
v_mfma_f32_16x16x32_bf16 v[108:111], v[44:47], v[52:55], v[108:111]
v_mfma_f32_16x16x32_bf16 v[92:95], v[44:47], v[56:59], v[92:95]
v_mfma_f32_16x16x32_bf16 v[124:127], v[44:47], v[60:63], v[124:127]
s_waitcnt lgkmcnt(0)
s_barrier
v_mfma_f32_16x16x32_bf16 v[64:67], v[144:147], v[160:163], v[64:67]
ds_read_b128 v[32:35], v128 offset:32768
v_mfma_f32_16x16x32_bf16 v[96:99], v[144:147], v[164:167], v[96:99]
ds_read_b128 v[48:51], v130 offset:32768
v_mfma_f32_16x16x32_bf16 v[80:83], v[144:147], v[168:171], v[80:83]
ds_read_b128 v[52:55], v130 offset:34816
v_mfma_f32_16x16x32_bf16 v[112:115], v[144:147], v[172:175], v[112:115]
ds_read_b128 v[56:59], v130 offset:36864
v_mfma_f32_16x16x32_bf16 v[68:71], v[148:151], v[160:163], v[68:71]
ds_read_b128 v[60:63], v130 offset:38912
v_mfma_f32_16x16x32_bf16 v[100:103], v[148:151], v[164:167], v[100:103]
ds_read_b128 v[36:39], v128 offset:34816
v_mfma_f32_16x16x32_bf16 v[84:87], v[148:151], v[168:171], v[84:87]
ds_read_b128 v[40:43], v128 offset:36864
v_mfma_f32_16x16x32_bf16 v[116:119], v[148:151], v[172:175], v[116:119]
ds_read_b128 v[44:47], v128 offset:38912
v_mfma_f32_16x16x32_bf16 v[72:75], v[152:155], v[160:163], v[72:75]
v_mfma_f32_16x16x32_bf16 v[104:107], v[152:155], v[164:167], v[104:107]
v_mfma_f32_16x16x32_bf16 v[88:91], v[152:155], v[168:171], v[88:91]
v_mfma_f32_16x16x32_bf16 v[120:123], v[152:155], v[172:175], v[120:123]
v_mfma_f32_16x16x32_bf16 v[76:79], v[156:159], v[160:163], v[76:79]
v_mfma_f32_16x16x32_bf16 v[108:111], v[156:159], v[164:167], v[108:111]
v_mfma_f32_16x16x32_bf16 v[92:95], v[156:159], v[168:171], v[92:95]
v_mfma_f32_16x16x32_bf16 v[124:127], v[156:159], v[172:175], v[124:127]
v_mov_b32 v8, 0
global_load_dword v9, v8, s[30:31] sc1
s_waitcnt lgkmcnt(6)
v_mfma_f32_16x16x32_bf16 v[64:67], v[32:35], v[48:51], v[64:67]
ds_read_b128 v[144:147], v129 offset:32768
s_waitcnt lgkmcnt(6)
v_mfma_f32_16x16x32_bf16 v[96:99], v[32:35], v[52:55], v[96:99]
ds_read_b128 v[160:163], v131 offset:32768
s_waitcnt lgkmcnt(6)
v_mfma_f32_16x16x32_bf16 v[80:83], v[32:35], v[56:59], v[80:83]
ds_read_b128 v[164:167], v131 offset:34816
s_waitcnt lgkmcnt(6)
v_mfma_f32_16x16x32_bf16 v[112:115], v[32:35], v[60:63], v[112:115]
ds_read_b128 v[168:171], v131 offset:36864
s_waitcnt lgkmcnt(6)
v_mfma_f32_16x16x32_bf16 v[68:71], v[36:39], v[48:51], v[68:71]
ds_read_b128 v[172:175], v131 offset:38912
v_mfma_f32_16x16x32_bf16 v[100:103], v[36:39], v[52:55], v[100:103]
ds_read_b128 v[148:151], v129 offset:34816
v_mfma_f32_16x16x32_bf16 v[84:87], v[36:39], v[56:59], v[84:87]
ds_read_b128 v[152:155], v129 offset:36864
v_mfma_f32_16x16x32_bf16 v[116:119], v[36:39], v[60:63], v[116:119]
ds_read_b128 v[156:159], v129 offset:38912
s_waitcnt lgkmcnt(9)
v_mfma_f32_16x16x32_bf16 v[72:75], v[40:43], v[48:51], v[72:75]
v_mfma_f32_16x16x32_bf16 v[104:107], v[40:43], v[52:55], v[104:107]
v_mfma_f32_16x16x32_bf16 v[88:91], v[40:43], v[56:59], v[88:91]
v_mfma_f32_16x16x32_bf16 v[120:123], v[40:43], v[60:63], v[120:123]
s_waitcnt lgkmcnt(8)
v_mfma_f32_16x16x32_bf16 v[76:79], v[44:47], v[48:51], v[76:79]
v_mfma_f32_16x16x32_bf16 v[108:111], v[44:47], v[52:55], v[108:111]
v_mfma_f32_16x16x32_bf16 v[92:95], v[44:47], v[56:59], v[92:95]
v_mfma_f32_16x16x32_bf16 v[124:127], v[44:47], v[60:63], v[124:127]
s_waitcnt lgkmcnt(0)
s_barrier
v_mfma_f32_16x16x32_bf16 v[64:67], v[144:147], v[160:163], v[64:67]
ds_read_b128 v[32:35], v132 offset:0
v_mfma_f32_16x16x32_bf16 v[96:99], v[144:147], v[164:167], v[96:99]
ds_read_b128 v[48:51], v134 offset:0
v_mfma_f32_16x16x32_bf16 v[80:83], v[144:147], v[168:171], v[80:83]
ds_read_b128 v[52:55], v134 offset:2048
v_mfma_f32_16x16x32_bf16 v[112:115], v[144:147], v[172:175], v[112:115]
ds_read_b128 v[56:59], v134 offset:4096
v_mfma_f32_16x16x32_bf16 v[68:71], v[148:151], v[160:163], v[68:71]
ds_read_b128 v[60:63], v134 offset:6144
v_mfma_f32_16x16x32_bf16 v[100:103], v[148:151], v[164:167], v[100:103]
ds_read_b128 v[36:39], v132 offset:2048
v_mfma_f32_16x16x32_bf16 v[84:87], v[148:151], v[168:171], v[84:87]
ds_read_b128 v[40:43], v132 offset:4096
v_mfma_f32_16x16x32_bf16 v[116:119], v[148:151], v[172:175], v[116:119]
ds_read_b128 v[44:47], v132 offset:6144
v_mfma_f32_16x16x32_bf16 v[72:75], v[152:155], v[160:163], v[72:75]
v_mfma_f32_16x16x32_bf16 v[104:107], v[152:155], v[164:167], v[104:107]
v_mfma_f32_16x16x32_bf16 v[88:91], v[152:155], v[168:171], v[88:91]
v_mfma_f32_16x16x32_bf16 v[120:123], v[152:155], v[172:175], v[120:123]
v_mfma_f32_16x16x32_bf16 v[76:79], v[156:159], v[160:163], v[76:79]
v_mfma_f32_16x16x32_bf16 v[108:111], v[156:159], v[164:167], v[108:111]
v_mfma_f32_16x16x32_bf16 v[92:95], v[156:159], v[168:171], v[92:95]
v_mfma_f32_16x16x32_bf16 v[124:127], v[156:159], v[172:175], v[124:127]
s_waitcnt lgkmcnt(6)
v_mfma_f32_16x16x32_bf16 v[64:67], v[32:35], v[48:51], v[64:67]
ds_read_b128 v[144:147], v133 offset:0
s_waitcnt lgkmcnt(6)
v_mfma_f32_16x16x32_bf16 v[96:99], v[32:35], v[52:55], v[96:99]
ds_read_b128 v[160:163], v135 offset:0
s_waitcnt lgkmcnt(6)
v_mfma_f32_16x16x32_bf16 v[80:83], v[32:35], v[56:59], v[80:83]
ds_read_b128 v[164:167], v135 offset:2048
s_waitcnt lgkmcnt(6)
v_mfma_f32_16x16x32_bf16 v[112:115], v[32:35], v[60:63], v[112:115]
ds_read_b128 v[168:171], v135 offset:4096
s_waitcnt lgkmcnt(6)
v_mfma_f32_16x16x32_bf16 v[68:71], v[36:39], v[48:51], v[68:71]
ds_read_b128 v[172:175], v135 offset:6144
v_mfma_f32_16x16x32_bf16 v[100:103], v[36:39], v[52:55], v[100:103]
ds_read_b128 v[148:151], v133 offset:2048
v_mfma_f32_16x16x32_bf16 v[84:87], v[36:39], v[56:59], v[84:87]
ds_read_b128 v[152:155], v133 offset:4096
v_mfma_f32_16x16x32_bf16 v[116:119], v[36:39], v[60:63], v[116:119]
ds_read_b128 v[156:159], v133 offset:6144
s_waitcnt lgkmcnt(9)
v_mfma_f32_16x16x32_bf16 v[72:75], v[40:43], v[48:51], v[72:75]
v_mfma_f32_16x16x32_bf16 v[104:107], v[40:43], v[52:55], v[104:107]
v_mfma_f32_16x16x32_bf16 v[88:91], v[40:43], v[56:59], v[88:91]
v_mfma_f32_16x16x32_bf16 v[120:123], v[40:43], v[60:63], v[120:123]
s_waitcnt lgkmcnt(8)
v_mfma_f32_16x16x32_bf16 v[76:79], v[44:47], v[48:51], v[76:79]
v_mfma_f32_16x16x32_bf16 v[108:111], v[44:47], v[52:55], v[108:111]
v_mfma_f32_16x16x32_bf16 v[92:95], v[44:47], v[56:59], v[92:95]
v_mfma_f32_16x16x32_bf16 v[124:127], v[44:47], v[60:63], v[124:127]
s_waitcnt lgkmcnt(0)
s_barrier
v_mfma_f32_16x16x32_bf16 v[64:67], v[144:147], v[160:163], v[64:67]
ds_read_b128 v[32:35], v128 offset:0
v_mfma_f32_16x16x32_bf16 v[96:99], v[144:147], v[164:167], v[96:99]
ds_read_b128 v[48:51], v130 offset:0
v_mfma_f32_16x16x32_bf16 v[80:83], v[144:147], v[168:171], v[80:83]
ds_read_b128 v[52:55], v130 offset:2048
v_mfma_f32_16x16x32_bf16 v[112:115], v[144:147], v[172:175], v[112:115]
ds_read_b128 v[56:59], v130 offset:4096
v_mfma_f32_16x16x32_bf16 v[68:71], v[148:151], v[160:163], v[68:71]
ds_read_b128 v[60:63], v130 offset:6144
v_mfma_f32_16x16x32_bf16 v[100:103], v[148:151], v[164:167], v[100:103]
ds_read_b128 v[36:39], v128 offset:2048
v_mfma_f32_16x16x32_bf16 v[84:87], v[148:151], v[168:171], v[84:87]
ds_read_b128 v[40:43], v128 offset:4096
v_mfma_f32_16x16x32_bf16 v[116:119], v[148:151], v[172:175], v[116:119]
ds_read_b128 v[44:47], v128 offset:6144
v_mfma_f32_16x16x32_bf16 v[72:75], v[152:155], v[160:163], v[72:75]
v_mfma_f32_16x16x32_bf16 v[104:107], v[152:155], v[164:167], v[104:107]
v_mfma_f32_16x16x32_bf16 v[88:91], v[152:155], v[168:171], v[88:91]
v_mfma_f32_16x16x32_bf16 v[120:123], v[152:155], v[172:175], v[120:123]
v_mfma_f32_16x16x32_bf16 v[76:79], v[156:159], v[160:163], v[76:79]
v_mfma_f32_16x16x32_bf16 v[108:111], v[156:159], v[164:167], v[108:111]
v_mfma_f32_16x16x32_bf16 v[92:95], v[156:159], v[168:171], v[92:95]
v_mfma_f32_16x16x32_bf16 v[124:127], v[156:159], v[172:175], v[124:127]
s_waitcnt lgkmcnt(6)
v_mfma_f32_16x16x32_bf16 v[64:67], v[32:35], v[48:51], v[64:67]
ds_read_b128 v[144:147], v129 offset:0
s_waitcnt lgkmcnt(6)
v_mfma_f32_16x16x32_bf16 v[96:99], v[32:35], v[52:55], v[96:99]
ds_read_b128 v[160:163], v131 offset:0
s_waitcnt lgkmcnt(6)
v_mfma_f32_16x16x32_bf16 v[80:83], v[32:35], v[56:59], v[80:83]
ds_read_b128 v[164:167], v131 offset:2048
s_waitcnt lgkmcnt(6)
v_mfma_f32_16x16x32_bf16 v[112:115], v[32:35], v[60:63], v[112:115]
ds_read_b128 v[168:171], v131 offset:4096
s_waitcnt lgkmcnt(6)
v_mfma_f32_16x16x32_bf16 v[68:71], v[36:39], v[48:51], v[68:71]
ds_read_b128 v[172:175], v131 offset:6144
v_mfma_f32_16x16x32_bf16 v[100:103], v[36:39], v[52:55], v[100:103]
ds_read_b128 v[148:151], v129 offset:2048
v_mfma_f32_16x16x32_bf16 v[84:87], v[36:39], v[56:59], v[84:87]
ds_read_b128 v[152:155], v129 offset:4096
v_mfma_f32_16x16x32_bf16 v[116:119], v[36:39], v[60:63], v[116:119]
ds_read_b128 v[156:159], v129 offset:6144
s_waitcnt lgkmcnt(9)
v_mfma_f32_16x16x32_bf16 v[72:75], v[40:43], v[48:51], v[72:75]
v_mfma_f32_16x16x32_bf16 v[104:107], v[40:43], v[52:55], v[104:107]
v_mfma_f32_16x16x32_bf16 v[88:91], v[40:43], v[56:59], v[88:91]
v_mfma_f32_16x16x32_bf16 v[120:123], v[40:43], v[60:63], v[120:123]
s_waitcnt lgkmcnt(8)
v_mfma_f32_16x16x32_bf16 v[76:79], v[44:47], v[48:51], v[76:79]
v_mfma_f32_16x16x32_bf16 v[108:111], v[44:47], v[52:55], v[108:111]
v_mfma_f32_16x16x32_bf16 v[92:95], v[44:47], v[56:59], v[92:95]
v_mfma_f32_16x16x32_bf16 v[124:127], v[44:47], v[60:63], v[124:127]
L_n47:
s_waitcnt vmcnt(0)
v_readfirstlane_b32 s37, v9
s_nop 0
s_cmp_lg_u32 s37, 0
s_cbranch_scc1 L_ng48
global_load_dword v9, v8, s[30:31] sc1
s_branch L_n47
L_ng48:
s_getreg_b32 s60, hwreg(HW_REG_XCC_ID, 0, 4)
s_lshl_b32 s61, s37, 4
s_or_b32 s100, s60, s61
v_mov_b32 v194, s100
v_mov_b32 v202, s37
v_mov_b32 v203, s37
s_waitcnt lgkmcnt(0)
v_mfma_f32_16x16x32_bf16 v[64:67], v[144:147], v[160:163], v[64:67]
v_mfma_f32_16x16x32_bf16 v[96:99], v[144:147], v[164:167], v[96:99]
v_mfma_f32_16x16x32_bf16 v[80:83], v[144:147], v[168:171], v[80:83]
v_mfma_f32_16x16x32_bf16 v[112:115], v[144:147], v[172:175], v[112:115]
v_mfma_f32_16x16x32_bf16 v[68:71], v[148:151], v[160:163], v[68:71]
v_mfma_f32_16x16x32_bf16 v[100:103], v[148:151], v[164:167], v[100:103]
v_mfma_f32_16x16x32_bf16 v[84:87], v[148:151], v[168:171], v[84:87]
v_mfma_f32_16x16x32_bf16 v[116:119], v[148:151], v[172:175], v[116:119]
v_mfma_f32_16x16x32_bf16 v[72:75], v[152:155], v[160:163], v[72:75]
v_mfma_f32_16x16x32_bf16 v[104:107], v[152:155], v[164:167], v[104:107]
v_mfma_f32_16x16x32_bf16 v[88:91], v[152:155], v[168:171], v[88:91]
v_mfma_f32_16x16x32_bf16 v[120:123], v[152:155], v[172:175], v[120:123]
v_mfma_f32_16x16x32_bf16 v[76:79], v[156:159], v[160:163], v[76:79]
v_mfma_f32_16x16x32_bf16 v[108:111], v[156:159], v[164:167], v[108:111]
v_mfma_f32_16x16x32_bf16 v[92:95], v[156:159], v[168:171], v[92:95]
v_mfma_f32_16x16x32_bf16 v[124:127], v[156:159], v[172:175], v[124:127]
v_pk_fma_f32 v[40:41], v[20:21], v[64:65], v[66:67] op_sel_hi:[0,1,1]
v_pk_fma_f32 v[42:43], v[20:21], v[80:81], v[82:83] op_sel_hi:[0,1,1]
v_pk_fma_f32 v[44:45], v[22:23], v[96:97], v[98:99] op_sel_hi:[0,1,1]
v_pk_fma_f32 v[46:47], v[22:23], v[112:113], v[114:115] op_sel_hi:[0,1,1]
v_pk_fma_f32 v[66:67], v[20:21], v[80:81], v[40:41] op_sel:[1,0,0] neg_lo:[1,0,0] neg_hi:[1,0,0]
v_pk_fma_f32 v[82:83], v[20:21], v[64:65], v[42:43] op_sel:[1,0,0]
v_pk_fma_f32 v[98:99], v[22:23], v[112:113], v[44:45] op_sel:[1,0,0] neg_lo:[1,0,0] neg_hi:[1,0,0]
v_pk_fma_f32 v[114:115], v[22:23], v[96:97], v[46:47] op_sel:[1,0,0]
v_pk_fma_f32 v[40:41], v[20:21], v[66:67], v[68:69] op_sel_hi:[0,1,1]
v_pk_fma_f32 v[42:43], v[20:21], v[82:83], v[84:85] op_sel_hi:[0,1,1]
v_pk_fma_f32 v[44:45], v[22:23], v[98:99], v[100:101] op_sel_hi:[0,1,1]
v_pk_fma_f32 v[46:47], v[22:23], v[114:115], v[116:117] op_sel_hi:[0,1,1]
v_pk_fma_f32 v[68:69], v[20:21], v[82:83], v[40:41] op_sel:[1,0,0] neg_lo:[1,0,0] neg_hi:[1,0,0]
v_pk_fma_f32 v[84:85], v[20:21], v[66:67], v[42:43] op_sel:[1,0,0]
v_pk_fma_f32 v[100:101], v[22:23], v[114:115], v[44:45] op_sel:[1,0,0] neg_lo:[1,0,0] neg_hi:[1,0,0]
v_pk_fma_f32 v[116:117], v[22:23], v[98:99], v[46:47] op_sel:[1,0,0]
v_pk_fma_f32 v[40:41], v[20:21], v[68:69], v[70:71] op_sel_hi:[0,1,1]
v_pk_fma_f32 v[42:43], v[20:21], v[84:85], v[86:87] op_sel_hi:[0,1,1]
v_pk_fma_f32 v[44:45], v[22:23], v[100:101], v[102:103] op_sel_hi:[0,1,1]
v_pk_fma_f32 v[46:47], v[22:23], v[116:117], v[118:119] op_sel_hi:[0,1,1]
v_pk_fma_f32 v[70:71], v[20:21], v[84:85], v[40:41] op_sel:[1,0,0] neg_lo:[1,0,0] neg_hi:[1,0,0]
v_pk_fma_f32 v[86:87], v[20:21], v[68:69], v[42:43] op_sel:[1,0,0]
v_pk_fma_f32 v[102:103], v[22:23], v[116:117], v[44:45] op_sel:[1,0,0] neg_lo:[1,0,0] neg_hi:[1,0,0]
v_pk_fma_f32 v[118:119], v[22:23], v[100:101], v[46:47] op_sel:[1,0,0]
v_pk_fma_f32 v[40:41], v[20:21], v[70:71], v[72:73] op_sel_hi:[0,1,1]
v_pk_fma_f32 v[42:43], v[20:21], v[86:87], v[88:89] op_sel_hi:[0,1,1]
v_pk_fma_f32 v[44:45], v[22:23], v[102:103], v[104:105] op_sel_hi:[0,1,1]
v_pk_fma_f32 v[46:47], v[22:23], v[118:119], v[120:121] op_sel_hi:[0,1,1]
v_pk_fma_f32 v[72:73], v[20:21], v[86:87], v[40:41] op_sel:[1,0,0] neg_lo:[1,0,0] neg_hi:[1,0,0]
v_pk_fma_f32 v[88:89], v[20:21], v[70:71], v[42:43] op_sel:[1,0,0]
v_pk_fma_f32 v[104:105], v[22:23], v[118:119], v[44:45] op_sel:[1,0,0] neg_lo:[1,0,0] neg_hi:[1,0,0]
v_pk_fma_f32 v[120:121], v[22:23], v[102:103], v[46:47] op_sel:[1,0,0]
v_pk_fma_f32 v[40:41], v[20:21], v[72:73], v[74:75] op_sel_hi:[0,1,1]
v_pk_fma_f32 v[42:43], v[20:21], v[88:89], v[90:91] op_sel_hi:[0,1,1]
v_pk_fma_f32 v[44:45], v[22:23], v[104:105], v[106:107] op_sel_hi:[0,1,1]
v_pk_fma_f32 v[46:47], v[22:23], v[120:121], v[122:123] op_sel_hi:[0,1,1]
v_pk_fma_f32 v[74:75], v[20:21], v[88:89], v[40:41] op_sel:[1,0,0] neg_lo:[1,0,0] neg_hi:[1,0,0]
v_pk_fma_f32 v[90:91], v[20:21], v[72:73], v[42:43] op_sel:[1,0,0]
v_pk_fma_f32 v[106:107], v[22:23], v[120:121], v[44:45] op_sel:[1,0,0] neg_lo:[1,0,0] neg_hi:[1,0,0]
v_pk_fma_f32 v[122:123], v[22:23], v[104:105], v[46:47] op_sel:[1,0,0]
v_pk_fma_f32 v[40:41], v[20:21], v[74:75], v[76:77] op_sel_hi:[0,1,1]
v_pk_fma_f32 v[42:43], v[20:21], v[90:91], v[92:93] op_sel_hi:[0,1,1]
v_pk_fma_f32 v[44:45], v[22:23], v[106:107], v[108:109] op_sel_hi:[0,1,1]
v_pk_fma_f32 v[46:47], v[22:23], v[122:123], v[124:125] op_sel_hi:[0,1,1]
v_pk_fma_f32 v[76:77], v[20:21], v[90:91], v[40:41] op_sel:[1,0,0] neg_lo:[1,0,0] neg_hi:[1,0,0]
v_pk_fma_f32 v[92:93], v[20:21], v[74:75], v[42:43] op_sel:[1,0,0]
v_pk_fma_f32 v[108:109], v[22:23], v[122:123], v[44:45] op_sel:[1,0,0] neg_lo:[1,0,0] neg_hi:[1,0,0]
v_pk_fma_f32 v[124:125], v[22:23], v[106:107], v[46:47] op_sel:[1,0,0]
v_pk_fma_f32 v[40:41], v[20:21], v[76:77], v[78:79] op_sel_hi:[0,1,1]
v_pk_fma_f32 v[42:43], v[20:21], v[92:93], v[94:95] op_sel_hi:[0,1,1]
v_pk_fma_f32 v[44:45], v[22:23], v[108:109], v[110:111] op_sel_hi:[0,1,1]
v_pk_fma_f32 v[46:47], v[22:23], v[124:125], v[126:127] op_sel_hi:[0,1,1]
v_pk_fma_f32 v[78:79], v[20:21], v[92:93], v[40:41] op_sel:[1,0,0] neg_lo:[1,0,0] neg_hi:[1,0,0]
v_pk_fma_f32 v[94:95], v[20:21], v[76:77], v[42:43] op_sel:[1,0,0]
v_pk_fma_f32 v[110:111], v[22:23], v[124:125], v[44:45] op_sel:[1,0,0] neg_lo:[1,0,0] neg_hi:[1,0,0]
v_pk_fma_f32 v[126:127], v[22:23], v[108:109], v[46:47] op_sel:[1,0,0]
v_fma_f32 v40, v176, v78, v79
v_fma_f32 v41, v176, v94, v95
v_fma_f32 v32, -v177, v94, v40
v_fma_f32 v33, v177, v78, v41
ds_write_b64 v15, v[32:33] offset:0
v_fma_f32 v40, v178, v110, v111
v_fma_f32 v41, v178, v126, v127
v_fma_f32 v34, -v179, v126, v40
v_fma_f32 v35, v179, v110, v41
ds_write_b64 v15, v[34:35] offset:2304
s_waitcnt lgkmcnt(0)
s_mov_b64 exec, 1
v_mov_b32 v197, 17
ds_write_b32 v13, v197 offset:32
s_mov_b64 exec, -1
L_ek49:
ds_read_b128 v[198:201], v12 offset:32
s_waitcnt lgkmcnt(0)
v_min3_u32 v197, v198, v199, v200
v_min_u32 v197, v197, v201
s_nop 0
v_readfirstlane_b32 s60, v197
s_nop 0
s_cmp_lt_u32 s60, 17
s_cbranch_scc1 L_ek49
ds_read_b128 v[48:51], v14
ds_read_b128 v[52:55], v14 offset:16
s_waitcnt lgkmcnt(1)
v_fma_f32 v40, v28, v48, v50
v_fma_f32 v41, v28, v49, v51
v_fma_f32 v32, -v29, v49, v40
v_fma_f32 v33, v29, v48, v41
s_waitcnt lgkmcnt(0)
v_fma_f32 v40, v28, v32, v52
v_fma_f32 v41, v28, v33, v53
v_fma_f32 v34, -v29, v33, v40
v_fma_f32 v35, v29, v32, v41
v_fma_f32 v40, v28, v34, v54
v_fma_f32 v41, v28, v35, v55
v_fma_f32 v32, -v29, v35, v40
v_fma_f32 v33, v29, v34, v41
v_mov_b32 v34, v32
v_mov_b32 v35, v33
s_nop 0
v_permlane32_swap_b32 v32, v34
v_permlane32_swap_b32 v33, v35
v_fma_f32 v40, v192, v32, v34
v_fma_f32 v41, v192, v33, v35
v_fma_f32 v200, -v193, v33, v40
v_fma_f32 v201, v193, v32, v41
s_cmp_lg_u32 s68, 0
s_cbranch_scc1 L_np51
buffer_store_dwordx4 v[200:203], v16, s[40:43], 0 offen sc1
s_cmp_lg_u32 s66, 0
s_cbranch_scc1 L_np51
s_mov_b64 exec, 1
global_store_dword v195, v194, s[32:33] sc1
s_mov_b64 exec, -1
L_np51:
global_load_dword v243, v18, s[32:33] sc1
v_add_u32 v15, -56, v15
ds_read_b64 v[32:33], v15 offset:0
ds_read_b64 v[34:35], v15 offset:8
ds_read_b64 v[36:37], v15 offset:16
ds_read_b64 v[38:39], v15 offset:24
ds_read_b64 v[40:41], v15 offset:32
ds_read_b64 v[42:43], v15 offset:40
ds_read_b64 v[44:45], v15 offset:48
ds_read_b64 v[46:47], v15 offset:2304
ds_read_b64 v[48:49], v15 offset:2312
ds_read_b64 v[50:51], v15 offset:2320
ds_read_b64 v[52:53], v15 offset:2328
ds_read_b64 v[54:55], v15 offset:2336
ds_read_b64 v[56:57], v15 offset:2344
ds_read_b64 v[58:59], v15 offset:2352
s_waitcnt lgkmcnt(0)
v_fma_f32 v60, v180, v32, v34
v_fma_f32 v61, v180, v33, v35
v_fma_f32 v34, -v181, v33, v60
v_fma_f32 v35, v181, v32, v61
v_fma_f32 v60, v180, v34, v36
v_fma_f32 v61, v180, v35, v37
v_fma_f32 v36, -v181, v35, v60
v_fma_f32 v37, v181, v34, v61
v_fma_f32 v60, v180, v36, v38
v_fma_f32 v61, v180, v37, v39
v_fma_f32 v38, -v181, v37, v60
v_fma_f32 v39, v181, v36, v61
v_fma_f32 v60, v180, v38, v40
v_fma_f32 v61, v180, v39, v41
v_fma_f32 v40, -v181, v39, v60
v_fma_f32 v41, v181, v38, v61
v_fma_f32 v60, v180, v40, v42
v_fma_f32 v61, v180, v41, v43
v_fma_f32 v42, -v181, v41, v60
v_fma_f32 v43, v181, v40, v61
v_fma_f32 v60, v180, v42, v44
v_fma_f32 v61, v180, v43, v45
v_fma_f32 v128, -v181, v43, v60
v_fma_f32 v130, v181, v42, v61
v_fma_f32 v60, v176, v128, v78
v_fma_f32 v61, v176, v130, v94
v_fma_f32 v129, -v177, v130, v60
v_fma_f32 v131, v177, v128, v61
v_fma_f32 v60, v182, v46, v48
v_fma_f32 v61, v182, v47, v49
v_fma_f32 v48, -v183, v47, v60
v_fma_f32 v49, v183, v46, v61
v_fma_f32 v60, v182, v48, v50
v_fma_f32 v61, v182, v49, v51
v_fma_f32 v50, -v183, v49, v60
v_fma_f32 v51, v183, v48, v61
v_fma_f32 v60, v182, v50, v52
v_fma_f32 v61, v182, v51, v53
v_fma_f32 v52, -v183, v51, v60
v_fma_f32 v53, v183, v50, v61
v_fma_f32 v60, v182, v52, v54
v_fma_f32 v61, v182, v53, v55
v_fma_f32 v54, -v183, v53, v60
v_fma_f32 v55, v183, v52, v61
v_fma_f32 v60, v182, v54, v56
v_fma_f32 v61, v182, v55, v57
v_fma_f32 v56, -v183, v55, v60
v_fma_f32 v57, v183, v54, v61
v_fma_f32 v60, v182, v56, v58
v_fma_f32 v61, v182, v57, v59
v_fma_f32 v132, -v183, v57, v60
v_fma_f32 v134, v183, v56, v61
v_fma_f32 v60, v178, v132, v110
v_fma_f32 v61, v178, v134, v126
v_fma_f32 v133, -v179, v134, v60
v_fma_f32 v135, v179, v132, v61
v_pk_mul_f32 v[32:33], v[24:25], v[64:65] op_sel_hi:[0,1]
v_pk_mul_f32 v[34:35], v[24:25], v[80:81] op_sel_hi:[0,1] neg_lo:[1,0] neg_hi:[1,0]
v_pk_fma_f32 v[34:35], v[24:25], v[64:65], v[34:35] op_sel:[1,0,0] neg_lo:[1,0,0] neg_hi:[1,0,0]
v_pk_fma_f32 v[64:65], v[24:25], v[80:81], v[32:33] op_sel:[1,0,0] neg_lo:[1,0,0] neg_hi:[1,0,0]
v_mov_b64 v[80:81], v[34:35]
v_pk_mul_f32 v[36:37], v[26:27], v[96:97] op_sel_hi:[0,1]
v_pk_mul_f32 v[38:39], v[26:27], v[112:113] op_sel_hi:[0,1] neg_lo:[1,0] neg_hi:[1,0]
v_pk_fma_f32 v[38:39], v[26:27], v[96:97], v[38:39] op_sel:[1,0,0] neg_lo:[1,0,0] neg_hi:[1,0,0]
v_pk_fma_f32 v[96:97], v[26:27], v[112:113], v[36:37] op_sel:[1,0,0] neg_lo:[1,0,0] neg_hi:[1,0,0]
v_mov_b64 v[112:113], v[38:39]
v_pk_mul_f32 v[32:33], v[24:25], v[66:67] op_sel_hi:[0,1]
v_pk_mul_f32 v[34:35], v[24:25], v[82:83] op_sel_hi:[0,1] neg_lo:[1,0] neg_hi:[1,0]
v_pk_fma_f32 v[34:35], v[24:25], v[66:67], v[34:35] op_sel:[1,0,0] neg_lo:[1,0,0] neg_hi:[1,0,0]
v_pk_fma_f32 v[66:67], v[24:25], v[82:83], v[32:33] op_sel:[1,0,0] neg_lo:[1,0,0] neg_hi:[1,0,0]
v_mov_b64 v[82:83], v[34:35]
v_pk_mul_f32 v[36:37], v[26:27], v[98:99] op_sel_hi:[0,1]
v_pk_mul_f32 v[38:39], v[26:27], v[114:115] op_sel_hi:[0,1] neg_lo:[1,0] neg_hi:[1,0]
v_pk_fma_f32 v[38:39], v[26:27], v[98:99], v[38:39] op_sel:[1,0,0] neg_lo:[1,0,0] neg_hi:[1,0,0]
v_pk_fma_f32 v[98:99], v[26:27], v[114:115], v[36:37] op_sel:[1,0,0] neg_lo:[1,0,0] neg_hi:[1,0,0]
v_mov_b64 v[114:115], v[38:39]
v_pk_mul_f32 v[32:33], v[24:25], v[68:69] op_sel_hi:[0,1]
v_pk_mul_f32 v[34:35], v[24:25], v[84:85] op_sel_hi:[0,1] neg_lo:[1,0] neg_hi:[1,0]
v_pk_fma_f32 v[34:35], v[24:25], v[68:69], v[34:35] op_sel:[1,0,0] neg_lo:[1,0,0] neg_hi:[1,0,0]
v_pk_fma_f32 v[68:69], v[24:25], v[84:85], v[32:33] op_sel:[1,0,0] neg_lo:[1,0,0] neg_hi:[1,0,0]
v_mov_b64 v[84:85], v[34:35]
v_pk_mul_f32 v[36:37], v[26:27], v[100:101] op_sel_hi:[0,1]
v_pk_mul_f32 v[38:39], v[26:27], v[116:117] op_sel_hi:[0,1] neg_lo:[1,0] neg_hi:[1,0]
v_pk_fma_f32 v[38:39], v[26:27], v[100:101], v[38:39] op_sel:[1,0,0] neg_lo:[1,0,0] neg_hi:[1,0,0]
v_pk_fma_f32 v[100:101], v[26:27], v[116:117], v[36:37] op_sel:[1,0,0] neg_lo:[1,0,0] neg_hi:[1,0,0]
v_mov_b64 v[116:117], v[38:39]
v_pk_mul_f32 v[32:33], v[24:25], v[70:71] op_sel_hi:[0,1]
v_pk_mul_f32 v[34:35], v[24:25], v[86:87] op_sel_hi:[0,1] neg_lo:[1,0] neg_hi:[1,0]
v_pk_fma_f32 v[34:35], v[24:25], v[70:71], v[34:35] op_sel:[1,0,0] neg_lo:[1,0,0] neg_hi:[1,0,0]
v_pk_fma_f32 v[70:71], v[24:25], v[86:87], v[32:33] op_sel:[1,0,0] neg_lo:[1,0,0] neg_hi:[1,0,0]
v_mov_b64 v[86:87], v[34:35]
v_pk_mul_f32 v[36:37], v[26:27], v[102:103] op_sel_hi:[0,1]
v_pk_mul_f32 v[38:39], v[26:27], v[118:119] op_sel_hi:[0,1] neg_lo:[1,0] neg_hi:[1,0]
v_pk_fma_f32 v[38:39], v[26:27], v[102:103], v[38:39] op_sel:[1,0,0] neg_lo:[1,0,0] neg_hi:[1,0,0]
v_pk_fma_f32 v[102:103], v[26:27], v[118:119], v[36:37] op_sel:[1,0,0] neg_lo:[1,0,0] neg_hi:[1,0,0]
v_mov_b64 v[118:119], v[38:39]
v_pk_mul_f32 v[32:33], v[24:25], v[72:73] op_sel_hi:[0,1]
v_pk_mul_f32 v[34:35], v[24:25], v[88:89] op_sel_hi:[0,1] neg_lo:[1,0] neg_hi:[1,0]
v_pk_fma_f32 v[34:35], v[24:25], v[72:73], v[34:35] op_sel:[1,0,0] neg_lo:[1,0,0] neg_hi:[1,0,0]
v_pk_fma_f32 v[72:73], v[24:25], v[88:89], v[32:33] op_sel:[1,0,0] neg_lo:[1,0,0] neg_hi:[1,0,0]
v_mov_b64 v[88:89], v[34:35]
v_pk_mul_f32 v[36:37], v[26:27], v[104:105] op_sel_hi:[0,1]
v_pk_mul_f32 v[38:39], v[26:27], v[120:121] op_sel_hi:[0,1] neg_lo:[1,0] neg_hi:[1,0]
v_pk_fma_f32 v[38:39], v[26:27], v[104:105], v[38:39] op_sel:[1,0,0] neg_lo:[1,0,0] neg_hi:[1,0,0]
v_pk_fma_f32 v[104:105], v[26:27], v[120:121], v[36:37] op_sel:[1,0,0] neg_lo:[1,0,0] neg_hi:[1,0,0]
v_mov_b64 v[120:121], v[38:39]
v_pk_mul_f32 v[32:33], v[24:25], v[74:75] op_sel_hi:[0,1]
v_pk_mul_f32 v[34:35], v[24:25], v[90:91] op_sel_hi:[0,1] neg_lo:[1,0] neg_hi:[1,0]
v_pk_fma_f32 v[34:35], v[24:25], v[74:75], v[34:35] op_sel:[1,0,0] neg_lo:[1,0,0] neg_hi:[1,0,0]
v_pk_fma_f32 v[74:75], v[24:25], v[90:91], v[32:33] op_sel:[1,0,0] neg_lo:[1,0,0] neg_hi:[1,0,0]
v_mov_b64 v[90:91], v[34:35]
v_pk_mul_f32 v[36:37], v[26:27], v[106:107] op_sel_hi:[0,1]
v_pk_mul_f32 v[38:39], v[26:27], v[122:123] op_sel_hi:[0,1] neg_lo:[1,0] neg_hi:[1,0]
v_pk_fma_f32 v[38:39], v[26:27], v[106:107], v[38:39] op_sel:[1,0,0] neg_lo:[1,0,0] neg_hi:[1,0,0]
v_pk_fma_f32 v[106:107], v[26:27], v[122:123], v[36:37] op_sel:[1,0,0] neg_lo:[1,0,0] neg_hi:[1,0,0]
v_mov_b64 v[122:123], v[38:39]
v_pk_mul_f32 v[32:33], v[24:25], v[76:77] op_sel_hi:[0,1]
v_pk_mul_f32 v[34:35], v[24:25], v[92:93] op_sel_hi:[0,1] neg_lo:[1,0] neg_hi:[1,0]
v_pk_fma_f32 v[34:35], v[24:25], v[76:77], v[34:35] op_sel:[1,0,0] neg_lo:[1,0,0] neg_hi:[1,0,0]
v_pk_fma_f32 v[76:77], v[24:25], v[92:93], v[32:33] op_sel:[1,0,0] neg_lo:[1,0,0] neg_hi:[1,0,0]
v_mov_b64 v[92:93], v[34:35]
v_pk_mul_f32 v[36:37], v[26:27], v[108:109] op_sel_hi:[0,1]
v_pk_mul_f32 v[38:39], v[26:27], v[124:125] op_sel_hi:[0,1] neg_lo:[1,0] neg_hi:[1,0]
v_pk_fma_f32 v[38:39], v[26:27], v[108:109], v[38:39] op_sel:[1,0,0] neg_lo:[1,0,0] neg_hi:[1,0,0]
v_pk_fma_f32 v[108:109], v[26:27], v[124:125], v[36:37] op_sel:[1,0,0] neg_lo:[1,0,0] neg_hi:[1,0,0]
v_mov_b64 v[124:125], v[38:39]
v_pk_mul_f32 v[32:33], v[24:25], v[78:79] op_sel_hi:[0,1]
v_pk_mul_f32 v[34:35], v[24:25], v[94:95] op_sel_hi:[0,1] neg_lo:[1,0] neg_hi:[1,0]
v_pk_fma_f32 v[34:35], v[24:25], v[78:79], v[34:35] op_sel:[1,0,0] neg_lo:[1,0,0] neg_hi:[1,0,0]
v_pk_fma_f32 v[78:79], v[24:25], v[94:95], v[32:33] op_sel:[1,0,0] neg_lo:[1,0,0] neg_hi:[1,0,0]
v_mov_b64 v[94:95], v[34:35]
v_pk_mul_f32 v[36:37], v[26:27], v[110:111] op_sel_hi:[0,1]
v_pk_mul_f32 v[38:39], v[26:27], v[126:127] op_sel_hi:[0,1] neg_lo:[1,0] neg_hi:[1,0]
v_pk_fma_f32 v[38:39], v[26:27], v[110:111], v[38:39] op_sel:[1,0,0] neg_lo:[1,0,0] neg_hi:[1,0,0]
v_pk_fma_f32 v[110:111], v[26:27], v[126:127], v[36:37] op_sel:[1,0,0] neg_lo:[1,0,0] neg_hi:[1,0,0]
v_mov_b64 v[126:127], v[38:39]
buffer_load_dwordx4 v[144:147], v136, s[40:43], 0 offen sc1
buffer_load_dwordx4 v[148:151], v137, s[40:43], 0 offen sc1
buffer_load_dwordx4 v[152:155], v138, s[40:43], 0 offen sc1
buffer_load_dwordx4 v[156:159], v139, s[40:43], 0 offen sc1
buffer_load_dwordx4 v[160:163], v140, s[40:43], 0 offen sc1
buffer_load_dwordx4 v[164:167], v141, s[40:43], 0 offen sc1
buffer_load_dwordx4 v[168:171], v142, s[40:43], 0 offen sc1
buffer_load_dwordx4 v[172:175], v143, s[40:43], 0 offen sc1
global_load_dword v197, v196, s[32:33] sc1
v_mov_b32 v14, 1
s_mov_b64 exec, 1
ds_write_b32 v13, v14
s_mov_b64 exec, -1
s_xor_b32 s60, s68, s101
s_xor_b32 s60, s60, 1
s_lshl_b32 s60, s60, 6
s_add_u32 s60, s60, s66
v_lshrrev_b32 v8, 3, v1
v_lshl_add_u32 v8, v8, 1, s60
v_lshlrev_b32 v8, 11, v8
v_and_b32 v14, 7, v1
v_lshrrev_b32 v15, 4, v1
v_xor_b32 v14, v14, v15
v_lshlrev_b32 v14, 4, v14
v_xor_b32 v15, 64, v14
v_add_u32 v244, v8, v14
v_add_u32 v245, v8, v15
v_add_u32 v245, 31744, v245
v_add_u32 v246, v8, v14
v_add_u32 v246, 63488, v246
v_add_u32 v247, v8, v15
v_add_u32 v247, 95232, v247
s_and_b32 s64, s36, 7
s_lshl_b32 s60, s64, 18
s_lshl_b32 s61, s101, 10
s_add_u32 s60, s60, s61
s_add_u32 s48, s20, s60
s_addc_u32 s49, s21, 0
s_sub_u32 s50, 262144, s61
s_mov_b32 s51, 0x20000
s_add_u32 s52, s22, s60
s_addc_u32 s53, s23, 0
s_sub_u32 s54, 262144, s61
s_mov_b32 s55, 0x20000
s_lshl_b32 s61, s64, 1
s_add_u32 s61, s61, s101
s_lshl_b32 s61, s61, 7
s_lshl_b32 s63, s35, 1
s_add_u32 s63, s63, s68
s_lshl_b32 s60, s63, 17
s_add_u32 s60, s60, s61
s_add_u32 s56, s10, s60
s_addc_u32 s57, s11, 0
s_sub_u32 s58, 131072, s61
s_mov_b32 s59, 0x20000
s_add_u32 s26, s26, s61
s_addc_u32 s27, s27, 0
s_lshl_b32 s61, s61, 1
s_add_u32 s61, s61, 4096
s_lshl_b32 s60, s63, 19
s_add_u32 s60, s60, s61
s_add_u32 s28, s28, s60
s_addc_u32 s29, s29, 0
s_sub_u32 s24, 0x80000, s61
s_lshl_b32 s67, s34, 12
s_lshl_b32 s65, s64, 13
s_lshl_b32 s64, s64, 7
s_lshl_b32 s60, s68, 14
s_lshl_b32 s61, s66, 11
s_add_u32 s60, s60, s61
s_add_u32 s60, s60, 65536
v_add_u32 v16, s60, v10
s_lshl_b32 s60, s34, 13
s_add_u32 s60, s60, 65536
v_add_u32 v17, s60, v11
v_xor_b32 v20, 0, v7
v_add_u32 v24, 0x10000, v20
v_xor_b32 v21, 32, v7
v_add_u32 v25, 0x10000, v21
v_xor_b32 v22, 64, v7
v_add_u32 v26, 0x10000, v22
v_xor_b32 v23, 96, v7
v_add_u32 v27, 0x10000, v23
s_mul_i32 s14, s63, 262144
s_lshl_b32 s61, s36, 13
s_add_u32 s14, s14, s61
s_lshl_b32 s61, s66, 11
s_add_u32 s14, s14, s61
v_cmp_gt_u32 vcc, 0x40000, v136
s_nop 1
v_cndmask_b32 v40, 0, v202, vcc
v_cmp_gt_u32 vcc, 0x40000, v137
s_nop 1
v_cndmask_b32 v41, 0, v202, vcc
v_cmp_gt_u32 vcc, 0x40000, v138
s_nop 1
v_cndmask_b32 v42, 0, v202, vcc
v_cmp_gt_u32 vcc, 0x40000, v139
s_nop 1
v_cndmask_b32 v43, 0, v202, vcc
v_cmp_gt_u32 vcc, 0x40000, v140
s_nop 1
v_cndmask_b32 v44, 0, v202, vcc
v_cmp_gt_u32 vcc, 0x40000, v141
s_nop 1
v_cndmask_b32 v45, 0, v202, vcc
v_cmp_gt_u32 vcc, 0x40000, v142
s_nop 1
v_cndmask_b32 v46, 0, v202, vcc
v_cmp_gt_u32 vcc, 0x40000, v143
s_nop 1
v_cndmask_b32 v47, 0, v202, vcc
s_mov_b32 s69, 0
L_poll52:
v_mov_b32 v8, 0
s_waitcnt vmcnt(8)
v_bitop3_b32 v8, v8, v146, v40 bitop3:0xf6
v_bitop3_b32 v8, v8, v147, v40 bitop3:0xf6
s_waitcnt vmcnt(7)
v_bitop3_b32 v8, v8, v150, v41 bitop3:0xf6
v_bitop3_b32 v8, v8, v151, v41 bitop3:0xf6
s_waitcnt vmcnt(6)
v_bitop3_b32 v8, v8, v154, v42 bitop3:0xf6
v_bitop3_b32 v8, v8, v155, v42 bitop3:0xf6
s_waitcnt vmcnt(5)
v_bitop3_b32 v8, v8, v158, v43 bitop3:0xf6
v_bitop3_b32 v8, v8, v159, v43 bitop3:0xf6
s_waitcnt vmcnt(4)
v_bitop3_b32 v8, v8, v162, v44 bitop3:0xf6
v_bitop3_b32 v8, v8, v163, v44 bitop3:0xf6
s_waitcnt vmcnt(3)
v_bitop3_b32 v8, v8, v166, v45 bitop3:0xf6
v_bitop3_b32 v8, v8, v167, v45 bitop3:0xf6
s_waitcnt vmcnt(2)
v_bitop3_b32 v8, v8, v170, v46 bitop3:0xf6
v_bitop3_b32 v8, v8, v171, v46 bitop3:0xf6
s_waitcnt vmcnt(1)
v_bitop3_b32 v8, v8, v174, v47 bitop3:0xf6
v_bitop3_b32 v8, v8, v175, v47 bitop3:0xf6
s_waitcnt vmcnt(0)
v_xor_b32 v197, v194, v197
v_lshrrev_b32 v9, 4, v197
v_or_b32 v8, v8, v9
v_cmp_ne_u32 vcc, 0, v8
s_nop 0
s_cbranch_vccz L_polled53
s_add_u32 s69, s69, 1
s_cmp_ge_u32 s69, 200000
s_cbranch_scc1 L_polled53
buffer_load_dwordx4 v[144:147], v136, s[40:43], 0 offen sc1
buffer_load_dwordx4 v[148:151], v137, s[40:43], 0 offen sc1
buffer_load_dwordx4 v[152:155], v138, s[40:43], 0 offen sc1
buffer_load_dwordx4 v[156:159], v139, s[40:43], 0 offen sc1
buffer_load_dwordx4 v[160:163], v140, s[40:43], 0 offen sc1
buffer_load_dwordx4 v[164:167], v141, s[40:43], 0 offen sc1
buffer_load_dwordx4 v[168:171], v142, s[40:43], 0 offen sc1
buffer_load_dwordx4 v[172:175], v143, s[40:43], 0 offen sc1
global_load_dword v197, v196, s[32:33] sc1
s_branch L_poll52
L_polled53:
v_cmp_ne_u32 vcc, 0, v197
s_nop 0
s_cmp_eq_u64 vcc, 0
s_cselect_b32 s100, 1, 0
s_add_u32 m0, s67, 0
s_add_u32 s62, s64, 0
s_and_b32 s62, s62, 0x3ff
buffer_load_dwordx4 v244, s[48:51], s62 offen offset:0 lds
buffer_load_dwordx4 v245, s[48:51], s62 offen offset:1024 lds
buffer_load_dwordx4 v246, s[48:51], s62 offen offset:2048 lds
buffer_load_dwordx4 v247, s[48:51], s62 offen offset:3072 lds
s_add_u32 m0, s67, 16384
s_nop 0
buffer_load_dwordx4 v244, s[52:55], s62 offen offset:0 lds
buffer_load_dwordx4 v245, s[52:55], s62 offen offset:1024 lds
buffer_load_dwordx4 v246, s[52:55], s62 offen offset:2048 lds
buffer_load_dwordx4 v247, s[52:55], s62 offen offset:3072 lds
v_mov_b32 v14, 2
s_mov_b64 exec, 1
ds_write_b32 v13, v14
s_mov_b64 exec, -1
v_fma_f32 v40, v2, v172, v168
v_fma_f32 v41, v2, v173, v169
v_fma_f32 v48, -v3, v173, v40
v_fma_f32 v49, v3, v172, v41
v_fma_f32 v40, v2, v48, v164
v_fma_f32 v41, v2, v49, v165
v_fma_f32 v172, -v3, v49, v40
v_fma_f32 v173, v3, v48, v41
v_fma_f32 v40, v2, v172, v160
v_fma_f32 v41, v2, v173, v161
v_fma_f32 v48, -v3, v173, v40
v_fma_f32 v49, v3, v172, v41
v_fma_f32 v40, v2, v48, v156
v_fma_f32 v41, v2, v49, v157
v_fma_f32 v172, -v3, v49, v40
v_fma_f32 v173, v3, v48, v41
v_fma_f32 v40, v2, v172, v152
v_fma_f32 v41, v2, v173, v153
v_fma_f32 v48, -v3, v173, v40
v_fma_f32 v49, v3, v172, v41
v_fma_f32 v40, v2, v48, v148
v_fma_f32 v41, v2, v49, v149
v_fma_f32 v172, -v3, v49, v40
v_fma_f32 v173, v3, v48, v41
v_fma_f32 v40, v2, v172, v144
v_fma_f32 v41, v2, v173, v145
v_fma_f32 v48, -v3, v173, v40
v_fma_f32 v49, v3, v172, v41
v_mov_b32 v50, v48
v_mov_b32 v51, v49
s_nop 0
v_permlane32_swap_b32 v48, v50
v_permlane32_swap_b32 v49, v51
v_fma_f32 v40, v30, v50, v48
v_fma_f32 v41, v30, v51, v49
v_fma_f32 v52, -v31, v51, v40
v_fma_f32 v53, v31, v50, v41
v_mov_b32 v54, v52
v_mov_b32 v55, v53
s_nop 0
v_permlane16_swap_b32 v52, v54
v_permlane16_swap_b32 v53, v55
v_pk_fma_f32 v[128:129], v[52:53], v[184:185], v[128:129] op_sel_hi:[0,1,1]
v_pk_fma_f32 v[130:131], v[52:53], v[186:187], v[130:131] op_sel_hi:[0,1,1]
v_pk_fma_f32 v[128:129], v[52:53], v[186:187], v[128:129] op_sel:[1,0,0] neg_lo:[1,0,0] neg_hi:[1,0,0]
v_pk_fma_f32 v[130:131], v[52:53], v[184:185], v[130:131] op_sel:[1,0,0]
v_pk_fma_f32 v[132:133], v[54:55], v[188:189], v[132:133] op_sel_hi:[0,1,1]
v_pk_fma_f32 v[134:135], v[54:55], v[190:191], v[134:135] op_sel_hi:[0,1,1]
v_pk_fma_f32 v[132:133], v[54:55], v[190:191], v[132:133] op_sel:[1,0,0] neg_lo:[1,0,0] neg_hi:[1,0,0]
v_pk_fma_f32 v[134:135], v[54:55], v[188:189], v[134:135] op_sel:[1,0,0]
v_pk_fma_f32 v[64:65], v[208:209], v[128:129], v[64:65] op_sel_hi:[0,1,1]
v_pk_fma_f32 v[80:81], v[208:209], v[130:131], v[80:81] op_sel_hi:[0,1,1] neg_lo:[1,0,0] neg_hi:[1,0,0]
v_pk_fma_f32 v[64:65], v[208:209], v[130:131], v[64:65] op_sel:[1,0,0] neg_lo:[1,0,0] neg_hi:[1,0,0]
v_pk_fma_f32 v[80:81], v[208:209], v[128:129], v[80:81] op_sel:[1,0,0] neg_lo:[1,0,0] neg_hi:[1,0,0]
v_cvt_pk_bf16_f32 v144, v64, v65
v_cvt_pk_bf16_f32 v152, v80, v81
v_pk_fma_f32 v[96:97], v[224:225], v[132:133], v[96:97] op_sel_hi:[0,1,1]
v_pk_fma_f32 v[112:113], v[224:225], v[134:135], v[112:113] op_sel_hi:[0,1,1] neg_lo:[1,0,0] neg_hi:[1,0,0]
v_pk_fma_f32 v[96:97], v[224:225], v[134:135], v[96:97] op_sel:[1,0,0] neg_lo:[1,0,0] neg_hi:[1,0,0]
v_pk_fma_f32 v[112:113], v[224:225], v[132:133], v[112:113] op_sel:[1,0,0] neg_lo:[1,0,0] neg_hi:[1,0,0]
v_cvt_pk_bf16_f32 v160, v96, v97
v_cvt_pk_bf16_f32 v168, v112, v113
v_pk_fma_f32 v[66:67], v[210:211], v[128:129], v[66:67] op_sel_hi:[0,1,1]
v_pk_fma_f32 v[82:83], v[210:211], v[130:131], v[82:83] op_sel_hi:[0,1,1] neg_lo:[1,0,0] neg_hi:[1,0,0]
v_pk_fma_f32 v[66:67], v[210:211], v[130:131], v[66:67] op_sel:[1,0,0] neg_lo:[1,0,0] neg_hi:[1,0,0]
v_pk_fma_f32 v[82:83], v[210:211], v[128:129], v[82:83] op_sel:[1,0,0] neg_lo:[1,0,0] neg_hi:[1,0,0]
v_cvt_pk_bf16_f32 v145, v66, v67
v_cvt_pk_bf16_f32 v153, v82, v83
v_pk_fma_f32 v[98:99], v[226:227], v[132:133], v[98:99] op_sel_hi:[0,1,1]
v_pk_fma_f32 v[114:115], v[226:227], v[134:135], v[114:115] op_sel_hi:[0,1,1] neg_lo:[1,0,0] neg_hi:[1,0,0]
v_pk_fma_f32 v[98:99], v[226:227], v[134:135], v[98:99] op_sel:[1,0,0] neg_lo:[1,0,0] neg_hi:[1,0,0]
v_pk_fma_f32 v[114:115], v[226:227], v[132:133], v[114:115] op_sel:[1,0,0] neg_lo:[1,0,0] neg_hi:[1,0,0]
v_cvt_pk_bf16_f32 v161, v98, v99
v_cvt_pk_bf16_f32 v169, v114, v115
v_pk_fma_f32 v[68:69], v[212:213], v[128:129], v[68:69] op_sel_hi:[0,1,1]
v_pk_fma_f32 v[84:85], v[212:213], v[130:131], v[84:85] op_sel_hi:[0,1,1] neg_lo:[1,0,0] neg_hi:[1,0,0]
v_pk_fma_f32 v[68:69], v[212:213], v[130:131], v[68:69] op_sel:[1,0,0] neg_lo:[1,0,0] neg_hi:[1,0,0]
v_pk_fma_f32 v[84:85], v[212:213], v[128:129], v[84:85] op_sel:[1,0,0] neg_lo:[1,0,0] neg_hi:[1,0,0]
v_cvt_pk_bf16_f32 v146, v68, v69
v_cvt_pk_bf16_f32 v154, v84, v85
v_pk_fma_f32 v[100:101], v[228:229], v[132:133], v[100:101] op_sel_hi:[0,1,1]
v_pk_fma_f32 v[116:117], v[228:229], v[134:135], v[116:117] op_sel_hi:[0,1,1] neg_lo:[1,0,0] neg_hi:[1,0,0]
v_pk_fma_f32 v[100:101], v[228:229], v[134:135], v[100:101] op_sel:[1,0,0] neg_lo:[1,0,0] neg_hi:[1,0,0]
v_pk_fma_f32 v[116:117], v[228:229], v[132:133], v[116:117] op_sel:[1,0,0] neg_lo:[1,0,0] neg_hi:[1,0,0]
v_cvt_pk_bf16_f32 v162, v100, v101
v_cvt_pk_bf16_f32 v170, v116, v117
v_pk_fma_f32 v[70:71], v[214:215], v[128:129], v[70:71] op_sel_hi:[0,1,1]
v_pk_fma_f32 v[86:87], v[214:215], v[130:131], v[86:87] op_sel_hi:[0,1,1] neg_lo:[1,0,0] neg_hi:[1,0,0]
v_pk_fma_f32 v[70:71], v[214:215], v[130:131], v[70:71] op_sel:[1,0,0] neg_lo:[1,0,0] neg_hi:[1,0,0]
v_pk_fma_f32 v[86:87], v[214:215], v[128:129], v[86:87] op_sel:[1,0,0] neg_lo:[1,0,0] neg_hi:[1,0,0]
v_cvt_pk_bf16_f32 v147, v70, v71
v_cvt_pk_bf16_f32 v155, v86, v87
v_pk_fma_f32 v[102:103], v[230:231], v[132:133], v[102:103] op_sel_hi:[0,1,1]
v_pk_fma_f32 v[118:119], v[230:231], v[134:135], v[118:119] op_sel_hi:[0,1,1] neg_lo:[1,0,0] neg_hi:[1,0,0]
v_pk_fma_f32 v[102:103], v[230:231], v[134:135], v[102:103] op_sel:[1,0,0] neg_lo:[1,0,0] neg_hi:[1,0,0]
v_pk_fma_f32 v[118:119], v[230:231], v[132:133], v[118:119] op_sel:[1,0,0] neg_lo:[1,0,0] neg_hi:[1,0,0]
v_cvt_pk_bf16_f32 v163, v102, v103
v_cvt_pk_bf16_f32 v171, v118, v119
v_mfma_f32_16x16x32_bf16 v[32:35], v[144:147], v[248:251], 0
v_mfma_f32_16x16x32_bf16 v[36:39], v[160:163], v[248:251], 0
v_mfma_f32_16x16x32_bf16 v[40:43], v[144:147], v[252:255], 0
v_mfma_f32_16x16x32_bf16 v[44:47], v[160:163], v[252:255], 0
v_mfma_f32_16x16x32_bf16 v[48:51], v[152:155], v[248:251], 0
v_mfma_f32_16x16x32_bf16 v[52:55], v[168:171], v[248:251], 0
v_mfma_f32_16x16x32_bf16 v[56:59], v[152:155], v[252:255], 0
v_mfma_f32_16x16x32_bf16 v[60:63], v[168:171], v[252:255], 0
v_pk_fma_f32 v[72:73], v[216:217], v[128:129], v[72:73] op_sel_hi:[0,1,1]
v_pk_fma_f32 v[88:89], v[216:217], v[130:131], v[88:89] op_sel_hi:[0,1,1] neg_lo:[1,0,0] neg_hi:[1,0,0]
v_pk_fma_f32 v[72:73], v[216:217], v[130:131], v[72:73] op_sel:[1,0,0] neg_lo:[1,0,0] neg_hi:[1,0,0]
v_pk_fma_f32 v[88:89], v[216:217], v[128:129], v[88:89] op_sel:[1,0,0] neg_lo:[1,0,0] neg_hi:[1,0,0]
v_cvt_pk_bf16_f32 v148, v72, v73
v_cvt_pk_bf16_f32 v156, v88, v89
v_pk_fma_f32 v[104:105], v[232:233], v[132:133], v[104:105] op_sel_hi:[0,1,1]
v_pk_fma_f32 v[120:121], v[232:233], v[134:135], v[120:121] op_sel_hi:[0,1,1] neg_lo:[1,0,0] neg_hi:[1,0,0]
v_pk_fma_f32 v[104:105], v[232:233], v[134:135], v[104:105] op_sel:[1,0,0] neg_lo:[1,0,0] neg_hi:[1,0,0]
v_pk_fma_f32 v[120:121], v[232:233], v[132:133], v[120:121] op_sel:[1,0,0] neg_lo:[1,0,0] neg_hi:[1,0,0]
v_cvt_pk_bf16_f32 v164, v104, v105
v_cvt_pk_bf16_f32 v172, v120, v121
v_pk_fma_f32 v[74:75], v[218:219], v[128:129], v[74:75] op_sel_hi:[0,1,1]
v_pk_fma_f32 v[90:91], v[218:219], v[130:131], v[90:91] op_sel_hi:[0,1,1] neg_lo:[1,0,0] neg_hi:[1,0,0]
v_pk_fma_f32 v[74:75], v[218:219], v[130:131], v[74:75] op_sel:[1,0,0] neg_lo:[1,0,0] neg_hi:[1,0,0]
v_pk_fma_f32 v[90:91], v[218:219], v[128:129], v[90:91] op_sel:[1,0,0] neg_lo:[1,0,0] neg_hi:[1,0,0]
v_cvt_pk_bf16_f32 v149, v74, v75
v_cvt_pk_bf16_f32 v157, v90, v91
v_pk_fma_f32 v[106:107], v[234:235], v[132:133], v[106:107] op_sel_hi:[0,1,1]
v_pk_fma_f32 v[122:123], v[234:235], v[134:135], v[122:123] op_sel_hi:[0,1,1] neg_lo:[1,0,0] neg_hi:[1,0,0]
v_pk_fma_f32 v[106:107], v[234:235], v[134:135], v[106:107] op_sel:[1,0,0] neg_lo:[1,0,0] neg_hi:[1,0,0]
v_pk_fma_f32 v[122:123], v[234:235], v[132:133], v[122:123] op_sel:[1,0,0] neg_lo:[1,0,0] neg_hi:[1,0,0]
v_cvt_pk_bf16_f32 v165, v106, v107
v_cvt_pk_bf16_f32 v173, v122, v123
s_add_u32 s61, s14, 0
v_cvt_pk_bf16_f32 v176, v32, v33
v_cvt_pk_bf16_f32 v177, v34, v35
v_cvt_pk_bf16_f32 v178, v36, v37
v_cvt_pk_bf16_f32 v179, v38, v39
buffer_store_dwordx4 v[176:179], v10, s[44:47], s61 offen offset:0 sc1
ds_write_b128 v16, v[176:179] offset:0
s_add_u32 s61, s14, 131072
v_cvt_pk_bf16_f32 v180, v40, v41
v_cvt_pk_bf16_f32 v181, v42, v43
v_cvt_pk_bf16_f32 v182, v44, v45
v_cvt_pk_bf16_f32 v183, v46, v47
buffer_store_dwordx4 v[180:183], v10, s[44:47], s61 offen offset:0 sc1
ds_write_b128 v16, v[180:183] offset:8192
s_add_u32 s61, s14, 4096
v_cvt_pk_bf16_f32 v184, v48, v49
v_cvt_pk_bf16_f32 v185, v50, v51
v_cvt_pk_bf16_f32 v186, v52, v53
v_cvt_pk_bf16_f32 v187, v54, v55
buffer_store_dwordx4 v[184:187], v10, s[44:47], s61 offen offset:0 sc1
ds_write_b128 v16, v[184:187] offset:4096
s_add_u32 s61, s14, 135168
v_cvt_pk_bf16_f32 v188, v56, v57
v_cvt_pk_bf16_f32 v189, v58, v59
v_cvt_pk_bf16_f32 v190, v60, v61
v_cvt_pk_bf16_f32 v191, v62, v63
buffer_store_dwordx4 v[188:191], v10, s[44:47], s61 offen offset:0 sc1
ds_write_b128 v16, v[188:191] offset:12288
v_pk_fma_f32 v[76:77], v[220:221], v[128:129], v[76:77] op_sel_hi:[0,1,1]
v_pk_fma_f32 v[92:93], v[220:221], v[130:131], v[92:93] op_sel_hi:[0,1,1] neg_lo:[1,0,0] neg_hi:[1,0,0]
v_pk_fma_f32 v[76:77], v[220:221], v[130:131], v[76:77] op_sel:[1,0,0] neg_lo:[1,0,0] neg_hi:[1,0,0]
v_pk_fma_f32 v[92:93], v[220:221], v[128:129], v[92:93] op_sel:[1,0,0] neg_lo:[1,0,0] neg_hi:[1,0,0]
v_cvt_pk_bf16_f32 v150, v76, v77
v_cvt_pk_bf16_f32 v158, v92, v93
v_pk_fma_f32 v[108:109], v[236:237], v[132:133], v[108:109] op_sel_hi:[0,1,1]
v_pk_fma_f32 v[124:125], v[236:237], v[134:135], v[124:125] op_sel_hi:[0,1,1] neg_lo:[1,0,0] neg_hi:[1,0,0]
v_pk_fma_f32 v[108:109], v[236:237], v[134:135], v[108:109] op_sel:[1,0,0] neg_lo:[1,0,0] neg_hi:[1,0,0]
v_pk_fma_f32 v[124:125], v[236:237], v[132:133], v[124:125] op_sel:[1,0,0] neg_lo:[1,0,0] neg_hi:[1,0,0]
v_cvt_pk_bf16_f32 v166, v108, v109
v_cvt_pk_bf16_f32 v174, v124, v125
v_pk_fma_f32 v[78:79], v[222:223], v[128:129], v[78:79] op_sel_hi:[0,1,1]
v_pk_fma_f32 v[94:95], v[222:223], v[130:131], v[94:95] op_sel_hi:[0,1,1] neg_lo:[1,0,0] neg_hi:[1,0,0]
v_pk_fma_f32 v[78:79], v[222:223], v[130:131], v[78:79] op_sel:[1,0,0] neg_lo:[1,0,0] neg_hi:[1,0,0]
v_pk_fma_f32 v[94:95], v[222:223], v[128:129], v[94:95] op_sel:[1,0,0] neg_lo:[1,0,0] neg_hi:[1,0,0]
v_cvt_pk_bf16_f32 v151, v78, v79
v_cvt_pk_bf16_f32 v159, v94, v95
v_pk_fma_f32 v[110:111], v[238:239], v[132:133], v[110:111] op_sel_hi:[0,1,1]
v_pk_fma_f32 v[126:127], v[238:239], v[134:135], v[126:127] op_sel_hi:[0,1,1] neg_lo:[1,0,0] neg_hi:[1,0,0]
v_pk_fma_f32 v[110:111], v[238:239], v[134:135], v[110:111] op_sel:[1,0,0] neg_lo:[1,0,0] neg_hi:[1,0,0]
v_pk_fma_f32 v[126:127], v[238:239], v[132:133], v[126:127] op_sel:[1,0,0] neg_lo:[1,0,0] neg_hi:[1,0,0]
v_cvt_pk_bf16_f32 v167, v110, v111
v_cvt_pk_bf16_f32 v175, v126, v127
v_mfma_f32_16x16x32_bf16 v[32:35], v[148:151], v[248:251], 0
v_mfma_f32_16x16x32_bf16 v[36:39], v[164:167], v[248:251], 0
v_mfma_f32_16x16x32_bf16 v[40:43], v[148:151], v[252:255], 0
v_mfma_f32_16x16x32_bf16 v[44:47], v[164:167], v[252:255], 0
v_mfma_f32_16x16x32_bf16 v[48:51], v[156:159], v[248:251], 0
v_mfma_f32_16x16x32_bf16 v[52:55], v[172:175], v[248:251], 0
v_mfma_f32_16x16x32_bf16 v[56:59], v[156:159], v[252:255], 0
v_mfma_f32_16x16x32_bf16 v[60:63], v[172:175], v[252:255], 0
s_add_u32 s61, s14, 0
v_cvt_pk_bf16_f32 v192, v32, v33
v_cvt_pk_bf16_f32 v193, v34, v35
v_cvt_pk_bf16_f32 v194, v36, v37
v_cvt_pk_bf16_f32 v195, v38, v39
buffer_store_dwordx4 v[192:195], v10, s[44:47], s61 offen offset:256 sc1
ds_write_b128 v16, v[192:195] offset:256
s_add_u32 s61, s14, 131072
v_cvt_pk_bf16_f32 v196, v40, v41
v_cvt_pk_bf16_f32 v197, v42, v43
v_cvt_pk_bf16_f32 v198, v44, v45
v_cvt_pk_bf16_f32 v199, v46, v47
buffer_store_dwordx4 v[196:199], v10, s[44:47], s61 offen offset:256 sc1
ds_write_b128 v16, v[196:199] offset:8448
s_add_u32 s61, s14, 4096
v_cvt_pk_bf16_f32 v200, v48, v49
v_cvt_pk_bf16_f32 v201, v50, v51
v_cvt_pk_bf16_f32 v202, v52, v53
v_cvt_pk_bf16_f32 v203, v54, v55
buffer_store_dwordx4 v[200:203], v10, s[44:47], s61 offen offset:256 sc1
ds_write_b128 v16, v[200:203] offset:4352
s_add_u32 s61, s14, 135168
v_cvt_pk_bf16_f32 v204, v56, v57
v_cvt_pk_bf16_f32 v205, v58, v59
v_cvt_pk_bf16_f32 v206, v60, v61
v_cvt_pk_bf16_f32 v207, v62, v63
buffer_store_dwordx4 v[204:207], v10, s[44:47], s61 offen offset:256 sc1
ds_write_b128 v16, v[204:207] offset:12544
v_mov_b32 v2, v11
s_lshl_b32 s60, s35, 2
s_add_u32 s60, s60, s34
s_mul_i32 s60, s60, 131072
s_lshl_b32 s61, s101, 16
s_add_u32 s60, s60, s61
s_add_u32 s42, s60, 1048576
s_add_u32 s40, s32, s42
s_addc_u32 s41, s33, 0
s_mov_b32 s42, 65536
s_mov_b32 s43, 0x20000
s_waitcnt vmcnt(8) lgkmcnt(0)
v_mov_b32 v14, 3
s_mov_b64 exec, 1
ds_write_b32 v13, v14
s_mov_b64 exec, -1
ds_read_b128 v[8:11], v12 offset:0
s_waitcnt lgkmcnt(0)
L_ck54:
v_min3_u32 v15, v8, v9, v10
v_min_u32 v15, v15, v11
s_nop 0
v_readfirstlane_b32 s60, v15
s_nop 0
s_cmp_ge_u32 s60, 3
s_cbranch_scc1 L_ckd55
ds_read_b128 v[8:11], v12 offset:0
s_waitcnt lgkmcnt(0)
s_branch L_ck54
L_ckd55:
ds_read_b128 v[148:151], v17 offset:0
ds_read_b128 v[152:155], v17 offset:1024
ds_read_b128 v[156:159], v17 offset:2048
ds_read_b128 v[160:163], v17 offset:3072
ds_read_b128 v[164:167], v17 offset:4096
ds_read_b128 v[168:171], v17 offset:5120
ds_read_b128 v[172:175], v17 offset:6144
ds_read_b128 v[176:179], v17 offset:7168
ds_read_b128 v[96:99], v20 offset:0
ds_read_b128 v[100:103], v20 offset:4096
ds_read_b128 v[104:107], v20 offset:8192
ds_read_b128 v[108:111], v20 offset:12288
s_waitcnt lgkmcnt(4)
v_mov_b32 v14, 4
s_mov_b64 exec, 1
ds_write_b32 v13, v14
s_mov_b64 exec, -1
s_waitcnt lgkmcnt(0)
v_mfma_f32_32x32x16_bf16 v[32:47], v[148:151], v[96:99], 0
ds_read_b128 v[112:115], v21 offset:0
ds_read_b128 v[116:119], v21 offset:4096
v_mfma_f32_32x32x16_bf16 v[48:63], v[148:151], v[100:103], 0
ds_read_b128 v[120:123], v21 offset:8192
ds_read_b128 v[124:127], v21 offset:12288
v_mfma_f32_32x32x16_bf16 v[64:79], v[148:151], v[104:107], 0
s_add_u32 m0, s67, 32768
s_add_u32 s62, s64, 128
s_and_b32 s62, s62, 0x3ff
buffer_load_dwordx4 v244, s[48:51], s62 offen offset:0 lds
v_mfma_f32_32x32x16_bf16 v[80:95], v[148:151], v[108:111], 0
s_waitcnt lgkmcnt(3)
v_mfma_f32_32x32x16_bf16 v[32:47], v[152:155], v[112:115], v[32:47]
ds_read_b128 v[96:99], v22 offset:0
ds_read_b128 v[100:103], v22 offset:4096
s_waitcnt lgkmcnt(4)
v_mfma_f32_32x32x16_bf16 v[48:63], v[152:155], v[116:119], v[48:63]
ds_read_b128 v[104:107], v22 offset:8192
ds_read_b128 v[108:111], v22 offset:12288
s_waitcnt lgkmcnt(5)
v_mfma_f32_32x32x16_bf16 v[64:79], v[152:155], v[120:123], v[64:79]
buffer_load_dwordx4 v245, s[48:51], s62 offen offset:1024 lds
s_waitcnt lgkmcnt(4)
v_mfma_f32_32x32x16_bf16 v[80:95], v[152:155], v[124:127], v[80:95]
s_waitcnt lgkmcnt(3)
v_mfma_f32_32x32x16_bf16 v[32:47], v[156:159], v[96:99], v[32:47]
ds_read_b128 v[112:115], v23 offset:0
ds_read_b128 v[116:119], v23 offset:4096
s_waitcnt lgkmcnt(4)
v_mfma_f32_32x32x16_bf16 v[48:63], v[156:159], v[100:103], v[48:63]
ds_read_b128 v[120:123], v23 offset:8192
ds_read_b128 v[124:127], v23 offset:12288
s_waitcnt lgkmcnt(5)
v_mfma_f32_32x32x16_bf16 v[64:79], v[156:159], v[104:107], v[64:79]
buffer_load_dwordx4 v246, s[48:51], s62 offen offset:2048 lds
s_waitcnt lgkmcnt(4)
v_mfma_f32_32x32x16_bf16 v[80:95], v[156:159], v[108:111], v[80:95]
s_waitcnt lgkmcnt(3)
v_mfma_f32_32x32x16_bf16 v[32:47], v[160:163], v[112:115], v[32:47]
ds_read_b128 v[96:99], v20 offset:16384
ds_read_b128 v[100:103], v20 offset:20480
s_waitcnt lgkmcnt(4)
v_mfma_f32_32x32x16_bf16 v[48:63], v[160:163], v[116:119], v[48:63]
ds_read_b128 v[104:107], v20 offset:24576
ds_read_b128 v[108:111], v20 offset:28672
s_waitcnt lgkmcnt(5)
v_mfma_f32_32x32x16_bf16 v[64:79], v[160:163], v[120:123], v[64:79]
buffer_load_dwordx4 v247, s[48:51], s62 offen offset:3072 lds
s_waitcnt lgkmcnt(4)
v_mfma_f32_32x32x16_bf16 v[80:95], v[160:163], v[124:127], v[80:95]
s_waitcnt lgkmcnt(3)
v_mfma_f32_32x32x16_bf16 v[32:47], v[164:167], v[96:99], v[32:47]
ds_read_b128 v[112:115], v21 offset:16384
ds_read_b128 v[116:119], v21 offset:20480
s_waitcnt lgkmcnt(4)
v_mfma_f32_32x32x16_bf16 v[48:63], v[164:167], v[100:103], v[48:63]
ds_read_b128 v[120:123], v21 offset:24576
ds_read_b128 v[124:127], v21 offset:28672
s_waitcnt lgkmcnt(5)
v_mfma_f32_32x32x16_bf16 v[64:79], v[164:167], v[104:107], v[64:79]
s_add_u32 m0, s67, 49152
s_nop 0
buffer_load_dwordx4 v244, s[52:55], s62 offen offset:0 lds
s_waitcnt lgkmcnt(4)
v_mfma_f32_32x32x16_bf16 v[80:95], v[164:167], v[108:111], v[80:95]
s_waitcnt lgkmcnt(3)
v_mfma_f32_32x32x16_bf16 v[32:47], v[168:171], v[112:115], v[32:47]
ds_read_b128 v[96:99], v22 offset:16384
ds_read_b128 v[100:103], v22 offset:20480
s_waitcnt lgkmcnt(4)
v_mfma_f32_32x32x16_bf16 v[48:63], v[168:171], v[116:119], v[48:63]
ds_read_b128 v[104:107], v22 offset:24576
ds_read_b128 v[108:111], v22 offset:28672
s_waitcnt lgkmcnt(5)
v_mfma_f32_32x32x16_bf16 v[64:79], v[168:171], v[120:123], v[64:79]
buffer_load_dwordx4 v245, s[52:55], s62 offen offset:1024 lds
s_waitcnt lgkmcnt(4)
v_mfma_f32_32x32x16_bf16 v[80:95], v[168:171], v[124:127], v[80:95]
s_waitcnt lgkmcnt(3)
v_mfma_f32_32x32x16_bf16 v[32:47], v[172:175], v[96:99], v[32:47]
ds_read_b128 v[112:115], v23 offset:16384
ds_read_b128 v[116:119], v23 offset:20480
s_waitcnt lgkmcnt(4)
v_mfma_f32_32x32x16_bf16 v[48:63], v[172:175], v[100:103], v[48:63]
ds_read_b128 v[120:123], v23 offset:24576
ds_read_b128 v[124:127], v23 offset:28672
s_waitcnt lgkmcnt(5)
v_mfma_f32_32x32x16_bf16 v[64:79], v[172:175], v[104:107], v[64:79]
buffer_load_dwordx4 v246, s[52:55], s62 offen offset:2048 lds
s_waitcnt lgkmcnt(4)
v_mfma_f32_32x32x16_bf16 v[80:95], v[172:175], v[108:111], v[80:95]
s_waitcnt lgkmcnt(0)
v_mfma_f32_32x32x16_bf16 v[32:47], v[176:179], v[112:115], v[32:47]
v_mfma_f32_32x32x16_bf16 v[48:63], v[176:179], v[116:119], v[48:63]
v_mfma_f32_32x32x16_bf16 v[64:79], v[176:179], v[120:123], v[64:79]
buffer_load_dwordx4 v247, s[52:55], s62 offen offset:3072 lds
v_mfma_f32_32x32x16_bf16 v[80:95], v[176:179], v[124:127], v[80:95]
s_lshl_b32 s60, s66, 3
v_lshl_add_u32 v17, v5, 4, s60
v_lshlrev_b32 v28, 11, v17
v_lshl_add_u32 v28, v6, 2, v28
v_lshlrev_b32 v29, 13, v17
v_lshl_add_u32 v29, v6, 3, v29
v_lshlrev_b32 v30, 2, v6
v_mov_b32 v15, s37
s_waitcnt vmcnt(8)
s_mov_b64 exec, 1
s_cmp_eq_u32 s100, 0
s_cbranch_scc1 L_rs56
global_store_dword v19, v15, s[32:33]
s_branch L_rd57
L_rs56:
global_store_dword v19, v15, s[32:33] sc1
L_rd57:
s_mov_b64 exec, -1
ds_read_b128 v[8:11], v12 offset:0
s_waitcnt lgkmcnt(0)
L_ck58:
v_min3_u32 v15, v8, v9, v10
v_min_u32 v15, v15, v11
s_nop 0
v_readfirstlane_b32 s60, v15
s_nop 0
s_cmp_ge_u32 s60, 4
s_cbranch_scc1 L_ckd59
ds_read_b128 v[8:11], v12 offset:0
s_waitcnt lgkmcnt(0)
s_branch L_ck58
L_ckd59:
ds_read_b128 v[8:11], v12 offset:16
s_waitcnt lgkmcnt(0)
L_ck60:
v_min3_u32 v15, v8, v9, v10
v_min_u32 v15, v15, v11
s_nop 0
v_readfirstlane_b32 s60, v15
s_nop 0
s_cmp_ge_u32 s60, 2
s_cbranch_scc1 L_ckd61
ds_read_b128 v[8:11], v12 offset:16
s_waitcnt lgkmcnt(0)
s_branch L_ck60
L_ckd61:
s_add_u32 m0, s67, 65536
s_add_u32 s62, s64, 256
s_and_b32 s62, s62, 0x3ff
buffer_load_dwordx4 v244, s[48:51], s62 offen offset:0 lds
buffer_load_dwordx4 v245, s[48:51], s62 offen offset:1024 lds
buffer_load_dwordx4 v246, s[48:51], s62 offen offset:2048 lds
buffer_load_dwordx4 v247, s[48:51], s62 offen offset:3072 lds
s_add_u32 m0, s67, 81920
s_nop 0
buffer_load_dwordx4 v244, s[52:55], s62 offen offset:0 lds
buffer_load_dwordx4 v245, s[52:55], s62 offen offset:1024 lds
buffer_load_dwordx4 v246, s[52:55], s62 offen offset:2048 lds
buffer_load_dwordx4 v247, s[52:55], s62 offen offset:3072 lds
s_mov_b32 s92, 0
L_w62:
global_load_dword v8, v18, s[32:33] sc1
s_waitcnt vmcnt(0)
v_cmp_ne_u32 vcc, s37, v8
s_nop 0
s_cbranch_vccz L_wd63
s_sleep 4
s_add_u32 s92, s92, 1
s_cmp_lt_u32 s92, 200000
s_cbranch_scc1 L_w62
L_wd63:
v_mov_b32 v14, 5
s_mov_b64 exec, 1
ds_write_b32 v13, v14
s_mov_b64 exec, -1
s_add_u32 s63, s65, 8192
s_and_b32 s63, s63, 0xffff
buffer_load_dwordx4 v[180:183], v2, s[40:43], s63 offen offset:0 sc1
buffer_load_dwordx4 v[184:187], v2, s[40:43], s63 offen offset:1024 sc1
buffer_load_dwordx4 v[188:191], v2, s[40:43], s63 offen offset:2048 sc1
buffer_load_dwordx4 v[192:195], v2, s[40:43], s63 offen offset:3072 sc1
s_add_u32 m0, s67, 98304
s_add_u32 s62, s64, 384
s_and_b32 s62, s62, 0x3ff
buffer_load_dwordx4 v244, s[48:51], s62 offen offset:0 lds
buffer_load_dwordx4 v245, s[48:51], s62 offen offset:1024 lds
buffer_load_dwordx4 v246, s[48:51], s62 offen offset:2048 lds
buffer_load_dwordx4 v247, s[48:51], s62 offen offset:3072 lds
s_add_u32 s63, s65, 12288
s_and_b32 s63, s63, 0xffff
buffer_load_dwordx4 v[196:199], v2, s[40:43], s63 offen offset:0 sc1
buffer_load_dwordx4 v[200:203], v2, s[40:43], s63 offen offset:1024 sc1
buffer_load_dwordx4 v[204:207], v2, s[40:43], s63 offen offset:2048 sc1
buffer_load_dwordx4 v[208:211], v2, s[40:43], s63 offen offset:3072 sc1
ds_read_b128 v[8:11], v12 offset:0
s_waitcnt lgkmcnt(0)
L_ck64:
v_min3_u32 v15, v8, v9, v10
v_min_u32 v15, v15, v11
s_nop 0
v_readfirstlane_b32 s60, v15
s_nop 0
s_cmp_ge_u32 s60, 5
s_cbranch_scc1 L_ckd65
ds_read_b128 v[8:11], v12 offset:0
s_waitcnt lgkmcnt(0)
s_branch L_ck64
L_ckd65:
ds_read_b128 v[96:99], v20 offset:32768
ds_read_b128 v[100:103], v20 offset:36864
ds_read_b128 v[104:107], v20 offset:40960
ds_read_b128 v[108:111], v20 offset:45056
s_waitcnt vmcnt(11) lgkmcnt(3)
v_mfma_f32_32x32x16_bf16 v[32:47], v[180:183], v[96:99], v[32:47]
ds_read_b128 v[112:115], v21 offset:32768
ds_read_b128 v[116:119], v21 offset:36864
s_waitcnt lgkmcnt(4)
v_mfma_f32_32x32x16_bf16 v[48:63], v[180:183], v[100:103], v[48:63]
ds_read_b128 v[120:123], v21 offset:40960
ds_read_b128 v[124:127], v21 offset:45056
s_waitcnt lgkmcnt(5)
v_mfma_f32_32x32x16_bf16 v[64:79], v[180:183], v[104:107], v[64:79]
s_waitcnt lgkmcnt(4)
v_mfma_f32_32x32x16_bf16 v[80:95], v[180:183], v[108:111], v[80:95]
s_add_u32 s63, s65, 16384
s_and_b32 s63, s63, 0xffff
buffer_load_dwordx4 v[212:215], v2, s[40:43], s63 offen offset:0 sc1
buffer_load_dwordx4 v[216:219], v2, s[40:43], s63 offen offset:1024 sc1
s_waitcnt vmcnt(12) lgkmcnt(3)
v_mfma_f32_32x32x16_bf16 v[32:47], v[184:187], v[112:115], v[32:47]
ds_read_b128 v[96:99], v22 offset:32768
ds_read_b128 v[100:103], v22 offset:36864
s_waitcnt lgkmcnt(4)
v_mfma_f32_32x32x16_bf16 v[48:63], v[184:187], v[116:119], v[48:63]
ds_read_b128 v[104:107], v22 offset:40960
ds_read_b128 v[108:111], v22 offset:45056
s_waitcnt lgkmcnt(5)
v_mfma_f32_32x32x16_bf16 v[64:79], v[184:187], v[120:123], v[64:79]
s_waitcnt lgkmcnt(4)
v_mfma_f32_32x32x16_bf16 v[80:95], v[184:187], v[124:127], v[80:95]
buffer_load_dwordx4 v[220:223], v2, s[40:43], s63 offen offset:2048 sc1
buffer_load_dwordx4 v[224:227], v2, s[40:43], s63 offen offset:3072 sc1
s_waitcnt vmcnt(13) lgkmcnt(3)
v_mfma_f32_32x32x16_bf16 v[32:47], v[188:191], v[96:99], v[32:47]
ds_read_b128 v[112:115], v23 offset:32768
ds_read_b128 v[116:119], v23 offset:36864
s_waitcnt lgkmcnt(4)
v_mfma_f32_32x32x16_bf16 v[48:63], v[188:191], v[100:103], v[48:63]
ds_read_b128 v[120:123], v23 offset:40960
ds_read_b128 v[124:127], v23 offset:45056
s_waitcnt lgkmcnt(5)
v_mfma_f32_32x32x16_bf16 v[64:79], v[188:191], v[104:107], v[64:79]
s_waitcnt lgkmcnt(4)
v_mfma_f32_32x32x16_bf16 v[80:95], v[188:191], v[108:111], v[80:95]
s_add_u32 s63, s65, 20480
s_and_b32 s63, s63, 0xffff
buffer_load_dwordx4 v[228:231], v2, s[40:43], s63 offen offset:0 sc1
buffer_load_dwordx4 v[232:235], v2, s[40:43], s63 offen offset:1024 sc1
s_waitcnt vmcnt(14) lgkmcnt(3)
v_mfma_f32_32x32x16_bf16 v[32:47], v[192:195], v[112:115], v[32:47]
ds_read_b128 v[96:99], v20 offset:49152
ds_read_b128 v[100:103], v20 offset:53248
s_waitcnt lgkmcnt(4)
v_mfma_f32_32x32x16_bf16 v[48:63], v[192:195], v[116:119], v[48:63]
ds_read_b128 v[104:107], v20 offset:57344
ds_read_b128 v[108:111], v20 offset:61440
s_waitcnt lgkmcnt(5)
v_mfma_f32_32x32x16_bf16 v[64:79], v[192:195], v[120:123], v[64:79]
s_waitcnt lgkmcnt(4)
v_mfma_f32_32x32x16_bf16 v[80:95], v[192:195], v[124:127], v[80:95]
buffer_load_dwordx4 v[236:239], v2, s[40:43], s63 offen offset:2048 sc1
buffer_load_dwordx4 v[240:243], v2, s[40:43], s63 offen offset:3072 sc1
s_waitcnt vmcnt(11) lgkmcnt(3)
v_mov_b32 v14, 6
s_mov_b64 exec, 1
ds_write_b32 v13, v14
s_mov_b64 exec, -1
v_mfma_f32_32x32x16_bf16 v[32:47], v[196:199], v[96:99], v[32:47]
ds_read_b128 v[112:115], v21 offset:49152
ds_read_b128 v[116:119], v21 offset:53248
s_waitcnt lgkmcnt(5)
v_mfma_f32_32x32x16_bf16 v[48:63], v[196:199], v[100:103], v[48:63]
ds_read_b128 v[120:123], v21 offset:57344
ds_read_b128 v[124:127], v21 offset:61440
s_waitcnt lgkmcnt(6)
v_mfma_f32_32x32x16_bf16 v[64:79], v[196:199], v[104:107], v[64:79]
s_add_u32 m0, s67, 0
s_nop 0
buffer_load_dwordx4 v244, s[52:55], s62 offen offset:0 lds
s_waitcnt lgkmcnt(5)
v_mfma_f32_32x32x16_bf16 v[80:95], v[196:199], v[108:111], v[80:95]
s_add_u32 s63, s65, 24576
s_and_b32 s63, s63, 0xffff
buffer_load_dwordx4 v[148:151], v2, s[40:43], s63 offen offset:0 sc1
buffer_load_dwordx4 v[152:155], v2, s[40:43], s63 offen offset:1024 sc1
s_waitcnt vmcnt(13) lgkmcnt(3)
v_mfma_f32_32x32x16_bf16 v[32:47], v[200:203], v[112:115], v[32:47]
ds_read_b128 v[96:99], v22 offset:49152
ds_read_b128 v[100:103], v22 offset:53248
s_waitcnt lgkmcnt(4)
v_mfma_f32_32x32x16_bf16 v[48:63], v[200:203], v[116:119], v[48:63]
ds_read_b128 v[104:107], v22 offset:57344
ds_read_b128 v[108:111], v22 offset:61440
s_waitcnt lgkmcnt(5)
v_mfma_f32_32x32x16_bf16 v[64:79], v[200:203], v[120:123], v[64:79]
buffer_load_dwordx4 v245, s[52:55], s62 offen offset:1024 lds
s_waitcnt lgkmcnt(4)
v_mfma_f32_32x32x16_bf16 v[80:95], v[200:203], v[124:127], v[80:95]
buffer_load_dwordx4 v[156:159], v2, s[40:43], s63 offen offset:2048 sc1
buffer_load_dwordx4 v[160:163], v2, s[40:43], s63 offen offset:3072 sc1
s_waitcnt vmcnt(15) lgkmcnt(3)
v_mfma_f32_32x32x16_bf16 v[32:47], v[204:207], v[96:99], v[32:47]
ds_read_b128 v[112:115], v23 offset:49152
ds_read_b128 v[116:119], v23 offset:53248
s_waitcnt lgkmcnt(4)
v_mfma_f32_32x32x16_bf16 v[48:63], v[204:207], v[100:103], v[48:63]
ds_read_b128 v[120:123], v23 offset:57344
ds_read_b128 v[124:127], v23 offset:61440
s_waitcnt lgkmcnt(5)
v_mfma_f32_32x32x16_bf16 v[64:79], v[204:207], v[104:107], v[64:79]
buffer_load_dwordx4 v246, s[52:55], s62 offen offset:2048 lds
s_waitcnt lgkmcnt(4)
v_mfma_f32_32x32x16_bf16 v[80:95], v[204:207], v[108:111], v[80:95]
s_add_u32 s63, s65, 28672
s_and_b32 s63, s63, 0xffff
buffer_load_dwordx4 v[164:167], v2, s[40:43], s63 offen offset:0 sc1
buffer_load_dwordx4 v[168:171], v2, s[40:43], s63 offen offset:1024 sc1
ds_read_b128 v[8:11], v12
s_waitcnt vmcnt(17) lgkmcnt(0)
L_ck66:
v_min3_u32 v15, v8, v9, v10
v_min_u32 v15, v15, v11
s_nop 0
v_readfirstlane_b32 s60, v15
s_nop 0
s_cmp_ge_u32 s60, 6
s_cbranch_scc1 L_ckd67
ds_read_b128 v[8:11], v12 offset:0
s_waitcnt lgkmcnt(0)
s_branch L_ck66
L_ckd67:
v_mfma_f32_32x32x16_bf16 v[32:47], v[208:211], v[112:115], v[32:47]
ds_read_b128 v[96:99], v24 offset:0
ds_read_b128 v[100:103], v24 offset:4096
v_mfma_f32_32x32x16_bf16 v[48:63], v[208:211], v[116:119], v[48:63]
ds_read_b128 v[104:107], v24 offset:8192
ds_read_b128 v[108:111], v24 offset:12288
v_mfma_f32_32x32x16_bf16 v[64:79], v[208:211], v[120:123], v[64:79]
buffer_load_dwordx4 v247, s[52:55], s62 offen offset:3072 lds
v_mfma_f32_32x32x16_bf16 v[80:95], v[208:211], v[124:127], v[80:95]
buffer_load_dwordx4 v[172:175], v2, s[40:43], s63 offen offset:2048 sc1
buffer_load_dwordx4 v[176:179], v2, s[40:43], s63 offen offset:3072 sc1
s_waitcnt vmcnt(19) lgkmcnt(3)
v_mfma_f32_32x32x16_bf16 v[32:47], v[212:215], v[96:99], v[32:47]
ds_read_b128 v[112:115], v25 offset:0
ds_read_b128 v[116:119], v25 offset:4096
s_waitcnt lgkmcnt(4)
v_mfma_f32_32x32x16_bf16 v[48:63], v[212:215], v[100:103], v[48:63]
ds_read_b128 v[120:123], v25 offset:8192
ds_read_b128 v[124:127], v25 offset:12288
s_waitcnt lgkmcnt(5)
v_mfma_f32_32x32x16_bf16 v[64:79], v[212:215], v[104:107], v[64:79]
s_add_u32 m0, s67, 16384
s_add_u32 s62, s64, 512
s_and_b32 s62, s62, 0x3ff
buffer_load_dwordx4 v244, s[48:51], s62 offen offset:0 lds
s_waitcnt lgkmcnt(4)
v_mfma_f32_32x32x16_bf16 v[80:95], v[212:215], v[108:111], v[80:95]
s_add_u32 s63, s65, 32768
s_and_b32 s63, s63, 0xffff
buffer_load_dwordx4 v[180:183], v2, s[40:43], s63 offen offset:0 sc1
buffer_load_dwordx4 v[184:187], v2, s[40:43], s63 offen offset:1024 sc1
s_waitcnt vmcnt(21) lgkmcnt(3)
v_mfma_f32_32x32x16_bf16 v[32:47], v[216:219], v[112:115], v[32:47]
ds_read_b128 v[96:99], v26 offset:0
ds_read_b128 v[100:103], v26 offset:4096
s_waitcnt lgkmcnt(4)
v_mfma_f32_32x32x16_bf16 v[48:63], v[216:219], v[116:119], v[48:63]
ds_read_b128 v[104:107], v26 offset:8192
ds_read_b128 v[108:111], v26 offset:12288
s_waitcnt lgkmcnt(5)
v_mfma_f32_32x32x16_bf16 v[64:79], v[216:219], v[120:123], v[64:79]
buffer_load_dwordx4 v245, s[48:51], s62 offen offset:1024 lds
s_waitcnt lgkmcnt(4)
v_mfma_f32_32x32x16_bf16 v[80:95], v[216:219], v[124:127], v[80:95]
buffer_load_dwordx4 v[188:191], v2, s[40:43], s63 offen offset:2048 sc1
buffer_load_dwordx4 v[192:195], v2, s[40:43], s63 offen offset:3072 sc1
s_waitcnt vmcnt(23) lgkmcnt(3)
v_mfma_f32_32x32x16_bf16 v[32:47], v[220:223], v[96:99], v[32:47]
ds_read_b128 v[112:115], v27 offset:0
ds_read_b128 v[116:119], v27 offset:4096
s_waitcnt lgkmcnt(4)
v_mfma_f32_32x32x16_bf16 v[48:63], v[220:223], v[100:103], v[48:63]
ds_read_b128 v[120:123], v27 offset:8192
ds_read_b128 v[124:127], v27 offset:12288
s_waitcnt lgkmcnt(5)
v_mfma_f32_32x32x16_bf16 v[64:79], v[220:223], v[104:107], v[64:79]
buffer_load_dwordx4 v246, s[48:51], s62 offen offset:2048 lds
s_waitcnt lgkmcnt(4)
v_mfma_f32_32x32x16_bf16 v[80:95], v[220:223], v[108:111], v[80:95]
s_add_u32 s63, s65, 36864
s_and_b32 s63, s63, 0xffff
buffer_load_dwordx4 v[196:199], v2, s[40:43], s63 offen offset:0 sc1
buffer_load_dwordx4 v[200:203], v2, s[40:43], s63 offen offset:1024 sc1
s_waitcnt vmcnt(25) lgkmcnt(3)
v_mfma_f32_32x32x16_bf16 v[32:47], v[224:227], v[112:115], v[32:47]
ds_read_b128 v[96:99], v24 offset:16384
ds_read_b128 v[100:103], v24 offset:20480
s_waitcnt lgkmcnt(4)
v_mfma_f32_32x32x16_bf16 v[48:63], v[224:227], v[116:119], v[48:63]
ds_read_b128 v[104:107], v24 offset:24576
ds_read_b128 v[108:111], v24 offset:28672
s_waitcnt lgkmcnt(5)
v_mfma_f32_32x32x16_bf16 v[64:79], v[224:227], v[120:123], v[64:79]
buffer_load_dwordx4 v247, s[48:51], s62 offen offset:3072 lds
s_waitcnt lgkmcnt(4)
v_mfma_f32_32x32x16_bf16 v[80:95], v[224:227], v[124:127], v[80:95]
buffer_load_dwordx4 v[204:207], v2, s[40:43], s63 offen offset:2048 sc1
buffer_load_dwordx4 v[208:211], v2, s[40:43], s63 offen offset:3072 sc1
s_waitcnt vmcnt(14) lgkmcnt(3)
v_mov_b32 v14, 7
s_mov_b64 exec, 1
ds_write_b32 v13, v14
s_mov_b64 exec, -1
v_mfma_f32_32x32x16_bf16 v[32:47], v[228:231], v[96:99], v[32:47]
ds_read_b128 v[112:115], v25 offset:16384
ds_read_b128 v[116:119], v25 offset:20480
s_waitcnt lgkmcnt(5)
v_mfma_f32_32x32x16_bf16 v[48:63], v[228:231], v[100:103], v[48:63]
ds_read_b128 v[120:123], v25 offset:24576
ds_read_b128 v[124:127], v25 offset:28672
s_waitcnt lgkmcnt(6)
v_mfma_f32_32x32x16_bf16 v[64:79], v[228:231], v[104:107], v[64:79]
s_add_u32 m0, s67, 32768
s_nop 0
buffer_load_dwordx4 v244, s[52:55], s62 offen offset:0 lds
s_waitcnt lgkmcnt(5)
v_mfma_f32_32x32x16_bf16 v[80:95], v[228:231], v[108:111], v[80:95]
s_add_u32 s63, s65, 40960
s_and_b32 s63, s63, 0xffff
buffer_load_dwordx4 v[212:215], v2, s[40:43], s63 offen offset:0 sc1
buffer_load_dwordx4 v[216:219], v2, s[40:43], s63 offen offset:1024 sc1
s_waitcnt vmcnt(29) lgkmcnt(3)
v_mfma_f32_32x32x16_bf16 v[32:47], v[232:235], v[112:115], v[32:47]
ds_read_b128 v[96:99], v26 offset:16384
ds_read_b128 v[100:103], v26 offset:20480
s_waitcnt lgkmcnt(4)
v_mfma_f32_32x32x16_bf16 v[48:63], v[232:235], v[116:119], v[48:63]
ds_read_b128 v[104:107], v26 offset:24576
ds_read_b128 v[108:111], v26 offset:28672
s_waitcnt lgkmcnt(5)
v_mfma_f32_32x32x16_bf16 v[64:79], v[232:235], v[120:123], v[64:79]
buffer_load_dwordx4 v245, s[52:55], s62 offen offset:1024 lds
s_waitcnt lgkmcnt(4)
v_mfma_f32_32x32x16_bf16 v[80:95], v[232:235], v[124:127], v[80:95]
buffer_load_dwordx4 v[220:223], v2, s[40:43], s63 offen offset:2048 sc1
buffer_load_dwordx4 v[224:227], v2, s[40:43], s63 offen offset:3072 sc1
s_waitcnt vmcnt(31) lgkmcnt(3)
v_mfma_f32_32x32x16_bf16 v[32:47], v[236:239], v[96:99], v[32:47]
ds_read_b128 v[112:115], v27 offset:16384
ds_read_b128 v[116:119], v27 offset:20480
s_waitcnt lgkmcnt(4)
v_mfma_f32_32x32x16_bf16 v[48:63], v[236:239], v[100:103], v[48:63]
ds_read_b128 v[120:123], v27 offset:24576
ds_read_b128 v[124:127], v27 offset:28672
s_waitcnt lgkmcnt(5)
v_mfma_f32_32x32x16_bf16 v[64:79], v[236:239], v[104:107], v[64:79]
buffer_load_dwordx4 v246, s[52:55], s62 offen offset:2048 lds
s_waitcnt lgkmcnt(4)
v_mfma_f32_32x32x16_bf16 v[80:95], v[236:239], v[108:111], v[80:95]
s_add_u32 s63, s65, 45056
s_and_b32 s63, s63, 0xffff
buffer_load_dwordx4 v[228:231], v2, s[40:43], s63 offen offset:0 sc1
buffer_load_dwordx4 v[232:235], v2, s[40:43], s63 offen offset:1024 sc1
ds_read_b128 v[8:11], v12
s_waitcnt vmcnt(33) lgkmcnt(0)
L_ck68:
v_min3_u32 v15, v8, v9, v10
v_min_u32 v15, v15, v11
s_nop 0
v_readfirstlane_b32 s60, v15
s_nop 0
s_cmp_ge_u32 s60, 7
s_cbranch_scc1 L_ckd69
ds_read_b128 v[8:11], v12 offset:0
s_waitcnt lgkmcnt(0)
s_branch L_ck68
L_ckd69:
v_mfma_f32_32x32x16_bf16 v[32:47], v[240:243], v[112:115], v[32:47]
ds_read_b128 v[96:99], v24 offset:32768
ds_read_b128 v[100:103], v24 offset:36864
v_mfma_f32_32x32x16_bf16 v[48:63], v[240:243], v[116:119], v[48:63]
ds_read_b128 v[104:107], v24 offset:40960
ds_read_b128 v[108:111], v24 offset:45056
v_mfma_f32_32x32x16_bf16 v[64:79], v[240:243], v[120:123], v[64:79]
buffer_load_dwordx4 v247, s[52:55], s62 offen offset:3072 lds
v_mfma_f32_32x32x16_bf16 v[80:95], v[240:243], v[124:127], v[80:95]
buffer_load_dwordx4 v[236:239], v2, s[40:43], s63 offen offset:2048 sc1
buffer_load_dwordx4 v[240:243], v2, s[40:43], s63 offen offset:3072 sc1
s_waitcnt vmcnt(34) lgkmcnt(3)
v_mfma_f32_32x32x16_bf16 v[32:47], v[148:151], v[96:99], v[32:47]
ds_read_b128 v[112:115], v25 offset:32768
ds_read_b128 v[116:119], v25 offset:36864
s_waitcnt lgkmcnt(4)
v_mfma_f32_32x32x16_bf16 v[48:63], v[148:151], v[100:103], v[48:63]
ds_read_b128 v[120:123], v25 offset:40960
ds_read_b128 v[124:127], v25 offset:45056
s_waitcnt lgkmcnt(5)
v_mfma_f32_32x32x16_bf16 v[64:79], v[148:151], v[104:107], v[64:79]
s_add_u32 m0, s67, 49152
s_add_u32 s62, s64, 640
s_and_b32 s62, s62, 0x3ff
buffer_load_dwordx4 v244, s[48:51], s62 offen offset:0 lds
s_waitcnt lgkmcnt(4)
v_mfma_f32_32x32x16_bf16 v[80:95], v[148:151], v[108:111], v[80:95]
s_add_u32 s63, s65, 49152
s_and_b32 s63, s63, 0xffff
buffer_load_dwordx4 v[148:151], v2, s[40:43], s63 offen offset:0 sc1
s_waitcnt vmcnt(35) lgkmcnt(3)
v_mfma_f32_32x32x16_bf16 v[32:47], v[152:155], v[112:115], v[32:47]
ds_read_b128 v[96:99], v26 offset:32768
ds_read_b128 v[100:103], v26 offset:36864
s_waitcnt lgkmcnt(4)
v_mfma_f32_32x32x16_bf16 v[48:63], v[152:155], v[116:119], v[48:63]
ds_read_b128 v[104:107], v26 offset:40960
ds_read_b128 v[108:111], v26 offset:45056
s_waitcnt lgkmcnt(5)
v_mfma_f32_32x32x16_bf16 v[64:79], v[152:155], v[120:123], v[64:79]
buffer_load_dwordx4 v245, s[48:51], s62 offen offset:1024 lds
s_waitcnt lgkmcnt(4)
v_mfma_f32_32x32x16_bf16 v[80:95], v[152:155], v[124:127], v[80:95]
buffer_load_dwordx4 v[152:155], v2, s[40:43], s63 offen offset:1024 sc1
s_waitcnt vmcnt(35) lgkmcnt(3)
v_mfma_f32_32x32x16_bf16 v[32:47], v[156:159], v[96:99], v[32:47]
ds_read_b128 v[112:115], v27 offset:32768
ds_read_b128 v[116:119], v27 offset:36864
s_waitcnt lgkmcnt(4)
v_mfma_f32_32x32x16_bf16 v[48:63], v[156:159], v[100:103], v[48:63]
ds_read_b128 v[120:123], v27 offset:40960
ds_read_b128 v[124:127], v27 offset:45056
s_waitcnt lgkmcnt(5)
v_mfma_f32_32x32x16_bf16 v[64:79], v[156:159], v[104:107], v[64:79]
buffer_load_dwordx4 v246, s[48:51], s62 offen offset:2048 lds
s_waitcnt lgkmcnt(4)
v_mfma_f32_32x32x16_bf16 v[80:95], v[156:159], v[108:111], v[80:95]
buffer_load_dwordx4 v[156:159], v2, s[40:43], s63 offen offset:2048 sc1
s_waitcnt vmcnt(36) lgkmcnt(3)
v_mfma_f32_32x32x16_bf16 v[32:47], v[160:163], v[112:115], v[32:47]
ds_read_b128 v[96:99], v20 offset:0
ds_read_b128 v[100:103], v20 offset:4096
s_waitcnt lgkmcnt(4)
v_mfma_f32_32x32x16_bf16 v[48:63], v[160:163], v[116:119], v[48:63]
ds_read_b128 v[104:107], v20 offset:8192
ds_read_b128 v[108:111], v20 offset:12288
s_waitcnt lgkmcnt(5)
v_mfma_f32_32x32x16_bf16 v[64:79], v[160:163], v[120:123], v[64:79]
buffer_load_dwordx4 v247, s[48:51], s62 offen offset:3072 lds
s_waitcnt lgkmcnt(4)
v_mfma_f32_32x32x16_bf16 v[80:95], v[160:163], v[124:127], v[80:95]
buffer_load_dwordx4 v[160:163], v2, s[40:43], s63 offen offset:3072 sc1
s_waitcnt vmcnt(10) lgkmcnt(3)
v_mov_b32 v14, 8
s_mov_b64 exec, 1
ds_write_b32 v13, v14
s_mov_b64 exec, -1
v_mfma_f32_32x32x16_bf16 v[32:47], v[164:167], v[96:99], v[32:47]
ds_read_b128 v[112:115], v21 offset:0
ds_read_b128 v[116:119], v21 offset:4096
s_waitcnt lgkmcnt(5)
v_mfma_f32_32x32x16_bf16 v[48:63], v[164:167], v[100:103], v[48:63]
ds_read_b128 v[120:123], v21 offset:8192
ds_read_b128 v[124:127], v21 offset:12288
s_waitcnt lgkmcnt(6)
v_mfma_f32_32x32x16_bf16 v[64:79], v[164:167], v[104:107], v[64:79]
s_add_u32 m0, s67, 65536
s_nop 0
buffer_load_dwordx4 v244, s[52:55], s62 offen offset:0 lds
s_waitcnt lgkmcnt(5)
v_mfma_f32_32x32x16_bf16 v[80:95], v[164:167], v[108:111], v[80:95]
s_add_u32 s63, s65, 53248
s_and_b32 s63, s63, 0xffff
buffer_load_dwordx4 v[164:167], v2, s[40:43], s63 offen offset:0 sc1
s_waitcnt vmcnt(37) lgkmcnt(3)
v_mfma_f32_32x32x16_bf16 v[32:47], v[168:171], v[112:115], v[32:47]
ds_read_b128 v[96:99], v22 offset:0
ds_read_b128 v[100:103], v22 offset:4096
s_waitcnt lgkmcnt(4)
v_mfma_f32_32x32x16_bf16 v[48:63], v[168:171], v[116:119], v[48:63]
ds_read_b128 v[104:107], v22 offset:8192
ds_read_b128 v[108:111], v22 offset:12288
s_waitcnt lgkmcnt(5)
v_mfma_f32_32x32x16_bf16 v[64:79], v[168:171], v[120:123], v[64:79]
buffer_load_dwordx4 v245, s[52:55], s62 offen offset:1024 lds
s_waitcnt lgkmcnt(4)
v_mfma_f32_32x32x16_bf16 v[80:95], v[168:171], v[124:127], v[80:95]
buffer_load_dwordx4 v[168:171], v2, s[40:43], s63 offen offset:1024 sc1
s_waitcnt vmcnt(37) lgkmcnt(3)
v_mfma_f32_32x32x16_bf16 v[32:47], v[172:175], v[96:99], v[32:47]
ds_read_b128 v[112:115], v23 offset:0
ds_read_b128 v[116:119], v23 offset:4096
s_waitcnt lgkmcnt(4)
v_mfma_f32_32x32x16_bf16 v[48:63], v[172:175], v[100:103], v[48:63]
ds_read_b128 v[120:123], v23 offset:8192
ds_read_b128 v[124:127], v23 offset:12288
s_waitcnt lgkmcnt(5)
v_mfma_f32_32x32x16_bf16 v[64:79], v[172:175], v[104:107], v[64:79]
buffer_load_dwordx4 v246, s[52:55], s62 offen offset:2048 lds
s_waitcnt lgkmcnt(4)
v_mfma_f32_32x32x16_bf16 v[80:95], v[172:175], v[108:111], v[80:95]
buffer_load_dwordx4 v[172:175], v2, s[40:43], s63 offen offset:2048 sc1
ds_read_b128 v[8:11], v12
s_waitcnt vmcnt(38) lgkmcnt(0)
L_ck70:
v_min3_u32 v15, v8, v9, v10
v_min_u32 v15, v15, v11
s_nop 0
v_readfirstlane_b32 s60, v15
s_nop 0
s_cmp_ge_u32 s60, 8
s_cbranch_scc1 L_ckd71
ds_read_b128 v[8:11], v12 offset:0
s_waitcnt lgkmcnt(0)
s_branch L_ck70
L_ckd71:
v_mfma_f32_32x32x16_bf16 v[32:47], v[176:179], v[112:115], v[32:47]
ds_read_b128 v[96:99], v20 offset:16384
ds_read_b128 v[100:103], v20 offset:20480
v_mfma_f32_32x32x16_bf16 v[48:63], v[176:179], v[116:119], v[48:63]
ds_read_b128 v[104:107], v20 offset:24576
ds_read_b128 v[108:111], v20 offset:28672
v_mfma_f32_32x32x16_bf16 v[64:79], v[176:179], v[120:123], v[64:79]
buffer_load_dwordx4 v247, s[52:55], s62 offen offset:3072 lds
v_mfma_f32_32x32x16_bf16 v[80:95], v[176:179], v[124:127], v[80:95]
buffer_load_dwordx4 v[176:179], v2, s[40:43], s63 offen offset:3072 sc1
s_waitcnt vmcnt(38) lgkmcnt(3)
v_mfma_f32_32x32x16_bf16 v[32:47], v[180:183], v[96:99], v[32:47]
ds_read_b128 v[112:115], v21 offset:16384
ds_read_b128 v[116:119], v21 offset:20480
s_waitcnt lgkmcnt(4)
v_mfma_f32_32x32x16_bf16 v[48:63], v[180:183], v[100:103], v[48:63]
ds_read_b128 v[120:123], v21 offset:24576
ds_read_b128 v[124:127], v21 offset:28672
s_waitcnt lgkmcnt(5)
v_mfma_f32_32x32x16_bf16 v[64:79], v[180:183], v[104:107], v[64:79]
s_add_u32 m0, s67, 81920
s_add_u32 s62, s64, 768
s_and_b32 s62, s62, 0x3ff
buffer_load_dwordx4 v244, s[48:51], s62 offen offset:0 lds
s_waitcnt lgkmcnt(4)
v_mfma_f32_32x32x16_bf16 v[80:95], v[180:183], v[108:111], v[80:95]
s_add_u32 s63, s65, 57344
s_and_b32 s63, s63, 0xffff
buffer_load_dwordx4 v[180:183], v2, s[40:43], s63 offen offset:0 sc1
s_waitcnt vmcnt(39) lgkmcnt(3)
v_mfma_f32_32x32x16_bf16 v[32:47], v[184:187], v[112:115], v[32:47]
ds_read_b128 v[96:99], v22 offset:16384
ds_read_b128 v[100:103], v22 offset:20480
s_waitcnt lgkmcnt(4)
v_mfma_f32_32x32x16_bf16 v[48:63], v[184:187], v[116:119], v[48:63]
ds_read_b128 v[104:107], v22 offset:24576
ds_read_b128 v[108:111], v22 offset:28672
s_waitcnt lgkmcnt(5)
v_mfma_f32_32x32x16_bf16 v[64:79], v[184:187], v[120:123], v[64:79]
buffer_load_dwordx4 v245, s[48:51], s62 offen offset:1024 lds
s_waitcnt lgkmcnt(4)
v_mfma_f32_32x32x16_bf16 v[80:95], v[184:187], v[124:127], v[80:95]
buffer_load_dwordx4 v[184:187], v2, s[40:43], s63 offen offset:1024 sc1
s_waitcnt vmcnt(39) lgkmcnt(3)
v_mfma_f32_32x32x16_bf16 v[32:47], v[188:191], v[96:99], v[32:47]
ds_read_b128 v[112:115], v23 offset:16384
ds_read_b128 v[116:119], v23 offset:20480
s_waitcnt lgkmcnt(4)
v_mfma_f32_32x32x16_bf16 v[48:63], v[188:191], v[100:103], v[48:63]
ds_read_b128 v[120:123], v23 offset:24576
ds_read_b128 v[124:127], v23 offset:28672
s_waitcnt lgkmcnt(5)
v_mfma_f32_32x32x16_bf16 v[64:79], v[188:191], v[104:107], v[64:79]
buffer_load_dwordx4 v246, s[48:51], s62 offen offset:2048 lds
s_waitcnt lgkmcnt(4)
v_mfma_f32_32x32x16_bf16 v[80:95], v[188:191], v[108:111], v[80:95]
buffer_load_dwordx4 v[188:191], v2, s[40:43], s63 offen offset:2048 sc1
s_waitcnt vmcnt(40) lgkmcnt(3)
v_mfma_f32_32x32x16_bf16 v[32:47], v[192:195], v[112:115], v[32:47]
ds_read_b128 v[96:99], v20 offset:32768
ds_read_b128 v[100:103], v20 offset:36864
s_waitcnt lgkmcnt(4)
v_mfma_f32_32x32x16_bf16 v[48:63], v[192:195], v[116:119], v[48:63]
ds_read_b128 v[104:107], v20 offset:40960
ds_read_b128 v[108:111], v20 offset:45056
s_waitcnt lgkmcnt(5)
v_mfma_f32_32x32x16_bf16 v[64:79], v[192:195], v[120:123], v[64:79]
buffer_load_dwordx4 v247, s[48:51], s62 offen offset:3072 lds
s_waitcnt lgkmcnt(4)
v_mfma_f32_32x32x16_bf16 v[80:95], v[192:195], v[124:127], v[80:95]
buffer_load_dwordx4 v[192:195], v2, s[40:43], s63 offen offset:3072 sc1
s_waitcnt vmcnt(9) lgkmcnt(3)
v_mov_b32 v14, 9
s_mov_b64 exec, 1
ds_write_b32 v13, v14
s_mov_b64 exec, -1
v_mfma_f32_32x32x16_bf16 v[32:47], v[196:199], v[96:99], v[32:47]
ds_read_b128 v[112:115], v21 offset:32768
ds_read_b128 v[116:119], v21 offset:36864
s_waitcnt lgkmcnt(5)
v_mfma_f32_32x32x16_bf16 v[48:63], v[196:199], v[100:103], v[48:63]
ds_read_b128 v[120:123], v21 offset:40960
ds_read_b128 v[124:127], v21 offset:45056
s_waitcnt lgkmcnt(6)
v_mfma_f32_32x32x16_bf16 v[64:79], v[196:199], v[104:107], v[64:79]
s_add_u32 m0, s67, 98304
s_nop 0
buffer_load_dwordx4 v244, s[52:55], s62 offen offset:0 lds
s_waitcnt lgkmcnt(5)
v_mfma_f32_32x32x16_bf16 v[80:95], v[196:199], v[108:111], v[80:95]
s_add_u32 s63, s65, 61440
s_and_b32 s63, s63, 0xffff
buffer_load_dwordx4 v[196:199], v2, s[40:43], s63 offen offset:0 sc1
s_waitcnt vmcnt(41) lgkmcnt(3)
v_mfma_f32_32x32x16_bf16 v[32:47], v[200:203], v[112:115], v[32:47]
ds_read_b128 v[96:99], v22 offset:32768
ds_read_b128 v[100:103], v22 offset:36864
s_waitcnt lgkmcnt(4)
v_mfma_f32_32x32x16_bf16 v[48:63], v[200:203], v[116:119], v[48:63]
ds_read_b128 v[104:107], v22 offset:40960
ds_read_b128 v[108:111], v22 offset:45056
s_waitcnt lgkmcnt(5)
v_mfma_f32_32x32x16_bf16 v[64:79], v[200:203], v[120:123], v[64:79]
buffer_load_dwordx4 v245, s[52:55], s62 offen offset:1024 lds
s_waitcnt lgkmcnt(4)
v_mfma_f32_32x32x16_bf16 v[80:95], v[200:203], v[124:127], v[80:95]
buffer_load_dwordx4 v[200:203], v2, s[40:43], s63 offen offset:1024 sc1
s_waitcnt vmcnt(41) lgkmcnt(3)
v_mfma_f32_32x32x16_bf16 v[32:47], v[204:207], v[96:99], v[32:47]
ds_read_b128 v[112:115], v23 offset:32768
ds_read_b128 v[116:119], v23 offset:36864
s_waitcnt lgkmcnt(4)
v_mfma_f32_32x32x16_bf16 v[48:63], v[204:207], v[100:103], v[48:63]
ds_read_b128 v[120:123], v23 offset:40960
ds_read_b128 v[124:127], v23 offset:45056
s_waitcnt lgkmcnt(5)
v_mfma_f32_32x32x16_bf16 v[64:79], v[204:207], v[104:107], v[64:79]
buffer_load_dwordx4 v246, s[52:55], s62 offen offset:2048 lds
s_waitcnt lgkmcnt(4)
v_mfma_f32_32x32x16_bf16 v[80:95], v[204:207], v[108:111], v[80:95]
buffer_load_dwordx4 v[204:207], v2, s[40:43], s63 offen offset:2048 sc1
ds_read_b128 v[8:11], v12
s_waitcnt vmcnt(42) lgkmcnt(0)
L_ck72:
v_min3_u32 v15, v8, v9, v10
v_min_u32 v15, v15, v11
s_nop 0
v_readfirstlane_b32 s60, v15
s_nop 0
s_cmp_ge_u32 s60, 9
s_cbranch_scc1 L_ckd73
ds_read_b128 v[8:11], v12 offset:0
s_waitcnt lgkmcnt(0)
s_branch L_ck72
L_ckd73:
v_mfma_f32_32x32x16_bf16 v[32:47], v[208:211], v[112:115], v[32:47]
ds_read_b128 v[96:99], v20 offset:49152
ds_read_b128 v[100:103], v20 offset:53248
v_mfma_f32_32x32x16_bf16 v[48:63], v[208:211], v[116:119], v[48:63]
ds_read_b128 v[104:107], v20 offset:57344
ds_read_b128 v[108:111], v20 offset:61440
v_mfma_f32_32x32x16_bf16 v[64:79], v[208:211], v[120:123], v[64:79]
buffer_load_dwordx4 v247, s[52:55], s62 offen offset:3072 lds
v_mfma_f32_32x32x16_bf16 v[80:95], v[208:211], v[124:127], v[80:95]
buffer_load_dwordx4 v[208:211], v2, s[40:43], s63 offen offset:3072 sc1
s_waitcnt vmcnt(42) lgkmcnt(3)
v_mfma_f32_32x32x16_bf16 v[32:47], v[212:215], v[96:99], v[32:47]
ds_read_b128 v[112:115], v21 offset:49152
ds_read_b128 v[116:119], v21 offset:53248
s_waitcnt lgkmcnt(4)
v_mfma_f32_32x32x16_bf16 v[48:63], v[212:215], v[100:103], v[48:63]
ds_read_b128 v[120:123], v21 offset:57344
ds_read_b128 v[124:127], v21 offset:61440
s_waitcnt lgkmcnt(5)
v_mfma_f32_32x32x16_bf16 v[64:79], v[212:215], v[104:107], v[64:79]
s_add_u32 m0, s67, 0
s_add_u32 s62, s64, 896
s_and_b32 s62, s62, 0x3ff
buffer_load_dwordx4 v244, s[48:51], s62 offen offset:0 lds
s_waitcnt lgkmcnt(4)
v_mfma_f32_32x32x16_bf16 v[80:95], v[212:215], v[108:111], v[80:95]
s_waitcnt vmcnt(42) lgkmcnt(3)
v_mfma_f32_32x32x16_bf16 v[32:47], v[216:219], v[112:115], v[32:47]
ds_read_b128 v[96:99], v22 offset:49152
ds_read_b128 v[100:103], v22 offset:53248
s_waitcnt lgkmcnt(4)
v_mfma_f32_32x32x16_bf16 v[48:63], v[216:219], v[116:119], v[48:63]
ds_read_b128 v[104:107], v22 offset:57344
ds_read_b128 v[108:111], v22 offset:61440
s_waitcnt lgkmcnt(5)
v_mfma_f32_32x32x16_bf16 v[64:79], v[216:219], v[120:123], v[64:79]
buffer_load_dwordx4 v245, s[48:51], s62 offen offset:1024 lds
s_waitcnt lgkmcnt(4)
v_mfma_f32_32x32x16_bf16 v[80:95], v[216:219], v[124:127], v[80:95]
s_waitcnt vmcnt(41) lgkmcnt(3)
v_mfma_f32_32x32x16_bf16 v[32:47], v[220:223], v[96:99], v[32:47]
ds_read_b128 v[112:115], v23 offset:49152
ds_read_b128 v[116:119], v23 offset:53248
s_waitcnt lgkmcnt(4)
v_mfma_f32_32x32x16_bf16 v[48:63], v[220:223], v[100:103], v[48:63]
ds_read_b128 v[120:123], v23 offset:57344
ds_read_b128 v[124:127], v23 offset:61440
s_waitcnt lgkmcnt(5)
v_mfma_f32_32x32x16_bf16 v[64:79], v[220:223], v[104:107], v[64:79]
buffer_load_dwordx4 v246, s[48:51], s62 offen offset:2048 lds
s_waitcnt lgkmcnt(4)
v_mfma_f32_32x32x16_bf16 v[80:95], v[220:223], v[108:111], v[80:95]
s_waitcnt vmcnt(41) lgkmcnt(3)
v_mfma_f32_32x32x16_bf16 v[32:47], v[224:227], v[112:115], v[32:47]
ds_read_b128 v[96:99], v24 offset:0
ds_read_b128 v[100:103], v24 offset:4096
s_waitcnt lgkmcnt(4)
v_mfma_f32_32x32x16_bf16 v[48:63], v[224:227], v[116:119], v[48:63]
ds_read_b128 v[104:107], v24 offset:8192
ds_read_b128 v[108:111], v24 offset:12288
s_waitcnt lgkmcnt(5)
v_mfma_f32_32x32x16_bf16 v[64:79], v[224:227], v[120:123], v[64:79]
buffer_load_dwordx4 v247, s[48:51], s62 offen offset:3072 lds
s_waitcnt lgkmcnt(4)
v_mfma_f32_32x32x16_bf16 v[80:95], v[224:227], v[124:127], v[80:95]
s_waitcnt vmcnt(5) lgkmcnt(3)
v_mov_b32 v14, 10
s_mov_b64 exec, 1
ds_write_b32 v13, v14
s_mov_b64 exec, -1
v_mfma_f32_32x32x16_bf16 v[32:47], v[228:231], v[96:99], v[32:47]
ds_read_b128 v[112:115], v25 offset:0
ds_read_b128 v[116:119], v25 offset:4096
s_waitcnt lgkmcnt(5)
v_mfma_f32_32x32x16_bf16 v[48:63], v[228:231], v[100:103], v[48:63]
ds_read_b128 v[120:123], v25 offset:8192
ds_read_b128 v[124:127], v25 offset:12288
s_waitcnt lgkmcnt(6)
v_mfma_f32_32x32x16_bf16 v[64:79], v[228:231], v[104:107], v[64:79]
s_add_u32 m0, s67, 16384
s_nop 0
buffer_load_dwordx4 v244, s[52:55], s62 offen offset:0 lds
s_waitcnt lgkmcnt(5)
v_mfma_f32_32x32x16_bf16 v[80:95], v[228:231], v[108:111], v[80:95]
s_waitcnt vmcnt(40) lgkmcnt(3)
v_mfma_f32_32x32x16_bf16 v[32:47], v[232:235], v[112:115], v[32:47]
ds_read_b128 v[96:99], v26 offset:0
ds_read_b128 v[100:103], v26 offset:4096
s_waitcnt lgkmcnt(4)
v_mfma_f32_32x32x16_bf16 v[48:63], v[232:235], v[116:119], v[48:63]
ds_read_b128 v[104:107], v26 offset:8192
ds_read_b128 v[108:111], v26 offset:12288
s_waitcnt lgkmcnt(5)
v_mfma_f32_32x32x16_bf16 v[64:79], v[232:235], v[120:123], v[64:79]
buffer_load_dwordx4 v245, s[52:55], s62 offen offset:1024 lds
s_waitcnt lgkmcnt(4)
v_mfma_f32_32x32x16_bf16 v[80:95], v[232:235], v[124:127], v[80:95]
s_waitcnt vmcnt(39) lgkmcnt(3)
v_mfma_f32_32x32x16_bf16 v[32:47], v[236:239], v[96:99], v[32:47]
ds_read_b128 v[112:115], v27 offset:0
ds_read_b128 v[116:119], v27 offset:4096
s_waitcnt lgkmcnt(4)
v_mfma_f32_32x32x16_bf16 v[48:63], v[236:239], v[100:103], v[48:63]
ds_read_b128 v[120:123], v27 offset:8192
ds_read_b128 v[124:127], v27 offset:12288
s_waitcnt lgkmcnt(5)
v_mfma_f32_32x32x16_bf16 v[64:79], v[236:239], v[104:107], v[64:79]
buffer_load_dwordx4 v246, s[52:55], s62 offen offset:2048 lds
s_waitcnt lgkmcnt(4)
v_mfma_f32_32x32x16_bf16 v[80:95], v[236:239], v[108:111], v[80:95]
ds_read_b128 v[8:11], v12
global_load_dword v31, v30, s[26:27]
s_waitcnt vmcnt(40) lgkmcnt(0)
L_ck74:
v_min3_u32 v15, v8, v9, v10
v_min_u32 v15, v15, v11
s_nop 0
v_readfirstlane_b32 s60, v15
s_nop 0
s_cmp_ge_u32 s60, 10
s_cbranch_scc1 L_ckd75
ds_read_b128 v[8:11], v12 offset:0
s_waitcnt lgkmcnt(0)
s_branch L_ck74
L_ckd75:
v_mfma_f32_32x32x16_bf16 v[32:47], v[240:243], v[112:115], v[32:47]
ds_read_b128 v[96:99], v24 offset:16384
ds_read_b128 v[100:103], v24 offset:20480
v_mfma_f32_32x32x16_bf16 v[48:63], v[240:243], v[116:119], v[48:63]
ds_read_b128 v[104:107], v24 offset:24576
ds_read_b128 v[108:111], v24 offset:28672
v_mfma_f32_32x32x16_bf16 v[64:79], v[240:243], v[120:123], v[64:79]
buffer_load_dwordx4 v247, s[52:55], s62 offen offset:3072 lds
v_mfma_f32_32x32x16_bf16 v[80:95], v[240:243], v[124:127], v[80:95]
s_mov_b32 s60, 0
buffer_load_dword v128, v28, s[56:59], s60 offen offset:0
s_waitcnt vmcnt(40) lgkmcnt(3)
v_mfma_f32_32x32x16_bf16 v[32:47], v[148:151], v[96:99], v[32:47]
ds_read_b128 v[112:115], v25 offset:16384
ds_read_b128 v[116:119], v25 offset:20480
s_waitcnt lgkmcnt(4)
v_mfma_f32_32x32x16_bf16 v[48:63], v[148:151], v[100:103], v[48:63]
ds_read_b128 v[120:123], v25 offset:24576
ds_read_b128 v[124:127], v25 offset:28672
s_waitcnt lgkmcnt(5)
v_mfma_f32_32x32x16_bf16 v[64:79], v[148:151], v[104:107], v[64:79]
s_waitcnt lgkmcnt(4)
v_mfma_f32_32x32x16_bf16 v[80:95], v[148:151], v[108:111], v[80:95]
s_mov_b32 s60, 0
buffer_load_dword v129, v28, s[56:59], s60 offen offset:2048
s_waitcnt vmcnt(39) lgkmcnt(3)
v_mfma_f32_32x32x16_bf16 v[32:47], v[152:155], v[112:115], v[32:47]
ds_read_b128 v[96:99], v26 offset:16384
ds_read_b128 v[100:103], v26 offset:20480
s_waitcnt lgkmcnt(4)
v_mfma_f32_32x32x16_bf16 v[48:63], v[152:155], v[116:119], v[48:63]
ds_read_b128 v[104:107], v26 offset:24576
ds_read_b128 v[108:111], v26 offset:28672
s_waitcnt lgkmcnt(5)
v_mfma_f32_32x32x16_bf16 v[64:79], v[152:155], v[120:123], v[64:79]
s_waitcnt lgkmcnt(4)
v_mfma_f32_32x32x16_bf16 v[80:95], v[152:155], v[124:127], v[80:95]
s_mov_b32 s60, 4096
buffer_load_dword v130, v28, s[56:59], s60 offen offset:0
s_waitcnt vmcnt(38) lgkmcnt(3)
v_mfma_f32_32x32x16_bf16 v[32:47], v[156:159], v[96:99], v[32:47]
ds_read_b128 v[112:115], v27 offset:16384
ds_read_b128 v[116:119], v27 offset:20480
s_waitcnt lgkmcnt(4)
v_mfma_f32_32x32x16_bf16 v[48:63], v[156:159], v[100:103], v[48:63]
ds_read_b128 v[120:123], v27 offset:24576
ds_read_b128 v[124:127], v27 offset:28672
s_waitcnt lgkmcnt(5)
v_mfma_f32_32x32x16_bf16 v[64:79], v[156:159], v[104:107], v[64:79]
s_waitcnt lgkmcnt(4)
v_mfma_f32_32x32x16_bf16 v[80:95], v[156:159], v[108:111], v[80:95]
s_mov_b32 s60, 4096
buffer_load_dword v131, v28, s[56:59], s60 offen offset:2048
s_waitcnt vmcnt(37) lgkmcnt(3)
v_mfma_f32_32x32x16_bf16 v[32:47], v[160:163], v[112:115], v[32:47]
ds_read_b128 v[96:99], v24 offset:32768
ds_read_b128 v[100:103], v24 offset:36864
s_waitcnt lgkmcnt(4)
v_mfma_f32_32x32x16_bf16 v[48:63], v[160:163], v[116:119], v[48:63]
s_waitcnt lgkmcnt(3)
v_mfma_f32_32x32x16_bf16 v[64:79], v[160:163], v[120:123], v[64:79]
s_waitcnt lgkmcnt(2)
v_mfma_f32_32x32x16_bf16 v[80:95], v[160:163], v[124:127], v[80:95]
s_mov_b32 s60, 65536
buffer_load_dword v132, v28, s[56:59], s60 offen offset:0
s_waitcnt vmcnt(5) lgkmcnt(1)
v_mov_b32 v14, 11
s_mov_b64 exec, 1
ds_write_b32 v13, v14
s_mov_b64 exec, -1
v_mfma_f32_32x32x16_bf16 v[32:47], v[164:167], v[96:99], v[32:47]
ds_read_b128 v[112:115], v25 offset:32768
ds_read_b128 v[116:119], v25 offset:36864
s_waitcnt lgkmcnt(3)
v_mfma_f32_32x32x16_bf16 v[48:63], v[164:167], v[100:103], v[48:63]
s_mov_b32 s60, 65536
buffer_load_dword v133, v28, s[56:59], s60 offen offset:2048
s_waitcnt vmcnt(35) lgkmcnt(1)
v_mfma_f32_32x32x16_bf16 v[32:47], v[168:171], v[112:115], v[32:47]
ds_read_b128 v[96:99], v26 offset:32768
ds_read_b128 v[100:103], v26 offset:36864
s_waitcnt lgkmcnt(2)
v_mfma_f32_32x32x16_bf16 v[48:63], v[168:171], v[116:119], v[48:63]
s_mov_b32 s60, 69632
buffer_load_dword v134, v28, s[56:59], s60 offen offset:0
s_waitcnt vmcnt(34) lgkmcnt(1)
v_mfma_f32_32x32x16_bf16 v[32:47], v[172:175], v[96:99], v[32:47]
ds_read_b128 v[112:115], v27 offset:32768
ds_read_b128 v[116:119], v27 offset:36864
s_waitcnt lgkmcnt(2)
v_mfma_f32_32x32x16_bf16 v[48:63], v[172:175], v[100:103], v[48:63]
ds_read_b128 v[8:11], v12
s_mov_b32 s60, 69632
buffer_load_dword v135, v28, s[56:59], s60 offen offset:2048
s_waitcnt vmcnt(33) lgkmcnt(0)
L_ck76:
v_min3_u32 v15, v8, v9, v10
v_min_u32 v15, v15, v11
s_nop 0
v_readfirstlane_b32 s60, v15
s_nop 0
s_cmp_ge_u32 s60, 11
s_cbranch_scc1 L_ckd77
ds_read_b128 v[8:11], v12 offset:0
s_waitcnt lgkmcnt(0)
s_branch L_ck76
L_ckd77:
v_mfma_f32_32x32x16_bf16 v[32:47], v[176:179], v[112:115], v[32:47]
ds_read_b128 v[96:99], v20 offset:0
ds_read_b128 v[100:103], v20 offset:4096
v_mfma_f32_32x32x16_bf16 v[48:63], v[176:179], v[116:119], v[48:63]
s_mov_b32 s60, 8192
buffer_load_dword v136, v28, s[56:59], s60 offen offset:0
s_waitcnt vmcnt(32) lgkmcnt(1)
v_mfma_f32_32x32x16_bf16 v[32:47], v[180:183], v[96:99], v[32:47]
ds_read_b128 v[112:115], v21 offset:0
ds_read_b128 v[116:119], v21 offset:4096
s_waitcnt lgkmcnt(2)
v_mfma_f32_32x32x16_bf16 v[48:63], v[180:183], v[100:103], v[48:63]
s_mov_b32 s60, 8192
buffer_load_dword v137, v28, s[56:59], s60 offen offset:2048
s_waitcnt vmcnt(31) lgkmcnt(1)
v_mfma_f32_32x32x16_bf16 v[32:47], v[184:187], v[112:115], v[32:47]
ds_read_b128 v[96:99], v22 offset:0
ds_read_b128 v[100:103], v22 offset:4096
s_waitcnt lgkmcnt(2)
v_mfma_f32_32x32x16_bf16 v[48:63], v[184:187], v[116:119], v[48:63]
s_mov_b32 s60, 12288
buffer_load_dword v138, v28, s[56:59], s60 offen offset:0
s_waitcnt vmcnt(30) lgkmcnt(1)
v_mfma_f32_32x32x16_bf16 v[32:47], v[188:191], v[96:99], v[32:47]
ds_read_b128 v[112:115], v23 offset:0
ds_read_b128 v[116:119], v23 offset:4096
s_waitcnt lgkmcnt(2)
v_mfma_f32_32x32x16_bf16 v[48:63], v[188:191], v[100:103], v[48:63]
s_mov_b32 s60, 12288
buffer_load_dword v139, v28, s[56:59], s60 offen offset:2048
s_waitcnt vmcnt(29) lgkmcnt(1)
v_mfma_f32_32x32x16_bf16 v[32:47], v[192:195], v[112:115], v[32:47]
ds_read_b128 v[96:99], v20 offset:16384
ds_read_b128 v[100:103], v20 offset:20480
s_waitcnt lgkmcnt(2)
v_mfma_f32_32x32x16_bf16 v[48:63], v[192:195], v[116:119], v[48:63]
s_mov_b32 s60, 73728
buffer_load_dword v140, v28, s[56:59], s60 offen offset:0
s_waitcnt vmcnt(28) lgkmcnt(1)
v_mfma_f32_32x32x16_bf16 v[32:47], v[196:199], v[96:99], v[32:47]
ds_read_b128 v[112:115], v21 offset:16384
ds_read_b128 v[116:119], v21 offset:20480
s_waitcnt lgkmcnt(2)
v_mfma_f32_32x32x16_bf16 v[48:63], v[196:199], v[100:103], v[48:63]
s_mov_b32 s60, 73728
buffer_load_dword v141, v28, s[56:59], s60 offen offset:2048
s_waitcnt vmcnt(27) lgkmcnt(1)
v_mfma_f32_32x32x16_bf16 v[32:47], v[200:203], v[112:115], v[32:47]
ds_read_b128 v[96:99], v22 offset:16384
ds_read_b128 v[100:103], v22 offset:20480
s_waitcnt lgkmcnt(2)
v_mfma_f32_32x32x16_bf16 v[48:63], v[200:203], v[116:119], v[48:63]
s_mov_b32 s60, 77824
buffer_load_dword v142, v28, s[56:59], s60 offen offset:0
s_waitcnt vmcnt(26) lgkmcnt(1)
v_mfma_f32_32x32x16_bf16 v[32:47], v[204:207], v[96:99], v[32:47]
ds_read_b128 v[112:115], v23 offset:16384
ds_read_b128 v[116:119], v23 offset:20480
s_waitcnt lgkmcnt(2)
v_mfma_f32_32x32x16_bf16 v[48:63], v[204:207], v[100:103], v[48:63]
s_mov_b32 s60, 77824
buffer_load_dword v143, v28, s[56:59], s60 offen offset:2048
s_waitcnt vmcnt(25) lgkmcnt(0)
v_mfma_f32_32x32x16_bf16 v[32:47], v[208:211], v[112:115], v[32:47]
v_mfma_f32_32x32x16_bf16 v[48:63], v[208:211], v[116:119], v[48:63]
s_mul_i32 s60, s37, 0x9e3779b1
s_and_b32 s60, s60, 0xbfff0000
s_or_b32 s60, s60, 0x20000000
s_sub_u32 s61, s37, 1
s_xor_b32 s61, s61, s60
s_cmp_lt_u32 s61, 0x10000
s_cselect_b32 s61, 0x10000, 0
s_xor_b32 s60, s60, s61
s_lshl_b32 s64, s35, 4
s_add_u32 s64, s64, s36
s_lshl_b32 s64, s64, 2
s_add_u32 s64, s64, s34
s_lshl_b32 s64, s64, 13
s_add_u32 s50, s64, 33554432
s_add_u32 s48, s32, s50
s_addc_u32 s49, s33, 0
s_mov_b32 s50, 8192
s_mov_b32 s51, 0x20000
s_xor_b32 s64, s64, 262144
s_add_u32 s54, s64, 33554432
s_add_u32 s52, s32, s54
s_addc_u32 s53, s33, 0
s_mov_b32 s54, 8192
s_mov_b32 s55, 0x20000
s_movk_i32 s64, 0x1000
v_cvt_pk_bf16_f32 v96, v32, v48
v_cvt_pk_bf16_f32 v97, v33, v49
v_cvt_pk_bf16_f32 v98, v34, v50
v_cvt_pk_bf16_f32 v99, v35, s60
buffer_store_dwordx4 v[96:99], v2, s[48:51], 0 offen offset:0 sc1
v_cvt_pk_bf16_f32 v100, v51, v36
v_cvt_pk_bf16_f32 v101, v52, v37
v_cvt_pk_bf16_f32 v102, v53, v38
v_cvt_pk_bf16_f32 v103, v54, s60
buffer_store_dwordx4 v[100:103], v2, s[48:51], 0 offen offset:1024 sc1
v_cvt_pk_bf16_f32 v244, v39, v55
v_cvt_pk_bf16_f32 v245, v40, v56
v_cvt_pk_bf16_f32 v246, v41, v57
v_cvt_pk_bf16_f32 v247, v42, s60
buffer_store_dwordx4 v[244:247], v2, s[48:51], 0 offen offset:2048 sc1
v_cvt_pk_bf16_f32 v248, v58, v43
v_cvt_pk_bf16_f32 v249, v59, v44
v_cvt_pk_bf16_f32 v250, v60, v45
v_cvt_pk_bf16_f32 v251, v61, s60
buffer_store_dwordx4 v[248:251], v2, s[48:51], 0 offen offset:3072 sc1
v_cvt_pk_bf16_f32 v252, v46, v62
v_cvt_pk_bf16_f32 v253, v47, v63
v_cvt_pk_bf16_f32 v254, v63, v63
v_cvt_pk_bf16_f32 v255, v63, s60
buffer_store_dwordx4 v[252:255], v2, s[48:51], s64 offen offset:0 sc1
ds_read_b128 v[104:107], v24 offset:40960
ds_read_b128 v[108:111], v24 offset:45056
ds_read_b128 v[120:123], v25 offset:40960
ds_read_b128 v[124:127], v25 offset:45056
s_waitcnt lgkmcnt(2)
v_mfma_f32_32x32x16_bf16 v[64:79], v[164:167], v[104:107], v[64:79]
v_mfma_f32_32x32x16_bf16 v[80:95], v[164:167], v[108:111], v[80:95]
ds_read_b128 v[104:107], v26 offset:40960
ds_read_b128 v[108:111], v26 offset:45056
s_waitcnt lgkmcnt(2)
v_mfma_f32_32x32x16_bf16 v[64:79], v[168:171], v[120:123], v[64:79]
v_mfma_f32_32x32x16_bf16 v[80:95], v[168:171], v[124:127], v[80:95]
ds_read_b128 v[120:123], v27 offset:40960
ds_read_b128 v[124:127], v27 offset:45056
s_waitcnt lgkmcnt(2)
v_mfma_f32_32x32x16_bf16 v[64:79], v[172:175], v[104:107], v[64:79]
v_mfma_f32_32x32x16_bf16 v[80:95], v[172:175], v[108:111], v[80:95]
ds_read_b128 v[104:107], v20 offset:8192
ds_read_b128 v[108:111], v20 offset:12288
s_waitcnt lgkmcnt(2)
v_mfma_f32_32x32x16_bf16 v[64:79], v[176:179], v[120:123], v[64:79]
v_mfma_f32_32x32x16_bf16 v[80:95], v[176:179], v[124:127], v[80:95]
ds_read_b128 v[120:123], v21 offset:8192
ds_read_b128 v[124:127], v21 offset:12288
s_waitcnt lgkmcnt(2)
v_mfma_f32_32x32x16_bf16 v[64:79], v[180:183], v[104:107], v[64:79]
v_mfma_f32_32x32x16_bf16 v[80:95], v[180:183], v[108:111], v[80:95]
ds_read_b128 v[104:107], v22 offset:8192
ds_read_b128 v[108:111], v22 offset:12288
s_waitcnt lgkmcnt(2)
v_mfma_f32_32x32x16_bf16 v[64:79], v[184:187], v[120:123], v[64:79]
v_mfma_f32_32x32x16_bf16 v[80:95], v[184:187], v[124:127], v[80:95]
ds_read_b128 v[120:123], v23 offset:8192
ds_read_b128 v[124:127], v23 offset:12288
s_waitcnt lgkmcnt(2)
v_mfma_f32_32x32x16_bf16 v[64:79], v[188:191], v[104:107], v[64:79]
v_mfma_f32_32x32x16_bf16 v[80:95], v[188:191], v[108:111], v[80:95]
ds_read_b128 v[104:107], v20 offset:24576
ds_read_b128 v[108:111], v20 offset:28672
s_waitcnt lgkmcnt(2)
v_mfma_f32_32x32x16_bf16 v[64:79], v[192:195], v[120:123], v[64:79]
v_mfma_f32_32x32x16_bf16 v[80:95], v[192:195], v[124:127], v[80:95]
ds_read_b128 v[120:123], v21 offset:24576
ds_read_b128 v[124:127], v21 offset:28672
s_waitcnt lgkmcnt(2)
v_mfma_f32_32x32x16_bf16 v[64:79], v[196:199], v[104:107], v[64:79]
v_mfma_f32_32x32x16_bf16 v[80:95], v[196:199], v[108:111], v[80:95]
ds_read_b128 v[104:107], v22 offset:24576
ds_read_b128 v[108:111], v22 offset:28672
s_waitcnt lgkmcnt(2)
v_mfma_f32_32x32x16_bf16 v[64:79], v[200:203], v[120:123], v[64:79]
v_mfma_f32_32x32x16_bf16 v[80:95], v[200:203], v[124:127], v[80:95]
ds_read_b128 v[120:123], v23 offset:24576
ds_read_b128 v[124:127], v23 offset:28672
s_waitcnt lgkmcnt(2)
v_mfma_f32_32x32x16_bf16 v[64:79], v[204:207], v[104:107], v[64:79]
v_mfma_f32_32x32x16_bf16 v[80:95], v[204:207], v[108:111], v[80:95]
s_waitcnt lgkmcnt(0)
v_mfma_f32_32x32x16_bf16 v[64:79], v[208:211], v[120:123], v[64:79]
v_mfma_f32_32x32x16_bf16 v[80:95], v[208:211], v[124:127], v[80:95]
s_waitcnt vmcnt(5)
v_lshlrev_b32 v8, 16, v31
v_and_b32 v9, 0xffff0000, v31
v_lshlrev_b32 v148, 16, v128
v_and_b32 v149, 0xffff0000, v128
v_pk_mul_f32 v[148:149], v[148:149], v[8:9]
v_cvt_pk_bf16_f32 v10, v148, v149
v_lshlrev_b32 v148, 16, v10
v_and_b32 v149, 0xffff0000, v10
s_nop 1
v_add_f32 v148, v148, v64
v_add_f32 v149, v149, v80
v_lshlrev_b32 v150, 16, v129
v_and_b32 v151, 0xffff0000, v129
v_pk_mul_f32 v[150:151], v[150:151], v[8:9]
v_cvt_pk_bf16_f32 v10, v150, v151
v_lshlrev_b32 v150, 16, v10
v_and_b32 v151, 0xffff0000, v10
v_add_f32 v150, v150, v65
v_add_f32 v151, v151, v81
v_lshlrev_b32 v152, 16, v130
v_and_b32 v153, 0xffff0000, v130
v_pk_mul_f32 v[152:153], v[152:153], v[8:9]
v_cvt_pk_bf16_f32 v10, v152, v153
v_lshlrev_b32 v152, 16, v10
v_and_b32 v153, 0xffff0000, v10
v_add_f32 v152, v152, v66
v_add_f32 v153, v153, v82
v_lshlrev_b32 v154, 16, v131
v_and_b32 v155, 0xffff0000, v131
v_pk_mul_f32 v[154:155], v[154:155], v[8:9]
v_cvt_pk_bf16_f32 v10, v154, v155
v_lshlrev_b32 v154, 16, v10
v_and_b32 v155, 0xffff0000, v10
v_add_f32 v154, v154, v67
v_add_f32 v155, v155, v83
v_lshlrev_b32 v156, 16, v132
v_and_b32 v157, 0xffff0000, v132
v_pk_mul_f32 v[156:157], v[156:157], v[8:9]
v_cvt_pk_bf16_f32 v10, v156, v157
v_lshlrev_b32 v156, 16, v10
v_and_b32 v157, 0xffff0000, v10
v_add_f32 v156, v156, v68
v_add_f32 v157, v157, v84
v_lshlrev_b32 v158, 16, v133
v_and_b32 v159, 0xffff0000, v133
v_pk_mul_f32 v[158:159], v[158:159], v[8:9]
v_cvt_pk_bf16_f32 v10, v158, v159
v_lshlrev_b32 v158, 16, v10
v_and_b32 v159, 0xffff0000, v10
v_add_f32 v158, v158, v69
v_add_f32 v159, v159, v85
v_lshlrev_b32 v160, 16, v134
v_and_b32 v161, 0xffff0000, v134
v_pk_mul_f32 v[160:161], v[160:161], v[8:9]
v_cvt_pk_bf16_f32 v10, v160, v161
v_lshlrev_b32 v160, 16, v10
v_and_b32 v161, 0xffff0000, v10
v_add_f32 v160, v160, v70
v_add_f32 v161, v161, v86
v_lshlrev_b32 v162, 16, v135
v_and_b32 v163, 0xffff0000, v135
v_pk_mul_f32 v[162:163], v[162:163], v[8:9]
v_cvt_pk_bf16_f32 v10, v162, v163
v_lshlrev_b32 v162, 16, v10
v_and_b32 v163, 0xffff0000, v10
v_add_f32 v162, v162, v71
v_add_f32 v163, v163, v87
v_lshlrev_b32 v164, 16, v136
v_and_b32 v165, 0xffff0000, v136
v_pk_mul_f32 v[164:165], v[164:165], v[8:9]
v_cvt_pk_bf16_f32 v10, v164, v165
v_lshlrev_b32 v164, 16, v10
v_and_b32 v165, 0xffff0000, v10
v_add_f32 v164, v164, v72
v_add_f32 v165, v165, v88
v_lshlrev_b32 v166, 16, v137
v_and_b32 v167, 0xffff0000, v137
v_pk_mul_f32 v[166:167], v[166:167], v[8:9]
v_cvt_pk_bf16_f32 v10, v166, v167
v_lshlrev_b32 v166, 16, v10
v_and_b32 v167, 0xffff0000, v10
v_add_f32 v166, v166, v73
v_add_f32 v167, v167, v89
v_lshlrev_b32 v168, 16, v138
v_and_b32 v169, 0xffff0000, v138
v_pk_mul_f32 v[168:169], v[168:169], v[8:9]
v_cvt_pk_bf16_f32 v10, v168, v169
v_lshlrev_b32 v168, 16, v10
v_and_b32 v169, 0xffff0000, v10
v_add_f32 v168, v168, v74
v_add_f32 v169, v169, v90
v_lshlrev_b32 v170, 16, v139
v_and_b32 v171, 0xffff0000, v139
v_pk_mul_f32 v[170:171], v[170:171], v[8:9]
v_cvt_pk_bf16_f32 v10, v170, v171
v_lshlrev_b32 v170, 16, v10
v_and_b32 v171, 0xffff0000, v10
v_add_f32 v170, v170, v75
v_add_f32 v171, v171, v91
v_lshlrev_b32 v172, 16, v140
v_and_b32 v173, 0xffff0000, v140
v_pk_mul_f32 v[172:173], v[172:173], v[8:9]
v_cvt_pk_bf16_f32 v10, v172, v173
v_lshlrev_b32 v172, 16, v10
v_and_b32 v173, 0xffff0000, v10
v_add_f32 v172, v172, v76
v_add_f32 v173, v173, v92
v_lshlrev_b32 v174, 16, v141
v_and_b32 v175, 0xffff0000, v141
v_pk_mul_f32 v[174:175], v[174:175], v[8:9]
v_cvt_pk_bf16_f32 v10, v174, v175
v_lshlrev_b32 v174, 16, v10
v_and_b32 v175, 0xffff0000, v10
v_add_f32 v174, v174, v77
v_add_f32 v175, v175, v93
v_lshlrev_b32 v176, 16, v142
v_and_b32 v177, 0xffff0000, v142
v_pk_mul_f32 v[176:177], v[176:177], v[8:9]
v_cvt_pk_bf16_f32 v10, v176, v177
v_lshlrev_b32 v176, 16, v10
v_and_b32 v177, 0xffff0000, v10
v_add_f32 v176, v176, v78
v_add_f32 v177, v177, v94
v_lshlrev_b32 v178, 16, v143
v_and_b32 v179, 0xffff0000, v143
v_pk_mul_f32 v[178:179], v[178:179], v[8:9]
v_cvt_pk_bf16_f32 v10, v178, v179
v_lshlrev_b32 v178, 16, v10
v_and_b32 v179, 0xffff0000, v10
v_add_f32 v178, v178, v79
v_add_f32 v179, v179, v95
s_mov_b32 s44, s28
s_mov_b32 s45, s29
s_mov_b32 s46, s24
s_mov_b32 s47, 0x20000
s_mov_b32 s92, 0
L_xw80:
s_load_dword s61, s[52:53], 5116 glc
s_add_u32 s92, s92, 1
s_waitcnt lgkmcnt(0)
s_xor_b32 s61, s61, s60
s_cmp_lt_u32 s61, 0x10000
s_cbranch_scc1 L_xwd81
s_cmp_lt_u32 s92, 200000
s_cbranch_scc1 L_xw80
L_xwd81:
s_mov_b32 s92, 0
buffer_load_dwordx4 v[180:183], v2, s[52:55], 0 offen offset:0 sc1
buffer_load_dwordx4 v[184:187], v2, s[52:55], 0 offen offset:1024 sc1
buffer_load_dwordx4 v[188:191], v2, s[52:55], 0 offen offset:2048 sc1
buffer_load_dwordx4 v[192:195], v2, s[52:55], 0 offen offset:3072 sc1
buffer_load_dwordx4 v[196:199], v2, s[52:55], s64 offen offset:0 sc1
L_xl78:
v_mov_b32 v10, 0
s_waitcnt vmcnt(4)
v_bitop3_b32 v10, v10, v183, s60 bitop3:0xf6
s_waitcnt vmcnt(3)
v_bitop3_b32 v10, v10, v187, s60 bitop3:0xf6
s_waitcnt vmcnt(2)
v_bitop3_b32 v10, v10, v191, s60 bitop3:0xf6
s_waitcnt vmcnt(1)
v_bitop3_b32 v10, v10, v195, s60 bitop3:0xf6
s_waitcnt vmcnt(0)
v_bitop3_b32 v10, v10, v199, s60 bitop3:0xf6
v_cmp_lt_u32 vcc, 0xffff, v10
s_nop 0
s_cbranch_vccz L_xd79
s_add_u32 s92, s92, 1
s_cmp_ge_u32 s92, 200000
s_cbranch_scc1 L_xd79
buffer_load_dwordx4 v[180:183], v2, s[52:55], 0 offen offset:0 sc1
buffer_load_dwordx4 v[184:187], v2, s[52:55], 0 offen offset:1024 sc1
buffer_load_dwordx4 v[188:191], v2, s[52:55], 0 offen offset:2048 sc1
buffer_load_dwordx4 v[192:195], v2, s[52:55], 0 offen offset:3072 sc1
buffer_load_dwordx4 v[196:199], v2, s[52:55], s64 offen offset:0 sc1
s_branch L_xl78
L_xd79:
v_lshlrev_b32 v10, 16, v180
v_and_b32 v11, 0xffff0000, v180
v_pk_add_f32 v[148:149], v[148:149], v[10:11]
s_mov_b32 s64, 0
buffer_store_dwordx2 v[148:149], v29, s[44:47], s64 offen nt
v_lshlrev_b32 v10, 16, v181
v_and_b32 v11, 0xffff0000, v181
v_pk_add_f32 v[150:151], v[150:151], v[10:11]
s_mov_b32 s64, 8192
buffer_store_dwordx2 v[150:151], v29, s[44:47], s64 offen nt
v_lshlrev_b32 v10, 16, v182
v_and_b32 v11, 0xffff0000, v182
v_pk_add_f32 v[152:153], v[152:153], v[10:11]
s_mov_b32 s64, 16384
buffer_store_dwordx2 v[152:153], v29, s[44:47], s64 offen nt
v_lshlrev_b32 v10, 16, v183
v_lshlrev_b32 v11, 16, v184
v_pk_add_f32 v[154:155], v[154:155], v[10:11]
s_mov_b32 s64, 24576
buffer_store_dwordx2 v[154:155], v29, s[44:47], s64 offen nt
v_and_b32 v10, 0xffff0000, v184
v_lshlrev_b32 v11, 16, v185
v_pk_add_f32 v[156:157], v[156:157], v[10:11]
s_mov_b32 s64, 262144
buffer_store_dwordx2 v[156:157], v29, s[44:47], s64 offen nt
v_and_b32 v10, 0xffff0000, v185
v_lshlrev_b32 v11, 16, v186
v_pk_add_f32 v[158:159], v[158:159], v[10:11]
s_mov_b32 s64, 270336
buffer_store_dwordx2 v[158:159], v29, s[44:47], s64 offen nt
v_and_b32 v10, 0xffff0000, v186
v_lshlrev_b32 v11, 16, v187
v_pk_add_f32 v[160:161], v[160:161], v[10:11]
s_mov_b32 s64, 278528
buffer_store_dwordx2 v[160:161], v29, s[44:47], s64 offen nt
v_lshlrev_b32 v10, 16, v188
v_and_b32 v11, 0xffff0000, v188
v_pk_add_f32 v[162:163], v[162:163], v[10:11]
s_mov_b32 s64, 286720
buffer_store_dwordx2 v[162:163], v29, s[44:47], s64 offen nt
v_lshlrev_b32 v10, 16, v189
v_and_b32 v11, 0xffff0000, v189
v_pk_add_f32 v[164:165], v[164:165], v[10:11]
s_mov_b32 s64, 32768
buffer_store_dwordx2 v[164:165], v29, s[44:47], s64 offen nt
v_lshlrev_b32 v10, 16, v190
v_and_b32 v11, 0xffff0000, v190
v_pk_add_f32 v[166:167], v[166:167], v[10:11]
s_mov_b32 s64, 40960
buffer_store_dwordx2 v[166:167], v29, s[44:47], s64 offen nt
v_lshlrev_b32 v10, 16, v191
v_lshlrev_b32 v11, 16, v192
v_pk_add_f32 v[168:169], v[168:169], v[10:11]
s_mov_b32 s64, 49152
buffer_store_dwordx2 v[168:169], v29, s[44:47], s64 offen nt
v_and_b32 v10, 0xffff0000, v192
v_lshlrev_b32 v11, 16, v193
v_pk_add_f32 v[170:171], v[170:171], v[10:11]
s_mov_b32 s64, 57344
buffer_store_dwordx2 v[170:171], v29, s[44:47], s64 offen nt
v_and_b32 v10, 0xffff0000, v193
v_lshlrev_b32 v11, 16, v194
v_pk_add_f32 v[172:173], v[172:173], v[10:11]
s_mov_b32 s64, 294912
buffer_store_dwordx2 v[172:173], v29, s[44:47], s64 offen nt
v_and_b32 v10, 0xffff0000, v194
v_lshlrev_b32 v11, 16, v195
v_pk_add_f32 v[174:175], v[174:175], v[10:11]
s_mov_b32 s64, 303104
buffer_store_dwordx2 v[174:175], v29, s[44:47], s64 offen nt
v_lshlrev_b32 v10, 16, v196
v_and_b32 v11, 0xffff0000, v196
v_pk_add_f32 v[176:177], v[176:177], v[10:11]
s_mov_b32 s64, 311296
buffer_store_dwordx2 v[176:177], v29, s[44:47], s64 offen nt
v_lshlrev_b32 v10, 16, v197
v_and_b32 v11, 0xffff0000, v197
v_pk_add_f32 v[178:179], v[178:179], v[10:11]
s_mov_b32 s64, 319488
buffer_store_dwordx2 v[178:179], v29, s[44:47], s64 offen nt
L_concat_heads__spectral_gfnet__ssm_conv_s5__prompt_kernel_end:
s_endpgm

.section .rodata,"a"
.p2align 6
.amdhsa_kernel concat_heads__spectral_gfnet__ssm_conv_s5__prompt_kernel
  .amdhsa_next_free_vgpr 256
  .amdhsa_next_free_sgpr 102
  .amdhsa_accum_offset 256
  .amdhsa_group_segment_fixed_size 0
  .amdhsa_kernarg_size 120
  .amdhsa_user_sgpr_count 2
  .amdhsa_user_sgpr_kernarg_segment_ptr 1
  .amdhsa_system_sgpr_workgroup_id_x 1
.end_amdhsa_kernel
.text
```

```asm
; @launch grid=(256,1,1) block=(512,1,1) lds=163840
.amdgcn_target "amdgcn-amd-amdhsa--gfx950"
.text
.globl concat_heads__spectral_gfnet__ssm_conv_s5__prompt_kernel
.p2align 8
.type concat_heads__spectral_gfnet__ssm_conv_s5__prompt_kernel,@function
concat_heads__spectral_gfnet__ssm_conv_s5__prompt_kernel:
s_cmp_ge_u32 s2, 256
s_cbranch_scc1 L_concat_heads__spectral_gfnet__ssm_conv_s5__prompt_kernel_end
s_load_dwordx16 s[4:19], s[0:1], 0
s_load_dwordx8 s[20:27], s[0:1], 64
s_load_dwordx4 s[28:31], s[0:1], 96
s_load_dwordx2 s[32:33], s[0:1], 112
v_lshrrev_b32 v2, 6, v0
v_and_b32 v1, 63, v0
v_readfirstlane_b32 s34, v2
s_and_b32 s60, s2, 7
s_lshr_b32 s61, s2, 3
s_lshr_b32 s35, s60, 1
s_lshl_b32 s35, s35, 2
s_lshr_b32 s62, s61, 3
s_add_u32 s35, s35, s62
s_and_b32 s36, s60, 1
s_lshl_b32 s36, s36, 3
s_and_b32 s62, s61, 7
s_add_u32 s36, s36, s62
s_xor_b32 s34, s34, 4
s_cmp_ge_u32 s34, 4
s_cbranch_scc0 L_concat_heads__spectral_gfnet__ssm_conv_s5__prompt_kernel_gemm
s_sub_u32 s66, s34, 4
s_setprio 0
s_waitcnt lgkmcnt(0)
s_mov_b32 s100, s20
s_mov_b32 s101, s21
s_bitcmp1_b32 s66, 0
s_cselect_b32 s100, s22, s20
s_cselect_b32 s101, s23, s21
s_cmp_lg_u32 s66, 1
s_cbranch_scc1 L_pf1
s_lshr_b32 s60, s2, 3
s_lshl_b32 s60, s60, 11
v_and_b32 v12, 15, v1
v_lshl_add_u32 v12, v12, 7, s60
v_min_u32 v12, L_concat_heads__spectral_gfnet__ssm_conv_s5__prompt_kernel_end-concat_heads__spectral_gfnet__ssm_conv_s5__prompt_kernel, v12
s_getpc_b64 s[60:61]
L_pc2:
s_sub_u32 s60, s60, L_pc2-concat_heads__spectral_gfnet__ssm_conv_s5__prompt_kernel
s_subb_u32 s61, s61, 0
global_load_dword v23, v12, s[60:61]
L_pf1:
s_lshl_b32 s60, s2, 3
s_add_u32 s60, s60, s34
s_cmp_lg_u32 s60, 4
s_cbranch_scc1 L_nn3
s_load_dword s3, s[32:33], 0
v_mov_b32 v22, 0
v_lshlrev_b32 v23, 7, v1
v_add_u32 v23, 4096, v23
global_store_dword v23, v22, s[32:33] sc1
L_nn3:
s_mov_b32 s48, s6
s_mov_b32 s49, s7
s_mov_b32 s50, 2101248
s_mov_b32 s51, 0x20000
s_mov_b32 s52, s8
s_mov_b32 s53, s9
s_mov_b32 s54, 2101248
s_mov_b32 s55, 0x20000
s_and_b32 s60, s2, 31
s_lshr_b32 s61, s2, 5
s_lshl_b32 s61, s61, 7
s_add_u32 s60, s60, s61
s_lshl_b32 s61, s66, 5
s_add_u32 s67, s60, s61
s_lshl_b32 s60, s67, 12
s_add_u32 s4, s4, s60
s_addc_u32 s5, s5, 0
s_mov_b32 s6, 4096
s_mov_b32 s7, 0x20000
v_lshlrev_b32 v2, 4, v1
v_xor_b32 v3, 128, v2
s_lshl_b32 s68, s66, 12
s_add_u32 s68, s68, 131072
s_add_u32 m0, s68, 0
s_mov_b32 s92, 0
buffer_load_dwordx4 v2, s[4:7], s92 offen offset:0 nt lds
buffer_load_dwordx4 v2, s[4:7], s92 offen offset:1024 nt lds
s_add_u32 m0, s68, 2048
s_mov_b32 s92, 2048
buffer_load_dwordx4 v3, s[4:7], s92 offen offset:0 nt lds
buffer_load_dwordx4 v3, s[4:7], s92 offen offset:1024 nt lds
s_and_b32 s60, s2, 7
s_bfe_u32 s61, s2, 0x10003
s_bfe_u32 s62, s2, 0x20004
s_lshr_b32 s63, s2, 6
s_lshr_b32 s64, s60, 1
s_lshl_b32 s64, s64, 3
s_lshl_b32 s65, s61, 2
s_add_u32 s64, s64, s65
s_and_b32 s65, s60, 1
s_lshl_b32 s65, s65, 1
s_add_u32 s64, s64, s65
s_lshl_b32 s64, s64, 5
s_lshl_b32 s65, s62, 3
s_add_u32 s64, s64, s65
s_lshl_b32 s65, s66, 1
s_add_u32 s64, s64, s65
s_mul_i32 s64, s64, 1026
s_lshl_b32 s65, s63, 8
s_add_u32 s69, s64, s65
v_bfe_u32 v8, v1, 4, 1
v_mul_u32_u24 v8, 32832, v8
v_lshrrev_b32 v9, 5, v1
s_mov_b32 s65, 1050624
v_mul_lo_u32 v9, s65, v9
v_add_u32 v8, v8, v9
v_and_b32 v9, 15, v1
s_lshl_b32 s65, s66, 1
v_xor_b32 v9, s65, v9
v_lshl_add_u32 v18, v9, 4, v8
v_xor_b32 v9, 1, v9
v_lshl_add_u32 v19, v9, 4, v8
v_add_u32 v19, 1026, v19
s_bfe_u32 s64, s2, 0x20005
s_lshl_b32 s64, s64, 8
s_bfe_u32 s65, s2, 0x10004
s_lshl_b32 s65, s65, 6
s_add_u32 s64, s64, s65
s_bfe_u32 s65, s2, 0x10003
s_lshl_b32 s65, s65, 7
s_add_u32 s64, s64, s65
s_and_b32 s65, s2, 7
s_lshl_b32 s65, s65, 2
s_add_u32 s64, s64, s65
v_bfe_u32 v8, v1, 3, 2
v_add_u32 v8, s64, v8
v_bfe_u32 v9, v1, 2, 1
v_lshl_add_u32 v8, v9, 5, v8
v_bfe_u32 v9, v1, 1, 1
v_lshl_add_u32 v8, v9, 10, v8
v_sub_u32 v9, 2048, v8
v_and_b32 v9, 2047, v9
v_and_b32 v10, 1, v1
v_cmp_eq_u32 vcc, 1, v10
s_nop 1
v_cndmask_b32 v8, v8, v9, vcc
v_mul_u32_u24 v17, 1026, v8
s_lshr_b32 s64, s2, 7
s_lshl_b32 s64, s64, 10
v_add_u32 v17, s64, v17
s_add_u32 m0, s68, 16384
s_nop 0
buffer_load_dwordx4 v18, s[48:51], s69 offen nt lds
s_add_u32 m0, s68, 17408
s_nop 0
buffer_load_dwordx4 v18, s[52:55], s69 offen nt lds
s_add_u32 m0, s68, 18432
s_nop 0
buffer_load_dwordx4 v19, s[48:51], s69 offen nt lds
s_add_u32 m0, s68, 19456
s_nop 0
buffer_load_dwordx4 v19, s[52:55], s69 offen nt lds
s_cmp_lg_u32 s66, 3
s_cbranch_scc1 L_nw4
s_mov_b32 exec_hi, 0
buffer_load_ushort v88, v17, s[48:51], 0 offen nt
buffer_load_ushort v89, v17, s[52:55], 0 offen nt
s_mov_b64 exec, -1
L_nw4:
s_barrier
v_and_b32 v92, 31, v1
v_cvt_f32_u32 v92, v92
v_lshrrev_b32 v93, 5, v1
v_lshlrev_b32 v93, 2, v93
v_cvt_f32_u32 v93, v93
v_mul_f32 v93, v92, v93
v_mul_f32 v93, 0x3d000000, v93
v_fmamk_f32 v94, v92, 0x0, v93
v_fract_f32 v94, v94
v_cos_f32 v95, v94
v_sin_f32 v96, v94
s_nop 0
v_cvt_pk_bf16_f32 v192, v95, v96
v_cvt_pk_bf16_f32 v208, -v96, v95
v_fmamk_f32 v97, v92, 0x3d000000, v93
v_fract_f32 v97, v97
v_cos_f32 v98, v97
v_sin_f32 v99, v97
s_nop 0
v_cvt_pk_bf16_f32 v193, v98, v99
v_cvt_pk_bf16_f32 v209, -v99, v98
v_fmamk_f32 v94, v92, 0x3d800000, v93
v_fract_f32 v94, v94
v_cos_f32 v95, v94
v_sin_f32 v96, v94
s_nop 0
v_cvt_pk_bf16_f32 v194, v95, v96
v_cvt_pk_bf16_f32 v210, -v96, v95
v_fmamk_f32 v97, v92, 0x3dc00000, v93
v_fract_f32 v97, v97
v_cos_f32 v98, v97
v_sin_f32 v99, v97
s_nop 0
v_cvt_pk_bf16_f32 v195, v98, v99
v_cvt_pk_bf16_f32 v211, -v99, v98
v_fmamk_f32 v94, v92, 0x3e800000, v93
v_fract_f32 v94, v94
v_cos_f32 v95, v94
v_sin_f32 v96, v94
s_nop 0
v_cvt_pk_bf16_f32 v196, v95, v96
v_cvt_pk_bf16_f32 v212, -v96, v95
v_fmamk_f32 v97, v92, 0x3e900000, v93
v_fract_f32 v97, v97
v_cos_f32 v98, v97
v_sin_f32 v99, v97
s_nop 0
v_cvt_pk_bf16_f32 v197, v98, v99
v_cvt_pk_bf16_f32 v213, -v99, v98
v_fmamk_f32 v94, v92, 0x3ea00000, v93
v_fract_f32 v94, v94
v_cos_f32 v95, v94
v_sin_f32 v96, v94
s_nop 0
v_cvt_pk_bf16_f32 v198, v95, v96
v_cvt_pk_bf16_f32 v214, -v96, v95
v_fmamk_f32 v97, v92, 0x3eb00000, v93
v_fract_f32 v97, v97
v_cos_f32 v98, v97
v_sin_f32 v99, v97
s_nop 0
v_cvt_pk_bf16_f32 v199, v98, v99
v_cvt_pk_bf16_f32 v215, -v99, v98
v_fmamk_f32 v94, v92, 0x3f000000, v93
v_fract_f32 v94, v94
v_cos_f32 v95, v94
v_sin_f32 v96, v94
s_nop 0
v_cvt_pk_bf16_f32 v200, v95, v96
v_cvt_pk_bf16_f32 v216, -v96, v95
v_fmamk_f32 v97, v92, 0x3f080000, v93
v_fract_f32 v97, v97
v_cos_f32 v98, v97
v_sin_f32 v99, v97
s_nop 0
v_cvt_pk_bf16_f32 v201, v98, v99
v_cvt_pk_bf16_f32 v217, -v99, v98
v_fmamk_f32 v94, v92, 0x3f100000, v93
v_fract_f32 v94, v94
v_cos_f32 v95, v94
v_sin_f32 v96, v94
s_nop 0
v_cvt_pk_bf16_f32 v202, v95, v96
v_cvt_pk_bf16_f32 v218, -v96, v95
v_fmamk_f32 v97, v92, 0x3f180000, v93
v_fract_f32 v97, v97
v_cos_f32 v98, v97
v_sin_f32 v99, v97
s_nop 0
v_cvt_pk_bf16_f32 v203, v98, v99
v_cvt_pk_bf16_f32 v219, -v99, v98
v_fmamk_f32 v94, v92, 0x3f400000, v93
v_fract_f32 v94, v94
v_cos_f32 v95, v94
v_sin_f32 v96, v94
s_nop 0
v_cvt_pk_bf16_f32 v204, v95, v96
v_cvt_pk_bf16_f32 v220, -v96, v95
v_fmamk_f32 v97, v92, 0x3f480000, v93
v_fract_f32 v97, v97
v_cos_f32 v98, v97
v_sin_f32 v99, v97
s_nop 0
v_cvt_pk_bf16_f32 v205, v98, v99
v_cvt_pk_bf16_f32 v221, -v99, v98
v_fmamk_f32 v94, v92, 0x3f500000, v93
v_fract_f32 v94, v94
v_cos_f32 v95, v94
v_sin_f32 v96, v94
s_nop 0
v_cvt_pk_bf16_f32 v206, v95, v96
v_cvt_pk_bf16_f32 v222, -v96, v95
v_fmamk_f32 v97, v92, 0x3f580000, v93
v_fract_f32 v97, v97
v_cos_f32 v98, v97
v_sin_f32 v99, v97
s_nop 0
v_cvt_pk_bf16_f32 v207, v98, v99
v_cvt_pk_bf16_f32 v223, -v99, v98
v_and_b32 v92, 31, v1
v_cvt_f32_u32 v92, v92
v_lshrrev_b32 v93, 5, v1
v_lshlrev_b32 v93, 2, v93
v_cvt_f32_u32 v93, v93
v_mul_f32 v93, v92, v93
v_mul_f32 v93, 0x3a800000, v93
v_fmamk_f32 v94, v92, 0x0, v93
v_cos_f32 v224, v94
v_sin_f32 v240, -v94
v_fmamk_f32 v95, v92, 0x3a800000, v93
v_cos_f32 v225, v95
v_sin_f32 v241, -v95
v_fmamk_f32 v94, v92, 0x3b000000, v93
v_cos_f32 v226, v94
v_sin_f32 v242, -v94
v_fmamk_f32 v95, v92, 0x3b400000, v93
v_cos_f32 v227, v95
v_sin_f32 v243, -v95
v_fmamk_f32 v94, v92, 0x3c000000, v93
v_cos_f32 v228, v94
v_sin_f32 v244, -v94
v_fmamk_f32 v95, v92, 0x3c100000, v93
v_cos_f32 v229, v95
v_sin_f32 v245, -v95
v_fmamk_f32 v94, v92, 0x3c200000, v93
v_cos_f32 v230, v94
v_sin_f32 v246, -v94
v_fmamk_f32 v95, v92, 0x3c300000, v93
v_cos_f32 v231, v95
v_sin_f32 v247, -v95
v_fmamk_f32 v94, v92, 0x3c800000, v93
v_cos_f32 v232, v94
v_sin_f32 v248, -v94
v_fmamk_f32 v95, v92, 0x3c880000, v93
v_cos_f32 v233, v95
v_sin_f32 v249, -v95
v_fmamk_f32 v94, v92, 0x3c900000, v93
v_cos_f32 v234, v94
v_sin_f32 v250, -v94
v_fmamk_f32 v95, v92, 0x3c980000, v93
v_cos_f32 v235, v95
v_sin_f32 v251, -v95
v_fmamk_f32 v94, v92, 0x3cc00000, v93
v_cos_f32 v236, v94
v_sin_f32 v252, -v94
v_fmamk_f32 v95, v92, 0x3cc80000, v93
v_cos_f32 v237, v95
v_sin_f32 v253, -v95
v_fmamk_f32 v94, v92, 0x3cd00000, v93
v_cos_f32 v238, v94
v_sin_f32 v254, -v94
v_fmamk_f32 v95, v92, 0x3cd80000, v93
v_cos_f32 v239, v95
v_sin_f32 v255, -v95
v_mov_b32 v184, 126992
s_lshl_b32 s64, s66, 2
v_add_u32 v185, s64, v184
v_and_b32 v8, 31, v1
v_lshrrev_b32 v9, 5, v1
v_and_b32 v10, 1, v1
v_lshrrev_b32 v11, 1, v8
v_lshlrev_b32 v4, 6, v11
v_lshl_add_u32 v4, v10, 4, v4
v_lshl_add_u32 v4, v9, 12, v4
v_add_u32 v11, v11, v10
v_lshlrev_b32 v11, 6, v11
v_lshl_add_u32 v11, v10, 4, v11
v_lshl_add_u32 v11, v9, 12, v11
v_sub_u32 v5, 5168, v11
v_bfe_u32 v11, v4, 7, 1
v_lshlrev_b32 v11, 5, v11
v_xor_b32 v4, v4, v11
v_bfe_u32 v11, v5, 7, 1
v_lshlrev_b32 v11, 5, v11
v_xor_b32 v5, v5, v11
v_add_u32 v6, 11264, v5
v_and_b32 v6, 0x3fff, v6
s_add_u32 s64, s64, 98304
v_add_u32 v4, s64, v4
v_add_u32 v5, s64, v5
v_add_u32 v6, s64, v6
v_bfe_u32 v11, v1, 3, 1
v_lshlrev_b32 v11, 5, v11
v_xor_b32 v7, v2, v11
v_bfe_u32 v12, v1, 2, 1
v_mul_u32_u24 v12, 2176, v12
v_bfe_u32 v13, v1, 3, 1
v_lshl_add_u32 v12, v13, 6, v12
v_lshl_add_u32 v12, v9, 8, v12
v_bfe_u32 v13, v1, 4, 1
v_lshl_add_u32 v12, v13, 5, v12
v_and_b32 v13, 3, v1
v_lshl_add_u32 v12, v13, 3, v12
v_add_u32 v12, s68, v12
v_xor_b32 v13, 128, v12
s_lshl_b32 s64, s2, 14
s_lshl_b32 s65, s66, 12
s_add_u32 s64, s64, s65
s_add_u32 s42, s64, 16777216
s_add_u32 s40, s32, s42
s_addc_u32 s41, s33, 0
s_mov_b32 s42, 4096
s_mov_b32 s43, 0x20000
s_add_u32 s46, s64, 16777216
s_add_u32 s44, s32, s46
s_addc_u32 s45, s33, 0
s_mov_b32 s46, 4096
s_mov_b32 s47, 0x20000
v_and_b32 v14, 7, v1
v_lshrrev_b32 v15, 3, v1
v_xor_b32 v16, v14, v15
v_lshlrev_b32 v16, 4, v16
v_lshl_add_u32 v16, v14, 11, v16
s_lshr_b32 s64, s66, 1
s_lshl_b32 s64, s64, 7
s_and_b32 s65, s66, 1
s_lshl_b32 s65, s65, 3
s_add_u32 s64, s64, s65
s_add_u32 s64, s64, 147456
v_add_u32 v16, s64, v16
v_lshlrev_b32 v15, 16, v15
v_lshl_add_u32 v22, v14, 4, v15
s_lshl_b32 s64, s63, 7
s_lshr_b32 s65, s66, 1
s_lshl_b32 s65, s65, 6
s_add_u32 s64, s64, s65
s_and_b32 s65, s66, 1
s_lshl_b32 s65, s65, 2
s_add_u32 s64, s64, s65
s_mul_i32 s64, s64, 8192
s_lshr_b32 s65, s60, 2
s_mul_i32 s65, s65, 0
s_add_u32 s64, s64, s65
s_lshl_b32 s65, s60, 10
s_add_u32 s64, s64, s65
s_lshl_b32 s65, s61, 9
s_add_u32 s64, s64, s65
s_lshl_b32 s65, s62, 7
s_add_u32 s64, s64, s65
s_add_u32 s58, s64, 25182208
s_add_u32 s56, s32, s58
s_addc_u32 s57, s33, 0
s_sub_u32 s58, 4194304, s64
s_mov_b32 s59, 0x20000
s_lshl_b32 s64, s35, 18
s_lshl_b32 s65, s36, 17
s_add_u32 s12, s10, s64
s_addc_u32 s13, s11, 0
s_mov_b32 s14, 262144
s_mov_b32 s15, 0x20000
s_bitcmp1_b32 s66, 0
s_cselect_b32 s8, s18, s16
s_cselect_b32 s9, s19, s17
s_add_u32 s20, s8, s65
s_addc_u32 s21, s9, 0
s_mov_b32 s22, 131072
s_mov_b32 s23, 0x20000
s_mul_i32 s16, s35, 128
s_mul_i32 s64, s36, 128
s_add_u32 s16, s16, s64
s_lshl_b32 s17, s66, 12
s_lshr_b32 s64, s66, 1
s_and_b32 s65, s66, 1
v_lshrrev_b32 v96, 5, v1
v_bfe_u32 v97, v1, 3, 2
v_and_b32 v98, 1, v97
v_lshrrev_b32 v99, 1, v97
v_lshlrev_b32 v100, 4, v96
v_lshl_add_u32 v100, v98, 3, v100
v_add_u32 v100, v100, v99
s_lshl_b32 s92, s64, 6
s_lshl_b32 s19, s65, 2
s_add_u32 s92, s92, s19
v_add_u32 v100, s92, v100
v_lshlrev_b32 v100, 11, v100
s_lshl_b32 s92, s64, 5
v_lshl_add_u32 v101, v96, 3, v97
v_add_u32 v101, s92, v101
v_lshlrev_b32 v101, 11, v101
v_and_b32 v98, 7, v1
v_lshrrev_b32 v99, 4, v1
v_xor_b32 v98, v98, v99
v_lshlrev_b32 v98, 4, v98
v_xor_b32 v99, 64, v98
v_add_u32 v176, v100, v98
v_add_u32 v177, v100, v99
v_add_u32 v177, 64512, v177
v_add_u32 v178, v101, v98
v_add_u32 v179, v101, v99
v_add_u32 v179, 31744, v179
s_lshl_b32 s92, s2, 3
s_add_u32 s92, s92, s34
s_cmp_lg_u32 s92, 4
s_cbranch_scc1 L_nn5
s_waitcnt vmcnt(8) lgkmcnt(0)
s_add_u32 s3, s3, 1
s_cmp_eq_u32 s3, 0
s_cselect_b32 s3, 1, s3
v_mov_b32 v11, s3
v_mov_b32 v10, 0
s_mov_b64 exec, 1
global_store_dword v10, v11, s[30:31] sc1
global_store_dword v10, v11, s[32:33] offset:0
s_mov_b64 exec, -1
L_nn5:
s_waitcnt vmcnt(4)
ds_read_b64_tr_b16 v[24:25], v12 offset:0
ds_read_b64_tr_b16 v[26:27], v13 offset:0
ds_read_b64_tr_b16 v[28:29], v12 offset:512
ds_read_b64_tr_b16 v[30:31], v13 offset:512
ds_read_b64_tr_b16 v[32:33], v12 offset:1024
ds_read_b64_tr_b16 v[34:35], v13 offset:1024
ds_read_b64_tr_b16 v[36:37], v12 offset:1536
ds_read_b64_tr_b16 v[38:39], v13 offset:1536
s_waitcnt lgkmcnt(0)
v_mfma_f32_32x32x16_bf16 v[40:55], v[24:27], v[192:195], 0
v_mfma_f32_32x32x16_bf16 v[40:55], v[28:31], v[196:199], v[40:55]
v_mfma_f32_32x32x16_bf16 v[40:55], v[32:35], v[200:203], v[40:55]
v_mfma_f32_32x32x16_bf16 v[40:55], v[36:39], v[204:207], v[40:55]
v_mfma_f32_32x32x16_bf16 v[56:71], v[24:27], v[208:211], 0
v_mfma_f32_32x32x16_bf16 v[56:71], v[28:31], v[212:215], v[56:71]
v_mfma_f32_32x32x16_bf16 v[56:71], v[32:35], v[216:219], v[56:71]
v_mfma_f32_32x32x16_bf16 v[56:71], v[36:39], v[220:223], v[56:71]
s_nop 7
v_mul_f32 v168, v40, v224
v_mul_f32 v169, v40, v240
s_nop 1
v_fma_f32 v168, -v56, v240, v168
v_fmac_f32 v169, v56, v224
v_cvt_pk_bf16_f32 v72, v168, v169
v_mul_f32 v170, v41, v225
v_mul_f32 v171, v41, v241
v_fma_f32 v170, -v57, v241, v170
v_fmac_f32 v171, v57, v225
v_cvt_pk_bf16_f32 v73, v170, v171
v_mul_f32 v172, v42, v226
v_mul_f32 v173, v42, v242
v_fma_f32 v172, -v58, v242, v172
v_fmac_f32 v173, v58, v226
v_cvt_pk_bf16_f32 v74, v172, v173
v_mul_f32 v174, v43, v227
v_mul_f32 v175, v43, v243
v_fma_f32 v174, -v59, v243, v174
v_fmac_f32 v175, v59, v227
v_cvt_pk_bf16_f32 v75, v174, v175
v_mul_f32 v168, v44, v228
v_mul_f32 v169, v44, v244
v_fma_f32 v168, -v60, v244, v168
v_fmac_f32 v169, v60, v228
v_cvt_pk_bf16_f32 v76, v168, v169
v_mul_f32 v170, v45, v229
v_mul_f32 v171, v45, v245
v_fma_f32 v170, -v61, v245, v170
v_fmac_f32 v171, v61, v229
v_cvt_pk_bf16_f32 v77, v170, v171
v_mul_f32 v172, v46, v230
v_mul_f32 v173, v46, v246
v_fma_f32 v172, -v62, v246, v172
v_fmac_f32 v173, v62, v230
v_cvt_pk_bf16_f32 v78, v172, v173
v_mul_f32 v174, v47, v231
v_mul_f32 v175, v47, v247
v_fma_f32 v174, -v63, v247, v174
v_fmac_f32 v175, v63, v231
v_cvt_pk_bf16_f32 v79, v174, v175
v_mul_f32 v168, v48, v232
v_mul_f32 v169, v48, v248
v_fma_f32 v168, -v64, v248, v168
v_fmac_f32 v169, v64, v232
v_cvt_pk_bf16_f32 v80, v168, v169
v_mul_f32 v170, v49, v233
v_mul_f32 v171, v49, v249
v_fma_f32 v170, -v65, v249, v170
v_fmac_f32 v171, v65, v233
v_cvt_pk_bf16_f32 v81, v170, v171
v_mul_f32 v172, v50, v234
v_mul_f32 v173, v50, v250
v_fma_f32 v172, -v66, v250, v172
v_fmac_f32 v173, v66, v234
v_cvt_pk_bf16_f32 v82, v172, v173
v_mul_f32 v174, v51, v235
v_mul_f32 v175, v51, v251
v_fma_f32 v174, -v67, v251, v174
v_fmac_f32 v175, v67, v235
v_cvt_pk_bf16_f32 v83, v174, v175
v_mul_f32 v168, v52, v236
v_mul_f32 v169, v52, v252
v_fma_f32 v168, -v68, v252, v168
v_fmac_f32 v169, v68, v236
v_cvt_pk_bf16_f32 v84, v168, v169
v_mul_f32 v170, v53, v237
v_mul_f32 v171, v53, v253
v_fma_f32 v170, -v69, v253, v170
v_fmac_f32 v171, v69, v237
v_cvt_pk_bf16_f32 v85, v170, v171
v_mul_f32 v172, v54, v238
v_mul_f32 v173, v54, v254
v_fma_f32 v172, -v70, v254, v172
v_fmac_f32 v173, v70, v238
v_cvt_pk_bf16_f32 v86, v172, v173
v_mul_f32 v174, v55, v239
v_mul_f32 v175, v55, v255
v_fma_f32 v174, -v71, v255, v174
v_fmac_f32 v175, v71, v239
v_cvt_pk_bf16_f32 v87, v174, v175
v_mfma_f32_32x32x16_bf16 v[40:55], v[192:195], v[72:75], 0
v_mfma_f32_32x32x16_bf16 v[40:55], v[196:199], v[76:79], v[40:55]
v_mfma_f32_32x32x16_bf16 v[40:55], v[200:203], v[80:83], v[40:55]
v_mfma_f32_32x32x16_bf16 v[40:55], v[204:207], v[84:87], v[40:55]
v_mfma_f32_32x32x16_bf16 v[56:71], v[208:211], v[72:75], 0
v_mfma_f32_32x32x16_bf16 v[56:71], v[212:215], v[76:79], v[56:71]
v_mfma_f32_32x32x16_bf16 v[56:71], v[216:219], v[80:83], v[56:71]
v_mfma_f32_32x32x16_bf16 v[56:71], v[220:223], v[84:87], v[56:71]
s_lshl_b32 s92, s66, 12
s_add_u32 s92, s92, 98304
v_add_u32 v8, s92, v7
s_nop 8
v_cvt_pk_bf16_f32 v72, v40, v56
ds_write_b32 v4, v72 offset:0
v_cvt_pk_bf16_f32 v73, v41, v57
ds_write_b32 v4, v73 offset:1024
v_cvt_pk_bf16_f32 v74, v42, v58
ds_write_b32 v4, v74 offset:2048
v_cvt_pk_bf16_f32 v75, v43, v59
ds_write_b32 v4, v75 offset:3072
v_cvt_pk_bf16_f32 v76, v44, v60
ds_write_b32 v4, v76 offset:8192
v_cvt_pk_bf16_f32 v77, v45, v61
ds_write_b32 v4, v77 offset:9216
v_cvt_pk_bf16_f32 v78, v46, v62
ds_write_b32 v4, v78 offset:10240
v_cvt_pk_bf16_f32 v79, v47, v63
ds_write_b32 v4, v79 offset:11264
v_cvt_pk_bf16_f32 v80, v48, v64
ds_write_b32 v6, v80 offset:0
v_cvt_pk_bf16_f32 v81, v49, v65
ds_write_b32 v5, v81 offset:10240
v_cvt_pk_bf16_f32 v82, v50, v66
ds_write_b32 v5, v82 offset:9216
v_cvt_pk_bf16_f32 v83, v51, v67
ds_write_b32 v5, v83 offset:8192
v_cvt_pk_bf16_f32 v84, v52, v68
ds_write_b32 v5, v84 offset:3072
v_cvt_pk_bf16_f32 v85, v53, v69
ds_write_b32 v5, v85 offset:2048
v_cvt_pk_bf16_f32 v86, v54, v70
ds_write_b32 v5, v86 offset:1024
v_cvt_pk_bf16_f32 v87, v55, v71
ds_write_b32 v5, v87 offset:0
s_waitcnt vmcnt(0)
s_waitcnt lgkmcnt(0)
v_mov_b32 v190, 1
s_mov_b64 exec, 1
ds_write_b32 v185, v190
s_mov_b64 exec, -1
L_lc6:
ds_read_b128 v[186:189], v184
s_waitcnt lgkmcnt(0)
v_min3_u32 v186, v186, v187, v188
v_min_u32 v186, v186, v189
s_nop 0
v_readfirstlane_b32 s92, v186
s_nop 0
s_cmp_ge_u32 s92, 1
s_cbranch_scc1 L_lcd7
s_sleep 1
s_branch L_lc6
L_lcd7:
ds_read_b128 v[72:75], v8 offset:0
ds_read_b128 v[76:79], v8 offset:1024
ds_read_b128 v[80:83], v8 offset:2048
ds_read_b128 v[84:87], v8 offset:3072
ds_read_b64 v[104:105], v16 offset:0
ds_read_b64 v[106:107], v16 offset:256
ds_read_b64 v[108:109], v16 offset:512
ds_read_b64 v[110:111], v16 offset:768
ds_read_b64 v[112:113], v16 offset:1024
ds_read_b64 v[114:115], v16 offset:1280
ds_read_b64 v[116:117], v16 offset:1536
ds_read_b64 v[118:119], v16 offset:1792
v_add_u32 v4, 32768, v4
v_add_u32 v5, 32768, v5
v_add_u32 v6, 32768, v6
s_waitcnt lgkmcnt(0)
v_mov_b32 v190, 2
s_mov_b64 exec, 1
ds_write_b32 v185, v190
s_mov_b64 exec, -1
s_mov_b32 s64, 0x05040100
s_mov_b32 s65, 0x07060302
v_lshlrev_b32 v88, 16, v88
v_lshlrev_b32 v89, 16, v89
v_lshlrev_b32 v23, 1, v1
v_add_f32_dpp v90, v88, v88 quad_perm:[1,0,3,2] row_mask:0xf bank_mask:0xf
v_subrev_f32_dpp v91, v89, v89 quad_perm:[1,0,3,2] row_mask:0xf bank_mask:0xf
v_mul_f32 v90, 0.5, v90
v_mul_f32 v91, 0.5, v91
v_cvt_pk_bf16_f32 v88, v90, v91
v_perm_b32 v120, v112, v104, s64
v_perm_b32 v121, v116, v108, s64
v_perm_b32 v122, v114, v106, s64
v_perm_b32 v123, v118, v110, s64
v_perm_b32 v124, v112, v104, s65
v_perm_b32 v125, v116, v108, s65
v_perm_b32 v126, v114, v106, s65
v_perm_b32 v127, v118, v110, s65
v_perm_b32 v128, v113, v105, s64
v_perm_b32 v129, v117, v109, s64
v_perm_b32 v130, v115, v107, s64
v_perm_b32 v131, v119, v111, s64
v_perm_b32 v132, v113, v105, s65
v_perm_b32 v133, v117, v109, s65
v_perm_b32 v134, v115, v107, s65
v_perm_b32 v135, v119, v111, s65
v_and_b32 v92, 31, v1
v_cvt_f32_u32 v92, v92
v_lshrrev_b32 v93, 5, v1
v_lshlrev_b32 v93, 2, v93
v_cvt_f32_u32 v93, v93
v_mul_f32 v92, 0x3a000000, v92
v_fmamk_f32 v93, v93, 0x3c800000, v92
v_add_f32 v94, 0x0, v93
v_cos_f32 v136, v94
v_sin_f32 v152, -v94
v_add_f32 v95, 0x3c800000, v93
v_cos_f32 v137, v95
v_sin_f32 v153, -v95
v_add_f32 v94, 0x3d000000, v93
v_cos_f32 v138, v94
v_sin_f32 v154, -v94
v_add_f32 v95, 0x3d400000, v93
v_cos_f32 v139, v95
v_sin_f32 v155, -v95
v_add_f32 v94, 0x3e000000, v93
v_cos_f32 v140, v94
v_sin_f32 v156, -v94
v_add_f32 v95, 0x3e100000, v93
v_cos_f32 v141, v95
v_sin_f32 v157, -v95
v_add_f32 v94, 0x3e200000, v93
v_cos_f32 v142, v94
v_sin_f32 v158, -v94
v_add_f32 v95, 0x3e300000, v93
v_cos_f32 v143, v95
v_sin_f32 v159, -v95
v_add_f32 v94, 0x3e800000, v93
v_cos_f32 v144, v94
v_sin_f32 v160, -v94
v_add_f32 v95, 0x3e880000, v93
v_cos_f32 v145, v95
v_sin_f32 v161, -v95
v_add_f32 v94, 0x3e900000, v93
v_cos_f32 v146, v94
v_sin_f32 v162, -v94
v_add_f32 v95, 0x3e980000, v93
v_cos_f32 v147, v95
v_sin_f32 v163, -v95
v_add_f32 v94, 0x3ec00000, v93
v_cos_f32 v148, v94
v_sin_f32 v164, -v94
v_add_f32 v95, 0x3ec80000, v93
v_cos_f32 v149, v95
v_sin_f32 v165, -v95
v_add_f32 v94, 0x3ed00000, v93
v_cos_f32 v150, v94
v_sin_f32 v166, -v94
v_add_f32 v95, 0x3ed80000, v93
v_cos_f32 v151, v95
v_sin_f32 v167, -v95
s_and_b32 s60, s2, 7
s_lshl_b32 s60, s60, 5
s_lshr_b32 s64, s2, 3
s_add_u32 s60, s60, s64
s_lshr_b32 s64, s66, 1
s_xor_b32 s64, s64, s66
s_and_b32 s64, s64, 1
s_or_b32 s65, s64, s60
s_cmp_eq_u32 s65, 0
s_cselect_b32 s61, 1, 0
s_lshl_b32 s65, s60, 1
s_add_u32 s64, s64, s65
s_mul_i32 s64, s64, 8192
s_add_u32 s64, s64, 25182208
s_lshr_b32 s65, s66, 1
s_mul_i32 s69, s65, 8192
s_add_u32 s69, s69, 25165824
s_cmp_eq_u32 s61, 1
s_cselect_b32 s64, s69, s64
s_cselect_b32 s65, 0, s65
s_cselect_b32 s90, s32, s32
s_cselect_b32 s91, s33, s33
s_lshl_b32 s62, s65, 31
s_or_b32 s63, s62, 0x3f800000
s_add_u32 s48, s90, s64
s_addc_u32 s49, s91, 0
s_mov_b32 s50, 8192
s_mov_b32 s51, 0x20000
s_lshl_b32 s64, s66, 20
s_lshl_b32 s65, s60, 6
s_add_u32 s64, s64, s65
s_add_u32 s54, s64, 16777216
s_add_u32 s52, s32, s54
s_addc_u32 s53, s33, 0
s_sub_u32 s54, 1048576, s65
s_mov_b32 s55, 0x20000
v_lshrrev_b32 v8, 2, v1
v_lshlrev_b32 v8, 14, v8
v_and_b32 v9, 3, v1
v_lshrrev_b32 v10, 4, v1
v_xor_b32 v9, v9, v10
v_lshl_add_u32 v14, v9, 4, v8
v_and_b32 v8, 31, v1
v_bfe_u32 v9, v1, 2, 2
v_xor_b32 v9, s66, v9
v_lshlrev_b32 v9, 4, v9
v_lshl_add_u32 v9, v8, 6, v9
v_lshrrev_b32 v8, 5, v1
v_lshl_add_u32 v9, v8, 11, v9
v_add_u32 v15, 131072, v9
s_lshl_b32 s64, s66, 13
s_add_u32 s64, s64, 131072
v_add_u32 v16, s64, v2
s_xor_b32 s65, s64, 24576
s_cmp_eq_u32 s61, 1
s_cselect_b32 s65, s64, s65
v_add_u32 v17, s65, v2
v_add_u32 v18, s68, v2
s_lshr_b32 s64, s66, 1
s_xor_b32 s64, s64, s66
s_and_b32 s64, s64, 1
s_lshl_b32 s69, s64, 13
s_add_u32 s69, s69, 147456
v_add_u32 v19, s69, v2
v_mul_f32 v136, s63, v136
v_mul_f32 v137, s63, v137
v_mul_f32 v138, s63, v138
v_mul_f32 v139, s63, v139
v_mul_f32 v140, s63, v140
v_mul_f32 v141, s63, v141
v_mul_f32 v142, s63, v142
v_mul_f32 v143, s63, v143
v_mul_f32 v144, s63, v144
v_mul_f32 v145, s63, v145
v_mul_f32 v146, s63, v146
v_mul_f32 v147, s63, v147
v_mul_f32 v148, s63, v148
v_mul_f32 v149, s63, v149
v_mul_f32 v150, s63, v150
v_mul_f32 v151, s63, v151
v_mul_f32 v152, s63, v152
v_mul_f32 v153, s63, v153
v_mul_f32 v154, s63, v154
v_mul_f32 v155, s63, v155
v_mul_f32 v156, s63, v156
v_mul_f32 v157, s63, v157
v_mul_f32 v158, s63, v158
v_mul_f32 v159, s63, v159
v_mul_f32 v160, s63, v160
v_mul_f32 v161, s63, v161
v_mul_f32 v162, s63, v162
v_mul_f32 v163, s63, v163
v_mul_f32 v164, s63, v164
v_mul_f32 v165, s63, v165
v_mul_f32 v166, s63, v166
v_mul_f32 v167, s63, v167
buffer_store_dwordx4 v[72:75], v2, s[40:43], 0 offen offset:0 sc1
buffer_store_dwordx4 v[76:79], v2, s[40:43], 0 offen offset:1024 sc1
buffer_store_dwordx4 v[80:83], v2, s[40:43], 0 offen offset:2048 sc1
buffer_store_dwordx4 v[84:87], v2, s[40:43], 0 offen offset:3072 sc1
s_setprio 3
s_barrier
s_add_u32 s8, s16, 256
s_and_b32 s8, s8, 0x7ff
s_add_u32 s9, s8, 2048
s_add_u32 s10, s8, 6144
s_add_u32 m0, s17, 65536
s_nop 0
buffer_load_dwordx4 v176, s[12:15], s8 offen offset:0 lds
buffer_load_dwordx4 v177, s[12:15], s8 offen offset:1024 lds
buffer_load_dwordx4 v176, s[12:15], s9 offen offset:2048 lds
buffer_load_dwordx4 v177, s[12:15], s9 offen offset:3072 lds
s_add_u32 m0, s17, 81920
s_nop 0
buffer_load_dwordx4 v178, s[20:23], s8 offen offset:0 lds
buffer_load_dwordx4 v179, s[20:23], s8 offen offset:1024 lds
buffer_load_dwordx4 v178, s[20:23], s10 offen offset:2048 lds
buffer_load_dwordx4 v179, s[20:23], s10 offen offset:3072 lds
s_barrier
s_add_u32 s8, s16, 384
s_and_b32 s8, s8, 0x7ff
s_add_u32 s9, s8, 2048
s_add_u32 s10, s8, 6144
s_add_u32 m0, s17, 0
s_nop 0
buffer_load_dwordx4 v176, s[12:15], s8 offen offset:0 lds
buffer_load_dwordx4 v177, s[12:15], s8 offen offset:1024 lds
buffer_load_dwordx4 v176, s[12:15], s9 offen offset:2048 lds
buffer_load_dwordx4 v177, s[12:15], s9 offen offset:3072 lds
s_add_u32 m0, s17, 16384
s_nop 0
buffer_load_dwordx4 v178, s[20:23], s8 offen offset:0 lds
buffer_load_dwordx4 v179, s[20:23], s8 offen offset:1024 lds
buffer_load_dwordx4 v178, s[20:23], s10 offen offset:2048 lds
buffer_load_dwordx4 v179, s[20:23], s10 offen offset:3072 lds
s_waitcnt vmcnt(8)
s_barrier
s_add_u32 s8, s16, 512
s_and_b32 s8, s8, 0x7ff
s_add_u32 s9, s8, 2048
s_add_u32 s10, s8, 6144
s_add_u32 m0, s17, 32768
s_nop 0
buffer_load_dwordx4 v176, s[12:15], s8 offen offset:0 lds
buffer_load_dwordx4 v177, s[12:15], s8 offen offset:1024 lds
buffer_load_dwordx4 v176, s[12:15], s9 offen offset:2048 lds
buffer_load_dwordx4 v177, s[12:15], s9 offen offset:3072 lds
s_add_u32 m0, s17, 49152
s_nop 0
buffer_load_dwordx4 v178, s[20:23], s8 offen offset:0 lds
buffer_load_dwordx4 v179, s[20:23], s8 offen offset:1024 lds
buffer_load_dwordx4 v178, s[20:23], s10 offen offset:2048 lds
buffer_load_dwordx4 v179, s[20:23], s10 offen offset:3072 lds
v_mov_b32 v20, 0
global_load_dword v21, v20, s[30:31] sc1
s_waitcnt vmcnt(9)
s_barrier
s_add_u32 s8, s16, 640
s_and_b32 s8, s8, 0x7ff
s_add_u32 s9, s8, 2048
s_add_u32 s10, s8, 6144
s_add_u32 m0, s17, 65536
s_nop 0
buffer_load_dwordx4 v176, s[12:15], s8 offen offset:0 lds
buffer_load_dwordx4 v177, s[12:15], s8 offen offset:1024 lds
buffer_load_dwordx4 v176, s[12:15], s9 offen offset:2048 lds
buffer_load_dwordx4 v177, s[12:15], s9 offen offset:3072 lds
s_add_u32 m0, s17, 81920
s_nop 0
buffer_load_dwordx4 v178, s[20:23], s8 offen offset:0 lds
buffer_load_dwordx4 v179, s[20:23], s8 offen offset:1024 lds
buffer_load_dwordx4 v178, s[20:23], s10 offen offset:2048 lds
buffer_load_dwordx4 v179, s[20:23], s10 offen offset:3072 lds
s_cmp_lg_u32 s66, 3
s_cbranch_scc1 L_nw8
s_lshr_b32 s64, s2, 7
s_mul_i32 s64, s64, 8192
s_bfe_u32 s65, s2, 0x10006
s_mul_i32 s65, s65, 4096
s_add_u32 s64, s64, s65
s_and_b32 s65, s2, 63
s_lshl_b32 s65, s65, 6
s_add_u32 s64, s64, s65
s_add_u32 s6, s64, 25165824
s_add_u32 s4, s32, s6
s_addc_u32 s5, s33, 0
s_mov_b32 s6, 64
s_mov_b32 s7, 0x20000
s_mov_b32 exec_lo, 0x55555555
s_mov_b32 exec_hi, 0
buffer_store_dword v88, v23, s[4:7], 0 offen sc1
s_mov_b64 exec, -1
L_nw8:
s_mov_b32 s92, 0
buffer_store_dwordx4 v[120:123], v22, s[56:59], s92 offen sc1
s_mov_b32 s92, 8192
buffer_store_dwordx4 v[124:127], v22, s[56:59], s92 offen sc1
s_mov_b32 s92, 16384
buffer_store_dwordx4 v[128:131], v22, s[56:59], s92 offen sc1
s_mov_b32 s92, 24576
buffer_store_dwordx4 v[132:135], v22, s[56:59], s92 offen sc1
s_waitcnt vmcnt(13)
s_barrier
s_add_u32 s8, s16, 768
s_and_b32 s8, s8, 0x7ff
s_add_u32 s9, s8, 2048
s_add_u32 s10, s8, 6144
s_add_u32 m0, s17, 0
s_nop 0
buffer_load_dwordx4 v176, s[12:15], s8 offen offset:0 lds
buffer_load_dwordx4 v177, s[12:15], s8 offen offset:1024 lds
buffer_load_dwordx4 v176, s[12:15], s9 offen offset:2048 lds
buffer_load_dwordx4 v177, s[12:15], s9 offen offset:3072 lds
s_add_u32 m0, s17, 16384
s_nop 0
buffer_load_dwordx4 v178, s[20:23], s8 offen offset:0 lds
buffer_load_dwordx4 v179, s[20:23], s8 offen offset:1024 lds
buffer_load_dwordx4 v178, s[20:23], s10 offen offset:2048 lds
buffer_load_dwordx4 v179, s[20:23], s10 offen offset:3072 lds
s_waitcnt vmcnt(12)
s_barrier
s_add_u32 s8, s16, 896
s_and_b32 s8, s8, 0x7ff
s_add_u32 s9, s8, 2048
s_add_u32 s10, s8, 6144
s_add_u32 m0, s17, 32768
s_nop 0
buffer_load_dwordx4 v176, s[12:15], s8 offen offset:0 lds
buffer_load_dwordx4 v177, s[12:15], s8 offen offset:1024 lds
buffer_load_dwordx4 v176, s[12:15], s9 offen offset:2048 lds
buffer_load_dwordx4 v177, s[12:15], s9 offen offset:3072 lds
s_add_u32 m0, s17, 49152
s_nop 0
buffer_load_dwordx4 v178, s[20:23], s8 offen offset:0 lds
buffer_load_dwordx4 v179, s[20:23], s8 offen offset:1024 lds
buffer_load_dwordx4 v178, s[20:23], s10 offen offset:2048 lds
buffer_load_dwordx4 v179, s[20:23], s10 offen offset:3072 lds
s_waitcnt vmcnt(8)
s_barrier
s_add_u32 s8, s16, 1024
s_and_b32 s8, s8, 0x7ff
s_add_u32 s9, s8, 2048
s_add_u32 s10, s8, 6144
s_add_u32 m0, s17, 65536
s_nop 0
buffer_load_dwordx4 v176, s[12:15], s8 offen offset:0 lds
buffer_load_dwordx4 v177, s[12:15], s8 offen offset:1024 lds
buffer_load_dwordx4 v176, s[12:15], s9 offen offset:2048 lds
buffer_load_dwordx4 v177, s[12:15], s9 offen offset:3072 lds
s_add_u32 m0, s17, 81920
s_nop 0
buffer_load_dwordx4 v178, s[20:23], s8 offen offset:0 lds
buffer_load_dwordx4 v179, s[20:23], s8 offen offset:1024 lds
buffer_load_dwordx4 v178, s[20:23], s10 offen offset:2048 lds
buffer_load_dwordx4 v179, s[20:23], s10 offen offset:3072 lds
v_readfirstlane_b32 s37, v21
s_nop 0
s_cmp_lg_u32 s37, 0
s_cbranch_scc1 L_sg10
v_mov_b32 v20, 0
L_n11:
global_load_dword v21, v20, s[30:31] sc1
s_waitcnt vmcnt(0)
v_readfirstlane_b32 s37, v21
s_nop 0
s_cmp_eq_u32 s37, 0
s_cbranch_scc1 L_n11
L_sg10:
s_cmp_lg_u32 s66, 0
s_cbranch_scc1 L_sg13
s_and_b32 s64, s2, 15
s_lshl_b32 s65, s64, 7
s_add_u32 s65, s65, 4096
s_add_u32 s90, s32, s65
s_addc_u32 s91, s33, 0
s_mov_b32 s18, 1
s_atomic_add s18, s[90:91], 0x0 glc
L_sg13:
s_waitcnt vmcnt(8)
s_barrier
s_add_u32 s8, s16, 1152
s_and_b32 s8, s8, 0x7ff
s_add_u32 s9, s8, 2048
s_add_u32 s10, s8, 6144
s_add_u32 m0, s17, 0
s_nop 0
buffer_load_dwordx4 v176, s[12:15], s8 offen offset:0 lds
buffer_load_dwordx4 v177, s[12:15], s8 offen offset:1024 lds
buffer_load_dwordx4 v176, s[12:15], s9 offen offset:2048 lds
buffer_load_dwordx4 v177, s[12:15], s9 offen offset:3072 lds
s_add_u32 m0, s17, 16384
s_nop 0
buffer_load_dwordx4 v178, s[20:23], s8 offen offset:0 lds
buffer_load_dwordx4 v179, s[20:23], s8 offen offset:1024 lds
buffer_load_dwordx4 v178, s[20:23], s10 offen offset:2048 lds
buffer_load_dwordx4 v179, s[20:23], s10 offen offset:3072 lds
s_waitcnt vmcnt(8)
s_barrier
s_add_u32 s8, s16, 1280
s_and_b32 s8, s8, 0x7ff
s_add_u32 s9, s8, 2048
s_add_u32 s10, s8, 6144
s_add_u32 m0, s17, 32768
s_nop 0
buffer_load_dwordx4 v176, s[12:15], s8 offen offset:0 lds
buffer_load_dwordx4 v177, s[12:15], s8 offen offset:1024 lds
buffer_load_dwordx4 v176, s[12:15], s9 offen offset:2048 lds
buffer_load_dwordx4 v177, s[12:15], s9 offen offset:3072 lds
s_add_u32 m0, s17, 49152
s_nop 0
buffer_load_dwordx4 v178, s[20:23], s8 offen offset:0 lds
buffer_load_dwordx4 v179, s[20:23], s8 offen offset:1024 lds
buffer_load_dwordx4 v178, s[20:23], s10 offen offset:2048 lds
buffer_load_dwordx4 v179, s[20:23], s10 offen offset:3072 lds
s_cmp_lg_u32 s66, 0
s_cbranch_scc1 L_sg14
s_waitcnt lgkmcnt(0)
s_cmp_lg_u32 s18, 15
s_cbranch_scc1 L_sg14
s_and_b32 s64, s2, 15
s_lshl_b32 s64, s64, 2
s_add_u32 s64, s64, 540672
v_lshl_add_u32 v22, v1, 7, s64
v_mov_b32 v23, s37
global_store_dword v22, v23, s[32:33] sc1
L_sg14:
s_waitcnt vmcnt(8)
s_barrier
s_add_u32 s8, s16, 1408
s_and_b32 s8, s8, 0x7ff
s_add_u32 s9, s8, 2048
s_add_u32 s10, s8, 6144
s_add_u32 m0, s17, 65536
s_nop 0
buffer_load_dwordx4 v176, s[12:15], s8 offen offset:0 lds
buffer_load_dwordx4 v177, s[12:15], s8 offen offset:1024 lds
buffer_load_dwordx4 v176, s[12:15], s9 offen offset:2048 lds
buffer_load_dwordx4 v177, s[12:15], s9 offen offset:3072 lds
s_add_u32 m0, s17, 81920
s_nop 0
buffer_load_dwordx4 v178, s[20:23], s8 offen offset:0 lds
buffer_load_dwordx4 v179, s[20:23], s8 offen offset:1024 lds
buffer_load_dwordx4 v178, s[20:23], s10 offen offset:2048 lds
buffer_load_dwordx4 v179, s[20:23], s10 offen offset:3072 lds
s_waitcnt vmcnt(8)
s_barrier
s_add_u32 s8, s16, 1536
s_and_b32 s8, s8, 0x7ff
s_add_u32 s9, s8, 2048
s_add_u32 s10, s8, 6144
s_add_u32 m0, s17, 0
s_nop 0
buffer_load_dwordx4 v176, s[12:15], s8 offen offset:0 lds
buffer_load_dwordx4 v177, s[12:15], s8 offen offset:1024 lds
buffer_load_dwordx4 v176, s[12:15], s9 offen offset:2048 lds
buffer_load_dwordx4 v177, s[12:15], s9 offen offset:3072 lds
s_add_u32 m0, s17, 16384
s_nop 0
buffer_load_dwordx4 v178, s[20:23], s8 offen offset:0 lds
buffer_load_dwordx4 v179, s[20:23], s8 offen offset:1024 lds
buffer_load_dwordx4 v178, s[20:23], s10 offen offset:2048 lds
buffer_load_dwordx4 v179, s[20:23], s10 offen offset:3072 lds
s_waitcnt vmcnt(8)
s_barrier
s_add_u32 s8, s16, 1664
s_and_b32 s8, s8, 0x7ff
s_add_u32 s9, s8, 2048
s_add_u32 s10, s8, 6144
s_add_u32 m0, s17, 32768
s_nop 0
buffer_load_dwordx4 v176, s[12:15], s8 offen offset:0 lds
buffer_load_dwordx4 v177, s[12:15], s8 offen offset:1024 lds
buffer_load_dwordx4 v176, s[12:15], s9 offen offset:2048 lds
buffer_load_dwordx4 v177, s[12:15], s9 offen offset:3072 lds
s_add_u32 m0, s17, 49152
s_nop 0
buffer_load_dwordx4 v178, s[20:23], s8 offen offset:0 lds
buffer_load_dwordx4 v179, s[20:23], s8 offen offset:1024 lds
buffer_load_dwordx4 v178, s[20:23], s10 offen offset:2048 lds
buffer_load_dwordx4 v179, s[20:23], s10 offen offset:3072 lds
s_waitcnt vmcnt(8)
s_barrier
s_add_u32 s8, s16, 1792
s_and_b32 s8, s8, 0x7ff
s_add_u32 s9, s8, 2048
s_add_u32 s10, s8, 6144
s_add_u32 m0, s17, 65536
s_nop 0
buffer_load_dwordx4 v176, s[12:15], s8 offen offset:0 lds
buffer_load_dwordx4 v177, s[12:15], s8 offen offset:1024 lds
buffer_load_dwordx4 v176, s[12:15], s9 offen offset:2048 lds
buffer_load_dwordx4 v177, s[12:15], s9 offen offset:3072 lds
s_add_u32 m0, s17, 81920
s_nop 0
buffer_load_dwordx4 v178, s[20:23], s8 offen offset:0 lds
buffer_load_dwordx4 v179, s[20:23], s8 offen offset:1024 lds
buffer_load_dwordx4 v178, s[20:23], s10 offen offset:2048 lds
buffer_load_dwordx4 v179, s[20:23], s10 offen offset:3072 lds
s_waitcnt vmcnt(8)
s_barrier
s_add_u32 s8, s16, 1920
s_and_b32 s8, s8, 0x7ff
s_add_u32 s9, s8, 2048
s_add_u32 s10, s8, 6144
s_add_u32 m0, s17, 0
s_nop 0
buffer_load_dwordx4 v176, s[12:15], s8 offen offset:0 lds
buffer_load_dwordx4 v177, s[12:15], s8 offen offset:1024 lds
buffer_load_dwordx4 v176, s[12:15], s9 offen offset:2048 lds
buffer_load_dwordx4 v177, s[12:15], s9 offen offset:3072 lds
s_add_u32 m0, s17, 16384
s_nop 0
buffer_load_dwordx4 v178, s[20:23], s8 offen offset:0 lds
buffer_load_dwordx4 v179, s[20:23], s8 offen offset:1024 lds
buffer_load_dwordx4 v178, s[20:23], s10 offen offset:2048 lds
buffer_load_dwordx4 v179, s[20:23], s10 offen offset:3072 lds
s_and_b32 s64, s2, 1
s_lshl_b32 s64, s64, 10
s_bfe_u32 s92, s2, 0x20001
s_lshl_b32 s92, s92, 19
s_add_u32 s64, s64, s92
s_lshr_b32 s92, s2, 3
s_lshl_b32 s92, s92, 14
s_add_u32 s64, s64, s92
s_lshr_b32 s92, s66, 1
s_lshl_b32 s92, s92, 13
s_add_u32 s64, s64, s92
v_bfe_u32 v22, v1, 3, 2
v_lshlrev_b32 v22, 11, v22
v_and_b32 v23, 7, v1
v_lshl_add_u32 v22, v23, 7, v22
v_add_u32 v22, s64, v22
s_mov_b32 exec_hi, 0
global_load_dword v23, v22, s[100:101]
s_mov_b64 exec, -1
s_waitcnt vmcnt(9)
s_barrier
s_waitcnt vmcnt(1)
s_barrier
s_setprio 0
s_cmp_lg_u32 s66, 0
s_cbranch_scc1 L_ph15
s_and_b32 s64, s2, 63
s_lshl_b32 s64, s64, 7
s_add_u32 s64, s64, 540672
s_add_u32 s90, s32, s64
s_addc_u32 s91, s33, 0
s_mov_b32 s64, s37
s_mov_b32 s65, s37
s_mov_b32 s92, 0
s_branch L_sp16
L_nok17:
s_add_u32 s92, s92, 1
s_cmp_ge_u32 s92, 200000
s_cbranch_scc1 L_ph15
s_sleep 10
L_sp16:
s_load_dwordx16 s[4:19], s[90:91], 0x0 glc
s_waitcnt lgkmcnt(0)
s_cmp_eq_u64 s[4:5], s[64:65]
s_cbranch_scc0 L_nok17
s_cmp_eq_u64 s[6:7], s[64:65]
s_cbranch_scc0 L_nok17
s_cmp_eq_u64 s[8:9], s[64:65]
s_cbranch_scc0 L_nok17
s_cmp_eq_u64 s[10:11], s[64:65]
s_cbranch_scc0 L_nok17
s_cmp_eq_u64 s[12:13], s[64:65]
s_cbranch_scc0 L_nok17
s_cmp_eq_u64 s[14:15], s[64:65]
s_cbranch_scc0 L_nok17
s_cmp_eq_u64 s[16:17], s[64:65]
s_cbranch_scc0 L_nok17
s_cmp_eq_u64 s[18:19], s[64:65]
s_cbranch_scc0 L_nok17
L_ph15:
v_mov_b32 v190, 3
s_mov_b64 exec, 1
ds_write_b32 v185, v190
s_mov_b64 exec, -1
L_lc18:
ds_read_b128 v[186:189], v184
s_waitcnt lgkmcnt(0)
v_min3_u32 v186, v186, v187, v188
v_min_u32 v186, v186, v189
s_nop 0
v_readfirstlane_b32 s92, v186
s_nop 0
s_cmp_ge_u32 s92, 3
s_cbranch_scc1 L_lcd19
s_sleep 1
s_branch L_lc18
L_lcd19:
s_setprio 0
s_add_u32 m0, s68, 0
s_mov_b32 s64, 0
buffer_load_dwordx4 v14, s[52:55], s64 offen sc1 lds
s_add_u32 m0, s68, 1024
s_mov_b32 s64, 262144
buffer_load_dwordx4 v14, s[52:55], s64 offen sc1 lds
s_add_u32 m0, s68, 2048
s_mov_b32 s64, 524288
buffer_load_dwordx4 v14, s[52:55], s64 offen sc1 lds
s_add_u32 m0, s68, 3072
s_mov_b32 s64, 786432
buffer_load_dwordx4 v14, s[52:55], s64 offen sc1 lds
s_cmp_eq_u32 s61, 1
s_cbranch_scc1 L_ws20
s_lshr_b32 s64, s66, 1
s_lshl_b32 s65, s64, 12
s_mul_i32 s64, s64, 4096
s_add_u32 m0, s69, s65
s_nop 0
buffer_load_dwordx4 v2, s[48:51], s64 offen offset:0 sc1 lds
buffer_load_dwordx4 v2, s[48:51], s64 offen offset:1024 sc1 lds
buffer_load_dwordx4 v2, s[48:51], s64 offen offset:2048 sc1 lds
buffer_load_dwordx4 v2, s[48:51], s64 offen offset:3072 sc1 lds
s_waitcnt vmcnt(0)
s_branch L_wd21
L_ws20:
s_movk_i32 s64, 4096
buffer_load_dwordx4 v[104:107], v2, s[48:51], 0 offen offset:0 sc1
buffer_load_dwordx4 v[108:111], v2, s[48:51], 0 offen offset:1024 sc1
buffer_load_dwordx4 v[112:115], v2, s[48:51], 0 offen offset:2048 sc1
buffer_load_dwordx4 v[116:119], v2, s[48:51], 0 offen offset:3072 sc1
buffer_load_dwordx4 v[120:123], v2, s[48:51], s64 offen offset:0 sc1
buffer_load_dwordx4 v[124:127], v2, s[48:51], s64 offen offset:1024 sc1
buffer_load_dwordx4 v[128:131], v2, s[48:51], s64 offen offset:2048 sc1
buffer_load_dwordx4 v[132:135], v2, s[48:51], s64 offen offset:3072 sc1
L_wd21:
s_waitcnt vmcnt(8)
v_mov_b32 v190, 4
s_mov_b64 exec, 1
ds_write_b32 v185, v190
s_mov_b64 exec, -1
L_lc22:
ds_read_b128 v[186:189], v184
s_waitcnt lgkmcnt(0)
v_min3_u32 v186, v186, v187, v188
v_min_u32 v186, v186, v189
s_nop 0
v_readfirstlane_b32 s92, v186
s_nop 0
s_cmp_ge_u32 s92, 4
s_cbranch_scc1 L_lcd23
s_sleep 1
s_branch L_lc22
L_lcd23:
ds_read_b128 v[72:75], v15 offset:0
ds_read_b128 v[76:79], v15 offset:4096
ds_read_b128 v[80:83], v15 offset:8192
ds_read_b128 v[84:87], v15 offset:12288
s_cmp_eq_u32 s61, 1
s_cbranch_scc1 L_wr24
ds_read_b128 v[104:107], v19 offset:0
ds_read_b128 v[108:111], v19 offset:1024
ds_read_b128 v[112:115], v19 offset:2048
ds_read_b128 v[116:119], v19 offset:3072
ds_read_b128 v[120:123], v19 offset:4096
ds_read_b128 v[124:127], v19 offset:5120
ds_read_b128 v[128:131], v19 offset:6144
ds_read_b128 v[132:135], v19 offset:7168
L_wr24:
s_waitcnt lgkmcnt(0)
v_mov_b32 v190, 5
s_mov_b64 exec, 1
ds_write_b32 v185, v190
s_mov_b64 exec, -1
s_lshl_b32 s64, s61, 31
s_or_b32 s64, s64, s62
L_fft25:
v_xor_b32 v24, s64, v72
v_xor_b32 v25, s64, v73
v_xor_b32 v26, s64, v74
v_xor_b32 v27, s64, v75
v_xor_b32 v28, s64, v76
v_xor_b32 v29, s64, v77
v_xor_b32 v30, s64, v78
v_xor_b32 v31, s64, v79
v_xor_b32 v32, s64, v80
v_xor_b32 v33, s64, v81
v_xor_b32 v34, s64, v82
v_xor_b32 v35, s64, v83
v_xor_b32 v36, s64, v84
v_xor_b32 v37, s64, v85
v_xor_b32 v38, s64, v86
v_xor_b32 v39, s64, v87
v_mfma_f32_32x32x16_bf16 v[40:55], v[24:27], v[192:195], 0
v_mfma_f32_32x32x16_bf16 v[40:55], v[28:31], v[196:199], v[40:55]
v_mfma_f32_32x32x16_bf16 v[40:55], v[32:35], v[200:203], v[40:55]
v_mfma_f32_32x32x16_bf16 v[40:55], v[36:39], v[204:207], v[40:55]
v_mfma_f32_32x32x16_bf16 v[56:71], v[24:27], v[208:211], 0
v_mfma_f32_32x32x16_bf16 v[56:71], v[28:31], v[212:215], v[56:71]
v_mfma_f32_32x32x16_bf16 v[56:71], v[32:35], v[216:219], v[56:71]
v_mfma_f32_32x32x16_bf16 v[56:71], v[36:39], v[220:223], v[56:71]
s_cmp_eq_u32 s61, 2
s_cbranch_scc1 L_once27
s_waitcnt vmcnt(0)
v_lshlrev_b32 v176, 16, v104
v_and_b32 v177, 0xffff0000, v104
v_lshlrev_b32 v178, 16, v105
v_and_b32 v179, 0xffff0000, v105
v_add_f32 v180, v176, v178
v_add_f32 v181, v177, v179
v_sub_f32 v176, v176, v178
v_sub_f32 v177, v177, v179
v_mul_f32 v104, v136, v176
v_mul_f32 v105, v136, v177
v_fma_f32 v136, v152, v176, v180
v_fma_f32 v152, v152, v177, v181
v_lshlrev_b32 v176, 16, v106
v_and_b32 v177, 0xffff0000, v106
v_lshlrev_b32 v178, 16, v107
v_and_b32 v179, 0xffff0000, v107
v_add_f32 v180, v176, v178
v_add_f32 v181, v177, v179
v_sub_f32 v176, v176, v178
v_sub_f32 v177, v177, v179
v_mul_f32 v106, v137, v176
v_mul_f32 v107, v137, v177
v_fma_f32 v137, v153, v176, v180
v_fma_f32 v153, v153, v177, v181
v_lshlrev_b32 v176, 16, v108
v_and_b32 v177, 0xffff0000, v108
v_lshlrev_b32 v178, 16, v109
v_and_b32 v179, 0xffff0000, v109
v_add_f32 v180, v176, v178
v_add_f32 v181, v177, v179
v_sub_f32 v176, v176, v178
v_sub_f32 v177, v177, v179
v_mul_f32 v108, v138, v176
v_mul_f32 v109, v138, v177
v_fma_f32 v138, v154, v176, v180
v_fma_f32 v154, v154, v177, v181
v_lshlrev_b32 v176, 16, v110
v_and_b32 v177, 0xffff0000, v110
v_lshlrev_b32 v178, 16, v111
v_and_b32 v179, 0xffff0000, v111
v_add_f32 v180, v176, v178
v_add_f32 v181, v177, v179
v_sub_f32 v176, v176, v178
v_sub_f32 v177, v177, v179
v_mul_f32 v110, v139, v176
v_mul_f32 v111, v139, v177
v_fma_f32 v139, v155, v176, v180
v_fma_f32 v155, v155, v177, v181
v_lshlrev_b32 v176, 16, v112
v_and_b32 v177, 0xffff0000, v112
v_lshlrev_b32 v178, 16, v113
v_and_b32 v179, 0xffff0000, v113
v_add_f32 v180, v176, v178
v_add_f32 v181, v177, v179
v_sub_f32 v176, v176, v178
v_sub_f32 v177, v177, v179
v_mul_f32 v112, v140, v176
v_mul_f32 v113, v140, v177
v_fma_f32 v140, v156, v176, v180
v_fma_f32 v156, v156, v177, v181
v_lshlrev_b32 v176, 16, v114
v_and_b32 v177, 0xffff0000, v114
v_lshlrev_b32 v178, 16, v115
v_and_b32 v179, 0xffff0000, v115
v_add_f32 v180, v176, v178
v_add_f32 v181, v177, v179
v_sub_f32 v176, v176, v178
v_sub_f32 v177, v177, v179
v_mul_f32 v114, v141, v176
v_mul_f32 v115, v141, v177
v_fma_f32 v141, v157, v176, v180
v_fma_f32 v157, v157, v177, v181
L_once27:
s_nop 5
v_mul_f32 v168, v40, v224
v_mul_f32 v169, v40, v240
s_nop 1
v_fma_f32 v168, -v56, v240, v168
v_fmac_f32 v169, v56, v224
v_cvt_pk_bf16_f32 v24, v168, v169
v_mul_f32 v170, v41, v225
v_mul_f32 v171, v41, v241
v_fma_f32 v170, -v57, v241, v170
v_fmac_f32 v171, v57, v225
v_cvt_pk_bf16_f32 v25, v170, v171
v_mul_f32 v172, v42, v226
v_mul_f32 v173, v42, v242
v_fma_f32 v172, -v58, v242, v172
v_fmac_f32 v173, v58, v226
v_cvt_pk_bf16_f32 v26, v172, v173
v_mul_f32 v174, v43, v227
v_mul_f32 v175, v43, v243
v_fma_f32 v174, -v59, v243, v174
v_fmac_f32 v175, v59, v227
v_cvt_pk_bf16_f32 v27, v174, v175
v_mul_f32 v168, v44, v228
v_mul_f32 v169, v44, v244
v_fma_f32 v168, -v60, v244, v168
v_fmac_f32 v169, v60, v228
v_cvt_pk_bf16_f32 v28, v168, v169
v_mul_f32 v170, v45, v229
v_mul_f32 v171, v45, v245
v_fma_f32 v170, -v61, v245, v170
v_fmac_f32 v171, v61, v229
v_cvt_pk_bf16_f32 v29, v170, v171
v_mul_f32 v172, v46, v230
v_mul_f32 v173, v46, v246
v_fma_f32 v172, -v62, v246, v172
v_fmac_f32 v173, v62, v230
v_cvt_pk_bf16_f32 v30, v172, v173
v_mul_f32 v174, v47, v231
v_mul_f32 v175, v47, v247
v_fma_f32 v174, -v63, v247, v174
v_fmac_f32 v175, v63, v231
v_cvt_pk_bf16_f32 v31, v174, v175
v_mul_f32 v168, v48, v232
v_mul_f32 v169, v48, v248
v_fma_f32 v168, -v64, v248, v168
v_fmac_f32 v169, v64, v232
v_cvt_pk_bf16_f32 v32, v168, v169
v_mul_f32 v170, v49, v233
v_mul_f32 v171, v49, v249
v_fma_f32 v170, -v65, v249, v170
v_fmac_f32 v171, v65, v233
v_cvt_pk_bf16_f32 v33, v170, v171
v_mul_f32 v172, v50, v234
v_mul_f32 v173, v50, v250
v_fma_f32 v172, -v66, v250, v172
v_fmac_f32 v173, v66, v234
v_cvt_pk_bf16_f32 v34, v172, v173
v_mul_f32 v174, v51, v235
v_mul_f32 v175, v51, v251
v_fma_f32 v174, -v67, v251, v174
v_fmac_f32 v175, v67, v235
v_cvt_pk_bf16_f32 v35, v174, v175
v_mul_f32 v168, v52, v236
v_mul_f32 v169, v52, v252
v_fma_f32 v168, -v68, v252, v168
v_fmac_f32 v169, v68, v236
v_cvt_pk_bf16_f32 v36, v168, v169
v_mul_f32 v170, v53, v237
v_mul_f32 v171, v53, v253
v_fma_f32 v170, -v69, v253, v170
v_fmac_f32 v171, v69, v237
v_cvt_pk_bf16_f32 v37, v170, v171
v_mul_f32 v172, v54, v238
v_mul_f32 v173, v54, v254
v_fma_f32 v172, -v70, v254, v172
v_fmac_f32 v173, v70, v238
v_cvt_pk_bf16_f32 v38, v172, v173
v_mul_f32 v174, v55, v239
v_mul_f32 v175, v55, v255
v_fma_f32 v174, -v71, v255, v174
v_fmac_f32 v175, v71, v239
v_cvt_pk_bf16_f32 v39, v174, v175
v_mfma_f32_32x32x16_bf16 v[40:55], v[192:195], v[24:27], 0
v_mfma_f32_32x32x16_bf16 v[40:55], v[196:199], v[28:31], v[40:55]
v_mfma_f32_32x32x16_bf16 v[40:55], v[200:203], v[32:35], v[40:55]
v_mfma_f32_32x32x16_bf16 v[40:55], v[204:207], v[36:39], v[40:55]
v_mfma_f32_32x32x16_bf16 v[56:71], v[208:211], v[24:27], 0
v_mfma_f32_32x32x16_bf16 v[56:71], v[212:215], v[28:31], v[56:71]
v_mfma_f32_32x32x16_bf16 v[56:71], v[216:219], v[32:35], v[56:71]
v_mfma_f32_32x32x16_bf16 v[56:71], v[220:223], v[36:39], v[56:71]
s_cmp_eq_u32 s61, 2
s_cbranch_scc1 L_once28
s_waitcnt vmcnt(0)
v_lshlrev_b32 v176, 16, v116
v_and_b32 v177, 0xffff0000, v116
v_lshlrev_b32 v178, 16, v117
v_and_b32 v179, 0xffff0000, v117
v_add_f32 v180, v176, v178
v_add_f32 v181, v177, v179
v_sub_f32 v176, v176, v178
v_sub_f32 v177, v177, v179
v_mul_f32 v116, v142, v176
v_mul_f32 v117, v142, v177
v_fma_f32 v142, v158, v176, v180
v_fma_f32 v158, v158, v177, v181
v_lshlrev_b32 v176, 16, v118
v_and_b32 v177, 0xffff0000, v118
v_lshlrev_b32 v178, 16, v119
v_and_b32 v179, 0xffff0000, v119
v_add_f32 v180, v176, v178
v_add_f32 v181, v177, v179
v_sub_f32 v176, v176, v178
v_sub_f32 v177, v177, v179
v_mul_f32 v118, v143, v176
v_mul_f32 v119, v143, v177
v_fma_f32 v143, v159, v176, v180
v_fma_f32 v159, v159, v177, v181
v_lshlrev_b32 v176, 16, v120
v_and_b32 v177, 0xffff0000, v120
v_lshlrev_b32 v178, 16, v121
v_and_b32 v179, 0xffff0000, v121
v_add_f32 v180, v176, v178
v_add_f32 v181, v177, v179
v_sub_f32 v176, v176, v178
v_sub_f32 v177, v177, v179
v_mul_f32 v120, v144, v176
v_mul_f32 v121, v144, v177
v_fma_f32 v144, v160, v176, v180
v_fma_f32 v160, v160, v177, v181
v_lshlrev_b32 v176, 16, v122
v_and_b32 v177, 0xffff0000, v122
v_lshlrev_b32 v178, 16, v123
v_and_b32 v179, 0xffff0000, v123
v_add_f32 v180, v176, v178
v_add_f32 v181, v177, v179
v_sub_f32 v176, v176, v178
v_sub_f32 v177, v177, v179
v_mul_f32 v122, v145, v176
v_mul_f32 v123, v145, v177
v_fma_f32 v145, v161, v176, v180
v_fma_f32 v161, v161, v177, v181
v_lshlrev_b32 v176, 16, v124
v_and_b32 v177, 0xffff0000, v124
v_lshlrev_b32 v178, 16, v125
v_and_b32 v179, 0xffff0000, v125
v_add_f32 v180, v176, v178
v_add_f32 v181, v177, v179
v_sub_f32 v176, v176, v178
v_sub_f32 v177, v177, v179
v_mul_f32 v124, v146, v176
v_mul_f32 v125, v146, v177
v_fma_f32 v146, v162, v176, v180
v_fma_f32 v162, v162, v177, v181
v_lshlrev_b32 v176, 16, v126
v_and_b32 v177, 0xffff0000, v126
v_lshlrev_b32 v178, 16, v127
v_and_b32 v179, 0xffff0000, v127
v_add_f32 v180, v176, v178
v_add_f32 v181, v177, v179
v_sub_f32 v176, v176, v178
v_sub_f32 v177, v177, v179
v_mul_f32 v126, v147, v176
v_mul_f32 v127, v147, v177
v_fma_f32 v147, v163, v176, v180
v_fma_f32 v163, v163, v177, v181
L_once28:
L_lc29:
ds_read_b128 v[186:189], v184
s_waitcnt lgkmcnt(0)
v_min3_u32 v186, v186, v187, v188
v_min_u32 v186, v186, v189
s_nop 0
v_readfirstlane_b32 s92, v186
s_nop 0
s_cmp_ge_u32 s92, 5
s_cbranch_scc1 L_lcd30
s_sleep 1
s_branch L_lc29
L_lcd30:
s_cmp_eq_u32 s61, 2
s_cbranch_scc1 L_nwr26
ds_write_b128 v16, v[40:43] offset:0
ds_write_b128 v16, v[44:47] offset:1024
ds_write_b128 v16, v[48:51] offset:2048
ds_write_b128 v16, v[52:55] offset:3072
ds_write_b128 v16, v[56:59] offset:4096
ds_write_b128 v16, v[60:63] offset:5120
ds_write_b128 v16, v[64:67] offset:6144
ds_write_b128 v16, v[68:71] offset:7168
s_cmp_eq_u32 s61, 0
s_cbranch_scc1 L_nwr26
s_mov_b32 s61, 2
s_mov_b32 s64, 0
s_branch L_fft25
L_nwr26:
v_lshlrev_b32 v176, 16, v128
v_and_b32 v177, 0xffff0000, v128
v_lshlrev_b32 v178, 16, v129
v_and_b32 v179, 0xffff0000, v129
v_add_f32 v180, v176, v178
v_add_f32 v181, v177, v179
v_sub_f32 v176, v176, v178
v_sub_f32 v177, v177, v179
v_mul_f32 v128, v148, v176
v_mul_f32 v129, v148, v177
v_fma_f32 v148, v164, v176, v180
v_fma_f32 v164, v164, v177, v181
v_lshlrev_b32 v176, 16, v130
v_and_b32 v177, 0xffff0000, v130
v_lshlrev_b32 v178, 16, v131
v_and_b32 v179, 0xffff0000, v131
v_add_f32 v180, v176, v178
v_add_f32 v181, v177, v179
v_sub_f32 v176, v176, v178
v_sub_f32 v177, v177, v179
v_mul_f32 v130, v149, v176
v_mul_f32 v131, v149, v177
v_fma_f32 v149, v165, v176, v180
v_fma_f32 v165, v165, v177, v181
s_waitcnt lgkmcnt(0)
v_mov_b32 v190, 6
s_mov_b64 exec, 1
ds_write_b32 v185, v190
s_mov_b64 exec, -1
v_lshlrev_b32 v176, 16, v132
v_and_b32 v177, 0xffff0000, v132
v_lshlrev_b32 v178, 16, v133
v_and_b32 v179, 0xffff0000, v133
v_add_f32 v180, v176, v178
v_add_f32 v181, v177, v179
v_sub_f32 v176, v176, v178
v_sub_f32 v177, v177, v179
v_mul_f32 v132, v150, v176
v_mul_f32 v133, v150, v177
v_fma_f32 v150, v166, v176, v180
v_fma_f32 v166, v166, v177, v181
v_lshlrev_b32 v176, 16, v134
v_and_b32 v177, 0xffff0000, v134
v_lshlrev_b32 v178, 16, v135
v_and_b32 v179, 0xffff0000, v135
v_add_f32 v180, v176, v178
v_add_f32 v181, v177, v179
v_sub_f32 v176, v176, v178
v_sub_f32 v177, v177, v179
v_mul_f32 v134, v151, v176
v_mul_f32 v135, v151, v177
v_fma_f32 v151, v167, v176, v180
v_fma_f32 v167, v167, v177, v181
v_mul_f32 v168, v152, v56
v_mul_f32 v56, v136, v56
v_fmac_f32 v56, v152, v40
v_fma_f32 v40, v136, v40, -v168
v_mul_f32 v169, v153, v57
v_mul_f32 v57, v137, v57
v_fmac_f32 v57, v153, v41
v_fma_f32 v41, v137, v41, -v169
v_mul_f32 v168, v154, v58
v_mul_f32 v58, v138, v58
v_fmac_f32 v58, v154, v42
v_fma_f32 v42, v138, v42, -v168
v_mul_f32 v169, v155, v59
v_mul_f32 v59, v139, v59
v_fmac_f32 v59, v155, v43
v_fma_f32 v43, v139, v43, -v169
v_mul_f32 v168, v156, v60
v_mul_f32 v60, v140, v60
v_fmac_f32 v60, v156, v44
v_fma_f32 v44, v140, v44, -v168
v_mul_f32 v169, v157, v61
v_mul_f32 v61, v141, v61
v_fmac_f32 v61, v157, v45
v_fma_f32 v45, v141, v45, -v169
L_lc31:
ds_read_b128 v[186:189], v184
s_waitcnt lgkmcnt(0)
v_min3_u32 v186, v186, v187, v188
v_min_u32 v186, v186, v189
s_nop 0
v_readfirstlane_b32 s92, v186
s_nop 0
s_cmp_ge_u32 s92, 6
s_cbranch_scc1 L_lcd32
s_sleep 1
s_branch L_lc31
L_lcd32:
ds_read_b128 v[72:75], v17 offset:0
ds_read_b128 v[76:79], v17 offset:1024
ds_read_b128 v[80:83], v17 offset:2048
ds_read_b128 v[84:87], v17 offset:3072
ds_read_b128 v[88:91], v17 offset:4096
ds_read_b128 v[92:95], v17 offset:5120
ds_read_b128 v[96:99], v17 offset:6144
ds_read_b128 v[100:103], v17 offset:7168
v_mul_f32 v168, v158, v62
v_mul_f32 v62, v142, v62
v_fmac_f32 v62, v158, v46
v_fma_f32 v46, v142, v46, -v168
v_mul_f32 v169, v159, v63
v_mul_f32 v63, v143, v63
v_fmac_f32 v63, v159, v47
v_fma_f32 v47, v143, v47, -v169
v_mul_f32 v168, v160, v64
v_mul_f32 v64, v144, v64
v_fmac_f32 v64, v160, v48
v_fma_f32 v48, v144, v48, -v168
v_mul_f32 v169, v161, v65
v_mul_f32 v65, v145, v65
v_fmac_f32 v65, v161, v49
v_fma_f32 v49, v145, v49, -v169
v_mul_f32 v168, v162, v66
v_mul_f32 v66, v146, v66
v_fmac_f32 v66, v162, v50
v_fma_f32 v50, v146, v50, -v168
v_mul_f32 v169, v163, v67
v_mul_f32 v67, v147, v67
v_fmac_f32 v67, v163, v51
v_fma_f32 v51, v147, v51, -v169
v_mul_f32 v168, v164, v68
v_mul_f32 v68, v148, v68
v_fmac_f32 v68, v164, v52
v_fma_f32 v52, v148, v52, -v168
v_mul_f32 v169, v165, v69
v_mul_f32 v69, v149, v69
v_fmac_f32 v69, v165, v53
v_fma_f32 v53, v149, v53, -v169
v_mul_f32 v168, v166, v70
v_mul_f32 v70, v150, v70
v_fmac_f32 v70, v166, v54
v_fma_f32 v54, v150, v54, -v168
v_mul_f32 v169, v167, v71
v_mul_f32 v71, v151, v71
v_fmac_f32 v71, v167, v55
v_fma_f32 v55, v151, v55, -v169
s_waitcnt lgkmcnt(0)
v_mov_b32 v190, 7
s_mov_b64 exec, 1
ds_write_b32 v185, v190
s_mov_b64 exec, -1
v_fma_f32 v40, -v104, v88, v40
v_fmac_f32 v56, v104, v72
v_fma_f32 v40, -v105, v72, v40
v_fma_f32 v56, -v105, v88, v56
v_cvt_pk_bf16_f32 v24, v56, v40
v_fma_f32 v41, -v106, v89, v41
v_fmac_f32 v57, v106, v73
v_fma_f32 v41, -v107, v73, v41
v_fma_f32 v57, -v107, v89, v57
v_cvt_pk_bf16_f32 v25, v57, v41
v_fma_f32 v42, -v108, v90, v42
v_fmac_f32 v58, v108, v74
v_fma_f32 v42, -v109, v74, v42
v_fma_f32 v58, -v109, v90, v58
v_cvt_pk_bf16_f32 v26, v58, v42
v_fma_f32 v43, -v110, v91, v43
v_fmac_f32 v59, v110, v75
v_fma_f32 v43, -v111, v75, v43
v_fma_f32 v59, -v111, v91, v59
v_cvt_pk_bf16_f32 v27, v59, v43
v_fma_f32 v44, -v112, v92, v44
v_fmac_f32 v60, v112, v76
v_fma_f32 v44, -v113, v76, v44
v_fma_f32 v60, -v113, v92, v60
v_cvt_pk_bf16_f32 v28, v60, v44
v_fma_f32 v45, -v114, v93, v45
v_fmac_f32 v61, v114, v77
v_fma_f32 v45, -v115, v77, v45
v_fma_f32 v61, -v115, v93, v61
v_cvt_pk_bf16_f32 v29, v61, v45
v_fma_f32 v46, -v116, v94, v46
v_fmac_f32 v62, v116, v78
v_fma_f32 v46, -v117, v78, v46
v_fma_f32 v62, -v117, v94, v62
v_cvt_pk_bf16_f32 v30, v62, v46
v_fma_f32 v47, -v118, v95, v47
v_fmac_f32 v63, v118, v79
v_fma_f32 v47, -v119, v79, v47
v_fma_f32 v63, -v119, v95, v63
v_cvt_pk_bf16_f32 v31, v63, v47
v_fma_f32 v48, -v120, v96, v48
v_fmac_f32 v64, v120, v80
v_fma_f32 v48, -v121, v80, v48
v_fma_f32 v64, -v121, v96, v64
v_cvt_pk_bf16_f32 v32, v64, v48
v_fma_f32 v49, -v122, v97, v49
v_fmac_f32 v65, v122, v81
v_fma_f32 v49, -v123, v81, v49
v_fma_f32 v65, -v123, v97, v65
v_cvt_pk_bf16_f32 v33, v65, v49
v_fma_f32 v50, -v124, v98, v50
v_fmac_f32 v66, v124, v82
v_fma_f32 v50, -v125, v82, v50
v_fma_f32 v66, -v125, v98, v66
v_cvt_pk_bf16_f32 v34, v66, v50
v_fma_f32 v51, -v126, v99, v51
v_fmac_f32 v67, v126, v83
v_fma_f32 v51, -v127, v83, v51
v_fma_f32 v67, -v127, v99, v67
v_cvt_pk_bf16_f32 v35, v67, v51
v_fma_f32 v52, -v128, v100, v52
v_fmac_f32 v68, v128, v84
v_fma_f32 v52, -v129, v84, v52
v_fma_f32 v68, -v129, v100, v68
v_cvt_pk_bf16_f32 v36, v68, v52
v_fma_f32 v53, -v130, v101, v53
v_fmac_f32 v69, v130, v85
v_fma_f32 v53, -v131, v85, v53
v_fma_f32 v69, -v131, v101, v69
v_cvt_pk_bf16_f32 v37, v69, v53
v_fma_f32 v54, -v132, v102, v54
v_fmac_f32 v70, v132, v86
v_fma_f32 v54, -v133, v86, v54
v_fma_f32 v70, -v133, v102, v70
v_cvt_pk_bf16_f32 v38, v70, v54
v_fma_f32 v55, -v134, v103, v55
v_fmac_f32 v71, v134, v87
v_fma_f32 v55, -v135, v87, v55
v_fma_f32 v71, -v135, v103, v71
v_cvt_pk_bf16_f32 v39, v71, v55
v_mfma_f32_32x32x16_bf16 v[40:55], v[24:27], v[192:195], 0
v_mfma_f32_32x32x16_bf16 v[40:55], v[28:31], v[196:199], v[40:55]
v_mfma_f32_32x32x16_bf16 v[40:55], v[32:35], v[200:203], v[40:55]
v_mfma_f32_32x32x16_bf16 v[40:55], v[36:39], v[204:207], v[40:55]
v_mfma_f32_32x32x16_bf16 v[56:71], v[24:27], v[208:211], 0
v_mfma_f32_32x32x16_bf16 v[56:71], v[28:31], v[212:215], v[56:71]
v_mfma_f32_32x32x16_bf16 v[56:71], v[32:35], v[216:219], v[56:71]
v_mfma_f32_32x32x16_bf16 v[56:71], v[36:39], v[220:223], v[56:71]
s_nop 7
v_mul_f32 v168, v40, v224
v_mul_f32 v169, v40, v240
s_nop 1
v_fma_f32 v168, -v56, v240, v168
v_fmac_f32 v169, v56, v224
v_cvt_pk_bf16_f32 v24, v168, v169
v_mul_f32 v170, v41, v225
v_mul_f32 v171, v41, v241
v_fma_f32 v170, -v57, v241, v170
v_fmac_f32 v171, v57, v225
v_cvt_pk_bf16_f32 v25, v170, v171
v_mul_f32 v172, v42, v226
v_mul_f32 v173, v42, v242
v_fma_f32 v172, -v58, v242, v172
v_fmac_f32 v173, v58, v226
v_cvt_pk_bf16_f32 v26, v172, v173
v_mul_f32 v174, v43, v227
v_mul_f32 v175, v43, v243
v_fma_f32 v174, -v59, v243, v174
v_fmac_f32 v175, v59, v227
v_cvt_pk_bf16_f32 v27, v174, v175
v_mul_f32 v168, v44, v228
v_mul_f32 v169, v44, v244
v_fma_f32 v168, -v60, v244, v168
v_fmac_f32 v169, v60, v228
v_cvt_pk_bf16_f32 v28, v168, v169
v_mul_f32 v170, v45, v229
v_mul_f32 v171, v45, v245
v_fma_f32 v170, -v61, v245, v170
v_fmac_f32 v171, v61, v229
v_cvt_pk_bf16_f32 v29, v170, v171
v_mul_f32 v172, v46, v230
v_mul_f32 v173, v46, v246
v_fma_f32 v172, -v62, v246, v172
v_fmac_f32 v173, v62, v230
v_cvt_pk_bf16_f32 v30, v172, v173
v_mul_f32 v174, v47, v231
v_mul_f32 v175, v47, v247
v_fma_f32 v174, -v63, v247, v174
v_fmac_f32 v175, v63, v231
v_cvt_pk_bf16_f32 v31, v174, v175
v_mul_f32 v168, v48, v232
v_mul_f32 v169, v48, v248
v_fma_f32 v168, -v64, v248, v168
v_fmac_f32 v169, v64, v232
v_cvt_pk_bf16_f32 v32, v168, v169
v_mul_f32 v170, v49, v233
v_mul_f32 v171, v49, v249
v_fma_f32 v170, -v65, v249, v170
v_fmac_f32 v171, v65, v233
v_cvt_pk_bf16_f32 v33, v170, v171
v_mul_f32 v172, v50, v234
v_mul_f32 v173, v50, v250
v_fma_f32 v172, -v66, v250, v172
v_fmac_f32 v173, v66, v234
v_cvt_pk_bf16_f32 v34, v172, v173
v_mul_f32 v174, v51, v235
v_mul_f32 v175, v51, v251
v_fma_f32 v174, -v67, v251, v174
v_fmac_f32 v175, v67, v235
v_cvt_pk_bf16_f32 v35, v174, v175
v_mul_f32 v168, v52, v236
v_mul_f32 v169, v52, v252
v_fma_f32 v168, -v68, v252, v168
v_fmac_f32 v169, v68, v236
v_cvt_pk_bf16_f32 v36, v168, v169
v_mul_f32 v170, v53, v237
v_mul_f32 v171, v53, v253
v_fma_f32 v170, -v69, v253, v170
v_fmac_f32 v171, v69, v237
v_cvt_pk_bf16_f32 v37, v170, v171
v_mul_f32 v172, v54, v238
v_mul_f32 v173, v54, v254
v_fma_f32 v172, -v70, v254, v172
v_fmac_f32 v173, v70, v238
v_cvt_pk_bf16_f32 v38, v172, v173
v_mul_f32 v174, v55, v239
v_mul_f32 v175, v55, v255
v_fma_f32 v174, -v71, v255, v174
v_fmac_f32 v175, v71, v239
v_cvt_pk_bf16_f32 v39, v174, v175
v_mfma_f32_32x32x16_bf16 v[40:55], v[192:195], v[24:27], 0
v_mfma_f32_32x32x16_bf16 v[40:55], v[196:199], v[28:31], v[40:55]
v_mfma_f32_32x32x16_bf16 v[40:55], v[200:203], v[32:35], v[40:55]
v_mfma_f32_32x32x16_bf16 v[40:55], v[204:207], v[36:39], v[40:55]
v_mfma_f32_32x32x16_bf16 v[56:71], v[208:211], v[24:27], 0
v_mfma_f32_32x32x16_bf16 v[56:71], v[212:215], v[28:31], v[56:71]
v_mfma_f32_32x32x16_bf16 v[56:71], v[216:219], v[32:35], v[56:71]
v_mfma_f32_32x32x16_bf16 v[56:71], v[220:223], v[36:39], v[56:71]
s_lshr_b32 s64, s62, 16
L_lc33:
ds_read_b128 v[186:189], v184
s_waitcnt lgkmcnt(0)
v_min3_u32 v186, v186, v187, v188
v_min_u32 v186, v186, v189
s_nop 0
v_readfirstlane_b32 s92, v186
s_nop 0
s_cmp_ge_u32 s92, 7
s_cbranch_scc1 L_lcd34
s_sleep 1
s_branch L_lc33
L_lcd34:
s_nop 1
v_cvt_pk_bf16_f32 v24, v40, v56
v_xor_b32 v24, s64, v24
v_cvt_pk_bf16_f32 v25, v41, v57
v_xor_b32 v25, s64, v25
v_cvt_pk_bf16_f32 v26, v42, v58
v_xor_b32 v26, s64, v26
v_cvt_pk_bf16_f32 v27, v43, v59
v_xor_b32 v27, s64, v27
ds_write_b128 v15, v[24:27] offset:0
v_cvt_pk_bf16_f32 v28, v44, v60
v_xor_b32 v28, s64, v28
v_cvt_pk_bf16_f32 v29, v45, v61
v_xor_b32 v29, s64, v29
v_cvt_pk_bf16_f32 v30, v46, v62
v_xor_b32 v30, s64, v30
v_cvt_pk_bf16_f32 v31, v47, v63
v_xor_b32 v31, s64, v31
ds_write_b128 v15, v[28:31] offset:4096
v_cvt_pk_bf16_f32 v32, v48, v64
v_xor_b32 v32, s64, v32
v_cvt_pk_bf16_f32 v33, v49, v65
v_xor_b32 v33, s64, v33
v_cvt_pk_bf16_f32 v34, v50, v66
v_xor_b32 v34, s64, v34
v_cvt_pk_bf16_f32 v35, v51, v67
v_xor_b32 v35, s64, v35
ds_write_b128 v15, v[32:35] offset:8192
v_cvt_pk_bf16_f32 v36, v52, v68
v_xor_b32 v36, s64, v36
v_cvt_pk_bf16_f32 v37, v53, v69
v_xor_b32 v37, s64, v37
v_cvt_pk_bf16_f32 v38, v54, v70
v_xor_b32 v38, s64, v38
v_cvt_pk_bf16_f32 v39, v55, v71
v_xor_b32 v39, s64, v39
ds_write_b128 v15, v[36:39] offset:12288
s_waitcnt lgkmcnt(0)
v_mov_b32 v190, 8
s_mov_b64 exec, 1
ds_write_b32 v185, v190
s_mov_b64 exec, -1
L_lc35:
ds_read_b128 v[186:189], v184
s_waitcnt lgkmcnt(0)
v_min3_u32 v186, v186, v187, v188
v_min_u32 v186, v186, v189
s_nop 0
v_readfirstlane_b32 s92, v186
s_nop 0
s_cmp_ge_u32 s92, 8
s_cbranch_scc1 L_lcd36
s_sleep 1
s_branch L_lc35
L_lcd36:
ds_read_b128 v[24:27], v18 offset:0
ds_read_b128 v[28:31], v18 offset:1024
ds_read_b128 v[32:35], v18 offset:2048
ds_read_b128 v[36:39], v18 offset:3072
s_mov_b32 s64, 0
s_waitcnt lgkmcnt(3)
buffer_store_dwordx4 v[24:27], v14, s[52:55], s64 offen sc1
s_mov_b32 s64, 262144
s_waitcnt lgkmcnt(2)
buffer_store_dwordx4 v[28:31], v14, s[52:55], s64 offen sc1
s_mov_b32 s64, 524288
s_waitcnt lgkmcnt(1)
buffer_store_dwordx4 v[32:35], v14, s[52:55], s64 offen sc1
s_mov_b32 s64, 786432
s_waitcnt lgkmcnt(0)
buffer_store_dwordx4 v[36:39], v14, s[52:55], s64 offen sc1
s_lshl_b32 s64, s67, 14
s_add_u32 s40, s28, s64
s_addc_u32 s41, s29, 0
s_mov_b32 s42, 16384
s_mov_b32 s43, 0x20000
v_and_b32 v8, 31, v1
v_lshrrev_b32 v9, 5, v1
v_lshlrev_b32 v14, 2, v8
v_lshl_add_u32 v14, v9, 9, v14
s_mov_b32 s64, 0x35000000
v_mul_f32 v224, s64, v224
v_mul_f32 v225, s64, v225
v_mul_f32 v226, s64, v226
v_mul_f32 v227, s64, v227
v_mul_f32 v228, s64, v228
v_mul_f32 v229, s64, v229
v_mul_f32 v230, s64, v230
v_mul_f32 v231, s64, v231
v_mul_f32 v232, s64, v232
v_mul_f32 v233, s64, v233
v_mul_f32 v234, s64, v234
v_mul_f32 v235, s64, v235
v_mul_f32 v236, s64, v236
v_mul_f32 v237, s64, v237
v_mul_f32 v238, s64, v238
v_mul_f32 v239, s64, v239
v_mul_f32 v240, s64, v240
v_mul_f32 v241, s64, v241
v_mul_f32 v242, s64, v242
v_mul_f32 v243, s64, v243
v_mul_f32 v244, s64, v244
v_mul_f32 v245, s64, v245
v_mul_f32 v246, s64, v246
v_mul_f32 v247, s64, v247
v_mul_f32 v248, s64, v248
v_mul_f32 v249, s64, v249
v_mul_f32 v250, s64, v250
v_mul_f32 v251, s64, v251
v_mul_f32 v252, s64, v252
v_mul_f32 v253, s64, v253
v_mul_f32 v254, s64, v254
v_mul_f32 v255, s64, v255
s_waitcnt vmcnt(0)
v_mov_b32 v190, 9
s_mov_b64 exec, 1
ds_write_b32 v185, v190
s_mov_b64 exec, -1
s_cmp_lg_u32 s66, 0
s_cbranch_scc1 L_ph37
L_lc38:
ds_read_b128 v[186:189], v184
s_waitcnt lgkmcnt(0)
v_min3_u32 v186, v186, v187, v188
v_min_u32 v186, v186, v189
s_nop 0
v_readfirstlane_b32 s92, v186
s_nop 0
s_cmp_ge_u32 s92, 9
s_cbranch_scc1 L_lcd39
s_sleep 1
s_branch L_lc38
L_lcd39:
s_and_b32 s64, s2, 15
s_lshl_b32 s65, s64, 7
s_add_u32 s65, s65, 6144
s_add_u32 s90, s32, s65
s_addc_u32 s91, s33, 0
s_mov_b32 s18, 1
s_atomic_add s18, s[90:91], 0x0 glc
L_ph37:
s_cmp_lg_u32 s66, 0
s_cbranch_scc1 L_sg40
s_and_b32 s64, s2, 15
s_lshl_b32 s64, s64, 2
s_add_u32 s64, s64, 548864
s_add_u32 s4, s32, s64
s_addc_u32 s5, s33, 0
s_waitcnt lgkmcnt(0)
s_cmp_lg_u32 s18, 15
s_cbranch_scc1 L_sg40
s_atomic_swap s37, s[4:5], 0x0
s_atomic_swap s37, s[4:5], 0x80
s_atomic_swap s37, s[4:5], 0x100
s_atomic_swap s37, s[4:5], 0x180
s_atomic_swap s37, s[4:5], 0x200
s_atomic_swap s37, s[4:5], 0x280
s_atomic_swap s37, s[4:5], 0x300
s_atomic_swap s37, s[4:5], 0x380
s_atomic_swap s37, s[4:5], 0x400
s_atomic_swap s37, s[4:5], 0x480
s_atomic_swap s37, s[4:5], 0x500
s_atomic_swap s37, s[4:5], 0x580
s_atomic_swap s37, s[4:5], 0x600
s_atomic_swap s37, s[4:5], 0x680
s_atomic_swap s37, s[4:5], 0x700
s_atomic_swap s37, s[4:5], 0x780
s_atomic_swap s37, s[4:5], 0x800
s_atomic_swap s37, s[4:5], 0x880
s_atomic_swap s37, s[4:5], 0x900
s_atomic_swap s37, s[4:5], 0x980
s_atomic_swap s37, s[4:5], 0xa00
s_atomic_swap s37, s[4:5], 0xa80
s_atomic_swap s37, s[4:5], 0xb00
s_atomic_swap s37, s[4:5], 0xb80
s_atomic_swap s37, s[4:5], 0xc00
s_atomic_swap s37, s[4:5], 0xc80
s_atomic_swap s37, s[4:5], 0xd00
s_atomic_swap s37, s[4:5], 0xd80
s_atomic_swap s37, s[4:5], 0xe00
s_atomic_swap s37, s[4:5], 0xe80
s_atomic_swap s37, s[4:5], 0xf00
s_atomic_swap s37, s[4:5], 0xf80
s_waitcnt lgkmcnt(0)
L_sg40:
s_cmp_lg_u32 s66, 0
s_cbranch_scc1 L_ph41
s_and_b32 s64, s2, 31
s_lshl_b32 s64, s64, 7
s_add_u32 s64, s64, 548864
s_add_u32 s90, s32, s64
s_addc_u32 s91, s33, 0
s_mov_b32 s64, s37
s_mov_b32 s65, s37
s_mov_b32 s92, 0
s_branch L_sp42
L_nok43:
s_add_u32 s92, s92, 1
s_cmp_ge_u32 s92, 200000
s_cbranch_scc1 L_ph41
s_sleep 10
L_sp42:
s_load_dwordx16 s[4:19], s[90:91], 0x0 glc
s_waitcnt lgkmcnt(0)
s_cmp_eq_u64 s[4:5], s[64:65]
s_cbranch_scc0 L_nok43
s_cmp_eq_u64 s[6:7], s[64:65]
s_cbranch_scc0 L_nok43
s_cmp_eq_u64 s[8:9], s[64:65]
s_cbranch_scc0 L_nok43
s_cmp_eq_u64 s[10:11], s[64:65]
s_cbranch_scc0 L_nok43
s_cmp_eq_u64 s[12:13], s[64:65]
s_cbranch_scc0 L_nok43
s_cmp_eq_u64 s[14:15], s[64:65]
s_cbranch_scc0 L_nok43
s_cmp_eq_u64 s[16:17], s[64:65]
s_cbranch_scc0 L_nok43
s_cmp_eq_u64 s[18:19], s[64:65]
s_cbranch_scc0 L_nok43
L_ph41:
v_mov_b32 v190, 10
s_mov_b64 exec, 1
ds_write_b32 v185, v190
s_mov_b64 exec, -1
L_lc44:
ds_read_b128 v[186:189], v184
s_waitcnt lgkmcnt(0)
v_min3_u32 v186, v186, v187, v188
v_min_u32 v186, v186, v189
s_nop 0
v_readfirstlane_b32 s92, v186
s_nop 0
s_cmp_ge_u32 s92, 10
s_cbranch_scc1 L_lcd45
s_sleep 1
s_branch L_lc44
L_lcd45:
s_setprio 0
s_mov_b32 m0, s68
s_nop 0
buffer_load_dwordx4 v7, s[44:47], 0 offen offset:0 sc1 lds
buffer_load_dwordx4 v7, s[44:47], 0 offen offset:1024 sc1 lds
buffer_load_dwordx4 v7, s[44:47], 0 offen offset:2048 sc1 lds
buffer_load_dwordx4 v7, s[44:47], 0 offen offset:3072 sc1 lds
s_waitcnt vmcnt(0)
v_mov_b32 v190, 11
s_mov_b64 exec, 1
ds_write_b32 v185, v190
s_mov_b64 exec, -1
L_lc46:
ds_read_b128 v[186:189], v184
s_waitcnt lgkmcnt(0)
v_min3_u32 v186, v186, v187, v188
v_min_u32 v186, v186, v189
s_nop 0
v_readfirstlane_b32 s92, v186
s_nop 0
s_cmp_ge_u32 s92, 11
s_cbranch_scc1 L_lcd47
s_sleep 1
s_branch L_lc46
L_lcd47:
ds_read_b32 v24, v4 offset:0
ds_read_b32 v25, v4 offset:1024
ds_read_b32 v26, v4 offset:2048
ds_read_b32 v27, v4 offset:3072
ds_read_b32 v28, v4 offset:8192
ds_read_b32 v29, v4 offset:9216
ds_read_b32 v30, v4 offset:10240
ds_read_b32 v31, v4 offset:11264
ds_read_b32 v32, v6 offset:0
ds_read_b32 v33, v5 offset:10240
ds_read_b32 v34, v5 offset:9216
ds_read_b32 v35, v5 offset:8192
ds_read_b32 v36, v5 offset:3072
ds_read_b32 v37, v5 offset:2048
ds_read_b32 v38, v5 offset:1024
ds_read_b32 v39, v5 offset:0
s_waitcnt lgkmcnt(0)
v_mfma_f32_32x32x16_bf16 v[40:55], v[24:27], v[192:195], 0
v_mfma_f32_32x32x16_bf16 v[40:55], v[28:31], v[196:199], v[40:55]
v_mfma_f32_32x32x16_bf16 v[40:55], v[32:35], v[200:203], v[40:55]
v_mfma_f32_32x32x16_bf16 v[40:55], v[36:39], v[204:207], v[40:55]
v_mfma_f32_32x32x16_bf16 v[56:71], v[24:27], v[208:211], 0
v_mfma_f32_32x32x16_bf16 v[56:71], v[28:31], v[212:215], v[56:71]
v_mfma_f32_32x32x16_bf16 v[56:71], v[32:35], v[216:219], v[56:71]
v_mfma_f32_32x32x16_bf16 v[56:71], v[36:39], v[220:223], v[56:71]
s_nop 7
v_mul_f32 v168, v40, v224
v_mul_f32 v169, v40, v240
s_nop 1
v_fma_f32 v168, -v56, v240, v168
v_fmac_f32 v169, v56, v224
v_cvt_pk_bf16_f32 v24, v168, v169
v_mul_f32 v170, v41, v225
v_mul_f32 v171, v41, v241
v_fma_f32 v170, -v57, v241, v170
v_fmac_f32 v171, v57, v225
v_cvt_pk_bf16_f32 v25, v170, v171
v_mul_f32 v172, v42, v226
v_mul_f32 v173, v42, v242
v_fma_f32 v172, -v58, v242, v172
v_fmac_f32 v173, v58, v226
v_cvt_pk_bf16_f32 v26, v172, v173
v_mul_f32 v174, v43, v227
v_mul_f32 v175, v43, v243
v_fma_f32 v174, -v59, v243, v174
v_fmac_f32 v175, v59, v227
v_cvt_pk_bf16_f32 v27, v174, v175
v_mul_f32 v168, v44, v228
v_mul_f32 v169, v44, v244
v_fma_f32 v168, -v60, v244, v168
v_fmac_f32 v169, v60, v228
v_cvt_pk_bf16_f32 v28, v168, v169
v_mul_f32 v170, v45, v229
v_mul_f32 v171, v45, v245
v_fma_f32 v170, -v61, v245, v170
v_fmac_f32 v171, v61, v229
v_cvt_pk_bf16_f32 v29, v170, v171
v_mul_f32 v172, v46, v230
v_mul_f32 v173, v46, v246
v_fma_f32 v172, -v62, v246, v172
v_fmac_f32 v173, v62, v230
v_cvt_pk_bf16_f32 v30, v172, v173
v_mul_f32 v174, v47, v231
v_mul_f32 v175, v47, v247
v_fma_f32 v174, -v63, v247, v174
v_fmac_f32 v175, v63, v231
v_cvt_pk_bf16_f32 v31, v174, v175
v_mul_f32 v168, v48, v232
v_mul_f32 v169, v48, v248
v_fma_f32 v168, -v64, v248, v168
v_fmac_f32 v169, v64, v232
v_cvt_pk_bf16_f32 v32, v168, v169
v_mul_f32 v170, v49, v233
v_mul_f32 v171, v49, v249
v_fma_f32 v170, -v65, v249, v170
v_fmac_f32 v171, v65, v233
v_cvt_pk_bf16_f32 v33, v170, v171
v_mul_f32 v172, v50, v234
v_mul_f32 v173, v50, v250
v_fma_f32 v172, -v66, v250, v172
v_fmac_f32 v173, v66, v234
v_cvt_pk_bf16_f32 v34, v172, v173
v_mul_f32 v174, v51, v235
v_mul_f32 v175, v51, v251
v_fma_f32 v174, -v67, v251, v174
v_fmac_f32 v175, v67, v235
v_cvt_pk_bf16_f32 v35, v174, v175
v_mul_f32 v168, v52, v236
v_mul_f32 v169, v52, v252
v_fma_f32 v168, -v68, v252, v168
v_fmac_f32 v169, v68, v236
v_cvt_pk_bf16_f32 v36, v168, v169
v_mul_f32 v170, v53, v237
v_mul_f32 v171, v53, v253
v_fma_f32 v170, -v69, v253, v170
v_fmac_f32 v171, v69, v237
v_cvt_pk_bf16_f32 v37, v170, v171
v_mul_f32 v172, v54, v238
v_mul_f32 v173, v54, v254
v_fma_f32 v172, -v70, v254, v172
v_fmac_f32 v173, v70, v238
v_cvt_pk_bf16_f32 v38, v172, v173
v_mul_f32 v174, v55, v239
v_mul_f32 v175, v55, v255
v_fma_f32 v174, -v71, v255, v174
v_fmac_f32 v175, v71, v239
v_cvt_pk_bf16_f32 v39, v174, v175
v_mfma_f32_32x32x16_bf16 v[40:55], v[192:195], v[24:27], 0
v_mfma_f32_32x32x16_bf16 v[40:55], v[196:199], v[28:31], v[40:55]
v_mfma_f32_32x32x16_bf16 v[40:55], v[200:203], v[32:35], v[40:55]
v_mfma_f32_32x32x16_bf16 v[40:55], v[204:207], v[36:39], v[40:55]
v_mfma_f32_32x32x16_bf16 v[56:71], v[208:211], v[24:27], 0
v_mfma_f32_32x32x16_bf16 v[56:71], v[212:215], v[28:31], v[56:71]
v_mfma_f32_32x32x16_bf16 v[56:71], v[216:219], v[32:35], v[56:71]
v_mfma_f32_32x32x16_bf16 v[56:71], v[220:223], v[36:39], v[56:71]
s_movk_i32 s64, 0x2000
s_nop 10
v_cvt_pk_bf16_f32 v73, v56, v40
v_lshlrev_b32 v72, 16, v73
v_and_b32 v73, 0xffff0000, v73
buffer_store_dword v72, v14, s[40:43], 0 offen offset:0 nt
buffer_store_dword v73, v14, s[40:43], s64 offen offset:0 nt
v_cvt_pk_bf16_f32 v75, v57, v41
v_lshlrev_b32 v74, 16, v75
v_and_b32 v75, 0xffff0000, v75
buffer_store_dword v74, v14, s[40:43], 0 offen offset:128 nt
buffer_store_dword v75, v14, s[40:43], s64 offen offset:128 nt
v_cvt_pk_bf16_f32 v77, v58, v42
v_lshlrev_b32 v76, 16, v77
v_and_b32 v77, 0xffff0000, v77
buffer_store_dword v76, v14, s[40:43], 0 offen offset:256 nt
buffer_store_dword v77, v14, s[40:43], s64 offen offset:256 nt
v_cvt_pk_bf16_f32 v79, v59, v43
v_lshlrev_b32 v78, 16, v79
v_and_b32 v79, 0xffff0000, v79
buffer_store_dword v78, v14, s[40:43], 0 offen offset:384 nt
buffer_store_dword v79, v14, s[40:43], s64 offen offset:384 nt
v_cvt_pk_bf16_f32 v81, v60, v44
v_lshlrev_b32 v80, 16, v81
v_and_b32 v81, 0xffff0000, v81
buffer_store_dword v80, v14, s[40:43], 0 offen offset:1024 nt
buffer_store_dword v81, v14, s[40:43], s64 offen offset:1024 nt
v_cvt_pk_bf16_f32 v83, v61, v45
v_lshlrev_b32 v82, 16, v83
v_and_b32 v83, 0xffff0000, v83
buffer_store_dword v82, v14, s[40:43], 0 offen offset:1152 nt
buffer_store_dword v83, v14, s[40:43], s64 offen offset:1152 nt
v_cvt_pk_bf16_f32 v85, v62, v46
v_lshlrev_b32 v84, 16, v85
v_and_b32 v85, 0xffff0000, v85
buffer_store_dword v84, v14, s[40:43], 0 offen offset:1280 nt
buffer_store_dword v85, v14, s[40:43], s64 offen offset:1280 nt
v_cvt_pk_bf16_f32 v87, v63, v47
v_lshlrev_b32 v86, 16, v87
v_and_b32 v87, 0xffff0000, v87
buffer_store_dword v86, v14, s[40:43], 0 offen offset:1408 nt
buffer_store_dword v87, v14, s[40:43], s64 offen offset:1408 nt
v_cvt_pk_bf16_f32 v89, v64, v48
v_lshlrev_b32 v88, 16, v89
v_and_b32 v89, 0xffff0000, v89
buffer_store_dword v88, v14, s[40:43], 0 offen offset:2048 nt
buffer_store_dword v89, v14, s[40:43], s64 offen offset:2048 nt
v_cvt_pk_bf16_f32 v91, v65, v49
v_lshlrev_b32 v90, 16, v91
v_and_b32 v91, 0xffff0000, v91
buffer_store_dword v90, v14, s[40:43], 0 offen offset:2176 nt
buffer_store_dword v91, v14, s[40:43], s64 offen offset:2176 nt
v_cvt_pk_bf16_f32 v93, v66, v50
v_lshlrev_b32 v92, 16, v93
v_and_b32 v93, 0xffff0000, v93
buffer_store_dword v92, v14, s[40:43], 0 offen offset:2304 nt
buffer_store_dword v93, v14, s[40:43], s64 offen offset:2304 nt
v_cvt_pk_bf16_f32 v95, v67, v51
v_lshlrev_b32 v94, 16, v95
v_and_b32 v95, 0xffff0000, v95
buffer_store_dword v94, v14, s[40:43], 0 offen offset:2432 nt
buffer_store_dword v95, v14, s[40:43], s64 offen offset:2432 nt
v_cvt_pk_bf16_f32 v97, v68, v52
v_lshlrev_b32 v96, 16, v97
v_and_b32 v97, 0xffff0000, v97
buffer_store_dword v96, v14, s[40:43], 0 offen offset:3072 nt
buffer_store_dword v97, v14, s[40:43], s64 offen offset:3072 nt
v_cvt_pk_bf16_f32 v99, v69, v53
v_lshlrev_b32 v98, 16, v99
v_and_b32 v99, 0xffff0000, v99
buffer_store_dword v98, v14, s[40:43], 0 offen offset:3200 nt
buffer_store_dword v99, v14, s[40:43], s64 offen offset:3200 nt
v_cvt_pk_bf16_f32 v101, v70, v54
v_lshlrev_b32 v100, 16, v101
v_and_b32 v101, 0xffff0000, v101
buffer_store_dword v100, v14, s[40:43], 0 offen offset:3328 nt
buffer_store_dword v101, v14, s[40:43], s64 offen offset:3328 nt
v_cvt_pk_bf16_f32 v103, v71, v55
v_lshlrev_b32 v102, 16, v103
v_and_b32 v103, 0xffff0000, v103
buffer_store_dword v102, v14, s[40:43], 0 offen offset:3456 nt
buffer_store_dword v103, v14, s[40:43], s64 offen offset:3456 nt
s_endpgm
L_concat_heads__spectral_gfnet__ssm_conv_s5__prompt_kernel_gemm:
s_lshr_b32 s68, s34, 1
s_and_b32 s66, s34, 1
s_lshr_b32 s101, s36, 3
v_and_b32 v6, 31, v1
v_lshrrev_b32 v5, 5, v1
v_lshlrev_b32 v11, 4, v1
v_mov_b64 v[64:65], 0
v_mov_b64 v[66:67], 0
s_mul_i32 s60, s34, 2304
s_add_u32 s60, s60, 114688
v_add_u32 v13, s60, v11
v_mov_b32 v12, 126976
ds_write_b128 v13, v[64:67]
ds_write_b128 v13, v[64:67] offset:1024
ds_write_b128 v13, v[64:67] offset:2048
s_mov_b64 exec, 1
ds_write_b128 v12, v[64:67]
ds_write_b128 v12, v[64:67] offset:16
ds_write_b128 v12, v[64:67] offset:32
ds_write_b128 v12, v[64:67] offset:48
ds_write_b128 v12, v[64:67] offset:64
s_mov_b64 exec, -1
s_lshl_b32 s60, s34, 2
v_add_u32 v13, s60, v12
s_waitcnt lgkmcnt(0)
s_barrier
v_bfe_u32 v4, v1, 2, 2
v_lshlrev_b32 v4, 3, v4
v_and_b32 v7, 3, v1
v_add_u32 v4, v4, v7
s_lshl_b32 s60, s36, 6
s_lshl_b32 s61, s66, 5
s_add_u32 s60, s60, s61
v_add_u32 v4, s60, v4
v_lshlrev_b32 v7, 1, v4
v_lshrrev_b32 v14, 5, v1
v_bfe_u32 v15, v1, 3, 2
v_and_b32 v16, 1, v15
v_lshrrev_b32 v17, 1, v15
v_lshlrev_b32 v18, 4, v14
v_lshl_add_u32 v18, v16, 3, v18
v_add_u32 v18, v18, v17
s_lshl_b32 s61, s68, 6
s_lshl_b32 s62, s66, 2
s_add_u32 s61, s61, s62
v_add_u32 v18, s61, v18
v_lshlrev_b32 v18, 11, v18
s_lshl_b32 s61, s68, 5
v_lshl_add_u32 v19, v14, 3, v15
v_add_u32 v19, s61, v19
v_lshlrev_b32 v19, 11, v19
v_and_b32 v16, 7, v1
v_lshrrev_b32 v17, 4, v1
v_xor_b32 v16, v16, v17
v_lshlrev_b32 v16, 4, v16
v_xor_b32 v17, 64, v16
v_add_u32 v244, v18, v16
v_add_u32 v245, v18, v17
v_add_u32 v245, 64512, v245
v_add_u32 v246, v19, v16
v_add_u32 v247, v19, v17
v_add_u32 v247, 31744, v247
s_mul_i32 s38, s35, 128
s_mul_i32 s60, s36, 128
s_add_u32 s38, s38, s60
s_lshl_b32 s60, s35, 18
s_lshl_b32 s61, s36, 17
s_lshl_b32 s39, s34, 12
s_waitcnt lgkmcnt(0)
global_load_ushort v248, v7, s[12:13] offset:0
global_load_ushort v249, v7, s[14:15] offset:0
global_load_ushort v250, v7, s[24:25] offset:0
global_load_ushort v251, v7, s[12:13] offset:8
global_load_ushort v252, v7, s[14:15] offset:8
global_load_ushort v253, v7, s[24:25] offset:8
s_add_u32 s48, s10, s60
s_addc_u32 s49, s11, 0
s_mov_b32 s50, 262144
s_mov_b32 s51, 0x20000
s_cmp_eq_u32 s66, 1
s_cselect_b32 s62, s18, s16
s_cselect_b32 s63, s19, s17
s_add_u32 s52, s62, s61
s_addc_u32 s53, s63, 0
s_mov_b32 s54, 131072
s_mov_b32 s55, 0x20000
s_add_u32 s62, s38, 0
s_and_b32 s62, s62, 0x7ff
s_add_u32 s63, s62, 2048
s_add_u32 s64, s62, 6144
s_add_u32 m0, s39, 0
s_nop 0
buffer_load_dwordx4 v244, s[48:51], s62 offen offset:0 lds
buffer_load_dwordx4 v245, s[48:51], s62 offen offset:1024 lds
buffer_load_dwordx4 v244, s[48:51], s63 offen offset:2048 lds
buffer_load_dwordx4 v245, s[48:51], s63 offen offset:3072 lds
s_add_u32 m0, s39, 16384
s_nop 0
buffer_load_dwordx4 v246, s[52:55], s62 offen offset:0 lds
buffer_load_dwordx4 v247, s[52:55], s62 offen offset:1024 lds
buffer_load_dwordx4 v246, s[52:55], s64 offen offset:2048 lds
buffer_load_dwordx4 v247, s[52:55], s64 offen offset:3072 lds
v_bfe_u32 v7, v1, 4, 1
v_lshl_add_u32 v4, v7, 2, v4
v_bfe_u32 v7, v6, 1, 3
v_xor_b32 v7, v7, v5
v_lshlrev_b32 v7, 4, v7
v_lshl_add_u32 v7, v6, 7, v7
v_and_b32 v8, 15, v1
v_lshrrev_b32 v9, 4, v1
v_lshrrev_b32 v14, 1, v8
v_xor_b32 v14, v14, v9
v_lshlrev_b32 v14, 4, v14
v_lshl_add_u32 v14, v8, 7, v14
s_lshl_b32 s60, s68, 13
s_lshl_b32 s61, s66, 13
s_add_u32 s61, s61, 16384
v_xor_b32 v15, 0, v14
v_add_u32 v128, s60, v15
v_add_u32 v130, s61, v15
v_add_u32 v132, 0x10000, v128
v_add_u32 v134, 0x10000, v130
v_xor_b32 v15, 64, v14
v_add_u32 v129, s60, v15
v_add_u32 v131, s61, v15
v_add_u32 v133, 0x10000, v129
v_add_u32 v135, 0x10000, v131
s_add_u32 s40, s32, 65536
s_addc_u32 s41, s33, 0
s_mov_b32 s42, 262144
s_mov_b32 s43, 0x20000
s_add_u32 s44, s32, 1048576
s_addc_u32 s45, s33, 0
s_mov_b32 s46, 8388608
s_mov_b32 s47, 0x20000
s_mul_i32 s60, s66, 4608
s_add_u32 s60, s60, 114752
s_lshl_b32 s61, s68, 5
s_add_u32 s61, s61, s60
v_mul_u32_u24 v14, 144, v6
v_add_u32 v14, s60, v14
v_lshl_add_u32 v14, v5, 5, v14
v_mul_u32_u24 v15, 144, v8
v_add_u32 v15, s61, v15
v_lshl_add_u32 v15, v9, 3, v15
s_lshl_b32 s60, s35, 14
v_lshl_add_u32 v16, v4, 4, s60
v_mov_b32 v17, 0x40000000
v_lshlrev_b32 v10, 14, v5
v_sub_u32 v10, v16, v10
v_subrev_u32 v136, 16384, v10
v_cmp_le_i32 vcc, 0, v136
s_nop 1
v_cndmask_b32 v136, v17, v136, vcc
v_subrev_u32 v137, 49152, v10
v_cmp_le_i32 vcc, 0, v137
s_nop 1
v_cndmask_b32 v137, v17, v137, vcc
v_subrev_u32 v138, 81920, v10
v_cmp_le_i32 vcc, 0, v138
s_nop 1
v_cndmask_b32 v138, v17, v138, vcc
v_subrev_u32 v139, 114688, v10
v_cmp_le_i32 vcc, 0, v139
s_nop 1
v_cndmask_b32 v139, v17, v139, vcc
v_subrev_u32 v140, 147456, v10
v_cmp_le_i32 vcc, 0, v140
s_nop 1
v_cndmask_b32 v140, v17, v140, vcc
v_subrev_u32 v141, 180224, v10
v_cmp_le_i32 vcc, 0, v141
s_nop 1
v_cndmask_b32 v141, v17, v141, vcc
v_subrev_u32 v142, 212992, v10
v_cmp_le_i32 vcc, 0, v142
s_nop 1
v_cndmask_b32 v142, v17, v142, vcc
v_subrev_u32 v143, 245760, v10
v_cmp_le_i32 vcc, 0, v143
s_nop 1
v_cndmask_b32 v143, v17, v143, vcc
v_lshlrev_b32 v17, 30, v5
v_or_b32 v16, v16, v17
s_lshl_b32 s60, s35, 11
s_add_u32 s60, s60, 32768
s_lshl_b32 s61, s36, 7
s_add_u32 s61, s61, s60
v_mov_b32 v195, s61
s_lshl_b32 s61, s101, 10
s_add_u32 s60, s60, s61
v_and_b32 v196, 7, v1
v_lshl_add_u32 v196, v196, 7, s60
s_lshl_b32 s60, s35, 1
s_add_u32 s60, s60, s68
s_lshl_b32 s60, s60, 12
s_add_u32 s60, s60, 393216
s_lshl_b32 s61, s101, 11
s_add_u32 s61, s61, s60
v_lshl_add_u32 v18, v8, 7, s61
s_lshl_b32 s61, s36, 8
s_add_u32 s60, s60, s61
s_lshl_b32 s61, s66, 7
s_add_u32 s60, s60, s61
v_mov_b32 v19, s60
v_lshrrev_b32 v10, 1, v9
v_lshlrev_b32 v10, 10, v10
v_and_b32 v17, 1, v9
v_lshl_add_u32 v10, v17, 9, v10
v_lshl_add_u32 v10, v8, 4, v10
s_lshl_b32 s60, s68, 2
v_add_u32 v9, s60, v9
v_cvt_f32_u32 v9, v9
v_mul_f32 v9, 0x41800000, v9
v_add_f32 v8, 0x41000000, v9
s_add_u32 s62, s38, 128
s_and_b32 s62, s62, 0x7ff
s_add_u32 s63, s62, 2048
s_add_u32 s64, s62, 6144
s_add_u32 m0, s39, 32768
s_nop 0
buffer_load_dwordx4 v244, s[48:51], s62 offen offset:0 lds
buffer_load_dwordx4 v245, s[48:51], s62 offen offset:1024 lds
buffer_load_dwordx4 v244, s[48:51], s63 offen offset:2048 lds
buffer_load_dwordx4 v245, s[48:51], s63 offen offset:3072 lds
s_add_u32 m0, s39, 49152
s_nop 0
buffer_load_dwordx4 v246, s[52:55], s62 offen offset:0 lds
buffer_load_dwordx4 v247, s[52:55], s62 offen offset:1024 lds
buffer_load_dwordx4 v246, s[52:55], s64 offen offset:2048 lds
buffer_load_dwordx4 v247, s[52:55], s64 offen offset:3072 lds
s_setprio 0
s_waitcnt vmcnt(8)
s_barrier
ds_read_b128 v[32:35], v128 offset:0
ds_read_b128 v[48:51], v130 offset:0
ds_read_b128 v[52:55], v130 offset:2048
ds_read_b128 v[56:59], v130 offset:4096
ds_read_b128 v[60:63], v130 offset:6144
ds_read_b128 v[36:39], v128 offset:2048
ds_read_b128 v[40:43], v128 offset:4096
ds_read_b128 v[44:47], v128 offset:6144
s_waitcnt lgkmcnt(6)
v_mfma_f32_16x16x32_bf16 v[64:67], v[32:35], v[48:51], 0
ds_read_b128 v[144:147], v129 offset:0
s_waitcnt lgkmcnt(6)
v_mfma_f32_16x16x32_bf16 v[96:99], v[32:35], v[52:55], 0
ds_read_b128 v[160:163], v131 offset:0
s_waitcnt lgkmcnt(6)
v_mfma_f32_16x16x32_bf16 v[80:83], v[32:35], v[56:59], 0
ds_read_b128 v[164:167], v131 offset:2048
s_waitcnt lgkmcnt(6)
v_mfma_f32_16x16x32_bf16 v[112:115], v[32:35], v[60:63], 0
ds_read_b128 v[168:171], v131 offset:4096
s_waitcnt lgkmcnt(6)
v_mfma_f32_16x16x32_bf16 v[68:71], v[36:39], v[48:51], 0
ds_read_b128 v[172:175], v131 offset:6144
v_mfma_f32_16x16x32_bf16 v[100:103], v[36:39], v[52:55], 0
ds_read_b128 v[148:151], v129 offset:2048
v_mfma_f32_16x16x32_bf16 v[84:87], v[36:39], v[56:59], 0
ds_read_b128 v[152:155], v129 offset:4096
v_mfma_f32_16x16x32_bf16 v[116:119], v[36:39], v[60:63], 0
ds_read_b128 v[156:159], v129 offset:6144
s_waitcnt lgkmcnt(9)
v_mfma_f32_16x16x32_bf16 v[72:75], v[40:43], v[48:51], 0
v_lshlrev_b32 v248, 16, v248
v_lshlrev_b32 v249, 16, v249
v_mfma_f32_16x16x32_bf16 v[104:107], v[40:43], v[52:55], 0
v_lshlrev_b32 v250, 16, v250
v_mul_f32 v250, 0x3fb8aa3b, v250
v_mfma_f32_16x16x32_bf16 v[88:91], v[40:43], v[56:59], 0
v_exp_f32 v250, v250
s_nop 0
v_cvt_pk_bf16_f32 v250, v250, v250
v_mfma_f32_16x16x32_bf16 v[120:123], v[40:43], v[60:63], 0
v_lshlrev_b32 v250, 16, v250
v_mul_f32 v204, v250, v248
s_waitcnt lgkmcnt(8)
v_mfma_f32_16x16x32_bf16 v[76:79], v[44:47], v[48:51], 0
v_mul_f32 v206, v250, v249
v_mul_f32 v204, 0x3fb8aa3b, v204
v_mfma_f32_16x16x32_bf16 v[108:111], v[44:47], v[52:55], 0
v_mul_f32 v206, 0.15915494, v206
v_mul_f32 v197, 0x3f800000, v204
v_mfma_f32_16x16x32_bf16 v[92:95], v[44:47], v[56:59], 0
v_mul_f32 v198, 0x3f800000, v206
v_exp_f32 v197, v197
v_mfma_f32_16x16x32_bf16 v[124:127], v[44:47], v[60:63], 0
v_rndne_f32 v199, v198
v_sub_f32 v198, v198, v199
s_waitcnt vmcnt(0) lgkmcnt(0)
s_barrier
v_mfma_f32_16x16x32_bf16 v[64:67], v[144:147], v[160:163], v[64:67]
ds_read_b128 v[32:35], v128 offset:32768
v_mfma_f32_16x16x32_bf16 v[96:99], v[144:147], v[164:167], v[96:99]
ds_read_b128 v[48:51], v130 offset:32768
v_mfma_f32_16x16x32_bf16 v[80:83], v[144:147], v[168:171], v[80:83]
ds_read_b128 v[52:55], v130 offset:34816
v_mfma_f32_16x16x32_bf16 v[112:115], v[144:147], v[172:175], v[112:115]
ds_read_b128 v[56:59], v130 offset:36864
v_mfma_f32_16x16x32_bf16 v[68:71], v[148:151], v[160:163], v[68:71]
ds_read_b128 v[60:63], v130 offset:38912
v_mfma_f32_16x16x32_bf16 v[100:103], v[148:151], v[164:167], v[100:103]
ds_read_b128 v[36:39], v128 offset:34816
v_mfma_f32_16x16x32_bf16 v[84:87], v[148:151], v[168:171], v[84:87]
ds_read_b128 v[40:43], v128 offset:36864
v_mfma_f32_16x16x32_bf16 v[116:119], v[148:151], v[172:175], v[116:119]
ds_read_b128 v[44:47], v128 offset:38912
v_mfma_f32_16x16x32_bf16 v[72:75], v[152:155], v[160:163], v[72:75]
v_cos_f32 v199, v198
v_sin_f32 v198, v198
v_mfma_f32_16x16x32_bf16 v[104:107], v[152:155], v[164:167], v[104:107]
v_mul_f32 v20, v197, v199
v_mul_f32 v21, v197, v198
v_mfma_f32_16x16x32_bf16 v[88:91], v[152:155], v[168:171], v[88:91]
v_add_f32 v197, -1.0, v20
v_mul_f32 v198, v248, v248
v_mfma_f32_16x16x32_bf16 v[120:123], v[152:155], v[172:175], v[120:123]
v_fma_f32 v198, v249, v249, v198
v_rcp_f32 v198, v198
v_mfma_f32_16x16x32_bf16 v[76:79], v[156:159], v[160:163], v[76:79]
v_add_f32 v198, v198, v198
v_mul_f32 v199, v197, v248
v_mfma_f32_16x16x32_bf16 v[108:111], v[156:159], v[164:167], v[108:111]
v_fma_f32 v199, v21, v249, v199
v_mul_f32 v24, v199, v198
v_mfma_f32_16x16x32_bf16 v[92:95], v[156:159], v[168:171], v[92:95]
v_mul_f32 v199, v21, v248
v_fma_f32 v199, -v197, v249, v199
v_mfma_f32_16x16x32_bf16 v[124:127], v[156:159], v[172:175], v[124:127]
v_mul_f32 v25, v199, v198
v_mul_f32 v197, 0x41000000, v204
s_waitcnt lgkmcnt(6)
v_mfma_f32_16x16x32_bf16 v[64:67], v[32:35], v[48:51], v[64:67]
ds_read_b128 v[144:147], v129 offset:32768
s_waitcnt lgkmcnt(6)
v_mfma_f32_16x16x32_bf16 v[96:99], v[32:35], v[52:55], v[96:99]
ds_read_b128 v[160:163], v131 offset:32768
s_waitcnt lgkmcnt(6)
v_mfma_f32_16x16x32_bf16 v[80:83], v[32:35], v[56:59], v[80:83]
ds_read_b128 v[164:167], v131 offset:34816
s_waitcnt lgkmcnt(6)
v_mfma_f32_16x16x32_bf16 v[112:115], v[32:35], v[60:63], v[112:115]
ds_read_b128 v[168:171], v131 offset:36864
s_waitcnt lgkmcnt(6)
v_mfma_f32_16x16x32_bf16 v[68:71], v[36:39], v[48:51], v[68:71]
ds_read_b128 v[172:175], v131 offset:38912
v_mfma_f32_16x16x32_bf16 v[100:103], v[36:39], v[52:55], v[100:103]
ds_read_b128 v[148:151], v129 offset:34816
v_mfma_f32_16x16x32_bf16 v[84:87], v[36:39], v[56:59], v[84:87]
ds_read_b128 v[152:155], v129 offset:36864
v_mfma_f32_16x16x32_bf16 v[116:119], v[36:39], v[60:63], v[116:119]
ds_read_b128 v[156:159], v129 offset:38912
s_waitcnt lgkmcnt(9)
v_mfma_f32_16x16x32_bf16 v[72:75], v[40:43], v[48:51], v[72:75]
v_mul_f32 v198, 0x41000000, v206
v_exp_f32 v197, v197
v_mfma_f32_16x16x32_bf16 v[104:107], v[40:43], v[52:55], v[104:107]
v_rndne_f32 v199, v198
v_sub_f32 v198, v198, v199
v_mfma_f32_16x16x32_bf16 v[88:91], v[40:43], v[56:59], v[88:91]
v_cos_f32 v199, v198
v_sin_f32 v198, v198
v_mfma_f32_16x16x32_bf16 v[120:123], v[40:43], v[60:63], v[120:123]
v_mul_f32 v176, v197, v199
v_mul_f32 v177, v197, v198
s_waitcnt lgkmcnt(8)
v_mfma_f32_16x16x32_bf16 v[76:79], v[44:47], v[48:51], v[76:79]
v_mul_f32 v197, 0x41800000, v204
v_mul_f32 v198, 0x41800000, v206
v_mfma_f32_16x16x32_bf16 v[108:111], v[44:47], v[52:55], v[108:111]
v_exp_f32 v197, v197
v_rndne_f32 v199, v198
v_mfma_f32_16x16x32_bf16 v[92:95], v[44:47], v[56:59], v[92:95]
v_sub_f32 v198, v198, v199
v_cos_f32 v199, v198
v_mfma_f32_16x16x32_bf16 v[124:127], v[44:47], v[60:63], v[124:127]
v_sin_f32 v198, v198
v_mul_f32 v180, v197, v199
s_waitcnt lgkmcnt(0)
s_barrier
v_mfma_f32_16x16x32_bf16 v[64:67], v[144:147], v[160:163], v[64:67]
ds_read_b128 v[32:35], v132 offset:0
v_mfma_f32_16x16x32_bf16 v[96:99], v[144:147], v[164:167], v[96:99]
ds_read_b128 v[48:51], v134 offset:0
v_mfma_f32_16x16x32_bf16 v[80:83], v[144:147], v[168:171], v[80:83]
ds_read_b128 v[52:55], v134 offset:2048
v_mfma_f32_16x16x32_bf16 v[112:115], v[144:147], v[172:175], v[112:115]
ds_read_b128 v[56:59], v134 offset:4096
v_mfma_f32_16x16x32_bf16 v[68:71], v[148:151], v[160:163], v[68:71]
ds_read_b128 v[60:63], v134 offset:6144
v_mfma_f32_16x16x32_bf16 v[100:103], v[148:151], v[164:167], v[100:103]
ds_read_b128 v[36:39], v132 offset:2048
v_mfma_f32_16x16x32_bf16 v[84:87], v[148:151], v[168:171], v[84:87]
ds_read_b128 v[40:43], v132 offset:4096
v_mfma_f32_16x16x32_bf16 v[116:119], v[148:151], v[172:175], v[116:119]
ds_read_b128 v[44:47], v132 offset:6144
v_mfma_f32_16x16x32_bf16 v[72:75], v[152:155], v[160:163], v[72:75]
v_mul_f32 v181, v197, v198
v_mul_f32 v197, v9, v204
v_mfma_f32_16x16x32_bf16 v[104:107], v[152:155], v[164:167], v[104:107]
v_mul_f32 v198, v9, v206
v_exp_f32 v197, v197
v_mfma_f32_16x16x32_bf16 v[88:91], v[152:155], v[168:171], v[88:91]
v_rndne_f32 v199, v198
v_sub_f32 v198, v198, v199
v_mfma_f32_16x16x32_bf16 v[120:123], v[152:155], v[172:175], v[120:123]
v_cos_f32 v199, v198
v_sin_f32 v198, v198
v_mfma_f32_16x16x32_bf16 v[76:79], v[156:159], v[160:163], v[76:79]
v_mul_f32 v200, v197, v199
v_mul_f32 v201, v197, v198
v_mfma_f32_16x16x32_bf16 v[108:111], v[156:159], v[164:167], v[108:111]
v_mov_b32 v184, v200
v_mov_b32 v186, v201
v_mfma_f32_16x16x32_bf16 v[92:95], v[156:159], v[168:171], v[92:95]
v_mul_f32 v197, v8, v204
v_mul_f32 v198, v8, v206
v_mfma_f32_16x16x32_bf16 v[124:127], v[156:159], v[172:175], v[124:127]
v_exp_f32 v197, v197
v_rndne_f32 v199, v198
s_waitcnt lgkmcnt(6)
v_mfma_f32_16x16x32_bf16 v[64:67], v[32:35], v[48:51], v[64:67]
ds_read_b128 v[144:147], v133 offset:0
s_waitcnt lgkmcnt(6)
v_mfma_f32_16x16x32_bf16 v[96:99], v[32:35], v[52:55], v[96:99]
ds_read_b128 v[160:163], v135 offset:0
s_waitcnt lgkmcnt(6)
v_mfma_f32_16x16x32_bf16 v[80:83], v[32:35], v[56:59], v[80:83]
ds_read_b128 v[164:167], v135 offset:2048
s_waitcnt lgkmcnt(6)
v_mfma_f32_16x16x32_bf16 v[112:115], v[32:35], v[60:63], v[112:115]
ds_read_b128 v[168:171], v135 offset:4096
s_waitcnt lgkmcnt(6)
v_mfma_f32_16x16x32_bf16 v[68:71], v[36:39], v[48:51], v[68:71]
ds_read_b128 v[172:175], v135 offset:6144
v_mfma_f32_16x16x32_bf16 v[100:103], v[36:39], v[52:55], v[100:103]
ds_read_b128 v[148:151], v133 offset:2048
v_mfma_f32_16x16x32_bf16 v[84:87], v[36:39], v[56:59], v[84:87]
ds_read_b128 v[152:155], v133 offset:4096
v_mfma_f32_16x16x32_bf16 v[116:119], v[36:39], v[60:63], v[116:119]
ds_read_b128 v[156:159], v133 offset:6144
s_waitcnt lgkmcnt(9)
v_mfma_f32_16x16x32_bf16 v[72:75], v[40:43], v[48:51], v[72:75]
v_sub_f32 v198, v198, v199
v_cos_f32 v199, v198
v_mfma_f32_16x16x32_bf16 v[104:107], v[40:43], v[52:55], v[104:107]
v_sin_f32 v198, v198
v_mul_f32 v200, v197, v199
v_mfma_f32_16x16x32_bf16 v[88:91], v[40:43], v[56:59], v[88:91]
v_mul_f32 v201, v197, v198
v_mov_b32 v185, v200
v_mfma_f32_16x16x32_bf16 v[120:123], v[40:43], v[60:63], v[120:123]
v_mov_b32 v187, v201
v_mul_f32 v197, v25, v21
s_waitcnt lgkmcnt(8)
v_mfma_f32_16x16x32_bf16 v[76:79], v[44:47], v[48:51], v[76:79]
v_mul_f32 v198, v25, v20
v_fma_f32 v208, v24, v20, -v197
v_mfma_f32_16x16x32_bf16 v[108:111], v[44:47], v[52:55], v[108:111]
v_fma_f32 v209, v24, v21, v198
v_mul_f32 v197, v209, v21
v_mfma_f32_16x16x32_bf16 v[92:95], v[44:47], v[56:59], v[92:95]
v_mul_f32 v198, v209, v20
v_fma_f32 v210, v208, v20, -v197
v_mfma_f32_16x16x32_bf16 v[124:127], v[44:47], v[60:63], v[124:127]
v_fma_f32 v211, v208, v21, v198
v_mul_f32 v197, v211, v21
s_waitcnt lgkmcnt(0)
s_barrier
v_mfma_f32_16x16x32_bf16 v[64:67], v[144:147], v[160:163], v[64:67]
ds_read_b128 v[32:35], v128 offset:0
v_mfma_f32_16x16x32_bf16 v[96:99], v[144:147], v[164:167], v[96:99]
ds_read_b128 v[48:51], v130 offset:0
v_mfma_f32_16x16x32_bf16 v[80:83], v[144:147], v[168:171], v[80:83]
ds_read_b128 v[52:55], v130 offset:2048
v_mfma_f32_16x16x32_bf16 v[112:115], v[144:147], v[172:175], v[112:115]
ds_read_b128 v[56:59], v130 offset:4096
v_mfma_f32_16x16x32_bf16 v[68:71], v[148:151], v[160:163], v[68:71]
ds_read_b128 v[60:63], v130 offset:6144
v_mfma_f32_16x16x32_bf16 v[100:103], v[148:151], v[164:167], v[100:103]
ds_read_b128 v[36:39], v128 offset:2048
v_mfma_f32_16x16x32_bf16 v[84:87], v[148:151], v[168:171], v[84:87]
ds_read_b128 v[40:43], v128 offset:4096
v_mfma_f32_16x16x32_bf16 v[116:119], v[148:151], v[172:175], v[116:119]
ds_read_b128 v[44:47], v128 offset:6144
v_mfma_f32_16x16x32_bf16 v[72:75], v[152:155], v[160:163], v[72:75]
v_mul_f32 v198, v211, v20
v_fma_f32 v212, v210, v20, -v197
v_mfma_f32_16x16x32_bf16 v[104:107], v[152:155], v[164:167], v[104:107]
v_fma_f32 v213, v210, v21, v198
v_mul_f32 v197, v213, v21
v_mfma_f32_16x16x32_bf16 v[88:91], v[152:155], v[168:171], v[88:91]
v_mul_f32 v198, v213, v20
v_fma_f32 v214, v212, v20, -v197
v_mfma_f32_16x16x32_bf16 v[120:123], v[152:155], v[172:175], v[120:123]
v_fma_f32 v215, v212, v21, v198
v_mul_f32 v197, v215, v21
v_mfma_f32_16x16x32_bf16 v[76:79], v[156:159], v[160:163], v[76:79]
v_mul_f32 v198, v215, v20
v_fma_f32 v216, v214, v20, -v197
v_mfma_f32_16x16x32_bf16 v[108:111], v[156:159], v[164:167], v[108:111]
v_fma_f32 v217, v214, v21, v198
v_mul_f32 v197, v217, v21
v_mfma_f32_16x16x32_bf16 v[92:95], v[156:159], v[168:171], v[92:95]
v_mul_f32 v198, v217, v20
v_fma_f32 v218, v216, v20, -v197
v_mfma_f32_16x16x32_bf16 v[124:127], v[156:159], v[172:175], v[124:127]
v_fma_f32 v219, v216, v21, v198
v_mul_f32 v197, v219, v21
s_waitcnt lgkmcnt(6)
v_mfma_f32_16x16x32_bf16 v[64:67], v[32:35], v[48:51], v[64:67]
ds_read_b128 v[144:147], v129 offset:0
s_waitcnt lgkmcnt(6)
v_mfma_f32_16x16x32_bf16 v[96:99], v[32:35], v[52:55], v[96:99]
ds_read_b128 v[160:163], v131 offset:0
s_waitcnt lgkmcnt(6)
v_mfma_f32_16x16x32_bf16 v[80:83], v[32:35], v[56:59], v[80:83]
ds_read_b128 v[164:167], v131 offset:2048
s_waitcnt lgkmcnt(6)
v_mfma_f32_16x16x32_bf16 v[112:115], v[32:35], v[60:63], v[112:115]
ds_read_b128 v[168:171], v131 offset:4096
s_waitcnt lgkmcnt(6)
v_mfma_f32_16x16x32_bf16 v[68:71], v[36:39], v[48:51], v[68:71]
ds_read_b128 v[172:175], v131 offset:6144
v_mfma_f32_16x16x32_bf16 v[100:103], v[36:39], v[52:55], v[100:103]
ds_read_b128 v[148:151], v129 offset:2048
v_mfma_f32_16x16x32_bf16 v[84:87], v[36:39], v[56:59], v[84:87]
ds_read_b128 v[152:155], v129 offset:4096
v_mfma_f32_16x16x32_bf16 v[116:119], v[36:39], v[60:63], v[116:119]
ds_read_b128 v[156:159], v129 offset:6144
s_waitcnt lgkmcnt(9)
v_mfma_f32_16x16x32_bf16 v[72:75], v[40:43], v[48:51], v[72:75]
v_mul_f32 v198, v219, v20
v_fma_f32 v220, v218, v20, -v197
v_mfma_f32_16x16x32_bf16 v[104:107], v[40:43], v[52:55], v[104:107]
v_fma_f32 v221, v218, v21, v198
v_mul_f32 v197, v221, v21
v_mfma_f32_16x16x32_bf16 v[88:91], v[40:43], v[56:59], v[88:91]
v_mul_f32 v198, v221, v20
v_fma_f32 v222, v220, v20, -v197
v_mfma_f32_16x16x32_bf16 v[120:123], v[40:43], v[60:63], v[120:123]
v_fma_f32 v223, v220, v21, v198
v_lshlrev_b32 v251, 16, v251
s_waitcnt lgkmcnt(8)
v_mfma_f32_16x16x32_bf16 v[76:79], v[44:47], v[48:51], v[76:79]
v_lshlrev_b32 v252, 16, v252
v_lshlrev_b32 v253, 16, v253
v_mfma_f32_16x16x32_bf16 v[108:111], v[44:47], v[52:55], v[108:111]
v_mul_f32 v253, 0x3fb8aa3b, v253
v_exp_f32 v253, v253
v_mfma_f32_16x16x32_bf16 v[92:95], v[44:47], v[56:59], v[92:95]
v_cvt_pk_bf16_f32 v253, v253, v253
v_lshlrev_b32 v253, 16, v253
v_mfma_f32_16x16x32_bf16 v[124:127], v[44:47], v[60:63], v[124:127]
v_mul_f32 v205, v253, v251
v_mul_f32 v207, v253, v252
s_waitcnt lgkmcnt(0)
s_barrier
v_mfma_f32_16x16x32_bf16 v[64:67], v[144:147], v[160:163], v[64:67]
ds_read_b128 v[32:35], v128 offset:32768
v_mfma_f32_16x16x32_bf16 v[96:99], v[144:147], v[164:167], v[96:99]
ds_read_b128 v[48:51], v130 offset:32768
v_mfma_f32_16x16x32_bf16 v[80:83], v[144:147], v[168:171], v[80:83]
ds_read_b128 v[52:55], v130 offset:34816
v_mfma_f32_16x16x32_bf16 v[112:115], v[144:147], v[172:175], v[112:115]
ds_read_b128 v[56:59], v130 offset:36864
v_mfma_f32_16x16x32_bf16 v[68:71], v[148:151], v[160:163], v[68:71]
ds_read_b128 v[60:63], v130 offset:38912
v_mfma_f32_16x16x32_bf16 v[100:103], v[148:151], v[164:167], v[100:103]
ds_read_b128 v[36:39], v128 offset:34816
v_mfma_f32_16x16x32_bf16 v[84:87], v[148:151], v[168:171], v[84:87]
ds_read_b128 v[40:43], v128 offset:36864
v_mfma_f32_16x16x32_bf16 v[116:119], v[148:151], v[172:175], v[116:119]
ds_read_b128 v[44:47], v128 offset:38912
v_mfma_f32_16x16x32_bf16 v[72:75], v[152:155], v[160:163], v[72:75]
v_mul_f32 v205, 0x3fb8aa3b, v205
v_mul_f32 v207, 0.15915494, v207
v_mfma_f32_16x16x32_bf16 v[104:107], v[152:155], v[164:167], v[104:107]
v_mul_f32 v197, 0x3f800000, v205
v_mul_f32 v198, 0x3f800000, v207
v_mfma_f32_16x16x32_bf16 v[88:91], v[152:155], v[168:171], v[88:91]
v_exp_f32 v197, v197
v_rndne_f32 v199, v198
v_mfma_f32_16x16x32_bf16 v[120:123], v[152:155], v[172:175], v[120:123]
v_sub_f32 v198, v198, v199
v_cos_f32 v199, v198
v_mfma_f32_16x16x32_bf16 v[76:79], v[156:159], v[160:163], v[76:79]
v_sin_f32 v198, v198
v_mul_f32 v22, v197, v199
v_mfma_f32_16x16x32_bf16 v[108:111], v[156:159], v[164:167], v[108:111]
v_mul_f32 v23, v197, v198
v_add_f32 v197, -1.0, v22
v_mfma_f32_16x16x32_bf16 v[92:95], v[156:159], v[168:171], v[92:95]
v_mul_f32 v198, v251, v251
v_fma_f32 v198, v252, v252, v198
v_mfma_f32_16x16x32_bf16 v[124:127], v[156:159], v[172:175], v[124:127]
v_rcp_f32 v198, v198
s_nop 0
v_add_f32 v198, v198, v198
s_waitcnt lgkmcnt(6)
v_mfma_f32_16x16x32_bf16 v[64:67], v[32:35], v[48:51], v[64:67]
ds_read_b128 v[144:147], v129 offset:32768
s_waitcnt lgkmcnt(6)
v_mfma_f32_16x16x32_bf16 v[96:99], v[32:35], v[52:55], v[96:99]
ds_read_b128 v[160:163], v131 offset:32768
s_waitcnt lgkmcnt(6)
v_mfma_f32_16x16x32_bf16 v[80:83], v[32:35], v[56:59], v[80:83]
ds_read_b128 v[164:167], v131 offset:34816
s_waitcnt lgkmcnt(6)
v_mfma_f32_16x16x32_bf16 v[112:115], v[32:35], v[60:63], v[112:115]
ds_read_b128 v[168:171], v131 offset:36864
s_waitcnt lgkmcnt(6)
v_mfma_f32_16x16x32_bf16 v[68:71], v[36:39], v[48:51], v[68:71]
ds_read_b128 v[172:175], v131 offset:38912
v_mfma_f32_16x16x32_bf16 v[100:103], v[36:39], v[52:55], v[100:103]
ds_read_b128 v[148:151], v129 offset:34816
v_mfma_f32_16x16x32_bf16 v[84:87], v[36:39], v[56:59], v[84:87]
ds_read_b128 v[152:155], v129 offset:36864
v_mfma_f32_16x16x32_bf16 v[116:119], v[36:39], v[60:63], v[116:119]
ds_read_b128 v[156:159], v129 offset:38912
s_waitcnt lgkmcnt(9)
v_mfma_f32_16x16x32_bf16 v[72:75], v[40:43], v[48:51], v[72:75]
v_mul_f32 v199, v197, v251
v_fma_f32 v199, v23, v252, v199
v_mfma_f32_16x16x32_bf16 v[104:107], v[40:43], v[52:55], v[104:107]
v_mul_f32 v26, v199, v198
v_mul_f32 v199, v23, v251
v_mfma_f32_16x16x32_bf16 v[88:91], v[40:43], v[56:59], v[88:91]
v_fma_f32 v199, -v197, v252, v199
v_mul_f32 v27, v199, v198
v_mfma_f32_16x16x32_bf16 v[120:123], v[40:43], v[60:63], v[120:123]
v_mul_f32 v197, 0x41000000, v205
v_mul_f32 v198, 0x41000000, v207
s_waitcnt lgkmcnt(8)
v_mfma_f32_16x16x32_bf16 v[76:79], v[44:47], v[48:51], v[76:79]
v_exp_f32 v197, v197
v_rndne_f32 v199, v198
v_mfma_f32_16x16x32_bf16 v[108:111], v[44:47], v[52:55], v[108:111]
v_sub_f32 v198, v198, v199
v_cos_f32 v199, v198
v_mfma_f32_16x16x32_bf16 v[92:95], v[44:47], v[56:59], v[92:95]
v_sin_f32 v198, v198
v_mul_f32 v178, v197, v199
v_mfma_f32_16x16x32_bf16 v[124:127], v[44:47], v[60:63], v[124:127]
v_mul_f32 v179, v197, v198
v_mul_f32 v197, 0x41800000, v205
s_waitcnt lgkmcnt(0)
s_barrier
v_mfma_f32_16x16x32_bf16 v[64:67], v[144:147], v[160:163], v[64:67]
ds_read_b128 v[32:35], v132 offset:0
v_mfma_f32_16x16x32_bf16 v[96:99], v[144:147], v[164:167], v[96:99]
ds_read_b128 v[48:51], v134 offset:0
v_mfma_f32_16x16x32_bf16 v[80:83], v[144:147], v[168:171], v[80:83]
ds_read_b128 v[52:55], v134 offset:2048
v_mfma_f32_16x16x32_bf16 v[112:115], v[144:147], v[172:175], v[112:115]
ds_read_b128 v[56:59], v134 offset:4096
v_mfma_f32_16x16x32_bf16 v[68:71], v[148:151], v[160:163], v[68:71]
ds_read_b128 v[60:63], v134 offset:6144
v_mfma_f32_16x16x32_bf16 v[100:103], v[148:151], v[164:167], v[100:103]
ds_read_b128 v[36:39], v132 offset:2048
v_mfma_f32_16x16x32_bf16 v[84:87], v[148:151], v[168:171], v[84:87]
ds_read_b128 v[40:43], v132 offset:4096
v_mfma_f32_16x16x32_bf16 v[116:119], v[148:151], v[172:175], v[116:119]
ds_read_b128 v[44:47], v132 offset:6144
v_mfma_f32_16x16x32_bf16 v[72:75], v[152:155], v[160:163], v[72:75]
v_mul_f32 v198, 0x41800000, v207
v_exp_f32 v197, v197
v_mfma_f32_16x16x32_bf16 v[104:107], v[152:155], v[164:167], v[104:107]
v_rndne_f32 v199, v198
v_sub_f32 v198, v198, v199
v_mfma_f32_16x16x32_bf16 v[88:91], v[152:155], v[168:171], v[88:91]
v_cos_f32 v199, v198
v_sin_f32 v198, v198
v_mfma_f32_16x16x32_bf16 v[120:123], v[152:155], v[172:175], v[120:123]
v_mul_f32 v182, v197, v199
v_mul_f32 v183, v197, v198
v_mfma_f32_16x16x32_bf16 v[76:79], v[156:159], v[160:163], v[76:79]
v_mul_f32 v197, v9, v205
v_mul_f32 v198, v9, v207
v_mfma_f32_16x16x32_bf16 v[108:111], v[156:159], v[164:167], v[108:111]
v_exp_f32 v197, v197
v_rndne_f32 v199, v198
v_mfma_f32_16x16x32_bf16 v[92:95], v[156:159], v[168:171], v[92:95]
v_sub_f32 v198, v198, v199
v_cos_f32 v199, v198
v_mfma_f32_16x16x32_bf16 v[124:127], v[156:159], v[172:175], v[124:127]
v_sin_f32 v198, v198
v_mul_f32 v200, v197, v199
s_waitcnt lgkmcnt(6)
v_mfma_f32_16x16x32_bf16 v[64:67], v[32:35], v[48:51], v[64:67]
ds_read_b128 v[144:147], v133 offset:0
s_waitcnt lgkmcnt(6)
v_mfma_f32_16x16x32_bf16 v[96:99], v[32:35], v[52:55], v[96:99]
ds_read_b128 v[160:163], v135 offset:0
s_waitcnt lgkmcnt(6)
v_mfma_f32_16x16x32_bf16 v[80:83], v[32:35], v[56:59], v[80:83]
ds_read_b128 v[164:167], v135 offset:2048
s_waitcnt lgkmcnt(6)
v_mfma_f32_16x16x32_bf16 v[112:115], v[32:35], v[60:63], v[112:115]
ds_read_b128 v[168:171], v135 offset:4096
s_waitcnt lgkmcnt(6)
v_mfma_f32_16x16x32_bf16 v[68:71], v[36:39], v[48:51], v[68:71]
ds_read_b128 v[172:175], v135 offset:6144
v_mfma_f32_16x16x32_bf16 v[100:103], v[36:39], v[52:55], v[100:103]
ds_read_b128 v[148:151], v133 offset:2048
v_mfma_f32_16x16x32_bf16 v[84:87], v[36:39], v[56:59], v[84:87]
ds_read_b128 v[152:155], v133 offset:4096
v_mfma_f32_16x16x32_bf16 v[116:119], v[36:39], v[60:63], v[116:119]
ds_read_b128 v[156:159], v133 offset:6144
s_waitcnt lgkmcnt(9)
v_mfma_f32_16x16x32_bf16 v[72:75], v[40:43], v[48:51], v[72:75]
v_mul_f32 v201, v197, v198
v_mov_b32 v188, v200
v_mfma_f32_16x16x32_bf16 v[104:107], v[40:43], v[52:55], v[104:107]
v_mov_b32 v190, v201
v_mul_f32 v197, v8, v205
v_mfma_f32_16x16x32_bf16 v[88:91], v[40:43], v[56:59], v[88:91]
v_mul_f32 v198, v8, v207
v_exp_f32 v197, v197
v_mfma_f32_16x16x32_bf16 v[120:123], v[40:43], v[60:63], v[120:123]
v_rndne_f32 v199, v198
v_sub_f32 v198, v198, v199
s_waitcnt lgkmcnt(8)
v_mfma_f32_16x16x32_bf16 v[76:79], v[44:47], v[48:51], v[76:79]
v_cos_f32 v199, v198
v_sin_f32 v198, v198
v_mfma_f32_16x16x32_bf16 v[108:111], v[44:47], v[52:55], v[108:111]
v_mul_f32 v200, v197, v199
v_mul_f32 v201, v197, v198
v_mfma_f32_16x16x32_bf16 v[92:95], v[44:47], v[56:59], v[92:95]
v_mov_b32 v189, v200
v_mov_b32 v191, v201
v_mfma_f32_16x16x32_bf16 v[124:127], v[44:47], v[60:63], v[124:127]
v_mul_f32 v197, v27, v23
v_mul_f32 v198, v27, v22
s_waitcnt lgkmcnt(0)
s_barrier
v_mfma_f32_16x16x32_bf16 v[64:67], v[144:147], v[160:163], v[64:67]
ds_read_b128 v[32:35], v128 offset:0
v_mfma_f32_16x16x32_bf16 v[96:99], v[144:147], v[164:167], v[96:99]
ds_read_b128 v[48:51], v130 offset:0
v_mfma_f32_16x16x32_bf16 v[80:83], v[144:147], v[168:171], v[80:83]
ds_read_b128 v[52:55], v130 offset:2048
v_mfma_f32_16x16x32_bf16 v[112:115], v[144:147], v[172:175], v[112:115]
ds_read_b128 v[56:59], v130 offset:4096
v_mfma_f32_16x16x32_bf16 v[68:71], v[148:151], v[160:163], v[68:71]
ds_read_b128 v[60:63], v130 offset:6144
v_mfma_f32_16x16x32_bf16 v[100:103], v[148:151], v[164:167], v[100:103]
ds_read_b128 v[36:39], v128 offset:2048
v_mfma_f32_16x16x32_bf16 v[84:87], v[148:151], v[168:171], v[84:87]
ds_read_b128 v[40:43], v128 offset:4096
v_mfma_f32_16x16x32_bf16 v[116:119], v[148:151], v[172:175], v[116:119]
ds_read_b128 v[44:47], v128 offset:6144
v_mfma_f32_16x16x32_bf16 v[72:75], v[152:155], v[160:163], v[72:75]
v_fma_f32 v224, v26, v22, -v197
v_fma_f32 v225, v26, v23, v198
v_mfma_f32_16x16x32_bf16 v[104:107], v[152:155], v[164:167], v[104:107]
v_mul_f32 v197, v225, v23
v_mul_f32 v198, v225, v22
v_mfma_f32_16x16x32_bf16 v[88:91], v[152:155], v[168:171], v[88:91]
v_fma_f32 v226, v224, v22, -v197
v_fma_f32 v227, v224, v23, v198
v_mfma_f32_16x16x32_bf16 v[120:123], v[152:155], v[172:175], v[120:123]
v_mul_f32 v197, v227, v23
v_mul_f32 v198, v227, v22
v_mfma_f32_16x16x32_bf16 v[76:79], v[156:159], v[160:163], v[76:79]
v_fma_f32 v228, v226, v22, -v197
v_fma_f32 v229, v226, v23, v198
v_mfma_f32_16x16x32_bf16 v[108:111], v[156:159], v[164:167], v[108:111]
v_mul_f32 v197, v229, v23
v_mul_f32 v198, v229, v22
v_mfma_f32_16x16x32_bf16 v[92:95], v[156:159], v[168:171], v[92:95]
v_fma_f32 v230, v228, v22, -v197
v_fma_f32 v231, v228, v23, v198
v_mfma_f32_16x16x32_bf16 v[124:127], v[156:159], v[172:175], v[124:127]
v_mul_f32 v197, v231, v23
v_mul_f32 v198, v231, v22
s_waitcnt lgkmcnt(6)
v_mfma_f32_16x16x32_bf16 v[64:67], v[32:35], v[48:51], v[64:67]
ds_read_b128 v[144:147], v129 offset:0
s_waitcnt lgkmcnt(6)
v_mfma_f32_16x16x32_bf16 v[96:99], v[32:35], v[52:55], v[96:99]
ds_read_b128 v[160:163], v131 offset:0
s_waitcnt lgkmcnt(6)
v_mfma_f32_16x16x32_bf16 v[80:83], v[32:35], v[56:59], v[80:83]
ds_read_b128 v[164:167], v131 offset:2048
s_waitcnt lgkmcnt(6)
v_mfma_f32_16x16x32_bf16 v[112:115], v[32:35], v[60:63], v[112:115]
ds_read_b128 v[168:171], v131 offset:4096
s_waitcnt lgkmcnt(6)
v_mfma_f32_16x16x32_bf16 v[68:71], v[36:39], v[48:51], v[68:71]
ds_read_b128 v[172:175], v131 offset:6144
v_mfma_f32_16x16x32_bf16 v[100:103], v[36:39], v[52:55], v[100:103]
ds_read_b128 v[148:151], v129 offset:2048
v_mfma_f32_16x16x32_bf16 v[84:87], v[36:39], v[56:59], v[84:87]
ds_read_b128 v[152:155], v129 offset:4096
v_mfma_f32_16x16x32_bf16 v[116:119], v[36:39], v[60:63], v[116:119]
ds_read_b128 v[156:159], v129 offset:6144
s_waitcnt lgkmcnt(9)
v_mfma_f32_16x16x32_bf16 v[72:75], v[40:43], v[48:51], v[72:75]
v_fma_f32 v232, v230, v22, -v197
v_fma_f32 v233, v230, v23, v198
v_mfma_f32_16x16x32_bf16 v[104:107], v[40:43], v[52:55], v[104:107]
v_mul_f32 v197, v233, v23
v_mul_f32 v198, v233, v22
v_mfma_f32_16x16x32_bf16 v[88:91], v[40:43], v[56:59], v[88:91]
v_fma_f32 v234, v232, v22, -v197
v_fma_f32 v235, v232, v23, v198
v_mfma_f32_16x16x32_bf16 v[120:123], v[40:43], v[60:63], v[120:123]
v_mul_f32 v197, v235, v23
v_mul_f32 v198, v235, v22
s_waitcnt lgkmcnt(8)
v_mfma_f32_16x16x32_bf16 v[76:79], v[44:47], v[48:51], v[76:79]
v_fma_f32 v236, v234, v22, -v197
v_fma_f32 v237, v234, v23, v198
v_mfma_f32_16x16x32_bf16 v[108:111], v[44:47], v[52:55], v[108:111]
v_mul_f32 v197, v237, v23
v_mul_f32 v198, v237, v22
v_mfma_f32_16x16x32_bf16 v[92:95], v[44:47], v[56:59], v[92:95]
v_fma_f32 v238, v236, v22, -v197
v_fma_f32 v239, v236, v23, v198
v_mfma_f32_16x16x32_bf16 v[124:127], v[44:47], v[60:63], v[124:127]
v_and_b32 v197, 16, v1
v_cmp_ne_u32 vcc, 0, v197
s_waitcnt lgkmcnt(0)
s_barrier
v_mfma_f32_16x16x32_bf16 v[64:67], v[144:147], v[160:163], v[64:67]
ds_read_b128 v[32:35], v128 offset:32768
v_mfma_f32_16x16x32_bf16 v[96:99], v[144:147], v[164:167], v[96:99]
ds_read_b128 v[48:51], v130 offset:32768
v_mfma_f32_16x16x32_bf16 v[80:83], v[144:147], v[168:171], v[80:83]
ds_read_b128 v[52:55], v130 offset:34816
v_mfma_f32_16x16x32_bf16 v[112:115], v[144:147], v[172:175], v[112:115]
ds_read_b128 v[56:59], v130 offset:36864
v_mfma_f32_16x16x32_bf16 v[68:71], v[148:151], v[160:163], v[68:71]
ds_read_b128 v[60:63], v130 offset:38912
v_mfma_f32_16x16x32_bf16 v[100:103], v[148:151], v[164:167], v[100:103]
ds_read_b128 v[36:39], v128 offset:34816
v_mfma_f32_16x16x32_bf16 v[84:87], v[148:151], v[168:171], v[84:87]
ds_read_b128 v[40:43], v128 offset:36864
v_mfma_f32_16x16x32_bf16 v[116:119], v[148:151], v[172:175], v[116:119]
ds_read_b128 v[44:47], v128 offset:38912
v_mfma_f32_16x16x32_bf16 v[72:75], v[152:155], v[160:163], v[72:75]
v_cndmask_b32 v204, v204, v205, vcc
v_cndmask_b32 v206, v206, v207, vcc
v_mfma_f32_16x16x32_bf16 v[104:107], v[152:155], v[164:167], v[104:107]
v_mul_f32 v197, 0x41800000, v204
v_mul_f32 v198, 0x41800000, v206
v_mfma_f32_16x16x32_bf16 v[88:91], v[152:155], v[168:171], v[88:91]
v_exp_f32 v197, v197
v_rndne_f32 v199, v198
v_mfma_f32_16x16x32_bf16 v[120:123], v[152:155], v[172:175], v[120:123]
v_sub_f32 v198, v198, v199
v_cos_f32 v199, v198
v_mfma_f32_16x16x32_bf16 v[76:79], v[156:159], v[160:163], v[76:79]
v_sin_f32 v198, v198
v_mul_f32 v28, v197, v199
v_mfma_f32_16x16x32_bf16 v[108:111], v[156:159], v[164:167], v[108:111]
v_mul_f32 v29, v197, v198
v_mul_f32 v197, 0x42800000, v204
v_mfma_f32_16x16x32_bf16 v[92:95], v[156:159], v[168:171], v[92:95]
v_mul_f32 v198, 0x42800000, v206
v_exp_f32 v197, v197
v_mfma_f32_16x16x32_bf16 v[124:127], v[156:159], v[172:175], v[124:127]
v_rndne_f32 v199, v198
v_sub_f32 v198, v198, v199
s_waitcnt lgkmcnt(6)
v_mfma_f32_16x16x32_bf16 v[64:67], v[32:35], v[48:51], v[64:67]
ds_read_b128 v[144:147], v129 offset:32768
s_waitcnt lgkmcnt(6)
v_mfma_f32_16x16x32_bf16 v[96:99], v[32:35], v[52:55], v[96:99]
ds_read_b128 v[160:163], v131 offset:32768
s_waitcnt lgkmcnt(6)
v_mfma_f32_16x16x32_bf16 v[80:83], v[32:35], v[56:59], v[80:83]
ds_read_b128 v[164:167], v131 offset:34816
s_waitcnt lgkmcnt(6)
v_mfma_f32_16x16x32_bf16 v[112:115], v[32:35], v[60:63], v[112:115]
ds_read_b128 v[168:171], v131 offset:36864
s_waitcnt lgkmcnt(6)
v_mfma_f32_16x16x32_bf16 v[68:71], v[36:39], v[48:51], v[68:71]
ds_read_b128 v[172:175], v131 offset:38912
v_mfma_f32_16x16x32_bf16 v[100:103], v[36:39], v[52:55], v[100:103]
ds_read_b128 v[148:151], v129 offset:34816
v_mfma_f32_16x16x32_bf16 v[84:87], v[36:39], v[56:59], v[84:87]
ds_read_b128 v[152:155], v129 offset:36864
v_mfma_f32_16x16x32_bf16 v[116:119], v[36:39], v[60:63], v[116:119]
ds_read_b128 v[156:159], v129 offset:38912
s_waitcnt lgkmcnt(9)
v_mfma_f32_16x16x32_bf16 v[72:75], v[40:43], v[48:51], v[72:75]
v_cos_f32 v199, v198
v_sin_f32 v198, v198
v_mfma_f32_16x16x32_bf16 v[104:107], v[40:43], v[52:55], v[104:107]
v_mul_f32 v192, v197, v199
v_mul_f32 v193, v197, v198
v_mfma_f32_16x16x32_bf16 v[88:91], v[40:43], v[56:59], v[88:91]
v_mul_f32 v197, 0x43000000, v204
v_mul_f32 v198, 0x43000000, v206
v_mfma_f32_16x16x32_bf16 v[120:123], v[40:43], v[60:63], v[120:123]
v_exp_f32 v197, v197
v_rndne_f32 v199, v198
s_waitcnt lgkmcnt(8)
v_mfma_f32_16x16x32_bf16 v[76:79], v[44:47], v[48:51], v[76:79]
v_sub_f32 v198, v198, v199
v_cos_f32 v199, v198
v_mfma_f32_16x16x32_bf16 v[108:111], v[44:47], v[52:55], v[108:111]
v_sin_f32 v198, v198
v_mul_f32 v30, v197, v199
v_mfma_f32_16x16x32_bf16 v[92:95], v[44:47], v[56:59], v[92:95]
v_mul_f32 v31, v197, v198
v_mul_f32 v197, 0x43800000, v204
v_mfma_f32_16x16x32_bf16 v[124:127], v[44:47], v[60:63], v[124:127]
v_mul_f32 v198, 0x43800000, v206
v_exp_f32 v197, v197
s_waitcnt lgkmcnt(0)
s_barrier
v_mfma_f32_16x16x32_bf16 v[64:67], v[144:147], v[160:163], v[64:67]
ds_read_b128 v[32:35], v132 offset:0
v_mfma_f32_16x16x32_bf16 v[96:99], v[144:147], v[164:167], v[96:99]
ds_read_b128 v[48:51], v134 offset:0
v_mfma_f32_16x16x32_bf16 v[80:83], v[144:147], v[168:171], v[80:83]
ds_read_b128 v[52:55], v134 offset:2048
v_mfma_f32_16x16x32_bf16 v[112:115], v[144:147], v[172:175], v[112:115]
ds_read_b128 v[56:59], v134 offset:4096
v_mfma_f32_16x16x32_bf16 v[68:71], v[148:151], v[160:163], v[68:71]
ds_read_b128 v[60:63], v134 offset:6144
v_mfma_f32_16x16x32_bf16 v[100:103], v[148:151], v[164:167], v[100:103]
ds_read_b128 v[36:39], v132 offset:2048
v_mfma_f32_16x16x32_bf16 v[84:87], v[148:151], v[168:171], v[84:87]
ds_read_b128 v[40:43], v132 offset:4096
v_mfma_f32_16x16x32_bf16 v[116:119], v[148:151], v[172:175], v[116:119]
ds_read_b128 v[44:47], v132 offset:6144
v_mfma_f32_16x16x32_bf16 v[72:75], v[152:155], v[160:163], v[72:75]
v_rndne_f32 v199, v198
v_sub_f32 v198, v198, v199
v_mfma_f32_16x16x32_bf16 v[104:107], v[152:155], v[164:167], v[104:107]
v_cos_f32 v199, v198
v_sin_f32 v198, v198
v_mfma_f32_16x16x32_bf16 v[88:91], v[152:155], v[168:171], v[88:91]
v_mul_f32 v2, v197, v199
v_mul_f32 v3, v197, v198
v_mfma_f32_16x16x32_bf16 v[120:123], v[152:155], v[172:175], v[120:123]
v_lshrrev_b32 v197, 4, v1
v_lshlrev_b32 v197, 2, v197
v_mfma_f32_16x16x32_bf16 v[76:79], v[156:159], v[160:163], v[76:79]
v_and_b32 v198, 15, v1
v_sub_u32 v197, v198, v197
v_mfma_f32_16x16x32_bf16 v[108:111], v[156:159], v[164:167], v[108:111]
v_mov_b32 v198, 0x3f80
v_mov_b32 v199, 1.0
v_mfma_f32_16x16x32_bf16 v[92:95], v[156:159], v[168:171], v[92:95]
v_cmp_eq_u32 vcc, 0, v197
s_nop 1
v_cndmask_b32 v248, 0, v198, vcc
v_mfma_f32_16x16x32_bf16 v[124:127], v[156:159], v[172:175], v[124:127]
v_cndmask_b32 v252, 0, v199, vcc
v_cmp_eq_u32 vcc, 1, v197
s_waitcnt lgkmcnt(6)
v_mfma_f32_16x16x32_bf16 v[64:67], v[32:35], v[48:51], v[64:67]
ds_read_b128 v[144:147], v133 offset:0
s_waitcnt lgkmcnt(6)
v_mfma_f32_16x16x32_bf16 v[96:99], v[32:35], v[52:55], v[96:99]
ds_read_b128 v[160:163], v135 offset:0
s_waitcnt lgkmcnt(6)
v_mfma_f32_16x16x32_bf16 v[80:83], v[32:35], v[56:59], v[80:83]
ds_read_b128 v[164:167], v135 offset:2048
s_waitcnt lgkmcnt(6)
v_mfma_f32_16x16x32_bf16 v[112:115], v[32:35], v[60:63], v[112:115]
ds_read_b128 v[168:171], v135 offset:4096
s_waitcnt lgkmcnt(6)
v_mfma_f32_16x16x32_bf16 v[68:71], v[36:39], v[48:51], v[68:71]
ds_read_b128 v[172:175], v135 offset:6144
v_mfma_f32_16x16x32_bf16 v[100:103], v[36:39], v[52:55], v[100:103]
ds_read_b128 v[148:151], v133 offset:2048
v_mfma_f32_16x16x32_bf16 v[84:87], v[36:39], v[56:59], v[84:87]
ds_read_b128 v[152:155], v133 offset:4096
v_mfma_f32_16x16x32_bf16 v[116:119], v[36:39], v[60:63], v[116:119]
ds_read_b128 v[156:159], v133 offset:6144
s_waitcnt lgkmcnt(9)
v_mfma_f32_16x16x32_bf16 v[72:75], v[40:43], v[48:51], v[72:75]
v_cndmask_b32 v249, 0, v198, vcc
v_cndmask_b32 v253, 0, v199, vcc
v_mfma_f32_16x16x32_bf16 v[104:107], v[40:43], v[52:55], v[104:107]
v_cmp_eq_u32 vcc, 2, v197
s_nop 1
v_cndmask_b32 v250, 0, v198, vcc
v_mfma_f32_16x16x32_bf16 v[88:91], v[40:43], v[56:59], v[88:91]
v_cndmask_b32 v254, 0, v199, vcc
v_cmp_eq_u32 vcc, 3, v197
v_mfma_f32_16x16x32_bf16 v[120:123], v[40:43], v[60:63], v[120:123]
s_nop 0
v_cndmask_b32 v251, 0, v198, vcc
v_cndmask_b32 v255, 0, v199, vcc
s_waitcnt lgkmcnt(8)
v_mfma_f32_16x16x32_bf16 v[76:79], v[44:47], v[48:51], v[76:79]
v_mfma_f32_16x16x32_bf16 v[108:111], v[44:47], v[52:55], v[108:111]
v_mfma_f32_16x16x32_bf16 v[92:95], v[44:47], v[56:59], v[92:95]
v_mfma_f32_16x16x32_bf16 v[124:127], v[44:47], v[60:63], v[124:127]
s_waitcnt lgkmcnt(0)
s_barrier
v_mfma_f32_16x16x32_bf16 v[64:67], v[144:147], v[160:163], v[64:67]
ds_read_b128 v[32:35], v128 offset:0
v_mfma_f32_16x16x32_bf16 v[96:99], v[144:147], v[164:167], v[96:99]
ds_read_b128 v[48:51], v130 offset:0
v_mfma_f32_16x16x32_bf16 v[80:83], v[144:147], v[168:171], v[80:83]
ds_read_b128 v[52:55], v130 offset:2048
v_mfma_f32_16x16x32_bf16 v[112:115], v[144:147], v[172:175], v[112:115]
ds_read_b128 v[56:59], v130 offset:4096
v_mfma_f32_16x16x32_bf16 v[68:71], v[148:151], v[160:163], v[68:71]
ds_read_b128 v[60:63], v130 offset:6144
v_mfma_f32_16x16x32_bf16 v[100:103], v[148:151], v[164:167], v[100:103]
ds_read_b128 v[36:39], v128 offset:2048
v_mfma_f32_16x16x32_bf16 v[84:87], v[148:151], v[168:171], v[84:87]
ds_read_b128 v[40:43], v128 offset:4096
v_mfma_f32_16x16x32_bf16 v[116:119], v[148:151], v[172:175], v[116:119]
ds_read_b128 v[44:47], v128 offset:6144
v_mfma_f32_16x16x32_bf16 v[72:75], v[152:155], v[160:163], v[72:75]
v_mfma_f32_16x16x32_bf16 v[104:107], v[152:155], v[164:167], v[104:107]
v_mfma_f32_16x16x32_bf16 v[88:91], v[152:155], v[168:171], v[88:91]
v_mfma_f32_16x16x32_bf16 v[120:123], v[152:155], v[172:175], v[120:123]
v_mfma_f32_16x16x32_bf16 v[76:79], v[156:159], v[160:163], v[76:79]
v_mfma_f32_16x16x32_bf16 v[108:111], v[156:159], v[164:167], v[108:111]
v_mfma_f32_16x16x32_bf16 v[92:95], v[156:159], v[168:171], v[92:95]
v_mfma_f32_16x16x32_bf16 v[124:127], v[156:159], v[172:175], v[124:127]
s_waitcnt lgkmcnt(6)
v_mfma_f32_16x16x32_bf16 v[64:67], v[32:35], v[48:51], v[64:67]
ds_read_b128 v[144:147], v129 offset:0
s_waitcnt lgkmcnt(6)
v_mfma_f32_16x16x32_bf16 v[96:99], v[32:35], v[52:55], v[96:99]
ds_read_b128 v[160:163], v131 offset:0
s_waitcnt lgkmcnt(6)
v_mfma_f32_16x16x32_bf16 v[80:83], v[32:35], v[56:59], v[80:83]
ds_read_b128 v[164:167], v131 offset:2048
s_waitcnt lgkmcnt(6)
v_mfma_f32_16x16x32_bf16 v[112:115], v[32:35], v[60:63], v[112:115]
ds_read_b128 v[168:171], v131 offset:4096
s_waitcnt lgkmcnt(6)
v_mfma_f32_16x16x32_bf16 v[68:71], v[36:39], v[48:51], v[68:71]
ds_read_b128 v[172:175], v131 offset:6144
v_mfma_f32_16x16x32_bf16 v[100:103], v[36:39], v[52:55], v[100:103]
ds_read_b128 v[148:151], v129 offset:2048
v_mfma_f32_16x16x32_bf16 v[84:87], v[36:39], v[56:59], v[84:87]
ds_read_b128 v[152:155], v129 offset:4096
v_mfma_f32_16x16x32_bf16 v[116:119], v[36:39], v[60:63], v[116:119]
ds_read_b128 v[156:159], v129 offset:6144
s_waitcnt lgkmcnt(9)
v_mfma_f32_16x16x32_bf16 v[72:75], v[40:43], v[48:51], v[72:75]
v_mfma_f32_16x16x32_bf16 v[104:107], v[40:43], v[52:55], v[104:107]
v_mfma_f32_16x16x32_bf16 v[88:91], v[40:43], v[56:59], v[88:91]
v_mfma_f32_16x16x32_bf16 v[120:123], v[40:43], v[60:63], v[120:123]
s_waitcnt lgkmcnt(8)
v_mfma_f32_16x16x32_bf16 v[76:79], v[44:47], v[48:51], v[76:79]
v_mfma_f32_16x16x32_bf16 v[108:111], v[44:47], v[52:55], v[108:111]
v_mfma_f32_16x16x32_bf16 v[92:95], v[44:47], v[56:59], v[92:95]
v_mfma_f32_16x16x32_bf16 v[124:127], v[44:47], v[60:63], v[124:127]
s_waitcnt lgkmcnt(0)
s_barrier
v_mfma_f32_16x16x32_bf16 v[64:67], v[144:147], v[160:163], v[64:67]
ds_read_b128 v[32:35], v128 offset:32768
v_mfma_f32_16x16x32_bf16 v[96:99], v[144:147], v[164:167], v[96:99]
ds_read_b128 v[48:51], v130 offset:32768
v_mfma_f32_16x16x32_bf16 v[80:83], v[144:147], v[168:171], v[80:83]
ds_read_b128 v[52:55], v130 offset:34816
v_mfma_f32_16x16x32_bf16 v[112:115], v[144:147], v[172:175], v[112:115]
ds_read_b128 v[56:59], v130 offset:36864
v_mfma_f32_16x16x32_bf16 v[68:71], v[148:151], v[160:163], v[68:71]
ds_read_b128 v[60:63], v130 offset:38912
v_mfma_f32_16x16x32_bf16 v[100:103], v[148:151], v[164:167], v[100:103]
ds_read_b128 v[36:39], v128 offset:34816
v_mfma_f32_16x16x32_bf16 v[84:87], v[148:151], v[168:171], v[84:87]
ds_read_b128 v[40:43], v128 offset:36864
v_mfma_f32_16x16x32_bf16 v[116:119], v[148:151], v[172:175], v[116:119]
ds_read_b128 v[44:47], v128 offset:38912
v_mfma_f32_16x16x32_bf16 v[72:75], v[152:155], v[160:163], v[72:75]
v_mfma_f32_16x16x32_bf16 v[104:107], v[152:155], v[164:167], v[104:107]
v_mfma_f32_16x16x32_bf16 v[88:91], v[152:155], v[168:171], v[88:91]
v_mfma_f32_16x16x32_bf16 v[120:123], v[152:155], v[172:175], v[120:123]
v_mfma_f32_16x16x32_bf16 v[76:79], v[156:159], v[160:163], v[76:79]
v_mfma_f32_16x16x32_bf16 v[108:111], v[156:159], v[164:167], v[108:111]
v_mfma_f32_16x16x32_bf16 v[92:95], v[156:159], v[168:171], v[92:95]
v_mfma_f32_16x16x32_bf16 v[124:127], v[156:159], v[172:175], v[124:127]
s_waitcnt lgkmcnt(6)
v_mfma_f32_16x16x32_bf16 v[64:67], v[32:35], v[48:51], v[64:67]
ds_read_b128 v[144:147], v129 offset:32768
s_waitcnt lgkmcnt(6)
v_mfma_f32_16x16x32_bf16 v[96:99], v[32:35], v[52:55], v[96:99]
ds_read_b128 v[160:163], v131 offset:32768
s_waitcnt lgkmcnt(6)
v_mfma_f32_16x16x32_bf16 v[80:83], v[32:35], v[56:59], v[80:83]
ds_read_b128 v[164:167], v131 offset:34816
s_waitcnt lgkmcnt(6)
v_mfma_f32_16x16x32_bf16 v[112:115], v[32:35], v[60:63], v[112:115]
ds_read_b128 v[168:171], v131 offset:36864
s_waitcnt lgkmcnt(6)
v_mfma_f32_16x16x32_bf16 v[68:71], v[36:39], v[48:51], v[68:71]
ds_read_b128 v[172:175], v131 offset:38912
v_mfma_f32_16x16x32_bf16 v[100:103], v[36:39], v[52:55], v[100:103]
ds_read_b128 v[148:151], v129 offset:34816
v_mfma_f32_16x16x32_bf16 v[84:87], v[36:39], v[56:59], v[84:87]
ds_read_b128 v[152:155], v129 offset:36864
v_mfma_f32_16x16x32_bf16 v[116:119], v[36:39], v[60:63], v[116:119]
ds_read_b128 v[156:159], v129 offset:38912
s_waitcnt lgkmcnt(9)
v_mfma_f32_16x16x32_bf16 v[72:75], v[40:43], v[48:51], v[72:75]
v_mfma_f32_16x16x32_bf16 v[104:107], v[40:43], v[52:55], v[104:107]
v_mfma_f32_16x16x32_bf16 v[88:91], v[40:43], v[56:59], v[88:91]
v_mfma_f32_16x16x32_bf16 v[120:123], v[40:43], v[60:63], v[120:123]
s_waitcnt lgkmcnt(8)
v_mfma_f32_16x16x32_bf16 v[76:79], v[44:47], v[48:51], v[76:79]
v_mfma_f32_16x16x32_bf16 v[108:111], v[44:47], v[52:55], v[108:111]
v_mfma_f32_16x16x32_bf16 v[92:95], v[44:47], v[56:59], v[92:95]
v_mfma_f32_16x16x32_bf16 v[124:127], v[44:47], v[60:63], v[124:127]
s_waitcnt lgkmcnt(0)
s_barrier
v_mfma_f32_16x16x32_bf16 v[64:67], v[144:147], v[160:163], v[64:67]
ds_read_b128 v[32:35], v132 offset:0
v_mfma_f32_16x16x32_bf16 v[96:99], v[144:147], v[164:167], v[96:99]
ds_read_b128 v[48:51], v134 offset:0
v_mfma_f32_16x16x32_bf16 v[80:83], v[144:147], v[168:171], v[80:83]
ds_read_b128 v[52:55], v134 offset:2048
v_mfma_f32_16x16x32_bf16 v[112:115], v[144:147], v[172:175], v[112:115]
ds_read_b128 v[56:59], v134 offset:4096
v_mfma_f32_16x16x32_bf16 v[68:71], v[148:151], v[160:163], v[68:71]
ds_read_b128 v[60:63], v134 offset:6144
v_mfma_f32_16x16x32_bf16 v[100:103], v[148:151], v[164:167], v[100:103]
ds_read_b128 v[36:39], v132 offset:2048
v_mfma_f32_16x16x32_bf16 v[84:87], v[148:151], v[168:171], v[84:87]
ds_read_b128 v[40:43], v132 offset:4096
v_mfma_f32_16x16x32_bf16 v[116:119], v[148:151], v[172:175], v[116:119]
ds_read_b128 v[44:47], v132 offset:6144
v_mfma_f32_16x16x32_bf16 v[72:75], v[152:155], v[160:163], v[72:75]
v_mfma_f32_16x16x32_bf16 v[104:107], v[152:155], v[164:167], v[104:107]
v_mfma_f32_16x16x32_bf16 v[88:91], v[152:155], v[168:171], v[88:91]
v_mfma_f32_16x16x32_bf16 v[120:123], v[152:155], v[172:175], v[120:123]
v_mfma_f32_16x16x32_bf16 v[76:79], v[156:159], v[160:163], v[76:79]
v_mfma_f32_16x16x32_bf16 v[108:111], v[156:159], v[164:167], v[108:111]
v_mfma_f32_16x16x32_bf16 v[92:95], v[156:159], v[168:171], v[92:95]
v_mfma_f32_16x16x32_bf16 v[124:127], v[156:159], v[172:175], v[124:127]
s_waitcnt lgkmcnt(6)
v_mfma_f32_16x16x32_bf16 v[64:67], v[32:35], v[48:51], v[64:67]
ds_read_b128 v[144:147], v133 offset:0
s_waitcnt lgkmcnt(6)
v_mfma_f32_16x16x32_bf16 v[96:99], v[32:35], v[52:55], v[96:99]
ds_read_b128 v[160:163], v135 offset:0
s_waitcnt lgkmcnt(6)
v_mfma_f32_16x16x32_bf16 v[80:83], v[32:35], v[56:59], v[80:83]
ds_read_b128 v[164:167], v135 offset:2048
s_waitcnt lgkmcnt(6)
v_mfma_f32_16x16x32_bf16 v[112:115], v[32:35], v[60:63], v[112:115]
ds_read_b128 v[168:171], v135 offset:4096
s_waitcnt lgkmcnt(6)
v_mfma_f32_16x16x32_bf16 v[68:71], v[36:39], v[48:51], v[68:71]
ds_read_b128 v[172:175], v135 offset:6144
v_mfma_f32_16x16x32_bf16 v[100:103], v[36:39], v[52:55], v[100:103]
ds_read_b128 v[148:151], v133 offset:2048
v_mfma_f32_16x16x32_bf16 v[84:87], v[36:39], v[56:59], v[84:87]
ds_read_b128 v[152:155], v133 offset:4096
v_mfma_f32_16x16x32_bf16 v[116:119], v[36:39], v[60:63], v[116:119]
ds_read_b128 v[156:159], v133 offset:6144
s_waitcnt lgkmcnt(9)
v_mfma_f32_16x16x32_bf16 v[72:75], v[40:43], v[48:51], v[72:75]
v_mfma_f32_16x16x32_bf16 v[104:107], v[40:43], v[52:55], v[104:107]
v_mfma_f32_16x16x32_bf16 v[88:91], v[40:43], v[56:59], v[88:91]
v_mfma_f32_16x16x32_bf16 v[120:123], v[40:43], v[60:63], v[120:123]
s_waitcnt lgkmcnt(8)
v_mfma_f32_16x16x32_bf16 v[76:79], v[44:47], v[48:51], v[76:79]
v_mfma_f32_16x16x32_bf16 v[108:111], v[44:47], v[52:55], v[108:111]
v_mfma_f32_16x16x32_bf16 v[92:95], v[44:47], v[56:59], v[92:95]
v_mfma_f32_16x16x32_bf16 v[124:127], v[44:47], v[60:63], v[124:127]
s_waitcnt lgkmcnt(0)
s_barrier
v_mfma_f32_16x16x32_bf16 v[64:67], v[144:147], v[160:163], v[64:67]
ds_read_b128 v[32:35], v128 offset:0
v_mfma_f32_16x16x32_bf16 v[96:99], v[144:147], v[164:167], v[96:99]
ds_read_b128 v[48:51], v130 offset:0
v_mfma_f32_16x16x32_bf16 v[80:83], v[144:147], v[168:171], v[80:83]
ds_read_b128 v[52:55], v130 offset:2048
v_mfma_f32_16x16x32_bf16 v[112:115], v[144:147], v[172:175], v[112:115]
ds_read_b128 v[56:59], v130 offset:4096
v_mfma_f32_16x16x32_bf16 v[68:71], v[148:151], v[160:163], v[68:71]
ds_read_b128 v[60:63], v130 offset:6144
v_mfma_f32_16x16x32_bf16 v[100:103], v[148:151], v[164:167], v[100:103]
ds_read_b128 v[36:39], v128 offset:2048
v_mfma_f32_16x16x32_bf16 v[84:87], v[148:151], v[168:171], v[84:87]
ds_read_b128 v[40:43], v128 offset:4096
v_mfma_f32_16x16x32_bf16 v[116:119], v[148:151], v[172:175], v[116:119]
ds_read_b128 v[44:47], v128 offset:6144
v_mfma_f32_16x16x32_bf16 v[72:75], v[152:155], v[160:163], v[72:75]
v_mfma_f32_16x16x32_bf16 v[104:107], v[152:155], v[164:167], v[104:107]
v_mfma_f32_16x16x32_bf16 v[88:91], v[152:155], v[168:171], v[88:91]
v_mfma_f32_16x16x32_bf16 v[120:123], v[152:155], v[172:175], v[120:123]
v_mfma_f32_16x16x32_bf16 v[76:79], v[156:159], v[160:163], v[76:79]
v_mfma_f32_16x16x32_bf16 v[108:111], v[156:159], v[164:167], v[108:111]
v_mfma_f32_16x16x32_bf16 v[92:95], v[156:159], v[168:171], v[92:95]
v_mfma_f32_16x16x32_bf16 v[124:127], v[156:159], v[172:175], v[124:127]
s_waitcnt lgkmcnt(6)
v_mfma_f32_16x16x32_bf16 v[64:67], v[32:35], v[48:51], v[64:67]
ds_read_b128 v[144:147], v129 offset:0
s_waitcnt lgkmcnt(6)
v_mfma_f32_16x16x32_bf16 v[96:99], v[32:35], v[52:55], v[96:99]
ds_read_b128 v[160:163], v131 offset:0
s_waitcnt lgkmcnt(6)
v_mfma_f32_16x16x32_bf16 v[80:83], v[32:35], v[56:59], v[80:83]
ds_read_b128 v[164:167], v131 offset:2048
s_waitcnt lgkmcnt(6)
v_mfma_f32_16x16x32_bf16 v[112:115], v[32:35], v[60:63], v[112:115]
ds_read_b128 v[168:171], v131 offset:4096
s_waitcnt lgkmcnt(6)
v_mfma_f32_16x16x32_bf16 v[68:71], v[36:39], v[48:51], v[68:71]
ds_read_b128 v[172:175], v131 offset:6144
v_mfma_f32_16x16x32_bf16 v[100:103], v[36:39], v[52:55], v[100:103]
ds_read_b128 v[148:151], v129 offset:2048
v_mfma_f32_16x16x32_bf16 v[84:87], v[36:39], v[56:59], v[84:87]
ds_read_b128 v[152:155], v129 offset:4096
v_mfma_f32_16x16x32_bf16 v[116:119], v[36:39], v[60:63], v[116:119]
ds_read_b128 v[156:159], v129 offset:6144
s_waitcnt lgkmcnt(9)
v_mfma_f32_16x16x32_bf16 v[72:75], v[40:43], v[48:51], v[72:75]
v_mfma_f32_16x16x32_bf16 v[104:107], v[40:43], v[52:55], v[104:107]
v_mfma_f32_16x16x32_bf16 v[88:91], v[40:43], v[56:59], v[88:91]
v_mfma_f32_16x16x32_bf16 v[120:123], v[40:43], v[60:63], v[120:123]
s_waitcnt lgkmcnt(8)
v_mfma_f32_16x16x32_bf16 v[76:79], v[44:47], v[48:51], v[76:79]
v_mfma_f32_16x16x32_bf16 v[108:111], v[44:47], v[52:55], v[108:111]
v_mfma_f32_16x16x32_bf16 v[92:95], v[44:47], v[56:59], v[92:95]
v_mfma_f32_16x16x32_bf16 v[124:127], v[44:47], v[60:63], v[124:127]
s_waitcnt lgkmcnt(0)
s_barrier
v_mfma_f32_16x16x32_bf16 v[64:67], v[144:147], v[160:163], v[64:67]
ds_read_b128 v[32:35], v128 offset:32768
v_mfma_f32_16x16x32_bf16 v[96:99], v[144:147], v[164:167], v[96:99]
ds_read_b128 v[48:51], v130 offset:32768
v_mfma_f32_16x16x32_bf16 v[80:83], v[144:147], v[168:171], v[80:83]
ds_read_b128 v[52:55], v130 offset:34816
v_mfma_f32_16x16x32_bf16 v[112:115], v[144:147], v[172:175], v[112:115]
ds_read_b128 v[56:59], v130 offset:36864
v_mfma_f32_16x16x32_bf16 v[68:71], v[148:151], v[160:163], v[68:71]
ds_read_b128 v[60:63], v130 offset:38912
v_mfma_f32_16x16x32_bf16 v[100:103], v[148:151], v[164:167], v[100:103]
ds_read_b128 v[36:39], v128 offset:34816
v_mfma_f32_16x16x32_bf16 v[84:87], v[148:151], v[168:171], v[84:87]
ds_read_b128 v[40:43], v128 offset:36864
v_mfma_f32_16x16x32_bf16 v[116:119], v[148:151], v[172:175], v[116:119]
ds_read_b128 v[44:47], v128 offset:38912
v_mfma_f32_16x16x32_bf16 v[72:75], v[152:155], v[160:163], v[72:75]
v_mfma_f32_16x16x32_bf16 v[104:107], v[152:155], v[164:167], v[104:107]
v_mfma_f32_16x16x32_bf16 v[88:91], v[152:155], v[168:171], v[88:91]
v_mfma_f32_16x16x32_bf16 v[120:123], v[152:155], v[172:175], v[120:123]
v_mfma_f32_16x16x32_bf16 v[76:79], v[156:159], v[160:163], v[76:79]
v_mfma_f32_16x16x32_bf16 v[108:111], v[156:159], v[164:167], v[108:111]
v_mfma_f32_16x16x32_bf16 v[92:95], v[156:159], v[168:171], v[92:95]
v_mfma_f32_16x16x32_bf16 v[124:127], v[156:159], v[172:175], v[124:127]
v_mov_b32 v8, 0
global_load_dword v9, v8, s[30:31] sc1
s_waitcnt lgkmcnt(6)
v_mfma_f32_16x16x32_bf16 v[64:67], v[32:35], v[48:51], v[64:67]
ds_read_b128 v[144:147], v129 offset:32768
s_waitcnt lgkmcnt(6)
v_mfma_f32_16x16x32_bf16 v[96:99], v[32:35], v[52:55], v[96:99]
ds_read_b128 v[160:163], v131 offset:32768
s_waitcnt lgkmcnt(6)
v_mfma_f32_16x16x32_bf16 v[80:83], v[32:35], v[56:59], v[80:83]
ds_read_b128 v[164:167], v131 offset:34816
s_waitcnt lgkmcnt(6)
v_mfma_f32_16x16x32_bf16 v[112:115], v[32:35], v[60:63], v[112:115]
ds_read_b128 v[168:171], v131 offset:36864
s_waitcnt lgkmcnt(6)
v_mfma_f32_16x16x32_bf16 v[68:71], v[36:39], v[48:51], v[68:71]
ds_read_b128 v[172:175], v131 offset:38912
v_mfma_f32_16x16x32_bf16 v[100:103], v[36:39], v[52:55], v[100:103]
ds_read_b128 v[148:151], v129 offset:34816
v_mfma_f32_16x16x32_bf16 v[84:87], v[36:39], v[56:59], v[84:87]
ds_read_b128 v[152:155], v129 offset:36864
v_mfma_f32_16x16x32_bf16 v[116:119], v[36:39], v[60:63], v[116:119]
ds_read_b128 v[156:159], v129 offset:38912
s_waitcnt lgkmcnt(9)
v_mfma_f32_16x16x32_bf16 v[72:75], v[40:43], v[48:51], v[72:75]
v_mfma_f32_16x16x32_bf16 v[104:107], v[40:43], v[52:55], v[104:107]
v_mfma_f32_16x16x32_bf16 v[88:91], v[40:43], v[56:59], v[88:91]
v_mfma_f32_16x16x32_bf16 v[120:123], v[40:43], v[60:63], v[120:123]
s_waitcnt lgkmcnt(8)
v_mfma_f32_16x16x32_bf16 v[76:79], v[44:47], v[48:51], v[76:79]
v_mfma_f32_16x16x32_bf16 v[108:111], v[44:47], v[52:55], v[108:111]
v_mfma_f32_16x16x32_bf16 v[92:95], v[44:47], v[56:59], v[92:95]
v_mfma_f32_16x16x32_bf16 v[124:127], v[44:47], v[60:63], v[124:127]
s_waitcnt lgkmcnt(0)
s_barrier
v_mfma_f32_16x16x32_bf16 v[64:67], v[144:147], v[160:163], v[64:67]
ds_read_b128 v[32:35], v132 offset:0
v_mfma_f32_16x16x32_bf16 v[96:99], v[144:147], v[164:167], v[96:99]
ds_read_b128 v[48:51], v134 offset:0
v_mfma_f32_16x16x32_bf16 v[80:83], v[144:147], v[168:171], v[80:83]
ds_read_b128 v[52:55], v134 offset:2048
v_mfma_f32_16x16x32_bf16 v[112:115], v[144:147], v[172:175], v[112:115]
ds_read_b128 v[56:59], v134 offset:4096
v_mfma_f32_16x16x32_bf16 v[68:71], v[148:151], v[160:163], v[68:71]
ds_read_b128 v[60:63], v134 offset:6144
v_mfma_f32_16x16x32_bf16 v[100:103], v[148:151], v[164:167], v[100:103]
ds_read_b128 v[36:39], v132 offset:2048
v_mfma_f32_16x16x32_bf16 v[84:87], v[148:151], v[168:171], v[84:87]
ds_read_b128 v[40:43], v132 offset:4096
v_mfma_f32_16x16x32_bf16 v[116:119], v[148:151], v[172:175], v[116:119]
ds_read_b128 v[44:47], v132 offset:6144
v_mfma_f32_16x16x32_bf16 v[72:75], v[152:155], v[160:163], v[72:75]
v_mfma_f32_16x16x32_bf16 v[104:107], v[152:155], v[164:167], v[104:107]
v_mfma_f32_16x16x32_bf16 v[88:91], v[152:155], v[168:171], v[88:91]
v_mfma_f32_16x16x32_bf16 v[120:123], v[152:155], v[172:175], v[120:123]
v_mfma_f32_16x16x32_bf16 v[76:79], v[156:159], v[160:163], v[76:79]
v_mfma_f32_16x16x32_bf16 v[108:111], v[156:159], v[164:167], v[108:111]
v_mfma_f32_16x16x32_bf16 v[92:95], v[156:159], v[168:171], v[92:95]
v_mfma_f32_16x16x32_bf16 v[124:127], v[156:159], v[172:175], v[124:127]
s_waitcnt lgkmcnt(6)
v_mfma_f32_16x16x32_bf16 v[64:67], v[32:35], v[48:51], v[64:67]
ds_read_b128 v[144:147], v133 offset:0
s_waitcnt lgkmcnt(6)
v_mfma_f32_16x16x32_bf16 v[96:99], v[32:35], v[52:55], v[96:99]
ds_read_b128 v[160:163], v135 offset:0
s_waitcnt lgkmcnt(6)
v_mfma_f32_16x16x32_bf16 v[80:83], v[32:35], v[56:59], v[80:83]
ds_read_b128 v[164:167], v135 offset:2048
s_waitcnt lgkmcnt(6)
v_mfma_f32_16x16x32_bf16 v[112:115], v[32:35], v[60:63], v[112:115]
ds_read_b128 v[168:171], v135 offset:4096
s_waitcnt lgkmcnt(6)
v_mfma_f32_16x16x32_bf16 v[68:71], v[36:39], v[48:51], v[68:71]
ds_read_b128 v[172:175], v135 offset:6144
v_mfma_f32_16x16x32_bf16 v[100:103], v[36:39], v[52:55], v[100:103]
ds_read_b128 v[148:151], v133 offset:2048
v_mfma_f32_16x16x32_bf16 v[84:87], v[36:39], v[56:59], v[84:87]
ds_read_b128 v[152:155], v133 offset:4096
v_mfma_f32_16x16x32_bf16 v[116:119], v[36:39], v[60:63], v[116:119]
ds_read_b128 v[156:159], v133 offset:6144
s_waitcnt lgkmcnt(9)
v_mfma_f32_16x16x32_bf16 v[72:75], v[40:43], v[48:51], v[72:75]
v_mfma_f32_16x16x32_bf16 v[104:107], v[40:43], v[52:55], v[104:107]
v_mfma_f32_16x16x32_bf16 v[88:91], v[40:43], v[56:59], v[88:91]
v_mfma_f32_16x16x32_bf16 v[120:123], v[40:43], v[60:63], v[120:123]
s_waitcnt lgkmcnt(8)
v_mfma_f32_16x16x32_bf16 v[76:79], v[44:47], v[48:51], v[76:79]
v_mfma_f32_16x16x32_bf16 v[108:111], v[44:47], v[52:55], v[108:111]
v_mfma_f32_16x16x32_bf16 v[92:95], v[44:47], v[56:59], v[92:95]
v_mfma_f32_16x16x32_bf16 v[124:127], v[44:47], v[60:63], v[124:127]
s_waitcnt lgkmcnt(0)
s_barrier
v_mfma_f32_16x16x32_bf16 v[64:67], v[144:147], v[160:163], v[64:67]
ds_read_b128 v[32:35], v128 offset:0
v_mfma_f32_16x16x32_bf16 v[96:99], v[144:147], v[164:167], v[96:99]
ds_read_b128 v[48:51], v130 offset:0
v_mfma_f32_16x16x32_bf16 v[80:83], v[144:147], v[168:171], v[80:83]
ds_read_b128 v[52:55], v130 offset:2048
v_mfma_f32_16x16x32_bf16 v[112:115], v[144:147], v[172:175], v[112:115]
ds_read_b128 v[56:59], v130 offset:4096
v_mfma_f32_16x16x32_bf16 v[68:71], v[148:151], v[160:163], v[68:71]
ds_read_b128 v[60:63], v130 offset:6144
v_mfma_f32_16x16x32_bf16 v[100:103], v[148:151], v[164:167], v[100:103]
ds_read_b128 v[36:39], v128 offset:2048
v_mfma_f32_16x16x32_bf16 v[84:87], v[148:151], v[168:171], v[84:87]
ds_read_b128 v[40:43], v128 offset:4096
v_mfma_f32_16x16x32_bf16 v[116:119], v[148:151], v[172:175], v[116:119]
ds_read_b128 v[44:47], v128 offset:6144
v_mfma_f32_16x16x32_bf16 v[72:75], v[152:155], v[160:163], v[72:75]
v_mfma_f32_16x16x32_bf16 v[104:107], v[152:155], v[164:167], v[104:107]
v_mfma_f32_16x16x32_bf16 v[88:91], v[152:155], v[168:171], v[88:91]
v_mfma_f32_16x16x32_bf16 v[120:123], v[152:155], v[172:175], v[120:123]
v_mfma_f32_16x16x32_bf16 v[76:79], v[156:159], v[160:163], v[76:79]
v_mfma_f32_16x16x32_bf16 v[108:111], v[156:159], v[164:167], v[108:111]
v_mfma_f32_16x16x32_bf16 v[92:95], v[156:159], v[168:171], v[92:95]
v_mfma_f32_16x16x32_bf16 v[124:127], v[156:159], v[172:175], v[124:127]
s_waitcnt lgkmcnt(6)
v_mfma_f32_16x16x32_bf16 v[64:67], v[32:35], v[48:51], v[64:67]
ds_read_b128 v[144:147], v129 offset:0
s_waitcnt lgkmcnt(6)
v_mfma_f32_16x16x32_bf16 v[96:99], v[32:35], v[52:55], v[96:99]
ds_read_b128 v[160:163], v131 offset:0
s_waitcnt lgkmcnt(6)
v_mfma_f32_16x16x32_bf16 v[80:83], v[32:35], v[56:59], v[80:83]
ds_read_b128 v[164:167], v131 offset:2048
s_waitcnt lgkmcnt(6)
v_mfma_f32_16x16x32_bf16 v[112:115], v[32:35], v[60:63], v[112:115]
ds_read_b128 v[168:171], v131 offset:4096
s_waitcnt lgkmcnt(6)
v_mfma_f32_16x16x32_bf16 v[68:71], v[36:39], v[48:51], v[68:71]
ds_read_b128 v[172:175], v131 offset:6144
v_mfma_f32_16x16x32_bf16 v[100:103], v[36:39], v[52:55], v[100:103]
ds_read_b128 v[148:151], v129 offset:2048
v_mfma_f32_16x16x32_bf16 v[84:87], v[36:39], v[56:59], v[84:87]
ds_read_b128 v[152:155], v129 offset:4096
v_mfma_f32_16x16x32_bf16 v[116:119], v[36:39], v[60:63], v[116:119]
ds_read_b128 v[156:159], v129 offset:6144
s_waitcnt lgkmcnt(9)
v_mfma_f32_16x16x32_bf16 v[72:75], v[40:43], v[48:51], v[72:75]
v_mfma_f32_16x16x32_bf16 v[104:107], v[40:43], v[52:55], v[104:107]
v_mfma_f32_16x16x32_bf16 v[88:91], v[40:43], v[56:59], v[88:91]
v_mfma_f32_16x16x32_bf16 v[120:123], v[40:43], v[60:63], v[120:123]
s_waitcnt lgkmcnt(8)
v_mfma_f32_16x16x32_bf16 v[76:79], v[44:47], v[48:51], v[76:79]
v_mfma_f32_16x16x32_bf16 v[108:111], v[44:47], v[52:55], v[108:111]
v_mfma_f32_16x16x32_bf16 v[92:95], v[44:47], v[56:59], v[92:95]
v_mfma_f32_16x16x32_bf16 v[124:127], v[44:47], v[60:63], v[124:127]
L_n48:
s_waitcnt vmcnt(0)
v_readfirstlane_b32 s37, v9
s_nop 0
s_cmp_lg_u32 s37, 0
s_cbranch_scc1 L_ng49
global_load_dword v9, v8, s[30:31] sc1
s_branch L_n48
L_ng49:
s_getreg_b32 s60, hwreg(HW_REG_XCC_ID, 0, 4)
s_lshl_b32 s61, s37, 4
s_or_b32 s100, s60, s61
v_mov_b32 v194, s100
v_mov_b32 v202, s37
v_mov_b32 v203, s37
s_waitcnt lgkmcnt(0)
v_mfma_f32_16x16x32_bf16 v[64:67], v[144:147], v[160:163], v[64:67]
v_mfma_f32_16x16x32_bf16 v[96:99], v[144:147], v[164:167], v[96:99]
v_mfma_f32_16x16x32_bf16 v[80:83], v[144:147], v[168:171], v[80:83]
v_mfma_f32_16x16x32_bf16 v[112:115], v[144:147], v[172:175], v[112:115]
v_mfma_f32_16x16x32_bf16 v[68:71], v[148:151], v[160:163], v[68:71]
v_mfma_f32_16x16x32_bf16 v[100:103], v[148:151], v[164:167], v[100:103]
v_mfma_f32_16x16x32_bf16 v[84:87], v[148:151], v[168:171], v[84:87]
v_mfma_f32_16x16x32_bf16 v[116:119], v[148:151], v[172:175], v[116:119]
v_mfma_f32_16x16x32_bf16 v[72:75], v[152:155], v[160:163], v[72:75]
v_mfma_f32_16x16x32_bf16 v[104:107], v[152:155], v[164:167], v[104:107]
v_mfma_f32_16x16x32_bf16 v[88:91], v[152:155], v[168:171], v[88:91]
v_mfma_f32_16x16x32_bf16 v[120:123], v[152:155], v[172:175], v[120:123]
v_mfma_f32_16x16x32_bf16 v[76:79], v[156:159], v[160:163], v[76:79]
v_mfma_f32_16x16x32_bf16 v[108:111], v[156:159], v[164:167], v[108:111]
v_mfma_f32_16x16x32_bf16 v[92:95], v[156:159], v[168:171], v[92:95]
v_mfma_f32_16x16x32_bf16 v[124:127], v[156:159], v[172:175], v[124:127]
v_pk_fma_f32 v[40:41], v[20:21], v[64:65], v[66:67] op_sel_hi:[0,1,1]
v_pk_fma_f32 v[42:43], v[20:21], v[80:81], v[82:83] op_sel_hi:[0,1,1]
v_pk_fma_f32 v[44:45], v[22:23], v[96:97], v[98:99] op_sel_hi:[0,1,1]
v_pk_fma_f32 v[46:47], v[22:23], v[112:113], v[114:115] op_sel_hi:[0,1,1]
v_pk_fma_f32 v[66:67], v[20:21], v[80:81], v[40:41] op_sel:[1,0,0] neg_lo:[1,0,0] neg_hi:[1,0,0]
v_pk_fma_f32 v[82:83], v[20:21], v[64:65], v[42:43] op_sel:[1,0,0]
v_pk_fma_f32 v[98:99], v[22:23], v[112:113], v[44:45] op_sel:[1,0,0] neg_lo:[1,0,0] neg_hi:[1,0,0]
v_pk_fma_f32 v[114:115], v[22:23], v[96:97], v[46:47] op_sel:[1,0,0]
v_pk_fma_f32 v[40:41], v[20:21], v[66:67], v[68:69] op_sel_hi:[0,1,1]
v_pk_fma_f32 v[42:43], v[20:21], v[82:83], v[84:85] op_sel_hi:[0,1,1]
v_pk_fma_f32 v[44:45], v[22:23], v[98:99], v[100:101] op_sel_hi:[0,1,1]
v_pk_fma_f32 v[46:47], v[22:23], v[114:115], v[116:117] op_sel_hi:[0,1,1]
v_pk_fma_f32 v[68:69], v[20:21], v[82:83], v[40:41] op_sel:[1,0,0] neg_lo:[1,0,0] neg_hi:[1,0,0]
v_pk_fma_f32 v[84:85], v[20:21], v[66:67], v[42:43] op_sel:[1,0,0]
v_pk_fma_f32 v[100:101], v[22:23], v[114:115], v[44:45] op_sel:[1,0,0] neg_lo:[1,0,0] neg_hi:[1,0,0]
v_pk_fma_f32 v[116:117], v[22:23], v[98:99], v[46:47] op_sel:[1,0,0]
v_pk_fma_f32 v[40:41], v[20:21], v[68:69], v[70:71] op_sel_hi:[0,1,1]
v_pk_fma_f32 v[42:43], v[20:21], v[84:85], v[86:87] op_sel_hi:[0,1,1]
v_pk_fma_f32 v[44:45], v[22:23], v[100:101], v[102:103] op_sel_hi:[0,1,1]
v_pk_fma_f32 v[46:47], v[22:23], v[116:117], v[118:119] op_sel_hi:[0,1,1]
v_pk_fma_f32 v[70:71], v[20:21], v[84:85], v[40:41] op_sel:[1,0,0] neg_lo:[1,0,0] neg_hi:[1,0,0]
v_pk_fma_f32 v[86:87], v[20:21], v[68:69], v[42:43] op_sel:[1,0,0]
v_pk_fma_f32 v[102:103], v[22:23], v[116:117], v[44:45] op_sel:[1,0,0] neg_lo:[1,0,0] neg_hi:[1,0,0]
v_pk_fma_f32 v[118:119], v[22:23], v[100:101], v[46:47] op_sel:[1,0,0]
v_pk_fma_f32 v[40:41], v[20:21], v[70:71], v[72:73] op_sel_hi:[0,1,1]
v_pk_fma_f32 v[42:43], v[20:21], v[86:87], v[88:89] op_sel_hi:[0,1,1]
v_pk_fma_f32 v[44:45], v[22:23], v[102:103], v[104:105] op_sel_hi:[0,1,1]
v_pk_fma_f32 v[46:47], v[22:23], v[118:119], v[120:121] op_sel_hi:[0,1,1]
v_pk_fma_f32 v[72:73], v[20:21], v[86:87], v[40:41] op_sel:[1,0,0] neg_lo:[1,0,0] neg_hi:[1,0,0]
v_pk_fma_f32 v[88:89], v[20:21], v[70:71], v[42:43] op_sel:[1,0,0]
v_pk_fma_f32 v[104:105], v[22:23], v[118:119], v[44:45] op_sel:[1,0,0] neg_lo:[1,0,0] neg_hi:[1,0,0]
v_pk_fma_f32 v[120:121], v[22:23], v[102:103], v[46:47] op_sel:[1,0,0]
v_pk_fma_f32 v[40:41], v[20:21], v[72:73], v[74:75] op_sel_hi:[0,1,1]
v_pk_fma_f32 v[42:43], v[20:21], v[88:89], v[90:91] op_sel_hi:[0,1,1]
v_pk_fma_f32 v[44:45], v[22:23], v[104:105], v[106:107] op_sel_hi:[0,1,1]
v_pk_fma_f32 v[46:47], v[22:23], v[120:121], v[122:123] op_sel_hi:[0,1,1]
v_pk_fma_f32 v[74:75], v[20:21], v[88:89], v[40:41] op_sel:[1,0,0] neg_lo:[1,0,0] neg_hi:[1,0,0]
v_pk_fma_f32 v[90:91], v[20:21], v[72:73], v[42:43] op_sel:[1,0,0]
v_pk_fma_f32 v[106:107], v[22:23], v[120:121], v[44:45] op_sel:[1,0,0] neg_lo:[1,0,0] neg_hi:[1,0,0]
v_pk_fma_f32 v[122:123], v[22:23], v[104:105], v[46:47] op_sel:[1,0,0]
v_pk_fma_f32 v[40:41], v[20:21], v[74:75], v[76:77] op_sel_hi:[0,1,1]
v_pk_fma_f32 v[42:43], v[20:21], v[90:91], v[92:93] op_sel_hi:[0,1,1]
v_pk_fma_f32 v[44:45], v[22:23], v[106:107], v[108:109] op_sel_hi:[0,1,1]
v_pk_fma_f32 v[46:47], v[22:23], v[122:123], v[124:125] op_sel_hi:[0,1,1]
v_pk_fma_f32 v[76:77], v[20:21], v[90:91], v[40:41] op_sel:[1,0,0] neg_lo:[1,0,0] neg_hi:[1,0,0]
v_pk_fma_f32 v[92:93], v[20:21], v[74:75], v[42:43] op_sel:[1,0,0]
v_pk_fma_f32 v[108:109], v[22:23], v[122:123], v[44:45] op_sel:[1,0,0] neg_lo:[1,0,0] neg_hi:[1,0,0]
v_pk_fma_f32 v[124:125], v[22:23], v[106:107], v[46:47] op_sel:[1,0,0]
v_pk_fma_f32 v[40:41], v[20:21], v[76:77], v[78:79] op_sel_hi:[0,1,1]
v_pk_fma_f32 v[42:43], v[20:21], v[92:93], v[94:95] op_sel_hi:[0,1,1]
v_pk_fma_f32 v[44:45], v[22:23], v[108:109], v[110:111] op_sel_hi:[0,1,1]
v_pk_fma_f32 v[46:47], v[22:23], v[124:125], v[126:127] op_sel_hi:[0,1,1]
v_pk_fma_f32 v[78:79], v[20:21], v[92:93], v[40:41] op_sel:[1,0,0] neg_lo:[1,0,0] neg_hi:[1,0,0]
v_pk_fma_f32 v[94:95], v[20:21], v[76:77], v[42:43] op_sel:[1,0,0]
v_pk_fma_f32 v[110:111], v[22:23], v[124:125], v[44:45] op_sel:[1,0,0] neg_lo:[1,0,0] neg_hi:[1,0,0]
v_pk_fma_f32 v[126:127], v[22:23], v[108:109], v[46:47] op_sel:[1,0,0]
v_fma_f32 v40, v176, v78, v79
v_fma_f32 v41, v176, v94, v95
v_fma_f32 v32, -v177, v94, v40
v_fma_f32 v33, v177, v78, v41
ds_write_b64 v15, v[32:33] offset:0
v_fma_f32 v40, v178, v110, v111
v_fma_f32 v41, v178, v126, v127
v_fma_f32 v34, -v179, v126, v40
v_fma_f32 v35, v179, v110, v41
ds_write_b64 v15, v[34:35] offset:2304
s_waitcnt lgkmcnt(0)
s_mov_b64 exec, 1
v_mov_b32 v197, 17
ds_write_b32 v13, v197 offset:32
s_mov_b64 exec, -1
L_ek50:
ds_read_b128 v[198:201], v12 offset:32
s_waitcnt lgkmcnt(0)
v_min3_u32 v197, v198, v199, v200
v_min_u32 v197, v197, v201
s_nop 0
v_readfirstlane_b32 s60, v197
s_nop 0
s_cmp_lt_u32 s60, 17
s_cbranch_scc1 L_ek50
ds_read_b128 v[48:51], v14
ds_read_b128 v[52:55], v14 offset:16
s_waitcnt lgkmcnt(1)
v_fma_f32 v40, v28, v48, v50
v_fma_f32 v41, v28, v49, v51
v_fma_f32 v32, -v29, v49, v40
v_fma_f32 v33, v29, v48, v41
s_waitcnt lgkmcnt(0)
v_fma_f32 v40, v28, v32, v52
v_fma_f32 v41, v28, v33, v53
v_fma_f32 v34, -v29, v33, v40
v_fma_f32 v35, v29, v32, v41
v_fma_f32 v40, v28, v34, v54
v_fma_f32 v41, v28, v35, v55
v_fma_f32 v32, -v29, v35, v40
v_fma_f32 v33, v29, v34, v41
v_mov_b32 v34, v32
v_mov_b32 v35, v33
s_nop 0
v_permlane32_swap_b32 v32, v34
v_permlane32_swap_b32 v33, v35
v_fma_f32 v40, v192, v32, v34
v_fma_f32 v41, v192, v33, v35
v_fma_f32 v200, -v193, v33, v40
v_fma_f32 v201, v193, v32, v41
s_cmp_lg_u32 s68, 0
s_cbranch_scc1 L_np52
buffer_store_dwordx4 v[200:203], v16, s[40:43], 0 offen sc1
s_cmp_lg_u32 s66, 0
s_cbranch_scc1 L_np52
s_mov_b64 exec, 1
global_store_dword v195, v194, s[32:33] sc1
s_mov_b64 exec, -1
L_np52:
global_load_dword v243, v18, s[32:33] sc1
v_add_u32 v15, -56, v15
ds_read_b64 v[32:33], v15 offset:0
ds_read_b64 v[34:35], v15 offset:8
ds_read_b64 v[36:37], v15 offset:16
ds_read_b64 v[38:39], v15 offset:24
ds_read_b64 v[40:41], v15 offset:32
ds_read_b64 v[42:43], v15 offset:40
ds_read_b64 v[44:45], v15 offset:48
ds_read_b64 v[46:47], v15 offset:2304
ds_read_b64 v[48:49], v15 offset:2312
ds_read_b64 v[50:51], v15 offset:2320
ds_read_b64 v[52:53], v15 offset:2328
ds_read_b64 v[54:55], v15 offset:2336
ds_read_b64 v[56:57], v15 offset:2344
ds_read_b64 v[58:59], v15 offset:2352
s_waitcnt lgkmcnt(0)
v_fma_f32 v60, v180, v32, v34
v_fma_f32 v61, v180, v33, v35
v_fma_f32 v34, -v181, v33, v60
v_fma_f32 v35, v181, v32, v61
v_fma_f32 v60, v180, v34, v36
v_fma_f32 v61, v180, v35, v37
v_fma_f32 v36, -v181, v35, v60
v_fma_f32 v37, v181, v34, v61
v_fma_f32 v60, v180, v36, v38
v_fma_f32 v61, v180, v37, v39
v_fma_f32 v38, -v181, v37, v60
v_fma_f32 v39, v181, v36, v61
v_fma_f32 v60, v180, v38, v40
v_fma_f32 v61, v180, v39, v41
v_fma_f32 v40, -v181, v39, v60
v_fma_f32 v41, v181, v38, v61
v_fma_f32 v60, v180, v40, v42
v_fma_f32 v61, v180, v41, v43
v_fma_f32 v42, -v181, v41, v60
v_fma_f32 v43, v181, v40, v61
v_fma_f32 v60, v180, v42, v44
v_fma_f32 v61, v180, v43, v45
v_fma_f32 v128, -v181, v43, v60
v_fma_f32 v130, v181, v42, v61
v_fma_f32 v60, v176, v128, v78
v_fma_f32 v61, v176, v130, v94
v_fma_f32 v129, -v177, v130, v60
v_fma_f32 v131, v177, v128, v61
v_fma_f32 v60, v182, v46, v48
v_fma_f32 v61, v182, v47, v49
v_fma_f32 v48, -v183, v47, v60
v_fma_f32 v49, v183, v46, v61
v_fma_f32 v60, v182, v48, v50
v_fma_f32 v61, v182, v49, v51
v_fma_f32 v50, -v183, v49, v60
v_fma_f32 v51, v183, v48, v61
v_fma_f32 v60, v182, v50, v52
v_fma_f32 v61, v182, v51, v53
v_fma_f32 v52, -v183, v51, v60
v_fma_f32 v53, v183, v50, v61
v_fma_f32 v60, v182, v52, v54
v_fma_f32 v61, v182, v53, v55
v_fma_f32 v54, -v183, v53, v60
v_fma_f32 v55, v183, v52, v61
v_fma_f32 v60, v182, v54, v56
v_fma_f32 v61, v182, v55, v57
v_fma_f32 v56, -v183, v55, v60
v_fma_f32 v57, v183, v54, v61
v_fma_f32 v60, v182, v56, v58
v_fma_f32 v61, v182, v57, v59
v_fma_f32 v132, -v183, v57, v60
v_fma_f32 v134, v183, v56, v61
v_fma_f32 v60, v178, v132, v110
v_fma_f32 v61, v178, v134, v126
v_fma_f32 v133, -v179, v134, v60
v_fma_f32 v135, v179, v132, v61
v_pk_mul_f32 v[32:33], v[24:25], v[64:65] op_sel_hi:[0,1]
v_pk_mul_f32 v[34:35], v[24:25], v[80:81] op_sel_hi:[0,1] neg_lo:[1,0] neg_hi:[1,0]
v_pk_fma_f32 v[34:35], v[24:25], v[64:65], v[34:35] op_sel:[1,0,0] neg_lo:[1,0,0] neg_hi:[1,0,0]
v_pk_fma_f32 v[64:65], v[24:25], v[80:81], v[32:33] op_sel:[1,0,0] neg_lo:[1,0,0] neg_hi:[1,0,0]
v_mov_b64 v[80:81], v[34:35]
v_pk_mul_f32 v[36:37], v[26:27], v[96:97] op_sel_hi:[0,1]
v_pk_mul_f32 v[38:39], v[26:27], v[112:113] op_sel_hi:[0,1] neg_lo:[1,0] neg_hi:[1,0]
v_pk_fma_f32 v[38:39], v[26:27], v[96:97], v[38:39] op_sel:[1,0,0] neg_lo:[1,0,0] neg_hi:[1,0,0]
v_pk_fma_f32 v[96:97], v[26:27], v[112:113], v[36:37] op_sel:[1,0,0] neg_lo:[1,0,0] neg_hi:[1,0,0]
v_mov_b64 v[112:113], v[38:39]
v_pk_mul_f32 v[32:33], v[24:25], v[66:67] op_sel_hi:[0,1]
v_pk_mul_f32 v[34:35], v[24:25], v[82:83] op_sel_hi:[0,1] neg_lo:[1,0] neg_hi:[1,0]
v_pk_fma_f32 v[34:35], v[24:25], v[66:67], v[34:35] op_sel:[1,0,0] neg_lo:[1,0,0] neg_hi:[1,0,0]
v_pk_fma_f32 v[66:67], v[24:25], v[82:83], v[32:33] op_sel:[1,0,0] neg_lo:[1,0,0] neg_hi:[1,0,0]
v_mov_b64 v[82:83], v[34:35]
v_pk_mul_f32 v[36:37], v[26:27], v[98:99] op_sel_hi:[0,1]
v_pk_mul_f32 v[38:39], v[26:27], v[114:115] op_sel_hi:[0,1] neg_lo:[1,0] neg_hi:[1,0]
v_pk_fma_f32 v[38:39], v[26:27], v[98:99], v[38:39] op_sel:[1,0,0] neg_lo:[1,0,0] neg_hi:[1,0,0]
v_pk_fma_f32 v[98:99], v[26:27], v[114:115], v[36:37] op_sel:[1,0,0] neg_lo:[1,0,0] neg_hi:[1,0,0]
v_mov_b64 v[114:115], v[38:39]
v_pk_mul_f32 v[32:33], v[24:25], v[68:69] op_sel_hi:[0,1]
v_pk_mul_f32 v[34:35], v[24:25], v[84:85] op_sel_hi:[0,1] neg_lo:[1,0] neg_hi:[1,0]
v_pk_fma_f32 v[34:35], v[24:25], v[68:69], v[34:35] op_sel:[1,0,0] neg_lo:[1,0,0] neg_hi:[1,0,0]
v_pk_fma_f32 v[68:69], v[24:25], v[84:85], v[32:33] op_sel:[1,0,0] neg_lo:[1,0,0] neg_hi:[1,0,0]
v_mov_b64 v[84:85], v[34:35]
v_pk_mul_f32 v[36:37], v[26:27], v[100:101] op_sel_hi:[0,1]
v_pk_mul_f32 v[38:39], v[26:27], v[116:117] op_sel_hi:[0,1] neg_lo:[1,0] neg_hi:[1,0]
v_pk_fma_f32 v[38:39], v[26:27], v[100:101], v[38:39] op_sel:[1,0,0] neg_lo:[1,0,0] neg_hi:[1,0,0]
v_pk_fma_f32 v[100:101], v[26:27], v[116:117], v[36:37] op_sel:[1,0,0] neg_lo:[1,0,0] neg_hi:[1,0,0]
v_mov_b64 v[116:117], v[38:39]
v_pk_mul_f32 v[32:33], v[24:25], v[70:71] op_sel_hi:[0,1]
v_pk_mul_f32 v[34:35], v[24:25], v[86:87] op_sel_hi:[0,1] neg_lo:[1,0] neg_hi:[1,0]
v_pk_fma_f32 v[34:35], v[24:25], v[70:71], v[34:35] op_sel:[1,0,0] neg_lo:[1,0,0] neg_hi:[1,0,0]
v_pk_fma_f32 v[70:71], v[24:25], v[86:87], v[32:33] op_sel:[1,0,0] neg_lo:[1,0,0] neg_hi:[1,0,0]
v_mov_b64 v[86:87], v[34:35]
v_pk_mul_f32 v[36:37], v[26:27], v[102:103] op_sel_hi:[0,1]
v_pk_mul_f32 v[38:39], v[26:27], v[118:119] op_sel_hi:[0,1] neg_lo:[1,0] neg_hi:[1,0]
v_pk_fma_f32 v[38:39], v[26:27], v[102:103], v[38:39] op_sel:[1,0,0] neg_lo:[1,0,0] neg_hi:[1,0,0]
v_pk_fma_f32 v[102:103], v[26:27], v[118:119], v[36:37] op_sel:[1,0,0] neg_lo:[1,0,0] neg_hi:[1,0,0]
v_mov_b64 v[118:119], v[38:39]
v_pk_mul_f32 v[32:33], v[24:25], v[72:73] op_sel_hi:[0,1]
v_pk_mul_f32 v[34:35], v[24:25], v[88:89] op_sel_hi:[0,1] neg_lo:[1,0] neg_hi:[1,0]
v_pk_fma_f32 v[34:35], v[24:25], v[72:73], v[34:35] op_sel:[1,0,0] neg_lo:[1,0,0] neg_hi:[1,0,0]
v_pk_fma_f32 v[72:73], v[24:25], v[88:89], v[32:33] op_sel:[1,0,0] neg_lo:[1,0,0] neg_hi:[1,0,0]
v_mov_b64 v[88:89], v[34:35]
v_pk_mul_f32 v[36:37], v[26:27], v[104:105] op_sel_hi:[0,1]
v_pk_mul_f32 v[38:39], v[26:27], v[120:121] op_sel_hi:[0,1] neg_lo:[1,0] neg_hi:[1,0]
v_pk_fma_f32 v[38:39], v[26:27], v[104:105], v[38:39] op_sel:[1,0,0] neg_lo:[1,0,0] neg_hi:[1,0,0]
v_pk_fma_f32 v[104:105], v[26:27], v[120:121], v[36:37] op_sel:[1,0,0] neg_lo:[1,0,0] neg_hi:[1,0,0]
v_mov_b64 v[120:121], v[38:39]
v_pk_mul_f32 v[32:33], v[24:25], v[74:75] op_sel_hi:[0,1]
v_pk_mul_f32 v[34:35], v[24:25], v[90:91] op_sel_hi:[0,1] neg_lo:[1,0] neg_hi:[1,0]
v_pk_fma_f32 v[34:35], v[24:25], v[74:75], v[34:35] op_sel:[1,0,0] neg_lo:[1,0,0] neg_hi:[1,0,0]
v_pk_fma_f32 v[74:75], v[24:25], v[90:91], v[32:33] op_sel:[1,0,0] neg_lo:[1,0,0] neg_hi:[1,0,0]
v_mov_b64 v[90:91], v[34:35]
v_pk_mul_f32 v[36:37], v[26:27], v[106:107] op_sel_hi:[0,1]
v_pk_mul_f32 v[38:39], v[26:27], v[122:123] op_sel_hi:[0,1] neg_lo:[1,0] neg_hi:[1,0]
v_pk_fma_f32 v[38:39], v[26:27], v[106:107], v[38:39] op_sel:[1,0,0] neg_lo:[1,0,0] neg_hi:[1,0,0]
v_pk_fma_f32 v[106:107], v[26:27], v[122:123], v[36:37] op_sel:[1,0,0] neg_lo:[1,0,0] neg_hi:[1,0,0]
v_mov_b64 v[122:123], v[38:39]
v_pk_mul_f32 v[32:33], v[24:25], v[76:77] op_sel_hi:[0,1]
v_pk_mul_f32 v[34:35], v[24:25], v[92:93] op_sel_hi:[0,1] neg_lo:[1,0] neg_hi:[1,0]
v_pk_fma_f32 v[34:35], v[24:25], v[76:77], v[34:35] op_sel:[1,0,0] neg_lo:[1,0,0] neg_hi:[1,0,0]
v_pk_fma_f32 v[76:77], v[24:25], v[92:93], v[32:33] op_sel:[1,0,0] neg_lo:[1,0,0] neg_hi:[1,0,0]
v_mov_b64 v[92:93], v[34:35]
v_pk_mul_f32 v[36:37], v[26:27], v[108:109] op_sel_hi:[0,1]
v_pk_mul_f32 v[38:39], v[26:27], v[124:125] op_sel_hi:[0,1] neg_lo:[1,0] neg_hi:[1,0]
v_pk_fma_f32 v[38:39], v[26:27], v[108:109], v[38:39] op_sel:[1,0,0] neg_lo:[1,0,0] neg_hi:[1,0,0]
v_pk_fma_f32 v[108:109], v[26:27], v[124:125], v[36:37] op_sel:[1,0,0] neg_lo:[1,0,0] neg_hi:[1,0,0]
v_mov_b64 v[124:125], v[38:39]
v_pk_mul_f32 v[32:33], v[24:25], v[78:79] op_sel_hi:[0,1]
v_pk_mul_f32 v[34:35], v[24:25], v[94:95] op_sel_hi:[0,1] neg_lo:[1,0] neg_hi:[1,0]
v_pk_fma_f32 v[34:35], v[24:25], v[78:79], v[34:35] op_sel:[1,0,0] neg_lo:[1,0,0] neg_hi:[1,0,0]
v_pk_fma_f32 v[78:79], v[24:25], v[94:95], v[32:33] op_sel:[1,0,0] neg_lo:[1,0,0] neg_hi:[1,0,0]
v_mov_b64 v[94:95], v[34:35]
v_pk_mul_f32 v[36:37], v[26:27], v[110:111] op_sel_hi:[0,1]
v_pk_mul_f32 v[38:39], v[26:27], v[126:127] op_sel_hi:[0,1] neg_lo:[1,0] neg_hi:[1,0]
v_pk_fma_f32 v[38:39], v[26:27], v[110:111], v[38:39] op_sel:[1,0,0] neg_lo:[1,0,0] neg_hi:[1,0,0]
v_pk_fma_f32 v[110:111], v[26:27], v[126:127], v[36:37] op_sel:[1,0,0] neg_lo:[1,0,0] neg_hi:[1,0,0]
v_mov_b64 v[126:127], v[38:39]
buffer_load_dwordx4 v[144:147], v136, s[40:43], 0 offen sc1
buffer_load_dwordx4 v[148:151], v137, s[40:43], 0 offen sc1
buffer_load_dwordx4 v[152:155], v138, s[40:43], 0 offen sc1
buffer_load_dwordx4 v[156:159], v139, s[40:43], 0 offen sc1
buffer_load_dwordx4 v[160:163], v140, s[40:43], 0 offen sc1
buffer_load_dwordx4 v[164:167], v141, s[40:43], 0 offen sc1
buffer_load_dwordx4 v[168:171], v142, s[40:43], 0 offen sc1
buffer_load_dwordx4 v[172:175], v143, s[40:43], 0 offen sc1
global_load_dword v197, v196, s[32:33] sc1
v_mov_b32 v14, 1
s_mov_b64 exec, 1
ds_write_b32 v13, v14
s_mov_b64 exec, -1
s_xor_b32 s60, s68, s101
s_xor_b32 s60, s60, 1
s_lshl_b32 s60, s60, 6
s_add_u32 s60, s60, s66
v_lshrrev_b32 v8, 3, v1
v_lshl_add_u32 v8, v8, 1, s60
v_lshlrev_b32 v8, 11, v8
v_and_b32 v14, 7, v1
v_lshrrev_b32 v15, 4, v1
v_xor_b32 v14, v14, v15
v_lshlrev_b32 v14, 4, v14
v_xor_b32 v15, 64, v14
v_add_u32 v244, v8, v14
v_add_u32 v245, v8, v15
v_add_u32 v245, 31744, v245
v_add_u32 v246, v8, v14
v_add_u32 v246, 63488, v246
v_add_u32 v247, v8, v15
v_add_u32 v247, 95232, v247
s_and_b32 s64, s36, 7
s_lshl_b32 s60, s64, 18
s_lshl_b32 s61, s101, 10
s_add_u32 s60, s60, s61
s_add_u32 s48, s20, s60
s_addc_u32 s49, s21, 0
s_sub_u32 s50, 262144, s61
s_mov_b32 s51, 0x20000
s_add_u32 s52, s22, s60
s_addc_u32 s53, s23, 0
s_sub_u32 s54, 262144, s61
s_mov_b32 s55, 0x20000
s_lshl_b32 s61, s64, 1
s_add_u32 s61, s61, s101
s_lshl_b32 s61, s61, 7
s_lshl_b32 s63, s35, 1
s_add_u32 s63, s63, s68
s_lshl_b32 s60, s63, 17
s_add_u32 s60, s60, s61
s_add_u32 s56, s10, s60
s_addc_u32 s57, s11, 0
s_sub_u32 s58, 131072, s61
s_mov_b32 s59, 0x20000
s_add_u32 s26, s26, s61
s_addc_u32 s27, s27, 0
s_lshl_b32 s61, s61, 1
s_add_u32 s61, s61, 4096
s_lshl_b32 s60, s63, 19
s_add_u32 s60, s60, s61
s_add_u32 s28, s28, s60
s_addc_u32 s29, s29, 0
s_sub_u32 s24, 0x80000, s61
s_lshl_b32 s67, s34, 12
s_lshl_b32 s65, s64, 13
s_lshl_b32 s64, s64, 7
s_lshl_b32 s60, s68, 14
s_lshl_b32 s61, s66, 11
s_add_u32 s60, s60, s61
s_add_u32 s60, s60, 65536
v_add_u32 v16, s60, v10
s_lshl_b32 s60, s34, 13
s_add_u32 s60, s60, 65536
v_add_u32 v17, s60, v11
v_xor_b32 v20, 0, v7
v_add_u32 v24, 0x10000, v20
v_xor_b32 v21, 32, v7
v_add_u32 v25, 0x10000, v21
v_xor_b32 v22, 64, v7
v_add_u32 v26, 0x10000, v22
v_xor_b32 v23, 96, v7
v_add_u32 v27, 0x10000, v23
s_mul_i32 s14, s63, 262144
s_lshl_b32 s61, s36, 13
s_add_u32 s14, s14, s61
s_lshl_b32 s61, s66, 11
s_add_u32 s14, s14, s61
v_cmp_gt_u32 vcc, 0x40000, v136
s_nop 1
v_cndmask_b32 v40, 0, v202, vcc
v_cmp_gt_u32 vcc, 0x40000, v137
s_nop 1
v_cndmask_b32 v41, 0, v202, vcc
v_cmp_gt_u32 vcc, 0x40000, v138
s_nop 1
v_cndmask_b32 v42, 0, v202, vcc
v_cmp_gt_u32 vcc, 0x40000, v139
s_nop 1
v_cndmask_b32 v43, 0, v202, vcc
v_cmp_gt_u32 vcc, 0x40000, v140
s_nop 1
v_cndmask_b32 v44, 0, v202, vcc
v_cmp_gt_u32 vcc, 0x40000, v141
s_nop 1
v_cndmask_b32 v45, 0, v202, vcc
v_cmp_gt_u32 vcc, 0x40000, v142
s_nop 1
v_cndmask_b32 v46, 0, v202, vcc
v_cmp_gt_u32 vcc, 0x40000, v143
s_nop 1
v_cndmask_b32 v47, 0, v202, vcc
s_mov_b32 s69, 0
L_poll53:
v_mov_b32 v8, 0
s_waitcnt vmcnt(8)
v_bitop3_b32 v8, v8, v146, v40 bitop3:0xf6
v_bitop3_b32 v8, v8, v147, v40 bitop3:0xf6
s_waitcnt vmcnt(7)
v_bitop3_b32 v8, v8, v150, v41 bitop3:0xf6
v_bitop3_b32 v8, v8, v151, v41 bitop3:0xf6
s_waitcnt vmcnt(6)
v_bitop3_b32 v8, v8, v154, v42 bitop3:0xf6
v_bitop3_b32 v8, v8, v155, v42 bitop3:0xf6
s_waitcnt vmcnt(5)
v_bitop3_b32 v8, v8, v158, v43 bitop3:0xf6
v_bitop3_b32 v8, v8, v159, v43 bitop3:0xf6
s_waitcnt vmcnt(4)
v_bitop3_b32 v8, v8, v162, v44 bitop3:0xf6
v_bitop3_b32 v8, v8, v163, v44 bitop3:0xf6
s_waitcnt vmcnt(3)
v_bitop3_b32 v8, v8, v166, v45 bitop3:0xf6
v_bitop3_b32 v8, v8, v167, v45 bitop3:0xf6
s_waitcnt vmcnt(2)
v_bitop3_b32 v8, v8, v170, v46 bitop3:0xf6
v_bitop3_b32 v8, v8, v171, v46 bitop3:0xf6
s_waitcnt vmcnt(1)
v_bitop3_b32 v8, v8, v174, v47 bitop3:0xf6
v_bitop3_b32 v8, v8, v175, v47 bitop3:0xf6
s_waitcnt vmcnt(0)
v_xor_b32 v197, v194, v197
v_lshrrev_b32 v9, 4, v197
v_or_b32 v8, v8, v9
v_cmp_ne_u32 vcc, 0, v8
s_nop 0
s_cbranch_vccz L_polled54
s_add_u32 s69, s69, 1
s_cmp_ge_u32 s69, 200000
s_cbranch_scc1 L_polled54
buffer_load_dwordx4 v[144:147], v136, s[40:43], 0 offen sc1
buffer_load_dwordx4 v[148:151], v137, s[40:43], 0 offen sc1
buffer_load_dwordx4 v[152:155], v138, s[40:43], 0 offen sc1
buffer_load_dwordx4 v[156:159], v139, s[40:43], 0 offen sc1
buffer_load_dwordx4 v[160:163], v140, s[40:43], 0 offen sc1
buffer_load_dwordx4 v[164:167], v141, s[40:43], 0 offen sc1
buffer_load_dwordx4 v[168:171], v142, s[40:43], 0 offen sc1
buffer_load_dwordx4 v[172:175], v143, s[40:43], 0 offen sc1
global_load_dword v197, v196, s[32:33] sc1
s_branch L_poll53
L_polled54:
v_cmp_ne_u32 vcc, 0, v197
s_nop 0
s_cmp_eq_u64 vcc, 0
s_cselect_b32 s100, 1, 0
s_add_u32 m0, s67, 0
s_add_u32 s62, s64, 0
s_and_b32 s62, s62, 0x3ff
buffer_load_dwordx4 v244, s[48:51], s62 offen offset:0 lds
buffer_load_dwordx4 v245, s[48:51], s62 offen offset:1024 lds
buffer_load_dwordx4 v246, s[48:51], s62 offen offset:2048 lds
buffer_load_dwordx4 v247, s[48:51], s62 offen offset:3072 lds
s_add_u32 m0, s67, 16384
s_nop 0
buffer_load_dwordx4 v244, s[52:55], s62 offen offset:0 lds
buffer_load_dwordx4 v245, s[52:55], s62 offen offset:1024 lds
buffer_load_dwordx4 v246, s[52:55], s62 offen offset:2048 lds
buffer_load_dwordx4 v247, s[52:55], s62 offen offset:3072 lds
v_mov_b32 v14, 2
s_mov_b64 exec, 1
ds_write_b32 v13, v14
s_mov_b64 exec, -1
v_fma_f32 v40, v2, v172, v168
v_fma_f32 v41, v2, v173, v169
v_fma_f32 v48, -v3, v173, v40
v_fma_f32 v49, v3, v172, v41
v_fma_f32 v40, v2, v48, v164
v_fma_f32 v41, v2, v49, v165
v_fma_f32 v172, -v3, v49, v40
v_fma_f32 v173, v3, v48, v41
v_fma_f32 v40, v2, v172, v160
v_fma_f32 v41, v2, v173, v161
v_fma_f32 v48, -v3, v173, v40
v_fma_f32 v49, v3, v172, v41
v_fma_f32 v40, v2, v48, v156
v_fma_f32 v41, v2, v49, v157
v_fma_f32 v172, -v3, v49, v40
v_fma_f32 v173, v3, v48, v41
v_fma_f32 v40, v2, v172, v152
v_fma_f32 v41, v2, v173, v153
v_fma_f32 v48, -v3, v173, v40
v_fma_f32 v49, v3, v172, v41
v_fma_f32 v40, v2, v48, v148
v_fma_f32 v41, v2, v49, v149
v_fma_f32 v172, -v3, v49, v40
v_fma_f32 v173, v3, v48, v41
v_fma_f32 v40, v2, v172, v144
v_fma_f32 v41, v2, v173, v145
v_fma_f32 v48, -v3, v173, v40
v_fma_f32 v49, v3, v172, v41
v_mov_b32 v50, v48
v_mov_b32 v51, v49
s_nop 0
v_permlane32_swap_b32 v48, v50
v_permlane32_swap_b32 v49, v51
v_fma_f32 v40, v30, v50, v48
v_fma_f32 v41, v30, v51, v49
v_fma_f32 v52, -v31, v51, v40
v_fma_f32 v53, v31, v50, v41
v_mov_b32 v54, v52
v_mov_b32 v55, v53
s_nop 0
v_permlane16_swap_b32 v52, v54
v_permlane16_swap_b32 v53, v55
v_pk_fma_f32 v[128:129], v[52:53], v[184:185], v[128:129] op_sel_hi:[0,1,1]
v_pk_fma_f32 v[130:131], v[52:53], v[186:187], v[130:131] op_sel_hi:[0,1,1]
v_pk_fma_f32 v[128:129], v[52:53], v[186:187], v[128:129] op_sel:[1,0,0] neg_lo:[1,0,0] neg_hi:[1,0,0]
v_pk_fma_f32 v[130:131], v[52:53], v[184:185], v[130:131] op_sel:[1,0,0]
v_pk_fma_f32 v[132:133], v[54:55], v[188:189], v[132:133] op_sel_hi:[0,1,1]
v_pk_fma_f32 v[134:135], v[54:55], v[190:191], v[134:135] op_sel_hi:[0,1,1]
v_pk_fma_f32 v[132:133], v[54:55], v[190:191], v[132:133] op_sel:[1,0,0] neg_lo:[1,0,0] neg_hi:[1,0,0]
v_pk_fma_f32 v[134:135], v[54:55], v[188:189], v[134:135] op_sel:[1,0,0]
v_pk_fma_f32 v[64:65], v[208:209], v[128:129], v[64:65] op_sel_hi:[0,1,1]
v_pk_fma_f32 v[80:81], v[208:209], v[130:131], v[80:81] op_sel_hi:[0,1,1] neg_lo:[1,0,0] neg_hi:[1,0,0]
v_pk_fma_f32 v[64:65], v[208:209], v[130:131], v[64:65] op_sel:[1,0,0] neg_lo:[1,0,0] neg_hi:[1,0,0]
v_pk_fma_f32 v[80:81], v[208:209], v[128:129], v[80:81] op_sel:[1,0,0] neg_lo:[1,0,0] neg_hi:[1,0,0]
v_cvt_pk_bf16_f32 v144, v64, v65
v_cvt_pk_bf16_f32 v152, v80, v81
v_pk_fma_f32 v[96:97], v[224:225], v[132:133], v[96:97] op_sel_hi:[0,1,1]
v_pk_fma_f32 v[112:113], v[224:225], v[134:135], v[112:113] op_sel_hi:[0,1,1] neg_lo:[1,0,0] neg_hi:[1,0,0]
v_pk_fma_f32 v[96:97], v[224:225], v[134:135], v[96:97] op_sel:[1,0,0] neg_lo:[1,0,0] neg_hi:[1,0,0]
v_pk_fma_f32 v[112:113], v[224:225], v[132:133], v[112:113] op_sel:[1,0,0] neg_lo:[1,0,0] neg_hi:[1,0,0]
v_cvt_pk_bf16_f32 v160, v96, v97
v_cvt_pk_bf16_f32 v168, v112, v113
v_pk_fma_f32 v[66:67], v[210:211], v[128:129], v[66:67] op_sel_hi:[0,1,1]
v_pk_fma_f32 v[82:83], v[210:211], v[130:131], v[82:83] op_sel_hi:[0,1,1] neg_lo:[1,0,0] neg_hi:[1,0,0]
v_pk_fma_f32 v[66:67], v[210:211], v[130:131], v[66:67] op_sel:[1,0,0] neg_lo:[1,0,0] neg_hi:[1,0,0]
v_pk_fma_f32 v[82:83], v[210:211], v[128:129], v[82:83] op_sel:[1,0,0] neg_lo:[1,0,0] neg_hi:[1,0,0]
v_cvt_pk_bf16_f32 v145, v66, v67
v_cvt_pk_bf16_f32 v153, v82, v83
v_pk_fma_f32 v[98:99], v[226:227], v[132:133], v[98:99] op_sel_hi:[0,1,1]
v_pk_fma_f32 v[114:115], v[226:227], v[134:135], v[114:115] op_sel_hi:[0,1,1] neg_lo:[1,0,0] neg_hi:[1,0,0]
v_pk_fma_f32 v[98:99], v[226:227], v[134:135], v[98:99] op_sel:[1,0,0] neg_lo:[1,0,0] neg_hi:[1,0,0]
v_pk_fma_f32 v[114:115], v[226:227], v[132:133], v[114:115] op_sel:[1,0,0] neg_lo:[1,0,0] neg_hi:[1,0,0]
v_cvt_pk_bf16_f32 v161, v98, v99
v_cvt_pk_bf16_f32 v169, v114, v115
v_pk_fma_f32 v[68:69], v[212:213], v[128:129], v[68:69] op_sel_hi:[0,1,1]
v_pk_fma_f32 v[84:85], v[212:213], v[130:131], v[84:85] op_sel_hi:[0,1,1] neg_lo:[1,0,0] neg_hi:[1,0,0]
v_pk_fma_f32 v[68:69], v[212:213], v[130:131], v[68:69] op_sel:[1,0,0] neg_lo:[1,0,0] neg_hi:[1,0,0]
v_pk_fma_f32 v[84:85], v[212:213], v[128:129], v[84:85] op_sel:[1,0,0] neg_lo:[1,0,0] neg_hi:[1,0,0]
v_cvt_pk_bf16_f32 v146, v68, v69
v_cvt_pk_bf16_f32 v154, v84, v85
v_pk_fma_f32 v[100:101], v[228:229], v[132:133], v[100:101] op_sel_hi:[0,1,1]
v_pk_fma_f32 v[116:117], v[228:229], v[134:135], v[116:117] op_sel_hi:[0,1,1] neg_lo:[1,0,0] neg_hi:[1,0,0]
v_pk_fma_f32 v[100:101], v[228:229], v[134:135], v[100:101] op_sel:[1,0,0] neg_lo:[1,0,0] neg_hi:[1,0,0]
v_pk_fma_f32 v[116:117], v[228:229], v[132:133], v[116:117] op_sel:[1,0,0] neg_lo:[1,0,0] neg_hi:[1,0,0]
v_cvt_pk_bf16_f32 v162, v100, v101
v_cvt_pk_bf16_f32 v170, v116, v117
v_pk_fma_f32 v[70:71], v[214:215], v[128:129], v[70:71] op_sel_hi:[0,1,1]
v_pk_fma_f32 v[86:87], v[214:215], v[130:131], v[86:87] op_sel_hi:[0,1,1] neg_lo:[1,0,0] neg_hi:[1,0,0]
v_pk_fma_f32 v[70:71], v[214:215], v[130:131], v[70:71] op_sel:[1,0,0] neg_lo:[1,0,0] neg_hi:[1,0,0]
v_pk_fma_f32 v[86:87], v[214:215], v[128:129], v[86:87] op_sel:[1,0,0] neg_lo:[1,0,0] neg_hi:[1,0,0]
v_cvt_pk_bf16_f32 v147, v70, v71
v_cvt_pk_bf16_f32 v155, v86, v87
v_pk_fma_f32 v[102:103], v[230:231], v[132:133], v[102:103] op_sel_hi:[0,1,1]
v_pk_fma_f32 v[118:119], v[230:231], v[134:135], v[118:119] op_sel_hi:[0,1,1] neg_lo:[1,0,0] neg_hi:[1,0,0]
v_pk_fma_f32 v[102:103], v[230:231], v[134:135], v[102:103] op_sel:[1,0,0] neg_lo:[1,0,0] neg_hi:[1,0,0]
v_pk_fma_f32 v[118:119], v[230:231], v[132:133], v[118:119] op_sel:[1,0,0] neg_lo:[1,0,0] neg_hi:[1,0,0]
v_cvt_pk_bf16_f32 v163, v102, v103
v_cvt_pk_bf16_f32 v171, v118, v119
v_mfma_f32_16x16x32_bf16 v[32:35], v[144:147], v[248:251], 0
v_mfma_f32_16x16x32_bf16 v[36:39], v[160:163], v[248:251], 0
v_mfma_f32_16x16x32_bf16 v[40:43], v[144:147], v[252:255], 0
v_mfma_f32_16x16x32_bf16 v[44:47], v[160:163], v[252:255], 0
v_mfma_f32_16x16x32_bf16 v[48:51], v[152:155], v[248:251], 0
v_mfma_f32_16x16x32_bf16 v[52:55], v[168:171], v[248:251], 0
v_mfma_f32_16x16x32_bf16 v[56:59], v[152:155], v[252:255], 0
v_mfma_f32_16x16x32_bf16 v[60:63], v[168:171], v[252:255], 0
v_pk_fma_f32 v[72:73], v[216:217], v[128:129], v[72:73] op_sel_hi:[0,1,1]
v_pk_fma_f32 v[88:89], v[216:217], v[130:131], v[88:89] op_sel_hi:[0,1,1] neg_lo:[1,0,0] neg_hi:[1,0,0]
v_pk_fma_f32 v[72:73], v[216:217], v[130:131], v[72:73] op_sel:[1,0,0] neg_lo:[1,0,0] neg_hi:[1,0,0]
v_pk_fma_f32 v[88:89], v[216:217], v[128:129], v[88:89] op_sel:[1,0,0] neg_lo:[1,0,0] neg_hi:[1,0,0]
v_cvt_pk_bf16_f32 v148, v72, v73
v_cvt_pk_bf16_f32 v156, v88, v89
v_pk_fma_f32 v[104:105], v[232:233], v[132:133], v[104:105] op_sel_hi:[0,1,1]
v_pk_fma_f32 v[120:121], v[232:233], v[134:135], v[120:121] op_sel_hi:[0,1,1] neg_lo:[1,0,0] neg_hi:[1,0,0]
v_pk_fma_f32 v[104:105], v[232:233], v[134:135], v[104:105] op_sel:[1,0,0] neg_lo:[1,0,0] neg_hi:[1,0,0]
v_pk_fma_f32 v[120:121], v[232:233], v[132:133], v[120:121] op_sel:[1,0,0] neg_lo:[1,0,0] neg_hi:[1,0,0]
v_cvt_pk_bf16_f32 v164, v104, v105
v_cvt_pk_bf16_f32 v172, v120, v121
v_pk_fma_f32 v[74:75], v[218:219], v[128:129], v[74:75] op_sel_hi:[0,1,1]
v_pk_fma_f32 v[90:91], v[218:219], v[130:131], v[90:91] op_sel_hi:[0,1,1] neg_lo:[1,0,0] neg_hi:[1,0,0]
v_pk_fma_f32 v[74:75], v[218:219], v[130:131], v[74:75] op_sel:[1,0,0] neg_lo:[1,0,0] neg_hi:[1,0,0]
v_pk_fma_f32 v[90:91], v[218:219], v[128:129], v[90:91] op_sel:[1,0,0] neg_lo:[1,0,0] neg_hi:[1,0,0]
v_cvt_pk_bf16_f32 v149, v74, v75
v_cvt_pk_bf16_f32 v157, v90, v91
v_pk_fma_f32 v[106:107], v[234:235], v[132:133], v[106:107] op_sel_hi:[0,1,1]
v_pk_fma_f32 v[122:123], v[234:235], v[134:135], v[122:123] op_sel_hi:[0,1,1] neg_lo:[1,0,0] neg_hi:[1,0,0]
v_pk_fma_f32 v[106:107], v[234:235], v[134:135], v[106:107] op_sel:[1,0,0] neg_lo:[1,0,0] neg_hi:[1,0,0]
v_pk_fma_f32 v[122:123], v[234:235], v[132:133], v[122:123] op_sel:[1,0,0] neg_lo:[1,0,0] neg_hi:[1,0,0]
v_cvt_pk_bf16_f32 v165, v106, v107
v_cvt_pk_bf16_f32 v173, v122, v123
s_add_u32 s61, s14, 0
v_cvt_pk_bf16_f32 v176, v32, v33
v_cvt_pk_bf16_f32 v177, v34, v35
v_cvt_pk_bf16_f32 v178, v36, v37
v_cvt_pk_bf16_f32 v179, v38, v39
buffer_store_dwordx4 v[176:179], v10, s[44:47], s61 offen offset:0 sc1
ds_write_b128 v16, v[176:179] offset:0
s_add_u32 s61, s14, 131072
v_cvt_pk_bf16_f32 v180, v40, v41
v_cvt_pk_bf16_f32 v181, v42, v43
v_cvt_pk_bf16_f32 v182, v44, v45
v_cvt_pk_bf16_f32 v183, v46, v47
buffer_store_dwordx4 v[180:183], v10, s[44:47], s61 offen offset:0 sc1
ds_write_b128 v16, v[180:183] offset:8192
s_add_u32 s61, s14, 4096
v_cvt_pk_bf16_f32 v184, v48, v49
v_cvt_pk_bf16_f32 v185, v50, v51
v_cvt_pk_bf16_f32 v186, v52, v53
v_cvt_pk_bf16_f32 v187, v54, v55
buffer_store_dwordx4 v[184:187], v10, s[44:47], s61 offen offset:0 sc1
ds_write_b128 v16, v[184:187] offset:4096
s_add_u32 s61, s14, 135168
v_cvt_pk_bf16_f32 v188, v56, v57
v_cvt_pk_bf16_f32 v189, v58, v59
v_cvt_pk_bf16_f32 v190, v60, v61
v_cvt_pk_bf16_f32 v191, v62, v63
buffer_store_dwordx4 v[188:191], v10, s[44:47], s61 offen offset:0 sc1
ds_write_b128 v16, v[188:191] offset:12288
v_pk_fma_f32 v[76:77], v[220:221], v[128:129], v[76:77] op_sel_hi:[0,1,1]
v_pk_fma_f32 v[92:93], v[220:221], v[130:131], v[92:93] op_sel_hi:[0,1,1] neg_lo:[1,0,0] neg_hi:[1,0,0]
v_pk_fma_f32 v[76:77], v[220:221], v[130:131], v[76:77] op_sel:[1,0,0] neg_lo:[1,0,0] neg_hi:[1,0,0]
v_pk_fma_f32 v[92:93], v[220:221], v[128:129], v[92:93] op_sel:[1,0,0] neg_lo:[1,0,0] neg_hi:[1,0,0]
v_cvt_pk_bf16_f32 v150, v76, v77
v_cvt_pk_bf16_f32 v158, v92, v93
v_pk_fma_f32 v[108:109], v[236:237], v[132:133], v[108:109] op_sel_hi:[0,1,1]
v_pk_fma_f32 v[124:125], v[236:237], v[134:135], v[124:125] op_sel_hi:[0,1,1] neg_lo:[1,0,0] neg_hi:[1,0,0]
v_pk_fma_f32 v[108:109], v[236:237], v[134:135], v[108:109] op_sel:[1,0,0] neg_lo:[1,0,0] neg_hi:[1,0,0]
v_pk_fma_f32 v[124:125], v[236:237], v[132:133], v[124:125] op_sel:[1,0,0] neg_lo:[1,0,0] neg_hi:[1,0,0]
v_cvt_pk_bf16_f32 v166, v108, v109
v_cvt_pk_bf16_f32 v174, v124, v125
v_pk_fma_f32 v[78:79], v[222:223], v[128:129], v[78:79] op_sel_hi:[0,1,1]
v_pk_fma_f32 v[94:95], v[222:223], v[130:131], v[94:95] op_sel_hi:[0,1,1] neg_lo:[1,0,0] neg_hi:[1,0,0]
v_pk_fma_f32 v[78:79], v[222:223], v[130:131], v[78:79] op_sel:[1,0,0] neg_lo:[1,0,0] neg_hi:[1,0,0]
v_pk_fma_f32 v[94:95], v[222:223], v[128:129], v[94:95] op_sel:[1,0,0] neg_lo:[1,0,0] neg_hi:[1,0,0]
v_cvt_pk_bf16_f32 v151, v78, v79
v_cvt_pk_bf16_f32 v159, v94, v95
v_pk_fma_f32 v[110:111], v[238:239], v[132:133], v[110:111] op_sel_hi:[0,1,1]
v_pk_fma_f32 v[126:127], v[238:239], v[134:135], v[126:127] op_sel_hi:[0,1,1] neg_lo:[1,0,0] neg_hi:[1,0,0]
v_pk_fma_f32 v[110:111], v[238:239], v[134:135], v[110:111] op_sel:[1,0,0] neg_lo:[1,0,0] neg_hi:[1,0,0]
v_pk_fma_f32 v[126:127], v[238:239], v[132:133], v[126:127] op_sel:[1,0,0] neg_lo:[1,0,0] neg_hi:[1,0,0]
v_cvt_pk_bf16_f32 v167, v110, v111
v_cvt_pk_bf16_f32 v175, v126, v127
v_mfma_f32_16x16x32_bf16 v[32:35], v[148:151], v[248:251], 0
v_mfma_f32_16x16x32_bf16 v[36:39], v[164:167], v[248:251], 0
v_mfma_f32_16x16x32_bf16 v[40:43], v[148:151], v[252:255], 0
v_mfma_f32_16x16x32_bf16 v[44:47], v[164:167], v[252:255], 0
v_mfma_f32_16x16x32_bf16 v[48:51], v[156:159], v[248:251], 0
v_mfma_f32_16x16x32_bf16 v[52:55], v[172:175], v[248:251], 0
v_mfma_f32_16x16x32_bf16 v[56:59], v[156:159], v[252:255], 0
v_mfma_f32_16x16x32_bf16 v[60:63], v[172:175], v[252:255], 0
s_add_u32 s61, s14, 0
v_cvt_pk_bf16_f32 v192, v32, v33
v_cvt_pk_bf16_f32 v193, v34, v35
v_cvt_pk_bf16_f32 v194, v36, v37
v_cvt_pk_bf16_f32 v195, v38, v39
buffer_store_dwordx4 v[192:195], v10, s[44:47], s61 offen offset:256 sc1
ds_write_b128 v16, v[192:195] offset:256
s_add_u32 s61, s14, 131072
v_cvt_pk_bf16_f32 v196, v40, v41
v_cvt_pk_bf16_f32 v197, v42, v43
v_cvt_pk_bf16_f32 v198, v44, v45
v_cvt_pk_bf16_f32 v199, v46, v47
buffer_store_dwordx4 v[196:199], v10, s[44:47], s61 offen offset:256 sc1
ds_write_b128 v16, v[196:199] offset:8448
s_add_u32 s61, s14, 4096
v_cvt_pk_bf16_f32 v200, v48, v49
v_cvt_pk_bf16_f32 v201, v50, v51
v_cvt_pk_bf16_f32 v202, v52, v53
v_cvt_pk_bf16_f32 v203, v54, v55
buffer_store_dwordx4 v[200:203], v10, s[44:47], s61 offen offset:256 sc1
ds_write_b128 v16, v[200:203] offset:4352
s_add_u32 s61, s14, 135168
v_cvt_pk_bf16_f32 v204, v56, v57
v_cvt_pk_bf16_f32 v205, v58, v59
v_cvt_pk_bf16_f32 v206, v60, v61
v_cvt_pk_bf16_f32 v207, v62, v63
buffer_store_dwordx4 v[204:207], v10, s[44:47], s61 offen offset:256 sc1
ds_write_b128 v16, v[204:207] offset:12544
v_mov_b32 v2, v11
s_lshl_b32 s60, s35, 2
s_add_u32 s60, s60, s34
s_mul_i32 s60, s60, 131072
s_lshl_b32 s61, s101, 16
s_add_u32 s60, s60, s61
s_add_u32 s42, s60, 1048576
s_add_u32 s40, s32, s42
s_addc_u32 s41, s33, 0
s_mov_b32 s42, 65536
s_mov_b32 s43, 0x20000
s_waitcnt vmcnt(8) lgkmcnt(0)
v_mov_b32 v14, 3
s_mov_b64 exec, 1
ds_write_b32 v13, v14
s_mov_b64 exec, -1
ds_read_b128 v[8:11], v12 offset:0
s_waitcnt lgkmcnt(0)
L_ck55:
v_min3_u32 v15, v8, v9, v10
v_min_u32 v15, v15, v11
s_nop 0
v_readfirstlane_b32 s60, v15
s_nop 0
s_cmp_ge_u32 s60, 3
s_cbranch_scc1 L_ckd56
ds_read_b128 v[8:11], v12 offset:0
s_waitcnt lgkmcnt(0)
s_branch L_ck55
L_ckd56:
ds_read_b128 v[148:151], v17 offset:0
ds_read_b128 v[152:155], v17 offset:1024
ds_read_b128 v[156:159], v17 offset:2048
ds_read_b128 v[160:163], v17 offset:3072
ds_read_b128 v[164:167], v17 offset:4096
ds_read_b128 v[168:171], v17 offset:5120
ds_read_b128 v[172:175], v17 offset:6144
ds_read_b128 v[176:179], v17 offset:7168
ds_read_b128 v[96:99], v20 offset:0
ds_read_b128 v[100:103], v20 offset:4096
ds_read_b128 v[104:107], v20 offset:8192
ds_read_b128 v[108:111], v20 offset:12288
s_waitcnt lgkmcnt(4)
v_mov_b32 v14, 4
s_mov_b64 exec, 1
ds_write_b32 v13, v14
s_mov_b64 exec, -1
s_waitcnt lgkmcnt(0)
v_mfma_f32_32x32x16_bf16 v[32:47], v[148:151], v[96:99], 0
ds_read_b128 v[112:115], v21 offset:0
ds_read_b128 v[116:119], v21 offset:4096
v_mfma_f32_32x32x16_bf16 v[48:63], v[148:151], v[100:103], 0
ds_read_b128 v[120:123], v21 offset:8192
ds_read_b128 v[124:127], v21 offset:12288
v_mfma_f32_32x32x16_bf16 v[64:79], v[148:151], v[104:107], 0
s_add_u32 m0, s67, 32768
s_add_u32 s62, s64, 128
s_and_b32 s62, s62, 0x3ff
buffer_load_dwordx4 v244, s[48:51], s62 offen offset:0 lds
v_mfma_f32_32x32x16_bf16 v[80:95], v[148:151], v[108:111], 0
s_waitcnt lgkmcnt(3)
v_mfma_f32_32x32x16_bf16 v[32:47], v[152:155], v[112:115], v[32:47]
ds_read_b128 v[96:99], v22 offset:0
ds_read_b128 v[100:103], v22 offset:4096
s_waitcnt lgkmcnt(4)
v_mfma_f32_32x32x16_bf16 v[48:63], v[152:155], v[116:119], v[48:63]
ds_read_b128 v[104:107], v22 offset:8192
ds_read_b128 v[108:111], v22 offset:12288
s_waitcnt lgkmcnt(5)
v_mfma_f32_32x32x16_bf16 v[64:79], v[152:155], v[120:123], v[64:79]
buffer_load_dwordx4 v245, s[48:51], s62 offen offset:1024 lds
s_waitcnt lgkmcnt(4)
v_mfma_f32_32x32x16_bf16 v[80:95], v[152:155], v[124:127], v[80:95]
s_waitcnt lgkmcnt(3)
v_mfma_f32_32x32x16_bf16 v[32:47], v[156:159], v[96:99], v[32:47]
ds_read_b128 v[112:115], v23 offset:0
ds_read_b128 v[116:119], v23 offset:4096
s_waitcnt lgkmcnt(4)
v_mfma_f32_32x32x16_bf16 v[48:63], v[156:159], v[100:103], v[48:63]
ds_read_b128 v[120:123], v23 offset:8192
ds_read_b128 v[124:127], v23 offset:12288
s_waitcnt lgkmcnt(5)
v_mfma_f32_32x32x16_bf16 v[64:79], v[156:159], v[104:107], v[64:79]
buffer_load_dwordx4 v246, s[48:51], s62 offen offset:2048 lds
s_waitcnt lgkmcnt(4)
v_mfma_f32_32x32x16_bf16 v[80:95], v[156:159], v[108:111], v[80:95]
s_waitcnt lgkmcnt(3)
v_mfma_f32_32x32x16_bf16 v[32:47], v[160:163], v[112:115], v[32:47]
ds_read_b128 v[96:99], v20 offset:16384
ds_read_b128 v[100:103], v20 offset:20480
s_waitcnt lgkmcnt(4)
v_mfma_f32_32x32x16_bf16 v[48:63], v[160:163], v[116:119], v[48:63]
ds_read_b128 v[104:107], v20 offset:24576
ds_read_b128 v[108:111], v20 offset:28672
s_waitcnt lgkmcnt(5)
v_mfma_f32_32x32x16_bf16 v[64:79], v[160:163], v[120:123], v[64:79]
buffer_load_dwordx4 v247, s[48:51], s62 offen offset:3072 lds
s_waitcnt lgkmcnt(4)
v_mfma_f32_32x32x16_bf16 v[80:95], v[160:163], v[124:127], v[80:95]
s_waitcnt lgkmcnt(3)
v_mfma_f32_32x32x16_bf16 v[32:47], v[164:167], v[96:99], v[32:47]
ds_read_b128 v[112:115], v21 offset:16384
ds_read_b128 v[116:119], v21 offset:20480
s_waitcnt lgkmcnt(4)
v_mfma_f32_32x32x16_bf16 v[48:63], v[164:167], v[100:103], v[48:63]
ds_read_b128 v[120:123], v21 offset:24576
ds_read_b128 v[124:127], v21 offset:28672
s_waitcnt lgkmcnt(5)
v_mfma_f32_32x32x16_bf16 v[64:79], v[164:167], v[104:107], v[64:79]
s_add_u32 m0, s67, 49152
s_nop 0
buffer_load_dwordx4 v244, s[52:55], s62 offen offset:0 lds
s_waitcnt lgkmcnt(4)
v_mfma_f32_32x32x16_bf16 v[80:95], v[164:167], v[108:111], v[80:95]
s_waitcnt lgkmcnt(3)
v_mfma_f32_32x32x16_bf16 v[32:47], v[168:171], v[112:115], v[32:47]
ds_read_b128 v[96:99], v22 offset:16384
ds_read_b128 v[100:103], v22 offset:20480
s_waitcnt lgkmcnt(4)
v_mfma_f32_32x32x16_bf16 v[48:63], v[168:171], v[116:119], v[48:63]
ds_read_b128 v[104:107], v22 offset:24576
ds_read_b128 v[108:111], v22 offset:28672
s_waitcnt lgkmcnt(5)
v_mfma_f32_32x32x16_bf16 v[64:79], v[168:171], v[120:123], v[64:79]
buffer_load_dwordx4 v245, s[52:55], s62 offen offset:1024 lds
s_waitcnt lgkmcnt(4)
v_mfma_f32_32x32x16_bf16 v[80:95], v[168:171], v[124:127], v[80:95]
s_waitcnt lgkmcnt(3)
v_mfma_f32_32x32x16_bf16 v[32:47], v[172:175], v[96:99], v[32:47]
ds_read_b128 v[112:115], v23 offset:16384
ds_read_b128 v[116:119], v23 offset:20480
s_waitcnt lgkmcnt(4)
v_mfma_f32_32x32x16_bf16 v[48:63], v[172:175], v[100:103], v[48:63]
ds_read_b128 v[120:123], v23 offset:24576
ds_read_b128 v[124:127], v23 offset:28672
s_waitcnt lgkmcnt(5)
v_mfma_f32_32x32x16_bf16 v[64:79], v[172:175], v[104:107], v[64:79]
buffer_load_dwordx4 v246, s[52:55], s62 offen offset:2048 lds
s_waitcnt lgkmcnt(4)
v_mfma_f32_32x32x16_bf16 v[80:95], v[172:175], v[108:111], v[80:95]
s_waitcnt lgkmcnt(0)
v_mfma_f32_32x32x16_bf16 v[32:47], v[176:179], v[112:115], v[32:47]
v_mfma_f32_32x32x16_bf16 v[48:63], v[176:179], v[116:119], v[48:63]
v_mfma_f32_32x32x16_bf16 v[64:79], v[176:179], v[120:123], v[64:79]
buffer_load_dwordx4 v247, s[52:55], s62 offen offset:3072 lds
v_mfma_f32_32x32x16_bf16 v[80:95], v[176:179], v[124:127], v[80:95]
s_lshl_b32 s60, s66, 3
v_lshl_add_u32 v17, v5, 4, s60
v_lshlrev_b32 v28, 11, v17
v_lshl_add_u32 v28, v6, 2, v28
v_lshlrev_b32 v29, 13, v17
v_lshl_add_u32 v29, v6, 3, v29
v_lshlrev_b32 v30, 2, v6
v_mov_b32 v15, s37
s_waitcnt vmcnt(8)
s_mov_b64 exec, 1
s_cmp_eq_u32 s100, 0
s_cbranch_scc1 L_rs57
global_store_dword v19, v15, s[32:33]
s_branch L_rd58
L_rs57:
global_store_dword v19, v15, s[32:33] sc1
L_rd58:
s_mov_b64 exec, -1
ds_read_b128 v[8:11], v12 offset:0
s_waitcnt lgkmcnt(0)
L_ck59:
v_min3_u32 v15, v8, v9, v10
v_min_u32 v15, v15, v11
s_nop 0
v_readfirstlane_b32 s60, v15
s_nop 0
s_cmp_ge_u32 s60, 4
s_cbranch_scc1 L_ckd60
ds_read_b128 v[8:11], v12 offset:0
s_waitcnt lgkmcnt(0)
s_branch L_ck59
L_ckd60:
ds_read_b128 v[8:11], v12 offset:16
s_waitcnt lgkmcnt(0)
L_ck61:
v_min3_u32 v15, v8, v9, v10
v_min_u32 v15, v15, v11
s_nop 0
v_readfirstlane_b32 s60, v15
s_nop 0
s_cmp_ge_u32 s60, 2
s_cbranch_scc1 L_ckd62
ds_read_b128 v[8:11], v12 offset:16
s_waitcnt lgkmcnt(0)
s_branch L_ck61
L_ckd62:
s_add_u32 m0, s67, 65536
s_add_u32 s62, s64, 256
s_and_b32 s62, s62, 0x3ff
buffer_load_dwordx4 v244, s[48:51], s62 offen offset:0 lds
buffer_load_dwordx4 v245, s[48:51], s62 offen offset:1024 lds
buffer_load_dwordx4 v246, s[48:51], s62 offen offset:2048 lds
buffer_load_dwordx4 v247, s[48:51], s62 offen offset:3072 lds
s_add_u32 m0, s67, 81920
s_nop 0
buffer_load_dwordx4 v244, s[52:55], s62 offen offset:0 lds
buffer_load_dwordx4 v245, s[52:55], s62 offen offset:1024 lds
buffer_load_dwordx4 v246, s[52:55], s62 offen offset:2048 lds
buffer_load_dwordx4 v247, s[52:55], s62 offen offset:3072 lds
s_mov_b32 s92, 0
L_w63:
global_load_dword v8, v18, s[32:33] sc1
s_waitcnt vmcnt(0)
v_cmp_ne_u32 vcc, s37, v8
s_nop 0
s_cbranch_vccz L_wd64
s_sleep 4
s_add_u32 s92, s92, 1
s_cmp_lt_u32 s92, 200000
s_cbranch_scc1 L_w63
L_wd64:
v_mov_b32 v14, 5
s_mov_b64 exec, 1
ds_write_b32 v13, v14
s_mov_b64 exec, -1
s_add_u32 s63, s65, 8192
s_and_b32 s63, s63, 0xffff
buffer_load_dwordx4 v[180:183], v2, s[40:43], s63 offen offset:0 sc1
buffer_load_dwordx4 v[184:187], v2, s[40:43], s63 offen offset:1024 sc1
buffer_load_dwordx4 v[188:191], v2, s[40:43], s63 offen offset:2048 sc1
buffer_load_dwordx4 v[192:195], v2, s[40:43], s63 offen offset:3072 sc1
s_add_u32 m0, s67, 98304
s_add_u32 s62, s64, 384
s_and_b32 s62, s62, 0x3ff
buffer_load_dwordx4 v244, s[48:51], s62 offen offset:0 lds
buffer_load_dwordx4 v245, s[48:51], s62 offen offset:1024 lds
buffer_load_dwordx4 v246, s[48:51], s62 offen offset:2048 lds
buffer_load_dwordx4 v247, s[48:51], s62 offen offset:3072 lds
s_add_u32 s63, s65, 12288
s_and_b32 s63, s63, 0xffff
buffer_load_dwordx4 v[196:199], v2, s[40:43], s63 offen offset:0 sc1
buffer_load_dwordx4 v[200:203], v2, s[40:43], s63 offen offset:1024 sc1
buffer_load_dwordx4 v[204:207], v2, s[40:43], s63 offen offset:2048 sc1
buffer_load_dwordx4 v[208:211], v2, s[40:43], s63 offen offset:3072 sc1
ds_read_b128 v[8:11], v12 offset:0
s_waitcnt lgkmcnt(0)
L_ck65:
v_min3_u32 v15, v8, v9, v10
v_min_u32 v15, v15, v11
s_nop 0
v_readfirstlane_b32 s60, v15
s_nop 0
s_cmp_ge_u32 s60, 5
s_cbranch_scc1 L_ckd66
ds_read_b128 v[8:11], v12 offset:0
s_waitcnt lgkmcnt(0)
s_branch L_ck65
L_ckd66:
ds_read_b128 v[96:99], v20 offset:32768
ds_read_b128 v[100:103], v20 offset:36864
ds_read_b128 v[104:107], v20 offset:40960
ds_read_b128 v[108:111], v20 offset:45056
s_waitcnt vmcnt(11) lgkmcnt(3)
v_mfma_f32_32x32x16_bf16 v[32:47], v[180:183], v[96:99], v[32:47]
ds_read_b128 v[112:115], v21 offset:32768
ds_read_b128 v[116:119], v21 offset:36864
s_waitcnt lgkmcnt(4)
v_mfma_f32_32x32x16_bf16 v[48:63], v[180:183], v[100:103], v[48:63]
ds_read_b128 v[120:123], v21 offset:40960
ds_read_b128 v[124:127], v21 offset:45056
s_waitcnt lgkmcnt(5)
v_mfma_f32_32x32x16_bf16 v[64:79], v[180:183], v[104:107], v[64:79]
s_waitcnt lgkmcnt(4)
v_mfma_f32_32x32x16_bf16 v[80:95], v[180:183], v[108:111], v[80:95]
s_add_u32 s63, s65, 16384
s_and_b32 s63, s63, 0xffff
buffer_load_dwordx4 v[212:215], v2, s[40:43], s63 offen offset:0 sc1
buffer_load_dwordx4 v[216:219], v2, s[40:43], s63 offen offset:1024 sc1
s_waitcnt vmcnt(12) lgkmcnt(3)
v_mfma_f32_32x32x16_bf16 v[32:47], v[184:187], v[112:115], v[32:47]
ds_read_b128 v[96:99], v22 offset:32768
ds_read_b128 v[100:103], v22 offset:36864
s_waitcnt lgkmcnt(4)
v_mfma_f32_32x32x16_bf16 v[48:63], v[184:187], v[116:119], v[48:63]
ds_read_b128 v[104:107], v22 offset:40960
ds_read_b128 v[108:111], v22 offset:45056
s_waitcnt lgkmcnt(5)
v_mfma_f32_32x32x16_bf16 v[64:79], v[184:187], v[120:123], v[64:79]
s_waitcnt lgkmcnt(4)
v_mfma_f32_32x32x16_bf16 v[80:95], v[184:187], v[124:127], v[80:95]
buffer_load_dwordx4 v[220:223], v2, s[40:43], s63 offen offset:2048 sc1
buffer_load_dwordx4 v[224:227], v2, s[40:43], s63 offen offset:3072 sc1
s_waitcnt vmcnt(13) lgkmcnt(3)
v_mfma_f32_32x32x16_bf16 v[32:47], v[188:191], v[96:99], v[32:47]
ds_read_b128 v[112:115], v23 offset:32768
ds_read_b128 v[116:119], v23 offset:36864
s_waitcnt lgkmcnt(4)
v_mfma_f32_32x32x16_bf16 v[48:63], v[188:191], v[100:103], v[48:63]
ds_read_b128 v[120:123], v23 offset:40960
ds_read_b128 v[124:127], v23 offset:45056
s_waitcnt lgkmcnt(5)
v_mfma_f32_32x32x16_bf16 v[64:79], v[188:191], v[104:107], v[64:79]
s_waitcnt lgkmcnt(4)
v_mfma_f32_32x32x16_bf16 v[80:95], v[188:191], v[108:111], v[80:95]
s_add_u32 s63, s65, 20480
s_and_b32 s63, s63, 0xffff
buffer_load_dwordx4 v[228:231], v2, s[40:43], s63 offen offset:0 sc1
buffer_load_dwordx4 v[232:235], v2, s[40:43], s63 offen offset:1024 sc1
s_waitcnt vmcnt(14) lgkmcnt(3)
v_mfma_f32_32x32x16_bf16 v[32:47], v[192:195], v[112:115], v[32:47]
ds_read_b128 v[96:99], v20 offset:49152
ds_read_b128 v[100:103], v20 offset:53248
s_waitcnt lgkmcnt(4)
v_mfma_f32_32x32x16_bf16 v[48:63], v[192:195], v[116:119], v[48:63]
ds_read_b128 v[104:107], v20 offset:57344
ds_read_b128 v[108:111], v20 offset:61440
s_waitcnt lgkmcnt(5)
v_mfma_f32_32x32x16_bf16 v[64:79], v[192:195], v[120:123], v[64:79]
s_waitcnt lgkmcnt(4)
v_mfma_f32_32x32x16_bf16 v[80:95], v[192:195], v[124:127], v[80:95]
buffer_load_dwordx4 v[236:239], v2, s[40:43], s63 offen offset:2048 sc1
buffer_load_dwordx4 v[240:243], v2, s[40:43], s63 offen offset:3072 sc1
s_waitcnt vmcnt(11) lgkmcnt(3)
v_mov_b32 v14, 6
s_mov_b64 exec, 1
ds_write_b32 v13, v14
s_mov_b64 exec, -1
v_mfma_f32_32x32x16_bf16 v[32:47], v[196:199], v[96:99], v[32:47]
ds_read_b128 v[112:115], v21 offset:49152
ds_read_b128 v[116:119], v21 offset:53248
s_waitcnt lgkmcnt(5)
v_mfma_f32_32x32x16_bf16 v[48:63], v[196:199], v[100:103], v[48:63]
ds_read_b128 v[120:123], v21 offset:57344
ds_read_b128 v[124:127], v21 offset:61440
s_waitcnt lgkmcnt(6)
v_mfma_f32_32x32x16_bf16 v[64:79], v[196:199], v[104:107], v[64:79]
s_add_u32 m0, s67, 0
s_nop 0
buffer_load_dwordx4 v244, s[52:55], s62 offen offset:0 lds
s_waitcnt lgkmcnt(5)
v_mfma_f32_32x32x16_bf16 v[80:95], v[196:199], v[108:111], v[80:95]
s_add_u32 s63, s65, 24576
s_and_b32 s63, s63, 0xffff
buffer_load_dwordx4 v[148:151], v2, s[40:43], s63 offen offset:0 sc1
buffer_load_dwordx4 v[152:155], v2, s[40:43], s63 offen offset:1024 sc1
s_waitcnt vmcnt(13) lgkmcnt(3)
v_mfma_f32_32x32x16_bf16 v[32:47], v[200:203], v[112:115], v[32:47]
ds_read_b128 v[96:99], v22 offset:49152
ds_read_b128 v[100:103], v22 offset:53248
s_waitcnt lgkmcnt(4)
v_mfma_f32_32x32x16_bf16 v[48:63], v[200:203], v[116:119], v[48:63]
ds_read_b128 v[104:107], v22 offset:57344
ds_read_b128 v[108:111], v22 offset:61440
s_waitcnt lgkmcnt(5)
v_mfma_f32_32x32x16_bf16 v[64:79], v[200:203], v[120:123], v[64:79]
buffer_load_dwordx4 v245, s[52:55], s62 offen offset:1024 lds
s_waitcnt lgkmcnt(4)
v_mfma_f32_32x32x16_bf16 v[80:95], v[200:203], v[124:127], v[80:95]
buffer_load_dwordx4 v[156:159], v2, s[40:43], s63 offen offset:2048 sc1
buffer_load_dwordx4 v[160:163], v2, s[40:43], s63 offen offset:3072 sc1
s_waitcnt vmcnt(15) lgkmcnt(3)
v_mfma_f32_32x32x16_bf16 v[32:47], v[204:207], v[96:99], v[32:47]
ds_read_b128 v[112:115], v23 offset:49152
ds_read_b128 v[116:119], v23 offset:53248
s_waitcnt lgkmcnt(4)
v_mfma_f32_32x32x16_bf16 v[48:63], v[204:207], v[100:103], v[48:63]
ds_read_b128 v[120:123], v23 offset:57344
ds_read_b128 v[124:127], v23 offset:61440
s_waitcnt lgkmcnt(5)
v_mfma_f32_32x32x16_bf16 v[64:79], v[204:207], v[104:107], v[64:79]
buffer_load_dwordx4 v246, s[52:55], s62 offen offset:2048 lds
s_waitcnt lgkmcnt(4)
v_mfma_f32_32x32x16_bf16 v[80:95], v[204:207], v[108:111], v[80:95]
s_add_u32 s63, s65, 28672
s_and_b32 s63, s63, 0xffff
buffer_load_dwordx4 v[164:167], v2, s[40:43], s63 offen offset:0 sc1
buffer_load_dwordx4 v[168:171], v2, s[40:43], s63 offen offset:1024 sc1
ds_read_b128 v[8:11], v12
s_waitcnt vmcnt(17) lgkmcnt(0)
L_ck67:
v_min3_u32 v15, v8, v9, v10
v_min_u32 v15, v15, v11
s_nop 0
v_readfirstlane_b32 s60, v15
s_nop 0
s_cmp_ge_u32 s60, 6
s_cbranch_scc1 L_ckd68
ds_read_b128 v[8:11], v12 offset:0
s_waitcnt lgkmcnt(0)
s_branch L_ck67
L_ckd68:
v_mfma_f32_32x32x16_bf16 v[32:47], v[208:211], v[112:115], v[32:47]
ds_read_b128 v[96:99], v24 offset:0
ds_read_b128 v[100:103], v24 offset:4096
v_mfma_f32_32x32x16_bf16 v[48:63], v[208:211], v[116:119], v[48:63]
ds_read_b128 v[104:107], v24 offset:8192
ds_read_b128 v[108:111], v24 offset:12288
v_mfma_f32_32x32x16_bf16 v[64:79], v[208:211], v[120:123], v[64:79]
buffer_load_dwordx4 v247, s[52:55], s62 offen offset:3072 lds
v_mfma_f32_32x32x16_bf16 v[80:95], v[208:211], v[124:127], v[80:95]
buffer_load_dwordx4 v[172:175], v2, s[40:43], s63 offen offset:2048 sc1
buffer_load_dwordx4 v[176:179], v2, s[40:43], s63 offen offset:3072 sc1
s_waitcnt vmcnt(19) lgkmcnt(3)
v_mfma_f32_32x32x16_bf16 v[32:47], v[212:215], v[96:99], v[32:47]
ds_read_b128 v[112:115], v25 offset:0
ds_read_b128 v[116:119], v25 offset:4096
s_waitcnt lgkmcnt(4)
v_mfma_f32_32x32x16_bf16 v[48:63], v[212:215], v[100:103], v[48:63]
ds_read_b128 v[120:123], v25 offset:8192
ds_read_b128 v[124:127], v25 offset:12288
s_waitcnt lgkmcnt(5)
v_mfma_f32_32x32x16_bf16 v[64:79], v[212:215], v[104:107], v[64:79]
s_add_u32 m0, s67, 16384
s_add_u32 s62, s64, 512
s_and_b32 s62, s62, 0x3ff
buffer_load_dwordx4 v244, s[48:51], s62 offen offset:0 lds
s_waitcnt lgkmcnt(4)
v_mfma_f32_32x32x16_bf16 v[80:95], v[212:215], v[108:111], v[80:95]
s_add_u32 s63, s65, 32768
s_and_b32 s63, s63, 0xffff
buffer_load_dwordx4 v[180:183], v2, s[40:43], s63 offen offset:0 sc1
buffer_load_dwordx4 v[184:187], v2, s[40:43], s63 offen offset:1024 sc1
s_waitcnt vmcnt(21) lgkmcnt(3)
v_mfma_f32_32x32x16_bf16 v[32:47], v[216:219], v[112:115], v[32:47]
ds_read_b128 v[96:99], v26 offset:0
ds_read_b128 v[100:103], v26 offset:4096
s_waitcnt lgkmcnt(4)
v_mfma_f32_32x32x16_bf16 v[48:63], v[216:219], v[116:119], v[48:63]
ds_read_b128 v[104:107], v26 offset:8192
ds_read_b128 v[108:111], v26 offset:12288
s_waitcnt lgkmcnt(5)
v_mfma_f32_32x32x16_bf16 v[64:79], v[216:219], v[120:123], v[64:79]
buffer_load_dwordx4 v245, s[48:51], s62 offen offset:1024 lds
s_waitcnt lgkmcnt(4)
v_mfma_f32_32x32x16_bf16 v[80:95], v[216:219], v[124:127], v[80:95]
buffer_load_dwordx4 v[188:191], v2, s[40:43], s63 offen offset:2048 sc1
buffer_load_dwordx4 v[192:195], v2, s[40:43], s63 offen offset:3072 sc1
s_waitcnt vmcnt(23) lgkmcnt(3)
v_mfma_f32_32x32x16_bf16 v[32:47], v[220:223], v[96:99], v[32:47]
ds_read_b128 v[112:115], v27 offset:0
ds_read_b128 v[116:119], v27 offset:4096
s_waitcnt lgkmcnt(4)
v_mfma_f32_32x32x16_bf16 v[48:63], v[220:223], v[100:103], v[48:63]
ds_read_b128 v[120:123], v27 offset:8192
ds_read_b128 v[124:127], v27 offset:12288
s_waitcnt lgkmcnt(5)
v_mfma_f32_32x32x16_bf16 v[64:79], v[220:223], v[104:107], v[64:79]
buffer_load_dwordx4 v246, s[48:51], s62 offen offset:2048 lds
s_waitcnt lgkmcnt(4)
v_mfma_f32_32x32x16_bf16 v[80:95], v[220:223], v[108:111], v[80:95]
s_add_u32 s63, s65, 36864
s_and_b32 s63, s63, 0xffff
buffer_load_dwordx4 v[196:199], v2, s[40:43], s63 offen offset:0 sc1
buffer_load_dwordx4 v[200:203], v2, s[40:43], s63 offen offset:1024 sc1
s_waitcnt vmcnt(25) lgkmcnt(3)
v_mfma_f32_32x32x16_bf16 v[32:47], v[224:227], v[112:115], v[32:47]
ds_read_b128 v[96:99], v24 offset:16384
ds_read_b128 v[100:103], v24 offset:20480
s_waitcnt lgkmcnt(4)
v_mfma_f32_32x32x16_bf16 v[48:63], v[224:227], v[116:119], v[48:63]
ds_read_b128 v[104:107], v24 offset:24576
ds_read_b128 v[108:111], v24 offset:28672
s_waitcnt lgkmcnt(5)
v_mfma_f32_32x32x16_bf16 v[64:79], v[224:227], v[120:123], v[64:79]
buffer_load_dwordx4 v247, s[48:51], s62 offen offset:3072 lds
s_waitcnt lgkmcnt(4)
v_mfma_f32_32x32x16_bf16 v[80:95], v[224:227], v[124:127], v[80:95]
buffer_load_dwordx4 v[204:207], v2, s[40:43], s63 offen offset:2048 sc1
buffer_load_dwordx4 v[208:211], v2, s[40:43], s63 offen offset:3072 sc1
s_waitcnt vmcnt(14) lgkmcnt(3)
v_mov_b32 v14, 7
s_mov_b64 exec, 1
ds_write_b32 v13, v14
s_mov_b64 exec, -1
v_mfma_f32_32x32x16_bf16 v[32:47], v[228:231], v[96:99], v[32:47]
ds_read_b128 v[112:115], v25 offset:16384
ds_read_b128 v[116:119], v25 offset:20480
s_waitcnt lgkmcnt(5)
v_mfma_f32_32x32x16_bf16 v[48:63], v[228:231], v[100:103], v[48:63]
ds_read_b128 v[120:123], v25 offset:24576
ds_read_b128 v[124:127], v25 offset:28672
s_waitcnt lgkmcnt(6)
v_mfma_f32_32x32x16_bf16 v[64:79], v[228:231], v[104:107], v[64:79]
s_add_u32 m0, s67, 32768
s_nop 0
buffer_load_dwordx4 v244, s[52:55], s62 offen offset:0 lds
s_waitcnt lgkmcnt(5)
v_mfma_f32_32x32x16_bf16 v[80:95], v[228:231], v[108:111], v[80:95]
s_add_u32 s63, s65, 40960
s_and_b32 s63, s63, 0xffff
buffer_load_dwordx4 v[212:215], v2, s[40:43], s63 offen offset:0 sc1
buffer_load_dwordx4 v[216:219], v2, s[40:43], s63 offen offset:1024 sc1
s_waitcnt vmcnt(29) lgkmcnt(3)
v_mfma_f32_32x32x16_bf16 v[32:47], v[232:235], v[112:115], v[32:47]
ds_read_b128 v[96:99], v26 offset:16384
ds_read_b128 v[100:103], v26 offset:20480
s_waitcnt lgkmcnt(4)
v_mfma_f32_32x32x16_bf16 v[48:63], v[232:235], v[116:119], v[48:63]
ds_read_b128 v[104:107], v26 offset:24576
ds_read_b128 v[108:111], v26 offset:28672
s_waitcnt lgkmcnt(5)
v_mfma_f32_32x32x16_bf16 v[64:79], v[232:235], v[120:123], v[64:79]
buffer_load_dwordx4 v245, s[52:55], s62 offen offset:1024 lds
s_waitcnt lgkmcnt(4)
v_mfma_f32_32x32x16_bf16 v[80:95], v[232:235], v[124:127], v[80:95]
buffer_load_dwordx4 v[220:223], v2, s[40:43], s63 offen offset:2048 sc1
buffer_load_dwordx4 v[224:227], v2, s[40:43], s63 offen offset:3072 sc1
s_waitcnt vmcnt(31) lgkmcnt(3)
v_mfma_f32_32x32x16_bf16 v[32:47], v[236:239], v[96:99], v[32:47]
ds_read_b128 v[112:115], v27 offset:16384
ds_read_b128 v[116:119], v27 offset:20480
s_waitcnt lgkmcnt(4)
v_mfma_f32_32x32x16_bf16 v[48:63], v[236:239], v[100:103], v[48:63]
ds_read_b128 v[120:123], v27 offset:24576
ds_read_b128 v[124:127], v27 offset:28672
s_waitcnt lgkmcnt(5)
v_mfma_f32_32x32x16_bf16 v[64:79], v[236:239], v[104:107], v[64:79]
buffer_load_dwordx4 v246, s[52:55], s62 offen offset:2048 lds
s_waitcnt lgkmcnt(4)
v_mfma_f32_32x32x16_bf16 v[80:95], v[236:239], v[108:111], v[80:95]
s_add_u32 s63, s65, 45056
s_and_b32 s63, s63, 0xffff
buffer_load_dwordx4 v[228:231], v2, s[40:43], s63 offen offset:0 sc1
buffer_load_dwordx4 v[232:235], v2, s[40:43], s63 offen offset:1024 sc1
ds_read_b128 v[8:11], v12
s_waitcnt vmcnt(33) lgkmcnt(0)
L_ck69:
v_min3_u32 v15, v8, v9, v10
v_min_u32 v15, v15, v11
s_nop 0
v_readfirstlane_b32 s60, v15
s_nop 0
s_cmp_ge_u32 s60, 7
s_cbranch_scc1 L_ckd70
ds_read_b128 v[8:11], v12 offset:0
s_waitcnt lgkmcnt(0)
s_branch L_ck69
L_ckd70:
v_mfma_f32_32x32x16_bf16 v[32:47], v[240:243], v[112:115], v[32:47]
ds_read_b128 v[96:99], v24 offset:32768
ds_read_b128 v[100:103], v24 offset:36864
v_mfma_f32_32x32x16_bf16 v[48:63], v[240:243], v[116:119], v[48:63]
ds_read_b128 v[104:107], v24 offset:40960
ds_read_b128 v[108:111], v24 offset:45056
v_mfma_f32_32x32x16_bf16 v[64:79], v[240:243], v[120:123], v[64:79]
buffer_load_dwordx4 v247, s[52:55], s62 offen offset:3072 lds
v_mfma_f32_32x32x16_bf16 v[80:95], v[240:243], v[124:127], v[80:95]
buffer_load_dwordx4 v[236:239], v2, s[40:43], s63 offen offset:2048 sc1
buffer_load_dwordx4 v[240:243], v2, s[40:43], s63 offen offset:3072 sc1
s_waitcnt vmcnt(34) lgkmcnt(3)
v_mfma_f32_32x32x16_bf16 v[32:47], v[148:151], v[96:99], v[32:47]
ds_read_b128 v[112:115], v25 offset:32768
ds_read_b128 v[116:119], v25 offset:36864
s_waitcnt lgkmcnt(4)
v_mfma_f32_32x32x16_bf16 v[48:63], v[148:151], v[100:103], v[48:63]
ds_read_b128 v[120:123], v25 offset:40960
ds_read_b128 v[124:127], v25 offset:45056
s_waitcnt lgkmcnt(5)
v_mfma_f32_32x32x16_bf16 v[64:79], v[148:151], v[104:107], v[64:79]
s_add_u32 m0, s67, 49152
s_add_u32 s62, s64, 640
s_and_b32 s62, s62, 0x3ff
buffer_load_dwordx4 v244, s[48:51], s62 offen offset:0 lds
s_waitcnt lgkmcnt(4)
v_mfma_f32_32x32x16_bf16 v[80:95], v[148:151], v[108:111], v[80:95]
s_add_u32 s63, s65, 49152
s_and_b32 s63, s63, 0xffff
buffer_load_dwordx4 v[148:151], v2, s[40:43], s63 offen offset:0 sc1
s_waitcnt vmcnt(35) lgkmcnt(3)
v_mfma_f32_32x32x16_bf16 v[32:47], v[152:155], v[112:115], v[32:47]
ds_read_b128 v[96:99], v26 offset:32768
ds_read_b128 v[100:103], v26 offset:36864
s_waitcnt lgkmcnt(4)
v_mfma_f32_32x32x16_bf16 v[48:63], v[152:155], v[116:119], v[48:63]
ds_read_b128 v[104:107], v26 offset:40960
ds_read_b128 v[108:111], v26 offset:45056
s_waitcnt lgkmcnt(5)
v_mfma_f32_32x32x16_bf16 v[64:79], v[152:155], v[120:123], v[64:79]
buffer_load_dwordx4 v245, s[48:51], s62 offen offset:1024 lds
s_waitcnt lgkmcnt(4)
v_mfma_f32_32x32x16_bf16 v[80:95], v[152:155], v[124:127], v[80:95]
buffer_load_dwordx4 v[152:155], v2, s[40:43], s63 offen offset:1024 sc1
s_waitcnt vmcnt(35) lgkmcnt(3)
v_mfma_f32_32x32x16_bf16 v[32:47], v[156:159], v[96:99], v[32:47]
ds_read_b128 v[112:115], v27 offset:32768
ds_read_b128 v[116:119], v27 offset:36864
s_waitcnt lgkmcnt(4)
v_mfma_f32_32x32x16_bf16 v[48:63], v[156:159], v[100:103], v[48:63]
ds_read_b128 v[120:123], v27 offset:40960
ds_read_b128 v[124:127], v27 offset:45056
s_waitcnt lgkmcnt(5)
v_mfma_f32_32x32x16_bf16 v[64:79], v[156:159], v[104:107], v[64:79]
buffer_load_dwordx4 v246, s[48:51], s62 offen offset:2048 lds
s_waitcnt lgkmcnt(4)
v_mfma_f32_32x32x16_bf16 v[80:95], v[156:159], v[108:111], v[80:95]
buffer_load_dwordx4 v[156:159], v2, s[40:43], s63 offen offset:2048 sc1
s_waitcnt vmcnt(36) lgkmcnt(3)
v_mfma_f32_32x32x16_bf16 v[32:47], v[160:163], v[112:115], v[32:47]
ds_read_b128 v[96:99], v20 offset:0
ds_read_b128 v[100:103], v20 offset:4096
s_waitcnt lgkmcnt(4)
v_mfma_f32_32x32x16_bf16 v[48:63], v[160:163], v[116:119], v[48:63]
ds_read_b128 v[104:107], v20 offset:8192
ds_read_b128 v[108:111], v20 offset:12288
s_waitcnt lgkmcnt(5)
v_mfma_f32_32x32x16_bf16 v[64:79], v[160:163], v[120:123], v[64:79]
buffer_load_dwordx4 v247, s[48:51], s62 offen offset:3072 lds
s_waitcnt lgkmcnt(4)
v_mfma_f32_32x32x16_bf16 v[80:95], v[160:163], v[124:127], v[80:95]
buffer_load_dwordx4 v[160:163], v2, s[40:43], s63 offen offset:3072 sc1
s_waitcnt vmcnt(10) lgkmcnt(3)
v_mov_b32 v14, 8
s_mov_b64 exec, 1
ds_write_b32 v13, v14
s_mov_b64 exec, -1
v_mfma_f32_32x32x16_bf16 v[32:47], v[164:167], v[96:99], v[32:47]
ds_read_b128 v[112:115], v21 offset:0
ds_read_b128 v[116:119], v21 offset:4096
s_waitcnt lgkmcnt(5)
v_mfma_f32_32x32x16_bf16 v[48:63], v[164:167], v[100:103], v[48:63]
ds_read_b128 v[120:123], v21 offset:8192
ds_read_b128 v[124:127], v21 offset:12288
s_waitcnt lgkmcnt(6)
v_mfma_f32_32x32x16_bf16 v[64:79], v[164:167], v[104:107], v[64:79]
s_add_u32 m0, s67, 65536
s_nop 0
buffer_load_dwordx4 v244, s[52:55], s62 offen offset:0 lds
s_waitcnt lgkmcnt(5)
v_mfma_f32_32x32x16_bf16 v[80:95], v[164:167], v[108:111], v[80:95]
s_add_u32 s63, s65, 53248
s_and_b32 s63, s63, 0xffff
buffer_load_dwordx4 v[164:167], v2, s[40:43], s63 offen offset:0 sc1
s_waitcnt vmcnt(37) lgkmcnt(3)
v_mfma_f32_32x32x16_bf16 v[32:47], v[168:171], v[112:115], v[32:47]
ds_read_b128 v[96:99], v22 offset:0
ds_read_b128 v[100:103], v22 offset:4096
s_waitcnt lgkmcnt(4)
v_mfma_f32_32x32x16_bf16 v[48:63], v[168:171], v[116:119], v[48:63]
ds_read_b128 v[104:107], v22 offset:8192
ds_read_b128 v[108:111], v22 offset:12288
s_waitcnt lgkmcnt(5)
v_mfma_f32_32x32x16_bf16 v[64:79], v[168:171], v[120:123], v[64:79]
buffer_load_dwordx4 v245, s[52:55], s62 offen offset:1024 lds
s_waitcnt lgkmcnt(4)
v_mfma_f32_32x32x16_bf16 v[80:95], v[168:171], v[124:127], v[80:95]
buffer_load_dwordx4 v[168:171], v2, s[40:43], s63 offen offset:1024 sc1
s_waitcnt vmcnt(37) lgkmcnt(3)
v_mfma_f32_32x32x16_bf16 v[32:47], v[172:175], v[96:99], v[32:47]
ds_read_b128 v[112:115], v23 offset:0
ds_read_b128 v[116:119], v23 offset:4096
s_waitcnt lgkmcnt(4)
v_mfma_f32_32x32x16_bf16 v[48:63], v[172:175], v[100:103], v[48:63]
ds_read_b128 v[120:123], v23 offset:8192
ds_read_b128 v[124:127], v23 offset:12288
s_waitcnt lgkmcnt(5)
v_mfma_f32_32x32x16_bf16 v[64:79], v[172:175], v[104:107], v[64:79]
buffer_load_dwordx4 v246, s[52:55], s62 offen offset:2048 lds
s_waitcnt lgkmcnt(4)
v_mfma_f32_32x32x16_bf16 v[80:95], v[172:175], v[108:111], v[80:95]
buffer_load_dwordx4 v[172:175], v2, s[40:43], s63 offen offset:2048 sc1
ds_read_b128 v[8:11], v12
s_waitcnt vmcnt(38) lgkmcnt(0)
L_ck71:
v_min3_u32 v15, v8, v9, v10
v_min_u32 v15, v15, v11
s_nop 0
v_readfirstlane_b32 s60, v15
s_nop 0
s_cmp_ge_u32 s60, 8
s_cbranch_scc1 L_ckd72
ds_read_b128 v[8:11], v12 offset:0
s_waitcnt lgkmcnt(0)
s_branch L_ck71
L_ckd72:
v_mfma_f32_32x32x16_bf16 v[32:47], v[176:179], v[112:115], v[32:47]
ds_read_b128 v[96:99], v20 offset:16384
ds_read_b128 v[100:103], v20 offset:20480
v_mfma_f32_32x32x16_bf16 v[48:63], v[176:179], v[116:119], v[48:63]
ds_read_b128 v[104:107], v20 offset:24576
ds_read_b128 v[108:111], v20 offset:28672
v_mfma_f32_32x32x16_bf16 v[64:79], v[176:179], v[120:123], v[64:79]
buffer_load_dwordx4 v247, s[52:55], s62 offen offset:3072 lds
v_mfma_f32_32x32x16_bf16 v[80:95], v[176:179], v[124:127], v[80:95]
buffer_load_dwordx4 v[176:179], v2, s[40:43], s63 offen offset:3072 sc1
s_waitcnt vmcnt(38) lgkmcnt(3)
v_mfma_f32_32x32x16_bf16 v[32:47], v[180:183], v[96:99], v[32:47]
ds_read_b128 v[112:115], v21 offset:16384
ds_read_b128 v[116:119], v21 offset:20480
s_waitcnt lgkmcnt(4)
v_mfma_f32_32x32x16_bf16 v[48:63], v[180:183], v[100:103], v[48:63]
ds_read_b128 v[120:123], v21 offset:24576
ds_read_b128 v[124:127], v21 offset:28672
s_waitcnt lgkmcnt(5)
v_mfma_f32_32x32x16_bf16 v[64:79], v[180:183], v[104:107], v[64:79]
s_add_u32 m0, s67, 81920
s_add_u32 s62, s64, 768
s_and_b32 s62, s62, 0x3ff
buffer_load_dwordx4 v244, s[48:51], s62 offen offset:0 lds
s_waitcnt lgkmcnt(4)
v_mfma_f32_32x32x16_bf16 v[80:95], v[180:183], v[108:111], v[80:95]
s_add_u32 s63, s65, 57344
s_and_b32 s63, s63, 0xffff
buffer_load_dwordx4 v[180:183], v2, s[40:43], s63 offen offset:0 sc1
s_waitcnt vmcnt(39) lgkmcnt(3)
v_mfma_f32_32x32x16_bf16 v[32:47], v[184:187], v[112:115], v[32:47]
ds_read_b128 v[96:99], v22 offset:16384
ds_read_b128 v[100:103], v22 offset:20480
s_waitcnt lgkmcnt(4)
v_mfma_f32_32x32x16_bf16 v[48:63], v[184:187], v[116:119], v[48:63]
ds_read_b128 v[104:107], v22 offset:24576
ds_read_b128 v[108:111], v22 offset:28672
s_waitcnt lgkmcnt(5)
v_mfma_f32_32x32x16_bf16 v[64:79], v[184:187], v[120:123], v[64:79]
buffer_load_dwordx4 v245, s[48:51], s62 offen offset:1024 lds
s_waitcnt lgkmcnt(4)
v_mfma_f32_32x32x16_bf16 v[80:95], v[184:187], v[124:127], v[80:95]
buffer_load_dwordx4 v[184:187], v2, s[40:43], s63 offen offset:1024 sc1
s_waitcnt vmcnt(39) lgkmcnt(3)
v_mfma_f32_32x32x16_bf16 v[32:47], v[188:191], v[96:99], v[32:47]
ds_read_b128 v[112:115], v23 offset:16384
ds_read_b128 v[116:119], v23 offset:20480
s_waitcnt lgkmcnt(4)
v_mfma_f32_32x32x16_bf16 v[48:63], v[188:191], v[100:103], v[48:63]
ds_read_b128 v[120:123], v23 offset:24576
ds_read_b128 v[124:127], v23 offset:28672
s_waitcnt lgkmcnt(5)
v_mfma_f32_32x32x16_bf16 v[64:79], v[188:191], v[104:107], v[64:79]
buffer_load_dwordx4 v246, s[48:51], s62 offen offset:2048 lds
s_waitcnt lgkmcnt(4)
v_mfma_f32_32x32x16_bf16 v[80:95], v[188:191], v[108:111], v[80:95]
buffer_load_dwordx4 v[188:191], v2, s[40:43], s63 offen offset:2048 sc1
s_waitcnt vmcnt(40) lgkmcnt(3)
v_mfma_f32_32x32x16_bf16 v[32:47], v[192:195], v[112:115], v[32:47]
ds_read_b128 v[96:99], v20 offset:32768
ds_read_b128 v[100:103], v20 offset:36864
s_waitcnt lgkmcnt(4)
v_mfma_f32_32x32x16_bf16 v[48:63], v[192:195], v[116:119], v[48:63]
ds_read_b128 v[104:107], v20 offset:40960
ds_read_b128 v[108:111], v20 offset:45056
s_waitcnt lgkmcnt(5)
v_mfma_f32_32x32x16_bf16 v[64:79], v[192:195], v[120:123], v[64:79]
buffer_load_dwordx4 v247, s[48:51], s62 offen offset:3072 lds
s_waitcnt lgkmcnt(4)
v_mfma_f32_32x32x16_bf16 v[80:95], v[192:195], v[124:127], v[80:95]
buffer_load_dwordx4 v[192:195], v2, s[40:43], s63 offen offset:3072 sc1
s_waitcnt vmcnt(9) lgkmcnt(3)
v_mov_b32 v14, 9
s_mov_b64 exec, 1
ds_write_b32 v13, v14
s_mov_b64 exec, -1
v_mfma_f32_32x32x16_bf16 v[32:47], v[196:199], v[96:99], v[32:47]
ds_read_b128 v[112:115], v21 offset:32768
ds_read_b128 v[116:119], v21 offset:36864
s_waitcnt lgkmcnt(5)
v_mfma_f32_32x32x16_bf16 v[48:63], v[196:199], v[100:103], v[48:63]
ds_read_b128 v[120:123], v21 offset:40960
ds_read_b128 v[124:127], v21 offset:45056
s_waitcnt lgkmcnt(6)
v_mfma_f32_32x32x16_bf16 v[64:79], v[196:199], v[104:107], v[64:79]
s_add_u32 m0, s67, 98304
s_nop 0
buffer_load_dwordx4 v244, s[52:55], s62 offen offset:0 lds
s_waitcnt lgkmcnt(5)
v_mfma_f32_32x32x16_bf16 v[80:95], v[196:199], v[108:111], v[80:95]
s_add_u32 s63, s65, 61440
s_and_b32 s63, s63, 0xffff
buffer_load_dwordx4 v[196:199], v2, s[40:43], s63 offen offset:0 sc1
s_waitcnt vmcnt(41) lgkmcnt(3)
v_mfma_f32_32x32x16_bf16 v[32:47], v[200:203], v[112:115], v[32:47]
ds_read_b128 v[96:99], v22 offset:32768
ds_read_b128 v[100:103], v22 offset:36864
s_waitcnt lgkmcnt(4)
v_mfma_f32_32x32x16_bf16 v[48:63], v[200:203], v[116:119], v[48:63]
ds_read_b128 v[104:107], v22 offset:40960
ds_read_b128 v[108:111], v22 offset:45056
s_waitcnt lgkmcnt(5)
v_mfma_f32_32x32x16_bf16 v[64:79], v[200:203], v[120:123], v[64:79]
buffer_load_dwordx4 v245, s[52:55], s62 offen offset:1024 lds
s_waitcnt lgkmcnt(4)
v_mfma_f32_32x32x16_bf16 v[80:95], v[200:203], v[124:127], v[80:95]
buffer_load_dwordx4 v[200:203], v2, s[40:43], s63 offen offset:1024 sc1
s_waitcnt vmcnt(41) lgkmcnt(3)
v_mfma_f32_32x32x16_bf16 v[32:47], v[204:207], v[96:99], v[32:47]
ds_read_b128 v[112:115], v23 offset:32768
ds_read_b128 v[116:119], v23 offset:36864
s_waitcnt lgkmcnt(4)
v_mfma_f32_32x32x16_bf16 v[48:63], v[204:207], v[100:103], v[48:63]
ds_read_b128 v[120:123], v23 offset:40960
ds_read_b128 v[124:127], v23 offset:45056
s_waitcnt lgkmcnt(5)
v_mfma_f32_32x32x16_bf16 v[64:79], v[204:207], v[104:107], v[64:79]
buffer_load_dwordx4 v246, s[52:55], s62 offen offset:2048 lds
s_waitcnt lgkmcnt(4)
v_mfma_f32_32x32x16_bf16 v[80:95], v[204:207], v[108:111], v[80:95]
buffer_load_dwordx4 v[204:207], v2, s[40:43], s63 offen offset:2048 sc1
ds_read_b128 v[8:11], v12
s_waitcnt vmcnt(42) lgkmcnt(0)
L_ck73:
v_min3_u32 v15, v8, v9, v10
v_min_u32 v15, v15, v11
s_nop 0
v_readfirstlane_b32 s60, v15
s_nop 0
s_cmp_ge_u32 s60, 9
s_cbranch_scc1 L_ckd74
ds_read_b128 v[8:11], v12 offset:0
s_waitcnt lgkmcnt(0)
s_branch L_ck73
L_ckd74:
v_mfma_f32_32x32x16_bf16 v[32:47], v[208:211], v[112:115], v[32:47]
ds_read_b128 v[96:99], v20 offset:49152
ds_read_b128 v[100:103], v20 offset:53248
v_mfma_f32_32x32x16_bf16 v[48:63], v[208:211], v[116:119], v[48:63]
ds_read_b128 v[104:107], v20 offset:57344
ds_read_b128 v[108:111], v20 offset:61440
v_mfma_f32_32x32x16_bf16 v[64:79], v[208:211], v[120:123], v[64:79]
buffer_load_dwordx4 v247, s[52:55], s62 offen offset:3072 lds
v_mfma_f32_32x32x16_bf16 v[80:95], v[208:211], v[124:127], v[80:95]
buffer_load_dwordx4 v[208:211], v2, s[40:43], s63 offen offset:3072 sc1
s_waitcnt vmcnt(42) lgkmcnt(3)
v_mfma_f32_32x32x16_bf16 v[32:47], v[212:215], v[96:99], v[32:47]
ds_read_b128 v[112:115], v21 offset:49152
ds_read_b128 v[116:119], v21 offset:53248
s_waitcnt lgkmcnt(4)
v_mfma_f32_32x32x16_bf16 v[48:63], v[212:215], v[100:103], v[48:63]
ds_read_b128 v[120:123], v21 offset:57344
ds_read_b128 v[124:127], v21 offset:61440
s_waitcnt lgkmcnt(5)
v_mfma_f32_32x32x16_bf16 v[64:79], v[212:215], v[104:107], v[64:79]
s_add_u32 m0, s67, 0
s_add_u32 s62, s64, 896
s_and_b32 s62, s62, 0x3ff
buffer_load_dwordx4 v244, s[48:51], s62 offen offset:0 lds
s_waitcnt lgkmcnt(4)
v_mfma_f32_32x32x16_bf16 v[80:95], v[212:215], v[108:111], v[80:95]
s_waitcnt vmcnt(42) lgkmcnt(3)
v_mfma_f32_32x32x16_bf16 v[32:47], v[216:219], v[112:115], v[32:47]
ds_read_b128 v[96:99], v22 offset:49152
ds_read_b128 v[100:103], v22 offset:53248
s_waitcnt lgkmcnt(4)
v_mfma_f32_32x32x16_bf16 v[48:63], v[216:219], v[116:119], v[48:63]
ds_read_b128 v[104:107], v22 offset:57344
ds_read_b128 v[108:111], v22 offset:61440
s_waitcnt lgkmcnt(5)
v_mfma_f32_32x32x16_bf16 v[64:79], v[216:219], v[120:123], v[64:79]
buffer_load_dwordx4 v245, s[48:51], s62 offen offset:1024 lds
s_waitcnt lgkmcnt(4)
v_mfma_f32_32x32x16_bf16 v[80:95], v[216:219], v[124:127], v[80:95]
s_waitcnt vmcnt(41) lgkmcnt(3)
v_mfma_f32_32x32x16_bf16 v[32:47], v[220:223], v[96:99], v[32:47]
ds_read_b128 v[112:115], v23 offset:49152
ds_read_b128 v[116:119], v23 offset:53248
s_waitcnt lgkmcnt(4)
v_mfma_f32_32x32x16_bf16 v[48:63], v[220:223], v[100:103], v[48:63]
ds_read_b128 v[120:123], v23 offset:57344
ds_read_b128 v[124:127], v23 offset:61440
s_waitcnt lgkmcnt(5)
v_mfma_f32_32x32x16_bf16 v[64:79], v[220:223], v[104:107], v[64:79]
buffer_load_dwordx4 v246, s[48:51], s62 offen offset:2048 lds
s_waitcnt lgkmcnt(4)
v_mfma_f32_32x32x16_bf16 v[80:95], v[220:223], v[108:111], v[80:95]
s_waitcnt vmcnt(41) lgkmcnt(3)
v_mfma_f32_32x32x16_bf16 v[32:47], v[224:227], v[112:115], v[32:47]
ds_read_b128 v[96:99], v24 offset:0
ds_read_b128 v[100:103], v24 offset:4096
s_waitcnt lgkmcnt(4)
v_mfma_f32_32x32x16_bf16 v[48:63], v[224:227], v[116:119], v[48:63]
ds_read_b128 v[104:107], v24 offset:8192
ds_read_b128 v[108:111], v24 offset:12288
s_waitcnt lgkmcnt(5)
v_mfma_f32_32x32x16_bf16 v[64:79], v[224:227], v[120:123], v[64:79]
buffer_load_dwordx4 v247, s[48:51], s62 offen offset:3072 lds
s_waitcnt lgkmcnt(4)
v_mfma_f32_32x32x16_bf16 v[80:95], v[224:227], v[124:127], v[80:95]
s_waitcnt vmcnt(5) lgkmcnt(3)
v_mov_b32 v14, 10
s_mov_b64 exec, 1
ds_write_b32 v13, v14
s_mov_b64 exec, -1
v_mfma_f32_32x32x16_bf16 v[32:47], v[228:231], v[96:99], v[32:47]
ds_read_b128 v[112:115], v25 offset:0
ds_read_b128 v[116:119], v25 offset:4096
s_waitcnt lgkmcnt(5)
v_mfma_f32_32x32x16_bf16 v[48:63], v[228:231], v[100:103], v[48:63]
ds_read_b128 v[120:123], v25 offset:8192
ds_read_b128 v[124:127], v25 offset:12288
s_waitcnt lgkmcnt(6)
v_mfma_f32_32x32x16_bf16 v[64:79], v[228:231], v[104:107], v[64:79]
s_add_u32 m0, s67, 16384
s_nop 0
buffer_load_dwordx4 v244, s[52:55], s62 offen offset:0 lds
s_waitcnt lgkmcnt(5)
v_mfma_f32_32x32x16_bf16 v[80:95], v[228:231], v[108:111], v[80:95]
s_waitcnt vmcnt(40) lgkmcnt(3)
v_mfma_f32_32x32x16_bf16 v[32:47], v[232:235], v[112:115], v[32:47]
ds_read_b128 v[96:99], v26 offset:0
ds_read_b128 v[100:103], v26 offset:4096
s_waitcnt lgkmcnt(4)
v_mfma_f32_32x32x16_bf16 v[48:63], v[232:235], v[116:119], v[48:63]
ds_read_b128 v[104:107], v26 offset:8192
ds_read_b128 v[108:111], v26 offset:12288
s_waitcnt lgkmcnt(5)
v_mfma_f32_32x32x16_bf16 v[64:79], v[232:235], v[120:123], v[64:79]
buffer_load_dwordx4 v245, s[52:55], s62 offen offset:1024 lds
s_waitcnt lgkmcnt(4)
v_mfma_f32_32x32x16_bf16 v[80:95], v[232:235], v[124:127], v[80:95]
s_waitcnt vmcnt(39) lgkmcnt(3)
v_mfma_f32_32x32x16_bf16 v[32:47], v[236:239], v[96:99], v[32:47]
ds_read_b128 v[112:115], v27 offset:0
ds_read_b128 v[116:119], v27 offset:4096
s_waitcnt lgkmcnt(4)
v_mfma_f32_32x32x16_bf16 v[48:63], v[236:239], v[100:103], v[48:63]
ds_read_b128 v[120:123], v27 offset:8192
ds_read_b128 v[124:127], v27 offset:12288
s_waitcnt lgkmcnt(5)
v_mfma_f32_32x32x16_bf16 v[64:79], v[236:239], v[104:107], v[64:79]
buffer_load_dwordx4 v246, s[52:55], s62 offen offset:2048 lds
s_waitcnt lgkmcnt(4)
v_mfma_f32_32x32x16_bf16 v[80:95], v[236:239], v[108:111], v[80:95]
ds_read_b128 v[8:11], v12
global_load_dword v31, v30, s[26:27]
s_waitcnt vmcnt(40) lgkmcnt(0)
L_ck75:
v_min3_u32 v15, v8, v9, v10
v_min_u32 v15, v15, v11
s_nop 0
v_readfirstlane_b32 s60, v15
s_nop 0
s_cmp_ge_u32 s60, 10
s_cbranch_scc1 L_ckd76
ds_read_b128 v[8:11], v12 offset:0
s_waitcnt lgkmcnt(0)
s_branch L_ck75
L_ckd76:
v_mfma_f32_32x32x16_bf16 v[32:47], v[240:243], v[112:115], v[32:47]
ds_read_b128 v[96:99], v24 offset:16384
ds_read_b128 v[100:103], v24 offset:20480
v_mfma_f32_32x32x16_bf16 v[48:63], v[240:243], v[116:119], v[48:63]
ds_read_b128 v[104:107], v24 offset:24576
ds_read_b128 v[108:111], v24 offset:28672
v_mfma_f32_32x32x16_bf16 v[64:79], v[240:243], v[120:123], v[64:79]
buffer_load_dwordx4 v247, s[52:55], s62 offen offset:3072 lds
v_mfma_f32_32x32x16_bf16 v[80:95], v[240:243], v[124:127], v[80:95]
s_mov_b32 s60, 0
buffer_load_dword v128, v28, s[56:59], s60 offen offset:0
s_waitcnt vmcnt(40) lgkmcnt(3)
v_mfma_f32_32x32x16_bf16 v[32:47], v[148:151], v[96:99], v[32:47]
ds_read_b128 v[112:115], v25 offset:16384
ds_read_b128 v[116:119], v25 offset:20480
s_waitcnt lgkmcnt(4)
v_mfma_f32_32x32x16_bf16 v[48:63], v[148:151], v[100:103], v[48:63]
ds_read_b128 v[120:123], v25 offset:24576
ds_read_b128 v[124:127], v25 offset:28672
s_waitcnt lgkmcnt(5)
v_mfma_f32_32x32x16_bf16 v[64:79], v[148:151], v[104:107], v[64:79]
s_waitcnt lgkmcnt(4)
v_mfma_f32_32x32x16_bf16 v[80:95], v[148:151], v[108:111], v[80:95]
s_mov_b32 s60, 0
buffer_load_dword v129, v28, s[56:59], s60 offen offset:2048
s_waitcnt vmcnt(39) lgkmcnt(3)
v_mfma_f32_32x32x16_bf16 v[32:47], v[152:155], v[112:115], v[32:47]
ds_read_b128 v[96:99], v26 offset:16384
ds_read_b128 v[100:103], v26 offset:20480
s_waitcnt lgkmcnt(4)
v_mfma_f32_32x32x16_bf16 v[48:63], v[152:155], v[116:119], v[48:63]
ds_read_b128 v[104:107], v26 offset:24576
ds_read_b128 v[108:111], v26 offset:28672
s_waitcnt lgkmcnt(5)
v_mfma_f32_32x32x16_bf16 v[64:79], v[152:155], v[120:123], v[64:79]
s_waitcnt lgkmcnt(4)
v_mfma_f32_32x32x16_bf16 v[80:95], v[152:155], v[124:127], v[80:95]
s_mov_b32 s60, 4096
buffer_load_dword v130, v28, s[56:59], s60 offen offset:0
s_waitcnt vmcnt(38) lgkmcnt(3)
v_mfma_f32_32x32x16_bf16 v[32:47], v[156:159], v[96:99], v[32:47]
ds_read_b128 v[112:115], v27 offset:16384
ds_read_b128 v[116:119], v27 offset:20480
s_waitcnt lgkmcnt(4)
v_mfma_f32_32x32x16_bf16 v[48:63], v[156:159], v[100:103], v[48:63]
ds_read_b128 v[120:123], v27 offset:24576
ds_read_b128 v[124:127], v27 offset:28672
s_waitcnt lgkmcnt(5)
v_mfma_f32_32x32x16_bf16 v[64:79], v[156:159], v[104:107], v[64:79]
s_waitcnt lgkmcnt(4)
v_mfma_f32_32x32x16_bf16 v[80:95], v[156:159], v[108:111], v[80:95]
s_mov_b32 s60, 4096
buffer_load_dword v131, v28, s[56:59], s60 offen offset:2048
s_waitcnt vmcnt(37) lgkmcnt(3)
v_mfma_f32_32x32x16_bf16 v[32:47], v[160:163], v[112:115], v[32:47]
ds_read_b128 v[96:99], v24 offset:32768
ds_read_b128 v[100:103], v24 offset:36864
s_waitcnt lgkmcnt(4)
v_mfma_f32_32x32x16_bf16 v[48:63], v[160:163], v[116:119], v[48:63]
s_waitcnt lgkmcnt(3)
v_mfma_f32_32x32x16_bf16 v[64:79], v[160:163], v[120:123], v[64:79]
s_waitcnt lgkmcnt(2)
v_mfma_f32_32x32x16_bf16 v[80:95], v[160:163], v[124:127], v[80:95]
s_mov_b32 s60, 65536
buffer_load_dword v132, v28, s[56:59], s60 offen offset:0
s_waitcnt vmcnt(5) lgkmcnt(1)
v_mov_b32 v14, 11
s_mov_b64 exec, 1
ds_write_b32 v13, v14
s_mov_b64 exec, -1
v_mfma_f32_32x32x16_bf16 v[32:47], v[164:167], v[96:99], v[32:47]
ds_read_b128 v[112:115], v25 offset:32768
ds_read_b128 v[116:119], v25 offset:36864
s_waitcnt lgkmcnt(3)
v_mfma_f32_32x32x16_bf16 v[48:63], v[164:167], v[100:103], v[48:63]
s_mov_b32 s60, 65536
buffer_load_dword v133, v28, s[56:59], s60 offen offset:2048
s_waitcnt vmcnt(35) lgkmcnt(1)
v_mfma_f32_32x32x16_bf16 v[32:47], v[168:171], v[112:115], v[32:47]
ds_read_b128 v[96:99], v26 offset:32768
ds_read_b128 v[100:103], v26 offset:36864
s_waitcnt lgkmcnt(2)
v_mfma_f32_32x32x16_bf16 v[48:63], v[168:171], v[116:119], v[48:63]
s_mov_b32 s60, 69632
buffer_load_dword v134, v28, s[56:59], s60 offen offset:0
s_waitcnt vmcnt(34) lgkmcnt(1)
v_mfma_f32_32x32x16_bf16 v[32:47], v[172:175], v[96:99], v[32:47]
ds_read_b128 v[112:115], v27 offset:32768
ds_read_b128 v[116:119], v27 offset:36864
s_waitcnt lgkmcnt(2)
v_mfma_f32_32x32x16_bf16 v[48:63], v[172:175], v[100:103], v[48:63]
ds_read_b128 v[8:11], v12
s_mov_b32 s60, 69632
buffer_load_dword v135, v28, s[56:59], s60 offen offset:2048
s_waitcnt vmcnt(33) lgkmcnt(0)
L_ck77:
v_min3_u32 v15, v8, v9, v10
v_min_u32 v15, v15, v11
s_nop 0
v_readfirstlane_b32 s60, v15
s_nop 0
s_cmp_ge_u32 s60, 11
s_cbranch_scc1 L_ckd78
ds_read_b128 v[8:11], v12 offset:0
s_waitcnt lgkmcnt(0)
s_branch L_ck77
L_ckd78:
v_mfma_f32_32x32x16_bf16 v[32:47], v[176:179], v[112:115], v[32:47]
ds_read_b128 v[96:99], v20 offset:0
ds_read_b128 v[100:103], v20 offset:4096
v_mfma_f32_32x32x16_bf16 v[48:63], v[176:179], v[116:119], v[48:63]
s_mov_b32 s60, 8192
buffer_load_dword v136, v28, s[56:59], s60 offen offset:0
s_waitcnt vmcnt(32) lgkmcnt(1)
v_mfma_f32_32x32x16_bf16 v[32:47], v[180:183], v[96:99], v[32:47]
ds_read_b128 v[112:115], v21 offset:0
ds_read_b128 v[116:119], v21 offset:4096
s_waitcnt lgkmcnt(2)
v_mfma_f32_32x32x16_bf16 v[48:63], v[180:183], v[100:103], v[48:63]
s_mov_b32 s60, 8192
buffer_load_dword v137, v28, s[56:59], s60 offen offset:2048
s_waitcnt vmcnt(31) lgkmcnt(1)
v_mfma_f32_32x32x16_bf16 v[32:47], v[184:187], v[112:115], v[32:47]
ds_read_b128 v[96:99], v22 offset:0
ds_read_b128 v[100:103], v22 offset:4096
s_waitcnt lgkmcnt(2)
v_mfma_f32_32x32x16_bf16 v[48:63], v[184:187], v[116:119], v[48:63]
s_mov_b32 s60, 12288
buffer_load_dword v138, v28, s[56:59], s60 offen offset:0
s_waitcnt vmcnt(30) lgkmcnt(1)
v_mfma_f32_32x32x16_bf16 v[32:47], v[188:191], v[96:99], v[32:47]
ds_read_b128 v[112:115], v23 offset:0
ds_read_b128 v[116:119], v23 offset:4096
s_waitcnt lgkmcnt(2)
v_mfma_f32_32x32x16_bf16 v[48:63], v[188:191], v[100:103], v[48:63]
s_mov_b32 s60, 12288
buffer_load_dword v139, v28, s[56:59], s60 offen offset:2048
s_waitcnt vmcnt(29) lgkmcnt(1)
v_mfma_f32_32x32x16_bf16 v[32:47], v[192:195], v[112:115], v[32:47]
ds_read_b128 v[96:99], v20 offset:16384
ds_read_b128 v[100:103], v20 offset:20480
s_waitcnt lgkmcnt(2)
v_mfma_f32_32x32x16_bf16 v[48:63], v[192:195], v[116:119], v[48:63]
s_mov_b32 s60, 73728
buffer_load_dword v140, v28, s[56:59], s60 offen offset:0
s_waitcnt vmcnt(28) lgkmcnt(1)
v_mfma_f32_32x32x16_bf16 v[32:47], v[196:199], v[96:99], v[32:47]
ds_read_b128 v[112:115], v21 offset:16384
ds_read_b128 v[116:119], v21 offset:20480
s_waitcnt lgkmcnt(2)
v_mfma_f32_32x32x16_bf16 v[48:63], v[196:199], v[100:103], v[48:63]
s_mov_b32 s60, 73728
buffer_load_dword v141, v28, s[56:59], s60 offen offset:2048
s_waitcnt vmcnt(27) lgkmcnt(1)
v_mfma_f32_32x32x16_bf16 v[32:47], v[200:203], v[112:115], v[32:47]
ds_read_b128 v[96:99], v22 offset:16384
ds_read_b128 v[100:103], v22 offset:20480
s_waitcnt lgkmcnt(2)
v_mfma_f32_32x32x16_bf16 v[48:63], v[200:203], v[116:119], v[48:63]
s_mov_b32 s60, 77824
buffer_load_dword v142, v28, s[56:59], s60 offen offset:0
s_waitcnt vmcnt(26) lgkmcnt(1)
v_mfma_f32_32x32x16_bf16 v[32:47], v[204:207], v[96:99], v[32:47]
ds_read_b128 v[112:115], v23 offset:16384
ds_read_b128 v[116:119], v23 offset:20480
s_waitcnt lgkmcnt(2)
v_mfma_f32_32x32x16_bf16 v[48:63], v[204:207], v[100:103], v[48:63]
s_mov_b32 s60, 77824
buffer_load_dword v143, v28, s[56:59], s60 offen offset:2048
s_waitcnt vmcnt(25) lgkmcnt(0)
v_mfma_f32_32x32x16_bf16 v[32:47], v[208:211], v[112:115], v[32:47]
v_mfma_f32_32x32x16_bf16 v[48:63], v[208:211], v[116:119], v[48:63]
s_mul_i32 s60, s37, 0x9e3779b1
s_and_b32 s60, s60, 0xbfff0000
s_or_b32 s60, s60, 0x20000000
s_sub_u32 s61, s37, 1
s_xor_b32 s61, s61, s60
s_cmp_lt_u32 s61, 0x10000
s_cselect_b32 s61, 0x10000, 0
s_xor_b32 s60, s60, s61
s_lshl_b32 s64, s35, 4
s_add_u32 s64, s64, s36
s_lshl_b32 s64, s64, 2
s_add_u32 s64, s64, s34
s_lshl_b32 s64, s64, 13
s_add_u32 s50, s64, 33554432
s_add_u32 s48, s32, s50
s_addc_u32 s49, s33, 0
s_mov_b32 s50, 8192
s_mov_b32 s51, 0x20000
s_xor_b32 s64, s64, 262144
s_add_u32 s54, s64, 33554432
s_add_u32 s52, s32, s54
s_addc_u32 s53, s33, 0
s_mov_b32 s54, 8192
s_mov_b32 s55, 0x20000
s_movk_i32 s64, 0x1000
v_cvt_pk_bf16_f32 v96, v32, v48
v_cvt_pk_bf16_f32 v97, v33, v49
v_cvt_pk_bf16_f32 v98, v34, v50
v_cvt_pk_bf16_f32 v99, v35, s60
buffer_store_dwordx4 v[96:99], v2, s[48:51], 0 offen offset:0 sc1
v_cvt_pk_bf16_f32 v100, v51, v36
v_cvt_pk_bf16_f32 v101, v52, v37
v_cvt_pk_bf16_f32 v102, v53, v38
v_cvt_pk_bf16_f32 v103, v54, s60
buffer_store_dwordx4 v[100:103], v2, s[48:51], 0 offen offset:1024 sc1
v_cvt_pk_bf16_f32 v244, v39, v55
v_cvt_pk_bf16_f32 v245, v40, v56
v_cvt_pk_bf16_f32 v246, v41, v57
v_cvt_pk_bf16_f32 v247, v42, s60
buffer_store_dwordx4 v[244:247], v2, s[48:51], 0 offen offset:2048 sc1
v_cvt_pk_bf16_f32 v248, v58, v43
v_cvt_pk_bf16_f32 v249, v59, v44
v_cvt_pk_bf16_f32 v250, v60, v45
v_cvt_pk_bf16_f32 v251, v61, s60
buffer_store_dwordx4 v[248:251], v2, s[48:51], 0 offen offset:3072 sc1
v_cvt_pk_bf16_f32 v252, v46, v62
v_cvt_pk_bf16_f32 v253, v47, v63
v_cvt_pk_bf16_f32 v254, v63, v63
v_cvt_pk_bf16_f32 v255, v63, s60
buffer_store_dwordx4 v[252:255], v2, s[48:51], s64 offen offset:0 sc1
ds_read_b128 v[104:107], v24 offset:40960
ds_read_b128 v[108:111], v24 offset:45056
ds_read_b128 v[120:123], v25 offset:40960
ds_read_b128 v[124:127], v25 offset:45056
s_waitcnt lgkmcnt(2)
v_mfma_f32_32x32x16_bf16 v[64:79], v[164:167], v[104:107], v[64:79]
v_mfma_f32_32x32x16_bf16 v[80:95], v[164:167], v[108:111], v[80:95]
ds_read_b128 v[104:107], v26 offset:40960
ds_read_b128 v[108:111], v26 offset:45056
s_waitcnt lgkmcnt(2)
v_mfma_f32_32x32x16_bf16 v[64:79], v[168:171], v[120:123], v[64:79]
v_mfma_f32_32x32x16_bf16 v[80:95], v[168:171], v[124:127], v[80:95]
ds_read_b128 v[120:123], v27 offset:40960
ds_read_b128 v[124:127], v27 offset:45056
s_waitcnt lgkmcnt(2)
v_mfma_f32_32x32x16_bf16 v[64:79], v[172:175], v[104:107], v[64:79]
v_mfma_f32_32x32x16_bf16 v[80:95], v[172:175], v[108:111], v[80:95]
ds_read_b128 v[104:107], v20 offset:8192
ds_read_b128 v[108:111], v20 offset:12288
s_waitcnt lgkmcnt(2)
v_mfma_f32_32x32x16_bf16 v[64:79], v[176:179], v[120:123], v[64:79]
v_mfma_f32_32x32x16_bf16 v[80:95], v[176:179], v[124:127], v[80:95]
ds_read_b128 v[120:123], v21 offset:8192
ds_read_b128 v[124:127], v21 offset:12288
s_waitcnt lgkmcnt(2)
v_mfma_f32_32x32x16_bf16 v[64:79], v[180:183], v[104:107], v[64:79]
v_mfma_f32_32x32x16_bf16 v[80:95], v[180:183], v[108:111], v[80:95]
ds_read_b128 v[104:107], v22 offset:8192
ds_read_b128 v[108:111], v22 offset:12288
s_waitcnt lgkmcnt(2)
v_mfma_f32_32x32x16_bf16 v[64:79], v[184:187], v[120:123], v[64:79]
v_mfma_f32_32x32x16_bf16 v[80:95], v[184:187], v[124:127], v[80:95]
ds_read_b128 v[120:123], v23 offset:8192
ds_read_b128 v[124:127], v23 offset:12288
s_waitcnt lgkmcnt(2)
v_mfma_f32_32x32x16_bf16 v[64:79], v[188:191], v[104:107], v[64:79]
v_mfma_f32_32x32x16_bf16 v[80:95], v[188:191], v[108:111], v[80:95]
ds_read_b128 v[104:107], v20 offset:24576
ds_read_b128 v[108:111], v20 offset:28672
s_waitcnt lgkmcnt(2)
v_mfma_f32_32x32x16_bf16 v[64:79], v[192:195], v[120:123], v[64:79]
v_mfma_f32_32x32x16_bf16 v[80:95], v[192:195], v[124:127], v[80:95]
ds_read_b128 v[120:123], v21 offset:24576
ds_read_b128 v[124:127], v21 offset:28672
s_waitcnt lgkmcnt(2)
v_mfma_f32_32x32x16_bf16 v[64:79], v[196:199], v[104:107], v[64:79]
v_mfma_f32_32x32x16_bf16 v[80:95], v[196:199], v[108:111], v[80:95]
ds_read_b128 v[104:107], v22 offset:24576
ds_read_b128 v[108:111], v22 offset:28672
s_waitcnt lgkmcnt(2)
v_mfma_f32_32x32x16_bf16 v[64:79], v[200:203], v[120:123], v[64:79]
v_mfma_f32_32x32x16_bf16 v[80:95], v[200:203], v[124:127], v[80:95]
ds_read_b128 v[120:123], v23 offset:24576
ds_read_b128 v[124:127], v23 offset:28672
s_waitcnt lgkmcnt(2)
v_mfma_f32_32x32x16_bf16 v[64:79], v[204:207], v[104:107], v[64:79]
v_mfma_f32_32x32x16_bf16 v[80:95], v[204:207], v[108:111], v[80:95]
s_waitcnt lgkmcnt(0)
v_mfma_f32_32x32x16_bf16 v[64:79], v[208:211], v[120:123], v[64:79]
v_mfma_f32_32x32x16_bf16 v[80:95], v[208:211], v[124:127], v[80:95]
s_waitcnt vmcnt(5)
v_lshlrev_b32 v8, 16, v31
v_and_b32 v9, 0xffff0000, v31
v_lshlrev_b32 v148, 16, v128
v_and_b32 v149, 0xffff0000, v128
v_pk_mul_f32 v[148:149], v[148:149], v[8:9]
v_cvt_pk_bf16_f32 v10, v148, v149
v_lshlrev_b32 v148, 16, v10
v_and_b32 v149, 0xffff0000, v10
s_nop 1
v_add_f32 v148, v148, v64
v_add_f32 v149, v149, v80
v_lshlrev_b32 v150, 16, v129
v_and_b32 v151, 0xffff0000, v129
v_pk_mul_f32 v[150:151], v[150:151], v[8:9]
v_cvt_pk_bf16_f32 v10, v150, v151
v_lshlrev_b32 v150, 16, v10
v_and_b32 v151, 0xffff0000, v10
v_add_f32 v150, v150, v65
v_add_f32 v151, v151, v81
v_lshlrev_b32 v152, 16, v130
v_and_b32 v153, 0xffff0000, v130
v_pk_mul_f32 v[152:153], v[152:153], v[8:9]
v_cvt_pk_bf16_f32 v10, v152, v153
v_lshlrev_b32 v152, 16, v10
v_and_b32 v153, 0xffff0000, v10
v_add_f32 v152, v152, v66
v_add_f32 v153, v153, v82
v_lshlrev_b32 v154, 16, v131
v_and_b32 v155, 0xffff0000, v131
v_pk_mul_f32 v[154:155], v[154:155], v[8:9]
v_cvt_pk_bf16_f32 v10, v154, v155
v_lshlrev_b32 v154, 16, v10
v_and_b32 v155, 0xffff0000, v10
v_add_f32 v154, v154, v67
v_add_f32 v155, v155, v83
v_lshlrev_b32 v156, 16, v132
v_and_b32 v157, 0xffff0000, v132
v_pk_mul_f32 v[156:157], v[156:157], v[8:9]
v_cvt_pk_bf16_f32 v10, v156, v157
v_lshlrev_b32 v156, 16, v10
v_and_b32 v157, 0xffff0000, v10
v_add_f32 v156, v156, v68
v_add_f32 v157, v157, v84
v_lshlrev_b32 v158, 16, v133
v_and_b32 v159, 0xffff0000, v133
v_pk_mul_f32 v[158:159], v[158:159], v[8:9]
v_cvt_pk_bf16_f32 v10, v158, v159
v_lshlrev_b32 v158, 16, v10
v_and_b32 v159, 0xffff0000, v10
v_add_f32 v158, v158, v69
v_add_f32 v159, v159, v85
v_lshlrev_b32 v160, 16, v134
v_and_b32 v161, 0xffff0000, v134
v_pk_mul_f32 v[160:161], v[160:161], v[8:9]
v_cvt_pk_bf16_f32 v10, v160, v161
v_lshlrev_b32 v160, 16, v10
v_and_b32 v161, 0xffff0000, v10
v_add_f32 v160, v160, v70
v_add_f32 v161, v161, v86
v_lshlrev_b32 v162, 16, v135
v_and_b32 v163, 0xffff0000, v135
v_pk_mul_f32 v[162:163], v[162:163], v[8:9]
v_cvt_pk_bf16_f32 v10, v162, v163
v_lshlrev_b32 v162, 16, v10
v_and_b32 v163, 0xffff0000, v10
v_add_f32 v162, v162, v71
v_add_f32 v163, v163, v87
v_lshlrev_b32 v164, 16, v136
v_and_b32 v165, 0xffff0000, v136
v_pk_mul_f32 v[164:165], v[164:165], v[8:9]
v_cvt_pk_bf16_f32 v10, v164, v165
v_lshlrev_b32 v164, 16, v10
v_and_b32 v165, 0xffff0000, v10
v_add_f32 v164, v164, v72
v_add_f32 v165, v165, v88
v_lshlrev_b32 v166, 16, v137
v_and_b32 v167, 0xffff0000, v137
v_pk_mul_f32 v[166:167], v[166:167], v[8:9]
v_cvt_pk_bf16_f32 v10, v166, v167
v_lshlrev_b32 v166, 16, v10
v_and_b32 v167, 0xffff0000, v10
v_add_f32 v166, v166, v73
v_add_f32 v167, v167, v89
v_lshlrev_b32 v168, 16, v138
v_and_b32 v169, 0xffff0000, v138
v_pk_mul_f32 v[168:169], v[168:169], v[8:9]
v_cvt_pk_bf16_f32 v10, v168, v169
v_lshlrev_b32 v168, 16, v10
v_and_b32 v169, 0xffff0000, v10
v_add_f32 v168, v168, v74
v_add_f32 v169, v169, v90
v_lshlrev_b32 v170, 16, v139
v_and_b32 v171, 0xffff0000, v139
v_pk_mul_f32 v[170:171], v[170:171], v[8:9]
v_cvt_pk_bf16_f32 v10, v170, v171
v_lshlrev_b32 v170, 16, v10
v_and_b32 v171, 0xffff0000, v10
v_add_f32 v170, v170, v75
v_add_f32 v171, v171, v91
v_lshlrev_b32 v172, 16, v140
v_and_b32 v173, 0xffff0000, v140
v_pk_mul_f32 v[172:173], v[172:173], v[8:9]
v_cvt_pk_bf16_f32 v10, v172, v173
v_lshlrev_b32 v172, 16, v10
v_and_b32 v173, 0xffff0000, v10
v_add_f32 v172, v172, v76
v_add_f32 v173, v173, v92
v_lshlrev_b32 v174, 16, v141
v_and_b32 v175, 0xffff0000, v141
v_pk_mul_f32 v[174:175], v[174:175], v[8:9]
v_cvt_pk_bf16_f32 v10, v174, v175
v_lshlrev_b32 v174, 16, v10
v_and_b32 v175, 0xffff0000, v10
v_add_f32 v174, v174, v77
v_add_f32 v175, v175, v93
v_lshlrev_b32 v176, 16, v142
v_and_b32 v177, 0xffff0000, v142
v_pk_mul_f32 v[176:177], v[176:177], v[8:9]
v_cvt_pk_bf16_f32 v10, v176, v177
v_lshlrev_b32 v176, 16, v10
v_and_b32 v177, 0xffff0000, v10
v_add_f32 v176, v176, v78
v_add_f32 v177, v177, v94
v_lshlrev_b32 v178, 16, v143
v_and_b32 v179, 0xffff0000, v143
v_pk_mul_f32 v[178:179], v[178:179], v[8:9]
v_cvt_pk_bf16_f32 v10, v178, v179
v_lshlrev_b32 v178, 16, v10
v_and_b32 v179, 0xffff0000, v10
v_add_f32 v178, v178, v79
v_add_f32 v179, v179, v95
s_mov_b32 s44, s28
s_mov_b32 s45, s29
s_mov_b32 s46, s24
s_mov_b32 s47, 0x20000
s_mov_b32 s92, 0
L_xw81:
s_load_dword s61, s[52:53], 5116 glc
s_add_u32 s92, s92, 1
s_waitcnt lgkmcnt(0)
s_xor_b32 s61, s61, s60
s_cmp_lt_u32 s61, 0x10000
s_cbranch_scc1 L_xwd82
s_cmp_lt_u32 s92, 200000
s_cbranch_scc1 L_xw81
L_xwd82:
s_mov_b32 s92, 0
buffer_load_dwordx4 v[180:183], v2, s[52:55], 0 offen offset:0 sc1
buffer_load_dwordx4 v[184:187], v2, s[52:55], 0 offen offset:1024 sc1
buffer_load_dwordx4 v[188:191], v2, s[52:55], 0 offen offset:2048 sc1
buffer_load_dwordx4 v[192:195], v2, s[52:55], 0 offen offset:3072 sc1
buffer_load_dwordx4 v[196:199], v2, s[52:55], s64 offen offset:0 sc1
L_xl79:
v_mov_b32 v10, 0
s_waitcnt vmcnt(4)
v_bitop3_b32 v10, v10, v183, s60 bitop3:0xf6
s_waitcnt vmcnt(3)
v_bitop3_b32 v10, v10, v187, s60 bitop3:0xf6
s_waitcnt vmcnt(2)
v_bitop3_b32 v10, v10, v191, s60 bitop3:0xf6
s_waitcnt vmcnt(1)
v_bitop3_b32 v10, v10, v195, s60 bitop3:0xf6
s_waitcnt vmcnt(0)
v_bitop3_b32 v10, v10, v199, s60 bitop3:0xf6
v_cmp_lt_u32 vcc, 0xffff, v10
s_nop 0
s_cbranch_vccz L_xd80
s_add_u32 s92, s92, 1
s_cmp_ge_u32 s92, 200000
s_cbranch_scc1 L_xd80
buffer_load_dwordx4 v[180:183], v2, s[52:55], 0 offen offset:0 sc1
buffer_load_dwordx4 v[184:187], v2, s[52:55], 0 offen offset:1024 sc1
buffer_load_dwordx4 v[188:191], v2, s[52:55], 0 offen offset:2048 sc1
buffer_load_dwordx4 v[192:195], v2, s[52:55], 0 offen offset:3072 sc1
buffer_load_dwordx4 v[196:199], v2, s[52:55], s64 offen offset:0 sc1
s_branch L_xl79
L_xd80:
v_lshlrev_b32 v10, 16, v180
v_and_b32 v11, 0xffff0000, v180
v_pk_add_f32 v[148:149], v[148:149], v[10:11]
s_mov_b32 s64, 0
buffer_store_dwordx2 v[148:149], v29, s[44:47], s64 offen nt
v_lshlrev_b32 v10, 16, v181
v_and_b32 v11, 0xffff0000, v181
v_pk_add_f32 v[150:151], v[150:151], v[10:11]
s_mov_b32 s64, 8192
buffer_store_dwordx2 v[150:151], v29, s[44:47], s64 offen nt
v_lshlrev_b32 v10, 16, v182
v_and_b32 v11, 0xffff0000, v182
v_pk_add_f32 v[152:153], v[152:153], v[10:11]
s_mov_b32 s64, 16384
buffer_store_dwordx2 v[152:153], v29, s[44:47], s64 offen nt
v_lshlrev_b32 v10, 16, v183
v_lshlrev_b32 v11, 16, v184
v_pk_add_f32 v[154:155], v[154:155], v[10:11]
s_mov_b32 s64, 24576
buffer_store_dwordx2 v[154:155], v29, s[44:47], s64 offen nt
v_and_b32 v10, 0xffff0000, v184
v_lshlrev_b32 v11, 16, v185
v_pk_add_f32 v[156:157], v[156:157], v[10:11]
s_mov_b32 s64, 262144
buffer_store_dwordx2 v[156:157], v29, s[44:47], s64 offen nt
v_and_b32 v10, 0xffff0000, v185
v_lshlrev_b32 v11, 16, v186
v_pk_add_f32 v[158:159], v[158:159], v[10:11]
s_mov_b32 s64, 270336
buffer_store_dwordx2 v[158:159], v29, s[44:47], s64 offen nt
v_and_b32 v10, 0xffff0000, v186
v_lshlrev_b32 v11, 16, v187
v_pk_add_f32 v[160:161], v[160:161], v[10:11]
s_mov_b32 s64, 278528
buffer_store_dwordx2 v[160:161], v29, s[44:47], s64 offen nt
v_lshlrev_b32 v10, 16, v188
v_and_b32 v11, 0xffff0000, v188
v_pk_add_f32 v[162:163], v[162:163], v[10:11]
s_mov_b32 s64, 286720
buffer_store_dwordx2 v[162:163], v29, s[44:47], s64 offen nt
v_lshlrev_b32 v10, 16, v189
v_and_b32 v11, 0xffff0000, v189
v_pk_add_f32 v[164:165], v[164:165], v[10:11]
s_mov_b32 s64, 32768
buffer_store_dwordx2 v[164:165], v29, s[44:47], s64 offen nt
v_lshlrev_b32 v10, 16, v190
v_and_b32 v11, 0xffff0000, v190
v_pk_add_f32 v[166:167], v[166:167], v[10:11]
s_mov_b32 s64, 40960
buffer_store_dwordx2 v[166:167], v29, s[44:47], s64 offen nt
v_lshlrev_b32 v10, 16, v191
v_lshlrev_b32 v11, 16, v192
v_pk_add_f32 v[168:169], v[168:169], v[10:11]
s_mov_b32 s64, 49152
buffer_store_dwordx2 v[168:169], v29, s[44:47], s64 offen nt
v_and_b32 v10, 0xffff0000, v192
v_lshlrev_b32 v11, 16, v193
v_pk_add_f32 v[170:171], v[170:171], v[10:11]
s_mov_b32 s64, 57344
buffer_store_dwordx2 v[170:171], v29, s[44:47], s64 offen nt
v_and_b32 v10, 0xffff0000, v193
v_lshlrev_b32 v11, 16, v194
v_pk_add_f32 v[172:173], v[172:173], v[10:11]
s_mov_b32 s64, 294912
buffer_store_dwordx2 v[172:173], v29, s[44:47], s64 offen nt
v_and_b32 v10, 0xffff0000, v194
v_lshlrev_b32 v11, 16, v195
v_pk_add_f32 v[174:175], v[174:175], v[10:11]
s_mov_b32 s64, 303104
buffer_store_dwordx2 v[174:175], v29, s[44:47], s64 offen nt
v_lshlrev_b32 v10, 16, v196
v_and_b32 v11, 0xffff0000, v196
v_pk_add_f32 v[176:177], v[176:177], v[10:11]
s_mov_b32 s64, 311296
buffer_store_dwordx2 v[176:177], v29, s[44:47], s64 offen nt
v_lshlrev_b32 v10, 16, v197
v_and_b32 v11, 0xffff0000, v197
v_pk_add_f32 v[178:179], v[178:179], v[10:11]
s_mov_b32 s64, 319488
buffer_store_dwordx2 v[178:179], v29, s[44:47], s64 offen nt
L_concat_heads__spectral_gfnet__ssm_conv_s5__prompt_kernel_end:
s_endpgm

.section .rodata,"a"
.p2align 6
.amdhsa_kernel concat_heads__spectral_gfnet__ssm_conv_s5__prompt_kernel
  .amdhsa_next_free_vgpr 256
  .amdhsa_next_free_sgpr 102
  .amdhsa_accum_offset 256
  .amdhsa_group_segment_fixed_size 0
  .amdhsa_kernarg_size 120
  .amdhsa_user_sgpr_count 2
  .amdhsa_user_sgpr_kernarg_segment_ptr 1
  .amdhsa_system_sgpr_workgroup_id_x 1
.end_amdhsa_kernel
.text
```

```asm
; @launch grid=(256,1,1) block=(512,1,1) lds=163840
.amdgcn_target "amdgcn-amd-amdhsa--gfx950"
.text
.globl concat_heads__spectral_gfnet__ssm_conv_s5__prompt_kernel
.p2align 8
.type concat_heads__spectral_gfnet__ssm_conv_s5__prompt_kernel,@function
concat_heads__spectral_gfnet__ssm_conv_s5__prompt_kernel:
s_cmp_ge_u32 s2, 256
s_cbranch_scc1 L_concat_heads__spectral_gfnet__ssm_conv_s5__prompt_kernel_end
s_load_dwordx16 s[4:19], s[0:1], 0
s_load_dwordx8 s[20:27], s[0:1], 64
s_load_dwordx4 s[28:31], s[0:1], 96
s_load_dwordx2 s[32:33], s[0:1], 112
v_lshrrev_b32 v2, 6, v0
v_and_b32 v1, 63, v0
v_readfirstlane_b32 s34, v2
s_and_b32 s60, s2, 7
s_lshr_b32 s61, s2, 3
s_lshr_b32 s35, s60, 1
s_lshl_b32 s35, s35, 2
s_lshr_b32 s62, s61, 3
s_add_u32 s35, s35, s62
s_and_b32 s36, s60, 1
s_lshl_b32 s36, s36, 3
s_and_b32 s62, s61, 7
s_add_u32 s36, s36, s62
s_xor_b32 s34, s34, 4
s_cmp_ge_u32 s34, 4
s_cbranch_scc0 L_concat_heads__spectral_gfnet__ssm_conv_s5__prompt_kernel_gemm
s_sub_u32 s66, s34, 4
s_setprio 0
s_waitcnt lgkmcnt(0)
s_mov_b32 s100, s20
s_mov_b32 s101, s21
s_bitcmp1_b32 s66, 0
s_cselect_b32 s100, s22, s20
s_cselect_b32 s101, s23, s21
s_cmp_lg_u32 s66, 1
s_cbranch_scc1 L_pf1
s_lshr_b32 s60, s2, 3
s_lshl_b32 s60, s60, 11
v_and_b32 v12, 15, v1
v_lshl_add_u32 v12, v12, 7, s60
v_min_u32 v12, L_concat_heads__spectral_gfnet__ssm_conv_s5__prompt_kernel_end-concat_heads__spectral_gfnet__ssm_conv_s5__prompt_kernel, v12
s_getpc_b64 s[60:61]
L_pc2:
s_sub_u32 s60, s60, L_pc2-concat_heads__spectral_gfnet__ssm_conv_s5__prompt_kernel
s_subb_u32 s61, s61, 0
global_load_dword v23, v12, s[60:61]
L_pf1:
s_lshl_b32 s60, s2, 3
s_add_u32 s60, s60, s34
s_cmp_lg_u32 s60, 4
s_cbranch_scc1 L_nn3
s_load_dword s3, s[32:33], 0
v_mov_b32 v22, 0
v_lshlrev_b32 v23, 7, v1
v_add_u32 v23, 4096, v23
global_store_dword v23, v22, s[32:33] sc1
L_nn3:
s_mov_b32 s48, s6
s_mov_b32 s49, s7
s_mov_b32 s50, 2101248
s_mov_b32 s51, 0x20000
s_mov_b32 s52, s8
s_mov_b32 s53, s9
s_mov_b32 s54, 2101248
s_mov_b32 s55, 0x20000
s_and_b32 s60, s2, 31
s_lshr_b32 s61, s2, 5
s_lshl_b32 s61, s61, 7
s_add_u32 s60, s60, s61
s_lshl_b32 s61, s66, 5
s_add_u32 s67, s60, s61
s_lshl_b32 s60, s67, 12
s_add_u32 s4, s4, s60
s_addc_u32 s5, s5, 0
s_mov_b32 s6, 4096
s_mov_b32 s7, 0x20000
v_lshlrev_b32 v2, 4, v1
v_xor_b32 v3, 128, v2
s_lshl_b32 s68, s66, 12
s_add_u32 s68, s68, 131072
s_add_u32 m0, s68, 0
s_mov_b32 s92, 0
buffer_load_dwordx4 v2, s[4:7], s92 offen offset:0 nt lds
buffer_load_dwordx4 v2, s[4:7], s92 offen offset:1024 nt lds
s_add_u32 m0, s68, 2048
s_mov_b32 s92, 2048
buffer_load_dwordx4 v3, s[4:7], s92 offen offset:0 nt lds
buffer_load_dwordx4 v3, s[4:7], s92 offen offset:1024 nt lds
s_and_b32 s60, s2, 7
s_bfe_u32 s61, s2, 0x10003
s_bfe_u32 s62, s2, 0x20004
s_lshr_b32 s63, s2, 6
s_lshr_b32 s64, s60, 1
s_lshl_b32 s64, s64, 3
s_lshl_b32 s65, s61, 2
s_add_u32 s64, s64, s65
s_and_b32 s65, s60, 1
s_lshl_b32 s65, s65, 1
s_add_u32 s64, s64, s65
s_lshl_b32 s64, s64, 5
s_lshl_b32 s65, s62, 3
s_add_u32 s64, s64, s65
s_lshl_b32 s65, s66, 1
s_add_u32 s64, s64, s65
s_mul_i32 s64, s64, 1026
s_lshl_b32 s65, s63, 8
s_add_u32 s69, s64, s65
v_bfe_u32 v8, v1, 4, 1
v_mul_u32_u24 v8, 32832, v8
v_lshrrev_b32 v9, 5, v1
s_mov_b32 s65, 1050624
v_mul_lo_u32 v9, s65, v9
v_add_u32 v8, v8, v9
v_and_b32 v9, 15, v1
s_lshl_b32 s65, s66, 1
v_xor_b32 v9, s65, v9
v_lshl_add_u32 v18, v9, 4, v8
v_xor_b32 v9, 1, v9
v_lshl_add_u32 v19, v9, 4, v8
v_add_u32 v19, 1026, v19
s_bfe_u32 s64, s2, 0x20005
s_lshl_b32 s64, s64, 8
s_bfe_u32 s65, s2, 0x10004
s_lshl_b32 s65, s65, 6
s_add_u32 s64, s64, s65
s_bfe_u32 s65, s2, 0x10003
s_lshl_b32 s65, s65, 7
s_add_u32 s64, s64, s65
s_and_b32 s65, s2, 7
s_lshl_b32 s65, s65, 2
s_add_u32 s64, s64, s65
v_bfe_u32 v8, v1, 3, 2
v_add_u32 v8, s64, v8
v_bfe_u32 v9, v1, 2, 1
v_lshl_add_u32 v8, v9, 5, v8
v_bfe_u32 v9, v1, 1, 1
v_lshl_add_u32 v8, v9, 10, v8
v_sub_u32 v9, 2048, v8
v_and_b32 v9, 2047, v9
v_and_b32 v10, 1, v1
v_cmp_eq_u32 vcc, 1, v10
s_nop 1
v_cndmask_b32 v8, v8, v9, vcc
v_mul_u32_u24 v17, 1026, v8
s_lshr_b32 s64, s2, 7
s_lshl_b32 s64, s64, 10
v_add_u32 v17, s64, v17
s_add_u32 m0, s68, 16384
s_nop 0
buffer_load_dwordx4 v18, s[48:51], s69 offen nt lds
s_add_u32 m0, s68, 17408
s_nop 0
buffer_load_dwordx4 v18, s[52:55], s69 offen nt lds
s_add_u32 m0, s68, 18432
s_nop 0
buffer_load_dwordx4 v19, s[48:51], s69 offen nt lds
s_add_u32 m0, s68, 19456
s_nop 0
buffer_load_dwordx4 v19, s[52:55], s69 offen nt lds
s_cmp_lg_u32 s66, 3
s_cbranch_scc1 L_nw4
s_mov_b32 exec_hi, 0
buffer_load_ushort v88, v17, s[48:51], 0 offen nt
buffer_load_ushort v89, v17, s[52:55], 0 offen nt
s_mov_b64 exec, -1
L_nw4:
s_barrier
v_and_b32 v92, 31, v1
v_cvt_f32_u32 v92, v92
v_lshrrev_b32 v93, 5, v1
v_lshlrev_b32 v93, 2, v93
v_cvt_f32_u32 v93, v93
v_mul_f32 v93, v92, v93
v_mul_f32 v93, 0x3d000000, v93
v_fmamk_f32 v94, v92, 0x0, v93
v_fract_f32 v94, v94
v_cos_f32 v95, v94
v_sin_f32 v96, v94
s_nop 0
v_cvt_pk_bf16_f32 v192, v95, v96
v_cvt_pk_bf16_f32 v208, -v96, v95
v_fmamk_f32 v97, v92, 0x3d000000, v93
v_fract_f32 v97, v97
v_cos_f32 v98, v97
v_sin_f32 v99, v97
s_nop 0
v_cvt_pk_bf16_f32 v193, v98, v99
v_cvt_pk_bf16_f32 v209, -v99, v98
v_fmamk_f32 v94, v92, 0x3d800000, v93
v_fract_f32 v94, v94
v_cos_f32 v95, v94
v_sin_f32 v96, v94
s_nop 0
v_cvt_pk_bf16_f32 v194, v95, v96
v_cvt_pk_bf16_f32 v210, -v96, v95
v_fmamk_f32 v97, v92, 0x3dc00000, v93
v_fract_f32 v97, v97
v_cos_f32 v98, v97
v_sin_f32 v99, v97
s_nop 0
v_cvt_pk_bf16_f32 v195, v98, v99
v_cvt_pk_bf16_f32 v211, -v99, v98
v_fmamk_f32 v94, v92, 0x3e800000, v93
v_fract_f32 v94, v94
v_cos_f32 v95, v94
v_sin_f32 v96, v94
s_nop 0
v_cvt_pk_bf16_f32 v196, v95, v96
v_cvt_pk_bf16_f32 v212, -v96, v95
v_fmamk_f32 v97, v92, 0x3e900000, v93
v_fract_f32 v97, v97
v_cos_f32 v98, v97
v_sin_f32 v99, v97
s_nop 0
v_cvt_pk_bf16_f32 v197, v98, v99
v_cvt_pk_bf16_f32 v213, -v99, v98
v_fmamk_f32 v94, v92, 0x3ea00000, v93
v_fract_f32 v94, v94
v_cos_f32 v95, v94
v_sin_f32 v96, v94
s_nop 0
v_cvt_pk_bf16_f32 v198, v95, v96
v_cvt_pk_bf16_f32 v214, -v96, v95
v_fmamk_f32 v97, v92, 0x3eb00000, v93
v_fract_f32 v97, v97
v_cos_f32 v98, v97
v_sin_f32 v99, v97
s_nop 0
v_cvt_pk_bf16_f32 v199, v98, v99
v_cvt_pk_bf16_f32 v215, -v99, v98
v_fmamk_f32 v94, v92, 0x3f000000, v93
v_fract_f32 v94, v94
v_cos_f32 v95, v94
v_sin_f32 v96, v94
s_nop 0
v_cvt_pk_bf16_f32 v200, v95, v96
v_cvt_pk_bf16_f32 v216, -v96, v95
v_fmamk_f32 v97, v92, 0x3f080000, v93
v_fract_f32 v97, v97
v_cos_f32 v98, v97
v_sin_f32 v99, v97
s_nop 0
v_cvt_pk_bf16_f32 v201, v98, v99
v_cvt_pk_bf16_f32 v217, -v99, v98
v_fmamk_f32 v94, v92, 0x3f100000, v93
v_fract_f32 v94, v94
v_cos_f32 v95, v94
v_sin_f32 v96, v94
s_nop 0
v_cvt_pk_bf16_f32 v202, v95, v96
v_cvt_pk_bf16_f32 v218, -v96, v95
v_fmamk_f32 v97, v92, 0x3f180000, v93
v_fract_f32 v97, v97
v_cos_f32 v98, v97
v_sin_f32 v99, v97
s_nop 0
v_cvt_pk_bf16_f32 v203, v98, v99
v_cvt_pk_bf16_f32 v219, -v99, v98
v_fmamk_f32 v94, v92, 0x3f400000, v93
v_fract_f32 v94, v94
v_cos_f32 v95, v94
v_sin_f32 v96, v94
s_nop 0
v_cvt_pk_bf16_f32 v204, v95, v96
v_cvt_pk_bf16_f32 v220, -v96, v95
v_fmamk_f32 v97, v92, 0x3f480000, v93
v_fract_f32 v97, v97
v_cos_f32 v98, v97
v_sin_f32 v99, v97
s_nop 0
v_cvt_pk_bf16_f32 v205, v98, v99
v_cvt_pk_bf16_f32 v221, -v99, v98
v_fmamk_f32 v94, v92, 0x3f500000, v93
v_fract_f32 v94, v94
v_cos_f32 v95, v94
v_sin_f32 v96, v94
s_nop 0
v_cvt_pk_bf16_f32 v206, v95, v96
v_cvt_pk_bf16_f32 v222, -v96, v95
v_fmamk_f32 v97, v92, 0x3f580000, v93
v_fract_f32 v97, v97
v_cos_f32 v98, v97
v_sin_f32 v99, v97
s_nop 0
v_cvt_pk_bf16_f32 v207, v98, v99
v_cvt_pk_bf16_f32 v223, -v99, v98
v_and_b32 v92, 31, v1
v_cvt_f32_u32 v92, v92
v_lshrrev_b32 v93, 5, v1
v_lshlrev_b32 v93, 2, v93
v_cvt_f32_u32 v93, v93
v_mul_f32 v93, v92, v93
v_mul_f32 v93, 0x3a800000, v93
v_fmamk_f32 v94, v92, 0x0, v93
v_cos_f32 v224, v94
v_sin_f32 v240, -v94
v_fmamk_f32 v95, v92, 0x3a800000, v93
v_cos_f32 v225, v95
v_sin_f32 v241, -v95
v_fmamk_f32 v94, v92, 0x3b000000, v93
v_cos_f32 v226, v94
v_sin_f32 v242, -v94
v_fmamk_f32 v95, v92, 0x3b400000, v93
v_cos_f32 v227, v95
v_sin_f32 v243, -v95
v_fmamk_f32 v94, v92, 0x3c000000, v93
v_cos_f32 v228, v94
v_sin_f32 v244, -v94
v_fmamk_f32 v95, v92, 0x3c100000, v93
v_cos_f32 v229, v95
v_sin_f32 v245, -v95
v_fmamk_f32 v94, v92, 0x3c200000, v93
v_cos_f32 v230, v94
v_sin_f32 v246, -v94
v_fmamk_f32 v95, v92, 0x3c300000, v93
v_cos_f32 v231, v95
v_sin_f32 v247, -v95
v_fmamk_f32 v94, v92, 0x3c800000, v93
v_cos_f32 v232, v94
v_sin_f32 v248, -v94
v_fmamk_f32 v95, v92, 0x3c880000, v93
v_cos_f32 v233, v95
v_sin_f32 v249, -v95
v_fmamk_f32 v94, v92, 0x3c900000, v93
v_cos_f32 v234, v94
v_sin_f32 v250, -v94
v_fmamk_f32 v95, v92, 0x3c980000, v93
v_cos_f32 v235, v95
v_sin_f32 v251, -v95
v_fmamk_f32 v94, v92, 0x3cc00000, v93
v_cos_f32 v236, v94
v_sin_f32 v252, -v94
v_fmamk_f32 v95, v92, 0x3cc80000, v93
v_cos_f32 v237, v95
v_sin_f32 v253, -v95
v_fmamk_f32 v94, v92, 0x3cd00000, v93
v_cos_f32 v238, v94
v_sin_f32 v254, -v94
v_fmamk_f32 v95, v92, 0x3cd80000, v93
v_cos_f32 v239, v95
v_sin_f32 v255, -v95
v_mov_b32 v184, 126992
s_lshl_b32 s64, s66, 2
v_add_u32 v185, s64, v184
v_and_b32 v8, 31, v1
v_lshrrev_b32 v9, 5, v1
v_and_b32 v10, 1, v1
v_lshrrev_b32 v11, 1, v8
v_lshlrev_b32 v4, 6, v11
v_lshl_add_u32 v4, v10, 4, v4
v_lshl_add_u32 v4, v9, 12, v4
v_add_u32 v11, v11, v10
v_lshlrev_b32 v11, 6, v11
v_lshl_add_u32 v11, v10, 4, v11
v_lshl_add_u32 v11, v9, 12, v11
v_sub_u32 v5, 5168, v11
v_bfe_u32 v11, v4, 7, 1
v_lshlrev_b32 v11, 5, v11
v_xor_b32 v4, v4, v11
v_bfe_u32 v11, v5, 7, 1
v_lshlrev_b32 v11, 5, v11
v_xor_b32 v5, v5, v11
v_add_u32 v6, 11264, v5
v_and_b32 v6, 0x3fff, v6
s_add_u32 s64, s64, 98304
v_add_u32 v4, s64, v4
v_add_u32 v5, s64, v5
v_add_u32 v6, s64, v6
v_bfe_u32 v11, v1, 3, 1
v_lshlrev_b32 v11, 5, v11
v_xor_b32 v7, v2, v11
v_bfe_u32 v12, v1, 2, 1
v_mul_u32_u24 v12, 2176, v12
v_bfe_u32 v13, v1, 3, 1
v_lshl_add_u32 v12, v13, 6, v12
v_lshl_add_u32 v12, v9, 8, v12
v_bfe_u32 v13, v1, 4, 1
v_lshl_add_u32 v12, v13, 5, v12
v_and_b32 v13, 3, v1
v_lshl_add_u32 v12, v13, 3, v12
v_add_u32 v12, s68, v12
v_xor_b32 v13, 128, v12
s_lshl_b32 s64, s2, 14
s_lshl_b32 s65, s66, 12
s_add_u32 s64, s64, s65
s_add_u32 s42, s64, 16777216
s_add_u32 s40, s32, s42
s_addc_u32 s41, s33, 0
s_mov_b32 s42, 4096
s_mov_b32 s43, 0x20000
s_add_u32 s46, s64, 16777216
s_add_u32 s44, s32, s46
s_addc_u32 s45, s33, 0
s_mov_b32 s46, 4096
s_mov_b32 s47, 0x20000
v_and_b32 v14, 7, v1
v_lshrrev_b32 v15, 3, v1
v_xor_b32 v16, v14, v15
v_lshlrev_b32 v16, 4, v16
v_lshl_add_u32 v16, v14, 11, v16
s_lshr_b32 s64, s66, 1
s_lshl_b32 s64, s64, 7
s_and_b32 s65, s66, 1
s_lshl_b32 s65, s65, 3
s_add_u32 s64, s64, s65
s_add_u32 s64, s64, 147456
v_add_u32 v21, s64, v16
v_lshlrev_b32 v15, 16, v15
v_lshl_add_u32 v22, v14, 4, v15
s_lshl_b32 s64, s63, 7
s_lshr_b32 s65, s66, 1
s_lshl_b32 s65, s65, 6
s_add_u32 s64, s64, s65
s_and_b32 s65, s66, 1
s_lshl_b32 s65, s65, 2
s_add_u32 s64, s64, s65
s_mul_i32 s64, s64, 8192
s_lshr_b32 s65, s60, 2
s_mul_i32 s65, s65, 0
s_add_u32 s64, s64, s65
s_lshl_b32 s65, s60, 10
s_add_u32 s64, s64, s65
s_lshl_b32 s65, s61, 9
s_add_u32 s64, s64, s65
s_lshl_b32 s65, s62, 7
s_add_u32 s64, s64, s65
s_add_u32 s58, s64, 25182208
s_add_u32 s56, s32, s58
s_addc_u32 s57, s33, 0
s_sub_u32 s58, 4194304, s64
s_mov_b32 s59, 0x20000
s_lshl_b32 s64, s35, 18
s_lshl_b32 s65, s36, 17
s_add_u32 s12, s10, s64
s_addc_u32 s13, s11, 0
s_mov_b32 s14, 262144
s_mov_b32 s15, 0x20000
s_bitcmp1_b32 s66, 0
s_cselect_b32 s8, s18, s16
s_cselect_b32 s9, s19, s17
s_add_u32 s20, s8, s65
s_addc_u32 s21, s9, 0
s_mov_b32 s22, 131072
s_mov_b32 s23, 0x20000
s_mul_i32 s16, s35, 128
s_mul_i32 s64, s36, 128
s_add_u32 s16, s16, s64
s_lshl_b32 s17, s66, 12
s_lshr_b32 s64, s66, 1
s_and_b32 s65, s66, 1
v_lshrrev_b32 v96, 5, v1
v_bfe_u32 v97, v1, 3, 2
v_and_b32 v98, 1, v97
v_lshrrev_b32 v99, 1, v97
v_lshlrev_b32 v100, 4, v96
v_lshl_add_u32 v100, v98, 3, v100
v_add_u32 v100, v100, v99
s_lshl_b32 s92, s64, 6
s_lshl_b32 s19, s65, 2
s_add_u32 s92, s92, s19
v_add_u32 v100, s92, v100
v_lshlrev_b32 v100, 11, v100
s_lshl_b32 s92, s64, 5
v_lshl_add_u32 v101, v96, 3, v97
v_add_u32 v101, s92, v101
v_lshlrev_b32 v101, 11, v101
v_and_b32 v98, 7, v1
v_lshrrev_b32 v99, 4, v1
v_xor_b32 v98, v98, v99
v_lshlrev_b32 v98, 4, v98
v_xor_b32 v99, 64, v98
v_add_u32 v176, v100, v98
v_add_u32 v177, v100, v99
v_add_u32 v177, 64512, v177
v_add_u32 v178, v101, v98
v_add_u32 v179, v101, v99
v_add_u32 v179, 31744, v179
s_lshl_b32 s92, s2, 3
s_add_u32 s92, s92, s34
s_cmp_lg_u32 s92, 4
s_cbranch_scc1 L_nn5
s_waitcnt vmcnt(8) lgkmcnt(0)
s_add_u32 s3, s3, 1
s_cmp_eq_u32 s3, 0
s_cselect_b32 s3, 1, s3
v_mov_b32 v11, s3
v_mov_b32 v10, 0
s_mov_b64 exec, 1
global_store_dword v10, v11, s[30:31] sc1
global_store_dword v10, v11, s[32:33] offset:0
s_mov_b64 exec, -1
L_nn5:
s_waitcnt vmcnt(4)
ds_read_b64_tr_b16 v[24:25], v12 offset:0
ds_read_b64_tr_b16 v[26:27], v13 offset:0
ds_read_b64_tr_b16 v[28:29], v12 offset:512
ds_read_b64_tr_b16 v[30:31], v13 offset:512
ds_read_b64_tr_b16 v[32:33], v12 offset:1024
ds_read_b64_tr_b16 v[34:35], v13 offset:1024
ds_read_b64_tr_b16 v[36:37], v12 offset:1536
ds_read_b64_tr_b16 v[38:39], v13 offset:1536
s_waitcnt lgkmcnt(0)
v_mfma_f32_32x32x16_bf16 v[40:55], v[24:27], v[192:195], 0
v_mfma_f32_32x32x16_bf16 v[40:55], v[28:31], v[196:199], v[40:55]
v_mfma_f32_32x32x16_bf16 v[40:55], v[32:35], v[200:203], v[40:55]
v_mfma_f32_32x32x16_bf16 v[40:55], v[36:39], v[204:207], v[40:55]
v_mfma_f32_32x32x16_bf16 v[56:71], v[24:27], v[208:211], 0
v_mfma_f32_32x32x16_bf16 v[56:71], v[28:31], v[212:215], v[56:71]
v_mfma_f32_32x32x16_bf16 v[56:71], v[32:35], v[216:219], v[56:71]
v_mfma_f32_32x32x16_bf16 v[56:71], v[36:39], v[220:223], v[56:71]
s_nop 7
v_mul_f32 v168, v40, v224
v_mul_f32 v169, v40, v240
s_nop 1
v_fma_f32 v168, -v56, v240, v168
v_fmac_f32 v169, v56, v224
v_cvt_pk_bf16_f32 v72, v168, v169
v_mul_f32 v170, v41, v225
v_mul_f32 v171, v41, v241
v_fma_f32 v170, -v57, v241, v170
v_fmac_f32 v171, v57, v225
v_cvt_pk_bf16_f32 v73, v170, v171
v_mul_f32 v172, v42, v226
v_mul_f32 v173, v42, v242
v_fma_f32 v172, -v58, v242, v172
v_fmac_f32 v173, v58, v226
v_cvt_pk_bf16_f32 v74, v172, v173
v_mul_f32 v174, v43, v227
v_mul_f32 v175, v43, v243
v_fma_f32 v174, -v59, v243, v174
v_fmac_f32 v175, v59, v227
v_cvt_pk_bf16_f32 v75, v174, v175
v_mul_f32 v168, v44, v228
v_mul_f32 v169, v44, v244
v_fma_f32 v168, -v60, v244, v168
v_fmac_f32 v169, v60, v228
v_cvt_pk_bf16_f32 v76, v168, v169
v_mul_f32 v170, v45, v229
v_mul_f32 v171, v45, v245
v_fma_f32 v170, -v61, v245, v170
v_fmac_f32 v171, v61, v229
v_cvt_pk_bf16_f32 v77, v170, v171
v_mul_f32 v172, v46, v230
v_mul_f32 v173, v46, v246
v_fma_f32 v172, -v62, v246, v172
v_fmac_f32 v173, v62, v230
v_cvt_pk_bf16_f32 v78, v172, v173
v_mul_f32 v174, v47, v231
v_mul_f32 v175, v47, v247
v_fma_f32 v174, -v63, v247, v174
v_fmac_f32 v175, v63, v231
v_cvt_pk_bf16_f32 v79, v174, v175
v_mul_f32 v168, v48, v232
v_mul_f32 v169, v48, v248
v_fma_f32 v168, -v64, v248, v168
v_fmac_f32 v169, v64, v232
v_cvt_pk_bf16_f32 v80, v168, v169
v_mul_f32 v170, v49, v233
v_mul_f32 v171, v49, v249
v_fma_f32 v170, -v65, v249, v170
v_fmac_f32 v171, v65, v233
v_cvt_pk_bf16_f32 v81, v170, v171
v_mul_f32 v172, v50, v234
v_mul_f32 v173, v50, v250
v_fma_f32 v172, -v66, v250, v172
v_fmac_f32 v173, v66, v234
v_cvt_pk_bf16_f32 v82, v172, v173
v_mul_f32 v174, v51, v235
v_mul_f32 v175, v51, v251
v_fma_f32 v174, -v67, v251, v174
v_fmac_f32 v175, v67, v235
v_cvt_pk_bf16_f32 v83, v174, v175
v_mul_f32 v168, v52, v236
v_mul_f32 v169, v52, v252
v_fma_f32 v168, -v68, v252, v168
v_fmac_f32 v169, v68, v236
v_cvt_pk_bf16_f32 v84, v168, v169
v_mul_f32 v170, v53, v237
v_mul_f32 v171, v53, v253
v_fma_f32 v170, -v69, v253, v170
v_fmac_f32 v171, v69, v237
v_cvt_pk_bf16_f32 v85, v170, v171
v_mul_f32 v172, v54, v238
v_mul_f32 v173, v54, v254
v_fma_f32 v172, -v70, v254, v172
v_fmac_f32 v173, v70, v238
v_cvt_pk_bf16_f32 v86, v172, v173
v_mul_f32 v174, v55, v239
v_mul_f32 v175, v55, v255
v_fma_f32 v174, -v71, v255, v174
v_fmac_f32 v175, v71, v239
v_cvt_pk_bf16_f32 v87, v174, v175
v_mfma_f32_32x32x16_bf16 v[40:55], v[192:195], v[72:75], 0
v_mfma_f32_32x32x16_bf16 v[40:55], v[196:199], v[76:79], v[40:55]
v_mfma_f32_32x32x16_bf16 v[40:55], v[200:203], v[80:83], v[40:55]
v_mfma_f32_32x32x16_bf16 v[40:55], v[204:207], v[84:87], v[40:55]
v_mfma_f32_32x32x16_bf16 v[56:71], v[208:211], v[72:75], 0
v_mfma_f32_32x32x16_bf16 v[56:71], v[212:215], v[76:79], v[56:71]
v_mfma_f32_32x32x16_bf16 v[56:71], v[216:219], v[80:83], v[56:71]
v_mfma_f32_32x32x16_bf16 v[56:71], v[220:223], v[84:87], v[56:71]
s_lshl_b32 s92, s66, 12
s_add_u32 s92, s92, 98304
v_add_u32 v8, s92, v7
s_nop 8
v_cvt_pk_bf16_f32 v72, v40, v56
ds_write_b32 v4, v72 offset:0
v_cvt_pk_bf16_f32 v73, v41, v57
ds_write_b32 v4, v73 offset:1024
v_cvt_pk_bf16_f32 v74, v42, v58
ds_write_b32 v4, v74 offset:2048
v_cvt_pk_bf16_f32 v75, v43, v59
ds_write_b32 v4, v75 offset:3072
v_cvt_pk_bf16_f32 v76, v44, v60
ds_write_b32 v4, v76 offset:8192
v_cvt_pk_bf16_f32 v77, v45, v61
ds_write_b32 v4, v77 offset:9216
v_cvt_pk_bf16_f32 v78, v46, v62
ds_write_b32 v4, v78 offset:10240
v_cvt_pk_bf16_f32 v79, v47, v63
ds_write_b32 v4, v79 offset:11264
v_cvt_pk_bf16_f32 v80, v48, v64
ds_write_b32 v6, v80 offset:0
v_cvt_pk_bf16_f32 v81, v49, v65
ds_write_b32 v5, v81 offset:10240
v_cvt_pk_bf16_f32 v82, v50, v66
ds_write_b32 v5, v82 offset:9216
v_cvt_pk_bf16_f32 v83, v51, v67
ds_write_b32 v5, v83 offset:8192
v_cvt_pk_bf16_f32 v84, v52, v68
ds_write_b32 v5, v84 offset:3072
v_cvt_pk_bf16_f32 v85, v53, v69
ds_write_b32 v5, v85 offset:2048
v_cvt_pk_bf16_f32 v86, v54, v70
ds_write_b32 v5, v86 offset:1024
v_cvt_pk_bf16_f32 v87, v55, v71
ds_write_b32 v5, v87 offset:0
s_waitcnt vmcnt(0)
s_waitcnt lgkmcnt(0)
v_mov_b32 v190, 1
s_mov_b64 exec, 1
ds_write_b32 v185, v190
s_mov_b64 exec, -1
L_lc6:
ds_read_b128 v[186:189], v184
s_waitcnt lgkmcnt(0)
v_min3_u32 v186, v186, v187, v188
v_min_u32 v186, v186, v189
s_nop 0
v_readfirstlane_b32 s92, v186
s_nop 0
s_cmp_ge_u32 s92, 1
s_cbranch_scc1 L_lcd7
s_sleep 1
s_branch L_lc6
L_lcd7:
ds_read_b128 v[72:75], v8 offset:0
ds_read_b128 v[76:79], v8 offset:1024
ds_read_b128 v[80:83], v8 offset:2048
ds_read_b128 v[84:87], v8 offset:3072
ds_read_b64 v[104:105], v21 offset:0
ds_read_b64 v[106:107], v21 offset:256
ds_read_b64 v[108:109], v21 offset:512
ds_read_b64 v[110:111], v21 offset:768
ds_read_b64 v[112:113], v21 offset:1024
ds_read_b64 v[114:115], v21 offset:1280
ds_read_b64 v[116:117], v21 offset:1536
ds_read_b64 v[118:119], v21 offset:1792
v_add_u32 v4, 32768, v4
v_add_u32 v5, 32768, v5
v_add_u32 v6, 32768, v6
s_waitcnt lgkmcnt(0)
v_mov_b32 v190, 2
s_mov_b64 exec, 1
ds_write_b32 v185, v190
s_mov_b64 exec, -1
s_mov_b32 s64, 0x05040100
s_mov_b32 s65, 0x07060302
v_lshlrev_b32 v88, 16, v88
v_lshlrev_b32 v89, 16, v89
v_lshlrev_b32 v23, 1, v1
v_add_f32_dpp v90, v88, v88 quad_perm:[1,0,3,2] row_mask:0xf bank_mask:0xf
v_subrev_f32_dpp v91, v89, v89 quad_perm:[1,0,3,2] row_mask:0xf bank_mask:0xf
v_mul_f32 v90, 0.5, v90
v_mul_f32 v91, 0.5, v91
v_cvt_pk_bf16_f32 v88, v90, v91
v_perm_b32 v120, v112, v104, s64
v_perm_b32 v121, v116, v108, s64
v_perm_b32 v122, v114, v106, s64
v_perm_b32 v123, v118, v110, s64
v_perm_b32 v124, v112, v104, s65
v_perm_b32 v125, v116, v108, s65
v_perm_b32 v126, v114, v106, s65
v_perm_b32 v127, v118, v110, s65
v_perm_b32 v128, v113, v105, s64
v_perm_b32 v129, v117, v109, s64
v_perm_b32 v130, v115, v107, s64
v_perm_b32 v131, v119, v111, s64
v_perm_b32 v132, v113, v105, s65
v_perm_b32 v133, v117, v109, s65
v_perm_b32 v134, v115, v107, s65
v_perm_b32 v135, v119, v111, s65
v_and_b32 v92, 31, v1
v_cvt_f32_u32 v92, v92
v_lshrrev_b32 v93, 5, v1
v_lshlrev_b32 v93, 2, v93
v_cvt_f32_u32 v93, v93
v_mul_f32 v92, 0x3a000000, v92
v_fmamk_f32 v93, v93, 0x3c800000, v92
v_add_f32 v94, 0x0, v93
v_cos_f32 v136, v94
v_sin_f32 v152, -v94
v_add_f32 v95, 0x3c800000, v93
v_cos_f32 v137, v95
v_sin_f32 v153, -v95
v_add_f32 v94, 0x3d000000, v93
v_cos_f32 v138, v94
v_sin_f32 v154, -v94
v_add_f32 v95, 0x3d400000, v93
v_cos_f32 v139, v95
v_sin_f32 v155, -v95
v_add_f32 v94, 0x3e000000, v93
v_cos_f32 v140, v94
v_sin_f32 v156, -v94
v_add_f32 v95, 0x3e100000, v93
v_cos_f32 v141, v95
v_sin_f32 v157, -v95
v_add_f32 v94, 0x3e200000, v93
v_cos_f32 v142, v94
v_sin_f32 v158, -v94
v_add_f32 v95, 0x3e300000, v93
v_cos_f32 v143, v95
v_sin_f32 v159, -v95
v_add_f32 v94, 0x3e800000, v93
v_cos_f32 v144, v94
v_sin_f32 v160, -v94
v_add_f32 v95, 0x3e880000, v93
v_cos_f32 v145, v95
v_sin_f32 v161, -v95
v_add_f32 v94, 0x3e900000, v93
v_cos_f32 v146, v94
v_sin_f32 v162, -v94
v_add_f32 v95, 0x3e980000, v93
v_cos_f32 v147, v95
v_sin_f32 v163, -v95
v_add_f32 v94, 0x3ec00000, v93
v_cos_f32 v148, v94
v_sin_f32 v164, -v94
v_add_f32 v95, 0x3ec80000, v93
v_cos_f32 v149, v95
v_sin_f32 v165, -v95
v_add_f32 v94, 0x3ed00000, v93
v_cos_f32 v150, v94
v_sin_f32 v166, -v94
v_add_f32 v95, 0x3ed80000, v93
v_cos_f32 v151, v95
v_sin_f32 v167, -v95
s_and_b32 s60, s2, 7
s_lshl_b32 s60, s60, 5
s_lshr_b32 s64, s2, 3
s_add_u32 s60, s60, s64
s_lshr_b32 s64, s66, 1
s_xor_b32 s64, s64, s66
s_and_b32 s64, s64, 1
s_or_b32 s65, s64, s60
s_cmp_eq_u32 s65, 0
s_cselect_b32 s61, 1, 0
s_lshl_b32 s65, s60, 1
s_add_u32 s64, s64, s65
s_mul_i32 s64, s64, 8192
s_add_u32 s64, s64, 25182208
s_lshr_b32 s65, s66, 1
s_mul_i32 s69, s65, 8192
s_add_u32 s69, s69, 25165824
s_cmp_eq_u32 s61, 1
s_cselect_b32 s64, s69, s64
s_cselect_b32 s65, 0, s65
s_cselect_b32 s90, s32, s32
s_cselect_b32 s91, s33, s33
s_lshl_b32 s62, s65, 31
s_or_b32 s63, s62, 0x3f800000
s_add_u32 s48, s90, s64
s_addc_u32 s49, s91, 0
s_mov_b32 s50, 8192
s_mov_b32 s51, 0x20000
s_lshl_b32 s64, s66, 20
s_lshl_b32 s65, s60, 6
s_add_u32 s64, s64, s65
s_add_u32 s54, s64, 16777216
s_add_u32 s52, s32, s54
s_addc_u32 s53, s33, 0
s_sub_u32 s54, 1048576, s65
s_mov_b32 s55, 0x20000
v_lshrrev_b32 v8, 2, v1
v_lshlrev_b32 v8, 14, v8
v_and_b32 v9, 3, v1
v_lshrrev_b32 v10, 4, v1
v_xor_b32 v9, v9, v10
v_lshl_add_u32 v14, v9, 4, v8
v_and_b32 v8, 31, v1
v_bfe_u32 v9, v1, 2, 2
v_xor_b32 v9, s66, v9
v_lshlrev_b32 v9, 4, v9
v_lshl_add_u32 v9, v8, 6, v9
v_lshrrev_b32 v8, 5, v1
v_lshl_add_u32 v9, v8, 11, v9
v_add_u32 v15, 131072, v9
s_lshl_b32 s64, s66, 13
s_add_u32 s64, s64, 131072
v_add_u32 v16, s64, v2
s_xor_b32 s65, s64, 24576
s_cmp_eq_u32 s61, 1
s_cselect_b32 s65, s64, s65
v_add_u32 v17, s65, v2
v_add_u32 v18, s68, v2
s_lshr_b32 s64, s66, 1
s_xor_b32 s64, s64, s66
s_and_b32 s64, s64, 1
s_lshl_b32 s69, s64, 13
s_add_u32 s69, s69, 147456
v_add_u32 v19, s69, v2
v_mul_f32 v136, s63, v136
v_mul_f32 v137, s63, v137
v_mul_f32 v138, s63, v138
v_mul_f32 v139, s63, v139
v_mul_f32 v140, s63, v140
v_mul_f32 v141, s63, v141
v_mul_f32 v142, s63, v142
v_mul_f32 v143, s63, v143
v_mul_f32 v144, s63, v144
v_mul_f32 v145, s63, v145
v_mul_f32 v146, s63, v146
v_mul_f32 v147, s63, v147
v_mul_f32 v148, s63, v148
v_mul_f32 v149, s63, v149
v_mul_f32 v150, s63, v150
v_mul_f32 v151, s63, v151
v_mul_f32 v152, s63, v152
v_mul_f32 v153, s63, v153
v_mul_f32 v154, s63, v154
v_mul_f32 v155, s63, v155
v_mul_f32 v156, s63, v156
v_mul_f32 v157, s63, v157
v_mul_f32 v158, s63, v158
v_mul_f32 v159, s63, v159
v_mul_f32 v160, s63, v160
v_mul_f32 v161, s63, v161
v_mul_f32 v162, s63, v162
v_mul_f32 v163, s63, v163
v_mul_f32 v164, s63, v164
v_mul_f32 v165, s63, v165
v_mul_f32 v166, s63, v166
v_mul_f32 v167, s63, v167
buffer_store_dwordx4 v[72:75], v2, s[40:43], 0 offen offset:0 sc1
buffer_store_dwordx4 v[76:79], v2, s[40:43], 0 offen offset:1024 sc1
buffer_store_dwordx4 v[80:83], v2, s[40:43], 0 offen offset:2048 sc1
buffer_store_dwordx4 v[84:87], v2, s[40:43], 0 offen offset:3072 sc1
s_setprio 3
s_barrier
s_add_u32 s8, s16, 256
s_and_b32 s8, s8, 0x7ff
s_add_u32 s9, s8, 2048
s_add_u32 s10, s8, 6144
s_add_u32 m0, s17, 65536
s_nop 0
buffer_load_dwordx4 v176, s[12:15], s8 offen offset:0 lds
buffer_load_dwordx4 v177, s[12:15], s8 offen offset:1024 lds
buffer_load_dwordx4 v176, s[12:15], s9 offen offset:2048 lds
buffer_load_dwordx4 v177, s[12:15], s9 offen offset:3072 lds
s_add_u32 m0, s17, 81920
s_nop 0
buffer_load_dwordx4 v178, s[20:23], s8 offen offset:0 lds
buffer_load_dwordx4 v179, s[20:23], s8 offen offset:1024 lds
buffer_load_dwordx4 v178, s[20:23], s10 offen offset:2048 lds
buffer_load_dwordx4 v179, s[20:23], s10 offen offset:3072 lds
s_barrier
s_add_u32 s8, s16, 384
s_and_b32 s8, s8, 0x7ff
s_add_u32 s9, s8, 2048
s_add_u32 s10, s8, 6144
s_add_u32 m0, s17, 0
s_nop 0
buffer_load_dwordx4 v176, s[12:15], s8 offen offset:0 lds
buffer_load_dwordx4 v177, s[12:15], s8 offen offset:1024 lds
buffer_load_dwordx4 v176, s[12:15], s9 offen offset:2048 lds
buffer_load_dwordx4 v177, s[12:15], s9 offen offset:3072 lds
s_add_u32 m0, s17, 16384
s_nop 0
buffer_load_dwordx4 v178, s[20:23], s8 offen offset:0 lds
buffer_load_dwordx4 v179, s[20:23], s8 offen offset:1024 lds
buffer_load_dwordx4 v178, s[20:23], s10 offen offset:2048 lds
buffer_load_dwordx4 v179, s[20:23], s10 offen offset:3072 lds
s_waitcnt vmcnt(8)
s_barrier
s_add_u32 s8, s16, 512
s_and_b32 s8, s8, 0x7ff
s_add_u32 s9, s8, 2048
s_add_u32 s10, s8, 6144
s_add_u32 m0, s17, 32768
s_nop 0
buffer_load_dwordx4 v176, s[12:15], s8 offen offset:0 lds
buffer_load_dwordx4 v177, s[12:15], s8 offen offset:1024 lds
buffer_load_dwordx4 v176, s[12:15], s9 offen offset:2048 lds
buffer_load_dwordx4 v177, s[12:15], s9 offen offset:3072 lds
s_add_u32 m0, s17, 49152
s_nop 0
buffer_load_dwordx4 v178, s[20:23], s8 offen offset:0 lds
buffer_load_dwordx4 v179, s[20:23], s8 offen offset:1024 lds
buffer_load_dwordx4 v178, s[20:23], s10 offen offset:2048 lds
buffer_load_dwordx4 v179, s[20:23], s10 offen offset:3072 lds
v_mov_b32 v20, 0
global_load_dword v21, v20, s[30:31] sc1
s_waitcnt vmcnt(9)
s_barrier
s_add_u32 s8, s16, 640
s_and_b32 s8, s8, 0x7ff
s_add_u32 s9, s8, 2048
s_add_u32 s10, s8, 6144
s_add_u32 m0, s17, 65536
s_nop 0
buffer_load_dwordx4 v176, s[12:15], s8 offen offset:0 lds
buffer_load_dwordx4 v177, s[12:15], s8 offen offset:1024 lds
buffer_load_dwordx4 v176, s[12:15], s9 offen offset:2048 lds
buffer_load_dwordx4 v177, s[12:15], s9 offen offset:3072 lds
s_add_u32 m0, s17, 81920
s_nop 0
buffer_load_dwordx4 v178, s[20:23], s8 offen offset:0 lds
buffer_load_dwordx4 v179, s[20:23], s8 offen offset:1024 lds
buffer_load_dwordx4 v178, s[20:23], s10 offen offset:2048 lds
buffer_load_dwordx4 v179, s[20:23], s10 offen offset:3072 lds
s_cmp_lg_u32 s66, 3
s_cbranch_scc1 L_nw8
s_lshr_b32 s64, s2, 7
s_mul_i32 s64, s64, 8192
s_bfe_u32 s65, s2, 0x10006
s_mul_i32 s65, s65, 4096
s_add_u32 s64, s64, s65
s_and_b32 s65, s2, 63
s_lshl_b32 s65, s65, 6
s_add_u32 s64, s64, s65
s_add_u32 s6, s64, 25165824
s_add_u32 s4, s32, s6
s_addc_u32 s5, s33, 0
s_mov_b32 s6, 64
s_mov_b32 s7, 0x20000
s_mov_b32 exec_lo, 0x55555555
s_mov_b32 exec_hi, 0
buffer_store_dword v88, v23, s[4:7], 0 offen sc1
s_mov_b64 exec, -1
L_nw8:
s_mov_b32 s92, 0
buffer_store_dwordx4 v[120:123], v22, s[56:59], s92 offen sc1
s_mov_b32 s92, 8192
buffer_store_dwordx4 v[124:127], v22, s[56:59], s92 offen sc1
s_mov_b32 s92, 16384
buffer_store_dwordx4 v[128:131], v22, s[56:59], s92 offen sc1
s_mov_b32 s92, 24576
buffer_store_dwordx4 v[132:135], v22, s[56:59], s92 offen sc1
s_waitcnt vmcnt(13)
s_barrier
s_add_u32 s8, s16, 768
s_and_b32 s8, s8, 0x7ff
s_add_u32 s9, s8, 2048
s_add_u32 s10, s8, 6144
s_add_u32 m0, s17, 0
s_nop 0
buffer_load_dwordx4 v176, s[12:15], s8 offen offset:0 lds
buffer_load_dwordx4 v177, s[12:15], s8 offen offset:1024 lds
buffer_load_dwordx4 v176, s[12:15], s9 offen offset:2048 lds
buffer_load_dwordx4 v177, s[12:15], s9 offen offset:3072 lds
s_add_u32 m0, s17, 16384
s_nop 0
buffer_load_dwordx4 v178, s[20:23], s8 offen offset:0 lds
buffer_load_dwordx4 v179, s[20:23], s8 offen offset:1024 lds
buffer_load_dwordx4 v178, s[20:23], s10 offen offset:2048 lds
buffer_load_dwordx4 v179, s[20:23], s10 offen offset:3072 lds
s_waitcnt vmcnt(12)
s_barrier
s_add_u32 s8, s16, 896
s_and_b32 s8, s8, 0x7ff
s_add_u32 s9, s8, 2048
s_add_u32 s10, s8, 6144
s_add_u32 m0, s17, 32768
s_nop 0
buffer_load_dwordx4 v176, s[12:15], s8 offen offset:0 lds
buffer_load_dwordx4 v177, s[12:15], s8 offen offset:1024 lds
buffer_load_dwordx4 v176, s[12:15], s9 offen offset:2048 lds
buffer_load_dwordx4 v177, s[12:15], s9 offen offset:3072 lds
s_add_u32 m0, s17, 49152
s_nop 0
buffer_load_dwordx4 v178, s[20:23], s8 offen offset:0 lds
buffer_load_dwordx4 v179, s[20:23], s8 offen offset:1024 lds
buffer_load_dwordx4 v178, s[20:23], s10 offen offset:2048 lds
buffer_load_dwordx4 v179, s[20:23], s10 offen offset:3072 lds
s_waitcnt vmcnt(8)
s_barrier
s_add_u32 s8, s16, 1024
s_and_b32 s8, s8, 0x7ff
s_add_u32 s9, s8, 2048
s_add_u32 s10, s8, 6144
s_add_u32 m0, s17, 65536
s_nop 0
buffer_load_dwordx4 v176, s[12:15], s8 offen offset:0 lds
buffer_load_dwordx4 v177, s[12:15], s8 offen offset:1024 lds
buffer_load_dwordx4 v176, s[12:15], s9 offen offset:2048 lds
buffer_load_dwordx4 v177, s[12:15], s9 offen offset:3072 lds
s_add_u32 m0, s17, 81920
s_nop 0
buffer_load_dwordx4 v178, s[20:23], s8 offen offset:0 lds
buffer_load_dwordx4 v179, s[20:23], s8 offen offset:1024 lds
buffer_load_dwordx4 v178, s[20:23], s10 offen offset:2048 lds
buffer_load_dwordx4 v179, s[20:23], s10 offen offset:3072 lds
v_readfirstlane_b32 s37, v21
s_nop 0
s_cmp_lg_u32 s37, 0
s_cbranch_scc1 L_sg10
v_mov_b32 v20, 0
L_n11:
global_load_dword v21, v20, s[30:31] sc1
s_waitcnt vmcnt(0)
v_readfirstlane_b32 s37, v21
s_nop 0
s_cmp_eq_u32 s37, 0
s_cbranch_scc1 L_n11
L_sg10:
s_cmp_lg_u32 s66, 0
s_cbranch_scc1 L_sg13
s_and_b32 s64, s2, 15
s_lshl_b32 s65, s64, 7
s_add_u32 s65, s65, 4096
s_add_u32 s90, s32, s65
s_addc_u32 s91, s33, 0
s_mov_b32 s18, 1
s_atomic_add s18, s[90:91], 0x0 glc
L_sg13:
s_waitcnt vmcnt(8)
s_barrier
s_add_u32 s8, s16, 1152
s_and_b32 s8, s8, 0x7ff
s_add_u32 s9, s8, 2048
s_add_u32 s10, s8, 6144
s_add_u32 m0, s17, 0
s_nop 0
buffer_load_dwordx4 v176, s[12:15], s8 offen offset:0 lds
buffer_load_dwordx4 v177, s[12:15], s8 offen offset:1024 lds
buffer_load_dwordx4 v176, s[12:15], s9 offen offset:2048 lds
buffer_load_dwordx4 v177, s[12:15], s9 offen offset:3072 lds
s_add_u32 m0, s17, 16384
s_nop 0
buffer_load_dwordx4 v178, s[20:23], s8 offen offset:0 lds
buffer_load_dwordx4 v179, s[20:23], s8 offen offset:1024 lds
buffer_load_dwordx4 v178, s[20:23], s10 offen offset:2048 lds
buffer_load_dwordx4 v179, s[20:23], s10 offen offset:3072 lds
s_waitcnt vmcnt(8)
s_barrier
s_add_u32 s8, s16, 1280
s_and_b32 s8, s8, 0x7ff
s_add_u32 s9, s8, 2048
s_add_u32 s10, s8, 6144
s_add_u32 m0, s17, 32768
s_nop 0
buffer_load_dwordx4 v176, s[12:15], s8 offen offset:0 lds
buffer_load_dwordx4 v177, s[12:15], s8 offen offset:1024 lds
buffer_load_dwordx4 v176, s[12:15], s9 offen offset:2048 lds
buffer_load_dwordx4 v177, s[12:15], s9 offen offset:3072 lds
s_add_u32 m0, s17, 49152
s_nop 0
buffer_load_dwordx4 v178, s[20:23], s8 offen offset:0 lds
buffer_load_dwordx4 v179, s[20:23], s8 offen offset:1024 lds
buffer_load_dwordx4 v178, s[20:23], s10 offen offset:2048 lds
buffer_load_dwordx4 v179, s[20:23], s10 offen offset:3072 lds
s_cmp_lg_u32 s66, 0
s_cbranch_scc1 L_sg14
s_waitcnt lgkmcnt(0)
s_cmp_lg_u32 s18, 15
s_cbranch_scc1 L_sg14
s_and_b32 s64, s2, 15
s_lshl_b32 s64, s64, 2
s_add_u32 s64, s64, 540672
v_lshl_add_u32 v22, v1, 7, s64
v_mov_b32 v23, s37
global_store_dword v22, v23, s[32:33] sc1
L_sg14:
s_waitcnt vmcnt(8)
s_barrier
s_add_u32 s8, s16, 1408
s_and_b32 s8, s8, 0x7ff
s_add_u32 s9, s8, 2048
s_add_u32 s10, s8, 6144
s_add_u32 m0, s17, 65536
s_nop 0
buffer_load_dwordx4 v176, s[12:15], s8 offen offset:0 lds
buffer_load_dwordx4 v177, s[12:15], s8 offen offset:1024 lds
buffer_load_dwordx4 v176, s[12:15], s9 offen offset:2048 lds
buffer_load_dwordx4 v177, s[12:15], s9 offen offset:3072 lds
s_add_u32 m0, s17, 81920
s_nop 0
buffer_load_dwordx4 v178, s[20:23], s8 offen offset:0 lds
buffer_load_dwordx4 v179, s[20:23], s8 offen offset:1024 lds
buffer_load_dwordx4 v178, s[20:23], s10 offen offset:2048 lds
buffer_load_dwordx4 v179, s[20:23], s10 offen offset:3072 lds
s_waitcnt vmcnt(8)
s_barrier
s_add_u32 s8, s16, 1536
s_and_b32 s8, s8, 0x7ff
s_add_u32 s9, s8, 2048
s_add_u32 s10, s8, 6144
s_add_u32 m0, s17, 0
s_nop 0
buffer_load_dwordx4 v176, s[12:15], s8 offen offset:0 lds
buffer_load_dwordx4 v177, s[12:15], s8 offen offset:1024 lds
buffer_load_dwordx4 v176, s[12:15], s9 offen offset:2048 lds
buffer_load_dwordx4 v177, s[12:15], s9 offen offset:3072 lds
s_add_u32 m0, s17, 16384
s_nop 0
buffer_load_dwordx4 v178, s[20:23], s8 offen offset:0 lds
buffer_load_dwordx4 v179, s[20:23], s8 offen offset:1024 lds
buffer_load_dwordx4 v178, s[20:23], s10 offen offset:2048 lds
buffer_load_dwordx4 v179, s[20:23], s10 offen offset:3072 lds
s_waitcnt vmcnt(8)
s_barrier
s_add_u32 s8, s16, 1664
s_and_b32 s8, s8, 0x7ff
s_add_u32 s9, s8, 2048
s_add_u32 s10, s8, 6144
s_add_u32 m0, s17, 32768
s_nop 0
buffer_load_dwordx4 v176, s[12:15], s8 offen offset:0 lds
buffer_load_dwordx4 v177, s[12:15], s8 offen offset:1024 lds
buffer_load_dwordx4 v176, s[12:15], s9 offen offset:2048 lds
buffer_load_dwordx4 v177, s[12:15], s9 offen offset:3072 lds
s_add_u32 m0, s17, 49152
s_nop 0
buffer_load_dwordx4 v178, s[20:23], s8 offen offset:0 lds
buffer_load_dwordx4 v179, s[20:23], s8 offen offset:1024 lds
buffer_load_dwordx4 v178, s[20:23], s10 offen offset:2048 lds
buffer_load_dwordx4 v179, s[20:23], s10 offen offset:3072 lds
s_waitcnt vmcnt(8)
s_barrier
s_add_u32 s8, s16, 1792
s_and_b32 s8, s8, 0x7ff
s_add_u32 s9, s8, 2048
s_add_u32 s10, s8, 6144
s_add_u32 m0, s17, 65536
s_nop 0
buffer_load_dwordx4 v176, s[12:15], s8 offen offset:0 lds
buffer_load_dwordx4 v177, s[12:15], s8 offen offset:1024 lds
buffer_load_dwordx4 v176, s[12:15], s9 offen offset:2048 lds
buffer_load_dwordx4 v177, s[12:15], s9 offen offset:3072 lds
s_add_u32 m0, s17, 81920
s_nop 0
buffer_load_dwordx4 v178, s[20:23], s8 offen offset:0 lds
buffer_load_dwordx4 v179, s[20:23], s8 offen offset:1024 lds
buffer_load_dwordx4 v178, s[20:23], s10 offen offset:2048 lds
buffer_load_dwordx4 v179, s[20:23], s10 offen offset:3072 lds
s_waitcnt vmcnt(8)
s_barrier
s_add_u32 s8, s16, 1920
s_and_b32 s8, s8, 0x7ff
s_add_u32 s9, s8, 2048
s_add_u32 s10, s8, 6144
s_add_u32 m0, s17, 0
s_nop 0
buffer_load_dwordx4 v176, s[12:15], s8 offen offset:0 lds
buffer_load_dwordx4 v177, s[12:15], s8 offen offset:1024 lds
buffer_load_dwordx4 v176, s[12:15], s9 offen offset:2048 lds
buffer_load_dwordx4 v177, s[12:15], s9 offen offset:3072 lds
s_add_u32 m0, s17, 16384
s_nop 0
buffer_load_dwordx4 v178, s[20:23], s8 offen offset:0 lds
buffer_load_dwordx4 v179, s[20:23], s8 offen offset:1024 lds
buffer_load_dwordx4 v178, s[20:23], s10 offen offset:2048 lds
buffer_load_dwordx4 v179, s[20:23], s10 offen offset:3072 lds
s_waitcnt vmcnt(8)
s_barrier
s_and_b32 s64, s2, 1
s_lshl_b32 s64, s64, 10
s_bfe_u32 s92, s2, 0x20001
s_lshl_b32 s92, s92, 19
s_add_u32 s64, s64, s92
s_lshr_b32 s92, s2, 3
s_lshl_b32 s92, s92, 14
s_add_u32 s64, s64, s92
s_lshr_b32 s92, s66, 1
s_lshl_b32 s92, s92, 13
s_add_u32 s64, s64, s92
v_bfe_u32 v22, v1, 3, 2
v_lshlrev_b32 v22, 11, v22
v_and_b32 v23, 7, v1
v_lshl_add_u32 v22, v23, 7, v22
v_add_u32 v22, s64, v22
s_mov_b32 exec_hi, 0
global_load_dword v23, v22, s[100:101]
s_mov_b64 exec, -1
s_lshl_b32 s64, s2, 2
s_add_u32 s64, s64, s66
s_lshr_b32 s64, s64, 4
s_lshl_b32 s64, s64, 7
s_add_u32 s64, s64, 540672
s_add_u32 s24, s32, s64
s_addc_u32 s25, s33, 0
s_load_dwordx16 s[4:19], s[24:25], 0x0 glc
s_waitcnt vmcnt(1)
s_barrier
s_setprio 0
s_mov_b32 s26, s37
s_mov_b32 s27, s37
s_mov_b32 s92, 0
s_branch L_sp17
L_late15:
s_add_u32 s92, s92, 1
s_cmp_ge_u32 s92, 200000
s_cbranch_scc1 L_go16
s_sleep 8
s_load_dwordx16 s[4:19], s[24:25], 0x0 glc
L_sp17:
s_waitcnt lgkmcnt(0)
s_cmp_eq_u64 s[4:5], s[26:27]
s_cbranch_scc0 L_late15
s_cmp_eq_u64 s[6:7], s[26:27]
s_cbranch_scc0 L_late15
s_cmp_eq_u64 s[8:9], s[26:27]
s_cbranch_scc0 L_late15
s_cmp_eq_u64 s[10:11], s[26:27]
s_cbranch_scc0 L_late15
s_cmp_eq_u64 s[12:13], s[26:27]
s_cbranch_scc0 L_late15
s_cmp_eq_u64 s[14:15], s[26:27]
s_cbranch_scc0 L_late15
s_cmp_eq_u64 s[16:17], s[26:27]
s_cbranch_scc0 L_late15
s_cmp_eq_u64 s[18:19], s[26:27]
s_cbranch_scc0 L_late15
L_go16:
s_setprio 0
s_add_u32 m0, s68, 0
s_mov_b32 s64, 0
buffer_load_dwordx4 v14, s[52:55], s64 offen sc1 lds
s_add_u32 m0, s68, 1024
s_mov_b32 s64, 262144
buffer_load_dwordx4 v14, s[52:55], s64 offen sc1 lds
s_add_u32 m0, s68, 2048
s_mov_b32 s64, 524288
buffer_load_dwordx4 v14, s[52:55], s64 offen sc1 lds
s_add_u32 m0, s68, 3072
s_mov_b32 s64, 786432
buffer_load_dwordx4 v14, s[52:55], s64 offen sc1 lds
s_cmp_eq_u32 s61, 1
s_cbranch_scc1 L_ws18
s_lshr_b32 s64, s66, 1
s_lshl_b32 s65, s64, 12
s_mul_i32 s64, s64, 4096
s_add_u32 m0, s69, s65
s_nop 0
buffer_load_dwordx4 v2, s[48:51], s64 offen offset:0 sc1 lds
buffer_load_dwordx4 v2, s[48:51], s64 offen offset:1024 sc1 lds
buffer_load_dwordx4 v2, s[48:51], s64 offen offset:2048 sc1 lds
buffer_load_dwordx4 v2, s[48:51], s64 offen offset:3072 sc1 lds
s_waitcnt vmcnt(0)
s_branch L_wd19
L_ws18:
s_movk_i32 s64, 4096
buffer_load_dwordx4 v[104:107], v2, s[48:51], 0 offen offset:0 sc1
buffer_load_dwordx4 v[108:111], v2, s[48:51], 0 offen offset:1024 sc1
buffer_load_dwordx4 v[112:115], v2, s[48:51], 0 offen offset:2048 sc1
buffer_load_dwordx4 v[116:119], v2, s[48:51], 0 offen offset:3072 sc1
buffer_load_dwordx4 v[120:123], v2, s[48:51], s64 offen offset:0 sc1
buffer_load_dwordx4 v[124:127], v2, s[48:51], s64 offen offset:1024 sc1
buffer_load_dwordx4 v[128:131], v2, s[48:51], s64 offen offset:2048 sc1
buffer_load_dwordx4 v[132:135], v2, s[48:51], s64 offen offset:3072 sc1
L_wd19:
s_waitcnt vmcnt(8)
v_mov_b32 v190, 3
s_mov_b64 exec, 1
ds_write_b32 v185, v190
s_mov_b64 exec, -1
L_lc20:
ds_read_b128 v[186:189], v184
s_waitcnt lgkmcnt(0)
v_min3_u32 v186, v186, v187, v188
v_min_u32 v186, v186, v189
s_nop 0
v_readfirstlane_b32 s92, v186
s_nop 0
s_cmp_ge_u32 s92, 3
s_cbranch_scc1 L_lcd21
s_sleep 1
s_branch L_lc20
L_lcd21:
ds_read_b128 v[72:75], v15 offset:0
ds_read_b128 v[76:79], v15 offset:4096
ds_read_b128 v[80:83], v15 offset:8192
ds_read_b128 v[84:87], v15 offset:12288
s_cmp_eq_u32 s61, 1
s_cbranch_scc1 L_wr22
ds_read_b128 v[104:107], v19 offset:0
ds_read_b128 v[108:111], v19 offset:1024
ds_read_b128 v[112:115], v19 offset:2048
ds_read_b128 v[116:119], v19 offset:3072
ds_read_b128 v[120:123], v19 offset:4096
ds_read_b128 v[124:127], v19 offset:5120
ds_read_b128 v[128:131], v19 offset:6144
ds_read_b128 v[132:135], v19 offset:7168
L_wr22:
s_waitcnt lgkmcnt(0)
v_mov_b32 v190, 4
s_mov_b64 exec, 1
ds_write_b32 v185, v190
s_mov_b64 exec, -1
s_lshl_b32 s64, s61, 31
s_or_b32 s64, s64, s62
L_fft23:
v_xor_b32 v24, s64, v72
v_xor_b32 v25, s64, v73
v_xor_b32 v26, s64, v74
v_xor_b32 v27, s64, v75
v_xor_b32 v28, s64, v76
v_xor_b32 v29, s64, v77
v_xor_b32 v30, s64, v78
v_xor_b32 v31, s64, v79
v_xor_b32 v32, s64, v80
v_xor_b32 v33, s64, v81
v_xor_b32 v34, s64, v82
v_xor_b32 v35, s64, v83
v_xor_b32 v36, s64, v84
v_xor_b32 v37, s64, v85
v_xor_b32 v38, s64, v86
v_xor_b32 v39, s64, v87
v_mfma_f32_32x32x16_bf16 v[40:55], v[24:27], v[192:195], 0
v_mfma_f32_32x32x16_bf16 v[40:55], v[28:31], v[196:199], v[40:55]
v_mfma_f32_32x32x16_bf16 v[40:55], v[32:35], v[200:203], v[40:55]
v_mfma_f32_32x32x16_bf16 v[40:55], v[36:39], v[204:207], v[40:55]
v_mfma_f32_32x32x16_bf16 v[56:71], v[24:27], v[208:211], 0
v_mfma_f32_32x32x16_bf16 v[56:71], v[28:31], v[212:215], v[56:71]
v_mfma_f32_32x32x16_bf16 v[56:71], v[32:35], v[216:219], v[56:71]
v_mfma_f32_32x32x16_bf16 v[56:71], v[36:39], v[220:223], v[56:71]
s_cmp_eq_u32 s61, 2
s_cbranch_scc1 L_once25
s_waitcnt vmcnt(0)
v_lshlrev_b32 v176, 16, v104
v_and_b32 v177, 0xffff0000, v104
v_lshlrev_b32 v178, 16, v105
v_and_b32 v179, 0xffff0000, v105
v_add_f32 v180, v176, v178
v_add_f32 v181, v177, v179
v_sub_f32 v176, v176, v178
v_sub_f32 v177, v177, v179
v_mul_f32 v104, v136, v176
v_mul_f32 v105, v136, v177
v_fma_f32 v136, v152, v176, v180
v_fma_f32 v152, v152, v177, v181
v_lshlrev_b32 v176, 16, v106
v_and_b32 v177, 0xffff0000, v106
v_lshlrev_b32 v178, 16, v107
v_and_b32 v179, 0xffff0000, v107
v_add_f32 v180, v176, v178
v_add_f32 v181, v177, v179
v_sub_f32 v176, v176, v178
v_sub_f32 v177, v177, v179
v_mul_f32 v106, v137, v176
v_mul_f32 v107, v137, v177
v_fma_f32 v137, v153, v176, v180
v_fma_f32 v153, v153, v177, v181
v_lshlrev_b32 v176, 16, v108
v_and_b32 v177, 0xffff0000, v108
v_lshlrev_b32 v178, 16, v109
v_and_b32 v179, 0xffff0000, v109
v_add_f32 v180, v176, v178
v_add_f32 v181, v177, v179
v_sub_f32 v176, v176, v178
v_sub_f32 v177, v177, v179
v_mul_f32 v108, v138, v176
v_mul_f32 v109, v138, v177
v_fma_f32 v138, v154, v176, v180
v_fma_f32 v154, v154, v177, v181
v_lshlrev_b32 v176, 16, v110
v_and_b32 v177, 0xffff0000, v110
v_lshlrev_b32 v178, 16, v111
v_and_b32 v179, 0xffff0000, v111
v_add_f32 v180, v176, v178
v_add_f32 v181, v177, v179
v_sub_f32 v176, v176, v178
v_sub_f32 v177, v177, v179
v_mul_f32 v110, v139, v176
v_mul_f32 v111, v139, v177
v_fma_f32 v139, v155, v176, v180
v_fma_f32 v155, v155, v177, v181
v_lshlrev_b32 v176, 16, v112
v_and_b32 v177, 0xffff0000, v112
v_lshlrev_b32 v178, 16, v113
v_and_b32 v179, 0xffff0000, v113
v_add_f32 v180, v176, v178
v_add_f32 v181, v177, v179
v_sub_f32 v176, v176, v178
v_sub_f32 v177, v177, v179
v_mul_f32 v112, v140, v176
v_mul_f32 v113, v140, v177
v_fma_f32 v140, v156, v176, v180
v_fma_f32 v156, v156, v177, v181
v_lshlrev_b32 v176, 16, v114
v_and_b32 v177, 0xffff0000, v114
v_lshlrev_b32 v178, 16, v115
v_and_b32 v179, 0xffff0000, v115
v_add_f32 v180, v176, v178
v_add_f32 v181, v177, v179
v_sub_f32 v176, v176, v178
v_sub_f32 v177, v177, v179
v_mul_f32 v114, v141, v176
v_mul_f32 v115, v141, v177
v_fma_f32 v141, v157, v176, v180
v_fma_f32 v157, v157, v177, v181
L_once25:
s_nop 5
v_mul_f32 v168, v40, v224
v_mul_f32 v169, v40, v240
s_nop 1
v_fma_f32 v168, -v56, v240, v168
v_fmac_f32 v169, v56, v224
v_cvt_pk_bf16_f32 v24, v168, v169
v_mul_f32 v170, v41, v225
v_mul_f32 v171, v41, v241
v_fma_f32 v170, -v57, v241, v170
v_fmac_f32 v171, v57, v225
v_cvt_pk_bf16_f32 v25, v170, v171
v_mul_f32 v172, v42, v226
v_mul_f32 v173, v42, v242
v_fma_f32 v172, -v58, v242, v172
v_fmac_f32 v173, v58, v226
v_cvt_pk_bf16_f32 v26, v172, v173
v_mul_f32 v174, v43, v227
v_mul_f32 v175, v43, v243
v_fma_f32 v174, -v59, v243, v174
v_fmac_f32 v175, v59, v227
v_cvt_pk_bf16_f32 v27, v174, v175
v_mul_f32 v168, v44, v228
v_mul_f32 v169, v44, v244
v_fma_f32 v168, -v60, v244, v168
v_fmac_f32 v169, v60, v228
v_cvt_pk_bf16_f32 v28, v168, v169
v_mul_f32 v170, v45, v229
v_mul_f32 v171, v45, v245
v_fma_f32 v170, -v61, v245, v170
v_fmac_f32 v171, v61, v229
v_cvt_pk_bf16_f32 v29, v170, v171
v_mul_f32 v172, v46, v230
v_mul_f32 v173, v46, v246
v_fma_f32 v172, -v62, v246, v172
v_fmac_f32 v173, v62, v230
v_cvt_pk_bf16_f32 v30, v172, v173
v_mul_f32 v174, v47, v231
v_mul_f32 v175, v47, v247
v_fma_f32 v174, -v63, v247, v174
v_fmac_f32 v175, v63, v231
v_cvt_pk_bf16_f32 v31, v174, v175
v_mul_f32 v168, v48, v232
v_mul_f32 v169, v48, v248
v_fma_f32 v168, -v64, v248, v168
v_fmac_f32 v169, v64, v232
v_cvt_pk_bf16_f32 v32, v168, v169
v_mul_f32 v170, v49, v233
v_mul_f32 v171, v49, v249
v_fma_f32 v170, -v65, v249, v170
v_fmac_f32 v171, v65, v233
v_cvt_pk_bf16_f32 v33, v170, v171
v_mul_f32 v172, v50, v234
v_mul_f32 v173, v50, v250
v_fma_f32 v172, -v66, v250, v172
v_fmac_f32 v173, v66, v234
v_cvt_pk_bf16_f32 v34, v172, v173
v_mul_f32 v174, v51, v235
v_mul_f32 v175, v51, v251
v_fma_f32 v174, -v67, v251, v174
v_fmac_f32 v175, v67, v235
v_cvt_pk_bf16_f32 v35, v174, v175
v_mul_f32 v168, v52, v236
v_mul_f32 v169, v52, v252
v_fma_f32 v168, -v68, v252, v168
v_fmac_f32 v169, v68, v236
v_cvt_pk_bf16_f32 v36, v168, v169
v_mul_f32 v170, v53, v237
v_mul_f32 v171, v53, v253
v_fma_f32 v170, -v69, v253, v170
v_fmac_f32 v171, v69, v237
v_cvt_pk_bf16_f32 v37, v170, v171
v_mul_f32 v172, v54, v238
v_mul_f32 v173, v54, v254
v_fma_f32 v172, -v70, v254, v172
v_fmac_f32 v173, v70, v238
v_cvt_pk_bf16_f32 v38, v172, v173
v_mul_f32 v174, v55, v239
v_mul_f32 v175, v55, v255
v_fma_f32 v174, -v71, v255, v174
v_fmac_f32 v175, v71, v239
v_cvt_pk_bf16_f32 v39, v174, v175
v_mfma_f32_32x32x16_bf16 v[40:55], v[192:195], v[24:27], 0
v_mfma_f32_32x32x16_bf16 v[40:55], v[196:199], v[28:31], v[40:55]
v_mfma_f32_32x32x16_bf16 v[40:55], v[200:203], v[32:35], v[40:55]
v_mfma_f32_32x32x16_bf16 v[40:55], v[204:207], v[36:39], v[40:55]
v_mfma_f32_32x32x16_bf16 v[56:71], v[208:211], v[24:27], 0
v_mfma_f32_32x32x16_bf16 v[56:71], v[212:215], v[28:31], v[56:71]
v_mfma_f32_32x32x16_bf16 v[56:71], v[216:219], v[32:35], v[56:71]
v_mfma_f32_32x32x16_bf16 v[56:71], v[220:223], v[36:39], v[56:71]
s_cmp_eq_u32 s61, 2
s_cbranch_scc1 L_once26
s_waitcnt vmcnt(0)
v_lshlrev_b32 v176, 16, v116
v_and_b32 v177, 0xffff0000, v116
v_lshlrev_b32 v178, 16, v117
v_and_b32 v179, 0xffff0000, v117
v_add_f32 v180, v176, v178
v_add_f32 v181, v177, v179
v_sub_f32 v176, v176, v178
v_sub_f32 v177, v177, v179
v_mul_f32 v116, v142, v176
v_mul_f32 v117, v142, v177
v_fma_f32 v142, v158, v176, v180
v_fma_f32 v158, v158, v177, v181
v_lshlrev_b32 v176, 16, v118
v_and_b32 v177, 0xffff0000, v118
v_lshlrev_b32 v178, 16, v119
v_and_b32 v179, 0xffff0000, v119
v_add_f32 v180, v176, v178
v_add_f32 v181, v177, v179
v_sub_f32 v176, v176, v178
v_sub_f32 v177, v177, v179
v_mul_f32 v118, v143, v176
v_mul_f32 v119, v143, v177
v_fma_f32 v143, v159, v176, v180
v_fma_f32 v159, v159, v177, v181
v_lshlrev_b32 v176, 16, v120
v_and_b32 v177, 0xffff0000, v120
v_lshlrev_b32 v178, 16, v121
v_and_b32 v179, 0xffff0000, v121
v_add_f32 v180, v176, v178
v_add_f32 v181, v177, v179
v_sub_f32 v176, v176, v178
v_sub_f32 v177, v177, v179
v_mul_f32 v120, v144, v176
v_mul_f32 v121, v144, v177
v_fma_f32 v144, v160, v176, v180
v_fma_f32 v160, v160, v177, v181
v_lshlrev_b32 v176, 16, v122
v_and_b32 v177, 0xffff0000, v122
v_lshlrev_b32 v178, 16, v123
v_and_b32 v179, 0xffff0000, v123
v_add_f32 v180, v176, v178
v_add_f32 v181, v177, v179
v_sub_f32 v176, v176, v178
v_sub_f32 v177, v177, v179
v_mul_f32 v122, v145, v176
v_mul_f32 v123, v145, v177
v_fma_f32 v145, v161, v176, v180
v_fma_f32 v161, v161, v177, v181
v_lshlrev_b32 v176, 16, v124
v_and_b32 v177, 0xffff0000, v124
v_lshlrev_b32 v178, 16, v125
v_and_b32 v179, 0xffff0000, v125
v_add_f32 v180, v176, v178
v_add_f32 v181, v177, v179
v_sub_f32 v176, v176, v178
v_sub_f32 v177, v177, v179
v_mul_f32 v124, v146, v176
v_mul_f32 v125, v146, v177
v_fma_f32 v146, v162, v176, v180
v_fma_f32 v162, v162, v177, v181
v_lshlrev_b32 v176, 16, v126
v_and_b32 v177, 0xffff0000, v126
v_lshlrev_b32 v178, 16, v127
v_and_b32 v179, 0xffff0000, v127
v_add_f32 v180, v176, v178
v_add_f32 v181, v177, v179
v_sub_f32 v176, v176, v178
v_sub_f32 v177, v177, v179
v_mul_f32 v126, v147, v176
v_mul_f32 v127, v147, v177
v_fma_f32 v147, v163, v176, v180
v_fma_f32 v163, v163, v177, v181
L_once26:
L_lc27:
ds_read_b128 v[186:189], v184
s_waitcnt lgkmcnt(0)
v_min3_u32 v186, v186, v187, v188
v_min_u32 v186, v186, v189
s_nop 0
v_readfirstlane_b32 s92, v186
s_nop 0
s_cmp_ge_u32 s92, 4
s_cbranch_scc1 L_lcd28
s_sleep 1
s_branch L_lc27
L_lcd28:
s_cmp_eq_u32 s61, 2
s_cbranch_scc1 L_nwr24
ds_write_b128 v16, v[40:43] offset:0
ds_write_b128 v16, v[44:47] offset:1024
ds_write_b128 v16, v[48:51] offset:2048
ds_write_b128 v16, v[52:55] offset:3072
ds_write_b128 v16, v[56:59] offset:4096
ds_write_b128 v16, v[60:63] offset:5120
ds_write_b128 v16, v[64:67] offset:6144
ds_write_b128 v16, v[68:71] offset:7168
s_cmp_eq_u32 s61, 0
s_cbranch_scc1 L_nwr24
s_mov_b32 s61, 2
s_mov_b32 s64, 0
s_branch L_fft23
L_nwr24:
v_lshlrev_b32 v176, 16, v128
v_and_b32 v177, 0xffff0000, v128
v_lshlrev_b32 v178, 16, v129
v_and_b32 v179, 0xffff0000, v129
v_add_f32 v180, v176, v178
v_add_f32 v181, v177, v179
v_sub_f32 v176, v176, v178
v_sub_f32 v177, v177, v179
v_mul_f32 v128, v148, v176
v_mul_f32 v129, v148, v177
v_fma_f32 v148, v164, v176, v180
v_fma_f32 v164, v164, v177, v181
v_lshlrev_b32 v176, 16, v130
v_and_b32 v177, 0xffff0000, v130
v_lshlrev_b32 v178, 16, v131
v_and_b32 v179, 0xffff0000, v131
v_add_f32 v180, v176, v178
v_add_f32 v181, v177, v179
v_sub_f32 v176, v176, v178
v_sub_f32 v177, v177, v179
v_mul_f32 v130, v149, v176
v_mul_f32 v131, v149, v177
v_fma_f32 v149, v165, v176, v180
v_fma_f32 v165, v165, v177, v181
s_waitcnt lgkmcnt(0)
v_mov_b32 v190, 5
s_mov_b64 exec, 1
ds_write_b32 v185, v190
s_mov_b64 exec, -1
v_lshlrev_b32 v176, 16, v132
v_and_b32 v177, 0xffff0000, v132
v_lshlrev_b32 v178, 16, v133
v_and_b32 v179, 0xffff0000, v133
v_add_f32 v180, v176, v178
v_add_f32 v181, v177, v179
v_sub_f32 v176, v176, v178
v_sub_f32 v177, v177, v179
v_mul_f32 v132, v150, v176
v_mul_f32 v133, v150, v177
v_fma_f32 v150, v166, v176, v180
v_fma_f32 v166, v166, v177, v181
v_lshlrev_b32 v176, 16, v134
v_and_b32 v177, 0xffff0000, v134
v_lshlrev_b32 v178, 16, v135
v_and_b32 v179, 0xffff0000, v135
v_add_f32 v180, v176, v178
v_add_f32 v181, v177, v179
v_sub_f32 v176, v176, v178
v_sub_f32 v177, v177, v179
v_mul_f32 v134, v151, v176
v_mul_f32 v135, v151, v177
v_fma_f32 v151, v167, v176, v180
v_fma_f32 v167, v167, v177, v181
v_mul_f32 v168, v152, v56
v_mul_f32 v56, v136, v56
v_fmac_f32 v56, v152, v40
v_fma_f32 v40, v136, v40, -v168
v_mul_f32 v169, v153, v57
v_mul_f32 v57, v137, v57
v_fmac_f32 v57, v153, v41
v_fma_f32 v41, v137, v41, -v169
v_mul_f32 v168, v154, v58
v_mul_f32 v58, v138, v58
v_fmac_f32 v58, v154, v42
v_fma_f32 v42, v138, v42, -v168
v_mul_f32 v169, v155, v59
v_mul_f32 v59, v139, v59
v_fmac_f32 v59, v155, v43
v_fma_f32 v43, v139, v43, -v169
v_mul_f32 v168, v156, v60
v_mul_f32 v60, v140, v60
v_fmac_f32 v60, v156, v44
v_fma_f32 v44, v140, v44, -v168
v_mul_f32 v169, v157, v61
v_mul_f32 v61, v141, v61
v_fmac_f32 v61, v157, v45
v_fma_f32 v45, v141, v45, -v169
L_lc29:
ds_read_b128 v[186:189], v184
s_waitcnt lgkmcnt(0)
v_min3_u32 v186, v186, v187, v188
v_min_u32 v186, v186, v189
s_nop 0
v_readfirstlane_b32 s92, v186
s_nop 0
s_cmp_ge_u32 s92, 5
s_cbranch_scc1 L_lcd30
s_sleep 1
s_branch L_lc29
L_lcd30:
ds_read_b128 v[72:75], v17 offset:0
ds_read_b128 v[76:79], v17 offset:1024
ds_read_b128 v[80:83], v17 offset:2048
ds_read_b128 v[84:87], v17 offset:3072
ds_read_b128 v[88:91], v17 offset:4096
ds_read_b128 v[92:95], v17 offset:5120
ds_read_b128 v[96:99], v17 offset:6144
ds_read_b128 v[100:103], v17 offset:7168
v_mul_f32 v168, v158, v62
v_mul_f32 v62, v142, v62
v_fmac_f32 v62, v158, v46
v_fma_f32 v46, v142, v46, -v168
v_mul_f32 v169, v159, v63
v_mul_f32 v63, v143, v63
v_fmac_f32 v63, v159, v47
v_fma_f32 v47, v143, v47, -v169
v_mul_f32 v168, v160, v64
v_mul_f32 v64, v144, v64
v_fmac_f32 v64, v160, v48
v_fma_f32 v48, v144, v48, -v168
v_mul_f32 v169, v161, v65
v_mul_f32 v65, v145, v65
v_fmac_f32 v65, v161, v49
v_fma_f32 v49, v145, v49, -v169
v_mul_f32 v168, v162, v66
v_mul_f32 v66, v146, v66
v_fmac_f32 v66, v162, v50
v_fma_f32 v50, v146, v50, -v168
v_mul_f32 v169, v163, v67
v_mul_f32 v67, v147, v67
v_fmac_f32 v67, v163, v51
v_fma_f32 v51, v147, v51, -v169
v_mul_f32 v168, v164, v68
v_mul_f32 v68, v148, v68
v_fmac_f32 v68, v164, v52
v_fma_f32 v52, v148, v52, -v168
v_mul_f32 v169, v165, v69
v_mul_f32 v69, v149, v69
v_fmac_f32 v69, v165, v53
v_fma_f32 v53, v149, v53, -v169
v_mul_f32 v168, v166, v70
v_mul_f32 v70, v150, v70
v_fmac_f32 v70, v166, v54
v_fma_f32 v54, v150, v54, -v168
v_mul_f32 v169, v167, v71
v_mul_f32 v71, v151, v71
v_fmac_f32 v71, v167, v55
v_fma_f32 v55, v151, v55, -v169
s_waitcnt lgkmcnt(0)
v_mov_b32 v190, 6
s_mov_b64 exec, 1
ds_write_b32 v185, v190
s_mov_b64 exec, -1
v_fma_f32 v40, -v104, v88, v40
v_fmac_f32 v56, v104, v72
v_fma_f32 v40, -v105, v72, v40
v_fma_f32 v56, -v105, v88, v56
v_cvt_pk_bf16_f32 v24, v56, v40
v_fma_f32 v41, -v106, v89, v41
v_fmac_f32 v57, v106, v73
v_fma_f32 v41, -v107, v73, v41
v_fma_f32 v57, -v107, v89, v57
v_cvt_pk_bf16_f32 v25, v57, v41
v_fma_f32 v42, -v108, v90, v42
v_fmac_f32 v58, v108, v74
v_fma_f32 v42, -v109, v74, v42
v_fma_f32 v58, -v109, v90, v58
v_cvt_pk_bf16_f32 v26, v58, v42
v_fma_f32 v43, -v110, v91, v43
v_fmac_f32 v59, v110, v75
v_fma_f32 v43, -v111, v75, v43
v_fma_f32 v59, -v111, v91, v59
v_cvt_pk_bf16_f32 v27, v59, v43
v_fma_f32 v44, -v112, v92, v44
v_fmac_f32 v60, v112, v76
v_fma_f32 v44, -v113, v76, v44
v_fma_f32 v60, -v113, v92, v60
v_cvt_pk_bf16_f32 v28, v60, v44
v_fma_f32 v45, -v114, v93, v45
v_fmac_f32 v61, v114, v77
v_fma_f32 v45, -v115, v77, v45
v_fma_f32 v61, -v115, v93, v61
v_cvt_pk_bf16_f32 v29, v61, v45
v_fma_f32 v46, -v116, v94, v46
v_fmac_f32 v62, v116, v78
v_fma_f32 v46, -v117, v78, v46
v_fma_f32 v62, -v117, v94, v62
v_cvt_pk_bf16_f32 v30, v62, v46
v_fma_f32 v47, -v118, v95, v47
v_fmac_f32 v63, v118, v79
v_fma_f32 v47, -v119, v79, v47
v_fma_f32 v63, -v119, v95, v63
v_cvt_pk_bf16_f32 v31, v63, v47
v_fma_f32 v48, -v120, v96, v48
v_fmac_f32 v64, v120, v80
v_fma_f32 v48, -v121, v80, v48
v_fma_f32 v64, -v121, v96, v64
v_cvt_pk_bf16_f32 v32, v64, v48
v_fma_f32 v49, -v122, v97, v49
v_fmac_f32 v65, v122, v81
v_fma_f32 v49, -v123, v81, v49
v_fma_f32 v65, -v123, v97, v65
v_cvt_pk_bf16_f32 v33, v65, v49
v_fma_f32 v50, -v124, v98, v50
v_fmac_f32 v66, v124, v82
v_fma_f32 v50, -v125, v82, v50
v_fma_f32 v66, -v125, v98, v66
v_cvt_pk_bf16_f32 v34, v66, v50
v_fma_f32 v51, -v126, v99, v51
v_fmac_f32 v67, v126, v83
v_fma_f32 v51, -v127, v83, v51
v_fma_f32 v67, -v127, v99, v67
v_cvt_pk_bf16_f32 v35, v67, v51
v_fma_f32 v52, -v128, v100, v52
v_fmac_f32 v68, v128, v84
v_fma_f32 v52, -v129, v84, v52
v_fma_f32 v68, -v129, v100, v68
v_cvt_pk_bf16_f32 v36, v68, v52
v_fma_f32 v53, -v130, v101, v53
v_fmac_f32 v69, v130, v85
v_fma_f32 v53, -v131, v85, v53
v_fma_f32 v69, -v131, v101, v69
v_cvt_pk_bf16_f32 v37, v69, v53
v_fma_f32 v54, -v132, v102, v54
v_fmac_f32 v70, v132, v86
v_fma_f32 v54, -v133, v86, v54
v_fma_f32 v70, -v133, v102, v70
v_cvt_pk_bf16_f32 v38, v70, v54
v_fma_f32 v55, -v134, v103, v55
v_fmac_f32 v71, v134, v87
v_fma_f32 v55, -v135, v87, v55
v_fma_f32 v71, -v135, v103, v71
v_cvt_pk_bf16_f32 v39, v71, v55
v_mfma_f32_32x32x16_bf16 v[40:55], v[24:27], v[192:195], 0
v_mfma_f32_32x32x16_bf16 v[40:55], v[28:31], v[196:199], v[40:55]
v_mfma_f32_32x32x16_bf16 v[40:55], v[32:35], v[200:203], v[40:55]
v_mfma_f32_32x32x16_bf16 v[40:55], v[36:39], v[204:207], v[40:55]
v_mfma_f32_32x32x16_bf16 v[56:71], v[24:27], v[208:211], 0
v_mfma_f32_32x32x16_bf16 v[56:71], v[28:31], v[212:215], v[56:71]
v_mfma_f32_32x32x16_bf16 v[56:71], v[32:35], v[216:219], v[56:71]
v_mfma_f32_32x32x16_bf16 v[56:71], v[36:39], v[220:223], v[56:71]
s_nop 7
v_mul_f32 v168, v40, v224
v_mul_f32 v169, v40, v240
s_nop 1
v_fma_f32 v168, -v56, v240, v168
v_fmac_f32 v169, v56, v224
v_cvt_pk_bf16_f32 v24, v168, v169
v_mul_f32 v170, v41, v225
v_mul_f32 v171, v41, v241
v_fma_f32 v170, -v57, v241, v170
v_fmac_f32 v171, v57, v225
v_cvt_pk_bf16_f32 v25, v170, v171
v_mul_f32 v172, v42, v226
v_mul_f32 v173, v42, v242
v_fma_f32 v172, -v58, v242, v172
v_fmac_f32 v173, v58, v226
v_cvt_pk_bf16_f32 v26, v172, v173
v_mul_f32 v174, v43, v227
v_mul_f32 v175, v43, v243
v_fma_f32 v174, -v59, v243, v174
v_fmac_f32 v175, v59, v227
v_cvt_pk_bf16_f32 v27, v174, v175
v_mul_f32 v168, v44, v228
v_mul_f32 v169, v44, v244
v_fma_f32 v168, -v60, v244, v168
v_fmac_f32 v169, v60, v228
v_cvt_pk_bf16_f32 v28, v168, v169
v_mul_f32 v170, v45, v229
v_mul_f32 v171, v45, v245
v_fma_f32 v170, -v61, v245, v170
v_fmac_f32 v171, v61, v229
v_cvt_pk_bf16_f32 v29, v170, v171
v_mul_f32 v172, v46, v230
v_mul_f32 v173, v46, v246
v_fma_f32 v172, -v62, v246, v172
v_fmac_f32 v173, v62, v230
v_cvt_pk_bf16_f32 v30, v172, v173
v_mul_f32 v174, v47, v231
v_mul_f32 v175, v47, v247
v_fma_f32 v174, -v63, v247, v174
v_fmac_f32 v175, v63, v231
v_cvt_pk_bf16_f32 v31, v174, v175
v_mul_f32 v168, v48, v232
v_mul_f32 v169, v48, v248
v_fma_f32 v168, -v64, v248, v168
v_fmac_f32 v169, v64, v232
v_cvt_pk_bf16_f32 v32, v168, v169
v_mul_f32 v170, v49, v233
v_mul_f32 v171, v49, v249
v_fma_f32 v170, -v65, v249, v170
v_fmac_f32 v171, v65, v233
v_cvt_pk_bf16_f32 v33, v170, v171
v_mul_f32 v172, v50, v234
v_mul_f32 v173, v50, v250
v_fma_f32 v172, -v66, v250, v172
v_fmac_f32 v173, v66, v234
v_cvt_pk_bf16_f32 v34, v172, v173
v_mul_f32 v174, v51, v235
v_mul_f32 v175, v51, v251
v_fma_f32 v174, -v67, v251, v174
v_fmac_f32 v175, v67, v235
v_cvt_pk_bf16_f32 v35, v174, v175
v_mul_f32 v168, v52, v236
v_mul_f32 v169, v52, v252
v_fma_f32 v168, -v68, v252, v168
v_fmac_f32 v169, v68, v236
v_cvt_pk_bf16_f32 v36, v168, v169
v_mul_f32 v170, v53, v237
v_mul_f32 v171, v53, v253
v_fma_f32 v170, -v69, v253, v170
v_fmac_f32 v171, v69, v237
v_cvt_pk_bf16_f32 v37, v170, v171
v_mul_f32 v172, v54, v238
v_mul_f32 v173, v54, v254
v_fma_f32 v172, -v70, v254, v172
v_fmac_f32 v173, v70, v238
v_cvt_pk_bf16_f32 v38, v172, v173
v_mul_f32 v174, v55, v239
v_mul_f32 v175, v55, v255
v_fma_f32 v174, -v71, v255, v174
v_fmac_f32 v175, v71, v239
v_cvt_pk_bf16_f32 v39, v174, v175
v_mfma_f32_32x32x16_bf16 v[40:55], v[192:195], v[24:27], 0
v_mfma_f32_32x32x16_bf16 v[40:55], v[196:199], v[28:31], v[40:55]
v_mfma_f32_32x32x16_bf16 v[40:55], v[200:203], v[32:35], v[40:55]
v_mfma_f32_32x32x16_bf16 v[40:55], v[204:207], v[36:39], v[40:55]
v_mfma_f32_32x32x16_bf16 v[56:71], v[208:211], v[24:27], 0
v_mfma_f32_32x32x16_bf16 v[56:71], v[212:215], v[28:31], v[56:71]
v_mfma_f32_32x32x16_bf16 v[56:71], v[216:219], v[32:35], v[56:71]
v_mfma_f32_32x32x16_bf16 v[56:71], v[220:223], v[36:39], v[56:71]
s_lshr_b32 s64, s62, 16
L_lc31:
ds_read_b128 v[186:189], v184
s_waitcnt lgkmcnt(0)
v_min3_u32 v186, v186, v187, v188
v_min_u32 v186, v186, v189
s_nop 0
v_readfirstlane_b32 s92, v186
s_nop 0
s_cmp_ge_u32 s92, 6
s_cbranch_scc1 L_lcd32
s_sleep 1
s_branch L_lc31
L_lcd32:
s_nop 1
v_cvt_pk_bf16_f32 v24, v40, v56
v_xor_b32 v24, s64, v24
v_cvt_pk_bf16_f32 v25, v41, v57
v_xor_b32 v25, s64, v25
v_cvt_pk_bf16_f32 v26, v42, v58
v_xor_b32 v26, s64, v26
v_cvt_pk_bf16_f32 v27, v43, v59
v_xor_b32 v27, s64, v27
ds_write_b128 v15, v[24:27] offset:0
v_cvt_pk_bf16_f32 v28, v44, v60
v_xor_b32 v28, s64, v28
v_cvt_pk_bf16_f32 v29, v45, v61
v_xor_b32 v29, s64, v29
v_cvt_pk_bf16_f32 v30, v46, v62
v_xor_b32 v30, s64, v30
v_cvt_pk_bf16_f32 v31, v47, v63
v_xor_b32 v31, s64, v31
ds_write_b128 v15, v[28:31] offset:4096
v_cvt_pk_bf16_f32 v32, v48, v64
v_xor_b32 v32, s64, v32
v_cvt_pk_bf16_f32 v33, v49, v65
v_xor_b32 v33, s64, v33
v_cvt_pk_bf16_f32 v34, v50, v66
v_xor_b32 v34, s64, v34
v_cvt_pk_bf16_f32 v35, v51, v67
v_xor_b32 v35, s64, v35
ds_write_b128 v15, v[32:35] offset:8192
v_cvt_pk_bf16_f32 v36, v52, v68
v_xor_b32 v36, s64, v36
v_cvt_pk_bf16_f32 v37, v53, v69
v_xor_b32 v37, s64, v37
v_cvt_pk_bf16_f32 v38, v54, v70
v_xor_b32 v38, s64, v38
v_cvt_pk_bf16_f32 v39, v55, v71
v_xor_b32 v39, s64, v39
ds_write_b128 v15, v[36:39] offset:12288
s_waitcnt lgkmcnt(0)
v_mov_b32 v190, 7
s_mov_b64 exec, 1
ds_write_b32 v185, v190
s_mov_b64 exec, -1
L_lc33:
ds_read_b128 v[186:189], v184
s_waitcnt lgkmcnt(0)
v_min3_u32 v186, v186, v187, v188
v_min_u32 v186, v186, v189
s_nop 0
v_readfirstlane_b32 s92, v186
s_nop 0
s_cmp_ge_u32 s92, 7
s_cbranch_scc1 L_lcd34
s_sleep 1
s_branch L_lc33
L_lcd34:
ds_read_b128 v[24:27], v18 offset:0
ds_read_b128 v[28:31], v18 offset:1024
ds_read_b128 v[32:35], v18 offset:2048
ds_read_b128 v[36:39], v18 offset:3072
s_mov_b32 s64, 0
s_waitcnt lgkmcnt(3)
buffer_store_dwordx4 v[24:27], v14, s[52:55], s64 offen sc1
s_mov_b32 s64, 262144
s_waitcnt lgkmcnt(2)
buffer_store_dwordx4 v[28:31], v14, s[52:55], s64 offen sc1
s_mov_b32 s64, 524288
s_waitcnt lgkmcnt(1)
buffer_store_dwordx4 v[32:35], v14, s[52:55], s64 offen sc1
s_mov_b32 s64, 786432
s_waitcnt lgkmcnt(0)
buffer_store_dwordx4 v[36:39], v14, s[52:55], s64 offen sc1
s_lshl_b32 s64, s67, 14
s_add_u32 s40, s28, s64
s_addc_u32 s41, s29, 0
s_mov_b32 s42, 16384
s_mov_b32 s43, 0x20000
v_and_b32 v8, 31, v1
v_lshrrev_b32 v9, 5, v1
v_lshlrev_b32 v14, 2, v8
v_lshl_add_u32 v14, v9, 9, v14
s_mov_b32 s64, 0x35000000
v_mul_f32 v224, s64, v224
v_mul_f32 v225, s64, v225
v_mul_f32 v226, s64, v226
v_mul_f32 v227, s64, v227
v_mul_f32 v228, s64, v228
v_mul_f32 v229, s64, v229
v_mul_f32 v230, s64, v230
v_mul_f32 v231, s64, v231
v_mul_f32 v232, s64, v232
v_mul_f32 v233, s64, v233
v_mul_f32 v234, s64, v234
v_mul_f32 v235, s64, v235
v_mul_f32 v236, s64, v236
v_mul_f32 v237, s64, v237
v_mul_f32 v238, s64, v238
v_mul_f32 v239, s64, v239
v_mul_f32 v240, s64, v240
v_mul_f32 v241, s64, v241
v_mul_f32 v242, s64, v242
v_mul_f32 v243, s64, v243
v_mul_f32 v244, s64, v244
v_mul_f32 v245, s64, v245
v_mul_f32 v246, s64, v246
v_mul_f32 v247, s64, v247
v_mul_f32 v248, s64, v248
v_mul_f32 v249, s64, v249
v_mul_f32 v250, s64, v250
v_mul_f32 v251, s64, v251
v_mul_f32 v252, s64, v252
v_mul_f32 v253, s64, v253
v_mul_f32 v254, s64, v254
v_mul_f32 v255, s64, v255
s_waitcnt vmcnt(0)
v_mov_b32 v190, 8
s_mov_b64 exec, 1
ds_write_b32 v185, v190
s_mov_b64 exec, -1
s_cmp_lg_u32 s66, 0
s_cbranch_scc1 L_ph35
L_lc36:
ds_read_b128 v[186:189], v184
s_waitcnt lgkmcnt(0)
v_min3_u32 v186, v186, v187, v188
v_min_u32 v186, v186, v189
s_nop 0
v_readfirstlane_b32 s92, v186
s_nop 0
s_cmp_ge_u32 s92, 8
s_cbranch_scc1 L_lcd37
s_sleep 1
s_branch L_lc36
L_lcd37:
s_and_b32 s64, s2, 15
s_lshl_b32 s65, s64, 7
s_add_u32 s65, s65, 6144
s_add_u32 s90, s32, s65
s_addc_u32 s91, s33, 0
s_mov_b32 s18, 1
s_atomic_add s18, s[90:91], 0x0 glc
L_ph35:
s_cmp_lg_u32 s66, 0
s_cbranch_scc1 L_sg38
s_and_b32 s64, s2, 15
s_lshl_b32 s64, s64, 2
s_add_u32 s64, s64, 548864
s_add_u32 s4, s32, s64
s_addc_u32 s5, s33, 0
s_waitcnt lgkmcnt(0)
s_cmp_lg_u32 s18, 15
s_cbranch_scc1 L_sg38
s_atomic_swap s37, s[4:5], 0x0
s_atomic_swap s37, s[4:5], 0x80
s_atomic_swap s37, s[4:5], 0x100
s_atomic_swap s37, s[4:5], 0x180
s_atomic_swap s37, s[4:5], 0x200
s_atomic_swap s37, s[4:5], 0x280
s_atomic_swap s37, s[4:5], 0x300
s_atomic_swap s37, s[4:5], 0x380
s_atomic_swap s37, s[4:5], 0x400
s_atomic_swap s37, s[4:5], 0x480
s_atomic_swap s37, s[4:5], 0x500
s_atomic_swap s37, s[4:5], 0x580
s_atomic_swap s37, s[4:5], 0x600
s_atomic_swap s37, s[4:5], 0x680
s_atomic_swap s37, s[4:5], 0x700
s_atomic_swap s37, s[4:5], 0x780
s_atomic_swap s37, s[4:5], 0x800
s_atomic_swap s37, s[4:5], 0x880
s_atomic_swap s37, s[4:5], 0x900
s_atomic_swap s37, s[4:5], 0x980
s_atomic_swap s37, s[4:5], 0xa00
s_atomic_swap s37, s[4:5], 0xa80
s_atomic_swap s37, s[4:5], 0xb00
s_atomic_swap s37, s[4:5], 0xb80
s_atomic_swap s37, s[4:5], 0xc00
s_atomic_swap s37, s[4:5], 0xc80
s_atomic_swap s37, s[4:5], 0xd00
s_atomic_swap s37, s[4:5], 0xd80
s_atomic_swap s37, s[4:5], 0xe00
s_atomic_swap s37, s[4:5], 0xe80
s_atomic_swap s37, s[4:5], 0xf00
s_atomic_swap s37, s[4:5], 0xf80
s_waitcnt lgkmcnt(0)
L_sg38:
s_cmp_lg_u32 s66, 0
s_cbranch_scc1 L_ph39
s_and_b32 s64, s2, 31
s_lshl_b32 s64, s64, 7
s_add_u32 s64, s64, 548864
s_add_u32 s90, s32, s64
s_addc_u32 s91, s33, 0
s_mov_b32 s64, s37
s_mov_b32 s65, s37
s_mov_b32 s92, 0
s_branch L_sp40
L_nok41:
s_add_u32 s92, s92, 1
s_cmp_ge_u32 s92, 200000
s_cbranch_scc1 L_ph39
s_sleep 10
L_sp40:
s_load_dwordx16 s[4:19], s[90:91], 0x0 glc
s_waitcnt lgkmcnt(0)
s_cmp_eq_u64 s[4:5], s[64:65]
s_cbranch_scc0 L_nok41
s_cmp_eq_u64 s[6:7], s[64:65]
s_cbranch_scc0 L_nok41
s_cmp_eq_u64 s[8:9], s[64:65]
s_cbranch_scc0 L_nok41
s_cmp_eq_u64 s[10:11], s[64:65]
s_cbranch_scc0 L_nok41
s_cmp_eq_u64 s[12:13], s[64:65]
s_cbranch_scc0 L_nok41
s_cmp_eq_u64 s[14:15], s[64:65]
s_cbranch_scc0 L_nok41
s_cmp_eq_u64 s[16:17], s[64:65]
s_cbranch_scc0 L_nok41
s_cmp_eq_u64 s[18:19], s[64:65]
s_cbranch_scc0 L_nok41
L_ph39:
v_mov_b32 v190, 9
s_mov_b64 exec, 1
ds_write_b32 v185, v190
s_mov_b64 exec, -1
L_lc42:
ds_read_b128 v[186:189], v184
s_waitcnt lgkmcnt(0)
v_min3_u32 v186, v186, v187, v188
v_min_u32 v186, v186, v189
s_nop 0
v_readfirstlane_b32 s92, v186
s_nop 0
s_cmp_ge_u32 s92, 9
s_cbranch_scc1 L_lcd43
s_sleep 1
s_branch L_lc42
L_lcd43:
s_setprio 0
v_add_u32 v191, -16, v184
L_lc44:
ds_read_b128 v[186:189], v191
s_waitcnt lgkmcnt(0)
v_min3_u32 v186, v186, v187, v188
v_min_u32 v186, v186, v189
s_nop 0
v_readfirstlane_b32 s92, v186
s_nop 0
s_cmp_ge_u32 s92, 11
s_cbranch_scc1 L_lcd45
s_sleep 1
s_branch L_lc44
L_lcd45:
s_mov_b32 m0, s68
s_nop 0
buffer_load_dwordx4 v7, s[44:47], 0 offen offset:0 sc1 lds
buffer_load_dwordx4 v7, s[44:47], 0 offen offset:1024 sc1 lds
buffer_load_dwordx4 v7, s[44:47], 0 offen offset:2048 sc1 lds
buffer_load_dwordx4 v7, s[44:47], 0 offen offset:3072 sc1 lds
s_waitcnt vmcnt(0)
v_mov_b32 v190, 10
s_mov_b64 exec, 1
ds_write_b32 v185, v190
s_mov_b64 exec, -1
L_lc46:
ds_read_b128 v[186:189], v184
s_waitcnt lgkmcnt(0)
v_min3_u32 v186, v186, v187, v188
v_min_u32 v186, v186, v189
s_nop 0
v_readfirstlane_b32 s92, v186
s_nop 0
s_cmp_ge_u32 s92, 10
s_cbranch_scc1 L_lcd47
s_sleep 1
s_branch L_lc46
L_lcd47:
ds_read_b32 v24, v4 offset:0
ds_read_b32 v25, v4 offset:1024
ds_read_b32 v26, v4 offset:2048
ds_read_b32 v27, v4 offset:3072
ds_read_b32 v28, v4 offset:8192
ds_read_b32 v29, v4 offset:9216
ds_read_b32 v30, v4 offset:10240
ds_read_b32 v31, v4 offset:11264
ds_read_b32 v32, v6 offset:0
ds_read_b32 v33, v5 offset:10240
ds_read_b32 v34, v5 offset:9216
ds_read_b32 v35, v5 offset:8192
ds_read_b32 v36, v5 offset:3072
ds_read_b32 v37, v5 offset:2048
ds_read_b32 v38, v5 offset:1024
ds_read_b32 v39, v5 offset:0
s_waitcnt lgkmcnt(0)
v_mfma_f32_32x32x16_bf16 v[40:55], v[24:27], v[192:195], 0
v_mfma_f32_32x32x16_bf16 v[40:55], v[28:31], v[196:199], v[40:55]
v_mfma_f32_32x32x16_bf16 v[40:55], v[32:35], v[200:203], v[40:55]
v_mfma_f32_32x32x16_bf16 v[40:55], v[36:39], v[204:207], v[40:55]
v_mfma_f32_32x32x16_bf16 v[56:71], v[24:27], v[208:211], 0
v_mfma_f32_32x32x16_bf16 v[56:71], v[28:31], v[212:215], v[56:71]
v_mfma_f32_32x32x16_bf16 v[56:71], v[32:35], v[216:219], v[56:71]
v_mfma_f32_32x32x16_bf16 v[56:71], v[36:39], v[220:223], v[56:71]
s_nop 7
v_mul_f32 v168, v40, v224
v_mul_f32 v169, v40, v240
s_nop 1
v_fma_f32 v168, -v56, v240, v168
v_fmac_f32 v169, v56, v224
v_cvt_pk_bf16_f32 v24, v168, v169
v_mul_f32 v170, v41, v225
v_mul_f32 v171, v41, v241
v_fma_f32 v170, -v57, v241, v170
v_fmac_f32 v171, v57, v225
v_cvt_pk_bf16_f32 v25, v170, v171
v_mul_f32 v172, v42, v226
v_mul_f32 v173, v42, v242
v_fma_f32 v172, -v58, v242, v172
v_fmac_f32 v173, v58, v226
v_cvt_pk_bf16_f32 v26, v172, v173
v_mul_f32 v174, v43, v227
v_mul_f32 v175, v43, v243
v_fma_f32 v174, -v59, v243, v174
v_fmac_f32 v175, v59, v227
v_cvt_pk_bf16_f32 v27, v174, v175
v_mul_f32 v168, v44, v228
v_mul_f32 v169, v44, v244
v_fma_f32 v168, -v60, v244, v168
v_fmac_f32 v169, v60, v228
v_cvt_pk_bf16_f32 v28, v168, v169
v_mul_f32 v170, v45, v229
v_mul_f32 v171, v45, v245
v_fma_f32 v170, -v61, v245, v170
v_fmac_f32 v171, v61, v229
v_cvt_pk_bf16_f32 v29, v170, v171
v_mul_f32 v172, v46, v230
v_mul_f32 v173, v46, v246
v_fma_f32 v172, -v62, v246, v172
v_fmac_f32 v173, v62, v230
v_cvt_pk_bf16_f32 v30, v172, v173
v_mul_f32 v174, v47, v231
v_mul_f32 v175, v47, v247
v_fma_f32 v174, -v63, v247, v174
v_fmac_f32 v175, v63, v231
v_cvt_pk_bf16_f32 v31, v174, v175
v_mul_f32 v168, v48, v232
v_mul_f32 v169, v48, v248
v_fma_f32 v168, -v64, v248, v168
v_fmac_f32 v169, v64, v232
v_cvt_pk_bf16_f32 v32, v168, v169
v_mul_f32 v170, v49, v233
v_mul_f32 v171, v49, v249
v_fma_f32 v170, -v65, v249, v170
v_fmac_f32 v171, v65, v233
v_cvt_pk_bf16_f32 v33, v170, v171
v_mul_f32 v172, v50, v234
v_mul_f32 v173, v50, v250
v_fma_f32 v172, -v66, v250, v172
v_fmac_f32 v173, v66, v234
v_cvt_pk_bf16_f32 v34, v172, v173
v_mul_f32 v174, v51, v235
v_mul_f32 v175, v51, v251
v_fma_f32 v174, -v67, v251, v174
v_fmac_f32 v175, v67, v235
v_cvt_pk_bf16_f32 v35, v174, v175
v_mul_f32 v168, v52, v236
v_mul_f32 v169, v52, v252
v_fma_f32 v168, -v68, v252, v168
v_fmac_f32 v169, v68, v236
v_cvt_pk_bf16_f32 v36, v168, v169
v_mul_f32 v170, v53, v237
v_mul_f32 v171, v53, v253
v_fma_f32 v170, -v69, v253, v170
v_fmac_f32 v171, v69, v237
v_cvt_pk_bf16_f32 v37, v170, v171
v_mul_f32 v172, v54, v238
v_mul_f32 v173, v54, v254
v_fma_f32 v172, -v70, v254, v172
v_fmac_f32 v173, v70, v238
v_cvt_pk_bf16_f32 v38, v172, v173
v_mul_f32 v174, v55, v239
v_mul_f32 v175, v55, v255
v_fma_f32 v174, -v71, v255, v174
v_fmac_f32 v175, v71, v239
v_cvt_pk_bf16_f32 v39, v174, v175
v_mfma_f32_32x32x16_bf16 v[40:55], v[192:195], v[24:27], 0
v_mfma_f32_32x32x16_bf16 v[40:55], v[196:199], v[28:31], v[40:55]
v_mfma_f32_32x32x16_bf16 v[40:55], v[200:203], v[32:35], v[40:55]
v_mfma_f32_32x32x16_bf16 v[40:55], v[204:207], v[36:39], v[40:55]
v_mfma_f32_32x32x16_bf16 v[56:71], v[208:211], v[24:27], 0
v_mfma_f32_32x32x16_bf16 v[56:71], v[212:215], v[28:31], v[56:71]
v_mfma_f32_32x32x16_bf16 v[56:71], v[216:219], v[32:35], v[56:71]
v_mfma_f32_32x32x16_bf16 v[56:71], v[220:223], v[36:39], v[56:71]
s_movk_i32 s64, 0x2000
s_nop 10
v_cvt_pk_bf16_f32 v73, v56, v40
v_lshlrev_b32 v72, 16, v73
v_and_b32 v73, 0xffff0000, v73
buffer_store_dword v72, v14, s[40:43], 0 offen offset:0 nt
buffer_store_dword v73, v14, s[40:43], s64 offen offset:0 nt
v_cvt_pk_bf16_f32 v75, v57, v41
v_lshlrev_b32 v74, 16, v75
v_and_b32 v75, 0xffff0000, v75
buffer_store_dword v74, v14, s[40:43], 0 offen offset:128 nt
buffer_store_dword v75, v14, s[40:43], s64 offen offset:128 nt
v_cvt_pk_bf16_f32 v77, v58, v42
v_lshlrev_b32 v76, 16, v77
v_and_b32 v77, 0xffff0000, v77
buffer_store_dword v76, v14, s[40:43], 0 offen offset:256 nt
buffer_store_dword v77, v14, s[40:43], s64 offen offset:256 nt
v_cvt_pk_bf16_f32 v79, v59, v43
v_lshlrev_b32 v78, 16, v79
v_and_b32 v79, 0xffff0000, v79
buffer_store_dword v78, v14, s[40:43], 0 offen offset:384 nt
buffer_store_dword v79, v14, s[40:43], s64 offen offset:384 nt
v_cvt_pk_bf16_f32 v81, v60, v44
v_lshlrev_b32 v80, 16, v81
v_and_b32 v81, 0xffff0000, v81
buffer_store_dword v80, v14, s[40:43], 0 offen offset:1024 nt
buffer_store_dword v81, v14, s[40:43], s64 offen offset:1024 nt
v_cvt_pk_bf16_f32 v83, v61, v45
v_lshlrev_b32 v82, 16, v83
v_and_b32 v83, 0xffff0000, v83
buffer_store_dword v82, v14, s[40:43], 0 offen offset:1152 nt
buffer_store_dword v83, v14, s[40:43], s64 offen offset:1152 nt
v_cvt_pk_bf16_f32 v85, v62, v46
v_lshlrev_b32 v84, 16, v85
v_and_b32 v85, 0xffff0000, v85
buffer_store_dword v84, v14, s[40:43], 0 offen offset:1280 nt
buffer_store_dword v85, v14, s[40:43], s64 offen offset:1280 nt
v_cvt_pk_bf16_f32 v87, v63, v47
v_lshlrev_b32 v86, 16, v87
v_and_b32 v87, 0xffff0000, v87
buffer_store_dword v86, v14, s[40:43], 0 offen offset:1408 nt
buffer_store_dword v87, v14, s[40:43], s64 offen offset:1408 nt
v_cvt_pk_bf16_f32 v89, v64, v48
v_lshlrev_b32 v88, 16, v89
v_and_b32 v89, 0xffff0000, v89
buffer_store_dword v88, v14, s[40:43], 0 offen offset:2048 nt
buffer_store_dword v89, v14, s[40:43], s64 offen offset:2048 nt
v_cvt_pk_bf16_f32 v91, v65, v49
v_lshlrev_b32 v90, 16, v91
v_and_b32 v91, 0xffff0000, v91
buffer_store_dword v90, v14, s[40:43], 0 offen offset:2176 nt
buffer_store_dword v91, v14, s[40:43], s64 offen offset:2176 nt
v_cvt_pk_bf16_f32 v93, v66, v50
v_lshlrev_b32 v92, 16, v93
v_and_b32 v93, 0xffff0000, v93
buffer_store_dword v92, v14, s[40:43], 0 offen offset:2304 nt
buffer_store_dword v93, v14, s[40:43], s64 offen offset:2304 nt
v_cvt_pk_bf16_f32 v95, v67, v51
v_lshlrev_b32 v94, 16, v95
v_and_b32 v95, 0xffff0000, v95
buffer_store_dword v94, v14, s[40:43], 0 offen offset:2432 nt
buffer_store_dword v95, v14, s[40:43], s64 offen offset:2432 nt
v_cvt_pk_bf16_f32 v97, v68, v52
v_lshlrev_b32 v96, 16, v97
v_and_b32 v97, 0xffff0000, v97
buffer_store_dword v96, v14, s[40:43], 0 offen offset:3072 nt
buffer_store_dword v97, v14, s[40:43], s64 offen offset:3072 nt
v_cvt_pk_bf16_f32 v99, v69, v53
v_lshlrev_b32 v98, 16, v99
v_and_b32 v99, 0xffff0000, v99
buffer_store_dword v98, v14, s[40:43], 0 offen offset:3200 nt
buffer_store_dword v99, v14, s[40:43], s64 offen offset:3200 nt
v_cvt_pk_bf16_f32 v101, v70, v54
v_lshlrev_b32 v100, 16, v101
v_and_b32 v101, 0xffff0000, v101
buffer_store_dword v100, v14, s[40:43], 0 offen offset:3328 nt
buffer_store_dword v101, v14, s[40:43], s64 offen offset:3328 nt
v_cvt_pk_bf16_f32 v103, v71, v55
v_lshlrev_b32 v102, 16, v103
v_and_b32 v103, 0xffff0000, v103
buffer_store_dword v102, v14, s[40:43], 0 offen offset:3456 nt
buffer_store_dword v103, v14, s[40:43], s64 offen offset:3456 nt
s_endpgm
L_concat_heads__spectral_gfnet__ssm_conv_s5__prompt_kernel_gemm:
s_lshr_b32 s68, s34, 1
s_and_b32 s66, s34, 1
s_lshr_b32 s101, s36, 3
v_and_b32 v6, 31, v1
v_lshrrev_b32 v5, 5, v1
v_lshlrev_b32 v11, 4, v1
v_mov_b64 v[64:65], 0
v_mov_b64 v[66:67], 0
s_mul_i32 s60, s34, 2304
s_add_u32 s60, s60, 114688
v_add_u32 v13, s60, v11
v_mov_b32 v12, 126976
ds_write_b128 v13, v[64:67]
ds_write_b128 v13, v[64:67] offset:1024
ds_write_b128 v13, v[64:67] offset:2048
s_mov_b64 exec, 1
ds_write_b128 v12, v[64:67]
ds_write_b128 v12, v[64:67] offset:16
ds_write_b128 v12, v[64:67] offset:32
ds_write_b128 v12, v[64:67] offset:48
ds_write_b128 v12, v[64:67] offset:64
s_mov_b64 exec, -1
s_lshl_b32 s60, s34, 2
v_add_u32 v13, s60, v12
s_waitcnt lgkmcnt(0)
s_barrier
v_bfe_u32 v4, v1, 2, 2
v_lshlrev_b32 v4, 3, v4
v_and_b32 v7, 3, v1
v_add_u32 v4, v4, v7
s_lshl_b32 s60, s36, 6
s_lshl_b32 s61, s66, 5
s_add_u32 s60, s60, s61
v_add_u32 v4, s60, v4
v_lshlrev_b32 v7, 1, v4
v_lshrrev_b32 v14, 5, v1
v_bfe_u32 v15, v1, 3, 2
v_and_b32 v16, 1, v15
v_lshrrev_b32 v17, 1, v15
v_lshlrev_b32 v18, 4, v14
v_lshl_add_u32 v18, v16, 3, v18
v_add_u32 v18, v18, v17
s_lshl_b32 s61, s68, 6
s_lshl_b32 s62, s66, 2
s_add_u32 s61, s61, s62
v_add_u32 v18, s61, v18
v_lshlrev_b32 v18, 11, v18
s_lshl_b32 s61, s68, 5
v_lshl_add_u32 v19, v14, 3, v15
v_add_u32 v19, s61, v19
v_lshlrev_b32 v19, 11, v19
v_and_b32 v16, 7, v1
v_lshrrev_b32 v17, 4, v1
v_xor_b32 v16, v16, v17
v_lshlrev_b32 v16, 4, v16
v_xor_b32 v17, 64, v16
v_add_u32 v244, v18, v16
v_add_u32 v245, v18, v17
v_add_u32 v245, 64512, v245
v_add_u32 v246, v19, v16
v_add_u32 v247, v19, v17
v_add_u32 v247, 31744, v247
s_mul_i32 s38, s35, 128
s_mul_i32 s60, s36, 128
s_add_u32 s38, s38, s60
s_lshl_b32 s60, s35, 18
s_lshl_b32 s61, s36, 17
s_lshl_b32 s39, s34, 12
s_waitcnt lgkmcnt(0)
global_load_ushort v248, v7, s[12:13] offset:0
global_load_ushort v249, v7, s[14:15] offset:0
global_load_ushort v250, v7, s[24:25] offset:0
global_load_ushort v251, v7, s[12:13] offset:8
global_load_ushort v252, v7, s[14:15] offset:8
global_load_ushort v253, v7, s[24:25] offset:8
s_add_u32 s48, s10, s60
s_addc_u32 s49, s11, 0
s_mov_b32 s50, 262144
s_mov_b32 s51, 0x20000
s_cmp_eq_u32 s66, 1
s_cselect_b32 s62, s18, s16
s_cselect_b32 s63, s19, s17
s_add_u32 s52, s62, s61
s_addc_u32 s53, s63, 0
s_mov_b32 s54, 131072
s_mov_b32 s55, 0x20000
s_add_u32 s62, s38, 0
s_and_b32 s62, s62, 0x7ff
s_add_u32 s63, s62, 2048
s_add_u32 s64, s62, 6144
s_add_u32 m0, s39, 0
s_nop 0
buffer_load_dwordx4 v244, s[48:51], s62 offen offset:0 lds
buffer_load_dwordx4 v245, s[48:51], s62 offen offset:1024 lds
buffer_load_dwordx4 v244, s[48:51], s63 offen offset:2048 lds
buffer_load_dwordx4 v245, s[48:51], s63 offen offset:3072 lds
s_add_u32 m0, s39, 16384
s_nop 0
buffer_load_dwordx4 v246, s[52:55], s62 offen offset:0 lds
buffer_load_dwordx4 v247, s[52:55], s62 offen offset:1024 lds
buffer_load_dwordx4 v246, s[52:55], s64 offen offset:2048 lds
buffer_load_dwordx4 v247, s[52:55], s64 offen offset:3072 lds
v_bfe_u32 v7, v1, 4, 1
v_lshl_add_u32 v4, v7, 2, v4
v_bfe_u32 v7, v6, 1, 3
v_xor_b32 v7, v7, v5
v_lshlrev_b32 v7, 4, v7
v_lshl_add_u32 v7, v6, 7, v7
v_and_b32 v8, 15, v1
v_lshrrev_b32 v9, 4, v1
v_lshrrev_b32 v14, 1, v8
v_xor_b32 v14, v14, v9
v_lshlrev_b32 v14, 4, v14
v_lshl_add_u32 v14, v8, 7, v14
s_lshl_b32 s60, s68, 13
s_lshl_b32 s61, s66, 13
s_add_u32 s61, s61, 16384
v_xor_b32 v15, 0, v14
v_add_u32 v128, s60, v15
v_add_u32 v130, s61, v15
v_add_u32 v132, 0x10000, v128
v_add_u32 v134, 0x10000, v130
v_xor_b32 v15, 64, v14
v_add_u32 v129, s60, v15
v_add_u32 v131, s61, v15
v_add_u32 v133, 0x10000, v129
v_add_u32 v135, 0x10000, v131
s_add_u32 s40, s32, 65536
s_addc_u32 s41, s33, 0
s_mov_b32 s42, 262144
s_mov_b32 s43, 0x20000
s_add_u32 s44, s32, 1048576
s_addc_u32 s45, s33, 0
s_mov_b32 s46, 8388608
s_mov_b32 s47, 0x20000
s_mul_i32 s60, s66, 4608
s_add_u32 s60, s60, 114752
s_lshl_b32 s61, s68, 5
s_add_u32 s61, s61, s60
v_mul_u32_u24 v14, 144, v6
v_add_u32 v14, s60, v14
v_lshl_add_u32 v14, v5, 5, v14
v_mul_u32_u24 v15, 144, v8
v_add_u32 v15, s61, v15
v_lshl_add_u32 v15, v9, 3, v15
s_lshl_b32 s60, s35, 14
v_lshl_add_u32 v16, v4, 4, s60
v_mov_b32 v17, 0x40000000
v_lshlrev_b32 v10, 14, v5
v_sub_u32 v10, v16, v10
v_subrev_u32 v136, 16384, v10
v_cmp_le_i32 vcc, 0, v136
s_nop 1
v_cndmask_b32 v136, v17, v136, vcc
v_subrev_u32 v137, 49152, v10
v_cmp_le_i32 vcc, 0, v137
s_nop 1
v_cndmask_b32 v137, v17, v137, vcc
v_subrev_u32 v138, 81920, v10
v_cmp_le_i32 vcc, 0, v138
s_nop 1
v_cndmask_b32 v138, v17, v138, vcc
v_subrev_u32 v139, 114688, v10
v_cmp_le_i32 vcc, 0, v139
s_nop 1
v_cndmask_b32 v139, v17, v139, vcc
v_subrev_u32 v140, 147456, v10
v_cmp_le_i32 vcc, 0, v140
s_nop 1
v_cndmask_b32 v140, v17, v140, vcc
v_subrev_u32 v141, 180224, v10
v_cmp_le_i32 vcc, 0, v141
s_nop 1
v_cndmask_b32 v141, v17, v141, vcc
v_subrev_u32 v142, 212992, v10
v_cmp_le_i32 vcc, 0, v142
s_nop 1
v_cndmask_b32 v142, v17, v142, vcc
v_subrev_u32 v143, 245760, v10
v_cmp_le_i32 vcc, 0, v143
s_nop 1
v_cndmask_b32 v143, v17, v143, vcc
v_lshlrev_b32 v17, 30, v5
v_or_b32 v16, v16, v17
s_lshl_b32 s60, s35, 11
s_add_u32 s60, s60, 32768
s_lshl_b32 s61, s36, 7
s_add_u32 s61, s61, s60
v_mov_b32 v195, s61
s_lshl_b32 s61, s101, 10
s_add_u32 s60, s60, s61
v_and_b32 v196, 7, v1
v_lshl_add_u32 v196, v196, 7, s60
s_lshl_b32 s60, s35, 1
s_add_u32 s60, s60, s68
s_lshl_b32 s60, s60, 12
s_add_u32 s60, s60, 393216
s_lshl_b32 s61, s101, 11
s_add_u32 s61, s61, s60
v_lshl_add_u32 v18, v8, 7, s61
s_lshl_b32 s61, s36, 8
s_add_u32 s60, s60, s61
s_lshl_b32 s61, s66, 7
s_add_u32 s60, s60, s61
v_mov_b32 v19, s60
v_lshrrev_b32 v10, 1, v9
v_lshlrev_b32 v10, 10, v10
v_and_b32 v17, 1, v9
v_lshl_add_u32 v10, v17, 9, v10
v_lshl_add_u32 v10, v8, 4, v10
s_lshl_b32 s60, s68, 2
v_add_u32 v9, s60, v9
v_cvt_f32_u32 v9, v9
v_mul_f32 v9, 0x41800000, v9
v_add_f32 v8, 0x41000000, v9
s_add_u32 s62, s38, 128
s_and_b32 s62, s62, 0x7ff
s_add_u32 s63, s62, 2048
s_add_u32 s64, s62, 6144
s_add_u32 m0, s39, 32768
s_nop 0
buffer_load_dwordx4 v244, s[48:51], s62 offen offset:0 lds
buffer_load_dwordx4 v245, s[48:51], s62 offen offset:1024 lds
buffer_load_dwordx4 v244, s[48:51], s63 offen offset:2048 lds
buffer_load_dwordx4 v245, s[48:51], s63 offen offset:3072 lds
s_add_u32 m0, s39, 49152
s_nop 0
buffer_load_dwordx4 v246, s[52:55], s62 offen offset:0 lds
buffer_load_dwordx4 v247, s[52:55], s62 offen offset:1024 lds
buffer_load_dwordx4 v246, s[52:55], s64 offen offset:2048 lds
buffer_load_dwordx4 v247, s[52:55], s64 offen offset:3072 lds
s_setprio 1
s_waitcnt vmcnt(8)
s_barrier
ds_read_b128 v[32:35], v128 offset:0
ds_read_b128 v[48:51], v130 offset:0
ds_read_b128 v[52:55], v130 offset:2048
ds_read_b128 v[56:59], v130 offset:4096
ds_read_b128 v[60:63], v130 offset:6144
ds_read_b128 v[36:39], v128 offset:2048
ds_read_b128 v[40:43], v128 offset:4096
ds_read_b128 v[44:47], v128 offset:6144
s_waitcnt lgkmcnt(6)
v_mfma_f32_16x16x32_bf16 v[64:67], v[32:35], v[48:51], 0
ds_read_b128 v[144:147], v129 offset:0
s_waitcnt lgkmcnt(6)
v_mfma_f32_16x16x32_bf16 v[96:99], v[32:35], v[52:55], 0
ds_read_b128 v[160:163], v131 offset:0
s_waitcnt lgkmcnt(6)
v_mfma_f32_16x16x32_bf16 v[80:83], v[32:35], v[56:59], 0
ds_read_b128 v[164:167], v131 offset:2048
s_waitcnt lgkmcnt(6)
v_mfma_f32_16x16x32_bf16 v[112:115], v[32:35], v[60:63], 0
ds_read_b128 v[168:171], v131 offset:4096
s_waitcnt lgkmcnt(6)
v_mfma_f32_16x16x32_bf16 v[68:71], v[36:39], v[48:51], 0
ds_read_b128 v[172:175], v131 offset:6144
v_mfma_f32_16x16x32_bf16 v[100:103], v[36:39], v[52:55], 0
ds_read_b128 v[148:151], v129 offset:2048
v_mfma_f32_16x16x32_bf16 v[84:87], v[36:39], v[56:59], 0
ds_read_b128 v[152:155], v129 offset:4096
v_mfma_f32_16x16x32_bf16 v[116:119], v[36:39], v[60:63], 0
ds_read_b128 v[156:159], v129 offset:6144
s_waitcnt lgkmcnt(9)
v_mfma_f32_16x16x32_bf16 v[72:75], v[40:43], v[48:51], 0
v_lshlrev_b32 v248, 16, v248
v_lshlrev_b32 v249, 16, v249
v_mfma_f32_16x16x32_bf16 v[104:107], v[40:43], v[52:55], 0
v_lshlrev_b32 v250, 16, v250
v_mul_f32 v250, 0x3fb8aa3b, v250
v_mfma_f32_16x16x32_bf16 v[88:91], v[40:43], v[56:59], 0
v_exp_f32 v250, v250
s_nop 0
v_cvt_pk_bf16_f32 v250, v250, v250
v_mfma_f32_16x16x32_bf16 v[120:123], v[40:43], v[60:63], 0
v_lshlrev_b32 v250, 16, v250
v_mul_f32 v204, v250, v248
s_waitcnt lgkmcnt(8)
v_mfma_f32_16x16x32_bf16 v[76:79], v[44:47], v[48:51], 0
v_mul_f32 v206, v250, v249
v_mul_f32 v204, 0x3fb8aa3b, v204
v_mfma_f32_16x16x32_bf16 v[108:111], v[44:47], v[52:55], 0
v_mul_f32 v206, 0.15915494, v206
v_mul_f32 v197, 0x3f800000, v204
v_mfma_f32_16x16x32_bf16 v[92:95], v[44:47], v[56:59], 0
v_mul_f32 v198, 0x3f800000, v206
v_exp_f32 v197, v197
v_mfma_f32_16x16x32_bf16 v[124:127], v[44:47], v[60:63], 0
v_rndne_f32 v199, v198
v_sub_f32 v198, v198, v199
s_waitcnt vmcnt(0) lgkmcnt(0)
s_barrier
v_mfma_f32_16x16x32_bf16 v[64:67], v[144:147], v[160:163], v[64:67]
ds_read_b128 v[32:35], v128 offset:32768
v_mfma_f32_16x16x32_bf16 v[96:99], v[144:147], v[164:167], v[96:99]
ds_read_b128 v[48:51], v130 offset:32768
v_mfma_f32_16x16x32_bf16 v[80:83], v[144:147], v[168:171], v[80:83]
ds_read_b128 v[52:55], v130 offset:34816
v_mfma_f32_16x16x32_bf16 v[112:115], v[144:147], v[172:175], v[112:115]
ds_read_b128 v[56:59], v130 offset:36864
v_mfma_f32_16x16x32_bf16 v[68:71], v[148:151], v[160:163], v[68:71]
ds_read_b128 v[60:63], v130 offset:38912
v_mfma_f32_16x16x32_bf16 v[100:103], v[148:151], v[164:167], v[100:103]
ds_read_b128 v[36:39], v128 offset:34816
v_mfma_f32_16x16x32_bf16 v[84:87], v[148:151], v[168:171], v[84:87]
ds_read_b128 v[40:43], v128 offset:36864
v_mfma_f32_16x16x32_bf16 v[116:119], v[148:151], v[172:175], v[116:119]
ds_read_b128 v[44:47], v128 offset:38912
v_mfma_f32_16x16x32_bf16 v[72:75], v[152:155], v[160:163], v[72:75]
v_cos_f32 v199, v198
v_sin_f32 v198, v198
v_mfma_f32_16x16x32_bf16 v[104:107], v[152:155], v[164:167], v[104:107]
v_mul_f32 v20, v197, v199
v_mul_f32 v21, v197, v198
v_mfma_f32_16x16x32_bf16 v[88:91], v[152:155], v[168:171], v[88:91]
v_add_f32 v197, -1.0, v20
v_mul_f32 v198, v248, v248
v_mfma_f32_16x16x32_bf16 v[120:123], v[152:155], v[172:175], v[120:123]
v_fma_f32 v198, v249, v249, v198
v_rcp_f32 v198, v198
v_mfma_f32_16x16x32_bf16 v[76:79], v[156:159], v[160:163], v[76:79]
v_add_f32 v198, v198, v198
v_mul_f32 v199, v197, v248
v_mfma_f32_16x16x32_bf16 v[108:111], v[156:159], v[164:167], v[108:111]
v_fma_f32 v199, v21, v249, v199
v_mul_f32 v24, v199, v198
v_mfma_f32_16x16x32_bf16 v[92:95], v[156:159], v[168:171], v[92:95]
v_mul_f32 v199, v21, v248
v_fma_f32 v199, -v197, v249, v199
v_mfma_f32_16x16x32_bf16 v[124:127], v[156:159], v[172:175], v[124:127]
v_mul_f32 v25, v199, v198
v_mul_f32 v197, 0x41000000, v204
s_waitcnt lgkmcnt(6)
v_mfma_f32_16x16x32_bf16 v[64:67], v[32:35], v[48:51], v[64:67]
ds_read_b128 v[144:147], v129 offset:32768
s_waitcnt lgkmcnt(6)
v_mfma_f32_16x16x32_bf16 v[96:99], v[32:35], v[52:55], v[96:99]
ds_read_b128 v[160:163], v131 offset:32768
s_waitcnt lgkmcnt(6)
v_mfma_f32_16x16x32_bf16 v[80:83], v[32:35], v[56:59], v[80:83]
ds_read_b128 v[164:167], v131 offset:34816
s_waitcnt lgkmcnt(6)
v_mfma_f32_16x16x32_bf16 v[112:115], v[32:35], v[60:63], v[112:115]
ds_read_b128 v[168:171], v131 offset:36864
s_waitcnt lgkmcnt(6)
v_mfma_f32_16x16x32_bf16 v[68:71], v[36:39], v[48:51], v[68:71]
ds_read_b128 v[172:175], v131 offset:38912
v_mfma_f32_16x16x32_bf16 v[100:103], v[36:39], v[52:55], v[100:103]
ds_read_b128 v[148:151], v129 offset:34816
v_mfma_f32_16x16x32_bf16 v[84:87], v[36:39], v[56:59], v[84:87]
ds_read_b128 v[152:155], v129 offset:36864
v_mfma_f32_16x16x32_bf16 v[116:119], v[36:39], v[60:63], v[116:119]
ds_read_b128 v[156:159], v129 offset:38912
s_waitcnt lgkmcnt(9)
v_mfma_f32_16x16x32_bf16 v[72:75], v[40:43], v[48:51], v[72:75]
v_mul_f32 v198, 0x41000000, v206
v_exp_f32 v197, v197
v_mfma_f32_16x16x32_bf16 v[104:107], v[40:43], v[52:55], v[104:107]
v_rndne_f32 v199, v198
v_sub_f32 v198, v198, v199
v_mfma_f32_16x16x32_bf16 v[88:91], v[40:43], v[56:59], v[88:91]
v_cos_f32 v199, v198
v_sin_f32 v198, v198
v_mfma_f32_16x16x32_bf16 v[120:123], v[40:43], v[60:63], v[120:123]
v_mul_f32 v176, v197, v199
v_mul_f32 v177, v197, v198
s_waitcnt lgkmcnt(8)
v_mfma_f32_16x16x32_bf16 v[76:79], v[44:47], v[48:51], v[76:79]
v_mul_f32 v197, 0x41800000, v204
v_mul_f32 v198, 0x41800000, v206
v_mfma_f32_16x16x32_bf16 v[108:111], v[44:47], v[52:55], v[108:111]
v_exp_f32 v197, v197
v_rndne_f32 v199, v198
v_mfma_f32_16x16x32_bf16 v[92:95], v[44:47], v[56:59], v[92:95]
v_sub_f32 v198, v198, v199
v_cos_f32 v199, v198
v_mfma_f32_16x16x32_bf16 v[124:127], v[44:47], v[60:63], v[124:127]
v_sin_f32 v198, v198
v_mul_f32 v180, v197, v199
s_waitcnt lgkmcnt(0)
s_barrier
v_mfma_f32_16x16x32_bf16 v[64:67], v[144:147], v[160:163], v[64:67]
ds_read_b128 v[32:35], v132 offset:0
v_mfma_f32_16x16x32_bf16 v[96:99], v[144:147], v[164:167], v[96:99]
ds_read_b128 v[48:51], v134 offset:0
v_mfma_f32_16x16x32_bf16 v[80:83], v[144:147], v[168:171], v[80:83]
ds_read_b128 v[52:55], v134 offset:2048
v_mfma_f32_16x16x32_bf16 v[112:115], v[144:147], v[172:175], v[112:115]
ds_read_b128 v[56:59], v134 offset:4096
v_mfma_f32_16x16x32_bf16 v[68:71], v[148:151], v[160:163], v[68:71]
ds_read_b128 v[60:63], v134 offset:6144
v_mfma_f32_16x16x32_bf16 v[100:103], v[148:151], v[164:167], v[100:103]
ds_read_b128 v[36:39], v132 offset:2048
v_mfma_f32_16x16x32_bf16 v[84:87], v[148:151], v[168:171], v[84:87]
ds_read_b128 v[40:43], v132 offset:4096
v_mfma_f32_16x16x32_bf16 v[116:119], v[148:151], v[172:175], v[116:119]
ds_read_b128 v[44:47], v132 offset:6144
v_mfma_f32_16x16x32_bf16 v[72:75], v[152:155], v[160:163], v[72:75]
v_mul_f32 v181, v197, v198
v_mul_f32 v197, v9, v204
v_mfma_f32_16x16x32_bf16 v[104:107], v[152:155], v[164:167], v[104:107]
v_mul_f32 v198, v9, v206
v_exp_f32 v197, v197
v_mfma_f32_16x16x32_bf16 v[88:91], v[152:155], v[168:171], v[88:91]
v_rndne_f32 v199, v198
v_sub_f32 v198, v198, v199
v_mfma_f32_16x16x32_bf16 v[120:123], v[152:155], v[172:175], v[120:123]
v_cos_f32 v199, v198
v_sin_f32 v198, v198
v_mfma_f32_16x16x32_bf16 v[76:79], v[156:159], v[160:163], v[76:79]
v_mul_f32 v200, v197, v199
v_mul_f32 v201, v197, v198
v_mfma_f32_16x16x32_bf16 v[108:111], v[156:159], v[164:167], v[108:111]
v_mov_b32 v184, v200
v_mov_b32 v186, v201
v_mfma_f32_16x16x32_bf16 v[92:95], v[156:159], v[168:171], v[92:95]
v_mul_f32 v197, v8, v204
v_mul_f32 v198, v8, v206
v_mfma_f32_16x16x32_bf16 v[124:127], v[156:159], v[172:175], v[124:127]
v_exp_f32 v197, v197
v_rndne_f32 v199, v198
s_waitcnt lgkmcnt(6)
v_mfma_f32_16x16x32_bf16 v[64:67], v[32:35], v[48:51], v[64:67]
ds_read_b128 v[144:147], v133 offset:0
s_waitcnt lgkmcnt(6)
v_mfma_f32_16x16x32_bf16 v[96:99], v[32:35], v[52:55], v[96:99]
ds_read_b128 v[160:163], v135 offset:0
s_waitcnt lgkmcnt(6)
v_mfma_f32_16x16x32_bf16 v[80:83], v[32:35], v[56:59], v[80:83]
ds_read_b128 v[164:167], v135 offset:2048
s_waitcnt lgkmcnt(6)
v_mfma_f32_16x16x32_bf16 v[112:115], v[32:35], v[60:63], v[112:115]
ds_read_b128 v[168:171], v135 offset:4096
s_waitcnt lgkmcnt(6)
v_mfma_f32_16x16x32_bf16 v[68:71], v[36:39], v[48:51], v[68:71]
ds_read_b128 v[172:175], v135 offset:6144
v_mfma_f32_16x16x32_bf16 v[100:103], v[36:39], v[52:55], v[100:103]
ds_read_b128 v[148:151], v133 offset:2048
v_mfma_f32_16x16x32_bf16 v[84:87], v[36:39], v[56:59], v[84:87]
ds_read_b128 v[152:155], v133 offset:4096
v_mfma_f32_16x16x32_bf16 v[116:119], v[36:39], v[60:63], v[116:119]
ds_read_b128 v[156:159], v133 offset:6144
s_waitcnt lgkmcnt(9)
v_mfma_f32_16x16x32_bf16 v[72:75], v[40:43], v[48:51], v[72:75]
v_sub_f32 v198, v198, v199
v_cos_f32 v199, v198
v_mfma_f32_16x16x32_bf16 v[104:107], v[40:43], v[52:55], v[104:107]
v_sin_f32 v198, v198
v_mul_f32 v200, v197, v199
v_mfma_f32_16x16x32_bf16 v[88:91], v[40:43], v[56:59], v[88:91]
v_mul_f32 v201, v197, v198
v_mov_b32 v185, v200
v_mfma_f32_16x16x32_bf16 v[120:123], v[40:43], v[60:63], v[120:123]
v_mov_b32 v187, v201
v_mul_f32 v197, v25, v21
s_waitcnt lgkmcnt(8)
v_mfma_f32_16x16x32_bf16 v[76:79], v[44:47], v[48:51], v[76:79]
v_mul_f32 v198, v25, v20
v_fma_f32 v208, v24, v20, -v197
v_mfma_f32_16x16x32_bf16 v[108:111], v[44:47], v[52:55], v[108:111]
v_fma_f32 v209, v24, v21, v198
v_mul_f32 v197, v209, v21
v_mfma_f32_16x16x32_bf16 v[92:95], v[44:47], v[56:59], v[92:95]
v_mul_f32 v198, v209, v20
v_fma_f32 v210, v208, v20, -v197
v_mfma_f32_16x16x32_bf16 v[124:127], v[44:47], v[60:63], v[124:127]
v_fma_f32 v211, v208, v21, v198
v_mul_f32 v197, v211, v21
s_waitcnt lgkmcnt(0)
s_barrier
v_mfma_f32_16x16x32_bf16 v[64:67], v[144:147], v[160:163], v[64:67]
ds_read_b128 v[32:35], v128 offset:0
v_mfma_f32_16x16x32_bf16 v[96:99], v[144:147], v[164:167], v[96:99]
ds_read_b128 v[48:51], v130 offset:0
v_mfma_f32_16x16x32_bf16 v[80:83], v[144:147], v[168:171], v[80:83]
ds_read_b128 v[52:55], v130 offset:2048
v_mfma_f32_16x16x32_bf16 v[112:115], v[144:147], v[172:175], v[112:115]
ds_read_b128 v[56:59], v130 offset:4096
v_mfma_f32_16x16x32_bf16 v[68:71], v[148:151], v[160:163], v[68:71]
ds_read_b128 v[60:63], v130 offset:6144
v_mfma_f32_16x16x32_bf16 v[100:103], v[148:151], v[164:167], v[100:103]
ds_read_b128 v[36:39], v128 offset:2048
v_mfma_f32_16x16x32_bf16 v[84:87], v[148:151], v[168:171], v[84:87]
ds_read_b128 v[40:43], v128 offset:4096
v_mfma_f32_16x16x32_bf16 v[116:119], v[148:151], v[172:175], v[116:119]
ds_read_b128 v[44:47], v128 offset:6144
v_mfma_f32_16x16x32_bf16 v[72:75], v[152:155], v[160:163], v[72:75]
v_mul_f32 v198, v211, v20
v_fma_f32 v212, v210, v20, -v197
v_mfma_f32_16x16x32_bf16 v[104:107], v[152:155], v[164:167], v[104:107]
v_fma_f32 v213, v210, v21, v198
v_mul_f32 v197, v213, v21
v_mfma_f32_16x16x32_bf16 v[88:91], v[152:155], v[168:171], v[88:91]
v_mul_f32 v198, v213, v20
v_fma_f32 v214, v212, v20, -v197
v_mfma_f32_16x16x32_bf16 v[120:123], v[152:155], v[172:175], v[120:123]
v_fma_f32 v215, v212, v21, v198
v_mul_f32 v197, v215, v21
v_mfma_f32_16x16x32_bf16 v[76:79], v[156:159], v[160:163], v[76:79]
v_mul_f32 v198, v215, v20
v_fma_f32 v216, v214, v20, -v197
v_mfma_f32_16x16x32_bf16 v[108:111], v[156:159], v[164:167], v[108:111]
v_fma_f32 v217, v214, v21, v198
v_mul_f32 v197, v217, v21
v_mfma_f32_16x16x32_bf16 v[92:95], v[156:159], v[168:171], v[92:95]
v_mul_f32 v198, v217, v20
v_fma_f32 v218, v216, v20, -v197
v_mfma_f32_16x16x32_bf16 v[124:127], v[156:159], v[172:175], v[124:127]
v_fma_f32 v219, v216, v21, v198
v_mul_f32 v197, v219, v21
s_waitcnt lgkmcnt(6)
v_mfma_f32_16x16x32_bf16 v[64:67], v[32:35], v[48:51], v[64:67]
ds_read_b128 v[144:147], v129 offset:0
s_waitcnt lgkmcnt(6)
v_mfma_f32_16x16x32_bf16 v[96:99], v[32:35], v[52:55], v[96:99]
ds_read_b128 v[160:163], v131 offset:0
s_waitcnt lgkmcnt(6)
v_mfma_f32_16x16x32_bf16 v[80:83], v[32:35], v[56:59], v[80:83]
ds_read_b128 v[164:167], v131 offset:2048
s_waitcnt lgkmcnt(6)
v_mfma_f32_16x16x32_bf16 v[112:115], v[32:35], v[60:63], v[112:115]
ds_read_b128 v[168:171], v131 offset:4096
s_waitcnt lgkmcnt(6)
v_mfma_f32_16x16x32_bf16 v[68:71], v[36:39], v[48:51], v[68:71]
ds_read_b128 v[172:175], v131 offset:6144
v_mfma_f32_16x16x32_bf16 v[100:103], v[36:39], v[52:55], v[100:103]
ds_read_b128 v[148:151], v129 offset:2048
v_mfma_f32_16x16x32_bf16 v[84:87], v[36:39], v[56:59], v[84:87]
ds_read_b128 v[152:155], v129 offset:4096
v_mfma_f32_16x16x32_bf16 v[116:119], v[36:39], v[60:63], v[116:119]
ds_read_b128 v[156:159], v129 offset:6144
s_waitcnt lgkmcnt(9)
v_mfma_f32_16x16x32_bf16 v[72:75], v[40:43], v[48:51], v[72:75]
v_mul_f32 v198, v219, v20
v_fma_f32 v220, v218, v20, -v197
v_mfma_f32_16x16x32_bf16 v[104:107], v[40:43], v[52:55], v[104:107]
v_fma_f32 v221, v218, v21, v198
v_mul_f32 v197, v221, v21
v_mfma_f32_16x16x32_bf16 v[88:91], v[40:43], v[56:59], v[88:91]
v_mul_f32 v198, v221, v20
v_fma_f32 v222, v220, v20, -v197
v_mfma_f32_16x16x32_bf16 v[120:123], v[40:43], v[60:63], v[120:123]
v_fma_f32 v223, v220, v21, v198
v_lshlrev_b32 v251, 16, v251
s_waitcnt lgkmcnt(8)
v_mfma_f32_16x16x32_bf16 v[76:79], v[44:47], v[48:51], v[76:79]
v_lshlrev_b32 v252, 16, v252
v_lshlrev_b32 v253, 16, v253
v_mfma_f32_16x16x32_bf16 v[108:111], v[44:47], v[52:55], v[108:111]
v_mul_f32 v253, 0x3fb8aa3b, v253
v_exp_f32 v253, v253
v_mfma_f32_16x16x32_bf16 v[92:95], v[44:47], v[56:59], v[92:95]
v_cvt_pk_bf16_f32 v253, v253, v253
v_lshlrev_b32 v253, 16, v253
v_mfma_f32_16x16x32_bf16 v[124:127], v[44:47], v[60:63], v[124:127]
v_mul_f32 v205, v253, v251
v_mul_f32 v207, v253, v252
s_waitcnt lgkmcnt(0)
s_barrier
v_mfma_f32_16x16x32_bf16 v[64:67], v[144:147], v[160:163], v[64:67]
ds_read_b128 v[32:35], v128 offset:32768
v_mfma_f32_16x16x32_bf16 v[96:99], v[144:147], v[164:167], v[96:99]
ds_read_b128 v[48:51], v130 offset:32768
v_mfma_f32_16x16x32_bf16 v[80:83], v[144:147], v[168:171], v[80:83]
ds_read_b128 v[52:55], v130 offset:34816
v_mfma_f32_16x16x32_bf16 v[112:115], v[144:147], v[172:175], v[112:115]
ds_read_b128 v[56:59], v130 offset:36864
v_mfma_f32_16x16x32_bf16 v[68:71], v[148:151], v[160:163], v[68:71]
ds_read_b128 v[60:63], v130 offset:38912
v_mfma_f32_16x16x32_bf16 v[100:103], v[148:151], v[164:167], v[100:103]
ds_read_b128 v[36:39], v128 offset:34816
v_mfma_f32_16x16x32_bf16 v[84:87], v[148:151], v[168:171], v[84:87]
ds_read_b128 v[40:43], v128 offset:36864
v_mfma_f32_16x16x32_bf16 v[116:119], v[148:151], v[172:175], v[116:119]
ds_read_b128 v[44:47], v128 offset:38912
v_mfma_f32_16x16x32_bf16 v[72:75], v[152:155], v[160:163], v[72:75]
v_mul_f32 v205, 0x3fb8aa3b, v205
v_mul_f32 v207, 0.15915494, v207
v_mfma_f32_16x16x32_bf16 v[104:107], v[152:155], v[164:167], v[104:107]
v_mul_f32 v197, 0x3f800000, v205
v_mul_f32 v198, 0x3f800000, v207
v_mfma_f32_16x16x32_bf16 v[88:91], v[152:155], v[168:171], v[88:91]
v_exp_f32 v197, v197
v_rndne_f32 v199, v198
v_mfma_f32_16x16x32_bf16 v[120:123], v[152:155], v[172:175], v[120:123]
v_sub_f32 v198, v198, v199
v_cos_f32 v199, v198
v_mfma_f32_16x16x32_bf16 v[76:79], v[156:159], v[160:163], v[76:79]
v_sin_f32 v198, v198
v_mul_f32 v22, v197, v199
v_mfma_f32_16x16x32_bf16 v[108:111], v[156:159], v[164:167], v[108:111]
v_mul_f32 v23, v197, v198
v_add_f32 v197, -1.0, v22
v_mfma_f32_16x16x32_bf16 v[92:95], v[156:159], v[168:171], v[92:95]
v_mul_f32 v198, v251, v251
v_fma_f32 v198, v252, v252, v198
v_mfma_f32_16x16x32_bf16 v[124:127], v[156:159], v[172:175], v[124:127]
v_rcp_f32 v198, v198
s_nop 0
v_add_f32 v198, v198, v198
s_waitcnt lgkmcnt(6)
v_mfma_f32_16x16x32_bf16 v[64:67], v[32:35], v[48:51], v[64:67]
ds_read_b128 v[144:147], v129 offset:32768
s_waitcnt lgkmcnt(6)
v_mfma_f32_16x16x32_bf16 v[96:99], v[32:35], v[52:55], v[96:99]
ds_read_b128 v[160:163], v131 offset:32768
s_waitcnt lgkmcnt(6)
v_mfma_f32_16x16x32_bf16 v[80:83], v[32:35], v[56:59], v[80:83]
ds_read_b128 v[164:167], v131 offset:34816
s_waitcnt lgkmcnt(6)
v_mfma_f32_16x16x32_bf16 v[112:115], v[32:35], v[60:63], v[112:115]
ds_read_b128 v[168:171], v131 offset:36864
s_waitcnt lgkmcnt(6)
v_mfma_f32_16x16x32_bf16 v[68:71], v[36:39], v[48:51], v[68:71]
ds_read_b128 v[172:175], v131 offset:38912
v_mfma_f32_16x16x32_bf16 v[100:103], v[36:39], v[52:55], v[100:103]
ds_read_b128 v[148:151], v129 offset:34816
v_mfma_f32_16x16x32_bf16 v[84:87], v[36:39], v[56:59], v[84:87]
ds_read_b128 v[152:155], v129 offset:36864
v_mfma_f32_16x16x32_bf16 v[116:119], v[36:39], v[60:63], v[116:119]
ds_read_b128 v[156:159], v129 offset:38912
s_waitcnt lgkmcnt(9)
v_mfma_f32_16x16x32_bf16 v[72:75], v[40:43], v[48:51], v[72:75]
v_mul_f32 v199, v197, v251
v_fma_f32 v199, v23, v252, v199
v_mfma_f32_16x16x32_bf16 v[104:107], v[40:43], v[52:55], v[104:107]
v_mul_f32 v26, v199, v198
v_mul_f32 v199, v23, v251
v_mfma_f32_16x16x32_bf16 v[88:91], v[40:43], v[56:59], v[88:91]
v_fma_f32 v199, -v197, v252, v199
v_mul_f32 v27, v199, v198
v_mfma_f32_16x16x32_bf16 v[120:123], v[40:43], v[60:63], v[120:123]
v_mul_f32 v197, 0x41000000, v205
v_mul_f32 v198, 0x41000000, v207
s_waitcnt lgkmcnt(8)
v_mfma_f32_16x16x32_bf16 v[76:79], v[44:47], v[48:51], v[76:79]
v_exp_f32 v197, v197
v_rndne_f32 v199, v198
v_mfma_f32_16x16x32_bf16 v[108:111], v[44:47], v[52:55], v[108:111]
v_sub_f32 v198, v198, v199
v_cos_f32 v199, v198
v_mfma_f32_16x16x32_bf16 v[92:95], v[44:47], v[56:59], v[92:95]
v_sin_f32 v198, v198
v_mul_f32 v178, v197, v199
v_mfma_f32_16x16x32_bf16 v[124:127], v[44:47], v[60:63], v[124:127]
v_mul_f32 v179, v197, v198
v_mul_f32 v197, 0x41800000, v205
s_waitcnt lgkmcnt(0)
s_barrier
v_mfma_f32_16x16x32_bf16 v[64:67], v[144:147], v[160:163], v[64:67]
ds_read_b128 v[32:35], v132 offset:0
v_mfma_f32_16x16x32_bf16 v[96:99], v[144:147], v[164:167], v[96:99]
ds_read_b128 v[48:51], v134 offset:0
v_mfma_f32_16x16x32_bf16 v[80:83], v[144:147], v[168:171], v[80:83]
ds_read_b128 v[52:55], v134 offset:2048
v_mfma_f32_16x16x32_bf16 v[112:115], v[144:147], v[172:175], v[112:115]
ds_read_b128 v[56:59], v134 offset:4096
v_mfma_f32_16x16x32_bf16 v[68:71], v[148:151], v[160:163], v[68:71]
ds_read_b128 v[60:63], v134 offset:6144
v_mfma_f32_16x16x32_bf16 v[100:103], v[148:151], v[164:167], v[100:103]
ds_read_b128 v[36:39], v132 offset:2048
v_mfma_f32_16x16x32_bf16 v[84:87], v[148:151], v[168:171], v[84:87]
ds_read_b128 v[40:43], v132 offset:4096
v_mfma_f32_16x16x32_bf16 v[116:119], v[148:151], v[172:175], v[116:119]
ds_read_b128 v[44:47], v132 offset:6144
v_mfma_f32_16x16x32_bf16 v[72:75], v[152:155], v[160:163], v[72:75]
v_mul_f32 v198, 0x41800000, v207
v_exp_f32 v197, v197
v_mfma_f32_16x16x32_bf16 v[104:107], v[152:155], v[164:167], v[104:107]
v_rndne_f32 v199, v198
v_sub_f32 v198, v198, v199
v_mfma_f32_16x16x32_bf16 v[88:91], v[152:155], v[168:171], v[88:91]
v_cos_f32 v199, v198
v_sin_f32 v198, v198
v_mfma_f32_16x16x32_bf16 v[120:123], v[152:155], v[172:175], v[120:123]
v_mul_f32 v182, v197, v199
v_mul_f32 v183, v197, v198
v_mfma_f32_16x16x32_bf16 v[76:79], v[156:159], v[160:163], v[76:79]
v_mul_f32 v197, v9, v205
v_mul_f32 v198, v9, v207
v_mfma_f32_16x16x32_bf16 v[108:111], v[156:159], v[164:167], v[108:111]
v_exp_f32 v197, v197
v_rndne_f32 v199, v198
v_mfma_f32_16x16x32_bf16 v[92:95], v[156:159], v[168:171], v[92:95]
v_sub_f32 v198, v198, v199
v_cos_f32 v199, v198
v_mfma_f32_16x16x32_bf16 v[124:127], v[156:159], v[172:175], v[124:127]
v_sin_f32 v198, v198
v_mul_f32 v200, v197, v199
s_waitcnt lgkmcnt(6)
v_mfma_f32_16x16x32_bf16 v[64:67], v[32:35], v[48:51], v[64:67]
ds_read_b128 v[144:147], v133 offset:0
s_waitcnt lgkmcnt(6)
v_mfma_f32_16x16x32_bf16 v[96:99], v[32:35], v[52:55], v[96:99]
ds_read_b128 v[160:163], v135 offset:0
s_waitcnt lgkmcnt(6)
v_mfma_f32_16x16x32_bf16 v[80:83], v[32:35], v[56:59], v[80:83]
ds_read_b128 v[164:167], v135 offset:2048
s_waitcnt lgkmcnt(6)
v_mfma_f32_16x16x32_bf16 v[112:115], v[32:35], v[60:63], v[112:115]
ds_read_b128 v[168:171], v135 offset:4096
s_waitcnt lgkmcnt(6)
v_mfma_f32_16x16x32_bf16 v[68:71], v[36:39], v[48:51], v[68:71]
ds_read_b128 v[172:175], v135 offset:6144
v_mfma_f32_16x16x32_bf16 v[100:103], v[36:39], v[52:55], v[100:103]
ds_read_b128 v[148:151], v133 offset:2048
v_mfma_f32_16x16x32_bf16 v[84:87], v[36:39], v[56:59], v[84:87]
ds_read_b128 v[152:155], v133 offset:4096
v_mfma_f32_16x16x32_bf16 v[116:119], v[36:39], v[60:63], v[116:119]
ds_read_b128 v[156:159], v133 offset:6144
s_waitcnt lgkmcnt(9)
v_mfma_f32_16x16x32_bf16 v[72:75], v[40:43], v[48:51], v[72:75]
v_mul_f32 v201, v197, v198
v_mov_b32 v188, v200
v_mfma_f32_16x16x32_bf16 v[104:107], v[40:43], v[52:55], v[104:107]
v_mov_b32 v190, v201
v_mul_f32 v197, v8, v205
v_mfma_f32_16x16x32_bf16 v[88:91], v[40:43], v[56:59], v[88:91]
v_mul_f32 v198, v8, v207
v_exp_f32 v197, v197
v_mfma_f32_16x16x32_bf16 v[120:123], v[40:43], v[60:63], v[120:123]
v_rndne_f32 v199, v198
v_sub_f32 v198, v198, v199
s_waitcnt lgkmcnt(8)
v_mfma_f32_16x16x32_bf16 v[76:79], v[44:47], v[48:51], v[76:79]
v_cos_f32 v199, v198
v_sin_f32 v198, v198
v_mfma_f32_16x16x32_bf16 v[108:111], v[44:47], v[52:55], v[108:111]
v_mul_f32 v200, v197, v199
v_mul_f32 v201, v197, v198
v_mfma_f32_16x16x32_bf16 v[92:95], v[44:47], v[56:59], v[92:95]
v_mov_b32 v189, v200
v_mov_b32 v191, v201
v_mfma_f32_16x16x32_bf16 v[124:127], v[44:47], v[60:63], v[124:127]
v_mul_f32 v197, v27, v23
v_mul_f32 v198, v27, v22
s_waitcnt lgkmcnt(0)
s_barrier
v_mfma_f32_16x16x32_bf16 v[64:67], v[144:147], v[160:163], v[64:67]
ds_read_b128 v[32:35], v128 offset:0
v_mfma_f32_16x16x32_bf16 v[96:99], v[144:147], v[164:167], v[96:99]
ds_read_b128 v[48:51], v130 offset:0
v_mfma_f32_16x16x32_bf16 v[80:83], v[144:147], v[168:171], v[80:83]
ds_read_b128 v[52:55], v130 offset:2048
v_mfma_f32_16x16x32_bf16 v[112:115], v[144:147], v[172:175], v[112:115]
ds_read_b128 v[56:59], v130 offset:4096
v_mfma_f32_16x16x32_bf16 v[68:71], v[148:151], v[160:163], v[68:71]
ds_read_b128 v[60:63], v130 offset:6144
v_mfma_f32_16x16x32_bf16 v[100:103], v[148:151], v[164:167], v[100:103]
ds_read_b128 v[36:39], v128 offset:2048
v_mfma_f32_16x16x32_bf16 v[84:87], v[148:151], v[168:171], v[84:87]
ds_read_b128 v[40:43], v128 offset:4096
v_mfma_f32_16x16x32_bf16 v[116:119], v[148:151], v[172:175], v[116:119]
ds_read_b128 v[44:47], v128 offset:6144
v_mfma_f32_16x16x32_bf16 v[72:75], v[152:155], v[160:163], v[72:75]
v_fma_f32 v224, v26, v22, -v197
v_fma_f32 v225, v26, v23, v198
v_mfma_f32_16x16x32_bf16 v[104:107], v[152:155], v[164:167], v[104:107]
v_mul_f32 v197, v225, v23
v_mul_f32 v198, v225, v22
v_mfma_f32_16x16x32_bf16 v[88:91], v[152:155], v[168:171], v[88:91]
v_fma_f32 v226, v224, v22, -v197
v_fma_f32 v227, v224, v23, v198
v_mfma_f32_16x16x32_bf16 v[120:123], v[152:155], v[172:175], v[120:123]
v_mul_f32 v197, v227, v23
v_mul_f32 v198, v227, v22
v_mfma_f32_16x16x32_bf16 v[76:79], v[156:159], v[160:163], v[76:79]
v_fma_f32 v228, v226, v22, -v197
v_fma_f32 v229, v226, v23, v198
v_mfma_f32_16x16x32_bf16 v[108:111], v[156:159], v[164:167], v[108:111]
v_mul_f32 v197, v229, v23
v_mul_f32 v198, v229, v22
v_mfma_f32_16x16x32_bf16 v[92:95], v[156:159], v[168:171], v[92:95]
v_fma_f32 v230, v228, v22, -v197
v_fma_f32 v231, v228, v23, v198
v_mfma_f32_16x16x32_bf16 v[124:127], v[156:159], v[172:175], v[124:127]
v_mul_f32 v197, v231, v23
v_mul_f32 v198, v231, v22
s_waitcnt lgkmcnt(6)
v_mfma_f32_16x16x32_bf16 v[64:67], v[32:35], v[48:51], v[64:67]
ds_read_b128 v[144:147], v129 offset:0
s_waitcnt lgkmcnt(6)
v_mfma_f32_16x16x32_bf16 v[96:99], v[32:35], v[52:55], v[96:99]
ds_read_b128 v[160:163], v131 offset:0
s_waitcnt lgkmcnt(6)
v_mfma_f32_16x16x32_bf16 v[80:83], v[32:35], v[56:59], v[80:83]
ds_read_b128 v[164:167], v131 offset:2048
s_waitcnt lgkmcnt(6)
v_mfma_f32_16x16x32_bf16 v[112:115], v[32:35], v[60:63], v[112:115]
ds_read_b128 v[168:171], v131 offset:4096
s_waitcnt lgkmcnt(6)
v_mfma_f32_16x16x32_bf16 v[68:71], v[36:39], v[48:51], v[68:71]
ds_read_b128 v[172:175], v131 offset:6144
v_mfma_f32_16x16x32_bf16 v[100:103], v[36:39], v[52:55], v[100:103]
ds_read_b128 v[148:151], v129 offset:2048
v_mfma_f32_16x16x32_bf16 v[84:87], v[36:39], v[56:59], v[84:87]
ds_read_b128 v[152:155], v129 offset:4096
v_mfma_f32_16x16x32_bf16 v[116:119], v[36:39], v[60:63], v[116:119]
ds_read_b128 v[156:159], v129 offset:6144
s_waitcnt lgkmcnt(9)
v_mfma_f32_16x16x32_bf16 v[72:75], v[40:43], v[48:51], v[72:75]
v_fma_f32 v232, v230, v22, -v197
v_fma_f32 v233, v230, v23, v198
v_mfma_f32_16x16x32_bf16 v[104:107], v[40:43], v[52:55], v[104:107]
v_mul_f32 v197, v233, v23
v_mul_f32 v198, v233, v22
v_mfma_f32_16x16x32_bf16 v[88:91], v[40:43], v[56:59], v[88:91]
v_fma_f32 v234, v232, v22, -v197
v_fma_f32 v235, v232, v23, v198
v_mfma_f32_16x16x32_bf16 v[120:123], v[40:43], v[60:63], v[120:123]
v_mul_f32 v197, v235, v23
v_mul_f32 v198, v235, v22
s_waitcnt lgkmcnt(8)
v_mfma_f32_16x16x32_bf16 v[76:79], v[44:47], v[48:51], v[76:79]
v_fma_f32 v236, v234, v22, -v197
v_fma_f32 v237, v234, v23, v198
v_mfma_f32_16x16x32_bf16 v[108:111], v[44:47], v[52:55], v[108:111]
v_mul_f32 v197, v237, v23
v_mul_f32 v198, v237, v22
v_mfma_f32_16x16x32_bf16 v[92:95], v[44:47], v[56:59], v[92:95]
v_fma_f32 v238, v236, v22, -v197
v_fma_f32 v239, v236, v23, v198
v_mfma_f32_16x16x32_bf16 v[124:127], v[44:47], v[60:63], v[124:127]
v_and_b32 v197, 16, v1
v_cmp_ne_u32 vcc, 0, v197
s_waitcnt lgkmcnt(0)
s_barrier
v_mfma_f32_16x16x32_bf16 v[64:67], v[144:147], v[160:163], v[64:67]
ds_read_b128 v[32:35], v128 offset:32768
v_mfma_f32_16x16x32_bf16 v[96:99], v[144:147], v[164:167], v[96:99]
ds_read_b128 v[48:51], v130 offset:32768
v_mfma_f32_16x16x32_bf16 v[80:83], v[144:147], v[168:171], v[80:83]
ds_read_b128 v[52:55], v130 offset:34816
v_mfma_f32_16x16x32_bf16 v[112:115], v[144:147], v[172:175], v[112:115]
ds_read_b128 v[56:59], v130 offset:36864
v_mfma_f32_16x16x32_bf16 v[68:71], v[148:151], v[160:163], v[68:71]
ds_read_b128 v[60:63], v130 offset:38912
v_mfma_f32_16x16x32_bf16 v[100:103], v[148:151], v[164:167], v[100:103]
ds_read_b128 v[36:39], v128 offset:34816
v_mfma_f32_16x16x32_bf16 v[84:87], v[148:151], v[168:171], v[84:87]
ds_read_b128 v[40:43], v128 offset:36864
v_mfma_f32_16x16x32_bf16 v[116:119], v[148:151], v[172:175], v[116:119]
ds_read_b128 v[44:47], v128 offset:38912
v_mfma_f32_16x16x32_bf16 v[72:75], v[152:155], v[160:163], v[72:75]
v_cndmask_b32 v204, v204, v205, vcc
v_cndmask_b32 v206, v206, v207, vcc
v_mfma_f32_16x16x32_bf16 v[104:107], v[152:155], v[164:167], v[104:107]
v_mul_f32 v197, 0x41800000, v204
v_mul_f32 v198, 0x41800000, v206
v_mfma_f32_16x16x32_bf16 v[88:91], v[152:155], v[168:171], v[88:91]
v_exp_f32 v197, v197
v_rndne_f32 v199, v198
v_mfma_f32_16x16x32_bf16 v[120:123], v[152:155], v[172:175], v[120:123]
v_sub_f32 v198, v198, v199
v_cos_f32 v199, v198
v_mfma_f32_16x16x32_bf16 v[76:79], v[156:159], v[160:163], v[76:79]
v_sin_f32 v198, v198
v_mul_f32 v28, v197, v199
v_mfma_f32_16x16x32_bf16 v[108:111], v[156:159], v[164:167], v[108:111]
v_mul_f32 v29, v197, v198
v_mul_f32 v197, 0x42800000, v204
v_mfma_f32_16x16x32_bf16 v[92:95], v[156:159], v[168:171], v[92:95]
v_mul_f32 v198, 0x42800000, v206
v_exp_f32 v197, v197
v_mfma_f32_16x16x32_bf16 v[124:127], v[156:159], v[172:175], v[124:127]
v_rndne_f32 v199, v198
v_sub_f32 v198, v198, v199
s_waitcnt lgkmcnt(6)
v_mfma_f32_16x16x32_bf16 v[64:67], v[32:35], v[48:51], v[64:67]
ds_read_b128 v[144:147], v129 offset:32768
s_waitcnt lgkmcnt(6)
v_mfma_f32_16x16x32_bf16 v[96:99], v[32:35], v[52:55], v[96:99]
ds_read_b128 v[160:163], v131 offset:32768
s_waitcnt lgkmcnt(6)
v_mfma_f32_16x16x32_bf16 v[80:83], v[32:35], v[56:59], v[80:83]
ds_read_b128 v[164:167], v131 offset:34816
s_waitcnt lgkmcnt(6)
v_mfma_f32_16x16x32_bf16 v[112:115], v[32:35], v[60:63], v[112:115]
ds_read_b128 v[168:171], v131 offset:36864
s_waitcnt lgkmcnt(6)
v_mfma_f32_16x16x32_bf16 v[68:71], v[36:39], v[48:51], v[68:71]
ds_read_b128 v[172:175], v131 offset:38912
v_mfma_f32_16x16x32_bf16 v[100:103], v[36:39], v[52:55], v[100:103]
ds_read_b128 v[148:151], v129 offset:34816
v_mfma_f32_16x16x32_bf16 v[84:87], v[36:39], v[56:59], v[84:87]
ds_read_b128 v[152:155], v129 offset:36864
v_mfma_f32_16x16x32_bf16 v[116:119], v[36:39], v[60:63], v[116:119]
ds_read_b128 v[156:159], v129 offset:38912
s_waitcnt lgkmcnt(9)
v_mfma_f32_16x16x32_bf16 v[72:75], v[40:43], v[48:51], v[72:75]
v_cos_f32 v199, v198
v_sin_f32 v198, v198
v_mfma_f32_16x16x32_bf16 v[104:107], v[40:43], v[52:55], v[104:107]
v_mul_f32 v192, v197, v199
v_mul_f32 v193, v197, v198
v_mfma_f32_16x16x32_bf16 v[88:91], v[40:43], v[56:59], v[88:91]
v_mul_f32 v197, 0x43000000, v204
v_mul_f32 v198, 0x43000000, v206
v_mfma_f32_16x16x32_bf16 v[120:123], v[40:43], v[60:63], v[120:123]
v_exp_f32 v197, v197
v_rndne_f32 v199, v198
s_waitcnt lgkmcnt(8)
v_mfma_f32_16x16x32_bf16 v[76:79], v[44:47], v[48:51], v[76:79]
v_sub_f32 v198, v198, v199
v_cos_f32 v199, v198
v_mfma_f32_16x16x32_bf16 v[108:111], v[44:47], v[52:55], v[108:111]
v_sin_f32 v198, v198
v_mul_f32 v30, v197, v199
v_mfma_f32_16x16x32_bf16 v[92:95], v[44:47], v[56:59], v[92:95]
v_mul_f32 v31, v197, v198
v_mul_f32 v197, 0x43800000, v204
v_mfma_f32_16x16x32_bf16 v[124:127], v[44:47], v[60:63], v[124:127]
v_mul_f32 v198, 0x43800000, v206
v_exp_f32 v197, v197
s_waitcnt lgkmcnt(0)
s_barrier
v_mfma_f32_16x16x32_bf16 v[64:67], v[144:147], v[160:163], v[64:67]
ds_read_b128 v[32:35], v132 offset:0
v_mfma_f32_16x16x32_bf16 v[96:99], v[144:147], v[164:167], v[96:99]
ds_read_b128 v[48:51], v134 offset:0
v_mfma_f32_16x16x32_bf16 v[80:83], v[144:147], v[168:171], v[80:83]
ds_read_b128 v[52:55], v134 offset:2048
v_mfma_f32_16x16x32_bf16 v[112:115], v[144:147], v[172:175], v[112:115]
ds_read_b128 v[56:59], v134 offset:4096
v_mfma_f32_16x16x32_bf16 v[68:71], v[148:151], v[160:163], v[68:71]
ds_read_b128 v[60:63], v134 offset:6144
v_mfma_f32_16x16x32_bf16 v[100:103], v[148:151], v[164:167], v[100:103]
ds_read_b128 v[36:39], v132 offset:2048
v_mfma_f32_16x16x32_bf16 v[84:87], v[148:151], v[168:171], v[84:87]
ds_read_b128 v[40:43], v132 offset:4096
v_mfma_f32_16x16x32_bf16 v[116:119], v[148:151], v[172:175], v[116:119]
ds_read_b128 v[44:47], v132 offset:6144
v_mfma_f32_16x16x32_bf16 v[72:75], v[152:155], v[160:163], v[72:75]
v_rndne_f32 v199, v198
v_sub_f32 v198, v198, v199
v_mfma_f32_16x16x32_bf16 v[104:107], v[152:155], v[164:167], v[104:107]
v_cos_f32 v199, v198
v_sin_f32 v198, v198
v_mfma_f32_16x16x32_bf16 v[88:91], v[152:155], v[168:171], v[88:91]
v_mul_f32 v2, v197, v199
v_mul_f32 v3, v197, v198
v_mfma_f32_16x16x32_bf16 v[120:123], v[152:155], v[172:175], v[120:123]
v_lshrrev_b32 v197, 4, v1
v_lshlrev_b32 v197, 2, v197
v_mfma_f32_16x16x32_bf16 v[76:79], v[156:159], v[160:163], v[76:79]
v_and_b32 v198, 15, v1
v_sub_u32 v197, v198, v197
v_mfma_f32_16x16x32_bf16 v[108:111], v[156:159], v[164:167], v[108:111]
v_mov_b32 v198, 0x3f80
v_mov_b32 v199, 1.0
v_mfma_f32_16x16x32_bf16 v[92:95], v[156:159], v[168:171], v[92:95]
v_cmp_eq_u32 vcc, 0, v197
s_nop 1
v_cndmask_b32 v248, 0, v198, vcc
v_mfma_f32_16x16x32_bf16 v[124:127], v[156:159], v[172:175], v[124:127]
v_cndmask_b32 v252, 0, v199, vcc
v_cmp_eq_u32 vcc, 1, v197
s_waitcnt lgkmcnt(6)
v_mfma_f32_16x16x32_bf16 v[64:67], v[32:35], v[48:51], v[64:67]
ds_read_b128 v[144:147], v133 offset:0
s_waitcnt lgkmcnt(6)
v_mfma_f32_16x16x32_bf16 v[96:99], v[32:35], v[52:55], v[96:99]
ds_read_b128 v[160:163], v135 offset:0
s_waitcnt lgkmcnt(6)
v_mfma_f32_16x16x32_bf16 v[80:83], v[32:35], v[56:59], v[80:83]
ds_read_b128 v[164:167], v135 offset:2048
s_waitcnt lgkmcnt(6)
v_mfma_f32_16x16x32_bf16 v[112:115], v[32:35], v[60:63], v[112:115]
ds_read_b128 v[168:171], v135 offset:4096
s_waitcnt lgkmcnt(6)
v_mfma_f32_16x16x32_bf16 v[68:71], v[36:39], v[48:51], v[68:71]
ds_read_b128 v[172:175], v135 offset:6144
v_mfma_f32_16x16x32_bf16 v[100:103], v[36:39], v[52:55], v[100:103]
ds_read_b128 v[148:151], v133 offset:2048
v_mfma_f32_16x16x32_bf16 v[84:87], v[36:39], v[56:59], v[84:87]
ds_read_b128 v[152:155], v133 offset:4096
v_mfma_f32_16x16x32_bf16 v[116:119], v[36:39], v[60:63], v[116:119]
ds_read_b128 v[156:159], v133 offset:6144
s_waitcnt lgkmcnt(9)
v_mfma_f32_16x16x32_bf16 v[72:75], v[40:43], v[48:51], v[72:75]
v_cndmask_b32 v249, 0, v198, vcc
v_cndmask_b32 v253, 0, v199, vcc
v_mfma_f32_16x16x32_bf16 v[104:107], v[40:43], v[52:55], v[104:107]
v_cmp_eq_u32 vcc, 2, v197
s_nop 1
v_cndmask_b32 v250, 0, v198, vcc
v_mfma_f32_16x16x32_bf16 v[88:91], v[40:43], v[56:59], v[88:91]
v_cndmask_b32 v254, 0, v199, vcc
v_cmp_eq_u32 vcc, 3, v197
v_mfma_f32_16x16x32_bf16 v[120:123], v[40:43], v[60:63], v[120:123]
s_nop 0
v_cndmask_b32 v251, 0, v198, vcc
v_cndmask_b32 v255, 0, v199, vcc
s_waitcnt lgkmcnt(8)
v_mfma_f32_16x16x32_bf16 v[76:79], v[44:47], v[48:51], v[76:79]
v_mfma_f32_16x16x32_bf16 v[108:111], v[44:47], v[52:55], v[108:111]
v_mfma_f32_16x16x32_bf16 v[92:95], v[44:47], v[56:59], v[92:95]
v_mfma_f32_16x16x32_bf16 v[124:127], v[44:47], v[60:63], v[124:127]
s_waitcnt lgkmcnt(0)
s_barrier
v_mfma_f32_16x16x32_bf16 v[64:67], v[144:147], v[160:163], v[64:67]
ds_read_b128 v[32:35], v128 offset:0
v_mfma_f32_16x16x32_bf16 v[96:99], v[144:147], v[164:167], v[96:99]
ds_read_b128 v[48:51], v130 offset:0
v_mfma_f32_16x16x32_bf16 v[80:83], v[144:147], v[168:171], v[80:83]
ds_read_b128 v[52:55], v130 offset:2048
v_mfma_f32_16x16x32_bf16 v[112:115], v[144:147], v[172:175], v[112:115]
ds_read_b128 v[56:59], v130 offset:4096
v_mfma_f32_16x16x32_bf16 v[68:71], v[148:151], v[160:163], v[68:71]
ds_read_b128 v[60:63], v130 offset:6144
v_mfma_f32_16x16x32_bf16 v[100:103], v[148:151], v[164:167], v[100:103]
ds_read_b128 v[36:39], v128 offset:2048
v_mfma_f32_16x16x32_bf16 v[84:87], v[148:151], v[168:171], v[84:87]
ds_read_b128 v[40:43], v128 offset:4096
v_mfma_f32_16x16x32_bf16 v[116:119], v[148:151], v[172:175], v[116:119]
ds_read_b128 v[44:47], v128 offset:6144
v_mfma_f32_16x16x32_bf16 v[72:75], v[152:155], v[160:163], v[72:75]
v_mfma_f32_16x16x32_bf16 v[104:107], v[152:155], v[164:167], v[104:107]
v_mfma_f32_16x16x32_bf16 v[88:91], v[152:155], v[168:171], v[88:91]
v_mfma_f32_16x16x32_bf16 v[120:123], v[152:155], v[172:175], v[120:123]
v_mfma_f32_16x16x32_bf16 v[76:79], v[156:159], v[160:163], v[76:79]
v_mfma_f32_16x16x32_bf16 v[108:111], v[156:159], v[164:167], v[108:111]
v_mfma_f32_16x16x32_bf16 v[92:95], v[156:159], v[168:171], v[92:95]
v_mfma_f32_16x16x32_bf16 v[124:127], v[156:159], v[172:175], v[124:127]
s_waitcnt lgkmcnt(6)
v_mfma_f32_16x16x32_bf16 v[64:67], v[32:35], v[48:51], v[64:67]
ds_read_b128 v[144:147], v129 offset:0
s_waitcnt lgkmcnt(6)
v_mfma_f32_16x16x32_bf16 v[96:99], v[32:35], v[52:55], v[96:99]
ds_read_b128 v[160:163], v131 offset:0
s_waitcnt lgkmcnt(6)
v_mfma_f32_16x16x32_bf16 v[80:83], v[32:35], v[56:59], v[80:83]
ds_read_b128 v[164:167], v131 offset:2048
s_waitcnt lgkmcnt(6)
v_mfma_f32_16x16x32_bf16 v[112:115], v[32:35], v[60:63], v[112:115]
ds_read_b128 v[168:171], v131 offset:4096
s_waitcnt lgkmcnt(6)
v_mfma_f32_16x16x32_bf16 v[68:71], v[36:39], v[48:51], v[68:71]
ds_read_b128 v[172:175], v131 offset:6144
v_mfma_f32_16x16x32_bf16 v[100:103], v[36:39], v[52:55], v[100:103]
ds_read_b128 v[148:151], v129 offset:2048
v_mfma_f32_16x16x32_bf16 v[84:87], v[36:39], v[56:59], v[84:87]
ds_read_b128 v[152:155], v129 offset:4096
v_mfma_f32_16x16x32_bf16 v[116:119], v[36:39], v[60:63], v[116:119]
ds_read_b128 v[156:159], v129 offset:6144
s_waitcnt lgkmcnt(9)
v_mfma_f32_16x16x32_bf16 v[72:75], v[40:43], v[48:51], v[72:75]
v_mfma_f32_16x16x32_bf16 v[104:107], v[40:43], v[52:55], v[104:107]
v_mfma_f32_16x16x32_bf16 v[88:91], v[40:43], v[56:59], v[88:91]
v_mfma_f32_16x16x32_bf16 v[120:123], v[40:43], v[60:63], v[120:123]
s_waitcnt lgkmcnt(8)
v_mfma_f32_16x16x32_bf16 v[76:79], v[44:47], v[48:51], v[76:79]
v_mfma_f32_16x16x32_bf16 v[108:111], v[44:47], v[52:55], v[108:111]
v_mfma_f32_16x16x32_bf16 v[92:95], v[44:47], v[56:59], v[92:95]
v_mfma_f32_16x16x32_bf16 v[124:127], v[44:47], v[60:63], v[124:127]
s_waitcnt lgkmcnt(0)
s_barrier
v_mfma_f32_16x16x32_bf16 v[64:67], v[144:147], v[160:163], v[64:67]
ds_read_b128 v[32:35], v128 offset:32768
v_mfma_f32_16x16x32_bf16 v[96:99], v[144:147], v[164:167], v[96:99]
ds_read_b128 v[48:51], v130 offset:32768
v_mfma_f32_16x16x32_bf16 v[80:83], v[144:147], v[168:171], v[80:83]
ds_read_b128 v[52:55], v130 offset:34816
v_mfma_f32_16x16x32_bf16 v[112:115], v[144:147], v[172:175], v[112:115]
ds_read_b128 v[56:59], v130 offset:36864
v_mfma_f32_16x16x32_bf16 v[68:71], v[148:151], v[160:163], v[68:71]
ds_read_b128 v[60:63], v130 offset:38912
v_mfma_f32_16x16x32_bf16 v[100:103], v[148:151], v[164:167], v[100:103]
ds_read_b128 v[36:39], v128 offset:34816
v_mfma_f32_16x16x32_bf16 v[84:87], v[148:151], v[168:171], v[84:87]
ds_read_b128 v[40:43], v128 offset:36864
v_mfma_f32_16x16x32_bf16 v[116:119], v[148:151], v[172:175], v[116:119]
ds_read_b128 v[44:47], v128 offset:38912
v_mfma_f32_16x16x32_bf16 v[72:75], v[152:155], v[160:163], v[72:75]
v_mfma_f32_16x16x32_bf16 v[104:107], v[152:155], v[164:167], v[104:107]
v_mfma_f32_16x16x32_bf16 v[88:91], v[152:155], v[168:171], v[88:91]
v_mfma_f32_16x16x32_bf16 v[120:123], v[152:155], v[172:175], v[120:123]
v_mfma_f32_16x16x32_bf16 v[76:79], v[156:159], v[160:163], v[76:79]
v_mfma_f32_16x16x32_bf16 v[108:111], v[156:159], v[164:167], v[108:111]
v_mfma_f32_16x16x32_bf16 v[92:95], v[156:159], v[168:171], v[92:95]
v_mfma_f32_16x16x32_bf16 v[124:127], v[156:159], v[172:175], v[124:127]
s_waitcnt lgkmcnt(6)
v_mfma_f32_16x16x32_bf16 v[64:67], v[32:35], v[48:51], v[64:67]
ds_read_b128 v[144:147], v129 offset:32768
s_waitcnt lgkmcnt(6)
v_mfma_f32_16x16x32_bf16 v[96:99], v[32:35], v[52:55], v[96:99]
ds_read_b128 v[160:163], v131 offset:32768
s_waitcnt lgkmcnt(6)
v_mfma_f32_16x16x32_bf16 v[80:83], v[32:35], v[56:59], v[80:83]
ds_read_b128 v[164:167], v131 offset:34816
s_waitcnt lgkmcnt(6)
v_mfma_f32_16x16x32_bf16 v[112:115], v[32:35], v[60:63], v[112:115]
ds_read_b128 v[168:171], v131 offset:36864
s_waitcnt lgkmcnt(6)
v_mfma_f32_16x16x32_bf16 v[68:71], v[36:39], v[48:51], v[68:71]
ds_read_b128 v[172:175], v131 offset:38912
v_mfma_f32_16x16x32_bf16 v[100:103], v[36:39], v[52:55], v[100:103]
ds_read_b128 v[148:151], v129 offset:34816
v_mfma_f32_16x16x32_bf16 v[84:87], v[36:39], v[56:59], v[84:87]
ds_read_b128 v[152:155], v129 offset:36864
v_mfma_f32_16x16x32_bf16 v[116:119], v[36:39], v[60:63], v[116:119]
ds_read_b128 v[156:159], v129 offset:38912
s_waitcnt lgkmcnt(9)
v_mfma_f32_16x16x32_bf16 v[72:75], v[40:43], v[48:51], v[72:75]
v_mfma_f32_16x16x32_bf16 v[104:107], v[40:43], v[52:55], v[104:107]
v_mfma_f32_16x16x32_bf16 v[88:91], v[40:43], v[56:59], v[88:91]
v_mfma_f32_16x16x32_bf16 v[120:123], v[40:43], v[60:63], v[120:123]
s_waitcnt lgkmcnt(8)
v_mfma_f32_16x16x32_bf16 v[76:79], v[44:47], v[48:51], v[76:79]
v_mfma_f32_16x16x32_bf16 v[108:111], v[44:47], v[52:55], v[108:111]
v_mfma_f32_16x16x32_bf16 v[92:95], v[44:47], v[56:59], v[92:95]
v_mfma_f32_16x16x32_bf16 v[124:127], v[44:47], v[60:63], v[124:127]
s_waitcnt lgkmcnt(0)
s_barrier
v_mfma_f32_16x16x32_bf16 v[64:67], v[144:147], v[160:163], v[64:67]
ds_read_b128 v[32:35], v132 offset:0
v_mfma_f32_16x16x32_bf16 v[96:99], v[144:147], v[164:167], v[96:99]
ds_read_b128 v[48:51], v134 offset:0
v_mfma_f32_16x16x32_bf16 v[80:83], v[144:147], v[168:171], v[80:83]
ds_read_b128 v[52:55], v134 offset:2048
v_mfma_f32_16x16x32_bf16 v[112:115], v[144:147], v[172:175], v[112:115]
ds_read_b128 v[56:59], v134 offset:4096
v_mfma_f32_16x16x32_bf16 v[68:71], v[148:151], v[160:163], v[68:71]
ds_read_b128 v[60:63], v134 offset:6144
v_mfma_f32_16x16x32_bf16 v[100:103], v[148:151], v[164:167], v[100:103]
ds_read_b128 v[36:39], v132 offset:2048
v_mfma_f32_16x16x32_bf16 v[84:87], v[148:151], v[168:171], v[84:87]
ds_read_b128 v[40:43], v132 offset:4096
v_mfma_f32_16x16x32_bf16 v[116:119], v[148:151], v[172:175], v[116:119]
ds_read_b128 v[44:47], v132 offset:6144
v_mfma_f32_16x16x32_bf16 v[72:75], v[152:155], v[160:163], v[72:75]
v_mfma_f32_16x16x32_bf16 v[104:107], v[152:155], v[164:167], v[104:107]
v_mfma_f32_16x16x32_bf16 v[88:91], v[152:155], v[168:171], v[88:91]
v_mfma_f32_16x16x32_bf16 v[120:123], v[152:155], v[172:175], v[120:123]
v_mfma_f32_16x16x32_bf16 v[76:79], v[156:159], v[160:163], v[76:79]
v_mfma_f32_16x16x32_bf16 v[108:111], v[156:159], v[164:167], v[108:111]
v_mfma_f32_16x16x32_bf16 v[92:95], v[156:159], v[168:171], v[92:95]
v_mfma_f32_16x16x32_bf16 v[124:127], v[156:159], v[172:175], v[124:127]
s_waitcnt lgkmcnt(6)
v_mfma_f32_16x16x32_bf16 v[64:67], v[32:35], v[48:51], v[64:67]
ds_read_b128 v[144:147], v133 offset:0
s_waitcnt lgkmcnt(6)
v_mfma_f32_16x16x32_bf16 v[96:99], v[32:35], v[52:55], v[96:99]
ds_read_b128 v[160:163], v135 offset:0
s_waitcnt lgkmcnt(6)
v_mfma_f32_16x16x32_bf16 v[80:83], v[32:35], v[56:59], v[80:83]
ds_read_b128 v[164:167], v135 offset:2048
s_waitcnt lgkmcnt(6)
v_mfma_f32_16x16x32_bf16 v[112:115], v[32:35], v[60:63], v[112:115]
ds_read_b128 v[168:171], v135 offset:4096
s_waitcnt lgkmcnt(6)
v_mfma_f32_16x16x32_bf16 v[68:71], v[36:39], v[48:51], v[68:71]
ds_read_b128 v[172:175], v135 offset:6144
v_mfma_f32_16x16x32_bf16 v[100:103], v[36:39], v[52:55], v[100:103]
ds_read_b128 v[148:151], v133 offset:2048
v_mfma_f32_16x16x32_bf16 v[84:87], v[36:39], v[56:59], v[84:87]
ds_read_b128 v[152:155], v133 offset:4096
v_mfma_f32_16x16x32_bf16 v[116:119], v[36:39], v[60:63], v[116:119]
ds_read_b128 v[156:159], v133 offset:6144
s_waitcnt lgkmcnt(9)
v_mfma_f32_16x16x32_bf16 v[72:75], v[40:43], v[48:51], v[72:75]
v_mfma_f32_16x16x32_bf16 v[104:107], v[40:43], v[52:55], v[104:107]
v_mfma_f32_16x16x32_bf16 v[88:91], v[40:43], v[56:59], v[88:91]
v_mfma_f32_16x16x32_bf16 v[120:123], v[40:43], v[60:63], v[120:123]
s_waitcnt lgkmcnt(8)
v_mfma_f32_16x16x32_bf16 v[76:79], v[44:47], v[48:51], v[76:79]
v_mfma_f32_16x16x32_bf16 v[108:111], v[44:47], v[52:55], v[108:111]
v_mfma_f32_16x16x32_bf16 v[92:95], v[44:47], v[56:59], v[92:95]
v_mfma_f32_16x16x32_bf16 v[124:127], v[44:47], v[60:63], v[124:127]
s_waitcnt lgkmcnt(0)
s_barrier
v_mfma_f32_16x16x32_bf16 v[64:67], v[144:147], v[160:163], v[64:67]
ds_read_b128 v[32:35], v128 offset:0
v_mfma_f32_16x16x32_bf16 v[96:99], v[144:147], v[164:167], v[96:99]
ds_read_b128 v[48:51], v130 offset:0
v_mfma_f32_16x16x32_bf16 v[80:83], v[144:147], v[168:171], v[80:83]
ds_read_b128 v[52:55], v130 offset:2048
v_mfma_f32_16x16x32_bf16 v[112:115], v[144:147], v[172:175], v[112:115]
ds_read_b128 v[56:59], v130 offset:4096
v_mfma_f32_16x16x32_bf16 v[68:71], v[148:151], v[160:163], v[68:71]
ds_read_b128 v[60:63], v130 offset:6144
v_mfma_f32_16x16x32_bf16 v[100:103], v[148:151], v[164:167], v[100:103]
ds_read_b128 v[36:39], v128 offset:2048
v_mfma_f32_16x16x32_bf16 v[84:87], v[148:151], v[168:171], v[84:87]
ds_read_b128 v[40:43], v128 offset:4096
v_mfma_f32_16x16x32_bf16 v[116:119], v[148:151], v[172:175], v[116:119]
ds_read_b128 v[44:47], v128 offset:6144
v_mfma_f32_16x16x32_bf16 v[72:75], v[152:155], v[160:163], v[72:75]
v_mfma_f32_16x16x32_bf16 v[104:107], v[152:155], v[164:167], v[104:107]
v_mfma_f32_16x16x32_bf16 v[88:91], v[152:155], v[168:171], v[88:91]
v_mfma_f32_16x16x32_bf16 v[120:123], v[152:155], v[172:175], v[120:123]
v_mfma_f32_16x16x32_bf16 v[76:79], v[156:159], v[160:163], v[76:79]
v_mfma_f32_16x16x32_bf16 v[108:111], v[156:159], v[164:167], v[108:111]
v_mfma_f32_16x16x32_bf16 v[92:95], v[156:159], v[168:171], v[92:95]
v_mfma_f32_16x16x32_bf16 v[124:127], v[156:159], v[172:175], v[124:127]
s_waitcnt lgkmcnt(6)
v_mfma_f32_16x16x32_bf16 v[64:67], v[32:35], v[48:51], v[64:67]
ds_read_b128 v[144:147], v129 offset:0
s_waitcnt lgkmcnt(6)
v_mfma_f32_16x16x32_bf16 v[96:99], v[32:35], v[52:55], v[96:99]
ds_read_b128 v[160:163], v131 offset:0
s_waitcnt lgkmcnt(6)
v_mfma_f32_16x16x32_bf16 v[80:83], v[32:35], v[56:59], v[80:83]
ds_read_b128 v[164:167], v131 offset:2048
s_waitcnt lgkmcnt(6)
v_mfma_f32_16x16x32_bf16 v[112:115], v[32:35], v[60:63], v[112:115]
ds_read_b128 v[168:171], v131 offset:4096
s_waitcnt lgkmcnt(6)
v_mfma_f32_16x16x32_bf16 v[68:71], v[36:39], v[48:51], v[68:71]
ds_read_b128 v[172:175], v131 offset:6144
v_mfma_f32_16x16x32_bf16 v[100:103], v[36:39], v[52:55], v[100:103]
ds_read_b128 v[148:151], v129 offset:2048
v_mfma_f32_16x16x32_bf16 v[84:87], v[36:39], v[56:59], v[84:87]
ds_read_b128 v[152:155], v129 offset:4096
v_mfma_f32_16x16x32_bf16 v[116:119], v[36:39], v[60:63], v[116:119]
ds_read_b128 v[156:159], v129 offset:6144
s_waitcnt lgkmcnt(9)
v_mfma_f32_16x16x32_bf16 v[72:75], v[40:43], v[48:51], v[72:75]
v_mfma_f32_16x16x32_bf16 v[104:107], v[40:43], v[52:55], v[104:107]
v_mfma_f32_16x16x32_bf16 v[88:91], v[40:43], v[56:59], v[88:91]
v_mfma_f32_16x16x32_bf16 v[120:123], v[40:43], v[60:63], v[120:123]
s_waitcnt lgkmcnt(8)
v_mfma_f32_16x16x32_bf16 v[76:79], v[44:47], v[48:51], v[76:79]
v_mfma_f32_16x16x32_bf16 v[108:111], v[44:47], v[52:55], v[108:111]
v_mfma_f32_16x16x32_bf16 v[92:95], v[44:47], v[56:59], v[92:95]
v_mfma_f32_16x16x32_bf16 v[124:127], v[44:47], v[60:63], v[124:127]
s_waitcnt lgkmcnt(0)
s_barrier
v_mfma_f32_16x16x32_bf16 v[64:67], v[144:147], v[160:163], v[64:67]
ds_read_b128 v[32:35], v128 offset:32768
v_mfma_f32_16x16x32_bf16 v[96:99], v[144:147], v[164:167], v[96:99]
ds_read_b128 v[48:51], v130 offset:32768
v_mfma_f32_16x16x32_bf16 v[80:83], v[144:147], v[168:171], v[80:83]
ds_read_b128 v[52:55], v130 offset:34816
v_mfma_f32_16x16x32_bf16 v[112:115], v[144:147], v[172:175], v[112:115]
ds_read_b128 v[56:59], v130 offset:36864
v_mfma_f32_16x16x32_bf16 v[68:71], v[148:151], v[160:163], v[68:71]
ds_read_b128 v[60:63], v130 offset:38912
v_mfma_f32_16x16x32_bf16 v[100:103], v[148:151], v[164:167], v[100:103]
ds_read_b128 v[36:39], v128 offset:34816
v_mfma_f32_16x16x32_bf16 v[84:87], v[148:151], v[168:171], v[84:87]
ds_read_b128 v[40:43], v128 offset:36864
v_mfma_f32_16x16x32_bf16 v[116:119], v[148:151], v[172:175], v[116:119]
ds_read_b128 v[44:47], v128 offset:38912
v_mfma_f32_16x16x32_bf16 v[72:75], v[152:155], v[160:163], v[72:75]
v_mfma_f32_16x16x32_bf16 v[104:107], v[152:155], v[164:167], v[104:107]
v_mfma_f32_16x16x32_bf16 v[88:91], v[152:155], v[168:171], v[88:91]
v_mfma_f32_16x16x32_bf16 v[120:123], v[152:155], v[172:175], v[120:123]
v_mfma_f32_16x16x32_bf16 v[76:79], v[156:159], v[160:163], v[76:79]
v_mfma_f32_16x16x32_bf16 v[108:111], v[156:159], v[164:167], v[108:111]
v_mfma_f32_16x16x32_bf16 v[92:95], v[156:159], v[168:171], v[92:95]
v_mfma_f32_16x16x32_bf16 v[124:127], v[156:159], v[172:175], v[124:127]
v_mov_b32 v8, 0
global_load_dword v9, v8, s[30:31] sc1
s_waitcnt lgkmcnt(6)
v_mfma_f32_16x16x32_bf16 v[64:67], v[32:35], v[48:51], v[64:67]
ds_read_b128 v[144:147], v129 offset:32768
s_waitcnt lgkmcnt(6)
v_mfma_f32_16x16x32_bf16 v[96:99], v[32:35], v[52:55], v[96:99]
ds_read_b128 v[160:163], v131 offset:32768
s_waitcnt lgkmcnt(6)
v_mfma_f32_16x16x32_bf16 v[80:83], v[32:35], v[56:59], v[80:83]
ds_read_b128 v[164:167], v131 offset:34816
s_waitcnt lgkmcnt(6)
v_mfma_f32_16x16x32_bf16 v[112:115], v[32:35], v[60:63], v[112:115]
ds_read_b128 v[168:171], v131 offset:36864
s_waitcnt lgkmcnt(6)
v_mfma_f32_16x16x32_bf16 v[68:71], v[36:39], v[48:51], v[68:71]
ds_read_b128 v[172:175], v131 offset:38912
v_mfma_f32_16x16x32_bf16 v[100:103], v[36:39], v[52:55], v[100:103]
ds_read_b128 v[148:151], v129 offset:34816
v_mfma_f32_16x16x32_bf16 v[84:87], v[36:39], v[56:59], v[84:87]
ds_read_b128 v[152:155], v129 offset:36864
v_mfma_f32_16x16x32_bf16 v[116:119], v[36:39], v[60:63], v[116:119]
ds_read_b128 v[156:159], v129 offset:38912
s_waitcnt lgkmcnt(9)
v_mfma_f32_16x16x32_bf16 v[72:75], v[40:43], v[48:51], v[72:75]
v_mfma_f32_16x16x32_bf16 v[104:107], v[40:43], v[52:55], v[104:107]
v_mfma_f32_16x16x32_bf16 v[88:91], v[40:43], v[56:59], v[88:91]
v_mfma_f32_16x16x32_bf16 v[120:123], v[40:43], v[60:63], v[120:123]
s_waitcnt lgkmcnt(8)
v_mfma_f32_16x16x32_bf16 v[76:79], v[44:47], v[48:51], v[76:79]
v_mfma_f32_16x16x32_bf16 v[108:111], v[44:47], v[52:55], v[108:111]
v_mfma_f32_16x16x32_bf16 v[92:95], v[44:47], v[56:59], v[92:95]
v_mfma_f32_16x16x32_bf16 v[124:127], v[44:47], v[60:63], v[124:127]
s_waitcnt lgkmcnt(0)
s_barrier
v_mfma_f32_16x16x32_bf16 v[64:67], v[144:147], v[160:163], v[64:67]
ds_read_b128 v[32:35], v132 offset:0
v_mfma_f32_16x16x32_bf16 v[96:99], v[144:147], v[164:167], v[96:99]
ds_read_b128 v[48:51], v134 offset:0
v_mfma_f32_16x16x32_bf16 v[80:83], v[144:147], v[168:171], v[80:83]
ds_read_b128 v[52:55], v134 offset:2048
v_mfma_f32_16x16x32_bf16 v[112:115], v[144:147], v[172:175], v[112:115]
ds_read_b128 v[56:59], v134 offset:4096
v_mfma_f32_16x16x32_bf16 v[68:71], v[148:151], v[160:163], v[68:71]
ds_read_b128 v[60:63], v134 offset:6144
v_mfma_f32_16x16x32_bf16 v[100:103], v[148:151], v[164:167], v[100:103]
ds_read_b128 v[36:39], v132 offset:2048
v_mfma_f32_16x16x32_bf16 v[84:87], v[148:151], v[168:171], v[84:87]
ds_read_b128 v[40:43], v132 offset:4096
v_mfma_f32_16x16x32_bf16 v[116:119], v[148:151], v[172:175], v[116:119]
ds_read_b128 v[44:47], v132 offset:6144
v_mfma_f32_16x16x32_bf16 v[72:75], v[152:155], v[160:163], v[72:75]
v_mfma_f32_16x16x32_bf16 v[104:107], v[152:155], v[164:167], v[104:107]
v_mfma_f32_16x16x32_bf16 v[88:91], v[152:155], v[168:171], v[88:91]
v_mfma_f32_16x16x32_bf16 v[120:123], v[152:155], v[172:175], v[120:123]
v_mfma_f32_16x16x32_bf16 v[76:79], v[156:159], v[160:163], v[76:79]
v_mfma_f32_16x16x32_bf16 v[108:111], v[156:159], v[164:167], v[108:111]
v_mfma_f32_16x16x32_bf16 v[92:95], v[156:159], v[168:171], v[92:95]
v_mfma_f32_16x16x32_bf16 v[124:127], v[156:159], v[172:175], v[124:127]
s_waitcnt lgkmcnt(6)
v_mfma_f32_16x16x32_bf16 v[64:67], v[32:35], v[48:51], v[64:67]
ds_read_b128 v[144:147], v133 offset:0
s_waitcnt lgkmcnt(6)
v_mfma_f32_16x16x32_bf16 v[96:99], v[32:35], v[52:55], v[96:99]
ds_read_b128 v[160:163], v135 offset:0
s_waitcnt lgkmcnt(6)
v_mfma_f32_16x16x32_bf16 v[80:83], v[32:35], v[56:59], v[80:83]
ds_read_b128 v[164:167], v135 offset:2048
s_waitcnt lgkmcnt(6)
v_mfma_f32_16x16x32_bf16 v[112:115], v[32:35], v[60:63], v[112:115]
ds_read_b128 v[168:171], v135 offset:4096
s_waitcnt lgkmcnt(6)
v_mfma_f32_16x16x32_bf16 v[68:71], v[36:39], v[48:51], v[68:71]
ds_read_b128 v[172:175], v135 offset:6144
v_mfma_f32_16x16x32_bf16 v[100:103], v[36:39], v[52:55], v[100:103]
ds_read_b128 v[148:151], v133 offset:2048
v_mfma_f32_16x16x32_bf16 v[84:87], v[36:39], v[56:59], v[84:87]
ds_read_b128 v[152:155], v133 offset:4096
v_mfma_f32_16x16x32_bf16 v[116:119], v[36:39], v[60:63], v[116:119]
ds_read_b128 v[156:159], v133 offset:6144
s_waitcnt lgkmcnt(9)
v_mfma_f32_16x16x32_bf16 v[72:75], v[40:43], v[48:51], v[72:75]
v_mfma_f32_16x16x32_bf16 v[104:107], v[40:43], v[52:55], v[104:107]
v_mfma_f32_16x16x32_bf16 v[88:91], v[40:43], v[56:59], v[88:91]
v_mfma_f32_16x16x32_bf16 v[120:123], v[40:43], v[60:63], v[120:123]
s_waitcnt lgkmcnt(8)
v_mfma_f32_16x16x32_bf16 v[76:79], v[44:47], v[48:51], v[76:79]
v_mfma_f32_16x16x32_bf16 v[108:111], v[44:47], v[52:55], v[108:111]
v_mfma_f32_16x16x32_bf16 v[92:95], v[44:47], v[56:59], v[92:95]
v_mfma_f32_16x16x32_bf16 v[124:127], v[44:47], v[60:63], v[124:127]
s_waitcnt lgkmcnt(0)
s_barrier
v_mfma_f32_16x16x32_bf16 v[64:67], v[144:147], v[160:163], v[64:67]
ds_read_b128 v[32:35], v128 offset:0
v_mfma_f32_16x16x32_bf16 v[96:99], v[144:147], v[164:167], v[96:99]
ds_read_b128 v[48:51], v130 offset:0
v_mfma_f32_16x16x32_bf16 v[80:83], v[144:147], v[168:171], v[80:83]
ds_read_b128 v[52:55], v130 offset:2048
v_mfma_f32_16x16x32_bf16 v[112:115], v[144:147], v[172:175], v[112:115]
ds_read_b128 v[56:59], v130 offset:4096
v_mfma_f32_16x16x32_bf16 v[68:71], v[148:151], v[160:163], v[68:71]
ds_read_b128 v[60:63], v130 offset:6144
v_mfma_f32_16x16x32_bf16 v[100:103], v[148:151], v[164:167], v[100:103]
ds_read_b128 v[36:39], v128 offset:2048
v_mfma_f32_16x16x32_bf16 v[84:87], v[148:151], v[168:171], v[84:87]
ds_read_b128 v[40:43], v128 offset:4096
v_mfma_f32_16x16x32_bf16 v[116:119], v[148:151], v[172:175], v[116:119]
ds_read_b128 v[44:47], v128 offset:6144
v_mfma_f32_16x16x32_bf16 v[72:75], v[152:155], v[160:163], v[72:75]
v_mfma_f32_16x16x32_bf16 v[104:107], v[152:155], v[164:167], v[104:107]
v_mfma_f32_16x16x32_bf16 v[88:91], v[152:155], v[168:171], v[88:91]
v_mfma_f32_16x16x32_bf16 v[120:123], v[152:155], v[172:175], v[120:123]
v_mfma_f32_16x16x32_bf16 v[76:79], v[156:159], v[160:163], v[76:79]
v_mfma_f32_16x16x32_bf16 v[108:111], v[156:159], v[164:167], v[108:111]
v_mfma_f32_16x16x32_bf16 v[92:95], v[156:159], v[168:171], v[92:95]
v_mfma_f32_16x16x32_bf16 v[124:127], v[156:159], v[172:175], v[124:127]
s_waitcnt lgkmcnt(6)
v_mfma_f32_16x16x32_bf16 v[64:67], v[32:35], v[48:51], v[64:67]
ds_read_b128 v[144:147], v129 offset:0
s_waitcnt lgkmcnt(6)
v_mfma_f32_16x16x32_bf16 v[96:99], v[32:35], v[52:55], v[96:99]
ds_read_b128 v[160:163], v131 offset:0
s_waitcnt lgkmcnt(6)
v_mfma_f32_16x16x32_bf16 v[80:83], v[32:35], v[56:59], v[80:83]
ds_read_b128 v[164:167], v131 offset:2048
s_waitcnt lgkmcnt(6)
v_mfma_f32_16x16x32_bf16 v[112:115], v[32:35], v[60:63], v[112:115]
ds_read_b128 v[168:171], v131 offset:4096
s_waitcnt lgkmcnt(6)
v_mfma_f32_16x16x32_bf16 v[68:71], v[36:39], v[48:51], v[68:71]
ds_read_b128 v[172:175], v131 offset:6144
v_mfma_f32_16x16x32_bf16 v[100:103], v[36:39], v[52:55], v[100:103]
ds_read_b128 v[148:151], v129 offset:2048
v_mfma_f32_16x16x32_bf16 v[84:87], v[36:39], v[56:59], v[84:87]
ds_read_b128 v[152:155], v129 offset:4096
v_mfma_f32_16x16x32_bf16 v[116:119], v[36:39], v[60:63], v[116:119]
ds_read_b128 v[156:159], v129 offset:6144
s_waitcnt lgkmcnt(9)
v_mfma_f32_16x16x32_bf16 v[72:75], v[40:43], v[48:51], v[72:75]
v_mfma_f32_16x16x32_bf16 v[104:107], v[40:43], v[52:55], v[104:107]
v_mfma_f32_16x16x32_bf16 v[88:91], v[40:43], v[56:59], v[88:91]
v_mfma_f32_16x16x32_bf16 v[120:123], v[40:43], v[60:63], v[120:123]
s_waitcnt lgkmcnt(8)
v_mfma_f32_16x16x32_bf16 v[76:79], v[44:47], v[48:51], v[76:79]
v_mfma_f32_16x16x32_bf16 v[108:111], v[44:47], v[52:55], v[108:111]
v_mfma_f32_16x16x32_bf16 v[92:95], v[44:47], v[56:59], v[92:95]
v_mfma_f32_16x16x32_bf16 v[124:127], v[44:47], v[60:63], v[124:127]
L_n48:
s_waitcnt vmcnt(0)
v_readfirstlane_b32 s37, v9
s_nop 0
s_cmp_lg_u32 s37, 0
s_cbranch_scc1 L_ng49
global_load_dword v9, v8, s[30:31] sc1
s_branch L_n48
L_ng49:
s_getreg_b32 s60, hwreg(HW_REG_XCC_ID, 0, 4)
s_lshl_b32 s61, s37, 4
s_or_b32 s100, s60, s61
v_mov_b32 v194, s100
v_mov_b32 v202, s37
v_mov_b32 v203, s37
s_waitcnt lgkmcnt(0)
v_mfma_f32_16x16x32_bf16 v[64:67], v[144:147], v[160:163], v[64:67]
v_mfma_f32_16x16x32_bf16 v[96:99], v[144:147], v[164:167], v[96:99]
v_mfma_f32_16x16x32_bf16 v[80:83], v[144:147], v[168:171], v[80:83]
v_mfma_f32_16x16x32_bf16 v[112:115], v[144:147], v[172:175], v[112:115]
v_mfma_f32_16x16x32_bf16 v[68:71], v[148:151], v[160:163], v[68:71]
v_mfma_f32_16x16x32_bf16 v[100:103], v[148:151], v[164:167], v[100:103]
v_mfma_f32_16x16x32_bf16 v[84:87], v[148:151], v[168:171], v[84:87]
v_mfma_f32_16x16x32_bf16 v[116:119], v[148:151], v[172:175], v[116:119]
v_mfma_f32_16x16x32_bf16 v[72:75], v[152:155], v[160:163], v[72:75]
v_mfma_f32_16x16x32_bf16 v[104:107], v[152:155], v[164:167], v[104:107]
v_mfma_f32_16x16x32_bf16 v[88:91], v[152:155], v[168:171], v[88:91]
v_mfma_f32_16x16x32_bf16 v[120:123], v[152:155], v[172:175], v[120:123]
v_mfma_f32_16x16x32_bf16 v[76:79], v[156:159], v[160:163], v[76:79]
v_mfma_f32_16x16x32_bf16 v[108:111], v[156:159], v[164:167], v[108:111]
v_mfma_f32_16x16x32_bf16 v[92:95], v[156:159], v[168:171], v[92:95]
v_mfma_f32_16x16x32_bf16 v[124:127], v[156:159], v[172:175], v[124:127]
v_pk_fma_f32 v[40:41], v[20:21], v[64:65], v[66:67] op_sel_hi:[0,1,1]
v_pk_fma_f32 v[42:43], v[20:21], v[80:81], v[82:83] op_sel_hi:[0,1,1]
v_pk_fma_f32 v[44:45], v[22:23], v[96:97], v[98:99] op_sel_hi:[0,1,1]
v_pk_fma_f32 v[46:47], v[22:23], v[112:113], v[114:115] op_sel_hi:[0,1,1]
v_pk_fma_f32 v[66:67], v[20:21], v[80:81], v[40:41] op_sel:[1,0,0] neg_lo:[1,0,0] neg_hi:[1,0,0]
v_pk_fma_f32 v[82:83], v[20:21], v[64:65], v[42:43] op_sel:[1,0,0]
v_pk_fma_f32 v[98:99], v[22:23], v[112:113], v[44:45] op_sel:[1,0,0] neg_lo:[1,0,0] neg_hi:[1,0,0]
v_pk_fma_f32 v[114:115], v[22:23], v[96:97], v[46:47] op_sel:[1,0,0]
v_pk_fma_f32 v[40:41], v[20:21], v[66:67], v[68:69] op_sel_hi:[0,1,1]
v_pk_fma_f32 v[42:43], v[20:21], v[82:83], v[84:85] op_sel_hi:[0,1,1]
v_pk_fma_f32 v[44:45], v[22:23], v[98:99], v[100:101] op_sel_hi:[0,1,1]
v_pk_fma_f32 v[46:47], v[22:23], v[114:115], v[116:117] op_sel_hi:[0,1,1]
v_pk_fma_f32 v[68:69], v[20:21], v[82:83], v[40:41] op_sel:[1,0,0] neg_lo:[1,0,0] neg_hi:[1,0,0]
v_pk_fma_f32 v[84:85], v[20:21], v[66:67], v[42:43] op_sel:[1,0,0]
v_pk_fma_f32 v[100:101], v[22:23], v[114:115], v[44:45] op_sel:[1,0,0] neg_lo:[1,0,0] neg_hi:[1,0,0]
v_pk_fma_f32 v[116:117], v[22:23], v[98:99], v[46:47] op_sel:[1,0,0]
v_pk_fma_f32 v[40:41], v[20:21], v[68:69], v[70:71] op_sel_hi:[0,1,1]
v_pk_fma_f32 v[42:43], v[20:21], v[84:85], v[86:87] op_sel_hi:[0,1,1]
v_pk_fma_f32 v[44:45], v[22:23], v[100:101], v[102:103] op_sel_hi:[0,1,1]
v_pk_fma_f32 v[46:47], v[22:23], v[116:117], v[118:119] op_sel_hi:[0,1,1]
v_pk_fma_f32 v[70:71], v[20:21], v[84:85], v[40:41] op_sel:[1,0,0] neg_lo:[1,0,0] neg_hi:[1,0,0]
v_pk_fma_f32 v[86:87], v[20:21], v[68:69], v[42:43] op_sel:[1,0,0]
v_pk_fma_f32 v[102:103], v[22:23], v[116:117], v[44:45] op_sel:[1,0,0] neg_lo:[1,0,0] neg_hi:[1,0,0]
v_pk_fma_f32 v[118:119], v[22:23], v[100:101], v[46:47] op_sel:[1,0,0]
v_pk_fma_f32 v[40:41], v[20:21], v[70:71], v[72:73] op_sel_hi:[0,1,1]
v_pk_fma_f32 v[42:43], v[20:21], v[86:87], v[88:89] op_sel_hi:[0,1,1]
v_pk_fma_f32 v[44:45], v[22:23], v[102:103], v[104:105] op_sel_hi:[0,1,1]
v_pk_fma_f32 v[46:47], v[22:23], v[118:119], v[120:121] op_sel_hi:[0,1,1]
v_pk_fma_f32 v[72:73], v[20:21], v[86:87], v[40:41] op_sel:[1,0,0] neg_lo:[1,0,0] neg_hi:[1,0,0]
v_pk_fma_f32 v[88:89], v[20:21], v[70:71], v[42:43] op_sel:[1,0,0]
v_pk_fma_f32 v[104:105], v[22:23], v[118:119], v[44:45] op_sel:[1,0,0] neg_lo:[1,0,0] neg_hi:[1,0,0]
v_pk_fma_f32 v[120:121], v[22:23], v[102:103], v[46:47] op_sel:[1,0,0]
v_pk_fma_f32 v[40:41], v[20:21], v[72:73], v[74:75] op_sel_hi:[0,1,1]
v_pk_fma_f32 v[42:43], v[20:21], v[88:89], v[90:91] op_sel_hi:[0,1,1]
v_pk_fma_f32 v[44:45], v[22:23], v[104:105], v[106:107] op_sel_hi:[0,1,1]
v_pk_fma_f32 v[46:47], v[22:23], v[120:121], v[122:123] op_sel_hi:[0,1,1]
v_pk_fma_f32 v[74:75], v[20:21], v[88:89], v[40:41] op_sel:[1,0,0] neg_lo:[1,0,0] neg_hi:[1,0,0]
v_pk_fma_f32 v[90:91], v[20:21], v[72:73], v[42:43] op_sel:[1,0,0]
v_pk_fma_f32 v[106:107], v[22:23], v[120:121], v[44:45] op_sel:[1,0,0] neg_lo:[1,0,0] neg_hi:[1,0,0]
v_pk_fma_f32 v[122:123], v[22:23], v[104:105], v[46:47] op_sel:[1,0,0]
v_pk_fma_f32 v[40:41], v[20:21], v[74:75], v[76:77] op_sel_hi:[0,1,1]
v_pk_fma_f32 v[42:43], v[20:21], v[90:91], v[92:93] op_sel_hi:[0,1,1]
v_pk_fma_f32 v[44:45], v[22:23], v[106:107], v[108:109] op_sel_hi:[0,1,1]
v_pk_fma_f32 v[46:47], v[22:23], v[122:123], v[124:125] op_sel_hi:[0,1,1]
v_pk_fma_f32 v[76:77], v[20:21], v[90:91], v[40:41] op_sel:[1,0,0] neg_lo:[1,0,0] neg_hi:[1,0,0]
v_pk_fma_f32 v[92:93], v[20:21], v[74:75], v[42:43] op_sel:[1,0,0]
v_pk_fma_f32 v[108:109], v[22:23], v[122:123], v[44:45] op_sel:[1,0,0] neg_lo:[1,0,0] neg_hi:[1,0,0]
v_pk_fma_f32 v[124:125], v[22:23], v[106:107], v[46:47] op_sel:[1,0,0]
v_pk_fma_f32 v[40:41], v[20:21], v[76:77], v[78:79] op_sel_hi:[0,1,1]
v_pk_fma_f32 v[42:43], v[20:21], v[92:93], v[94:95] op_sel_hi:[0,1,1]
v_pk_fma_f32 v[44:45], v[22:23], v[108:109], v[110:111] op_sel_hi:[0,1,1]
v_pk_fma_f32 v[46:47], v[22:23], v[124:125], v[126:127] op_sel_hi:[0,1,1]
v_pk_fma_f32 v[78:79], v[20:21], v[92:93], v[40:41] op_sel:[1,0,0] neg_lo:[1,0,0] neg_hi:[1,0,0]
v_pk_fma_f32 v[94:95], v[20:21], v[76:77], v[42:43] op_sel:[1,0,0]
v_pk_fma_f32 v[110:111], v[22:23], v[124:125], v[44:45] op_sel:[1,0,0] neg_lo:[1,0,0] neg_hi:[1,0,0]
v_pk_fma_f32 v[126:127], v[22:23], v[108:109], v[46:47] op_sel:[1,0,0]
v_fma_f32 v40, v176, v78, v79
v_fma_f32 v41, v176, v94, v95
v_fma_f32 v32, -v177, v94, v40
v_fma_f32 v33, v177, v78, v41
ds_write_b64 v15, v[32:33] offset:0
v_fma_f32 v40, v178, v110, v111
v_fma_f32 v41, v178, v126, v127
v_fma_f32 v34, -v179, v126, v40
v_fma_f32 v35, v179, v110, v41
ds_write_b64 v15, v[34:35] offset:2304
s_waitcnt lgkmcnt(0)
s_mov_b64 exec, 1
v_mov_b32 v197, 17
ds_write_b32 v13, v197 offset:32
s_mov_b64 exec, -1
L_ek50:
ds_read_b128 v[198:201], v12 offset:32
s_waitcnt lgkmcnt(0)
v_min3_u32 v197, v198, v199, v200
v_min_u32 v197, v197, v201
s_nop 0
v_readfirstlane_b32 s60, v197
s_nop 0
s_cmp_lt_u32 s60, 17
s_cbranch_scc1 L_ek50
ds_read_b128 v[48:51], v14
ds_read_b128 v[52:55], v14 offset:16
s_waitcnt lgkmcnt(1)
v_fma_f32 v40, v28, v48, v50
v_fma_f32 v41, v28, v49, v51
v_fma_f32 v32, -v29, v49, v40
v_fma_f32 v33, v29, v48, v41
s_waitcnt lgkmcnt(0)
v_fma_f32 v40, v28, v32, v52
v_fma_f32 v41, v28, v33, v53
v_fma_f32 v34, -v29, v33, v40
v_fma_f32 v35, v29, v32, v41
v_fma_f32 v40, v28, v34, v54
v_fma_f32 v41, v28, v35, v55
v_fma_f32 v32, -v29, v35, v40
v_fma_f32 v33, v29, v34, v41
v_mov_b32 v34, v32
v_mov_b32 v35, v33
s_nop 0
v_permlane32_swap_b32 v32, v34
v_permlane32_swap_b32 v33, v35
v_fma_f32 v40, v192, v32, v34
v_fma_f32 v41, v192, v33, v35
v_fma_f32 v200, -v193, v33, v40
v_fma_f32 v201, v193, v32, v41
s_cmp_lg_u32 s68, 0
s_cbranch_scc1 L_np52
buffer_store_dwordx4 v[200:203], v16, s[40:43], 0 offen sc1
s_cmp_lg_u32 s66, 0
s_cbranch_scc1 L_np52
s_mov_b64 exec, 1
global_store_dword v195, v194, s[32:33] sc1
s_mov_b64 exec, -1
L_np52:
global_load_dword v243, v18, s[32:33] sc1
v_add_u32 v15, -56, v15
ds_read_b64 v[32:33], v15 offset:0
ds_read_b64 v[34:35], v15 offset:8
ds_read_b64 v[36:37], v15 offset:16
ds_read_b64 v[38:39], v15 offset:24
ds_read_b64 v[40:41], v15 offset:32
ds_read_b64 v[42:43], v15 offset:40
ds_read_b64 v[44:45], v15 offset:48
ds_read_b64 v[46:47], v15 offset:2304
ds_read_b64 v[48:49], v15 offset:2312
ds_read_b64 v[50:51], v15 offset:2320
ds_read_b64 v[52:53], v15 offset:2328
ds_read_b64 v[54:55], v15 offset:2336
ds_read_b64 v[56:57], v15 offset:2344
ds_read_b64 v[58:59], v15 offset:2352
s_waitcnt lgkmcnt(0)
v_fma_f32 v60, v180, v32, v34
v_fma_f32 v61, v180, v33, v35
v_fma_f32 v34, -v181, v33, v60
v_fma_f32 v35, v181, v32, v61
v_fma_f32 v60, v180, v34, v36
v_fma_f32 v61, v180, v35, v37
v_fma_f32 v36, -v181, v35, v60
v_fma_f32 v37, v181, v34, v61
v_fma_f32 v60, v180, v36, v38
v_fma_f32 v61, v180, v37, v39
v_fma_f32 v38, -v181, v37, v60
v_fma_f32 v39, v181, v36, v61
v_fma_f32 v60, v180, v38, v40
v_fma_f32 v61, v180, v39, v41
v_fma_f32 v40, -v181, v39, v60
v_fma_f32 v41, v181, v38, v61
v_fma_f32 v60, v180, v40, v42
v_fma_f32 v61, v180, v41, v43
v_fma_f32 v42, -v181, v41, v60
v_fma_f32 v43, v181, v40, v61
v_fma_f32 v60, v180, v42, v44
v_fma_f32 v61, v180, v43, v45
v_fma_f32 v128, -v181, v43, v60
v_fma_f32 v130, v181, v42, v61
v_fma_f32 v60, v176, v128, v78
v_fma_f32 v61, v176, v130, v94
v_fma_f32 v129, -v177, v130, v60
v_fma_f32 v131, v177, v128, v61
v_fma_f32 v60, v182, v46, v48
v_fma_f32 v61, v182, v47, v49
v_fma_f32 v48, -v183, v47, v60
v_fma_f32 v49, v183, v46, v61
v_fma_f32 v60, v182, v48, v50
v_fma_f32 v61, v182, v49, v51
v_fma_f32 v50, -v183, v49, v60
v_fma_f32 v51, v183, v48, v61
v_fma_f32 v60, v182, v50, v52
v_fma_f32 v61, v182, v51, v53
v_fma_f32 v52, -v183, v51, v60
v_fma_f32 v53, v183, v50, v61
v_fma_f32 v60, v182, v52, v54
v_fma_f32 v61, v182, v53, v55
v_fma_f32 v54, -v183, v53, v60
v_fma_f32 v55, v183, v52, v61
v_fma_f32 v60, v182, v54, v56
v_fma_f32 v61, v182, v55, v57
v_fma_f32 v56, -v183, v55, v60
v_fma_f32 v57, v183, v54, v61
v_fma_f32 v60, v182, v56, v58
v_fma_f32 v61, v182, v57, v59
v_fma_f32 v132, -v183, v57, v60
v_fma_f32 v134, v183, v56, v61
v_fma_f32 v60, v178, v132, v110
v_fma_f32 v61, v178, v134, v126
v_fma_f32 v133, -v179, v134, v60
v_fma_f32 v135, v179, v132, v61
v_pk_mul_f32 v[32:33], v[24:25], v[64:65] op_sel_hi:[0,1]
v_pk_mul_f32 v[34:35], v[24:25], v[80:81] op_sel_hi:[0,1] neg_lo:[1,0] neg_hi:[1,0]
v_pk_fma_f32 v[34:35], v[24:25], v[64:65], v[34:35] op_sel:[1,0,0] neg_lo:[1,0,0] neg_hi:[1,0,0]
v_pk_fma_f32 v[64:65], v[24:25], v[80:81], v[32:33] op_sel:[1,0,0] neg_lo:[1,0,0] neg_hi:[1,0,0]
v_mov_b64 v[80:81], v[34:35]
v_pk_mul_f32 v[36:37], v[26:27], v[96:97] op_sel_hi:[0,1]
v_pk_mul_f32 v[38:39], v[26:27], v[112:113] op_sel_hi:[0,1] neg_lo:[1,0] neg_hi:[1,0]
v_pk_fma_f32 v[38:39], v[26:27], v[96:97], v[38:39] op_sel:[1,0,0] neg_lo:[1,0,0] neg_hi:[1,0,0]
v_pk_fma_f32 v[96:97], v[26:27], v[112:113], v[36:37] op_sel:[1,0,0] neg_lo:[1,0,0] neg_hi:[1,0,0]
v_mov_b64 v[112:113], v[38:39]
v_pk_mul_f32 v[32:33], v[24:25], v[66:67] op_sel_hi:[0,1]
v_pk_mul_f32 v[34:35], v[24:25], v[82:83] op_sel_hi:[0,1] neg_lo:[1,0] neg_hi:[1,0]
v_pk_fma_f32 v[34:35], v[24:25], v[66:67], v[34:35] op_sel:[1,0,0] neg_lo:[1,0,0] neg_hi:[1,0,0]
v_pk_fma_f32 v[66:67], v[24:25], v[82:83], v[32:33] op_sel:[1,0,0] neg_lo:[1,0,0] neg_hi:[1,0,0]
v_mov_b64 v[82:83], v[34:35]
v_pk_mul_f32 v[36:37], v[26:27], v[98:99] op_sel_hi:[0,1]
v_pk_mul_f32 v[38:39], v[26:27], v[114:115] op_sel_hi:[0,1] neg_lo:[1,0] neg_hi:[1,0]
v_pk_fma_f32 v[38:39], v[26:27], v[98:99], v[38:39] op_sel:[1,0,0] neg_lo:[1,0,0] neg_hi:[1,0,0]
v_pk_fma_f32 v[98:99], v[26:27], v[114:115], v[36:37] op_sel:[1,0,0] neg_lo:[1,0,0] neg_hi:[1,0,0]
v_mov_b64 v[114:115], v[38:39]
v_pk_mul_f32 v[32:33], v[24:25], v[68:69] op_sel_hi:[0,1]
v_pk_mul_f32 v[34:35], v[24:25], v[84:85] op_sel_hi:[0,1] neg_lo:[1,0] neg_hi:[1,0]
v_pk_fma_f32 v[34:35], v[24:25], v[68:69], v[34:35] op_sel:[1,0,0] neg_lo:[1,0,0] neg_hi:[1,0,0]
v_pk_fma_f32 v[68:69], v[24:25], v[84:85], v[32:33] op_sel:[1,0,0] neg_lo:[1,0,0] neg_hi:[1,0,0]
v_mov_b64 v[84:85], v[34:35]
v_pk_mul_f32 v[36:37], v[26:27], v[100:101] op_sel_hi:[0,1]
v_pk_mul_f32 v[38:39], v[26:27], v[116:117] op_sel_hi:[0,1] neg_lo:[1,0] neg_hi:[1,0]
v_pk_fma_f32 v[38:39], v[26:27], v[100:101], v[38:39] op_sel:[1,0,0] neg_lo:[1,0,0] neg_hi:[1,0,0]
v_pk_fma_f32 v[100:101], v[26:27], v[116:117], v[36:37] op_sel:[1,0,0] neg_lo:[1,0,0] neg_hi:[1,0,0]
v_mov_b64 v[116:117], v[38:39]
v_pk_mul_f32 v[32:33], v[24:25], v[70:71] op_sel_hi:[0,1]
v_pk_mul_f32 v[34:35], v[24:25], v[86:87] op_sel_hi:[0,1] neg_lo:[1,0] neg_hi:[1,0]
v_pk_fma_f32 v[34:35], v[24:25], v[70:71], v[34:35] op_sel:[1,0,0] neg_lo:[1,0,0] neg_hi:[1,0,0]
v_pk_fma_f32 v[70:71], v[24:25], v[86:87], v[32:33] op_sel:[1,0,0] neg_lo:[1,0,0] neg_hi:[1,0,0]
v_mov_b64 v[86:87], v[34:35]
v_pk_mul_f32 v[36:37], v[26:27], v[102:103] op_sel_hi:[0,1]
v_pk_mul_f32 v[38:39], v[26:27], v[118:119] op_sel_hi:[0,1] neg_lo:[1,0] neg_hi:[1,0]
v_pk_fma_f32 v[38:39], v[26:27], v[102:103], v[38:39] op_sel:[1,0,0] neg_lo:[1,0,0] neg_hi:[1,0,0]
v_pk_fma_f32 v[102:103], v[26:27], v[118:119], v[36:37] op_sel:[1,0,0] neg_lo:[1,0,0] neg_hi:[1,0,0]
v_mov_b64 v[118:119], v[38:39]
v_pk_mul_f32 v[32:33], v[24:25], v[72:73] op_sel_hi:[0,1]
v_pk_mul_f32 v[34:35], v[24:25], v[88:89] op_sel_hi:[0,1] neg_lo:[1,0] neg_hi:[1,0]
v_pk_fma_f32 v[34:35], v[24:25], v[72:73], v[34:35] op_sel:[1,0,0] neg_lo:[1,0,0] neg_hi:[1,0,0]
v_pk_fma_f32 v[72:73], v[24:25], v[88:89], v[32:33] op_sel:[1,0,0] neg_lo:[1,0,0] neg_hi:[1,0,0]
v_mov_b64 v[88:89], v[34:35]
v_pk_mul_f32 v[36:37], v[26:27], v[104:105] op_sel_hi:[0,1]
v_pk_mul_f32 v[38:39], v[26:27], v[120:121] op_sel_hi:[0,1] neg_lo:[1,0] neg_hi:[1,0]
v_pk_fma_f32 v[38:39], v[26:27], v[104:105], v[38:39] op_sel:[1,0,0] neg_lo:[1,0,0] neg_hi:[1,0,0]
v_pk_fma_f32 v[104:105], v[26:27], v[120:121], v[36:37] op_sel:[1,0,0] neg_lo:[1,0,0] neg_hi:[1,0,0]
v_mov_b64 v[120:121], v[38:39]
v_pk_mul_f32 v[32:33], v[24:25], v[74:75] op_sel_hi:[0,1]
v_pk_mul_f32 v[34:35], v[24:25], v[90:91] op_sel_hi:[0,1] neg_lo:[1,0] neg_hi:[1,0]
v_pk_fma_f32 v[34:35], v[24:25], v[74:75], v[34:35] op_sel:[1,0,0] neg_lo:[1,0,0] neg_hi:[1,0,0]
v_pk_fma_f32 v[74:75], v[24:25], v[90:91], v[32:33] op_sel:[1,0,0] neg_lo:[1,0,0] neg_hi:[1,0,0]
v_mov_b64 v[90:91], v[34:35]
v_pk_mul_f32 v[36:37], v[26:27], v[106:107] op_sel_hi:[0,1]
v_pk_mul_f32 v[38:39], v[26:27], v[122:123] op_sel_hi:[0,1] neg_lo:[1,0] neg_hi:[1,0]
v_pk_fma_f32 v[38:39], v[26:27], v[106:107], v[38:39] op_sel:[1,0,0] neg_lo:[1,0,0] neg_hi:[1,0,0]
v_pk_fma_f32 v[106:107], v[26:27], v[122:123], v[36:37] op_sel:[1,0,0] neg_lo:[1,0,0] neg_hi:[1,0,0]
v_mov_b64 v[122:123], v[38:39]
v_pk_mul_f32 v[32:33], v[24:25], v[76:77] op_sel_hi:[0,1]
v_pk_mul_f32 v[34:35], v[24:25], v[92:93] op_sel_hi:[0,1] neg_lo:[1,0] neg_hi:[1,0]
v_pk_fma_f32 v[34:35], v[24:25], v[76:77], v[34:35] op_sel:[1,0,0] neg_lo:[1,0,0] neg_hi:[1,0,0]
v_pk_fma_f32 v[76:77], v[24:25], v[92:93], v[32:33] op_sel:[1,0,0] neg_lo:[1,0,0] neg_hi:[1,0,0]
v_mov_b64 v[92:93], v[34:35]
v_pk_mul_f32 v[36:37], v[26:27], v[108:109] op_sel_hi:[0,1]
v_pk_mul_f32 v[38:39], v[26:27], v[124:125] op_sel_hi:[0,1] neg_lo:[1,0] neg_hi:[1,0]
v_pk_fma_f32 v[38:39], v[26:27], v[108:109], v[38:39] op_sel:[1,0,0] neg_lo:[1,0,0] neg_hi:[1,0,0]
v_pk_fma_f32 v[108:109], v[26:27], v[124:125], v[36:37] op_sel:[1,0,0] neg_lo:[1,0,0] neg_hi:[1,0,0]
v_mov_b64 v[124:125], v[38:39]
v_pk_mul_f32 v[32:33], v[24:25], v[78:79] op_sel_hi:[0,1]
v_pk_mul_f32 v[34:35], v[24:25], v[94:95] op_sel_hi:[0,1] neg_lo:[1,0] neg_hi:[1,0]
v_pk_fma_f32 v[34:35], v[24:25], v[78:79], v[34:35] op_sel:[1,0,0] neg_lo:[1,0,0] neg_hi:[1,0,0]
v_pk_fma_f32 v[78:79], v[24:25], v[94:95], v[32:33] op_sel:[1,0,0] neg_lo:[1,0,0] neg_hi:[1,0,0]
v_mov_b64 v[94:95], v[34:35]
v_pk_mul_f32 v[36:37], v[26:27], v[110:111] op_sel_hi:[0,1]
v_pk_mul_f32 v[38:39], v[26:27], v[126:127] op_sel_hi:[0,1] neg_lo:[1,0] neg_hi:[1,0]
v_pk_fma_f32 v[38:39], v[26:27], v[110:111], v[38:39] op_sel:[1,0,0] neg_lo:[1,0,0] neg_hi:[1,0,0]
v_pk_fma_f32 v[110:111], v[26:27], v[126:127], v[36:37] op_sel:[1,0,0] neg_lo:[1,0,0] neg_hi:[1,0,0]
v_mov_b64 v[126:127], v[38:39]
buffer_load_dwordx4 v[144:147], v136, s[40:43], 0 offen sc1
buffer_load_dwordx4 v[148:151], v137, s[40:43], 0 offen sc1
buffer_load_dwordx4 v[152:155], v138, s[40:43], 0 offen sc1
buffer_load_dwordx4 v[156:159], v139, s[40:43], 0 offen sc1
buffer_load_dwordx4 v[160:163], v140, s[40:43], 0 offen sc1
buffer_load_dwordx4 v[164:167], v141, s[40:43], 0 offen sc1
buffer_load_dwordx4 v[168:171], v142, s[40:43], 0 offen sc1
buffer_load_dwordx4 v[172:175], v143, s[40:43], 0 offen sc1
global_load_dword v197, v196, s[32:33] sc1
v_mov_b32 v14, 1
s_mov_b64 exec, 1
ds_write_b32 v13, v14
s_mov_b64 exec, -1
s_xor_b32 s60, s68, s101
s_xor_b32 s60, s60, 1
s_lshl_b32 s60, s60, 6
s_add_u32 s60, s60, s66
v_lshrrev_b32 v8, 3, v1
v_lshl_add_u32 v8, v8, 1, s60
v_lshlrev_b32 v8, 11, v8
v_and_b32 v14, 7, v1
v_lshrrev_b32 v15, 4, v1
v_xor_b32 v14, v14, v15
v_lshlrev_b32 v14, 4, v14
v_xor_b32 v15, 64, v14
v_add_u32 v244, v8, v14
v_add_u32 v245, v8, v15
v_add_u32 v245, 31744, v245
v_add_u32 v246, v8, v14
v_add_u32 v246, 63488, v246
v_add_u32 v247, v8, v15
v_add_u32 v247, 95232, v247
s_and_b32 s64, s36, 7
s_lshl_b32 s60, s64, 18
s_lshl_b32 s61, s101, 10
s_add_u32 s60, s60, s61
s_add_u32 s48, s20, s60
s_addc_u32 s49, s21, 0
s_sub_u32 s50, 262144, s61
s_mov_b32 s51, 0x20000
s_add_u32 s52, s22, s60
s_addc_u32 s53, s23, 0
s_sub_u32 s54, 262144, s61
s_mov_b32 s55, 0x20000
s_lshl_b32 s61, s64, 1
s_add_u32 s61, s61, s101
s_lshl_b32 s61, s61, 7
s_lshl_b32 s63, s35, 1
s_add_u32 s63, s63, s68
s_lshl_b32 s60, s63, 17
s_add_u32 s60, s60, s61
s_add_u32 s56, s10, s60
s_addc_u32 s57, s11, 0
s_sub_u32 s58, 131072, s61
s_mov_b32 s59, 0x20000
s_add_u32 s26, s26, s61
s_addc_u32 s27, s27, 0
s_lshl_b32 s61, s61, 1
s_add_u32 s61, s61, 4096
s_lshl_b32 s60, s63, 19
s_add_u32 s60, s60, s61
s_add_u32 s28, s28, s60
s_addc_u32 s29, s29, 0
s_sub_u32 s24, 0x80000, s61
s_lshl_b32 s67, s34, 12
s_lshl_b32 s65, s64, 13
s_lshl_b32 s64, s64, 7
s_lshl_b32 s60, s68, 14
s_lshl_b32 s61, s66, 11
s_add_u32 s60, s60, s61
s_add_u32 s60, s60, 65536
v_add_u32 v16, s60, v10
s_lshl_b32 s60, s34, 13
s_add_u32 s60, s60, 65536
v_add_u32 v17, s60, v11
v_xor_b32 v20, 0, v7
v_add_u32 v24, 0x10000, v20
v_xor_b32 v21, 32, v7
v_add_u32 v25, 0x10000, v21
v_xor_b32 v22, 64, v7
v_add_u32 v26, 0x10000, v22
v_xor_b32 v23, 96, v7
v_add_u32 v27, 0x10000, v23
s_mul_i32 s14, s63, 262144
s_lshl_b32 s61, s36, 13
s_add_u32 s14, s14, s61
s_lshl_b32 s61, s66, 11
s_add_u32 s14, s14, s61
v_cmp_gt_u32 vcc, 0x40000, v136
s_nop 1
v_cndmask_b32 v40, 0, v202, vcc
v_cmp_gt_u32 vcc, 0x40000, v137
s_nop 1
v_cndmask_b32 v41, 0, v202, vcc
v_cmp_gt_u32 vcc, 0x40000, v138
s_nop 1
v_cndmask_b32 v42, 0, v202, vcc
v_cmp_gt_u32 vcc, 0x40000, v139
s_nop 1
v_cndmask_b32 v43, 0, v202, vcc
v_cmp_gt_u32 vcc, 0x40000, v140
s_nop 1
v_cndmask_b32 v44, 0, v202, vcc
v_cmp_gt_u32 vcc, 0x40000, v141
s_nop 1
v_cndmask_b32 v45, 0, v202, vcc
v_cmp_gt_u32 vcc, 0x40000, v142
s_nop 1
v_cndmask_b32 v46, 0, v202, vcc
v_cmp_gt_u32 vcc, 0x40000, v143
s_nop 1
v_cndmask_b32 v47, 0, v202, vcc
s_mov_b32 s69, 0
L_poll53:
v_mov_b32 v8, 0
s_waitcnt vmcnt(8)
v_bitop3_b32 v8, v8, v146, v40 bitop3:0xf6
v_bitop3_b32 v8, v8, v147, v40 bitop3:0xf6
s_waitcnt vmcnt(7)
v_bitop3_b32 v8, v8, v150, v41 bitop3:0xf6
v_bitop3_b32 v8, v8, v151, v41 bitop3:0xf6
s_waitcnt vmcnt(6)
v_bitop3_b32 v8, v8, v154, v42 bitop3:0xf6
v_bitop3_b32 v8, v8, v155, v42 bitop3:0xf6
s_waitcnt vmcnt(5)
v_bitop3_b32 v8, v8, v158, v43 bitop3:0xf6
v_bitop3_b32 v8, v8, v159, v43 bitop3:0xf6
s_waitcnt vmcnt(4)
v_bitop3_b32 v8, v8, v162, v44 bitop3:0xf6
v_bitop3_b32 v8, v8, v163, v44 bitop3:0xf6
s_waitcnt vmcnt(3)
v_bitop3_b32 v8, v8, v166, v45 bitop3:0xf6
v_bitop3_b32 v8, v8, v167, v45 bitop3:0xf6
s_waitcnt vmcnt(2)
v_bitop3_b32 v8, v8, v170, v46 bitop3:0xf6
v_bitop3_b32 v8, v8, v171, v46 bitop3:0xf6
s_waitcnt vmcnt(1)
v_bitop3_b32 v8, v8, v174, v47 bitop3:0xf6
v_bitop3_b32 v8, v8, v175, v47 bitop3:0xf6
s_waitcnt vmcnt(0)
v_xor_b32 v197, v194, v197
v_lshrrev_b32 v9, 4, v197
v_or_b32 v8, v8, v9
v_cmp_ne_u32 vcc, 0, v8
s_nop 0
s_cbranch_vccz L_polled54
s_add_u32 s69, s69, 1
s_cmp_ge_u32 s69, 200000
s_cbranch_scc1 L_polled54
buffer_load_dwordx4 v[144:147], v136, s[40:43], 0 offen sc1
buffer_load_dwordx4 v[148:151], v137, s[40:43], 0 offen sc1
buffer_load_dwordx4 v[152:155], v138, s[40:43], 0 offen sc1
buffer_load_dwordx4 v[156:159], v139, s[40:43], 0 offen sc1
buffer_load_dwordx4 v[160:163], v140, s[40:43], 0 offen sc1
buffer_load_dwordx4 v[164:167], v141, s[40:43], 0 offen sc1
buffer_load_dwordx4 v[168:171], v142, s[40:43], 0 offen sc1
buffer_load_dwordx4 v[172:175], v143, s[40:43], 0 offen sc1
global_load_dword v197, v196, s[32:33] sc1
s_branch L_poll53
L_polled54:
v_cmp_ne_u32 vcc, 0, v197
s_nop 0
s_cmp_eq_u64 vcc, 0
s_cselect_b32 s100, 1, 0
s_add_u32 m0, s67, 0
s_add_u32 s62, s64, 0
s_and_b32 s62, s62, 0x3ff
buffer_load_dwordx4 v244, s[48:51], s62 offen offset:0 lds
buffer_load_dwordx4 v245, s[48:51], s62 offen offset:1024 lds
buffer_load_dwordx4 v246, s[48:51], s62 offen offset:2048 lds
buffer_load_dwordx4 v247, s[48:51], s62 offen offset:3072 lds
s_add_u32 m0, s67, 16384
s_nop 0
buffer_load_dwordx4 v244, s[52:55], s62 offen offset:0 lds
buffer_load_dwordx4 v245, s[52:55], s62 offen offset:1024 lds
buffer_load_dwordx4 v246, s[52:55], s62 offen offset:2048 lds
buffer_load_dwordx4 v247, s[52:55], s62 offen offset:3072 lds
v_mov_b32 v14, 2
s_mov_b64 exec, 1
ds_write_b32 v13, v14
s_mov_b64 exec, -1
v_fma_f32 v40, v2, v172, v168
v_fma_f32 v41, v2, v173, v169
v_fma_f32 v48, -v3, v173, v40
v_fma_f32 v49, v3, v172, v41
v_fma_f32 v40, v2, v48, v164
v_fma_f32 v41, v2, v49, v165
v_fma_f32 v172, -v3, v49, v40
v_fma_f32 v173, v3, v48, v41
v_fma_f32 v40, v2, v172, v160
v_fma_f32 v41, v2, v173, v161
v_fma_f32 v48, -v3, v173, v40
v_fma_f32 v49, v3, v172, v41
v_fma_f32 v40, v2, v48, v156
v_fma_f32 v41, v2, v49, v157
v_fma_f32 v172, -v3, v49, v40
v_fma_f32 v173, v3, v48, v41
v_fma_f32 v40, v2, v172, v152
v_fma_f32 v41, v2, v173, v153
v_fma_f32 v48, -v3, v173, v40
v_fma_f32 v49, v3, v172, v41
v_fma_f32 v40, v2, v48, v148
v_fma_f32 v41, v2, v49, v149
v_fma_f32 v172, -v3, v49, v40
v_fma_f32 v173, v3, v48, v41
v_fma_f32 v40, v2, v172, v144
v_fma_f32 v41, v2, v173, v145
v_fma_f32 v48, -v3, v173, v40
v_fma_f32 v49, v3, v172, v41
v_mov_b32 v50, v48
v_mov_b32 v51, v49
s_nop 0
v_permlane32_swap_b32 v48, v50
v_permlane32_swap_b32 v49, v51
v_fma_f32 v40, v30, v50, v48
v_fma_f32 v41, v30, v51, v49
v_fma_f32 v52, -v31, v51, v40
v_fma_f32 v53, v31, v50, v41
v_mov_b32 v54, v52
v_mov_b32 v55, v53
s_nop 0
v_permlane16_swap_b32 v52, v54
v_permlane16_swap_b32 v53, v55
v_pk_fma_f32 v[128:129], v[52:53], v[184:185], v[128:129] op_sel_hi:[0,1,1]
v_pk_fma_f32 v[130:131], v[52:53], v[186:187], v[130:131] op_sel_hi:[0,1,1]
v_pk_fma_f32 v[128:129], v[52:53], v[186:187], v[128:129] op_sel:[1,0,0] neg_lo:[1,0,0] neg_hi:[1,0,0]
v_pk_fma_f32 v[130:131], v[52:53], v[184:185], v[130:131] op_sel:[1,0,0]
v_pk_fma_f32 v[132:133], v[54:55], v[188:189], v[132:133] op_sel_hi:[0,1,1]
v_pk_fma_f32 v[134:135], v[54:55], v[190:191], v[134:135] op_sel_hi:[0,1,1]
v_pk_fma_f32 v[132:133], v[54:55], v[190:191], v[132:133] op_sel:[1,0,0] neg_lo:[1,0,0] neg_hi:[1,0,0]
v_pk_fma_f32 v[134:135], v[54:55], v[188:189], v[134:135] op_sel:[1,0,0]
v_pk_fma_f32 v[64:65], v[208:209], v[128:129], v[64:65] op_sel_hi:[0,1,1]
v_pk_fma_f32 v[80:81], v[208:209], v[130:131], v[80:81] op_sel_hi:[0,1,1] neg_lo:[1,0,0] neg_hi:[1,0,0]
v_pk_fma_f32 v[64:65], v[208:209], v[130:131], v[64:65] op_sel:[1,0,0] neg_lo:[1,0,0] neg_hi:[1,0,0]
v_pk_fma_f32 v[80:81], v[208:209], v[128:129], v[80:81] op_sel:[1,0,0] neg_lo:[1,0,0] neg_hi:[1,0,0]
v_cvt_pk_bf16_f32 v144, v64, v65
v_cvt_pk_bf16_f32 v152, v80, v81
v_pk_fma_f32 v[96:97], v[224:225], v[132:133], v[96:97] op_sel_hi:[0,1,1]
v_pk_fma_f32 v[112:113], v[224:225], v[134:135], v[112:113] op_sel_hi:[0,1,1] neg_lo:[1,0,0] neg_hi:[1,0,0]
v_pk_fma_f32 v[96:97], v[224:225], v[134:135], v[96:97] op_sel:[1,0,0] neg_lo:[1,0,0] neg_hi:[1,0,0]
v_pk_fma_f32 v[112:113], v[224:225], v[132:133], v[112:113] op_sel:[1,0,0] neg_lo:[1,0,0] neg_hi:[1,0,0]
v_cvt_pk_bf16_f32 v160, v96, v97
v_cvt_pk_bf16_f32 v168, v112, v113
v_pk_fma_f32 v[66:67], v[210:211], v[128:129], v[66:67] op_sel_hi:[0,1,1]
v_pk_fma_f32 v[82:83], v[210:211], v[130:131], v[82:83] op_sel_hi:[0,1,1] neg_lo:[1,0,0] neg_hi:[1,0,0]
v_pk_fma_f32 v[66:67], v[210:211], v[130:131], v[66:67] op_sel:[1,0,0] neg_lo:[1,0,0] neg_hi:[1,0,0]
v_pk_fma_f32 v[82:83], v[210:211], v[128:129], v[82:83] op_sel:[1,0,0] neg_lo:[1,0,0] neg_hi:[1,0,0]
v_cvt_pk_bf16_f32 v145, v66, v67
v_cvt_pk_bf16_f32 v153, v82, v83
v_pk_fma_f32 v[98:99], v[226:227], v[132:133], v[98:99] op_sel_hi:[0,1,1]
v_pk_fma_f32 v[114:115], v[226:227], v[134:135], v[114:115] op_sel_hi:[0,1,1] neg_lo:[1,0,0] neg_hi:[1,0,0]
v_pk_fma_f32 v[98:99], v[226:227], v[134:135], v[98:99] op_sel:[1,0,0] neg_lo:[1,0,0] neg_hi:[1,0,0]
v_pk_fma_f32 v[114:115], v[226:227], v[132:133], v[114:115] op_sel:[1,0,0] neg_lo:[1,0,0] neg_hi:[1,0,0]
v_cvt_pk_bf16_f32 v161, v98, v99
v_cvt_pk_bf16_f32 v169, v114, v115
v_pk_fma_f32 v[68:69], v[212:213], v[128:129], v[68:69] op_sel_hi:[0,1,1]
v_pk_fma_f32 v[84:85], v[212:213], v[130:131], v[84:85] op_sel_hi:[0,1,1] neg_lo:[1,0,0] neg_hi:[1,0,0]
v_pk_fma_f32 v[68:69], v[212:213], v[130:131], v[68:69] op_sel:[1,0,0] neg_lo:[1,0,0] neg_hi:[1,0,0]
v_pk_fma_f32 v[84:85], v[212:213], v[128:129], v[84:85] op_sel:[1,0,0] neg_lo:[1,0,0] neg_hi:[1,0,0]
v_cvt_pk_bf16_f32 v146, v68, v69
v_cvt_pk_bf16_f32 v154, v84, v85
v_pk_fma_f32 v[100:101], v[228:229], v[132:133], v[100:101] op_sel_hi:[0,1,1]
v_pk_fma_f32 v[116:117], v[228:229], v[134:135], v[116:117] op_sel_hi:[0,1,1] neg_lo:[1,0,0] neg_hi:[1,0,0]
v_pk_fma_f32 v[100:101], v[228:229], v[134:135], v[100:101] op_sel:[1,0,0] neg_lo:[1,0,0] neg_hi:[1,0,0]
v_pk_fma_f32 v[116:117], v[228:229], v[132:133], v[116:117] op_sel:[1,0,0] neg_lo:[1,0,0] neg_hi:[1,0,0]
v_cvt_pk_bf16_f32 v162, v100, v101
v_cvt_pk_bf16_f32 v170, v116, v117
v_pk_fma_f32 v[70:71], v[214:215], v[128:129], v[70:71] op_sel_hi:[0,1,1]
v_pk_fma_f32 v[86:87], v[214:215], v[130:131], v[86:87] op_sel_hi:[0,1,1] neg_lo:[1,0,0] neg_hi:[1,0,0]
v_pk_fma_f32 v[70:71], v[214:215], v[130:131], v[70:71] op_sel:[1,0,0] neg_lo:[1,0,0] neg_hi:[1,0,0]
v_pk_fma_f32 v[86:87], v[214:215], v[128:129], v[86:87] op_sel:[1,0,0] neg_lo:[1,0,0] neg_hi:[1,0,0]
v_cvt_pk_bf16_f32 v147, v70, v71
v_cvt_pk_bf16_f32 v155, v86, v87
v_pk_fma_f32 v[102:103], v[230:231], v[132:133], v[102:103] op_sel_hi:[0,1,1]
v_pk_fma_f32 v[118:119], v[230:231], v[134:135], v[118:119] op_sel_hi:[0,1,1] neg_lo:[1,0,0] neg_hi:[1,0,0]
v_pk_fma_f32 v[102:103], v[230:231], v[134:135], v[102:103] op_sel:[1,0,0] neg_lo:[1,0,0] neg_hi:[1,0,0]
v_pk_fma_f32 v[118:119], v[230:231], v[132:133], v[118:119] op_sel:[1,0,0] neg_lo:[1,0,0] neg_hi:[1,0,0]
v_cvt_pk_bf16_f32 v163, v102, v103
v_cvt_pk_bf16_f32 v171, v118, v119
v_mfma_f32_16x16x32_bf16 v[32:35], v[144:147], v[248:251], 0
v_mfma_f32_16x16x32_bf16 v[36:39], v[160:163], v[248:251], 0
v_mfma_f32_16x16x32_bf16 v[40:43], v[144:147], v[252:255], 0
v_mfma_f32_16x16x32_bf16 v[44:47], v[160:163], v[252:255], 0
v_mfma_f32_16x16x32_bf16 v[48:51], v[152:155], v[248:251], 0
v_mfma_f32_16x16x32_bf16 v[52:55], v[168:171], v[248:251], 0
v_mfma_f32_16x16x32_bf16 v[56:59], v[152:155], v[252:255], 0
v_mfma_f32_16x16x32_bf16 v[60:63], v[168:171], v[252:255], 0
v_pk_fma_f32 v[72:73], v[216:217], v[128:129], v[72:73] op_sel_hi:[0,1,1]
v_pk_fma_f32 v[88:89], v[216:217], v[130:131], v[88:89] op_sel_hi:[0,1,1] neg_lo:[1,0,0] neg_hi:[1,0,0]
v_pk_fma_f32 v[72:73], v[216:217], v[130:131], v[72:73] op_sel:[1,0,0] neg_lo:[1,0,0] neg_hi:[1,0,0]
v_pk_fma_f32 v[88:89], v[216:217], v[128:129], v[88:89] op_sel:[1,0,0] neg_lo:[1,0,0] neg_hi:[1,0,0]
v_cvt_pk_bf16_f32 v148, v72, v73
v_cvt_pk_bf16_f32 v156, v88, v89
v_pk_fma_f32 v[104:105], v[232:233], v[132:133], v[104:105] op_sel_hi:[0,1,1]
v_pk_fma_f32 v[120:121], v[232:233], v[134:135], v[120:121] op_sel_hi:[0,1,1] neg_lo:[1,0,0] neg_hi:[1,0,0]
v_pk_fma_f32 v[104:105], v[232:233], v[134:135], v[104:105] op_sel:[1,0,0] neg_lo:[1,0,0] neg_hi:[1,0,0]
v_pk_fma_f32 v[120:121], v[232:233], v[132:133], v[120:121] op_sel:[1,0,0] neg_lo:[1,0,0] neg_hi:[1,0,0]
v_cvt_pk_bf16_f32 v164, v104, v105
v_cvt_pk_bf16_f32 v172, v120, v121
v_pk_fma_f32 v[74:75], v[218:219], v[128:129], v[74:75] op_sel_hi:[0,1,1]
v_pk_fma_f32 v[90:91], v[218:219], v[130:131], v[90:91] op_sel_hi:[0,1,1] neg_lo:[1,0,0] neg_hi:[1,0,0]
v_pk_fma_f32 v[74:75], v[218:219], v[130:131], v[74:75] op_sel:[1,0,0] neg_lo:[1,0,0] neg_hi:[1,0,0]
v_pk_fma_f32 v[90:91], v[218:219], v[128:129], v[90:91] op_sel:[1,0,0] neg_lo:[1,0,0] neg_hi:[1,0,0]
v_cvt_pk_bf16_f32 v149, v74, v75
v_cvt_pk_bf16_f32 v157, v90, v91
v_pk_fma_f32 v[106:107], v[234:235], v[132:133], v[106:107] op_sel_hi:[0,1,1]
v_pk_fma_f32 v[122:123], v[234:235], v[134:135], v[122:123] op_sel_hi:[0,1,1] neg_lo:[1,0,0] neg_hi:[1,0,0]
v_pk_fma_f32 v[106:107], v[234:235], v[134:135], v[106:107] op_sel:[1,0,0] neg_lo:[1,0,0] neg_hi:[1,0,0]
v_pk_fma_f32 v[122:123], v[234:235], v[132:133], v[122:123] op_sel:[1,0,0] neg_lo:[1,0,0] neg_hi:[1,0,0]
v_cvt_pk_bf16_f32 v165, v106, v107
v_cvt_pk_bf16_f32 v173, v122, v123
s_add_u32 s61, s14, 0
v_cvt_pk_bf16_f32 v176, v32, v33
v_cvt_pk_bf16_f32 v177, v34, v35
v_cvt_pk_bf16_f32 v178, v36, v37
v_cvt_pk_bf16_f32 v179, v38, v39
buffer_store_dwordx4 v[176:179], v10, s[44:47], s61 offen offset:0 sc1
ds_write_b128 v16, v[176:179] offset:0
s_add_u32 s61, s14, 131072
v_cvt_pk_bf16_f32 v180, v40, v41
v_cvt_pk_bf16_f32 v181, v42, v43
v_cvt_pk_bf16_f32 v182, v44, v45
v_cvt_pk_bf16_f32 v183, v46, v47
buffer_store_dwordx4 v[180:183], v10, s[44:47], s61 offen offset:0 sc1
ds_write_b128 v16, v[180:183] offset:8192
s_add_u32 s61, s14, 4096
v_cvt_pk_bf16_f32 v184, v48, v49
v_cvt_pk_bf16_f32 v185, v50, v51
v_cvt_pk_bf16_f32 v186, v52, v53
v_cvt_pk_bf16_f32 v187, v54, v55
buffer_store_dwordx4 v[184:187], v10, s[44:47], s61 offen offset:0 sc1
ds_write_b128 v16, v[184:187] offset:4096
s_add_u32 s61, s14, 135168
v_cvt_pk_bf16_f32 v188, v56, v57
v_cvt_pk_bf16_f32 v189, v58, v59
v_cvt_pk_bf16_f32 v190, v60, v61
v_cvt_pk_bf16_f32 v191, v62, v63
buffer_store_dwordx4 v[188:191], v10, s[44:47], s61 offen offset:0 sc1
ds_write_b128 v16, v[188:191] offset:12288
v_pk_fma_f32 v[76:77], v[220:221], v[128:129], v[76:77] op_sel_hi:[0,1,1]
v_pk_fma_f32 v[92:93], v[220:221], v[130:131], v[92:93] op_sel_hi:[0,1,1] neg_lo:[1,0,0] neg_hi:[1,0,0]
v_pk_fma_f32 v[76:77], v[220:221], v[130:131], v[76:77] op_sel:[1,0,0] neg_lo:[1,0,0] neg_hi:[1,0,0]
v_pk_fma_f32 v[92:93], v[220:221], v[128:129], v[92:93] op_sel:[1,0,0] neg_lo:[1,0,0] neg_hi:[1,0,0]
v_cvt_pk_bf16_f32 v150, v76, v77
v_cvt_pk_bf16_f32 v158, v92, v93
v_pk_fma_f32 v[108:109], v[236:237], v[132:133], v[108:109] op_sel_hi:[0,1,1]
v_pk_fma_f32 v[124:125], v[236:237], v[134:135], v[124:125] op_sel_hi:[0,1,1] neg_lo:[1,0,0] neg_hi:[1,0,0]
v_pk_fma_f32 v[108:109], v[236:237], v[134:135], v[108:109] op_sel:[1,0,0] neg_lo:[1,0,0] neg_hi:[1,0,0]
v_pk_fma_f32 v[124:125], v[236:237], v[132:133], v[124:125] op_sel:[1,0,0] neg_lo:[1,0,0] neg_hi:[1,0,0]
v_cvt_pk_bf16_f32 v166, v108, v109
v_cvt_pk_bf16_f32 v174, v124, v125
v_pk_fma_f32 v[78:79], v[222:223], v[128:129], v[78:79] op_sel_hi:[0,1,1]
v_pk_fma_f32 v[94:95], v[222:223], v[130:131], v[94:95] op_sel_hi:[0,1,1] neg_lo:[1,0,0] neg_hi:[1,0,0]
v_pk_fma_f32 v[78:79], v[222:223], v[130:131], v[78:79] op_sel:[1,0,0] neg_lo:[1,0,0] neg_hi:[1,0,0]
v_pk_fma_f32 v[94:95], v[222:223], v[128:129], v[94:95] op_sel:[1,0,0] neg_lo:[1,0,0] neg_hi:[1,0,0]
v_cvt_pk_bf16_f32 v151, v78, v79
v_cvt_pk_bf16_f32 v159, v94, v95
v_pk_fma_f32 v[110:111], v[238:239], v[132:133], v[110:111] op_sel_hi:[0,1,1]
v_pk_fma_f32 v[126:127], v[238:239], v[134:135], v[126:127] op_sel_hi:[0,1,1] neg_lo:[1,0,0] neg_hi:[1,0,0]
v_pk_fma_f32 v[110:111], v[238:239], v[134:135], v[110:111] op_sel:[1,0,0] neg_lo:[1,0,0] neg_hi:[1,0,0]
v_pk_fma_f32 v[126:127], v[238:239], v[132:133], v[126:127] op_sel:[1,0,0] neg_lo:[1,0,0] neg_hi:[1,0,0]
v_cvt_pk_bf16_f32 v167, v110, v111
v_cvt_pk_bf16_f32 v175, v126, v127
v_mfma_f32_16x16x32_bf16 v[32:35], v[148:151], v[248:251], 0
v_mfma_f32_16x16x32_bf16 v[36:39], v[164:167], v[248:251], 0
v_mfma_f32_16x16x32_bf16 v[40:43], v[148:151], v[252:255], 0
v_mfma_f32_16x16x32_bf16 v[44:47], v[164:167], v[252:255], 0
v_mfma_f32_16x16x32_bf16 v[48:51], v[156:159], v[248:251], 0
v_mfma_f32_16x16x32_bf16 v[52:55], v[172:175], v[248:251], 0
v_mfma_f32_16x16x32_bf16 v[56:59], v[156:159], v[252:255], 0
v_mfma_f32_16x16x32_bf16 v[60:63], v[172:175], v[252:255], 0
s_add_u32 s61, s14, 0
v_cvt_pk_bf16_f32 v192, v32, v33
v_cvt_pk_bf16_f32 v193, v34, v35
v_cvt_pk_bf16_f32 v194, v36, v37
v_cvt_pk_bf16_f32 v195, v38, v39
buffer_store_dwordx4 v[192:195], v10, s[44:47], s61 offen offset:256 sc1
ds_write_b128 v16, v[192:195] offset:256
s_add_u32 s61, s14, 131072
v_cvt_pk_bf16_f32 v196, v40, v41
v_cvt_pk_bf16_f32 v197, v42, v43
v_cvt_pk_bf16_f32 v198, v44, v45
v_cvt_pk_bf16_f32 v199, v46, v47
buffer_store_dwordx4 v[196:199], v10, s[44:47], s61 offen offset:256 sc1
ds_write_b128 v16, v[196:199] offset:8448
s_add_u32 s61, s14, 4096
v_cvt_pk_bf16_f32 v200, v48, v49
v_cvt_pk_bf16_f32 v201, v50, v51
v_cvt_pk_bf16_f32 v202, v52, v53
v_cvt_pk_bf16_f32 v203, v54, v55
buffer_store_dwordx4 v[200:203], v10, s[44:47], s61 offen offset:256 sc1
ds_write_b128 v16, v[200:203] offset:4352
s_add_u32 s61, s14, 135168
v_cvt_pk_bf16_f32 v204, v56, v57
v_cvt_pk_bf16_f32 v205, v58, v59
v_cvt_pk_bf16_f32 v206, v60, v61
v_cvt_pk_bf16_f32 v207, v62, v63
buffer_store_dwordx4 v[204:207], v10, s[44:47], s61 offen offset:256 sc1
ds_write_b128 v16, v[204:207] offset:12544
v_mov_b32 v2, v11
s_lshl_b32 s60, s35, 2
s_add_u32 s60, s60, s34
s_mul_i32 s60, s60, 131072
s_lshl_b32 s61, s101, 16
s_add_u32 s60, s60, s61
s_add_u32 s42, s60, 1048576
s_add_u32 s40, s32, s42
s_addc_u32 s41, s33, 0
s_mov_b32 s42, 65536
s_mov_b32 s43, 0x20000
s_waitcnt vmcnt(8) lgkmcnt(0)
v_mov_b32 v14, 3
s_mov_b64 exec, 1
ds_write_b32 v13, v14
s_mov_b64 exec, -1
ds_read_b128 v[8:11], v12 offset:0
s_waitcnt lgkmcnt(0)
L_ck55:
v_min3_u32 v15, v8, v9, v10
v_min_u32 v15, v15, v11
s_nop 0
v_readfirstlane_b32 s60, v15
s_nop 0
s_cmp_ge_u32 s60, 3
s_cbranch_scc1 L_ckd56
ds_read_b128 v[8:11], v12 offset:0
s_waitcnt lgkmcnt(0)
s_branch L_ck55
L_ckd56:
ds_read_b128 v[148:151], v17 offset:0
ds_read_b128 v[152:155], v17 offset:1024
ds_read_b128 v[156:159], v17 offset:2048
ds_read_b128 v[160:163], v17 offset:3072
ds_read_b128 v[164:167], v17 offset:4096
ds_read_b128 v[168:171], v17 offset:5120
ds_read_b128 v[172:175], v17 offset:6144
ds_read_b128 v[176:179], v17 offset:7168
ds_read_b128 v[96:99], v20 offset:0
ds_read_b128 v[100:103], v20 offset:4096
ds_read_b128 v[104:107], v20 offset:8192
ds_read_b128 v[108:111], v20 offset:12288
s_waitcnt lgkmcnt(4)
v_mov_b32 v14, 4
s_mov_b64 exec, 1
ds_write_b32 v13, v14
s_mov_b64 exec, -1
s_waitcnt lgkmcnt(0)
v_mfma_f32_32x32x16_bf16 v[32:47], v[148:151], v[96:99], 0
ds_read_b128 v[112:115], v21 offset:0
ds_read_b128 v[116:119], v21 offset:4096
v_mfma_f32_32x32x16_bf16 v[48:63], v[148:151], v[100:103], 0
ds_read_b128 v[120:123], v21 offset:8192
ds_read_b128 v[124:127], v21 offset:12288
v_mfma_f32_32x32x16_bf16 v[64:79], v[148:151], v[104:107], 0
s_add_u32 m0, s67, 32768
s_add_u32 s62, s64, 128
s_and_b32 s62, s62, 0x3ff
buffer_load_dwordx4 v244, s[48:51], s62 offen offset:0 lds
v_mfma_f32_32x32x16_bf16 v[80:95], v[148:151], v[108:111], 0
s_waitcnt lgkmcnt(3)
v_mfma_f32_32x32x16_bf16 v[32:47], v[152:155], v[112:115], v[32:47]
ds_read_b128 v[96:99], v22 offset:0
ds_read_b128 v[100:103], v22 offset:4096
s_waitcnt lgkmcnt(4)
v_mfma_f32_32x32x16_bf16 v[48:63], v[152:155], v[116:119], v[48:63]
ds_read_b128 v[104:107], v22 offset:8192
ds_read_b128 v[108:111], v22 offset:12288
s_waitcnt lgkmcnt(5)
v_mfma_f32_32x32x16_bf16 v[64:79], v[152:155], v[120:123], v[64:79]
buffer_load_dwordx4 v245, s[48:51], s62 offen offset:1024 lds
s_waitcnt lgkmcnt(4)
v_mfma_f32_32x32x16_bf16 v[80:95], v[152:155], v[124:127], v[80:95]
s_waitcnt lgkmcnt(3)
v_mfma_f32_32x32x16_bf16 v[32:47], v[156:159], v[96:99], v[32:47]
ds_read_b128 v[112:115], v23 offset:0
ds_read_b128 v[116:119], v23 offset:4096
s_waitcnt lgkmcnt(4)
v_mfma_f32_32x32x16_bf16 v[48:63], v[156:159], v[100:103], v[48:63]
ds_read_b128 v[120:123], v23 offset:8192
ds_read_b128 v[124:127], v23 offset:12288
s_waitcnt lgkmcnt(5)
v_mfma_f32_32x32x16_bf16 v[64:79], v[156:159], v[104:107], v[64:79]
buffer_load_dwordx4 v246, s[48:51], s62 offen offset:2048 lds
s_waitcnt lgkmcnt(4)
v_mfma_f32_32x32x16_bf16 v[80:95], v[156:159], v[108:111], v[80:95]
s_waitcnt lgkmcnt(3)
v_mfma_f32_32x32x16_bf16 v[32:47], v[160:163], v[112:115], v[32:47]
ds_read_b128 v[96:99], v20 offset:16384
ds_read_b128 v[100:103], v20 offset:20480
s_waitcnt lgkmcnt(4)
v_mfma_f32_32x32x16_bf16 v[48:63], v[160:163], v[116:119], v[48:63]
ds_read_b128 v[104:107], v20 offset:24576
ds_read_b128 v[108:111], v20 offset:28672
s_waitcnt lgkmcnt(5)
v_mfma_f32_32x32x16_bf16 v[64:79], v[160:163], v[120:123], v[64:79]
buffer_load_dwordx4 v247, s[48:51], s62 offen offset:3072 lds
s_waitcnt lgkmcnt(4)
v_mfma_f32_32x32x16_bf16 v[80:95], v[160:163], v[124:127], v[80:95]
s_waitcnt lgkmcnt(3)
v_mfma_f32_32x32x16_bf16 v[32:47], v[164:167], v[96:99], v[32:47]
ds_read_b128 v[112:115], v21 offset:16384
ds_read_b128 v[116:119], v21 offset:20480
s_waitcnt lgkmcnt(4)
v_mfma_f32_32x32x16_bf16 v[48:63], v[164:167], v[100:103], v[48:63]
ds_read_b128 v[120:123], v21 offset:24576
ds_read_b128 v[124:127], v21 offset:28672
s_waitcnt lgkmcnt(5)
v_mfma_f32_32x32x16_bf16 v[64:79], v[164:167], v[104:107], v[64:79]
s_add_u32 m0, s67, 49152
s_nop 0
buffer_load_dwordx4 v244, s[52:55], s62 offen offset:0 lds
s_waitcnt lgkmcnt(4)
v_mfma_f32_32x32x16_bf16 v[80:95], v[164:167], v[108:111], v[80:95]
s_waitcnt lgkmcnt(3)
v_mfma_f32_32x32x16_bf16 v[32:47], v[168:171], v[112:115], v[32:47]
ds_read_b128 v[96:99], v22 offset:16384
ds_read_b128 v[100:103], v22 offset:20480
s_waitcnt lgkmcnt(4)
v_mfma_f32_32x32x16_bf16 v[48:63], v[168:171], v[116:119], v[48:63]
ds_read_b128 v[104:107], v22 offset:24576
ds_read_b128 v[108:111], v22 offset:28672
s_waitcnt lgkmcnt(5)
v_mfma_f32_32x32x16_bf16 v[64:79], v[168:171], v[120:123], v[64:79]
buffer_load_dwordx4 v245, s[52:55], s62 offen offset:1024 lds
s_waitcnt lgkmcnt(4)
v_mfma_f32_32x32x16_bf16 v[80:95], v[168:171], v[124:127], v[80:95]
s_waitcnt lgkmcnt(3)
v_mfma_f32_32x32x16_bf16 v[32:47], v[172:175], v[96:99], v[32:47]
ds_read_b128 v[112:115], v23 offset:16384
ds_read_b128 v[116:119], v23 offset:20480
s_waitcnt lgkmcnt(4)
v_mfma_f32_32x32x16_bf16 v[48:63], v[172:175], v[100:103], v[48:63]
ds_read_b128 v[120:123], v23 offset:24576
ds_read_b128 v[124:127], v23 offset:28672
s_waitcnt lgkmcnt(5)
v_mfma_f32_32x32x16_bf16 v[64:79], v[172:175], v[104:107], v[64:79]
buffer_load_dwordx4 v246, s[52:55], s62 offen offset:2048 lds
s_waitcnt lgkmcnt(4)
v_mfma_f32_32x32x16_bf16 v[80:95], v[172:175], v[108:111], v[80:95]
s_waitcnt lgkmcnt(0)
v_mfma_f32_32x32x16_bf16 v[32:47], v[176:179], v[112:115], v[32:47]
v_mfma_f32_32x32x16_bf16 v[48:63], v[176:179], v[116:119], v[48:63]
v_mfma_f32_32x32x16_bf16 v[64:79], v[176:179], v[120:123], v[64:79]
buffer_load_dwordx4 v247, s[52:55], s62 offen offset:3072 lds
v_mfma_f32_32x32x16_bf16 v[80:95], v[176:179], v[124:127], v[80:95]
s_lshl_b32 s60, s66, 3
v_lshl_add_u32 v17, v5, 4, s60
v_lshlrev_b32 v28, 11, v17
v_lshl_add_u32 v28, v6, 2, v28
v_lshlrev_b32 v29, 13, v17
v_lshl_add_u32 v29, v6, 3, v29
v_lshlrev_b32 v30, 2, v6
v_mov_b32 v15, s37
s_waitcnt vmcnt(8)
s_mov_b64 exec, 1
s_cmp_eq_u32 s100, 0
s_cbranch_scc1 L_rs57
global_store_dword v19, v15, s[32:33]
s_branch L_rd58
L_rs57:
global_store_dword v19, v15, s[32:33] sc1
L_rd58:
s_mov_b64 exec, -1
ds_read_b128 v[8:11], v12 offset:0
s_waitcnt lgkmcnt(0)
L_ck59:
v_min3_u32 v15, v8, v9, v10
v_min_u32 v15, v15, v11
s_nop 0
v_readfirstlane_b32 s60, v15
s_nop 0
s_cmp_ge_u32 s60, 4
s_cbranch_scc1 L_ckd60
ds_read_b128 v[8:11], v12 offset:0
s_waitcnt lgkmcnt(0)
s_branch L_ck59
L_ckd60:
ds_read_b128 v[8:11], v12 offset:16
s_waitcnt lgkmcnt(0)
L_ck61:
v_min3_u32 v15, v8, v9, v10
v_min_u32 v15, v15, v11
s_nop 0
v_readfirstlane_b32 s60, v15
s_nop 0
s_cmp_ge_u32 s60, 2
s_cbranch_scc1 L_ckd62
ds_read_b128 v[8:11], v12 offset:16
s_waitcnt lgkmcnt(0)
s_branch L_ck61
L_ckd62:
s_add_u32 m0, s67, 65536
s_add_u32 s62, s64, 256
s_and_b32 s62, s62, 0x3ff
buffer_load_dwordx4 v244, s[48:51], s62 offen offset:0 lds
buffer_load_dwordx4 v245, s[48:51], s62 offen offset:1024 lds
buffer_load_dwordx4 v246, s[48:51], s62 offen offset:2048 lds
buffer_load_dwordx4 v247, s[48:51], s62 offen offset:3072 lds
s_add_u32 m0, s67, 81920
s_nop 0
buffer_load_dwordx4 v244, s[52:55], s62 offen offset:0 lds
buffer_load_dwordx4 v245, s[52:55], s62 offen offset:1024 lds
buffer_load_dwordx4 v246, s[52:55], s62 offen offset:2048 lds
buffer_load_dwordx4 v247, s[52:55], s62 offen offset:3072 lds
s_mov_b32 s92, 0
L_w63:
global_load_dword v8, v18, s[32:33] sc1
s_waitcnt vmcnt(0)
v_cmp_ne_u32 vcc, s37, v8
s_nop 0
s_cbranch_vccz L_wd64
s_sleep 4
s_add_u32 s92, s92, 1
s_cmp_lt_u32 s92, 200000
s_cbranch_scc1 L_w63
L_wd64:
v_mov_b32 v14, 5
s_mov_b64 exec, 1
ds_write_b32 v13, v14
s_mov_b64 exec, -1
s_add_u32 s63, s65, 8192
s_and_b32 s63, s63, 0xffff
buffer_load_dwordx4 v[180:183], v2, s[40:43], s63 offen offset:0 sc1
buffer_load_dwordx4 v[184:187], v2, s[40:43], s63 offen offset:1024 sc1
buffer_load_dwordx4 v[188:191], v2, s[40:43], s63 offen offset:2048 sc1
buffer_load_dwordx4 v[192:195], v2, s[40:43], s63 offen offset:3072 sc1
s_add_u32 m0, s67, 98304
s_add_u32 s62, s64, 384
s_and_b32 s62, s62, 0x3ff
buffer_load_dwordx4 v244, s[48:51], s62 offen offset:0 lds
buffer_load_dwordx4 v245, s[48:51], s62 offen offset:1024 lds
buffer_load_dwordx4 v246, s[48:51], s62 offen offset:2048 lds
buffer_load_dwordx4 v247, s[48:51], s62 offen offset:3072 lds
s_add_u32 s63, s65, 12288
s_and_b32 s63, s63, 0xffff
buffer_load_dwordx4 v[196:199], v2, s[40:43], s63 offen offset:0 sc1
buffer_load_dwordx4 v[200:203], v2, s[40:43], s63 offen offset:1024 sc1
buffer_load_dwordx4 v[204:207], v2, s[40:43], s63 offen offset:2048 sc1
buffer_load_dwordx4 v[208:211], v2, s[40:43], s63 offen offset:3072 sc1
ds_read_b128 v[8:11], v12 offset:0
s_waitcnt lgkmcnt(0)
L_ck65:
v_min3_u32 v15, v8, v9, v10
v_min_u32 v15, v15, v11
s_nop 0
v_readfirstlane_b32 s60, v15
s_nop 0
s_cmp_ge_u32 s60, 5
s_cbranch_scc1 L_ckd66
ds_read_b128 v[8:11], v12 offset:0
s_waitcnt lgkmcnt(0)
s_branch L_ck65
L_ckd66:
ds_read_b128 v[96:99], v20 offset:32768
ds_read_b128 v[100:103], v20 offset:36864
ds_read_b128 v[104:107], v20 offset:40960
ds_read_b128 v[108:111], v20 offset:45056
s_waitcnt vmcnt(11) lgkmcnt(3)
v_mfma_f32_32x32x16_bf16 v[32:47], v[180:183], v[96:99], v[32:47]
ds_read_b128 v[112:115], v21 offset:32768
ds_read_b128 v[116:119], v21 offset:36864
s_waitcnt lgkmcnt(4)
v_mfma_f32_32x32x16_bf16 v[48:63], v[180:183], v[100:103], v[48:63]
ds_read_b128 v[120:123], v21 offset:40960
ds_read_b128 v[124:127], v21 offset:45056
s_waitcnt lgkmcnt(5)
v_mfma_f32_32x32x16_bf16 v[64:79], v[180:183], v[104:107], v[64:79]
s_waitcnt lgkmcnt(4)
v_mfma_f32_32x32x16_bf16 v[80:95], v[180:183], v[108:111], v[80:95]
s_add_u32 s63, s65, 16384
s_and_b32 s63, s63, 0xffff
buffer_load_dwordx4 v[212:215], v2, s[40:43], s63 offen offset:0 sc1
buffer_load_dwordx4 v[216:219], v2, s[40:43], s63 offen offset:1024 sc1
s_waitcnt vmcnt(12) lgkmcnt(3)
v_mfma_f32_32x32x16_bf16 v[32:47], v[184:187], v[112:115], v[32:47]
ds_read_b128 v[96:99], v22 offset:32768
ds_read_b128 v[100:103], v22 offset:36864
s_waitcnt lgkmcnt(4)
v_mfma_f32_32x32x16_bf16 v[48:63], v[184:187], v[116:119], v[48:63]
ds_read_b128 v[104:107], v22 offset:40960
ds_read_b128 v[108:111], v22 offset:45056
s_waitcnt lgkmcnt(5)
v_mfma_f32_32x32x16_bf16 v[64:79], v[184:187], v[120:123], v[64:79]
s_waitcnt lgkmcnt(4)
v_mfma_f32_32x32x16_bf16 v[80:95], v[184:187], v[124:127], v[80:95]
buffer_load_dwordx4 v[220:223], v2, s[40:43], s63 offen offset:2048 sc1
buffer_load_dwordx4 v[224:227], v2, s[40:43], s63 offen offset:3072 sc1
s_waitcnt vmcnt(13) lgkmcnt(3)
v_mfma_f32_32x32x16_bf16 v[32:47], v[188:191], v[96:99], v[32:47]
ds_read_b128 v[112:115], v23 offset:32768
ds_read_b128 v[116:119], v23 offset:36864
s_waitcnt lgkmcnt(4)
v_mfma_f32_32x32x16_bf16 v[48:63], v[188:191], v[100:103], v[48:63]
ds_read_b128 v[120:123], v23 offset:40960
ds_read_b128 v[124:127], v23 offset:45056
s_waitcnt lgkmcnt(5)
v_mfma_f32_32x32x16_bf16 v[64:79], v[188:191], v[104:107], v[64:79]
s_waitcnt lgkmcnt(4)
v_mfma_f32_32x32x16_bf16 v[80:95], v[188:191], v[108:111], v[80:95]
s_add_u32 s63, s65, 20480
s_and_b32 s63, s63, 0xffff
buffer_load_dwordx4 v[228:231], v2, s[40:43], s63 offen offset:0 sc1
buffer_load_dwordx4 v[232:235], v2, s[40:43], s63 offen offset:1024 sc1
s_waitcnt vmcnt(14) lgkmcnt(3)
v_mfma_f32_32x32x16_bf16 v[32:47], v[192:195], v[112:115], v[32:47]
ds_read_b128 v[96:99], v20 offset:49152
ds_read_b128 v[100:103], v20 offset:53248
s_waitcnt lgkmcnt(4)
v_mfma_f32_32x32x16_bf16 v[48:63], v[192:195], v[116:119], v[48:63]
ds_read_b128 v[104:107], v20 offset:57344
ds_read_b128 v[108:111], v20 offset:61440
s_waitcnt lgkmcnt(5)
v_mfma_f32_32x32x16_bf16 v[64:79], v[192:195], v[120:123], v[64:79]
s_waitcnt lgkmcnt(4)
v_mfma_f32_32x32x16_bf16 v[80:95], v[192:195], v[124:127], v[80:95]
buffer_load_dwordx4 v[236:239], v2, s[40:43], s63 offen offset:2048 sc1
buffer_load_dwordx4 v[240:243], v2, s[40:43], s63 offen offset:3072 sc1
s_waitcnt vmcnt(11) lgkmcnt(3)
v_mov_b32 v14, 6
s_mov_b64 exec, 1
ds_write_b32 v13, v14
s_mov_b64 exec, -1
v_mfma_f32_32x32x16_bf16 v[32:47], v[196:199], v[96:99], v[32:47]
ds_read_b128 v[112:115], v21 offset:49152
ds_read_b128 v[116:119], v21 offset:53248
s_waitcnt lgkmcnt(5)
v_mfma_f32_32x32x16_bf16 v[48:63], v[196:199], v[100:103], v[48:63]
ds_read_b128 v[120:123], v21 offset:57344
ds_read_b128 v[124:127], v21 offset:61440
s_waitcnt lgkmcnt(6)
v_mfma_f32_32x32x16_bf16 v[64:79], v[196:199], v[104:107], v[64:79]
s_add_u32 m0, s67, 0
s_nop 0
buffer_load_dwordx4 v244, s[52:55], s62 offen offset:0 lds
s_waitcnt lgkmcnt(5)
v_mfma_f32_32x32x16_bf16 v[80:95], v[196:199], v[108:111], v[80:95]
s_add_u32 s63, s65, 24576
s_and_b32 s63, s63, 0xffff
buffer_load_dwordx4 v[148:151], v2, s[40:43], s63 offen offset:0 sc1
buffer_load_dwordx4 v[152:155], v2, s[40:43], s63 offen offset:1024 sc1
s_waitcnt vmcnt(13) lgkmcnt(3)
v_mfma_f32_32x32x16_bf16 v[32:47], v[200:203], v[112:115], v[32:47]
ds_read_b128 v[96:99], v22 offset:49152
ds_read_b128 v[100:103], v22 offset:53248
s_waitcnt lgkmcnt(4)
v_mfma_f32_32x32x16_bf16 v[48:63], v[200:203], v[116:119], v[48:63]
ds_read_b128 v[104:107], v22 offset:57344
ds_read_b128 v[108:111], v22 offset:61440
s_waitcnt lgkmcnt(5)
v_mfma_f32_32x32x16_bf16 v[64:79], v[200:203], v[120:123], v[64:79]
buffer_load_dwordx4 v245, s[52:55], s62 offen offset:1024 lds
s_waitcnt lgkmcnt(4)
v_mfma_f32_32x32x16_bf16 v[80:95], v[200:203], v[124:127], v[80:95]
buffer_load_dwordx4 v[156:159], v2, s[40:43], s63 offen offset:2048 sc1
buffer_load_dwordx4 v[160:163], v2, s[40:43], s63 offen offset:3072 sc1
s_waitcnt vmcnt(15) lgkmcnt(3)
v_mfma_f32_32x32x16_bf16 v[32:47], v[204:207], v[96:99], v[32:47]
ds_read_b128 v[112:115], v23 offset:49152
ds_read_b128 v[116:119], v23 offset:53248
s_waitcnt lgkmcnt(4)
v_mfma_f32_32x32x16_bf16 v[48:63], v[204:207], v[100:103], v[48:63]
ds_read_b128 v[120:123], v23 offset:57344
ds_read_b128 v[124:127], v23 offset:61440
s_waitcnt lgkmcnt(5)
v_mfma_f32_32x32x16_bf16 v[64:79], v[204:207], v[104:107], v[64:79]
buffer_load_dwordx4 v246, s[52:55], s62 offen offset:2048 lds
s_waitcnt lgkmcnt(4)
v_mfma_f32_32x32x16_bf16 v[80:95], v[204:207], v[108:111], v[80:95]
s_add_u32 s63, s65, 28672
s_and_b32 s63, s63, 0xffff
buffer_load_dwordx4 v[164:167], v2, s[40:43], s63 offen offset:0 sc1
buffer_load_dwordx4 v[168:171], v2, s[40:43], s63 offen offset:1024 sc1
ds_read_b128 v[8:11], v12
s_waitcnt vmcnt(17) lgkmcnt(0)
L_ck67:
v_min3_u32 v15, v8, v9, v10
v_min_u32 v15, v15, v11
s_nop 0
v_readfirstlane_b32 s60, v15
s_nop 0
s_cmp_ge_u32 s60, 6
s_cbranch_scc1 L_ckd68
ds_read_b128 v[8:11], v12 offset:0
s_waitcnt lgkmcnt(0)
s_branch L_ck67
L_ckd68:
v_mfma_f32_32x32x16_bf16 v[32:47], v[208:211], v[112:115], v[32:47]
ds_read_b128 v[96:99], v24 offset:0
ds_read_b128 v[100:103], v24 offset:4096
v_mfma_f32_32x32x16_bf16 v[48:63], v[208:211], v[116:119], v[48:63]
ds_read_b128 v[104:107], v24 offset:8192
ds_read_b128 v[108:111], v24 offset:12288
v_mfma_f32_32x32x16_bf16 v[64:79], v[208:211], v[120:123], v[64:79]
buffer_load_dwordx4 v247, s[52:55], s62 offen offset:3072 lds
v_mfma_f32_32x32x16_bf16 v[80:95], v[208:211], v[124:127], v[80:95]
buffer_load_dwordx4 v[172:175], v2, s[40:43], s63 offen offset:2048 sc1
buffer_load_dwordx4 v[176:179], v2, s[40:43], s63 offen offset:3072 sc1
s_waitcnt vmcnt(19) lgkmcnt(3)
v_mfma_f32_32x32x16_bf16 v[32:47], v[212:215], v[96:99], v[32:47]
ds_read_b128 v[112:115], v25 offset:0
ds_read_b128 v[116:119], v25 offset:4096
s_waitcnt lgkmcnt(4)
v_mfma_f32_32x32x16_bf16 v[48:63], v[212:215], v[100:103], v[48:63]
ds_read_b128 v[120:123], v25 offset:8192
ds_read_b128 v[124:127], v25 offset:12288
s_waitcnt lgkmcnt(5)
v_mfma_f32_32x32x16_bf16 v[64:79], v[212:215], v[104:107], v[64:79]
s_add_u32 m0, s67, 16384
s_add_u32 s62, s64, 512
s_and_b32 s62, s62, 0x3ff
buffer_load_dwordx4 v244, s[48:51], s62 offen offset:0 lds
s_waitcnt lgkmcnt(4)
v_mfma_f32_32x32x16_bf16 v[80:95], v[212:215], v[108:111], v[80:95]
s_add_u32 s63, s65, 32768
s_and_b32 s63, s63, 0xffff
buffer_load_dwordx4 v[180:183], v2, s[40:43], s63 offen offset:0 sc1
buffer_load_dwordx4 v[184:187], v2, s[40:43], s63 offen offset:1024 sc1
s_waitcnt vmcnt(21) lgkmcnt(3)
v_mfma_f32_32x32x16_bf16 v[32:47], v[216:219], v[112:115], v[32:47]
ds_read_b128 v[96:99], v26 offset:0
ds_read_b128 v[100:103], v26 offset:4096
s_waitcnt lgkmcnt(4)
v_mfma_f32_32x32x16_bf16 v[48:63], v[216:219], v[116:119], v[48:63]
ds_read_b128 v[104:107], v26 offset:8192
ds_read_b128 v[108:111], v26 offset:12288
s_waitcnt lgkmcnt(5)
v_mfma_f32_32x32x16_bf16 v[64:79], v[216:219], v[120:123], v[64:79]
buffer_load_dwordx4 v245, s[48:51], s62 offen offset:1024 lds
s_waitcnt lgkmcnt(4)
v_mfma_f32_32x32x16_bf16 v[80:95], v[216:219], v[124:127], v[80:95]
buffer_load_dwordx4 v[188:191], v2, s[40:43], s63 offen offset:2048 sc1
buffer_load_dwordx4 v[192:195], v2, s[40:43], s63 offen offset:3072 sc1
s_waitcnt vmcnt(23) lgkmcnt(3)
v_mfma_f32_32x32x16_bf16 v[32:47], v[220:223], v[96:99], v[32:47]
ds_read_b128 v[112:115], v27 offset:0
ds_read_b128 v[116:119], v27 offset:4096
s_waitcnt lgkmcnt(4)
v_mfma_f32_32x32x16_bf16 v[48:63], v[220:223], v[100:103], v[48:63]
ds_read_b128 v[120:123], v27 offset:8192
ds_read_b128 v[124:127], v27 offset:12288
s_waitcnt lgkmcnt(5)
v_mfma_f32_32x32x16_bf16 v[64:79], v[220:223], v[104:107], v[64:79]
buffer_load_dwordx4 v246, s[48:51], s62 offen offset:2048 lds
s_waitcnt lgkmcnt(4)
v_mfma_f32_32x32x16_bf16 v[80:95], v[220:223], v[108:111], v[80:95]
s_add_u32 s63, s65, 36864
s_and_b32 s63, s63, 0xffff
buffer_load_dwordx4 v[196:199], v2, s[40:43], s63 offen offset:0 sc1
buffer_load_dwordx4 v[200:203], v2, s[40:43], s63 offen offset:1024 sc1
s_waitcnt vmcnt(25) lgkmcnt(3)
v_mfma_f32_32x32x16_bf16 v[32:47], v[224:227], v[112:115], v[32:47]
ds_read_b128 v[96:99], v24 offset:16384
ds_read_b128 v[100:103], v24 offset:20480
s_waitcnt lgkmcnt(4)
v_mfma_f32_32x32x16_bf16 v[48:63], v[224:227], v[116:119], v[48:63]
ds_read_b128 v[104:107], v24 offset:24576
ds_read_b128 v[108:111], v24 offset:28672
s_waitcnt lgkmcnt(5)
v_mfma_f32_32x32x16_bf16 v[64:79], v[224:227], v[120:123], v[64:79]
buffer_load_dwordx4 v247, s[48:51], s62 offen offset:3072 lds
s_waitcnt lgkmcnt(4)
v_mfma_f32_32x32x16_bf16 v[80:95], v[224:227], v[124:127], v[80:95]
buffer_load_dwordx4 v[204:207], v2, s[40:43], s63 offen offset:2048 sc1
buffer_load_dwordx4 v[208:211], v2, s[40:43], s63 offen offset:3072 sc1
s_waitcnt vmcnt(14) lgkmcnt(3)
v_mov_b32 v14, 7
s_mov_b64 exec, 1
ds_write_b32 v13, v14
s_mov_b64 exec, -1
v_mfma_f32_32x32x16_bf16 v[32:47], v[228:231], v[96:99], v[32:47]
ds_read_b128 v[112:115], v25 offset:16384
ds_read_b128 v[116:119], v25 offset:20480
s_waitcnt lgkmcnt(5)
v_mfma_f32_32x32x16_bf16 v[48:63], v[228:231], v[100:103], v[48:63]
ds_read_b128 v[120:123], v25 offset:24576
ds_read_b128 v[124:127], v25 offset:28672
s_waitcnt lgkmcnt(6)
v_mfma_f32_32x32x16_bf16 v[64:79], v[228:231], v[104:107], v[64:79]
s_add_u32 m0, s67, 32768
s_nop 0
buffer_load_dwordx4 v244, s[52:55], s62 offen offset:0 lds
s_waitcnt lgkmcnt(5)
v_mfma_f32_32x32x16_bf16 v[80:95], v[228:231], v[108:111], v[80:95]
s_add_u32 s63, s65, 40960
s_and_b32 s63, s63, 0xffff
buffer_load_dwordx4 v[212:215], v2, s[40:43], s63 offen offset:0 sc1
buffer_load_dwordx4 v[216:219], v2, s[40:43], s63 offen offset:1024 sc1
s_waitcnt vmcnt(29) lgkmcnt(3)
v_mfma_f32_32x32x16_bf16 v[32:47], v[232:235], v[112:115], v[32:47]
ds_read_b128 v[96:99], v26 offset:16384
ds_read_b128 v[100:103], v26 offset:20480
s_waitcnt lgkmcnt(4)
v_mfma_f32_32x32x16_bf16 v[48:63], v[232:235], v[116:119], v[48:63]
ds_read_b128 v[104:107], v26 offset:24576
ds_read_b128 v[108:111], v26 offset:28672
s_waitcnt lgkmcnt(5)
v_mfma_f32_32x32x16_bf16 v[64:79], v[232:235], v[120:123], v[64:79]
buffer_load_dwordx4 v245, s[52:55], s62 offen offset:1024 lds
s_waitcnt lgkmcnt(4)
v_mfma_f32_32x32x16_bf16 v[80:95], v[232:235], v[124:127], v[80:95]
buffer_load_dwordx4 v[220:223], v2, s[40:43], s63 offen offset:2048 sc1
buffer_load_dwordx4 v[224:227], v2, s[40:43], s63 offen offset:3072 sc1
s_waitcnt vmcnt(31) lgkmcnt(3)
v_mfma_f32_32x32x16_bf16 v[32:47], v[236:239], v[96:99], v[32:47]
ds_read_b128 v[112:115], v27 offset:16384
ds_read_b128 v[116:119], v27 offset:20480
s_waitcnt lgkmcnt(4)
v_mfma_f32_32x32x16_bf16 v[48:63], v[236:239], v[100:103], v[48:63]
ds_read_b128 v[120:123], v27 offset:24576
ds_read_b128 v[124:127], v27 offset:28672
s_waitcnt lgkmcnt(5)
v_mfma_f32_32x32x16_bf16 v[64:79], v[236:239], v[104:107], v[64:79]
buffer_load_dwordx4 v246, s[52:55], s62 offen offset:2048 lds
s_waitcnt lgkmcnt(4)
v_mfma_f32_32x32x16_bf16 v[80:95], v[236:239], v[108:111], v[80:95]
s_add_u32 s63, s65, 45056
s_and_b32 s63, s63, 0xffff
buffer_load_dwordx4 v[228:231], v2, s[40:43], s63 offen offset:0 sc1
buffer_load_dwordx4 v[232:235], v2, s[40:43], s63 offen offset:1024 sc1
ds_read_b128 v[8:11], v12
s_waitcnt vmcnt(33) lgkmcnt(0)
L_ck69:
v_min3_u32 v15, v8, v9, v10
v_min_u32 v15, v15, v11
s_nop 0
v_readfirstlane_b32 s60, v15
s_nop 0
s_cmp_ge_u32 s60, 7
s_cbranch_scc1 L_ckd70
ds_read_b128 v[8:11], v12 offset:0
s_waitcnt lgkmcnt(0)
s_branch L_ck69
L_ckd70:
v_mfma_f32_32x32x16_bf16 v[32:47], v[240:243], v[112:115], v[32:47]
ds_read_b128 v[96:99], v24 offset:32768
ds_read_b128 v[100:103], v24 offset:36864
v_mfma_f32_32x32x16_bf16 v[48:63], v[240:243], v[116:119], v[48:63]
ds_read_b128 v[104:107], v24 offset:40960
ds_read_b128 v[108:111], v24 offset:45056
v_mfma_f32_32x32x16_bf16 v[64:79], v[240:243], v[120:123], v[64:79]
buffer_load_dwordx4 v247, s[52:55], s62 offen offset:3072 lds
v_mfma_f32_32x32x16_bf16 v[80:95], v[240:243], v[124:127], v[80:95]
buffer_load_dwordx4 v[236:239], v2, s[40:43], s63 offen offset:2048 sc1
buffer_load_dwordx4 v[240:243], v2, s[40:43], s63 offen offset:3072 sc1
s_waitcnt vmcnt(34) lgkmcnt(3)
v_mfma_f32_32x32x16_bf16 v[32:47], v[148:151], v[96:99], v[32:47]
ds_read_b128 v[112:115], v25 offset:32768
ds_read_b128 v[116:119], v25 offset:36864
s_waitcnt lgkmcnt(4)
v_mfma_f32_32x32x16_bf16 v[48:63], v[148:151], v[100:103], v[48:63]
ds_read_b128 v[120:123], v25 offset:40960
ds_read_b128 v[124:127], v25 offset:45056
s_waitcnt lgkmcnt(5)
v_mfma_f32_32x32x16_bf16 v[64:79], v[148:151], v[104:107], v[64:79]
s_add_u32 m0, s67, 49152
s_add_u32 s62, s64, 640
s_and_b32 s62, s62, 0x3ff
buffer_load_dwordx4 v244, s[48:51], s62 offen offset:0 lds
s_waitcnt lgkmcnt(4)
v_mfma_f32_32x32x16_bf16 v[80:95], v[148:151], v[108:111], v[80:95]
s_add_u32 s63, s65, 49152
s_and_b32 s63, s63, 0xffff
buffer_load_dwordx4 v[148:151], v2, s[40:43], s63 offen offset:0 sc1
s_waitcnt vmcnt(35) lgkmcnt(3)
v_mfma_f32_32x32x16_bf16 v[32:47], v[152:155], v[112:115], v[32:47]
ds_read_b128 v[96:99], v26 offset:32768
ds_read_b128 v[100:103], v26 offset:36864
s_waitcnt lgkmcnt(4)
v_mfma_f32_32x32x16_bf16 v[48:63], v[152:155], v[116:119], v[48:63]
ds_read_b128 v[104:107], v26 offset:40960
ds_read_b128 v[108:111], v26 offset:45056
s_waitcnt lgkmcnt(5)
v_mfma_f32_32x32x16_bf16 v[64:79], v[152:155], v[120:123], v[64:79]
buffer_load_dwordx4 v245, s[48:51], s62 offen offset:1024 lds
s_waitcnt lgkmcnt(4)
v_mfma_f32_32x32x16_bf16 v[80:95], v[152:155], v[124:127], v[80:95]
buffer_load_dwordx4 v[152:155], v2, s[40:43], s63 offen offset:1024 sc1
s_waitcnt vmcnt(35) lgkmcnt(3)
v_mfma_f32_32x32x16_bf16 v[32:47], v[156:159], v[96:99], v[32:47]
ds_read_b128 v[112:115], v27 offset:32768
ds_read_b128 v[116:119], v27 offset:36864
s_waitcnt lgkmcnt(4)
v_mfma_f32_32x32x16_bf16 v[48:63], v[156:159], v[100:103], v[48:63]
ds_read_b128 v[120:123], v27 offset:40960
ds_read_b128 v[124:127], v27 offset:45056
s_waitcnt lgkmcnt(5)
v_mfma_f32_32x32x16_bf16 v[64:79], v[156:159], v[104:107], v[64:79]
buffer_load_dwordx4 v246, s[48:51], s62 offen offset:2048 lds
s_waitcnt lgkmcnt(4)
v_mfma_f32_32x32x16_bf16 v[80:95], v[156:159], v[108:111], v[80:95]
buffer_load_dwordx4 v[156:159], v2, s[40:43], s63 offen offset:2048 sc1
s_waitcnt vmcnt(36) lgkmcnt(3)
v_mfma_f32_32x32x16_bf16 v[32:47], v[160:163], v[112:115], v[32:47]
ds_read_b128 v[96:99], v20 offset:0
ds_read_b128 v[100:103], v20 offset:4096
s_waitcnt lgkmcnt(4)
v_mfma_f32_32x32x16_bf16 v[48:63], v[160:163], v[116:119], v[48:63]
ds_read_b128 v[104:107], v20 offset:8192
ds_read_b128 v[108:111], v20 offset:12288
s_waitcnt lgkmcnt(5)
v_mfma_f32_32x32x16_bf16 v[64:79], v[160:163], v[120:123], v[64:79]
buffer_load_dwordx4 v247, s[48:51], s62 offen offset:3072 lds
s_waitcnt lgkmcnt(4)
v_mfma_f32_32x32x16_bf16 v[80:95], v[160:163], v[124:127], v[80:95]
buffer_load_dwordx4 v[160:163], v2, s[40:43], s63 offen offset:3072 sc1
s_waitcnt vmcnt(10) lgkmcnt(3)
v_mov_b32 v14, 8
s_mov_b64 exec, 1
ds_write_b32 v13, v14
s_mov_b64 exec, -1
v_mfma_f32_32x32x16_bf16 v[32:47], v[164:167], v[96:99], v[32:47]
ds_read_b128 v[112:115], v21 offset:0
ds_read_b128 v[116:119], v21 offset:4096
s_waitcnt lgkmcnt(5)
v_mfma_f32_32x32x16_bf16 v[48:63], v[164:167], v[100:103], v[48:63]
ds_read_b128 v[120:123], v21 offset:8192
ds_read_b128 v[124:127], v21 offset:12288
s_waitcnt lgkmcnt(6)
v_mfma_f32_32x32x16_bf16 v[64:79], v[164:167], v[104:107], v[64:79]
s_add_u32 m0, s67, 65536
s_nop 0
buffer_load_dwordx4 v244, s[52:55], s62 offen offset:0 lds
s_waitcnt lgkmcnt(5)
v_mfma_f32_32x32x16_bf16 v[80:95], v[164:167], v[108:111], v[80:95]
s_add_u32 s63, s65, 53248
s_and_b32 s63, s63, 0xffff
buffer_load_dwordx4 v[164:167], v2, s[40:43], s63 offen offset:0 sc1
s_waitcnt vmcnt(37) lgkmcnt(3)
v_mfma_f32_32x32x16_bf16 v[32:47], v[168:171], v[112:115], v[32:47]
ds_read_b128 v[96:99], v22 offset:0
ds_read_b128 v[100:103], v22 offset:4096
s_waitcnt lgkmcnt(4)
v_mfma_f32_32x32x16_bf16 v[48:63], v[168:171], v[116:119], v[48:63]
ds_read_b128 v[104:107], v22 offset:8192
ds_read_b128 v[108:111], v22 offset:12288
s_waitcnt lgkmcnt(5)
v_mfma_f32_32x32x16_bf16 v[64:79], v[168:171], v[120:123], v[64:79]
buffer_load_dwordx4 v245, s[52:55], s62 offen offset:1024 lds
s_waitcnt lgkmcnt(4)
v_mfma_f32_32x32x16_bf16 v[80:95], v[168:171], v[124:127], v[80:95]
buffer_load_dwordx4 v[168:171], v2, s[40:43], s63 offen offset:1024 sc1
s_waitcnt vmcnt(37) lgkmcnt(3)
v_mfma_f32_32x32x16_bf16 v[32:47], v[172:175], v[96:99], v[32:47]
ds_read_b128 v[112:115], v23 offset:0
ds_read_b128 v[116:119], v23 offset:4096
s_waitcnt lgkmcnt(4)
v_mfma_f32_32x32x16_bf16 v[48:63], v[172:175], v[100:103], v[48:63]
ds_read_b128 v[120:123], v23 offset:8192
ds_read_b128 v[124:127], v23 offset:12288
s_waitcnt lgkmcnt(5)
v_mfma_f32_32x32x16_bf16 v[64:79], v[172:175], v[104:107], v[64:79]
buffer_load_dwordx4 v246, s[52:55], s62 offen offset:2048 lds
s_waitcnt lgkmcnt(4)
v_mfma_f32_32x32x16_bf16 v[80:95], v[172:175], v[108:111], v[80:95]
buffer_load_dwordx4 v[172:175], v2, s[40:43], s63 offen offset:2048 sc1
ds_read_b128 v[8:11], v12
s_waitcnt vmcnt(38) lgkmcnt(0)
L_ck71:
v_min3_u32 v15, v8, v9, v10
v_min_u32 v15, v15, v11
s_nop 0
v_readfirstlane_b32 s60, v15
s_nop 0
s_cmp_ge_u32 s60, 8
s_cbranch_scc1 L_ckd72
ds_read_b128 v[8:11], v12 offset:0
s_waitcnt lgkmcnt(0)
s_branch L_ck71
L_ckd72:
v_mfma_f32_32x32x16_bf16 v[32:47], v[176:179], v[112:115], v[32:47]
ds_read_b128 v[96:99], v20 offset:16384
ds_read_b128 v[100:103], v20 offset:20480
v_mfma_f32_32x32x16_bf16 v[48:63], v[176:179], v[116:119], v[48:63]
ds_read_b128 v[104:107], v20 offset:24576
ds_read_b128 v[108:111], v20 offset:28672
v_mfma_f32_32x32x16_bf16 v[64:79], v[176:179], v[120:123], v[64:79]
buffer_load_dwordx4 v247, s[52:55], s62 offen offset:3072 lds
v_mfma_f32_32x32x16_bf16 v[80:95], v[176:179], v[124:127], v[80:95]
buffer_load_dwordx4 v[176:179], v2, s[40:43], s63 offen offset:3072 sc1
s_waitcnt vmcnt(38) lgkmcnt(3)
v_mfma_f32_32x32x16_bf16 v[32:47], v[180:183], v[96:99], v[32:47]
ds_read_b128 v[112:115], v21 offset:16384
ds_read_b128 v[116:119], v21 offset:20480
s_waitcnt lgkmcnt(4)
v_mfma_f32_32x32x16_bf16 v[48:63], v[180:183], v[100:103], v[48:63]
ds_read_b128 v[120:123], v21 offset:24576
ds_read_b128 v[124:127], v21 offset:28672
s_waitcnt lgkmcnt(5)
v_mfma_f32_32x32x16_bf16 v[64:79], v[180:183], v[104:107], v[64:79]
s_add_u32 m0, s67, 81920
s_add_u32 s62, s64, 768
s_and_b32 s62, s62, 0x3ff
buffer_load_dwordx4 v244, s[48:51], s62 offen offset:0 lds
s_waitcnt lgkmcnt(4)
v_mfma_f32_32x32x16_bf16 v[80:95], v[180:183], v[108:111], v[80:95]
s_add_u32 s63, s65, 57344
s_and_b32 s63, s63, 0xffff
buffer_load_dwordx4 v[180:183], v2, s[40:43], s63 offen offset:0 sc1
s_waitcnt vmcnt(39) lgkmcnt(3)
v_mfma_f32_32x32x16_bf16 v[32:47], v[184:187], v[112:115], v[32:47]
ds_read_b128 v[96:99], v22 offset:16384
ds_read_b128 v[100:103], v22 offset:20480
s_waitcnt lgkmcnt(4)
v_mfma_f32_32x32x16_bf16 v[48:63], v[184:187], v[116:119], v[48:63]
ds_read_b128 v[104:107], v22 offset:24576
ds_read_b128 v[108:111], v22 offset:28672
s_waitcnt lgkmcnt(5)
v_mfma_f32_32x32x16_bf16 v[64:79], v[184:187], v[120:123], v[64:79]
buffer_load_dwordx4 v245, s[48:51], s62 offen offset:1024 lds
s_waitcnt lgkmcnt(4)
v_mfma_f32_32x32x16_bf16 v[80:95], v[184:187], v[124:127], v[80:95]
buffer_load_dwordx4 v[184:187], v2, s[40:43], s63 offen offset:1024 sc1
s_waitcnt vmcnt(39) lgkmcnt(3)
v_mfma_f32_32x32x16_bf16 v[32:47], v[188:191], v[96:99], v[32:47]
ds_read_b128 v[112:115], v23 offset:16384
ds_read_b128 v[116:119], v23 offset:20480
s_waitcnt lgkmcnt(4)
v_mfma_f32_32x32x16_bf16 v[48:63], v[188:191], v[100:103], v[48:63]
ds_read_b128 v[120:123], v23 offset:24576
ds_read_b128 v[124:127], v23 offset:28672
s_waitcnt lgkmcnt(5)
v_mfma_f32_32x32x16_bf16 v[64:79], v[188:191], v[104:107], v[64:79]
buffer_load_dwordx4 v246, s[48:51], s62 offen offset:2048 lds
s_waitcnt lgkmcnt(4)
v_mfma_f32_32x32x16_bf16 v[80:95], v[188:191], v[108:111], v[80:95]
buffer_load_dwordx4 v[188:191], v2, s[40:43], s63 offen offset:2048 sc1
s_waitcnt vmcnt(40) lgkmcnt(3)
v_mfma_f32_32x32x16_bf16 v[32:47], v[192:195], v[112:115], v[32:47]
ds_read_b128 v[96:99], v20 offset:32768
ds_read_b128 v[100:103], v20 offset:36864
s_waitcnt lgkmcnt(4)
v_mfma_f32_32x32x16_bf16 v[48:63], v[192:195], v[116:119], v[48:63]
ds_read_b128 v[104:107], v20 offset:40960
ds_read_b128 v[108:111], v20 offset:45056
s_waitcnt lgkmcnt(5)
v_mfma_f32_32x32x16_bf16 v[64:79], v[192:195], v[120:123], v[64:79]
buffer_load_dwordx4 v247, s[48:51], s62 offen offset:3072 lds
s_waitcnt lgkmcnt(4)
v_mfma_f32_32x32x16_bf16 v[80:95], v[192:195], v[124:127], v[80:95]
buffer_load_dwordx4 v[192:195], v2, s[40:43], s63 offen offset:3072 sc1
s_waitcnt vmcnt(9) lgkmcnt(3)
v_mov_b32 v14, 9
s_mov_b64 exec, 1
ds_write_b32 v13, v14
s_mov_b64 exec, -1
v_mfma_f32_32x32x16_bf16 v[32:47], v[196:199], v[96:99], v[32:47]
ds_read_b128 v[112:115], v21 offset:32768
ds_read_b128 v[116:119], v21 offset:36864
s_waitcnt lgkmcnt(5)
v_mfma_f32_32x32x16_bf16 v[48:63], v[196:199], v[100:103], v[48:63]
ds_read_b128 v[120:123], v21 offset:40960
ds_read_b128 v[124:127], v21 offset:45056
s_waitcnt lgkmcnt(6)
v_mfma_f32_32x32x16_bf16 v[64:79], v[196:199], v[104:107], v[64:79]
s_add_u32 m0, s67, 98304
s_nop 0
buffer_load_dwordx4 v244, s[52:55], s62 offen offset:0 lds
s_waitcnt lgkmcnt(5)
v_mfma_f32_32x32x16_bf16 v[80:95], v[196:199], v[108:111], v[80:95]
s_add_u32 s63, s65, 61440
s_and_b32 s63, s63, 0xffff
buffer_load_dwordx4 v[196:199], v2, s[40:43], s63 offen offset:0 sc1
s_waitcnt vmcnt(41) lgkmcnt(3)
v_mfma_f32_32x32x16_bf16 v[32:47], v[200:203], v[112:115], v[32:47]
ds_read_b128 v[96:99], v22 offset:32768
ds_read_b128 v[100:103], v22 offset:36864
s_waitcnt lgkmcnt(4)
v_mfma_f32_32x32x16_bf16 v[48:63], v[200:203], v[116:119], v[48:63]
ds_read_b128 v[104:107], v22 offset:40960
ds_read_b128 v[108:111], v22 offset:45056
s_waitcnt lgkmcnt(5)
v_mfma_f32_32x32x16_bf16 v[64:79], v[200:203], v[120:123], v[64:79]
buffer_load_dwordx4 v245, s[52:55], s62 offen offset:1024 lds
s_waitcnt lgkmcnt(4)
v_mfma_f32_32x32x16_bf16 v[80:95], v[200:203], v[124:127], v[80:95]
buffer_load_dwordx4 v[200:203], v2, s[40:43], s63 offen offset:1024 sc1
s_waitcnt vmcnt(41) lgkmcnt(3)
v_mfma_f32_32x32x16_bf16 v[32:47], v[204:207], v[96:99], v[32:47]
ds_read_b128 v[112:115], v23 offset:32768
ds_read_b128 v[116:119], v23 offset:36864
s_waitcnt lgkmcnt(4)
v_mfma_f32_32x32x16_bf16 v[48:63], v[204:207], v[100:103], v[48:63]
ds_read_b128 v[120:123], v23 offset:40960
ds_read_b128 v[124:127], v23 offset:45056
s_waitcnt lgkmcnt(5)
v_mfma_f32_32x32x16_bf16 v[64:79], v[204:207], v[104:107], v[64:79]
buffer_load_dwordx4 v246, s[52:55], s62 offen offset:2048 lds
s_waitcnt lgkmcnt(4)
v_mfma_f32_32x32x16_bf16 v[80:95], v[204:207], v[108:111], v[80:95]
buffer_load_dwordx4 v[204:207], v2, s[40:43], s63 offen offset:2048 sc1
ds_read_b128 v[8:11], v12
s_waitcnt vmcnt(42) lgkmcnt(0)
L_ck73:
v_min3_u32 v15, v8, v9, v10
v_min_u32 v15, v15, v11
s_nop 0
v_readfirstlane_b32 s60, v15
s_nop 0
s_cmp_ge_u32 s60, 9
s_cbranch_scc1 L_ckd74
ds_read_b128 v[8:11], v12 offset:0
s_waitcnt lgkmcnt(0)
s_branch L_ck73
L_ckd74:
v_mfma_f32_32x32x16_bf16 v[32:47], v[208:211], v[112:115], v[32:47]
ds_read_b128 v[96:99], v20 offset:49152
ds_read_b128 v[100:103], v20 offset:53248
v_mfma_f32_32x32x16_bf16 v[48:63], v[208:211], v[116:119], v[48:63]
ds_read_b128 v[104:107], v20 offset:57344
ds_read_b128 v[108:111], v20 offset:61440
v_mfma_f32_32x32x16_bf16 v[64:79], v[208:211], v[120:123], v[64:79]
buffer_load_dwordx4 v247, s[52:55], s62 offen offset:3072 lds
v_mfma_f32_32x32x16_bf16 v[80:95], v[208:211], v[124:127], v[80:95]
buffer_load_dwordx4 v[208:211], v2, s[40:43], s63 offen offset:3072 sc1
s_waitcnt vmcnt(42) lgkmcnt(3)
v_mfma_f32_32x32x16_bf16 v[32:47], v[212:215], v[96:99], v[32:47]
ds_read_b128 v[112:115], v21 offset:49152
ds_read_b128 v[116:119], v21 offset:53248
s_waitcnt lgkmcnt(4)
v_mfma_f32_32x32x16_bf16 v[48:63], v[212:215], v[100:103], v[48:63]
ds_read_b128 v[120:123], v21 offset:57344
ds_read_b128 v[124:127], v21 offset:61440
s_waitcnt lgkmcnt(5)
v_mfma_f32_32x32x16_bf16 v[64:79], v[212:215], v[104:107], v[64:79]
s_add_u32 m0, s67, 0
s_add_u32 s62, s64, 896
s_and_b32 s62, s62, 0x3ff
buffer_load_dwordx4 v244, s[48:51], s62 offen offset:0 lds
s_waitcnt lgkmcnt(4)
v_mfma_f32_32x32x16_bf16 v[80:95], v[212:215], v[108:111], v[80:95]
s_waitcnt vmcnt(42) lgkmcnt(3)
v_mfma_f32_32x32x16_bf16 v[32:47], v[216:219], v[112:115], v[32:47]
ds_read_b128 v[96:99], v22 offset:49152
ds_read_b128 v[100:103], v22 offset:53248
s_waitcnt lgkmcnt(4)
v_mfma_f32_32x32x16_bf16 v[48:63], v[216:219], v[116:119], v[48:63]
ds_read_b128 v[104:107], v22 offset:57344
ds_read_b128 v[108:111], v22 offset:61440
s_waitcnt lgkmcnt(5)
v_mfma_f32_32x32x16_bf16 v[64:79], v[216:219], v[120:123], v[64:79]
buffer_load_dwordx4 v245, s[48:51], s62 offen offset:1024 lds
s_waitcnt lgkmcnt(4)
v_mfma_f32_32x32x16_bf16 v[80:95], v[216:219], v[124:127], v[80:95]
s_waitcnt vmcnt(41) lgkmcnt(3)
v_mfma_f32_32x32x16_bf16 v[32:47], v[220:223], v[96:99], v[32:47]
ds_read_b128 v[112:115], v23 offset:49152
ds_read_b128 v[116:119], v23 offset:53248
s_waitcnt lgkmcnt(4)
v_mfma_f32_32x32x16_bf16 v[48:63], v[220:223], v[100:103], v[48:63]
ds_read_b128 v[120:123], v23 offset:57344
ds_read_b128 v[124:127], v23 offset:61440
s_waitcnt lgkmcnt(5)
v_mfma_f32_32x32x16_bf16 v[64:79], v[220:223], v[104:107], v[64:79]
buffer_load_dwordx4 v246, s[48:51], s62 offen offset:2048 lds
s_waitcnt lgkmcnt(4)
v_mfma_f32_32x32x16_bf16 v[80:95], v[220:223], v[108:111], v[80:95]
s_waitcnt vmcnt(41) lgkmcnt(3)
v_mfma_f32_32x32x16_bf16 v[32:47], v[224:227], v[112:115], v[32:47]
ds_read_b128 v[96:99], v24 offset:0
ds_read_b128 v[100:103], v24 offset:4096
s_waitcnt lgkmcnt(4)
v_mfma_f32_32x32x16_bf16 v[48:63], v[224:227], v[116:119], v[48:63]
ds_read_b128 v[104:107], v24 offset:8192
ds_read_b128 v[108:111], v24 offset:12288
s_waitcnt lgkmcnt(5)
v_mfma_f32_32x32x16_bf16 v[64:79], v[224:227], v[120:123], v[64:79]
buffer_load_dwordx4 v247, s[48:51], s62 offen offset:3072 lds
s_waitcnt lgkmcnt(4)
v_mfma_f32_32x32x16_bf16 v[80:95], v[224:227], v[124:127], v[80:95]
s_waitcnt vmcnt(5) lgkmcnt(3)
v_mov_b32 v14, 10
s_mov_b64 exec, 1
ds_write_b32 v13, v14
s_mov_b64 exec, -1
v_mfma_f32_32x32x16_bf16 v[32:47], v[228:231], v[96:99], v[32:47]
ds_read_b128 v[112:115], v25 offset:0
ds_read_b128 v[116:119], v25 offset:4096
s_waitcnt lgkmcnt(5)
v_mfma_f32_32x32x16_bf16 v[48:63], v[228:231], v[100:103], v[48:63]
ds_read_b128 v[120:123], v25 offset:8192
ds_read_b128 v[124:127], v25 offset:12288
s_waitcnt lgkmcnt(6)
v_mfma_f32_32x32x16_bf16 v[64:79], v[228:231], v[104:107], v[64:79]
s_add_u32 m0, s67, 16384
s_nop 0
buffer_load_dwordx4 v244, s[52:55], s62 offen offset:0 lds
s_waitcnt lgkmcnt(5)
v_mfma_f32_32x32x16_bf16 v[80:95], v[228:231], v[108:111], v[80:95]
s_waitcnt vmcnt(40) lgkmcnt(3)
v_mfma_f32_32x32x16_bf16 v[32:47], v[232:235], v[112:115], v[32:47]
ds_read_b128 v[96:99], v26 offset:0
ds_read_b128 v[100:103], v26 offset:4096
s_waitcnt lgkmcnt(4)
v_mfma_f32_32x32x16_bf16 v[48:63], v[232:235], v[116:119], v[48:63]
ds_read_b128 v[104:107], v26 offset:8192
ds_read_b128 v[108:111], v26 offset:12288
s_waitcnt lgkmcnt(5)
v_mfma_f32_32x32x16_bf16 v[64:79], v[232:235], v[120:123], v[64:79]
buffer_load_dwordx4 v245, s[52:55], s62 offen offset:1024 lds
s_waitcnt lgkmcnt(4)
v_mfma_f32_32x32x16_bf16 v[80:95], v[232:235], v[124:127], v[80:95]
s_waitcnt vmcnt(39) lgkmcnt(3)
v_mfma_f32_32x32x16_bf16 v[32:47], v[236:239], v[96:99], v[32:47]
ds_read_b128 v[112:115], v27 offset:0
ds_read_b128 v[116:119], v27 offset:4096
s_waitcnt lgkmcnt(4)
v_mfma_f32_32x32x16_bf16 v[48:63], v[236:239], v[100:103], v[48:63]
ds_read_b128 v[120:123], v27 offset:8192
ds_read_b128 v[124:127], v27 offset:12288
s_waitcnt lgkmcnt(5)
v_mfma_f32_32x32x16_bf16 v[64:79], v[236:239], v[104:107], v[64:79]
buffer_load_dwordx4 v246, s[52:55], s62 offen offset:2048 lds
s_waitcnt lgkmcnt(4)
v_mfma_f32_32x32x16_bf16 v[80:95], v[236:239], v[108:111], v[80:95]
ds_read_b128 v[8:11], v12
global_load_dword v31, v30, s[26:27]
s_waitcnt vmcnt(40) lgkmcnt(0)
L_ck75:
v_min3_u32 v15, v8, v9, v10
v_min_u32 v15, v15, v11
s_nop 0
v_readfirstlane_b32 s60, v15
s_nop 0
s_cmp_ge_u32 s60, 10
s_cbranch_scc1 L_ckd76
ds_read_b128 v[8:11], v12 offset:0
s_waitcnt lgkmcnt(0)
s_branch L_ck75
L_ckd76:
v_mfma_f32_32x32x16_bf16 v[32:47], v[240:243], v[112:115], v[32:47]
ds_read_b128 v[96:99], v24 offset:16384
ds_read_b128 v[100:103], v24 offset:20480
v_mfma_f32_32x32x16_bf16 v[48:63], v[240:243], v[116:119], v[48:63]
ds_read_b128 v[104:107], v24 offset:24576
ds_read_b128 v[108:111], v24 offset:28672
v_mfma_f32_32x32x16_bf16 v[64:79], v[240:243], v[120:123], v[64:79]
buffer_load_dwordx4 v247, s[52:55], s62 offen offset:3072 lds
v_mfma_f32_32x32x16_bf16 v[80:95], v[240:243], v[124:127], v[80:95]
s_mov_b32 s60, 0
buffer_load_dword v128, v28, s[56:59], s60 offen offset:0
s_waitcnt vmcnt(40) lgkmcnt(3)
v_mfma_f32_32x32x16_bf16 v[32:47], v[148:151], v[96:99], v[32:47]
ds_read_b128 v[112:115], v25 offset:16384
ds_read_b128 v[116:119], v25 offset:20480
s_waitcnt lgkmcnt(4)
v_mfma_f32_32x32x16_bf16 v[48:63], v[148:151], v[100:103], v[48:63]
ds_read_b128 v[120:123], v25 offset:24576
ds_read_b128 v[124:127], v25 offset:28672
s_waitcnt lgkmcnt(5)
v_mfma_f32_32x32x16_bf16 v[64:79], v[148:151], v[104:107], v[64:79]
s_waitcnt lgkmcnt(4)
v_mfma_f32_32x32x16_bf16 v[80:95], v[148:151], v[108:111], v[80:95]
s_mov_b32 s60, 0
buffer_load_dword v129, v28, s[56:59], s60 offen offset:2048
s_waitcnt vmcnt(39) lgkmcnt(3)
v_mfma_f32_32x32x16_bf16 v[32:47], v[152:155], v[112:115], v[32:47]
ds_read_b128 v[96:99], v26 offset:16384
ds_read_b128 v[100:103], v26 offset:20480
s_waitcnt lgkmcnt(4)
v_mfma_f32_32x32x16_bf16 v[48:63], v[152:155], v[116:119], v[48:63]
ds_read_b128 v[104:107], v26 offset:24576
ds_read_b128 v[108:111], v26 offset:28672
s_waitcnt lgkmcnt(5)
v_mfma_f32_32x32x16_bf16 v[64:79], v[152:155], v[120:123], v[64:79]
s_waitcnt lgkmcnt(4)
v_mfma_f32_32x32x16_bf16 v[80:95], v[152:155], v[124:127], v[80:95]
s_mov_b32 s60, 4096
buffer_load_dword v130, v28, s[56:59], s60 offen offset:0
s_waitcnt vmcnt(38) lgkmcnt(3)
v_mfma_f32_32x32x16_bf16 v[32:47], v[156:159], v[96:99], v[32:47]
ds_read_b128 v[112:115], v27 offset:16384
ds_read_b128 v[116:119], v27 offset:20480
s_waitcnt lgkmcnt(4)
v_mfma_f32_32x32x16_bf16 v[48:63], v[156:159], v[100:103], v[48:63]
ds_read_b128 v[120:123], v27 offset:24576
ds_read_b128 v[124:127], v27 offset:28672
s_waitcnt lgkmcnt(5)
v_mfma_f32_32x32x16_bf16 v[64:79], v[156:159], v[104:107], v[64:79]
s_waitcnt lgkmcnt(4)
v_mfma_f32_32x32x16_bf16 v[80:95], v[156:159], v[108:111], v[80:95]
s_mov_b32 s60, 4096
buffer_load_dword v131, v28, s[56:59], s60 offen offset:2048
s_waitcnt vmcnt(37) lgkmcnt(3)
v_mfma_f32_32x32x16_bf16 v[32:47], v[160:163], v[112:115], v[32:47]
ds_read_b128 v[96:99], v24 offset:32768
ds_read_b128 v[100:103], v24 offset:36864
s_waitcnt lgkmcnt(4)
v_mfma_f32_32x32x16_bf16 v[48:63], v[160:163], v[116:119], v[48:63]
s_waitcnt lgkmcnt(3)
v_mfma_f32_32x32x16_bf16 v[64:79], v[160:163], v[120:123], v[64:79]
s_waitcnt lgkmcnt(2)
v_mfma_f32_32x32x16_bf16 v[80:95], v[160:163], v[124:127], v[80:95]
s_mov_b32 s60, 65536
buffer_load_dword v132, v28, s[56:59], s60 offen offset:0
s_waitcnt vmcnt(5) lgkmcnt(1)
v_mov_b32 v14, 11
s_mov_b64 exec, 1
ds_write_b32 v13, v14
s_mov_b64 exec, -1
v_mfma_f32_32x32x16_bf16 v[32:47], v[164:167], v[96:99], v[32:47]
ds_read_b128 v[112:115], v25 offset:32768
ds_read_b128 v[116:119], v25 offset:36864
s_waitcnt lgkmcnt(3)
v_mfma_f32_32x32x16_bf16 v[48:63], v[164:167], v[100:103], v[48:63]
s_mov_b32 s60, 65536
buffer_load_dword v133, v28, s[56:59], s60 offen offset:2048
s_waitcnt vmcnt(35) lgkmcnt(1)
v_mfma_f32_32x32x16_bf16 v[32:47], v[168:171], v[112:115], v[32:47]
ds_read_b128 v[96:99], v26 offset:32768
ds_read_b128 v[100:103], v26 offset:36864
s_waitcnt lgkmcnt(2)
v_mfma_f32_32x32x16_bf16 v[48:63], v[168:171], v[116:119], v[48:63]
s_mov_b32 s60, 69632
buffer_load_dword v134, v28, s[56:59], s60 offen offset:0
s_waitcnt vmcnt(34) lgkmcnt(1)
v_mfma_f32_32x32x16_bf16 v[32:47], v[172:175], v[96:99], v[32:47]
ds_read_b128 v[112:115], v27 offset:32768
ds_read_b128 v[116:119], v27 offset:36864
s_waitcnt lgkmcnt(2)
v_mfma_f32_32x32x16_bf16 v[48:63], v[172:175], v[100:103], v[48:63]
ds_read_b128 v[8:11], v12
s_mov_b32 s60, 69632
buffer_load_dword v135, v28, s[56:59], s60 offen offset:2048
s_waitcnt vmcnt(33) lgkmcnt(0)
L_ck77:
v_min3_u32 v15, v8, v9, v10
v_min_u32 v15, v15, v11
s_nop 0
v_readfirstlane_b32 s60, v15
s_nop 0
s_cmp_ge_u32 s60, 11
s_cbranch_scc1 L_ckd78
ds_read_b128 v[8:11], v12 offset:0
s_waitcnt lgkmcnt(0)
s_branch L_ck77
L_ckd78:
v_mfma_f32_32x32x16_bf16 v[32:47], v[176:179], v[112:115], v[32:47]
ds_read_b128 v[96:99], v20 offset:0
ds_read_b128 v[100:103], v20 offset:4096
v_mfma_f32_32x32x16_bf16 v[48:63], v[176:179], v[116:119], v[48:63]
s_mov_b32 s60, 8192
buffer_load_dword v136, v28, s[56:59], s60 offen offset:0
s_waitcnt vmcnt(32) lgkmcnt(1)
v_mfma_f32_32x32x16_bf16 v[32:47], v[180:183], v[96:99], v[32:47]
ds_read_b128 v[112:115], v21 offset:0
ds_read_b128 v[116:119], v21 offset:4096
s_waitcnt lgkmcnt(2)
v_mfma_f32_32x32x16_bf16 v[48:63], v[180:183], v[100:103], v[48:63]
s_mov_b32 s60, 8192
buffer_load_dword v137, v28, s[56:59], s60 offen offset:2048
s_waitcnt vmcnt(31) lgkmcnt(1)
v_mfma_f32_32x32x16_bf16 v[32:47], v[184:187], v[112:115], v[32:47]
ds_read_b128 v[96:99], v22 offset:0
ds_read_b128 v[100:103], v22 offset:4096
s_waitcnt lgkmcnt(2)
v_mfma_f32_32x32x16_bf16 v[48:63], v[184:187], v[116:119], v[48:63]
s_mov_b32 s60, 12288
buffer_load_dword v138, v28, s[56:59], s60 offen offset:0
s_waitcnt vmcnt(30) lgkmcnt(1)
v_mfma_f32_32x32x16_bf16 v[32:47], v[188:191], v[96:99], v[32:47]
ds_read_b128 v[112:115], v23 offset:0
ds_read_b128 v[116:119], v23 offset:4096
s_waitcnt lgkmcnt(2)
v_mfma_f32_32x32x16_bf16 v[48:63], v[188:191], v[100:103], v[48:63]
s_mov_b32 s60, 12288
buffer_load_dword v139, v28, s[56:59], s60 offen offset:2048
s_waitcnt vmcnt(29) lgkmcnt(1)
v_mfma_f32_32x32x16_bf16 v[32:47], v[192:195], v[112:115], v[32:47]
ds_read_b128 v[96:99], v20 offset:16384
ds_read_b128 v[100:103], v20 offset:20480
s_waitcnt lgkmcnt(2)
v_mfma_f32_32x32x16_bf16 v[48:63], v[192:195], v[116:119], v[48:63]
s_mov_b32 s60, 73728
buffer_load_dword v140, v28, s[56:59], s60 offen offset:0
s_waitcnt vmcnt(28) lgkmcnt(1)
v_mfma_f32_32x32x16_bf16 v[32:47], v[196:199], v[96:99], v[32:47]
ds_read_b128 v[112:115], v21 offset:16384
ds_read_b128 v[116:119], v21 offset:20480
s_waitcnt lgkmcnt(2)
v_mfma_f32_32x32x16_bf16 v[48:63], v[196:199], v[100:103], v[48:63]
s_mov_b32 s60, 73728
buffer_load_dword v141, v28, s[56:59], s60 offen offset:2048
s_waitcnt vmcnt(27) lgkmcnt(1)
v_mfma_f32_32x32x16_bf16 v[32:47], v[200:203], v[112:115], v[32:47]
ds_read_b128 v[96:99], v22 offset:16384
ds_read_b128 v[100:103], v22 offset:20480
s_waitcnt lgkmcnt(2)
v_mfma_f32_32x32x16_bf16 v[48:63], v[200:203], v[116:119], v[48:63]
s_mov_b32 s60, 77824
buffer_load_dword v142, v28, s[56:59], s60 offen offset:0
s_waitcnt vmcnt(26) lgkmcnt(1)
v_mfma_f32_32x32x16_bf16 v[32:47], v[204:207], v[96:99], v[32:47]
ds_read_b128 v[112:115], v23 offset:16384
ds_read_b128 v[116:119], v23 offset:20480
s_waitcnt lgkmcnt(2)
v_mfma_f32_32x32x16_bf16 v[48:63], v[204:207], v[100:103], v[48:63]
s_mov_b32 s60, 77824
buffer_load_dword v143, v28, s[56:59], s60 offen offset:2048
s_waitcnt vmcnt(25) lgkmcnt(0)
v_mfma_f32_32x32x16_bf16 v[32:47], v[208:211], v[112:115], v[32:47]
v_mfma_f32_32x32x16_bf16 v[48:63], v[208:211], v[116:119], v[48:63]
s_mul_i32 s60, s37, 0x9e3779b1
s_and_b32 s60, s60, 0xbfff0000
s_or_b32 s60, s60, 0x20000000
s_sub_u32 s61, s37, 1
s_xor_b32 s61, s61, s60
s_cmp_lt_u32 s61, 0x10000
s_cselect_b32 s61, 0x10000, 0
s_xor_b32 s60, s60, s61
s_lshl_b32 s64, s35, 4
s_add_u32 s64, s64, s36
s_lshl_b32 s64, s64, 2
s_add_u32 s64, s64, s34
s_lshl_b32 s64, s64, 13
s_add_u32 s50, s64, 33554432
s_add_u32 s48, s32, s50
s_addc_u32 s49, s33, 0
s_mov_b32 s50, 8192
s_mov_b32 s51, 0x20000
s_xor_b32 s64, s64, 262144
s_add_u32 s54, s64, 33554432
s_add_u32 s52, s32, s54
s_addc_u32 s53, s33, 0
s_mov_b32 s54, 8192
s_mov_b32 s55, 0x20000
s_movk_i32 s64, 0x1000
v_cvt_pk_bf16_f32 v96, v32, v48
v_cvt_pk_bf16_f32 v97, v33, v49
v_cvt_pk_bf16_f32 v98, v34, v50
v_cvt_pk_bf16_f32 v99, v35, s60
buffer_store_dwordx4 v[96:99], v2, s[48:51], 0 offen offset:0 sc1
v_cvt_pk_bf16_f32 v100, v51, v36
v_cvt_pk_bf16_f32 v101, v52, v37
v_cvt_pk_bf16_f32 v102, v53, v38
v_cvt_pk_bf16_f32 v103, v54, s60
buffer_store_dwordx4 v[100:103], v2, s[48:51], 0 offen offset:1024 sc1
v_cvt_pk_bf16_f32 v244, v39, v55
v_cvt_pk_bf16_f32 v245, v40, v56
v_cvt_pk_bf16_f32 v246, v41, v57
v_cvt_pk_bf16_f32 v247, v42, s60
buffer_store_dwordx4 v[244:247], v2, s[48:51], 0 offen offset:2048 sc1
v_cvt_pk_bf16_f32 v248, v58, v43
v_cvt_pk_bf16_f32 v249, v59, v44
v_cvt_pk_bf16_f32 v250, v60, v45
v_cvt_pk_bf16_f32 v251, v61, s60
buffer_store_dwordx4 v[248:251], v2, s[48:51], 0 offen offset:3072 sc1
v_cvt_pk_bf16_f32 v252, v46, v62
v_cvt_pk_bf16_f32 v253, v47, v63
v_cvt_pk_bf16_f32 v254, v63, v63
v_cvt_pk_bf16_f32 v255, v63, s60
buffer_store_dwordx4 v[252:255], v2, s[48:51], s64 offen offset:0 sc1
ds_read_b128 v[104:107], v24 offset:40960
ds_read_b128 v[108:111], v24 offset:45056
ds_read_b128 v[120:123], v25 offset:40960
ds_read_b128 v[124:127], v25 offset:45056
s_waitcnt lgkmcnt(2)
v_mfma_f32_32x32x16_bf16 v[64:79], v[164:167], v[104:107], v[64:79]
v_mfma_f32_32x32x16_bf16 v[80:95], v[164:167], v[108:111], v[80:95]
ds_read_b128 v[104:107], v26 offset:40960
ds_read_b128 v[108:111], v26 offset:45056
s_waitcnt lgkmcnt(2)
v_mfma_f32_32x32x16_bf16 v[64:79], v[168:171], v[120:123], v[64:79]
v_mfma_f32_32x32x16_bf16 v[80:95], v[168:171], v[124:127], v[80:95]
ds_read_b128 v[120:123], v27 offset:40960
ds_read_b128 v[124:127], v27 offset:45056
s_waitcnt lgkmcnt(2)
v_mfma_f32_32x32x16_bf16 v[64:79], v[172:175], v[104:107], v[64:79]
v_mfma_f32_32x32x16_bf16 v[80:95], v[172:175], v[108:111], v[80:95]
ds_read_b128 v[104:107], v20 offset:8192
ds_read_b128 v[108:111], v20 offset:12288
s_waitcnt lgkmcnt(2)
v_mfma_f32_32x32x16_bf16 v[64:79], v[176:179], v[120:123], v[64:79]
v_mfma_f32_32x32x16_bf16 v[80:95], v[176:179], v[124:127], v[80:95]
ds_read_b128 v[120:123], v21 offset:8192
ds_read_b128 v[124:127], v21 offset:12288
s_waitcnt lgkmcnt(2)
v_mfma_f32_32x32x16_bf16 v[64:79], v[180:183], v[104:107], v[64:79]
v_mfma_f32_32x32x16_bf16 v[80:95], v[180:183], v[108:111], v[80:95]
ds_read_b128 v[104:107], v22 offset:8192
ds_read_b128 v[108:111], v22 offset:12288
s_waitcnt lgkmcnt(2)
v_mfma_f32_32x32x16_bf16 v[64:79], v[184:187], v[120:123], v[64:79]
v_mfma_f32_32x32x16_bf16 v[80:95], v[184:187], v[124:127], v[80:95]
ds_read_b128 v[120:123], v23 offset:8192
ds_read_b128 v[124:127], v23 offset:12288
s_waitcnt lgkmcnt(2)
v_mfma_f32_32x32x16_bf16 v[64:79], v[188:191], v[104:107], v[64:79]
v_mfma_f32_32x32x16_bf16 v[80:95], v[188:191], v[108:111], v[80:95]
ds_read_b128 v[104:107], v20 offset:24576
ds_read_b128 v[108:111], v20 offset:28672
s_waitcnt lgkmcnt(2)
v_mfma_f32_32x32x16_bf16 v[64:79], v[192:195], v[120:123], v[64:79]
v_mfma_f32_32x32x16_bf16 v[80:95], v[192:195], v[124:127], v[80:95]
ds_read_b128 v[120:123], v21 offset:24576
ds_read_b128 v[124:127], v21 offset:28672
s_waitcnt lgkmcnt(2)
v_mfma_f32_32x32x16_bf16 v[64:79], v[196:199], v[104:107], v[64:79]
v_mfma_f32_32x32x16_bf16 v[80:95], v[196:199], v[108:111], v[80:95]
ds_read_b128 v[104:107], v22 offset:24576
ds_read_b128 v[108:111], v22 offset:28672
s_waitcnt lgkmcnt(2)
v_mfma_f32_32x32x16_bf16 v[64:79], v[200:203], v[120:123], v[64:79]
v_mfma_f32_32x32x16_bf16 v[80:95], v[200:203], v[124:127], v[80:95]
ds_read_b128 v[120:123], v23 offset:24576
ds_read_b128 v[124:127], v23 offset:28672
s_waitcnt lgkmcnt(2)
v_mfma_f32_32x32x16_bf16 v[64:79], v[204:207], v[104:107], v[64:79]
v_mfma_f32_32x32x16_bf16 v[80:95], v[204:207], v[108:111], v[80:95]
s_waitcnt lgkmcnt(0)
v_mfma_f32_32x32x16_bf16 v[64:79], v[208:211], v[120:123], v[64:79]
v_mfma_f32_32x32x16_bf16 v[80:95], v[208:211], v[124:127], v[80:95]
s_waitcnt vmcnt(5)
v_lshlrev_b32 v8, 16, v31
v_and_b32 v9, 0xffff0000, v31
v_lshlrev_b32 v148, 16, v128
v_and_b32 v149, 0xffff0000, v128
v_pk_mul_f32 v[148:149], v[148:149], v[8:9]
v_cvt_pk_bf16_f32 v10, v148, v149
v_lshlrev_b32 v148, 16, v10
v_and_b32 v149, 0xffff0000, v10
s_nop 1
v_add_f32 v148, v148, v64
v_add_f32 v149, v149, v80
v_lshlrev_b32 v150, 16, v129
v_and_b32 v151, 0xffff0000, v129
v_pk_mul_f32 v[150:151], v[150:151], v[8:9]
v_cvt_pk_bf16_f32 v10, v150, v151
v_lshlrev_b32 v150, 16, v10
v_and_b32 v151, 0xffff0000, v10
v_add_f32 v150, v150, v65
v_add_f32 v151, v151, v81
v_lshlrev_b32 v152, 16, v130
v_and_b32 v153, 0xffff0000, v130
v_pk_mul_f32 v[152:153], v[152:153], v[8:9]
v_cvt_pk_bf16_f32 v10, v152, v153
v_lshlrev_b32 v152, 16, v10
v_and_b32 v153, 0xffff0000, v10
v_add_f32 v152, v152, v66
v_add_f32 v153, v153, v82
v_lshlrev_b32 v154, 16, v131
v_and_b32 v155, 0xffff0000, v131
v_pk_mul_f32 v[154:155], v[154:155], v[8:9]
v_cvt_pk_bf16_f32 v10, v154, v155
v_lshlrev_b32 v154, 16, v10
v_and_b32 v155, 0xffff0000, v10
v_add_f32 v154, v154, v67
v_add_f32 v155, v155, v83
v_lshlrev_b32 v156, 16, v132
v_and_b32 v157, 0xffff0000, v132
v_pk_mul_f32 v[156:157], v[156:157], v[8:9]
v_cvt_pk_bf16_f32 v10, v156, v157
v_lshlrev_b32 v156, 16, v10
v_and_b32 v157, 0xffff0000, v10
v_add_f32 v156, v156, v68
v_add_f32 v157, v157, v84
v_lshlrev_b32 v158, 16, v133
v_and_b32 v159, 0xffff0000, v133
v_pk_mul_f32 v[158:159], v[158:159], v[8:9]
v_cvt_pk_bf16_f32 v10, v158, v159
v_lshlrev_b32 v158, 16, v10
v_and_b32 v159, 0xffff0000, v10
v_add_f32 v158, v158, v69
v_add_f32 v159, v159, v85
v_lshlrev_b32 v160, 16, v134
v_and_b32 v161, 0xffff0000, v134
v_pk_mul_f32 v[160:161], v[160:161], v[8:9]
v_cvt_pk_bf16_f32 v10, v160, v161
v_lshlrev_b32 v160, 16, v10
v_and_b32 v161, 0xffff0000, v10
v_add_f32 v160, v160, v70
v_add_f32 v161, v161, v86
v_lshlrev_b32 v162, 16, v135
v_and_b32 v163, 0xffff0000, v135
v_pk_mul_f32 v[162:163], v[162:163], v[8:9]
v_cvt_pk_bf16_f32 v10, v162, v163
v_lshlrev_b32 v162, 16, v10
v_and_b32 v163, 0xffff0000, v10
v_add_f32 v162, v162, v71
v_add_f32 v163, v163, v87
v_lshlrev_b32 v164, 16, v136
v_and_b32 v165, 0xffff0000, v136
v_pk_mul_f32 v[164:165], v[164:165], v[8:9]
v_cvt_pk_bf16_f32 v10, v164, v165
v_lshlrev_b32 v164, 16, v10
v_and_b32 v165, 0xffff0000, v10
v_add_f32 v164, v164, v72
v_add_f32 v165, v165, v88
v_lshlrev_b32 v166, 16, v137
v_and_b32 v167, 0xffff0000, v137
v_pk_mul_f32 v[166:167], v[166:167], v[8:9]
v_cvt_pk_bf16_f32 v10, v166, v167
v_lshlrev_b32 v166, 16, v10
v_and_b32 v167, 0xffff0000, v10
v_add_f32 v166, v166, v73
v_add_f32 v167, v167, v89
v_lshlrev_b32 v168, 16, v138
v_and_b32 v169, 0xffff0000, v138
v_pk_mul_f32 v[168:169], v[168:169], v[8:9]
v_cvt_pk_bf16_f32 v10, v168, v169
v_lshlrev_b32 v168, 16, v10
v_and_b32 v169, 0xffff0000, v10
v_add_f32 v168, v168, v74
v_add_f32 v169, v169, v90
v_lshlrev_b32 v170, 16, v139
v_and_b32 v171, 0xffff0000, v139
v_pk_mul_f32 v[170:171], v[170:171], v[8:9]
v_cvt_pk_bf16_f32 v10, v170, v171
v_lshlrev_b32 v170, 16, v10
v_and_b32 v171, 0xffff0000, v10
v_add_f32 v170, v170, v75
v_add_f32 v171, v171, v91
v_lshlrev_b32 v172, 16, v140
v_and_b32 v173, 0xffff0000, v140
v_pk_mul_f32 v[172:173], v[172:173], v[8:9]
v_cvt_pk_bf16_f32 v10, v172, v173
v_lshlrev_b32 v172, 16, v10
v_and_b32 v173, 0xffff0000, v10
v_add_f32 v172, v172, v76
v_add_f32 v173, v173, v92
v_lshlrev_b32 v174, 16, v141
v_and_b32 v175, 0xffff0000, v141
v_pk_mul_f32 v[174:175], v[174:175], v[8:9]
v_cvt_pk_bf16_f32 v10, v174, v175
v_lshlrev_b32 v174, 16, v10
v_and_b32 v175, 0xffff0000, v10
v_add_f32 v174, v174, v77
v_add_f32 v175, v175, v93
v_lshlrev_b32 v176, 16, v142
v_and_b32 v177, 0xffff0000, v142
v_pk_mul_f32 v[176:177], v[176:177], v[8:9]
v_cvt_pk_bf16_f32 v10, v176, v177
v_lshlrev_b32 v176, 16, v10
v_and_b32 v177, 0xffff0000, v10
v_add_f32 v176, v176, v78
v_add_f32 v177, v177, v94
v_lshlrev_b32 v178, 16, v143
v_and_b32 v179, 0xffff0000, v143
v_pk_mul_f32 v[178:179], v[178:179], v[8:9]
v_cvt_pk_bf16_f32 v10, v178, v179
v_lshlrev_b32 v178, 16, v10
v_and_b32 v179, 0xffff0000, v10
v_add_f32 v178, v178, v79
v_add_f32 v179, v179, v95
s_mov_b32 s44, s28
s_mov_b32 s45, s29
s_mov_b32 s46, s24
s_mov_b32 s47, 0x20000
s_mov_b32 s92, 0
L_xw81:
s_load_dword s61, s[52:53], 5116 glc
s_add_u32 s92, s92, 1
s_waitcnt lgkmcnt(0)
s_xor_b32 s61, s61, s60
s_cmp_lt_u32 s61, 0x10000
s_cbranch_scc1 L_xwd82
s_cmp_lt_u32 s92, 200000
s_cbranch_scc1 L_xw81
L_xwd82:
s_mov_b32 s92, 0
buffer_load_dwordx4 v[180:183], v2, s[52:55], 0 offen offset:0 sc1
buffer_load_dwordx4 v[184:187], v2, s[52:55], 0 offen offset:1024 sc1
buffer_load_dwordx4 v[188:191], v2, s[52:55], 0 offen offset:2048 sc1
buffer_load_dwordx4 v[192:195], v2, s[52:55], 0 offen offset:3072 sc1
buffer_load_dwordx4 v[196:199], v2, s[52:55], s64 offen offset:0 sc1
L_xl79:
v_mov_b32 v10, 0
s_waitcnt vmcnt(4)
v_bitop3_b32 v10, v10, v183, s60 bitop3:0xf6
s_waitcnt vmcnt(3)
v_bitop3_b32 v10, v10, v187, s60 bitop3:0xf6
s_waitcnt vmcnt(2)
v_bitop3_b32 v10, v10, v191, s60 bitop3:0xf6
s_waitcnt vmcnt(1)
v_bitop3_b32 v10, v10, v195, s60 bitop3:0xf6
s_waitcnt vmcnt(0)
v_bitop3_b32 v10, v10, v199, s60 bitop3:0xf6
v_cmp_lt_u32 vcc, 0xffff, v10
s_nop 0
s_cbranch_vccz L_xd80
s_add_u32 s92, s92, 1
s_cmp_ge_u32 s92, 200000
s_cbranch_scc1 L_xd80
buffer_load_dwordx4 v[180:183], v2, s[52:55], 0 offen offset:0 sc1
buffer_load_dwordx4 v[184:187], v2, s[52:55], 0 offen offset:1024 sc1
buffer_load_dwordx4 v[188:191], v2, s[52:55], 0 offen offset:2048 sc1
buffer_load_dwordx4 v[192:195], v2, s[52:55], 0 offen offset:3072 sc1
buffer_load_dwordx4 v[196:199], v2, s[52:55], s64 offen offset:0 sc1
s_branch L_xl79
L_xd80:
v_lshlrev_b32 v10, 16, v180
v_and_b32 v11, 0xffff0000, v180
v_pk_add_f32 v[148:149], v[148:149], v[10:11]
s_mov_b32 s64, 0
buffer_store_dwordx2 v[148:149], v29, s[44:47], s64 offen nt
v_lshlrev_b32 v10, 16, v181
v_and_b32 v11, 0xffff0000, v181
v_pk_add_f32 v[150:151], v[150:151], v[10:11]
s_mov_b32 s64, 8192
buffer_store_dwordx2 v[150:151], v29, s[44:47], s64 offen nt
v_lshlrev_b32 v10, 16, v182
v_and_b32 v11, 0xffff0000, v182
v_pk_add_f32 v[152:153], v[152:153], v[10:11]
s_mov_b32 s64, 16384
buffer_store_dwordx2 v[152:153], v29, s[44:47], s64 offen nt
v_lshlrev_b32 v10, 16, v183
v_lshlrev_b32 v11, 16, v184
v_pk_add_f32 v[154:155], v[154:155], v[10:11]
s_mov_b32 s64, 24576
buffer_store_dwordx2 v[154:155], v29, s[44:47], s64 offen nt
v_and_b32 v10, 0xffff0000, v184
v_lshlrev_b32 v11, 16, v185
v_pk_add_f32 v[156:157], v[156:157], v[10:11]
s_mov_b32 s64, 262144
buffer_store_dwordx2 v[156:157], v29, s[44:47], s64 offen nt
v_and_b32 v10, 0xffff0000, v185
v_lshlrev_b32 v11, 16, v186
v_pk_add_f32 v[158:159], v[158:159], v[10:11]
s_mov_b32 s64, 270336
buffer_store_dwordx2 v[158:159], v29, s[44:47], s64 offen nt
v_and_b32 v10, 0xffff0000, v186
v_lshlrev_b32 v11, 16, v187
v_pk_add_f32 v[160:161], v[160:161], v[10:11]
s_mov_b32 s64, 278528
buffer_store_dwordx2 v[160:161], v29, s[44:47], s64 offen nt
v_lshlrev_b32 v10, 16, v188
v_and_b32 v11, 0xffff0000, v188
v_pk_add_f32 v[162:163], v[162:163], v[10:11]
s_mov_b32 s64, 286720
buffer_store_dwordx2 v[162:163], v29, s[44:47], s64 offen nt
v_lshlrev_b32 v10, 16, v189
v_and_b32 v11, 0xffff0000, v189
v_pk_add_f32 v[164:165], v[164:165], v[10:11]
s_mov_b32 s64, 32768
buffer_store_dwordx2 v[164:165], v29, s[44:47], s64 offen nt
v_lshlrev_b32 v10, 16, v190
v_and_b32 v11, 0xffff0000, v190
v_pk_add_f32 v[166:167], v[166:167], v[10:11]
s_mov_b32 s64, 40960
buffer_store_dwordx2 v[166:167], v29, s[44:47], s64 offen nt
v_lshlrev_b32 v10, 16, v191
v_lshlrev_b32 v11, 16, v192
v_pk_add_f32 v[168:169], v[168:169], v[10:11]
s_mov_b32 s64, 49152
buffer_store_dwordx2 v[168:169], v29, s[44:47], s64 offen nt
v_and_b32 v10, 0xffff0000, v192
v_lshlrev_b32 v11, 16, v193
v_pk_add_f32 v[170:171], v[170:171], v[10:11]
s_mov_b32 s64, 57344
buffer_store_dwordx2 v[170:171], v29, s[44:47], s64 offen nt
v_and_b32 v10, 0xffff0000, v193
v_lshlrev_b32 v11, 16, v194
v_pk_add_f32 v[172:173], v[172:173], v[10:11]
s_mov_b32 s64, 294912
buffer_store_dwordx2 v[172:173], v29, s[44:47], s64 offen nt
v_and_b32 v10, 0xffff0000, v194
v_lshlrev_b32 v11, 16, v195
v_pk_add_f32 v[174:175], v[174:175], v[10:11]
s_mov_b32 s64, 303104
buffer_store_dwordx2 v[174:175], v29, s[44:47], s64 offen nt
v_lshlrev_b32 v10, 16, v196
v_and_b32 v11, 0xffff0000, v196
v_pk_add_f32 v[176:177], v[176:177], v[10:11]
s_mov_b32 s64, 311296
buffer_store_dwordx2 v[176:177], v29, s[44:47], s64 offen nt
v_lshlrev_b32 v10, 16, v197
v_and_b32 v11, 0xffff0000, v197
v_pk_add_f32 v[178:179], v[178:179], v[10:11]
s_mov_b32 s64, 319488
buffer_store_dwordx2 v[178:179], v29, s[44:47], s64 offen nt
L_concat_heads__spectral_gfnet__ssm_conv_s5__prompt_kernel_end:
s_endpgm

.section .rodata,"a"
.p2align 6
.amdhsa_kernel concat_heads__spectral_gfnet__ssm_conv_s5__prompt_kernel
  .amdhsa_next_free_vgpr 256
  .amdhsa_next_free_sgpr 102
  .amdhsa_accum_offset 256
  .amdhsa_group_segment_fixed_size 0
  .amdhsa_kernarg_size 120
  .amdhsa_user_sgpr_count 2
  .amdhsa_user_sgpr_kernarg_segment_ptr 1
  .amdhsa_system_sgpr_workgroup_id_x 1
.end_amdhsa_kernel
.text
```

```asm
; @launch grid=(256,1,1) block=(512,1,1) lds=163840
.amdgcn_target "amdgcn-amd-amdhsa--gfx950"
.text
.globl concat_heads__spectral_gfnet__ssm_conv_s5__prompt_kernel
.p2align 8
.type concat_heads__spectral_gfnet__ssm_conv_s5__prompt_kernel,@function
concat_heads__spectral_gfnet__ssm_conv_s5__prompt_kernel:
s_cmp_ge_u32 s2, 256
s_cbranch_scc1 L_concat_heads__spectral_gfnet__ssm_conv_s5__prompt_kernel_end
s_load_dwordx16 s[4:19], s[0:1], 0
s_load_dwordx8 s[20:27], s[0:1], 64
s_load_dwordx4 s[28:31], s[0:1], 96
s_load_dwordx2 s[32:33], s[0:1], 112
v_lshrrev_b32 v2, 6, v0
v_and_b32 v1, 63, v0
v_readfirstlane_b32 s34, v2
s_and_b32 s60, s2, 7
s_lshr_b32 s61, s2, 3
s_lshr_b32 s35, s60, 1
s_lshl_b32 s35, s35, 2
s_lshr_b32 s62, s61, 3
s_add_u32 s35, s35, s62
s_and_b32 s36, s60, 1
s_lshl_b32 s36, s36, 3
s_and_b32 s62, s61, 7
s_add_u32 s36, s36, s62
s_xor_b32 s34, s34, 4
s_cmp_ge_u32 s34, 4
s_cbranch_scc0 L_concat_heads__spectral_gfnet__ssm_conv_s5__prompt_kernel_gemm
s_sub_u32 s66, s34, 4
s_setprio 0
s_waitcnt lgkmcnt(0)
s_mov_b32 s100, s20
s_mov_b32 s101, s21
s_bitcmp1_b32 s66, 0
s_cselect_b32 s100, s22, s20
s_cselect_b32 s101, s23, s21
s_cmp_lg_u32 s66, 1
s_cbranch_scc1 L_pf1
s_lshr_b32 s60, s2, 3
s_lshl_b32 s60, s60, 11
v_and_b32 v12, 15, v1
v_lshl_add_u32 v12, v12, 7, s60
v_min_u32 v12, L_concat_heads__spectral_gfnet__ssm_conv_s5__prompt_kernel_end-concat_heads__spectral_gfnet__ssm_conv_s5__prompt_kernel, v12
s_getpc_b64 s[60:61]
L_pc2:
s_sub_u32 s60, s60, L_pc2-concat_heads__spectral_gfnet__ssm_conv_s5__prompt_kernel
s_subb_u32 s61, s61, 0
global_load_dword v23, v12, s[60:61]
L_pf1:
s_lshl_b32 s60, s2, 3
s_add_u32 s60, s60, s34
s_cmp_lg_u32 s60, 4
s_cbranch_scc1 L_nn3
s_load_dword s3, s[32:33], 0
L_nn3:
s_mov_b32 s48, s6
s_mov_b32 s49, s7
s_mov_b32 s50, 2101248
s_mov_b32 s51, 0x20000
s_mov_b32 s52, s8
s_mov_b32 s53, s9
s_mov_b32 s54, 2101248
s_mov_b32 s55, 0x20000
s_and_b32 s60, s2, 31
s_lshr_b32 s61, s2, 5
s_lshl_b32 s61, s61, 7
s_add_u32 s60, s60, s61
s_lshl_b32 s61, s66, 5
s_add_u32 s67, s60, s61
s_lshl_b32 s60, s67, 12
s_add_u32 s4, s4, s60
s_addc_u32 s5, s5, 0
s_mov_b32 s6, 4096
s_mov_b32 s7, 0x20000
v_lshlrev_b32 v2, 4, v1
v_xor_b32 v3, 128, v2
s_lshl_b32 s68, s66, 12
s_add_u32 s68, s68, 131072
s_add_u32 m0, s68, 0
s_mov_b32 s92, 0
buffer_load_dwordx4 v2, s[4:7], s92 offen offset:0 nt lds
buffer_load_dwordx4 v2, s[4:7], s92 offen offset:1024 nt lds
s_add_u32 m0, s68, 2048
s_mov_b32 s92, 2048
buffer_load_dwordx4 v3, s[4:7], s92 offen offset:0 nt lds
buffer_load_dwordx4 v3, s[4:7], s92 offen offset:1024 nt lds
s_and_b32 s60, s2, 7
s_bfe_u32 s61, s2, 0x10003
s_bfe_u32 s62, s2, 0x20004
s_lshr_b32 s63, s2, 6
s_lshr_b32 s64, s60, 1
s_lshl_b32 s64, s64, 3
s_lshl_b32 s65, s61, 2
s_add_u32 s64, s64, s65
s_and_b32 s65, s60, 1
s_lshl_b32 s65, s65, 1
s_add_u32 s64, s64, s65
s_lshl_b32 s64, s64, 5
s_lshl_b32 s65, s62, 3
s_add_u32 s64, s64, s65
s_lshl_b32 s65, s66, 1
s_add_u32 s64, s64, s65
s_mul_i32 s64, s64, 1026
s_lshl_b32 s65, s63, 8
s_add_u32 s69, s64, s65
v_bfe_u32 v8, v1, 4, 1
v_mul_u32_u24 v8, 32832, v8
v_lshrrev_b32 v9, 5, v1
s_mov_b32 s65, 1050624
v_mul_lo_u32 v9, s65, v9
v_add_u32 v8, v8, v9
v_and_b32 v9, 15, v1
s_lshl_b32 s65, s66, 1
v_xor_b32 v9, s65, v9
v_lshl_add_u32 v18, v9, 4, v8
v_xor_b32 v9, 1, v9
v_lshl_add_u32 v19, v9, 4, v8
v_add_u32 v19, 1026, v19
s_bfe_u32 s64, s2, 0x20005
s_lshl_b32 s64, s64, 8
s_bfe_u32 s65, s2, 0x10004
s_lshl_b32 s65, s65, 6
s_add_u32 s64, s64, s65
s_bfe_u32 s65, s2, 0x10003
s_lshl_b32 s65, s65, 7
s_add_u32 s64, s64, s65
s_and_b32 s65, s2, 7
s_lshl_b32 s65, s65, 2
s_add_u32 s64, s64, s65
v_bfe_u32 v8, v1, 3, 2
v_add_u32 v8, s64, v8
v_bfe_u32 v9, v1, 2, 1
v_lshl_add_u32 v8, v9, 5, v8
v_bfe_u32 v9, v1, 1, 1
v_lshl_add_u32 v8, v9, 10, v8
v_sub_u32 v9, 2048, v8
v_and_b32 v9, 2047, v9
v_and_b32 v10, 1, v1
v_cmp_eq_u32 vcc, 1, v10
s_nop 1
v_cndmask_b32 v8, v8, v9, vcc
v_mul_u32_u24 v17, 1026, v8
s_lshr_b32 s64, s2, 7
s_lshl_b32 s64, s64, 10
v_add_u32 v17, s64, v17
s_add_u32 m0, s68, 16384
s_nop 0
buffer_load_dwordx4 v18, s[48:51], s69 offen nt lds
s_add_u32 m0, s68, 17408
s_nop 0
buffer_load_dwordx4 v18, s[52:55], s69 offen nt lds
s_add_u32 m0, s68, 18432
s_nop 0
buffer_load_dwordx4 v19, s[48:51], s69 offen nt lds
s_add_u32 m0, s68, 19456
s_nop 0
buffer_load_dwordx4 v19, s[52:55], s69 offen nt lds
s_cmp_lg_u32 s66, 3
s_cbranch_scc1 L_nw4
s_mov_b32 exec_hi, 0
buffer_load_ushort v88, v17, s[48:51], 0 offen nt
buffer_load_ushort v89, v17, s[52:55], 0 offen nt
s_mov_b64 exec, -1
L_nw4:
s_cmp_lg_u32 s2, 0
s_cbranch_scc1 L_nz5
s_lshl_b32 s24, s66, 10
s_add_u32 s24, s24, 4096
s_add_u32 s24, s32, s24
s_addc_u32 s25, s33, 0
s_mov_b32 s26, 0
s_atomic_swap s26, s[24:25], 0x0
s_atomic_swap s26, s[24:25], 0x80
s_atomic_swap s26, s[24:25], 0x100
s_atomic_swap s26, s[24:25], 0x180
s_atomic_swap s26, s[24:25], 0x200
s_atomic_swap s26, s[24:25], 0x280
s_atomic_swap s26, s[24:25], 0x300
s_atomic_swap s26, s[24:25], 0x380
L_nz5:
s_barrier
v_and_b32 v92, 31, v1
v_cvt_f32_u32 v92, v92
v_lshrrev_b32 v93, 5, v1
v_lshlrev_b32 v93, 2, v93
v_cvt_f32_u32 v93, v93
v_mul_f32 v93, v92, v93
v_mul_f32 v93, 0x3d000000, v93
v_fmamk_f32 v94, v92, 0x0, v93
v_fract_f32 v94, v94
v_cos_f32 v95, v94
v_sin_f32 v96, v94
s_nop 0
v_cvt_pk_bf16_f32 v192, v95, v96
v_cvt_pk_bf16_f32 v208, -v96, v95
v_fmamk_f32 v97, v92, 0x3d000000, v93
v_fract_f32 v97, v97
v_cos_f32 v98, v97
v_sin_f32 v99, v97
s_nop 0
v_cvt_pk_bf16_f32 v193, v98, v99
v_cvt_pk_bf16_f32 v209, -v99, v98
v_fmamk_f32 v94, v92, 0x3d800000, v93
v_fract_f32 v94, v94
v_cos_f32 v95, v94
v_sin_f32 v96, v94
s_nop 0
v_cvt_pk_bf16_f32 v194, v95, v96
v_cvt_pk_bf16_f32 v210, -v96, v95
v_fmamk_f32 v97, v92, 0x3dc00000, v93
v_fract_f32 v97, v97
v_cos_f32 v98, v97
v_sin_f32 v99, v97
s_nop 0
v_cvt_pk_bf16_f32 v195, v98, v99
v_cvt_pk_bf16_f32 v211, -v99, v98
v_fmamk_f32 v94, v92, 0x3e800000, v93
v_fract_f32 v94, v94
v_cos_f32 v95, v94
v_sin_f32 v96, v94
s_nop 0
v_cvt_pk_bf16_f32 v196, v95, v96
v_cvt_pk_bf16_f32 v212, -v96, v95
v_fmamk_f32 v97, v92, 0x3e900000, v93
v_fract_f32 v97, v97
v_cos_f32 v98, v97
v_sin_f32 v99, v97
s_nop 0
v_cvt_pk_bf16_f32 v197, v98, v99
v_cvt_pk_bf16_f32 v213, -v99, v98
v_fmamk_f32 v94, v92, 0x3ea00000, v93
v_fract_f32 v94, v94
v_cos_f32 v95, v94
v_sin_f32 v96, v94
s_nop 0
v_cvt_pk_bf16_f32 v198, v95, v96
v_cvt_pk_bf16_f32 v214, -v96, v95
v_fmamk_f32 v97, v92, 0x3eb00000, v93
v_fract_f32 v97, v97
v_cos_f32 v98, v97
v_sin_f32 v99, v97
s_nop 0
v_cvt_pk_bf16_f32 v199, v98, v99
v_cvt_pk_bf16_f32 v215, -v99, v98
v_fmamk_f32 v94, v92, 0x3f000000, v93
v_fract_f32 v94, v94
v_cos_f32 v95, v94
v_sin_f32 v96, v94
s_nop 0
v_cvt_pk_bf16_f32 v200, v95, v96
v_cvt_pk_bf16_f32 v216, -v96, v95
v_fmamk_f32 v97, v92, 0x3f080000, v93
v_fract_f32 v97, v97
v_cos_f32 v98, v97
v_sin_f32 v99, v97
s_nop 0
v_cvt_pk_bf16_f32 v201, v98, v99
v_cvt_pk_bf16_f32 v217, -v99, v98
v_fmamk_f32 v94, v92, 0x3f100000, v93
v_fract_f32 v94, v94
v_cos_f32 v95, v94
v_sin_f32 v96, v94
s_nop 0
v_cvt_pk_bf16_f32 v202, v95, v96
v_cvt_pk_bf16_f32 v218, -v96, v95
v_fmamk_f32 v97, v92, 0x3f180000, v93
v_fract_f32 v97, v97
v_cos_f32 v98, v97
v_sin_f32 v99, v97
s_nop 0
v_cvt_pk_bf16_f32 v203, v98, v99
v_cvt_pk_bf16_f32 v219, -v99, v98
v_fmamk_f32 v94, v92, 0x3f400000, v93
v_fract_f32 v94, v94
v_cos_f32 v95, v94
v_sin_f32 v96, v94
s_nop 0
v_cvt_pk_bf16_f32 v204, v95, v96
v_cvt_pk_bf16_f32 v220, -v96, v95
v_fmamk_f32 v97, v92, 0x3f480000, v93
v_fract_f32 v97, v97
v_cos_f32 v98, v97
v_sin_f32 v99, v97
s_nop 0
v_cvt_pk_bf16_f32 v205, v98, v99
v_cvt_pk_bf16_f32 v221, -v99, v98
v_fmamk_f32 v94, v92, 0x3f500000, v93
v_fract_f32 v94, v94
v_cos_f32 v95, v94
v_sin_f32 v96, v94
s_nop 0
v_cvt_pk_bf16_f32 v206, v95, v96
v_cvt_pk_bf16_f32 v222, -v96, v95
v_fmamk_f32 v97, v92, 0x3f580000, v93
v_fract_f32 v97, v97
v_cos_f32 v98, v97
v_sin_f32 v99, v97
s_nop 0
v_cvt_pk_bf16_f32 v207, v98, v99
v_cvt_pk_bf16_f32 v223, -v99, v98
v_and_b32 v92, 31, v1
v_cvt_f32_u32 v92, v92
v_lshrrev_b32 v93, 5, v1
v_lshlrev_b32 v93, 2, v93
v_cvt_f32_u32 v93, v93
v_mul_f32 v93, v92, v93
v_mul_f32 v93, 0x3a800000, v93
v_fmamk_f32 v94, v92, 0x0, v93
v_cos_f32 v224, v94
v_sin_f32 v240, -v94
v_fmamk_f32 v95, v92, 0x3a800000, v93
v_cos_f32 v225, v95
v_sin_f32 v241, -v95
v_fmamk_f32 v94, v92, 0x3b000000, v93
v_cos_f32 v226, v94
v_sin_f32 v242, -v94
v_fmamk_f32 v95, v92, 0x3b400000, v93
v_cos_f32 v227, v95
v_sin_f32 v243, -v95
v_fmamk_f32 v94, v92, 0x3c000000, v93
v_cos_f32 v228, v94
v_sin_f32 v244, -v94
v_fmamk_f32 v95, v92, 0x3c100000, v93
v_cos_f32 v229, v95
v_sin_f32 v245, -v95
v_fmamk_f32 v94, v92, 0x3c200000, v93
v_cos_f32 v230, v94
v_sin_f32 v246, -v94
v_fmamk_f32 v95, v92, 0x3c300000, v93
v_cos_f32 v231, v95
v_sin_f32 v247, -v95
v_fmamk_f32 v94, v92, 0x3c800000, v93
v_cos_f32 v232, v94
v_sin_f32 v248, -v94
v_fmamk_f32 v95, v92, 0x3c880000, v93
v_cos_f32 v233, v95
v_sin_f32 v249, -v95
v_fmamk_f32 v94, v92, 0x3c900000, v93
v_cos_f32 v234, v94
v_sin_f32 v250, -v94
v_fmamk_f32 v95, v92, 0x3c980000, v93
v_cos_f32 v235, v95
v_sin_f32 v251, -v95
v_fmamk_f32 v94, v92, 0x3cc00000, v93
v_cos_f32 v236, v94
v_sin_f32 v252, -v94
v_fmamk_f32 v95, v92, 0x3cc80000, v93
v_cos_f32 v237, v95
v_sin_f32 v253, -v95
v_fmamk_f32 v94, v92, 0x3cd00000, v93
v_cos_f32 v238, v94
v_sin_f32 v254, -v94
v_fmamk_f32 v95, v92, 0x3cd80000, v93
v_cos_f32 v239, v95
v_sin_f32 v255, -v95
v_mov_b32 v184, 126992
s_lshl_b32 s64, s66, 2
v_add_u32 v185, s64, v184
v_and_b32 v8, 31, v1
v_lshrrev_b32 v9, 5, v1
v_and_b32 v10, 1, v1
v_lshrrev_b32 v11, 1, v8
v_lshlrev_b32 v4, 6, v11
v_lshl_add_u32 v4, v10, 4, v4
v_lshl_add_u32 v4, v9, 12, v4
v_add_u32 v11, v11, v10
v_lshlrev_b32 v11, 6, v11
v_lshl_add_u32 v11, v10, 4, v11
v_lshl_add_u32 v11, v9, 12, v11
v_sub_u32 v5, 5168, v11
v_bfe_u32 v11, v4, 7, 1
v_lshlrev_b32 v11, 5, v11
v_xor_b32 v4, v4, v11
v_bfe_u32 v11, v5, 7, 1
v_lshlrev_b32 v11, 5, v11
v_xor_b32 v5, v5, v11
v_add_u32 v6, 11264, v5
v_and_b32 v6, 0x3fff, v6
s_add_u32 s64, s64, 98304
v_add_u32 v4, s64, v4
v_add_u32 v5, s64, v5
v_add_u32 v6, s64, v6
v_bfe_u32 v11, v1, 3, 1
v_lshlrev_b32 v11, 5, v11
v_xor_b32 v7, v2, v11
v_bfe_u32 v12, v1, 2, 1
v_mul_u32_u24 v12, 2176, v12
v_bfe_u32 v13, v1, 3, 1
v_lshl_add_u32 v12, v13, 6, v12
v_lshl_add_u32 v12, v9, 8, v12
v_bfe_u32 v13, v1, 4, 1
v_lshl_add_u32 v12, v13, 5, v12
v_and_b32 v13, 3, v1
v_lshl_add_u32 v12, v13, 3, v12
v_add_u32 v12, s68, v12
v_xor_b32 v13, 128, v12
s_lshl_b32 s64, s2, 14
s_lshl_b32 s65, s66, 12
s_add_u32 s64, s64, s65
s_add_u32 s42, s64, 16777216
s_add_u32 s40, s32, s42
s_addc_u32 s41, s33, 0
s_mov_b32 s42, 4096
s_mov_b32 s43, 0x20000
s_add_u32 s46, s64, 16777216
s_add_u32 s44, s32, s46
s_addc_u32 s45, s33, 0
s_mov_b32 s46, 4096
s_mov_b32 s47, 0x20000
v_and_b32 v14, 7, v1
v_lshrrev_b32 v15, 3, v1
v_xor_b32 v16, v14, v15
v_lshlrev_b32 v16, 4, v16
v_lshl_add_u32 v16, v14, 11, v16
s_lshr_b32 s64, s66, 1
s_lshl_b32 s64, s64, 7
s_and_b32 s65, s66, 1
s_lshl_b32 s65, s65, 3
s_add_u32 s64, s64, s65
s_add_u32 s64, s64, 147456
v_add_u32 v21, s64, v16
v_lshlrev_b32 v15, 16, v15
v_lshl_add_u32 v22, v14, 4, v15
s_lshl_b32 s64, s63, 7
s_lshr_b32 s65, s66, 1
s_lshl_b32 s65, s65, 6
s_add_u32 s64, s64, s65
s_and_b32 s65, s66, 1
s_lshl_b32 s65, s65, 2
s_add_u32 s64, s64, s65
s_mul_i32 s64, s64, 8192
s_lshr_b32 s65, s60, 2
s_mul_i32 s65, s65, 0
s_add_u32 s64, s64, s65
s_lshl_b32 s65, s60, 10
s_add_u32 s64, s64, s65
s_lshl_b32 s65, s61, 9
s_add_u32 s64, s64, s65
s_lshl_b32 s65, s62, 7
s_add_u32 s64, s64, s65
s_add_u32 s58, s64, 25182208
s_add_u32 s56, s32, s58
s_addc_u32 s57, s33, 0
s_sub_u32 s58, 4194304, s64
s_mov_b32 s59, 0x20000
s_lshl_b32 s64, s35, 18
s_lshl_b32 s65, s36, 17
s_add_u32 s12, s10, s64
s_addc_u32 s13, s11, 0
s_mov_b32 s14, 262144
s_mov_b32 s15, 0x20000
s_bitcmp1_b32 s66, 0
s_cselect_b32 s8, s18, s16
s_cselect_b32 s9, s19, s17
s_add_u32 s20, s8, s65
s_addc_u32 s21, s9, 0
s_mov_b32 s22, 131072
s_mov_b32 s23, 0x20000
s_mul_i32 s16, s35, 128
s_mul_i32 s64, s36, 128
s_add_u32 s16, s16, s64
s_bfe_u32 s64, s16, 0x30007
s_cmp_eq_u32 s64, 3
s_cselect_b32 s64, 128, 0
s_add_u32 s16, s16, s64
s_lshl_b32 s17, s66, 12
s_lshr_b32 s64, s66, 1
s_and_b32 s65, s66, 1
v_lshrrev_b32 v96, 5, v1
v_bfe_u32 v97, v1, 3, 2
v_and_b32 v98, 1, v97
v_lshrrev_b32 v99, 1, v97
v_lshlrev_b32 v100, 4, v96
v_lshl_add_u32 v100, v98, 3, v100
v_add_u32 v100, v100, v99
s_lshl_b32 s92, s64, 6
s_lshl_b32 s19, s65, 2
s_add_u32 s92, s92, s19
v_add_u32 v100, s92, v100
v_lshlrev_b32 v100, 11, v100
s_lshl_b32 s92, s64, 5
v_lshl_add_u32 v101, v96, 3, v97
v_add_u32 v101, s92, v101
v_lshlrev_b32 v101, 11, v101
v_and_b32 v98, 7, v1
v_lshrrev_b32 v99, 4, v1
v_xor_b32 v98, v98, v99
v_lshlrev_b32 v98, 4, v98
v_xor_b32 v99, 64, v98
v_add_u32 v176, v100, v98
v_add_u32 v177, v100, v99
v_add_u32 v177, 64512, v177
v_add_u32 v178, v101, v98
v_add_u32 v179, v101, v99
v_add_u32 v179, 31744, v179
s_waitcnt vmcnt(4)
ds_read_b64_tr_b16 v[24:25], v12 offset:0
ds_read_b64_tr_b16 v[26:27], v13 offset:0
ds_read_b64_tr_b16 v[28:29], v12 offset:512
ds_read_b64_tr_b16 v[30:31], v13 offset:512
ds_read_b64_tr_b16 v[32:33], v12 offset:1024
ds_read_b64_tr_b16 v[34:35], v13 offset:1024
ds_read_b64_tr_b16 v[36:37], v12 offset:1536
ds_read_b64_tr_b16 v[38:39], v13 offset:1536
s_waitcnt lgkmcnt(0)
v_mfma_f32_32x32x16_bf16 v[40:55], v[24:27], v[192:195], 0
v_mfma_f32_32x32x16_bf16 v[40:55], v[28:31], v[196:199], v[40:55]
v_mfma_f32_32x32x16_bf16 v[40:55], v[32:35], v[200:203], v[40:55]
v_mfma_f32_32x32x16_bf16 v[40:55], v[36:39], v[204:207], v[40:55]
v_mfma_f32_32x32x16_bf16 v[56:71], v[24:27], v[208:211], 0
v_mfma_f32_32x32x16_bf16 v[56:71], v[28:31], v[212:215], v[56:71]
v_mfma_f32_32x32x16_bf16 v[56:71], v[32:35], v[216:219], v[56:71]
v_mfma_f32_32x32x16_bf16 v[56:71], v[36:39], v[220:223], v[56:71]
s_nop 7
v_mul_f32 v168, v40, v224
v_mul_f32 v169, v40, v240
s_nop 1
v_fma_f32 v168, -v56, v240, v168
v_fmac_f32 v169, v56, v224
v_cvt_pk_bf16_f32 v72, v168, v169
v_mul_f32 v170, v41, v225
v_mul_f32 v171, v41, v241
v_fma_f32 v170, -v57, v241, v170
v_fmac_f32 v171, v57, v225
v_cvt_pk_bf16_f32 v73, v170, v171
v_mul_f32 v172, v42, v226
v_mul_f32 v173, v42, v242
v_fma_f32 v172, -v58, v242, v172
v_fmac_f32 v173, v58, v226
v_cvt_pk_bf16_f32 v74, v172, v173
v_mul_f32 v174, v43, v227
v_mul_f32 v175, v43, v243
v_fma_f32 v174, -v59, v243, v174
v_fmac_f32 v175, v59, v227
v_cvt_pk_bf16_f32 v75, v174, v175
v_mul_f32 v168, v44, v228
v_mul_f32 v169, v44, v244
v_fma_f32 v168, -v60, v244, v168
v_fmac_f32 v169, v60, v228
v_cvt_pk_bf16_f32 v76, v168, v169
v_mul_f32 v170, v45, v229
v_mul_f32 v171, v45, v245
v_fma_f32 v170, -v61, v245, v170
v_fmac_f32 v171, v61, v229
v_cvt_pk_bf16_f32 v77, v170, v171
v_mul_f32 v172, v46, v230
v_mul_f32 v173, v46, v246
v_fma_f32 v172, -v62, v246, v172
v_fmac_f32 v173, v62, v230
v_cvt_pk_bf16_f32 v78, v172, v173
v_mul_f32 v174, v47, v231
v_mul_f32 v175, v47, v247
v_fma_f32 v174, -v63, v247, v174
v_fmac_f32 v175, v63, v231
v_cvt_pk_bf16_f32 v79, v174, v175
v_mul_f32 v168, v48, v232
v_mul_f32 v169, v48, v248
v_fma_f32 v168, -v64, v248, v168
v_fmac_f32 v169, v64, v232
v_cvt_pk_bf16_f32 v80, v168, v169
v_mul_f32 v170, v49, v233
v_mul_f32 v171, v49, v249
v_fma_f32 v170, -v65, v249, v170
v_fmac_f32 v171, v65, v233
v_cvt_pk_bf16_f32 v81, v170, v171
v_mul_f32 v172, v50, v234
v_mul_f32 v173, v50, v250
v_fma_f32 v172, -v66, v250, v172
v_fmac_f32 v173, v66, v234
v_cvt_pk_bf16_f32 v82, v172, v173
v_mul_f32 v174, v51, v235
v_mul_f32 v175, v51, v251
v_fma_f32 v174, -v67, v251, v174
v_fmac_f32 v175, v67, v235
v_cvt_pk_bf16_f32 v83, v174, v175
v_mul_f32 v168, v52, v236
v_mul_f32 v169, v52, v252
v_fma_f32 v168, -v68, v252, v168
v_fmac_f32 v169, v68, v236
v_cvt_pk_bf16_f32 v84, v168, v169
v_mul_f32 v170, v53, v237
v_mul_f32 v171, v53, v253
v_fma_f32 v170, -v69, v253, v170
v_fmac_f32 v171, v69, v237
v_cvt_pk_bf16_f32 v85, v170, v171
v_mul_f32 v172, v54, v238
v_mul_f32 v173, v54, v254
v_fma_f32 v172, -v70, v254, v172
v_fmac_f32 v173, v70, v238
v_cvt_pk_bf16_f32 v86, v172, v173
v_mul_f32 v174, v55, v239
v_mul_f32 v175, v55, v255
v_fma_f32 v174, -v71, v255, v174
v_fmac_f32 v175, v71, v239
v_cvt_pk_bf16_f32 v87, v174, v175
v_mfma_f32_32x32x16_bf16 v[40:55], v[192:195], v[72:75], 0
v_mfma_f32_32x32x16_bf16 v[40:55], v[196:199], v[76:79], v[40:55]
v_mfma_f32_32x32x16_bf16 v[40:55], v[200:203], v[80:83], v[40:55]
v_mfma_f32_32x32x16_bf16 v[40:55], v[204:207], v[84:87], v[40:55]
v_mfma_f32_32x32x16_bf16 v[56:71], v[208:211], v[72:75], 0
v_mfma_f32_32x32x16_bf16 v[56:71], v[212:215], v[76:79], v[56:71]
v_mfma_f32_32x32x16_bf16 v[56:71], v[216:219], v[80:83], v[56:71]
v_mfma_f32_32x32x16_bf16 v[56:71], v[220:223], v[84:87], v[56:71]
s_lshl_b32 s92, s66, 12
s_add_u32 s92, s92, 98304
v_add_u32 v8, s92, v7
s_nop 8
v_cvt_pk_bf16_f32 v72, v40, v56
ds_write_b32 v4, v72 offset:0
v_cvt_pk_bf16_f32 v73, v41, v57
ds_write_b32 v4, v73 offset:1024
v_cvt_pk_bf16_f32 v74, v42, v58
ds_write_b32 v4, v74 offset:2048
v_cvt_pk_bf16_f32 v75, v43, v59
ds_write_b32 v4, v75 offset:3072
v_cvt_pk_bf16_f32 v76, v44, v60
ds_write_b32 v4, v76 offset:8192
v_cvt_pk_bf16_f32 v77, v45, v61
ds_write_b32 v4, v77 offset:9216
v_cvt_pk_bf16_f32 v78, v46, v62
ds_write_b32 v4, v78 offset:10240
v_cvt_pk_bf16_f32 v79, v47, v63
ds_write_b32 v4, v79 offset:11264
v_cvt_pk_bf16_f32 v80, v48, v64
ds_write_b32 v6, v80 offset:0
v_cvt_pk_bf16_f32 v81, v49, v65
ds_write_b32 v5, v81 offset:10240
v_cvt_pk_bf16_f32 v82, v50, v66
ds_write_b32 v5, v82 offset:9216
v_cvt_pk_bf16_f32 v83, v51, v67
ds_write_b32 v5, v83 offset:8192
v_cvt_pk_bf16_f32 v84, v52, v68
ds_write_b32 v5, v84 offset:3072
v_cvt_pk_bf16_f32 v85, v53, v69
ds_write_b32 v5, v85 offset:2048
v_cvt_pk_bf16_f32 v86, v54, v70
ds_write_b32 v5, v86 offset:1024
v_cvt_pk_bf16_f32 v87, v55, v71
ds_write_b32 v5, v87 offset:0
s_waitcnt vmcnt(0)
s_waitcnt lgkmcnt(0)
v_mov_b32 v190, 1
s_mov_b64 exec, 1
ds_write_b32 v185, v190
s_mov_b64 exec, -1
L_lc6:
ds_read_b128 v[186:189], v184
s_waitcnt lgkmcnt(0)
v_min3_u32 v186, v186, v187, v188
v_min_u32 v186, v186, v189
s_nop 0
v_readfirstlane_b32 s92, v186
s_nop 0
s_cmp_ge_u32 s92, 1
s_cbranch_scc1 L_lcd7
s_sleep 1
s_branch L_lc6
L_lcd7:
ds_read_b128 v[72:75], v8 offset:0
ds_read_b128 v[76:79], v8 offset:1024
ds_read_b128 v[80:83], v8 offset:2048
ds_read_b128 v[84:87], v8 offset:3072
ds_read_b64 v[104:105], v21 offset:0
ds_read_b64 v[106:107], v21 offset:256
ds_read_b64 v[108:109], v21 offset:512
ds_read_b64 v[110:111], v21 offset:768
ds_read_b64 v[112:113], v21 offset:1024
ds_read_b64 v[114:115], v21 offset:1280
ds_read_b64 v[116:117], v21 offset:1536
ds_read_b64 v[118:119], v21 offset:1792
v_add_u32 v4, 32768, v4
v_add_u32 v5, 32768, v5
v_add_u32 v6, 32768, v6
s_waitcnt lgkmcnt(0)
v_mov_b32 v190, 2
s_mov_b64 exec, 1
ds_write_b32 v185, v190
s_mov_b64 exec, -1
s_lshl_b32 s92, s2, 3
s_add_u32 s92, s92, s34
s_cmp_lg_u32 s92, 4
s_cbranch_scc1 L_nn8
s_add_u32 s3, s3, 1
s_cmp_eq_u32 s3, 0
s_cselect_b32 s3, 1, s3
s_atomic_swap s3, s[30:31], 0x0
s_atomic_swap s3, s[32:33], 0x0
L_nn8:
s_mov_b32 s64, 0x05040100
s_mov_b32 s65, 0x07060302
v_lshlrev_b32 v88, 16, v88
v_lshlrev_b32 v89, 16, v89
v_lshlrev_b32 v23, 1, v1
v_add_f32_dpp v90, v88, v88 quad_perm:[1,0,3,2] row_mask:0xf bank_mask:0xf
v_subrev_f32_dpp v91, v89, v89 quad_perm:[1,0,3,2] row_mask:0xf bank_mask:0xf
v_mul_f32 v90, 0.5, v90
v_mul_f32 v91, 0.5, v91
v_cvt_pk_bf16_f32 v88, v90, v91
v_perm_b32 v120, v112, v104, s64
v_perm_b32 v121, v116, v108, s64
v_perm_b32 v122, v114, v106, s64
v_perm_b32 v123, v118, v110, s64
v_perm_b32 v124, v112, v104, s65
v_perm_b32 v125, v116, v108, s65
v_perm_b32 v126, v114, v106, s65
v_perm_b32 v127, v118, v110, s65
v_perm_b32 v128, v113, v105, s64
v_perm_b32 v129, v117, v109, s64
v_perm_b32 v130, v115, v107, s64
v_perm_b32 v131, v119, v111, s64
v_perm_b32 v132, v113, v105, s65
v_perm_b32 v133, v117, v109, s65
v_perm_b32 v134, v115, v107, s65
v_perm_b32 v135, v119, v111, s65
v_and_b32 v92, 31, v1
v_cvt_f32_u32 v92, v92
v_lshrrev_b32 v93, 5, v1
v_lshlrev_b32 v93, 2, v93
v_cvt_f32_u32 v93, v93
v_mul_f32 v92, 0x3a000000, v92
v_fmamk_f32 v93, v93, 0x3c800000, v92
v_add_f32 v94, 0x0, v93
v_cos_f32 v136, v94
v_sin_f32 v152, -v94
v_add_f32 v95, 0x3c800000, v93
v_cos_f32 v137, v95
v_sin_f32 v153, -v95
v_add_f32 v94, 0x3d000000, v93
v_cos_f32 v138, v94
v_sin_f32 v154, -v94
v_add_f32 v95, 0x3d400000, v93
v_cos_f32 v139, v95
v_sin_f32 v155, -v95
v_add_f32 v94, 0x3e000000, v93
v_cos_f32 v140, v94
v_sin_f32 v156, -v94
v_add_f32 v95, 0x3e100000, v93
v_cos_f32 v141, v95
v_sin_f32 v157, -v95
v_add_f32 v94, 0x3e200000, v93
v_cos_f32 v142, v94
v_sin_f32 v158, -v94
v_add_f32 v95, 0x3e300000, v93
v_cos_f32 v143, v95
v_sin_f32 v159, -v95
v_add_f32 v94, 0x3e800000, v93
v_cos_f32 v144, v94
v_sin_f32 v160, -v94
v_add_f32 v95, 0x3e880000, v93
v_cos_f32 v145, v95
v_sin_f32 v161, -v95
v_add_f32 v94, 0x3e900000, v93
v_cos_f32 v146, v94
v_sin_f32 v162, -v94
v_add_f32 v95, 0x3e980000, v93
v_cos_f32 v147, v95
v_sin_f32 v163, -v95
v_add_f32 v94, 0x3ec00000, v93
v_cos_f32 v148, v94
v_sin_f32 v164, -v94
v_add_f32 v95, 0x3ec80000, v93
v_cos_f32 v149, v95
v_sin_f32 v165, -v95
v_add_f32 v94, 0x3ed00000, v93
v_cos_f32 v150, v94
v_sin_f32 v166, -v94
v_add_f32 v95, 0x3ed80000, v93
v_cos_f32 v151, v95
v_sin_f32 v167, -v95
s_and_b32 s60, s2, 7
s_lshl_b32 s60, s60, 5
s_lshr_b32 s64, s2, 3
s_add_u32 s60, s60, s64
s_lshr_b32 s64, s66, 1
s_xor_b32 s64, s64, s66
s_and_b32 s64, s64, 1
s_or_b32 s65, s64, s60
s_cmp_eq_u32 s65, 0
s_cselect_b32 s61, 1, 0
s_lshl_b32 s65, s60, 1
s_add_u32 s64, s64, s65
s_mul_i32 s64, s64, 8192
s_add_u32 s64, s64, 25182208
s_lshr_b32 s65, s66, 1
s_mul_i32 s69, s65, 8192
s_add_u32 s69, s69, 25165824
s_cmp_eq_u32 s61, 1
s_cselect_b32 s64, s69, s64
s_cselect_b32 s65, 0, s65
s_cselect_b32 s90, s32, s32
s_cselect_b32 s91, s33, s33
s_lshl_b32 s62, s65, 31
s_or_b32 s63, s62, 0x3f800000
s_add_u32 s48, s90, s64
s_addc_u32 s49, s91, 0
s_mov_b32 s50, 8192
s_mov_b32 s51, 0x20000
s_lshl_b32 s64, s66, 20
s_lshl_b32 s65, s60, 6
s_add_u32 s64, s64, s65
s_add_u32 s54, s64, 16777216
s_add_u32 s52, s32, s54
s_addc_u32 s53, s33, 0
s_sub_u32 s54, 1048576, s65
s_mov_b32 s55, 0x20000
v_lshrrev_b32 v8, 2, v1
v_lshlrev_b32 v8, 14, v8
v_and_b32 v9, 3, v1
v_lshrrev_b32 v10, 4, v1
v_xor_b32 v9, v9, v10
v_lshl_add_u32 v14, v9, 4, v8
v_and_b32 v8, 31, v1
v_bfe_u32 v9, v1, 2, 2
v_xor_b32 v9, s66, v9
v_lshlrev_b32 v9, 4, v9
v_lshl_add_u32 v9, v8, 6, v9
v_lshrrev_b32 v8, 5, v1
v_lshl_add_u32 v9, v8, 11, v9
v_add_u32 v15, 131072, v9
s_lshl_b32 s64, s66, 13
s_add_u32 s64, s64, 131072
v_add_u32 v16, s64, v2
s_xor_b32 s65, s64, 24576
s_cmp_eq_u32 s61, 1
s_cselect_b32 s65, s64, s65
v_add_u32 v17, s65, v2
v_add_u32 v18, s68, v2
s_lshr_b32 s64, s66, 1
s_xor_b32 s64, s64, s66
s_and_b32 s64, s64, 1
s_lshl_b32 s69, s64, 13
s_add_u32 s69, s69, 147456
v_add_u32 v19, s69, v2
v_mul_f32 v136, s63, v136
v_mul_f32 v137, s63, v137
v_mul_f32 v138, s63, v138
v_mul_f32 v139, s63, v139
v_mul_f32 v140, s63, v140
v_mul_f32 v141, s63, v141
v_mul_f32 v142, s63, v142
v_mul_f32 v143, s63, v143
v_mul_f32 v144, s63, v144
v_mul_f32 v145, s63, v145
v_mul_f32 v146, s63, v146
v_mul_f32 v147, s63, v147
v_mul_f32 v148, s63, v148
v_mul_f32 v149, s63, v149
v_mul_f32 v150, s63, v150
v_mul_f32 v151, s63, v151
v_mul_f32 v152, s63, v152
v_mul_f32 v153, s63, v153
v_mul_f32 v154, s63, v154
v_mul_f32 v155, s63, v155
v_mul_f32 v156, s63, v156
v_mul_f32 v157, s63, v157
v_mul_f32 v158, s63, v158
v_mul_f32 v159, s63, v159
v_mul_f32 v160, s63, v160
v_mul_f32 v161, s63, v161
v_mul_f32 v162, s63, v162
v_mul_f32 v163, s63, v163
v_mul_f32 v164, s63, v164
v_mul_f32 v165, s63, v165
v_mul_f32 v166, s63, v166
v_mul_f32 v167, s63, v167
buffer_store_dwordx4 v[72:75], v2, s[40:43], 0 offen offset:0 sc1
buffer_store_dwordx4 v[76:79], v2, s[40:43], 0 offen offset:1024 sc1
buffer_store_dwordx4 v[80:83], v2, s[40:43], 0 offen offset:2048 sc1
buffer_store_dwordx4 v[84:87], v2, s[40:43], 0 offen offset:3072 sc1
s_setprio 3
s_barrier
s_add_u32 s8, s16, 256
s_and_b32 s8, s8, 0x7ff
s_add_u32 s9, s8, 2048
s_add_u32 s10, s8, 6144
s_add_u32 m0, s17, 65536
s_nop 0
buffer_load_dwordx4 v176, s[12:15], s8 offen offset:0 lds
buffer_load_dwordx4 v177, s[12:15], s8 offen offset:1024 lds
buffer_load_dwordx4 v176, s[12:15], s9 offen offset:2048 lds
buffer_load_dwordx4 v177, s[12:15], s9 offen offset:3072 lds
s_add_u32 m0, s17, 81920
s_nop 0
buffer_load_dwordx4 v178, s[20:23], s8 offen offset:0 lds
buffer_load_dwordx4 v179, s[20:23], s8 offen offset:1024 lds
buffer_load_dwordx4 v178, s[20:23], s10 offen offset:2048 lds
buffer_load_dwordx4 v179, s[20:23], s10 offen offset:3072 lds
s_barrier
s_add_u32 s8, s16, 384
s_and_b32 s8, s8, 0x7ff
s_add_u32 s9, s8, 2048
s_add_u32 s10, s8, 6144
s_add_u32 m0, s17, 0
s_nop 0
buffer_load_dwordx4 v176, s[12:15], s8 offen offset:0 lds
buffer_load_dwordx4 v177, s[12:15], s8 offen offset:1024 lds
buffer_load_dwordx4 v176, s[12:15], s9 offen offset:2048 lds
buffer_load_dwordx4 v177, s[12:15], s9 offen offset:3072 lds
s_add_u32 m0, s17, 16384
s_nop 0
buffer_load_dwordx4 v178, s[20:23], s8 offen offset:0 lds
buffer_load_dwordx4 v179, s[20:23], s8 offen offset:1024 lds
buffer_load_dwordx4 v178, s[20:23], s10 offen offset:2048 lds
buffer_load_dwordx4 v179, s[20:23], s10 offen offset:3072 lds
s_waitcnt vmcnt(8)
s_barrier
s_add_u32 s8, s16, 512
s_and_b32 s8, s8, 0x7ff
s_add_u32 s9, s8, 2048
s_add_u32 s10, s8, 6144
s_add_u32 m0, s17, 32768
s_nop 0
buffer_load_dwordx4 v176, s[12:15], s8 offen offset:0 lds
buffer_load_dwordx4 v177, s[12:15], s8 offen offset:1024 lds
buffer_load_dwordx4 v176, s[12:15], s9 offen offset:2048 lds
buffer_load_dwordx4 v177, s[12:15], s9 offen offset:3072 lds
s_add_u32 m0, s17, 49152
s_nop 0
buffer_load_dwordx4 v178, s[20:23], s8 offen offset:0 lds
buffer_load_dwordx4 v179, s[20:23], s8 offen offset:1024 lds
buffer_load_dwordx4 v178, s[20:23], s10 offen offset:2048 lds
buffer_load_dwordx4 v179, s[20:23], s10 offen offset:3072 lds
v_mov_b32 v20, 0
global_load_dword v21, v20, s[30:31] sc1
s_waitcnt vmcnt(9)
s_barrier
s_add_u32 s8, s16, 640
s_and_b32 s8, s8, 0x7ff
s_add_u32 s9, s8, 2048
s_add_u32 s10, s8, 6144
s_add_u32 m0, s17, 65536
s_nop 0
buffer_load_dwordx4 v176, s[12:15], s8 offen offset:0 lds
buffer_load_dwordx4 v177, s[12:15], s8 offen offset:1024 lds
buffer_load_dwordx4 v176, s[12:15], s9 offen offset:2048 lds
buffer_load_dwordx4 v177, s[12:15], s9 offen offset:3072 lds
s_add_u32 m0, s17, 81920
s_nop 0
buffer_load_dwordx4 v178, s[20:23], s8 offen offset:0 lds
buffer_load_dwordx4 v179, s[20:23], s8 offen offset:1024 lds
buffer_load_dwordx4 v178, s[20:23], s10 offen offset:2048 lds
buffer_load_dwordx4 v179, s[20:23], s10 offen offset:3072 lds
s_cmp_lg_u32 s66, 3
s_cbranch_scc1 L_nw9
s_lshr_b32 s64, s2, 7
s_mul_i32 s64, s64, 8192
s_bfe_u32 s65, s2, 0x10006
s_mul_i32 s65, s65, 4096
s_add_u32 s64, s64, s65
s_and_b32 s65, s2, 63
s_lshl_b32 s65, s65, 6
s_add_u32 s64, s64, s65
s_add_u32 s6, s64, 25165824
s_add_u32 s4, s32, s6
s_addc_u32 s5, s33, 0
s_mov_b32 s6, 64
s_mov_b32 s7, 0x20000
s_mov_b32 exec_lo, 0x55555555
s_mov_b32 exec_hi, 0
buffer_store_dword v88, v23, s[4:7], 0 offen sc1
s_mov_b64 exec, -1
L_nw9:
s_mov_b32 s92, 0
buffer_store_dwordx4 v[120:123], v22, s[56:59], s92 offen sc1
s_mov_b32 s92, 8192
buffer_store_dwordx4 v[124:127], v22, s[56:59], s92 offen sc1
s_mov_b32 s92, 16384
buffer_store_dwordx4 v[128:131], v22, s[56:59], s92 offen sc1
s_mov_b32 s92, 24576
buffer_store_dwordx4 v[132:135], v22, s[56:59], s92 offen sc1
s_waitcnt vmcnt(13)
s_barrier
s_add_u32 s8, s16, 768
s_and_b32 s8, s8, 0x7ff
s_add_u32 s9, s8, 2048
s_add_u32 s10, s8, 6144
s_add_u32 m0, s17, 0
s_nop 0
buffer_load_dwordx4 v176, s[12:15], s8 offen offset:0 lds
buffer_load_dwordx4 v177, s[12:15], s8 offen offset:1024 lds
buffer_load_dwordx4 v176, s[12:15], s9 offen offset:2048 lds
buffer_load_dwordx4 v177, s[12:15], s9 offen offset:3072 lds
s_add_u32 m0, s17, 16384
s_nop 0
buffer_load_dwordx4 v178, s[20:23], s8 offen offset:0 lds
buffer_load_dwordx4 v179, s[20:23], s8 offen offset:1024 lds
buffer_load_dwordx4 v178, s[20:23], s10 offen offset:2048 lds
buffer_load_dwordx4 v179, s[20:23], s10 offen offset:3072 lds
s_waitcnt vmcnt(12)
s_barrier
s_add_u32 s8, s16, 896
s_and_b32 s8, s8, 0x7ff
s_add_u32 s9, s8, 2048
s_add_u32 s10, s8, 6144
s_add_u32 m0, s17, 32768
s_nop 0
buffer_load_dwordx4 v176, s[12:15], s8 offen offset:0 lds
buffer_load_dwordx4 v177, s[12:15], s8 offen offset:1024 lds
buffer_load_dwordx4 v176, s[12:15], s9 offen offset:2048 lds
buffer_load_dwordx4 v177, s[12:15], s9 offen offset:3072 lds
s_add_u32 m0, s17, 49152
s_nop 0
buffer_load_dwordx4 v178, s[20:23], s8 offen offset:0 lds
buffer_load_dwordx4 v179, s[20:23], s8 offen offset:1024 lds
buffer_load_dwordx4 v178, s[20:23], s10 offen offset:2048 lds
buffer_load_dwordx4 v179, s[20:23], s10 offen offset:3072 lds
s_waitcnt vmcnt(8)
s_barrier
s_add_u32 s8, s16, 1024
s_and_b32 s8, s8, 0x7ff
s_add_u32 s9, s8, 2048
s_add_u32 s10, s8, 6144
s_add_u32 m0, s17, 65536
s_nop 0
buffer_load_dwordx4 v176, s[12:15], s8 offen offset:0 lds
buffer_load_dwordx4 v177, s[12:15], s8 offen offset:1024 lds
buffer_load_dwordx4 v176, s[12:15], s9 offen offset:2048 lds
buffer_load_dwordx4 v177, s[12:15], s9 offen offset:3072 lds
s_add_u32 m0, s17, 81920
s_nop 0
buffer_load_dwordx4 v178, s[20:23], s8 offen offset:0 lds
buffer_load_dwordx4 v179, s[20:23], s8 offen offset:1024 lds
buffer_load_dwordx4 v178, s[20:23], s10 offen offset:2048 lds
buffer_load_dwordx4 v179, s[20:23], s10 offen offset:3072 lds
v_readfirstlane_b32 s37, v21
s_nop 0
s_cmp_lg_u32 s37, 0
s_cbranch_scc1 L_sg11
v_mov_b32 v20, 0
L_n12:
global_load_dword v21, v20, s[30:31] sc1
s_waitcnt vmcnt(0)
v_readfirstlane_b32 s37, v21
s_nop 0
s_cmp_eq_u32 s37, 0
s_cbranch_scc1 L_n12
L_sg11:
s_cmp_lg_u32 s66, 0
s_cbranch_scc1 L_sg14
s_and_b32 s64, s2, 15
s_lshl_b32 s65, s64, 7
s_add_u32 s65, s65, 4096
s_add_u32 s90, s32, s65
s_addc_u32 s91, s33, 0
s_mov_b32 s18, 1
s_atomic_add s18, s[90:91], 0x0 glc
L_sg14:
s_waitcnt vmcnt(8)
s_barrier
s_add_u32 s8, s16, 1152
s_and_b32 s8, s8, 0x7ff
s_add_u32 s9, s8, 2048
s_add_u32 s10, s8, 6144
s_add_u32 m0, s17, 0
s_nop 0
buffer_load_dwordx4 v176, s[12:15], s8 offen offset:0 lds
buffer_load_dwordx4 v177, s[12:15], s8 offen offset:1024 lds
buffer_load_dwordx4 v176, s[12:15], s9 offen offset:2048 lds
buffer_load_dwordx4 v177, s[12:15], s9 offen offset:3072 lds
s_add_u32 m0, s17, 16384
s_nop 0
buffer_load_dwordx4 v178, s[20:23], s8 offen offset:0 lds
buffer_load_dwordx4 v179, s[20:23], s8 offen offset:1024 lds
buffer_load_dwordx4 v178, s[20:23], s10 offen offset:2048 lds
buffer_load_dwordx4 v179, s[20:23], s10 offen offset:3072 lds
s_waitcnt vmcnt(8)
s_barrier
s_add_u32 s8, s16, 1280
s_and_b32 s8, s8, 0x7ff
s_add_u32 s9, s8, 2048
s_add_u32 s10, s8, 6144
s_add_u32 m0, s17, 32768
s_nop 0
buffer_load_dwordx4 v176, s[12:15], s8 offen offset:0 lds
buffer_load_dwordx4 v177, s[12:15], s8 offen offset:1024 lds
buffer_load_dwordx4 v176, s[12:15], s9 offen offset:2048 lds
buffer_load_dwordx4 v177, s[12:15], s9 offen offset:3072 lds
s_add_u32 m0, s17, 49152
s_nop 0
buffer_load_dwordx4 v178, s[20:23], s8 offen offset:0 lds
buffer_load_dwordx4 v179, s[20:23], s8 offen offset:1024 lds
buffer_load_dwordx4 v178, s[20:23], s10 offen offset:2048 lds
buffer_load_dwordx4 v179, s[20:23], s10 offen offset:3072 lds
s_cmp_lg_u32 s66, 0
s_cbranch_scc1 L_sg15
s_waitcnt lgkmcnt(0)
s_cmp_lg_u32 s18, 15
s_cbranch_scc1 L_sg15
s_and_b32 s64, s2, 15
s_lshl_b32 s64, s64, 2
s_add_u32 s64, s64, 540672
v_lshl_add_u32 v22, v1, 7, s64
v_mov_b32 v23, s37
global_store_dword v22, v23, s[32:33] sc1
L_sg15:
s_waitcnt vmcnt(8)
s_barrier
s_add_u32 s8, s16, 1408
s_and_b32 s8, s8, 0x7ff
s_add_u32 s9, s8, 2048
s_add_u32 s10, s8, 6144
s_add_u32 m0, s17, 65536
s_nop 0
buffer_load_dwordx4 v176, s[12:15], s8 offen offset:0 lds
buffer_load_dwordx4 v177, s[12:15], s8 offen offset:1024 lds
buffer_load_dwordx4 v176, s[12:15], s9 offen offset:2048 lds
buffer_load_dwordx4 v177, s[12:15], s9 offen offset:3072 lds
s_add_u32 m0, s17, 81920
s_nop 0
buffer_load_dwordx4 v178, s[20:23], s8 offen offset:0 lds
buffer_load_dwordx4 v179, s[20:23], s8 offen offset:1024 lds
buffer_load_dwordx4 v178, s[20:23], s10 offen offset:2048 lds
buffer_load_dwordx4 v179, s[20:23], s10 offen offset:3072 lds
s_waitcnt vmcnt(8)
s_barrier
s_add_u32 s8, s16, 1536
s_and_b32 s8, s8, 0x7ff
s_add_u32 s9, s8, 2048
s_add_u32 s10, s8, 6144
s_add_u32 m0, s17, 0
s_nop 0
buffer_load_dwordx4 v176, s[12:15], s8 offen offset:0 lds
buffer_load_dwordx4 v177, s[12:15], s8 offen offset:1024 lds
buffer_load_dwordx4 v176, s[12:15], s9 offen offset:2048 lds
buffer_load_dwordx4 v177, s[12:15], s9 offen offset:3072 lds
s_add_u32 m0, s17, 16384
s_nop 0
buffer_load_dwordx4 v178, s[20:23], s8 offen offset:0 lds
buffer_load_dwordx4 v179, s[20:23], s8 offen offset:1024 lds
buffer_load_dwordx4 v178, s[20:23], s10 offen offset:2048 lds
buffer_load_dwordx4 v179, s[20:23], s10 offen offset:3072 lds
s_waitcnt vmcnt(8)
s_barrier
s_add_u32 s8, s16, 1664
s_and_b32 s8, s8, 0x7ff
s_add_u32 s9, s8, 2048
s_add_u32 s10, s8, 6144
s_add_u32 m0, s17, 32768
s_nop 0
buffer_load_dwordx4 v176, s[12:15], s8 offen offset:0 lds
buffer_load_dwordx4 v177, s[12:15], s8 offen offset:1024 lds
buffer_load_dwordx4 v176, s[12:15], s9 offen offset:2048 lds
buffer_load_dwordx4 v177, s[12:15], s9 offen offset:3072 lds
s_add_u32 m0, s17, 49152
s_nop 0
buffer_load_dwordx4 v178, s[20:23], s8 offen offset:0 lds
buffer_load_dwordx4 v179, s[20:23], s8 offen offset:1024 lds
buffer_load_dwordx4 v178, s[20:23], s10 offen offset:2048 lds
buffer_load_dwordx4 v179, s[20:23], s10 offen offset:3072 lds
s_waitcnt vmcnt(8)
s_barrier
s_add_u32 s8, s16, 1792
s_and_b32 s8, s8, 0x7ff
s_add_u32 s9, s8, 2048
s_add_u32 s10, s8, 6144
s_add_u32 m0, s17, 65536
s_nop 0
buffer_load_dwordx4 v176, s[12:15], s8 offen offset:0 lds
buffer_load_dwordx4 v177, s[12:15], s8 offen offset:1024 lds
buffer_load_dwordx4 v176, s[12:15], s9 offen offset:2048 lds
buffer_load_dwordx4 v177, s[12:15], s9 offen offset:3072 lds
s_add_u32 m0, s17, 81920
s_nop 0
buffer_load_dwordx4 v178, s[20:23], s8 offen offset:0 lds
buffer_load_dwordx4 v179, s[20:23], s8 offen offset:1024 lds
buffer_load_dwordx4 v178, s[20:23], s10 offen offset:2048 lds
buffer_load_dwordx4 v179, s[20:23], s10 offen offset:3072 lds
s_waitcnt vmcnt(8)
s_barrier
s_add_u32 s8, s16, 1920
s_and_b32 s8, s8, 0x7ff
s_add_u32 s9, s8, 2048
s_add_u32 s10, s8, 6144
s_add_u32 m0, s17, 0
s_nop 0
buffer_load_dwordx4 v176, s[12:15], s8 offen offset:0 lds
buffer_load_dwordx4 v177, s[12:15], s8 offen offset:1024 lds
buffer_load_dwordx4 v176, s[12:15], s9 offen offset:2048 lds
buffer_load_dwordx4 v177, s[12:15], s9 offen offset:3072 lds
s_add_u32 m0, s17, 16384
s_nop 0
buffer_load_dwordx4 v178, s[20:23], s8 offen offset:0 lds
buffer_load_dwordx4 v179, s[20:23], s8 offen offset:1024 lds
buffer_load_dwordx4 v178, s[20:23], s10 offen offset:2048 lds
buffer_load_dwordx4 v179, s[20:23], s10 offen offset:3072 lds
s_waitcnt vmcnt(8)
s_barrier
s_and_b32 s64, s2, 1
s_lshl_b32 s64, s64, 10
s_bfe_u32 s92, s2, 0x20001
s_lshl_b32 s92, s92, 19
s_add_u32 s64, s64, s92
s_lshr_b32 s92, s2, 3
s_lshl_b32 s92, s92, 14
s_add_u32 s64, s64, s92
s_lshr_b32 s92, s66, 1
s_lshl_b32 s92, s92, 13
s_add_u32 s64, s64, s92
v_bfe_u32 v22, v1, 3, 2
v_lshlrev_b32 v22, 11, v22
v_and_b32 v23, 7, v1
v_lshl_add_u32 v22, v23, 7, v22
v_add_u32 v22, s64, v22
s_mov_b32 exec_hi, 0
global_load_dword v23, v22, s[100:101]
s_mov_b64 exec, -1
s_lshl_b32 s64, s2, 2
s_add_u32 s64, s64, s66
s_lshr_b32 s64, s64, 4
s_lshl_b32 s64, s64, 7
s_add_u32 s64, s64, 540672
s_add_u32 s24, s32, s64
s_addc_u32 s25, s33, 0
s_load_dwordx16 s[4:19], s[24:25], 0x0 glc
s_waitcnt vmcnt(1)
s_barrier
s_setprio 0
s_mov_b32 s26, s37
s_mov_b32 s27, s37
s_mov_b32 s92, 0
s_branch L_sp18
L_late16:
s_add_u32 s92, s92, 1
s_cmp_ge_u32 s92, 200000
s_cbranch_scc1 L_go17
s_sleep 8
s_load_dwordx16 s[4:19], s[24:25], 0x0 glc
L_sp18:
s_waitcnt lgkmcnt(0)
s_cmp_eq_u64 s[4:5], s[26:27]
s_cbranch_scc0 L_late16
s_cmp_eq_u64 s[6:7], s[26:27]
s_cbranch_scc0 L_late16
s_cmp_eq_u64 s[8:9], s[26:27]
s_cbranch_scc0 L_late16
s_cmp_eq_u64 s[10:11], s[26:27]
s_cbranch_scc0 L_late16
s_cmp_eq_u64 s[12:13], s[26:27]
s_cbranch_scc0 L_late16
s_cmp_eq_u64 s[14:15], s[26:27]
s_cbranch_scc0 L_late16
s_cmp_eq_u64 s[16:17], s[26:27]
s_cbranch_scc0 L_late16
s_cmp_eq_u64 s[18:19], s[26:27]
s_cbranch_scc0 L_late16
L_go17:
s_setprio 0
s_add_u32 m0, s68, 0
s_mov_b32 s64, 0
buffer_load_dwordx4 v14, s[52:55], s64 offen sc1 lds
s_add_u32 m0, s68, 1024
s_mov_b32 s64, 262144
buffer_load_dwordx4 v14, s[52:55], s64 offen sc1 lds
s_add_u32 m0, s68, 2048
s_mov_b32 s64, 524288
buffer_load_dwordx4 v14, s[52:55], s64 offen sc1 lds
s_add_u32 m0, s68, 3072
s_mov_b32 s64, 786432
buffer_load_dwordx4 v14, s[52:55], s64 offen sc1 lds
s_cmp_eq_u32 s61, 1
s_cbranch_scc1 L_ws19
s_lshr_b32 s64, s66, 1
s_lshl_b32 s65, s64, 12
s_mul_i32 s64, s64, 4096
s_add_u32 m0, s69, s65
s_nop 0
buffer_load_dwordx4 v2, s[48:51], s64 offen offset:0 sc1 lds
buffer_load_dwordx4 v2, s[48:51], s64 offen offset:1024 sc1 lds
buffer_load_dwordx4 v2, s[48:51], s64 offen offset:2048 sc1 lds
buffer_load_dwordx4 v2, s[48:51], s64 offen offset:3072 sc1 lds
s_waitcnt vmcnt(0)
s_branch L_wd20
L_ws19:
s_movk_i32 s64, 4096
buffer_load_dwordx4 v[104:107], v2, s[48:51], 0 offen offset:0 sc1
buffer_load_dwordx4 v[108:111], v2, s[48:51], 0 offen offset:1024 sc1
buffer_load_dwordx4 v[112:115], v2, s[48:51], 0 offen offset:2048 sc1
buffer_load_dwordx4 v[116:119], v2, s[48:51], 0 offen offset:3072 sc1
buffer_load_dwordx4 v[120:123], v2, s[48:51], s64 offen offset:0 sc1
buffer_load_dwordx4 v[124:127], v2, s[48:51], s64 offen offset:1024 sc1
buffer_load_dwordx4 v[128:131], v2, s[48:51], s64 offen offset:2048 sc1
buffer_load_dwordx4 v[132:135], v2, s[48:51], s64 offen offset:3072 sc1
L_wd20:
s_waitcnt vmcnt(8)
v_mov_b32 v190, 3
s_mov_b64 exec, 1
ds_write_b32 v185, v190
s_mov_b64 exec, -1
L_lc21:
ds_read_b128 v[186:189], v184
s_waitcnt lgkmcnt(0)
v_min3_u32 v186, v186, v187, v188
v_min_u32 v186, v186, v189
s_nop 0
v_readfirstlane_b32 s92, v186
s_nop 0
s_cmp_ge_u32 s92, 3
s_cbranch_scc1 L_lcd22
s_sleep 1
s_branch L_lc21
L_lcd22:
ds_read_b128 v[72:75], v15 offset:0
ds_read_b128 v[76:79], v15 offset:4096
ds_read_b128 v[80:83], v15 offset:8192
ds_read_b128 v[84:87], v15 offset:12288
s_cmp_eq_u32 s61, 1
s_cbranch_scc1 L_wr23
ds_read_b128 v[104:107], v19 offset:0
ds_read_b128 v[108:111], v19 offset:1024
ds_read_b128 v[112:115], v19 offset:2048
ds_read_b128 v[116:119], v19 offset:3072
ds_read_b128 v[120:123], v19 offset:4096
ds_read_b128 v[124:127], v19 offset:5120
ds_read_b128 v[128:131], v19 offset:6144
ds_read_b128 v[132:135], v19 offset:7168
L_wr23:
s_waitcnt lgkmcnt(0)
v_mov_b32 v190, 4
s_mov_b64 exec, 1
ds_write_b32 v185, v190
s_mov_b64 exec, -1
s_lshl_b32 s64, s61, 31
s_or_b32 s64, s64, s62
L_fft24:
v_xor_b32 v24, s64, v72
v_xor_b32 v25, s64, v73
v_xor_b32 v26, s64, v74
v_xor_b32 v27, s64, v75
v_xor_b32 v28, s64, v76
v_xor_b32 v29, s64, v77
v_xor_b32 v30, s64, v78
v_xor_b32 v31, s64, v79
v_xor_b32 v32, s64, v80
v_xor_b32 v33, s64, v81
v_xor_b32 v34, s64, v82
v_xor_b32 v35, s64, v83
v_xor_b32 v36, s64, v84
v_xor_b32 v37, s64, v85
v_xor_b32 v38, s64, v86
v_xor_b32 v39, s64, v87
v_mfma_f32_32x32x16_bf16 v[40:55], v[24:27], v[192:195], 0
v_mfma_f32_32x32x16_bf16 v[40:55], v[28:31], v[196:199], v[40:55]
v_mfma_f32_32x32x16_bf16 v[40:55], v[32:35], v[200:203], v[40:55]
v_mfma_f32_32x32x16_bf16 v[40:55], v[36:39], v[204:207], v[40:55]
v_mfma_f32_32x32x16_bf16 v[56:71], v[24:27], v[208:211], 0
v_mfma_f32_32x32x16_bf16 v[56:71], v[28:31], v[212:215], v[56:71]
v_mfma_f32_32x32x16_bf16 v[56:71], v[32:35], v[216:219], v[56:71]
v_mfma_f32_32x32x16_bf16 v[56:71], v[36:39], v[220:223], v[56:71]
s_cmp_eq_u32 s61, 2
s_cbranch_scc1 L_once26
s_waitcnt vmcnt(0)
v_lshlrev_b32 v176, 16, v104
v_and_b32 v177, 0xffff0000, v104
v_lshlrev_b32 v178, 16, v105
v_and_b32 v179, 0xffff0000, v105
v_add_f32 v180, v176, v178
v_add_f32 v181, v177, v179
v_sub_f32 v176, v176, v178
v_sub_f32 v177, v177, v179
v_mul_f32 v104, v136, v176
v_mul_f32 v105, v136, v177
v_fma_f32 v136, v152, v176, v180
v_fma_f32 v152, v152, v177, v181
v_lshlrev_b32 v176, 16, v106
v_and_b32 v177, 0xffff0000, v106
v_lshlrev_b32 v178, 16, v107
v_and_b32 v179, 0xffff0000, v107
v_add_f32 v180, v176, v178
v_add_f32 v181, v177, v179
v_sub_f32 v176, v176, v178
v_sub_f32 v177, v177, v179
v_mul_f32 v106, v137, v176
v_mul_f32 v107, v137, v177
v_fma_f32 v137, v153, v176, v180
v_fma_f32 v153, v153, v177, v181
v_lshlrev_b32 v176, 16, v108
v_and_b32 v177, 0xffff0000, v108
v_lshlrev_b32 v178, 16, v109
v_and_b32 v179, 0xffff0000, v109
v_add_f32 v180, v176, v178
v_add_f32 v181, v177, v179
v_sub_f32 v176, v176, v178
v_sub_f32 v177, v177, v179
v_mul_f32 v108, v138, v176
v_mul_f32 v109, v138, v177
v_fma_f32 v138, v154, v176, v180
v_fma_f32 v154, v154, v177, v181
v_lshlrev_b32 v176, 16, v110
v_and_b32 v177, 0xffff0000, v110
v_lshlrev_b32 v178, 16, v111
v_and_b32 v179, 0xffff0000, v111
v_add_f32 v180, v176, v178
v_add_f32 v181, v177, v179
v_sub_f32 v176, v176, v178
v_sub_f32 v177, v177, v179
v_mul_f32 v110, v139, v176
v_mul_f32 v111, v139, v177
v_fma_f32 v139, v155, v176, v180
v_fma_f32 v155, v155, v177, v181
v_lshlrev_b32 v176, 16, v112
v_and_b32 v177, 0xffff0000, v112
v_lshlrev_b32 v178, 16, v113
v_and_b32 v179, 0xffff0000, v113
v_add_f32 v180, v176, v178
v_add_f32 v181, v177, v179
v_sub_f32 v176, v176, v178
v_sub_f32 v177, v177, v179
v_mul_f32 v112, v140, v176
v_mul_f32 v113, v140, v177
v_fma_f32 v140, v156, v176, v180
v_fma_f32 v156, v156, v177, v181
v_lshlrev_b32 v176, 16, v114
v_and_b32 v177, 0xffff0000, v114
v_lshlrev_b32 v178, 16, v115
v_and_b32 v179, 0xffff0000, v115
v_add_f32 v180, v176, v178
v_add_f32 v181, v177, v179
v_sub_f32 v176, v176, v178
v_sub_f32 v177, v177, v179
v_mul_f32 v114, v141, v176
v_mul_f32 v115, v141, v177
v_fma_f32 v141, v157, v176, v180
v_fma_f32 v157, v157, v177, v181
L_once26:
s_nop 5
v_mul_f32 v168, v40, v224
v_mul_f32 v169, v40, v240
s_nop 1
v_fma_f32 v168, -v56, v240, v168
v_fmac_f32 v169, v56, v224
v_cvt_pk_bf16_f32 v24, v168, v169
v_mul_f32 v170, v41, v225
v_mul_f32 v171, v41, v241
v_fma_f32 v170, -v57, v241, v170
v_fmac_f32 v171, v57, v225
v_cvt_pk_bf16_f32 v25, v170, v171
v_mul_f32 v172, v42, v226
v_mul_f32 v173, v42, v242
v_fma_f32 v172, -v58, v242, v172
v_fmac_f32 v173, v58, v226
v_cvt_pk_bf16_f32 v26, v172, v173
v_mul_f32 v174, v43, v227
v_mul_f32 v175, v43, v243
v_fma_f32 v174, -v59, v243, v174
v_fmac_f32 v175, v59, v227
v_cvt_pk_bf16_f32 v27, v174, v175
v_mul_f32 v168, v44, v228
v_mul_f32 v169, v44, v244
v_fma_f32 v168, -v60, v244, v168
v_fmac_f32 v169, v60, v228
v_cvt_pk_bf16_f32 v28, v168, v169
v_mul_f32 v170, v45, v229
v_mul_f32 v171, v45, v245
v_fma_f32 v170, -v61, v245, v170
v_fmac_f32 v171, v61, v229
v_cvt_pk_bf16_f32 v29, v170, v171
v_mul_f32 v172, v46, v230
v_mul_f32 v173, v46, v246
v_fma_f32 v172, -v62, v246, v172
v_fmac_f32 v173, v62, v230
v_cvt_pk_bf16_f32 v30, v172, v173
v_mul_f32 v174, v47, v231
v_mul_f32 v175, v47, v247
v_fma_f32 v174, -v63, v247, v174
v_fmac_f32 v175, v63, v231
v_cvt_pk_bf16_f32 v31, v174, v175
v_mul_f32 v168, v48, v232
v_mul_f32 v169, v48, v248
v_fma_f32 v168, -v64, v248, v168
v_fmac_f32 v169, v64, v232
v_cvt_pk_bf16_f32 v32, v168, v169
v_mul_f32 v170, v49, v233
v_mul_f32 v171, v49, v249
v_fma_f32 v170, -v65, v249, v170
v_fmac_f32 v171, v65, v233
v_cvt_pk_bf16_f32 v33, v170, v171
v_mul_f32 v172, v50, v234
v_mul_f32 v173, v50, v250
v_fma_f32 v172, -v66, v250, v172
v_fmac_f32 v173, v66, v234
v_cvt_pk_bf16_f32 v34, v172, v173
v_mul_f32 v174, v51, v235
v_mul_f32 v175, v51, v251
v_fma_f32 v174, -v67, v251, v174
v_fmac_f32 v175, v67, v235
v_cvt_pk_bf16_f32 v35, v174, v175
v_mul_f32 v168, v52, v236
v_mul_f32 v169, v52, v252
v_fma_f32 v168, -v68, v252, v168
v_fmac_f32 v169, v68, v236
v_cvt_pk_bf16_f32 v36, v168, v169
v_mul_f32 v170, v53, v237
v_mul_f32 v171, v53, v253
v_fma_f32 v170, -v69, v253, v170
v_fmac_f32 v171, v69, v237
v_cvt_pk_bf16_f32 v37, v170, v171
v_mul_f32 v172, v54, v238
v_mul_f32 v173, v54, v254
v_fma_f32 v172, -v70, v254, v172
v_fmac_f32 v173, v70, v238
v_cvt_pk_bf16_f32 v38, v172, v173
v_mul_f32 v174, v55, v239
v_mul_f32 v175, v55, v255
v_fma_f32 v174, -v71, v255, v174
v_fmac_f32 v175, v71, v239
v_cvt_pk_bf16_f32 v39, v174, v175
v_mfma_f32_32x32x16_bf16 v[40:55], v[192:195], v[24:27], 0
v_mfma_f32_32x32x16_bf16 v[40:55], v[196:199], v[28:31], v[40:55]
v_mfma_f32_32x32x16_bf16 v[40:55], v[200:203], v[32:35], v[40:55]
v_mfma_f32_32x32x16_bf16 v[40:55], v[204:207], v[36:39], v[40:55]
v_mfma_f32_32x32x16_bf16 v[56:71], v[208:211], v[24:27], 0
v_mfma_f32_32x32x16_bf16 v[56:71], v[212:215], v[28:31], v[56:71]
v_mfma_f32_32x32x16_bf16 v[56:71], v[216:219], v[32:35], v[56:71]
v_mfma_f32_32x32x16_bf16 v[56:71], v[220:223], v[36:39], v[56:71]
s_cmp_eq_u32 s61, 2
s_cbranch_scc1 L_once27
s_waitcnt vmcnt(0)
v_lshlrev_b32 v176, 16, v116
v_and_b32 v177, 0xffff0000, v116
v_lshlrev_b32 v178, 16, v117
v_and_b32 v179, 0xffff0000, v117
v_add_f32 v180, v176, v178
v_add_f32 v181, v177, v179
v_sub_f32 v176, v176, v178
v_sub_f32 v177, v177, v179
v_mul_f32 v116, v142, v176
v_mul_f32 v117, v142, v177
v_fma_f32 v142, v158, v176, v180
v_fma_f32 v158, v158, v177, v181
v_lshlrev_b32 v176, 16, v118
v_and_b32 v177, 0xffff0000, v118
v_lshlrev_b32 v178, 16, v119
v_and_b32 v179, 0xffff0000, v119
v_add_f32 v180, v176, v178
v_add_f32 v181, v177, v179
v_sub_f32 v176, v176, v178
v_sub_f32 v177, v177, v179
v_mul_f32 v118, v143, v176
v_mul_f32 v119, v143, v177
v_fma_f32 v143, v159, v176, v180
v_fma_f32 v159, v159, v177, v181
v_lshlrev_b32 v176, 16, v120
v_and_b32 v177, 0xffff0000, v120
v_lshlrev_b32 v178, 16, v121
v_and_b32 v179, 0xffff0000, v121
v_add_f32 v180, v176, v178
v_add_f32 v181, v177, v179
v_sub_f32 v176, v176, v178
v_sub_f32 v177, v177, v179
v_mul_f32 v120, v144, v176
v_mul_f32 v121, v144, v177
v_fma_f32 v144, v160, v176, v180
v_fma_f32 v160, v160, v177, v181
v_lshlrev_b32 v176, 16, v122
v_and_b32 v177, 0xffff0000, v122
v_lshlrev_b32 v178, 16, v123
v_and_b32 v179, 0xffff0000, v123
v_add_f32 v180, v176, v178
v_add_f32 v181, v177, v179
v_sub_f32 v176, v176, v178
v_sub_f32 v177, v177, v179
v_mul_f32 v122, v145, v176
v_mul_f32 v123, v145, v177
v_fma_f32 v145, v161, v176, v180
v_fma_f32 v161, v161, v177, v181
v_lshlrev_b32 v176, 16, v124
v_and_b32 v177, 0xffff0000, v124
v_lshlrev_b32 v178, 16, v125
v_and_b32 v179, 0xffff0000, v125
v_add_f32 v180, v176, v178
v_add_f32 v181, v177, v179
v_sub_f32 v176, v176, v178
v_sub_f32 v177, v177, v179
v_mul_f32 v124, v146, v176
v_mul_f32 v125, v146, v177
v_fma_f32 v146, v162, v176, v180
v_fma_f32 v162, v162, v177, v181
v_lshlrev_b32 v176, 16, v126
v_and_b32 v177, 0xffff0000, v126
v_lshlrev_b32 v178, 16, v127
v_and_b32 v179, 0xffff0000, v127
v_add_f32 v180, v176, v178
v_add_f32 v181, v177, v179
v_sub_f32 v176, v176, v178
v_sub_f32 v177, v177, v179
v_mul_f32 v126, v147, v176
v_mul_f32 v127, v147, v177
v_fma_f32 v147, v163, v176, v180
v_fma_f32 v163, v163, v177, v181
L_once27:
L_lc28:
ds_read_b128 v[186:189], v184
s_waitcnt lgkmcnt(0)
v_min3_u32 v186, v186, v187, v188
v_min_u32 v186, v186, v189
s_nop 0
v_readfirstlane_b32 s92, v186
s_nop 0
s_cmp_ge_u32 s92, 4
s_cbranch_scc1 L_lcd29
s_sleep 1
s_branch L_lc28
L_lcd29:
s_cmp_eq_u32 s61, 2
s_cbranch_scc1 L_nwr25
ds_write_b128 v16, v[40:43] offset:0
ds_write_b128 v16, v[44:47] offset:1024
ds_write_b128 v16, v[48:51] offset:2048
ds_write_b128 v16, v[52:55] offset:3072
ds_write_b128 v16, v[56:59] offset:4096
ds_write_b128 v16, v[60:63] offset:5120
ds_write_b128 v16, v[64:67] offset:6144
ds_write_b128 v16, v[68:71] offset:7168
s_cmp_eq_u32 s61, 0
s_cbranch_scc1 L_nwr25
s_mov_b32 s61, 2
s_mov_b32 s64, 0
s_branch L_fft24
L_nwr25:
v_lshlrev_b32 v176, 16, v128
v_and_b32 v177, 0xffff0000, v128
v_lshlrev_b32 v178, 16, v129
v_and_b32 v179, 0xffff0000, v129
v_add_f32 v180, v176, v178
v_add_f32 v181, v177, v179
v_sub_f32 v176, v176, v178
v_sub_f32 v177, v177, v179
v_mul_f32 v128, v148, v176
v_mul_f32 v129, v148, v177
v_fma_f32 v148, v164, v176, v180
v_fma_f32 v164, v164, v177, v181
v_lshlrev_b32 v176, 16, v130
v_and_b32 v177, 0xffff0000, v130
v_lshlrev_b32 v178, 16, v131
v_and_b32 v179, 0xffff0000, v131
v_add_f32 v180, v176, v178
v_add_f32 v181, v177, v179
v_sub_f32 v176, v176, v178
v_sub_f32 v177, v177, v179
v_mul_f32 v130, v149, v176
v_mul_f32 v131, v149, v177
v_fma_f32 v149, v165, v176, v180
v_fma_f32 v165, v165, v177, v181
s_waitcnt lgkmcnt(0)
v_mov_b32 v190, 5
s_mov_b64 exec, 1
ds_write_b32 v185, v190
s_mov_b64 exec, -1
v_lshlrev_b32 v176, 16, v132
v_and_b32 v177, 0xffff0000, v132
v_lshlrev_b32 v178, 16, v133
v_and_b32 v179, 0xffff0000, v133
v_add_f32 v180, v176, v178
v_add_f32 v181, v177, v179
v_sub_f32 v176, v176, v178
v_sub_f32 v177, v177, v179
v_mul_f32 v132, v150, v176
v_mul_f32 v133, v150, v177
v_fma_f32 v150, v166, v176, v180
v_fma_f32 v166, v166, v177, v181
v_lshlrev_b32 v176, 16, v134
v_and_b32 v177, 0xffff0000, v134
v_lshlrev_b32 v178, 16, v135
v_and_b32 v179, 0xffff0000, v135
v_add_f32 v180, v176, v178
v_add_f32 v181, v177, v179
v_sub_f32 v176, v176, v178
v_sub_f32 v177, v177, v179
v_mul_f32 v134, v151, v176
v_mul_f32 v135, v151, v177
v_fma_f32 v151, v167, v176, v180
v_fma_f32 v167, v167, v177, v181
v_mul_f32 v168, v152, v56
v_mul_f32 v56, v136, v56
v_fmac_f32 v56, v152, v40
v_fma_f32 v40, v136, v40, -v168
v_mul_f32 v169, v153, v57
v_mul_f32 v57, v137, v57
v_fmac_f32 v57, v153, v41
v_fma_f32 v41, v137, v41, -v169
v_mul_f32 v168, v154, v58
v_mul_f32 v58, v138, v58
v_fmac_f32 v58, v154, v42
v_fma_f32 v42, v138, v42, -v168
v_mul_f32 v169, v155, v59
v_mul_f32 v59, v139, v59
v_fmac_f32 v59, v155, v43
v_fma_f32 v43, v139, v43, -v169
v_mul_f32 v168, v156, v60
v_mul_f32 v60, v140, v60
v_fmac_f32 v60, v156, v44
v_fma_f32 v44, v140, v44, -v168
v_mul_f32 v169, v157, v61
v_mul_f32 v61, v141, v61
v_fmac_f32 v61, v157, v45
v_fma_f32 v45, v141, v45, -v169
L_lc30:
ds_read_b128 v[186:189], v184
s_waitcnt lgkmcnt(0)
v_min3_u32 v186, v186, v187, v188
v_min_u32 v186, v186, v189
s_nop 0
v_readfirstlane_b32 s92, v186
s_nop 0
s_cmp_ge_u32 s92, 5
s_cbranch_scc1 L_lcd31
s_sleep 1
s_branch L_lc30
L_lcd31:
ds_read_b128 v[72:75], v17 offset:0
ds_read_b128 v[76:79], v17 offset:1024
ds_read_b128 v[80:83], v17 offset:2048
ds_read_b128 v[84:87], v17 offset:3072
ds_read_b128 v[88:91], v17 offset:4096
ds_read_b128 v[92:95], v17 offset:5120
ds_read_b128 v[96:99], v17 offset:6144
ds_read_b128 v[100:103], v17 offset:7168
v_mul_f32 v168, v158, v62
v_mul_f32 v62, v142, v62
v_fmac_f32 v62, v158, v46
v_fma_f32 v46, v142, v46, -v168
v_mul_f32 v169, v159, v63
v_mul_f32 v63, v143, v63
v_fmac_f32 v63, v159, v47
v_fma_f32 v47, v143, v47, -v169
v_mul_f32 v168, v160, v64
v_mul_f32 v64, v144, v64
v_fmac_f32 v64, v160, v48
v_fma_f32 v48, v144, v48, -v168
v_mul_f32 v169, v161, v65
v_mul_f32 v65, v145, v65
v_fmac_f32 v65, v161, v49
v_fma_f32 v49, v145, v49, -v169
v_mul_f32 v168, v162, v66
v_mul_f32 v66, v146, v66
v_fmac_f32 v66, v162, v50
v_fma_f32 v50, v146, v50, -v168
v_mul_f32 v169, v163, v67
v_mul_f32 v67, v147, v67
v_fmac_f32 v67, v163, v51
v_fma_f32 v51, v147, v51, -v169
v_mul_f32 v168, v164, v68
v_mul_f32 v68, v148, v68
v_fmac_f32 v68, v164, v52
v_fma_f32 v52, v148, v52, -v168
v_mul_f32 v169, v165, v69
v_mul_f32 v69, v149, v69
v_fmac_f32 v69, v165, v53
v_fma_f32 v53, v149, v53, -v169
v_mul_f32 v168, v166, v70
v_mul_f32 v70, v150, v70
v_fmac_f32 v70, v166, v54
v_fma_f32 v54, v150, v54, -v168
v_mul_f32 v169, v167, v71
v_mul_f32 v71, v151, v71
v_fmac_f32 v71, v167, v55
v_fma_f32 v55, v151, v55, -v169
s_waitcnt lgkmcnt(0)
v_mov_b32 v190, 6
s_mov_b64 exec, 1
ds_write_b32 v185, v190
s_mov_b64 exec, -1
v_fma_f32 v40, -v104, v88, v40
v_fmac_f32 v56, v104, v72
v_fma_f32 v40, -v105, v72, v40
v_fma_f32 v56, -v105, v88, v56
v_cvt_pk_bf16_f32 v24, v56, v40
v_fma_f32 v41, -v106, v89, v41
v_fmac_f32 v57, v106, v73
v_fma_f32 v41, -v107, v73, v41
v_fma_f32 v57, -v107, v89, v57
v_cvt_pk_bf16_f32 v25, v57, v41
v_fma_f32 v42, -v108, v90, v42
v_fmac_f32 v58, v108, v74
v_fma_f32 v42, -v109, v74, v42
v_fma_f32 v58, -v109, v90, v58
v_cvt_pk_bf16_f32 v26, v58, v42
v_fma_f32 v43, -v110, v91, v43
v_fmac_f32 v59, v110, v75
v_fma_f32 v43, -v111, v75, v43
v_fma_f32 v59, -v111, v91, v59
v_cvt_pk_bf16_f32 v27, v59, v43
v_fma_f32 v44, -v112, v92, v44
v_fmac_f32 v60, v112, v76
v_fma_f32 v44, -v113, v76, v44
v_fma_f32 v60, -v113, v92, v60
v_cvt_pk_bf16_f32 v28, v60, v44
v_fma_f32 v45, -v114, v93, v45
v_fmac_f32 v61, v114, v77
v_fma_f32 v45, -v115, v77, v45
v_fma_f32 v61, -v115, v93, v61
v_cvt_pk_bf16_f32 v29, v61, v45
v_fma_f32 v46, -v116, v94, v46
v_fmac_f32 v62, v116, v78
v_fma_f32 v46, -v117, v78, v46
v_fma_f32 v62, -v117, v94, v62
v_cvt_pk_bf16_f32 v30, v62, v46
v_fma_f32 v47, -v118, v95, v47
v_fmac_f32 v63, v118, v79
v_fma_f32 v47, -v119, v79, v47
v_fma_f32 v63, -v119, v95, v63
v_cvt_pk_bf16_f32 v31, v63, v47
v_fma_f32 v48, -v120, v96, v48
v_fmac_f32 v64, v120, v80
v_fma_f32 v48, -v121, v80, v48
v_fma_f32 v64, -v121, v96, v64
v_cvt_pk_bf16_f32 v32, v64, v48
v_fma_f32 v49, -v122, v97, v49
v_fmac_f32 v65, v122, v81
v_fma_f32 v49, -v123, v81, v49
v_fma_f32 v65, -v123, v97, v65
v_cvt_pk_bf16_f32 v33, v65, v49
v_fma_f32 v50, -v124, v98, v50
v_fmac_f32 v66, v124, v82
v_fma_f32 v50, -v125, v82, v50
v_fma_f32 v66, -v125, v98, v66
v_cvt_pk_bf16_f32 v34, v66, v50
v_fma_f32 v51, -v126, v99, v51
v_fmac_f32 v67, v126, v83
v_fma_f32 v51, -v127, v83, v51
v_fma_f32 v67, -v127, v99, v67
v_cvt_pk_bf16_f32 v35, v67, v51
v_fma_f32 v52, -v128, v100, v52
v_fmac_f32 v68, v128, v84
v_fma_f32 v52, -v129, v84, v52
v_fma_f32 v68, -v129, v100, v68
v_cvt_pk_bf16_f32 v36, v68, v52
v_fma_f32 v53, -v130, v101, v53
v_fmac_f32 v69, v130, v85
v_fma_f32 v53, -v131, v85, v53
v_fma_f32 v69, -v131, v101, v69
v_cvt_pk_bf16_f32 v37, v69, v53
v_fma_f32 v54, -v132, v102, v54
v_fmac_f32 v70, v132, v86
v_fma_f32 v54, -v133, v86, v54
v_fma_f32 v70, -v133, v102, v70
v_cvt_pk_bf16_f32 v38, v70, v54
v_fma_f32 v55, -v134, v103, v55
v_fmac_f32 v71, v134, v87
v_fma_f32 v55, -v135, v87, v55
v_fma_f32 v71, -v135, v103, v71
v_cvt_pk_bf16_f32 v39, v71, v55
v_mfma_f32_32x32x16_bf16 v[40:55], v[24:27], v[192:195], 0
v_mfma_f32_32x32x16_bf16 v[40:55], v[28:31], v[196:199], v[40:55]
v_mfma_f32_32x32x16_bf16 v[40:55], v[32:35], v[200:203], v[40:55]
v_mfma_f32_32x32x16_bf16 v[40:55], v[36:39], v[204:207], v[40:55]
v_mfma_f32_32x32x16_bf16 v[56:71], v[24:27], v[208:211], 0
v_mfma_f32_32x32x16_bf16 v[56:71], v[28:31], v[212:215], v[56:71]
v_mfma_f32_32x32x16_bf16 v[56:71], v[32:35], v[216:219], v[56:71]
v_mfma_f32_32x32x16_bf16 v[56:71], v[36:39], v[220:223], v[56:71]
s_nop 7
v_mul_f32 v168, v40, v224
v_mul_f32 v169, v40, v240
s_nop 1
v_fma_f32 v168, -v56, v240, v168
v_fmac_f32 v169, v56, v224
v_cvt_pk_bf16_f32 v24, v168, v169
v_mul_f32 v170, v41, v225
v_mul_f32 v171, v41, v241
v_fma_f32 v170, -v57, v241, v170
v_fmac_f32 v171, v57, v225
v_cvt_pk_bf16_f32 v25, v170, v171
v_mul_f32 v172, v42, v226
v_mul_f32 v173, v42, v242
v_fma_f32 v172, -v58, v242, v172
v_fmac_f32 v173, v58, v226
v_cvt_pk_bf16_f32 v26, v172, v173
v_mul_f32 v174, v43, v227
v_mul_f32 v175, v43, v243
v_fma_f32 v174, -v59, v243, v174
v_fmac_f32 v175, v59, v227
v_cvt_pk_bf16_f32 v27, v174, v175
v_mul_f32 v168, v44, v228
v_mul_f32 v169, v44, v244
v_fma_f32 v168, -v60, v244, v168
v_fmac_f32 v169, v60, v228
v_cvt_pk_bf16_f32 v28, v168, v169
v_mul_f32 v170, v45, v229
v_mul_f32 v171, v45, v245
v_fma_f32 v170, -v61, v245, v170
v_fmac_f32 v171, v61, v229
v_cvt_pk_bf16_f32 v29, v170, v171
v_mul_f32 v172, v46, v230
v_mul_f32 v173, v46, v246
v_fma_f32 v172, -v62, v246, v172
v_fmac_f32 v173, v62, v230
v_cvt_pk_bf16_f32 v30, v172, v173
v_mul_f32 v174, v47, v231
v_mul_f32 v175, v47, v247
v_fma_f32 v174, -v63, v247, v174
v_fmac_f32 v175, v63, v231
v_cvt_pk_bf16_f32 v31, v174, v175
v_mul_f32 v168, v48, v232
v_mul_f32 v169, v48, v248
v_fma_f32 v168, -v64, v248, v168
v_fmac_f32 v169, v64, v232
v_cvt_pk_bf16_f32 v32, v168, v169
v_mul_f32 v170, v49, v233
v_mul_f32 v171, v49, v249
v_fma_f32 v170, -v65, v249, v170
v_fmac_f32 v171, v65, v233
v_cvt_pk_bf16_f32 v33, v170, v171
v_mul_f32 v172, v50, v234
v_mul_f32 v173, v50, v250
v_fma_f32 v172, -v66, v250, v172
v_fmac_f32 v173, v66, v234
v_cvt_pk_bf16_f32 v34, v172, v173
v_mul_f32 v174, v51, v235
v_mul_f32 v175, v51, v251
v_fma_f32 v174, -v67, v251, v174
v_fmac_f32 v175, v67, v235
v_cvt_pk_bf16_f32 v35, v174, v175
v_mul_f32 v168, v52, v236
v_mul_f32 v169, v52, v252
v_fma_f32 v168, -v68, v252, v168
v_fmac_f32 v169, v68, v236
v_cvt_pk_bf16_f32 v36, v168, v169
v_mul_f32 v170, v53, v237
v_mul_f32 v171, v53, v253
v_fma_f32 v170, -v69, v253, v170
v_fmac_f32 v171, v69, v237
v_cvt_pk_bf16_f32 v37, v170, v171
v_mul_f32 v172, v54, v238
v_mul_f32 v173, v54, v254
v_fma_f32 v172, -v70, v254, v172
v_fmac_f32 v173, v70, v238
v_cvt_pk_bf16_f32 v38, v172, v173
v_mul_f32 v174, v55, v239
v_mul_f32 v175, v55, v255
v_fma_f32 v174, -v71, v255, v174
v_fmac_f32 v175, v71, v239
v_cvt_pk_bf16_f32 v39, v174, v175
v_mfma_f32_32x32x16_bf16 v[40:55], v[192:195], v[24:27], 0
v_mfma_f32_32x32x16_bf16 v[40:55], v[196:199], v[28:31], v[40:55]
v_mfma_f32_32x32x16_bf16 v[40:55], v[200:203], v[32:35], v[40:55]
v_mfma_f32_32x32x16_bf16 v[40:55], v[204:207], v[36:39], v[40:55]
v_mfma_f32_32x32x16_bf16 v[56:71], v[208:211], v[24:27], 0
v_mfma_f32_32x32x16_bf16 v[56:71], v[212:215], v[28:31], v[56:71]
v_mfma_f32_32x32x16_bf16 v[56:71], v[216:219], v[32:35], v[56:71]
v_mfma_f32_32x32x16_bf16 v[56:71], v[220:223], v[36:39], v[56:71]
s_lshr_b32 s64, s62, 16
L_lc32:
ds_read_b128 v[186:189], v184
s_waitcnt lgkmcnt(0)
v_min3_u32 v186, v186, v187, v188
v_min_u32 v186, v186, v189
s_nop 0
v_readfirstlane_b32 s92, v186
s_nop 0
s_cmp_ge_u32 s92, 6
s_cbranch_scc1 L_lcd33
s_sleep 1
s_branch L_lc32
L_lcd33:
s_nop 1
v_cvt_pk_bf16_f32 v24, v40, v56
v_xor_b32 v24, s64, v24
v_cvt_pk_bf16_f32 v25, v41, v57
v_xor_b32 v25, s64, v25
v_cvt_pk_bf16_f32 v26, v42, v58
v_xor_b32 v26, s64, v26
v_cvt_pk_bf16_f32 v27, v43, v59
v_xor_b32 v27, s64, v27
ds_write_b128 v15, v[24:27] offset:0
v_cvt_pk_bf16_f32 v28, v44, v60
v_xor_b32 v28, s64, v28
v_cvt_pk_bf16_f32 v29, v45, v61
v_xor_b32 v29, s64, v29
v_cvt_pk_bf16_f32 v30, v46, v62
v_xor_b32 v30, s64, v30
v_cvt_pk_bf16_f32 v31, v47, v63
v_xor_b32 v31, s64, v31
ds_write_b128 v15, v[28:31] offset:4096
v_cvt_pk_bf16_f32 v32, v48, v64
v_xor_b32 v32, s64, v32
v_cvt_pk_bf16_f32 v33, v49, v65
v_xor_b32 v33, s64, v33
v_cvt_pk_bf16_f32 v34, v50, v66
v_xor_b32 v34, s64, v34
v_cvt_pk_bf16_f32 v35, v51, v67
v_xor_b32 v35, s64, v35
ds_write_b128 v15, v[32:35] offset:8192
v_cvt_pk_bf16_f32 v36, v52, v68
v_xor_b32 v36, s64, v36
v_cvt_pk_bf16_f32 v37, v53, v69
v_xor_b32 v37, s64, v37
v_cvt_pk_bf16_f32 v38, v54, v70
v_xor_b32 v38, s64, v38
v_cvt_pk_bf16_f32 v39, v55, v71
v_xor_b32 v39, s64, v39
ds_write_b128 v15, v[36:39] offset:12288
s_waitcnt lgkmcnt(0)
v_mov_b32 v190, 7
s_mov_b64 exec, 1
ds_write_b32 v185, v190
s_mov_b64 exec, -1
L_lc34:
ds_read_b128 v[186:189], v184
s_waitcnt lgkmcnt(0)
v_min3_u32 v186, v186, v187, v188
v_min_u32 v186, v186, v189
s_nop 0
v_readfirstlane_b32 s92, v186
s_nop 0
s_cmp_ge_u32 s92, 7
s_cbranch_scc1 L_lcd35
s_sleep 1
s_branch L_lc34
L_lcd35:
ds_read_b128 v[24:27], v18 offset:0
ds_read_b128 v[28:31], v18 offset:1024
ds_read_b128 v[32:35], v18 offset:2048
ds_read_b128 v[36:39], v18 offset:3072
s_mov_b32 s64, 0
s_waitcnt lgkmcnt(3)
buffer_store_dwordx4 v[24:27], v14, s[52:55], s64 offen sc1
s_mov_b32 s64, 262144
s_waitcnt lgkmcnt(2)
buffer_store_dwordx4 v[28:31], v14, s[52:55], s64 offen sc1
s_mov_b32 s64, 524288
s_waitcnt lgkmcnt(1)
buffer_store_dwordx4 v[32:35], v14, s[52:55], s64 offen sc1
s_mov_b32 s64, 786432
s_waitcnt lgkmcnt(0)
buffer_store_dwordx4 v[36:39], v14, s[52:55], s64 offen sc1
s_lshl_b32 s64, s67, 14
s_add_u32 s40, s28, s64
s_addc_u32 s41, s29, 0
s_mov_b32 s42, 16384
s_mov_b32 s43, 0x20000
v_and_b32 v8, 31, v1
v_lshrrev_b32 v9, 5, v1
v_lshlrev_b32 v14, 2, v8
v_lshl_add_u32 v14, v9, 9, v14
s_mov_b32 s64, 0x35000000
v_mul_f32 v224, s64, v224
v_mul_f32 v225, s64, v225
v_mul_f32 v226, s64, v226
v_mul_f32 v227, s64, v227
v_mul_f32 v228, s64, v228
v_mul_f32 v229, s64, v229
v_mul_f32 v230, s64, v230
v_mul_f32 v231, s64, v231
v_mul_f32 v232, s64, v232
v_mul_f32 v233, s64, v233
v_mul_f32 v234, s64, v234
v_mul_f32 v235, s64, v235
v_mul_f32 v236, s64, v236
v_mul_f32 v237, s64, v237
v_mul_f32 v238, s64, v238
v_mul_f32 v239, s64, v239
v_mul_f32 v240, s64, v240
v_mul_f32 v241, s64, v241
v_mul_f32 v242, s64, v242
v_mul_f32 v243, s64, v243
v_mul_f32 v244, s64, v244
v_mul_f32 v245, s64, v245
v_mul_f32 v246, s64, v246
v_mul_f32 v247, s64, v247
v_mul_f32 v248, s64, v248
v_mul_f32 v249, s64, v249
v_mul_f32 v250, s64, v250
v_mul_f32 v251, s64, v251
v_mul_f32 v252, s64, v252
v_mul_f32 v253, s64, v253
v_mul_f32 v254, s64, v254
v_mul_f32 v255, s64, v255
s_waitcnt vmcnt(0)
v_mov_b32 v190, 8
s_mov_b64 exec, 1
ds_write_b32 v185, v190
s_mov_b64 exec, -1
s_cmp_lg_u32 s66, 0
s_cbranch_scc1 L_ph36
L_lc37:
ds_read_b128 v[186:189], v184
s_waitcnt lgkmcnt(0)
v_min3_u32 v186, v186, v187, v188
v_min_u32 v186, v186, v189
s_nop 0
v_readfirstlane_b32 s92, v186
s_nop 0
s_cmp_ge_u32 s92, 8
s_cbranch_scc1 L_lcd38
s_sleep 1
s_branch L_lc37
L_lcd38:
s_and_b32 s64, s2, 15
s_lshl_b32 s65, s64, 7
s_add_u32 s65, s65, 6144
s_add_u32 s90, s32, s65
s_addc_u32 s91, s33, 0
s_mov_b32 s18, 1
s_atomic_add s18, s[90:91], 0x0 glc
L_ph36:
s_cmp_lg_u32 s66, 0
s_cbranch_scc1 L_sg39
s_and_b32 s64, s2, 15
s_lshl_b32 s64, s64, 2
s_add_u32 s64, s64, 548864
s_add_u32 s4, s32, s64
s_addc_u32 s5, s33, 0
s_waitcnt lgkmcnt(0)
s_cmp_lg_u32 s18, 15
s_cbranch_scc1 L_sg39
s_atomic_swap s37, s[4:5], 0x0
s_atomic_swap s37, s[4:5], 0x80
s_atomic_swap s37, s[4:5], 0x100
s_atomic_swap s37, s[4:5], 0x180
s_atomic_swap s37, s[4:5], 0x200
s_atomic_swap s37, s[4:5], 0x280
s_atomic_swap s37, s[4:5], 0x300
s_atomic_swap s37, s[4:5], 0x380
s_atomic_swap s37, s[4:5], 0x400
s_atomic_swap s37, s[4:5], 0x480
s_atomic_swap s37, s[4:5], 0x500
s_atomic_swap s37, s[4:5], 0x580
s_atomic_swap s37, s[4:5], 0x600
s_atomic_swap s37, s[4:5], 0x680
s_atomic_swap s37, s[4:5], 0x700
s_atomic_swap s37, s[4:5], 0x780
s_atomic_swap s37, s[4:5], 0x800
s_atomic_swap s37, s[4:5], 0x880
s_atomic_swap s37, s[4:5], 0x900
s_atomic_swap s37, s[4:5], 0x980
s_atomic_swap s37, s[4:5], 0xa00
s_atomic_swap s37, s[4:5], 0xa80
s_atomic_swap s37, s[4:5], 0xb00
s_atomic_swap s37, s[4:5], 0xb80
s_atomic_swap s37, s[4:5], 0xc00
s_atomic_swap s37, s[4:5], 0xc80
s_atomic_swap s37, s[4:5], 0xd00
s_atomic_swap s37, s[4:5], 0xd80
s_atomic_swap s37, s[4:5], 0xe00
s_atomic_swap s37, s[4:5], 0xe80
s_atomic_swap s37, s[4:5], 0xf00
s_atomic_swap s37, s[4:5], 0xf80
s_waitcnt lgkmcnt(0)
L_sg39:
s_cmp_lg_u32 s66, 0
s_cbranch_scc1 L_ph40
s_and_b32 s64, s2, 31
s_lshl_b32 s64, s64, 7
s_add_u32 s64, s64, 548864
s_add_u32 s90, s32, s64
s_addc_u32 s91, s33, 0
s_mov_b32 s64, s37
s_mov_b32 s65, s37
s_mov_b32 s92, 0
s_branch L_sp41
L_nok42:
s_add_u32 s92, s92, 1
s_cmp_ge_u32 s92, 200000
s_cbranch_scc1 L_ph40
s_sleep 10
L_sp41:
s_load_dwordx16 s[4:19], s[90:91], 0x0 glc
s_waitcnt lgkmcnt(0)
s_cmp_eq_u64 s[4:5], s[64:65]
s_cbranch_scc0 L_nok42
s_cmp_eq_u64 s[6:7], s[64:65]
s_cbranch_scc0 L_nok42
s_cmp_eq_u64 s[8:9], s[64:65]
s_cbranch_scc0 L_nok42
s_cmp_eq_u64 s[10:11], s[64:65]
s_cbranch_scc0 L_nok42
s_cmp_eq_u64 s[12:13], s[64:65]
s_cbranch_scc0 L_nok42
s_cmp_eq_u64 s[14:15], s[64:65]
s_cbranch_scc0 L_nok42
s_cmp_eq_u64 s[16:17], s[64:65]
s_cbranch_scc0 L_nok42
s_cmp_eq_u64 s[18:19], s[64:65]
s_cbranch_scc0 L_nok42
L_ph40:
v_mov_b32 v190, 9
s_mov_b64 exec, 1
ds_write_b32 v185, v190
s_mov_b64 exec, -1
L_lc43:
ds_read_b128 v[186:189], v184
s_waitcnt lgkmcnt(0)
v_min3_u32 v186, v186, v187, v188
v_min_u32 v186, v186, v189
s_nop 0
v_readfirstlane_b32 s92, v186
s_nop 0
s_cmp_ge_u32 s92, 9
s_cbranch_scc1 L_lcd44
s_sleep 1
s_branch L_lc43
L_lcd44:
s_setprio 0
v_add_u32 v191, -16, v184
L_lc45:
ds_read_b128 v[186:189], v191
s_waitcnt lgkmcnt(0)
v_min3_u32 v186, v186, v187, v188
v_min_u32 v186, v186, v189
s_nop 0
v_readfirstlane_b32 s92, v186
s_nop 0
s_cmp_ge_u32 s92, 11
s_cbranch_scc1 L_lcd46
s_sleep 1
s_branch L_lc45
L_lcd46:
s_mov_b32 m0, s68
s_nop 0
buffer_load_dwordx4 v7, s[44:47], 0 offen offset:0 sc1 lds
buffer_load_dwordx4 v7, s[44:47], 0 offen offset:1024 sc1 lds
buffer_load_dwordx4 v7, s[44:47], 0 offen offset:2048 sc1 lds
buffer_load_dwordx4 v7, s[44:47], 0 offen offset:3072 sc1 lds
s_waitcnt vmcnt(0)
v_mov_b32 v190, 10
s_mov_b64 exec, 1
ds_write_b32 v185, v190
s_mov_b64 exec, -1
L_lc47:
ds_read_b128 v[186:189], v184
s_waitcnt lgkmcnt(0)
v_min3_u32 v186, v186, v187, v188
v_min_u32 v186, v186, v189
s_nop 0
v_readfirstlane_b32 s92, v186
s_nop 0
s_cmp_ge_u32 s92, 10
s_cbranch_scc1 L_lcd48
s_sleep 1
s_branch L_lc47
L_lcd48:
ds_read_b32 v24, v4 offset:0
ds_read_b32 v25, v4 offset:1024
ds_read_b32 v26, v4 offset:2048
ds_read_b32 v27, v4 offset:3072
ds_read_b32 v28, v4 offset:8192
ds_read_b32 v29, v4 offset:9216
ds_read_b32 v30, v4 offset:10240
ds_read_b32 v31, v4 offset:11264
ds_read_b32 v32, v6 offset:0
ds_read_b32 v33, v5 offset:10240
ds_read_b32 v34, v5 offset:9216
ds_read_b32 v35, v5 offset:8192
ds_read_b32 v36, v5 offset:3072
ds_read_b32 v37, v5 offset:2048
ds_read_b32 v38, v5 offset:1024
ds_read_b32 v39, v5 offset:0
s_waitcnt lgkmcnt(0)
v_mfma_f32_32x32x16_bf16 v[40:55], v[24:27], v[192:195], 0
v_mfma_f32_32x32x16_bf16 v[40:55], v[28:31], v[196:199], v[40:55]
v_mfma_f32_32x32x16_bf16 v[40:55], v[32:35], v[200:203], v[40:55]
v_mfma_f32_32x32x16_bf16 v[40:55], v[36:39], v[204:207], v[40:55]
v_mfma_f32_32x32x16_bf16 v[56:71], v[24:27], v[208:211], 0
v_mfma_f32_32x32x16_bf16 v[56:71], v[28:31], v[212:215], v[56:71]
v_mfma_f32_32x32x16_bf16 v[56:71], v[32:35], v[216:219], v[56:71]
v_mfma_f32_32x32x16_bf16 v[56:71], v[36:39], v[220:223], v[56:71]
s_nop 7
v_mul_f32 v168, v40, v224
v_mul_f32 v169, v40, v240
s_nop 1
v_fma_f32 v168, -v56, v240, v168
v_fmac_f32 v169, v56, v224
v_cvt_pk_bf16_f32 v24, v168, v169
v_mul_f32 v170, v41, v225
v_mul_f32 v171, v41, v241
v_fma_f32 v170, -v57, v241, v170
v_fmac_f32 v171, v57, v225
v_cvt_pk_bf16_f32 v25, v170, v171
v_mul_f32 v172, v42, v226
v_mul_f32 v173, v42, v242
v_fma_f32 v172, -v58, v242, v172
v_fmac_f32 v173, v58, v226
v_cvt_pk_bf16_f32 v26, v172, v173
v_mul_f32 v174, v43, v227
v_mul_f32 v175, v43, v243
v_fma_f32 v174, -v59, v243, v174
v_fmac_f32 v175, v59, v227
v_cvt_pk_bf16_f32 v27, v174, v175
v_mul_f32 v168, v44, v228
v_mul_f32 v169, v44, v244
v_fma_f32 v168, -v60, v244, v168
v_fmac_f32 v169, v60, v228
v_cvt_pk_bf16_f32 v28, v168, v169
v_mul_f32 v170, v45, v229
v_mul_f32 v171, v45, v245
v_fma_f32 v170, -v61, v245, v170
v_fmac_f32 v171, v61, v229
v_cvt_pk_bf16_f32 v29, v170, v171
v_mul_f32 v172, v46, v230
v_mul_f32 v173, v46, v246
v_fma_f32 v172, -v62, v246, v172
v_fmac_f32 v173, v62, v230
v_cvt_pk_bf16_f32 v30, v172, v173
v_mul_f32 v174, v47, v231
v_mul_f32 v175, v47, v247
v_fma_f32 v174, -v63, v247, v174
v_fmac_f32 v175, v63, v231
v_cvt_pk_bf16_f32 v31, v174, v175
v_mul_f32 v168, v48, v232
v_mul_f32 v169, v48, v248
v_fma_f32 v168, -v64, v248, v168
v_fmac_f32 v169, v64, v232
v_cvt_pk_bf16_f32 v32, v168, v169
v_mul_f32 v170, v49, v233
v_mul_f32 v171, v49, v249
v_fma_f32 v170, -v65, v249, v170
v_fmac_f32 v171, v65, v233
v_cvt_pk_bf16_f32 v33, v170, v171
v_mul_f32 v172, v50, v234
v_mul_f32 v173, v50, v250
v_fma_f32 v172, -v66, v250, v172
v_fmac_f32 v173, v66, v234
v_cvt_pk_bf16_f32 v34, v172, v173
v_mul_f32 v174, v51, v235
v_mul_f32 v175, v51, v251
v_fma_f32 v174, -v67, v251, v174
v_fmac_f32 v175, v67, v235
v_cvt_pk_bf16_f32 v35, v174, v175
v_mul_f32 v168, v52, v236
v_mul_f32 v169, v52, v252
v_fma_f32 v168, -v68, v252, v168
v_fmac_f32 v169, v68, v236
v_cvt_pk_bf16_f32 v36, v168, v169
v_mul_f32 v170, v53, v237
v_mul_f32 v171, v53, v253
v_fma_f32 v170, -v69, v253, v170
v_fmac_f32 v171, v69, v237
v_cvt_pk_bf16_f32 v37, v170, v171
v_mul_f32 v172, v54, v238
v_mul_f32 v173, v54, v254
v_fma_f32 v172, -v70, v254, v172
v_fmac_f32 v173, v70, v238
v_cvt_pk_bf16_f32 v38, v172, v173
v_mul_f32 v174, v55, v239
v_mul_f32 v175, v55, v255
v_fma_f32 v174, -v71, v255, v174
v_fmac_f32 v175, v71, v239
v_cvt_pk_bf16_f32 v39, v174, v175
v_mfma_f32_32x32x16_bf16 v[40:55], v[192:195], v[24:27], 0
v_mfma_f32_32x32x16_bf16 v[40:55], v[196:199], v[28:31], v[40:55]
v_mfma_f32_32x32x16_bf16 v[40:55], v[200:203], v[32:35], v[40:55]
v_mfma_f32_32x32x16_bf16 v[40:55], v[204:207], v[36:39], v[40:55]
v_mfma_f32_32x32x16_bf16 v[56:71], v[208:211], v[24:27], 0
v_mfma_f32_32x32x16_bf16 v[56:71], v[212:215], v[28:31], v[56:71]
v_mfma_f32_32x32x16_bf16 v[56:71], v[216:219], v[32:35], v[56:71]
v_mfma_f32_32x32x16_bf16 v[56:71], v[220:223], v[36:39], v[56:71]
s_movk_i32 s64, 0x2000
s_nop 10
v_cvt_pk_bf16_f32 v73, v56, v40
v_lshlrev_b32 v72, 16, v73
v_and_b32 v73, 0xffff0000, v73
buffer_store_dword v72, v14, s[40:43], 0 offen offset:0 nt
buffer_store_dword v73, v14, s[40:43], s64 offen offset:0 nt
v_cvt_pk_bf16_f32 v75, v57, v41
v_lshlrev_b32 v74, 16, v75
v_and_b32 v75, 0xffff0000, v75
buffer_store_dword v74, v14, s[40:43], 0 offen offset:128 nt
buffer_store_dword v75, v14, s[40:43], s64 offen offset:128 nt
v_cvt_pk_bf16_f32 v77, v58, v42
v_lshlrev_b32 v76, 16, v77
v_and_b32 v77, 0xffff0000, v77
buffer_store_dword v76, v14, s[40:43], 0 offen offset:256 nt
buffer_store_dword v77, v14, s[40:43], s64 offen offset:256 nt
v_cvt_pk_bf16_f32 v79, v59, v43
v_lshlrev_b32 v78, 16, v79
v_and_b32 v79, 0xffff0000, v79
buffer_store_dword v78, v14, s[40:43], 0 offen offset:384 nt
buffer_store_dword v79, v14, s[40:43], s64 offen offset:384 nt
v_cvt_pk_bf16_f32 v81, v60, v44
v_lshlrev_b32 v80, 16, v81
v_and_b32 v81, 0xffff0000, v81
buffer_store_dword v80, v14, s[40:43], 0 offen offset:1024 nt
buffer_store_dword v81, v14, s[40:43], s64 offen offset:1024 nt
v_cvt_pk_bf16_f32 v83, v61, v45
v_lshlrev_b32 v82, 16, v83
v_and_b32 v83, 0xffff0000, v83
buffer_store_dword v82, v14, s[40:43], 0 offen offset:1152 nt
buffer_store_dword v83, v14, s[40:43], s64 offen offset:1152 nt
v_cvt_pk_bf16_f32 v85, v62, v46
v_lshlrev_b32 v84, 16, v85
v_and_b32 v85, 0xffff0000, v85
buffer_store_dword v84, v14, s[40:43], 0 offen offset:1280 nt
buffer_store_dword v85, v14, s[40:43], s64 offen offset:1280 nt
v_cvt_pk_bf16_f32 v87, v63, v47
v_lshlrev_b32 v86, 16, v87
v_and_b32 v87, 0xffff0000, v87
buffer_store_dword v86, v14, s[40:43], 0 offen offset:1408 nt
buffer_store_dword v87, v14, s[40:43], s64 offen offset:1408 nt
v_cvt_pk_bf16_f32 v89, v64, v48
v_lshlrev_b32 v88, 16, v89
v_and_b32 v89, 0xffff0000, v89
buffer_store_dword v88, v14, s[40:43], 0 offen offset:2048 nt
buffer_store_dword v89, v14, s[40:43], s64 offen offset:2048 nt
v_cvt_pk_bf16_f32 v91, v65, v49
v_lshlrev_b32 v90, 16, v91
v_and_b32 v91, 0xffff0000, v91
buffer_store_dword v90, v14, s[40:43], 0 offen offset:2176 nt
buffer_store_dword v91, v14, s[40:43], s64 offen offset:2176 nt
v_cvt_pk_bf16_f32 v93, v66, v50
v_lshlrev_b32 v92, 16, v93
v_and_b32 v93, 0xffff0000, v93
buffer_store_dword v92, v14, s[40:43], 0 offen offset:2304 nt
buffer_store_dword v93, v14, s[40:43], s64 offen offset:2304 nt
v_cvt_pk_bf16_f32 v95, v67, v51
v_lshlrev_b32 v94, 16, v95
v_and_b32 v95, 0xffff0000, v95
buffer_store_dword v94, v14, s[40:43], 0 offen offset:2432 nt
buffer_store_dword v95, v14, s[40:43], s64 offen offset:2432 nt
v_cvt_pk_bf16_f32 v97, v68, v52
v_lshlrev_b32 v96, 16, v97
v_and_b32 v97, 0xffff0000, v97
buffer_store_dword v96, v14, s[40:43], 0 offen offset:3072 nt
buffer_store_dword v97, v14, s[40:43], s64 offen offset:3072 nt
v_cvt_pk_bf16_f32 v99, v69, v53
v_lshlrev_b32 v98, 16, v99
v_and_b32 v99, 0xffff0000, v99
buffer_store_dword v98, v14, s[40:43], 0 offen offset:3200 nt
buffer_store_dword v99, v14, s[40:43], s64 offen offset:3200 nt
v_cvt_pk_bf16_f32 v101, v70, v54
v_lshlrev_b32 v100, 16, v101
v_and_b32 v101, 0xffff0000, v101
buffer_store_dword v100, v14, s[40:43], 0 offen offset:3328 nt
buffer_store_dword v101, v14, s[40:43], s64 offen offset:3328 nt
v_cvt_pk_bf16_f32 v103, v71, v55
v_lshlrev_b32 v102, 16, v103
v_and_b32 v103, 0xffff0000, v103
buffer_store_dword v102, v14, s[40:43], 0 offen offset:3456 nt
buffer_store_dword v103, v14, s[40:43], s64 offen offset:3456 nt
s_endpgm
L_concat_heads__spectral_gfnet__ssm_conv_s5__prompt_kernel_gemm:
s_lshr_b32 s68, s34, 1
s_and_b32 s66, s34, 1
s_lshr_b32 s101, s36, 3
v_and_b32 v6, 31, v1
v_lshrrev_b32 v5, 5, v1
v_lshlrev_b32 v11, 4, v1
v_mov_b64 v[64:65], 0
v_mov_b64 v[66:67], 0
s_mul_i32 s60, s34, 2304
s_add_u32 s60, s60, 114688
v_add_u32 v13, s60, v11
v_mov_b32 v12, 126976
ds_write_b128 v13, v[64:67]
ds_write_b128 v13, v[64:67] offset:1024
ds_write_b128 v13, v[64:67] offset:2048
s_mov_b64 exec, 1
ds_write_b128 v12, v[64:67]
ds_write_b128 v12, v[64:67] offset:16
ds_write_b128 v12, v[64:67] offset:32
ds_write_b128 v12, v[64:67] offset:48
ds_write_b128 v12, v[64:67] offset:64
s_mov_b64 exec, -1
s_lshl_b32 s60, s34, 2
v_add_u32 v13, s60, v12
s_waitcnt lgkmcnt(0)
s_barrier
v_bfe_u32 v4, v1, 2, 2
v_lshlrev_b32 v4, 3, v4
v_and_b32 v7, 3, v1
v_add_u32 v4, v4, v7
s_lshl_b32 s60, s36, 6
s_lshl_b32 s61, s66, 5
s_add_u32 s60, s60, s61
v_add_u32 v4, s60, v4
v_lshlrev_b32 v7, 1, v4
v_lshrrev_b32 v14, 5, v1
v_bfe_u32 v15, v1, 3, 2
v_and_b32 v16, 1, v15
v_lshrrev_b32 v17, 1, v15
v_lshlrev_b32 v18, 4, v14
v_lshl_add_u32 v18, v16, 3, v18
v_add_u32 v18, v18, v17
s_lshl_b32 s61, s68, 6
s_lshl_b32 s62, s66, 2
s_add_u32 s61, s61, s62
v_add_u32 v18, s61, v18
v_lshlrev_b32 v18, 11, v18
s_lshl_b32 s61, s68, 5
v_lshl_add_u32 v19, v14, 3, v15
v_add_u32 v19, s61, v19
v_lshlrev_b32 v19, 11, v19
v_and_b32 v16, 7, v1
v_lshrrev_b32 v17, 4, v1
v_xor_b32 v16, v16, v17
v_lshlrev_b32 v16, 4, v16
v_xor_b32 v17, 64, v16
v_add_u32 v244, v18, v16
v_add_u32 v245, v18, v17
v_add_u32 v245, 64512, v245
v_add_u32 v246, v19, v16
v_add_u32 v247, v19, v17
v_add_u32 v247, 31744, v247
s_mul_i32 s38, s35, 128
s_mul_i32 s60, s36, 128
s_add_u32 s38, s38, s60
s_bfe_u32 s60, s38, 0x30007
s_cmp_eq_u32 s60, 3
s_cselect_b32 s60, 128, 0
s_add_u32 s38, s38, s60
s_lshl_b32 s60, s35, 18
s_lshl_b32 s61, s36, 17
s_lshl_b32 s39, s34, 12
s_waitcnt lgkmcnt(0)
global_load_ushort v248, v7, s[12:13] offset:0
global_load_ushort v249, v7, s[14:15] offset:0
global_load_ushort v250, v7, s[24:25] offset:0
global_load_ushort v251, v7, s[12:13] offset:8
global_load_ushort v252, v7, s[14:15] offset:8
global_load_ushort v253, v7, s[24:25] offset:8
s_add_u32 s48, s10, s60
s_addc_u32 s49, s11, 0
s_mov_b32 s50, 262144
s_mov_b32 s51, 0x20000
s_cmp_eq_u32 s66, 1
s_cselect_b32 s62, s18, s16
s_cselect_b32 s63, s19, s17
s_add_u32 s52, s62, s61
s_addc_u32 s53, s63, 0
s_mov_b32 s54, 131072
s_mov_b32 s55, 0x20000
s_add_u32 s62, s38, 0
s_and_b32 s62, s62, 0x7ff
s_add_u32 s63, s62, 2048
s_add_u32 s64, s62, 6144
s_add_u32 m0, s39, 0
s_nop 0
buffer_load_dwordx4 v244, s[48:51], s62 offen offset:0 lds
buffer_load_dwordx4 v245, s[48:51], s62 offen offset:1024 lds
buffer_load_dwordx4 v244, s[48:51], s63 offen offset:2048 lds
buffer_load_dwordx4 v245, s[48:51], s63 offen offset:3072 lds
s_add_u32 m0, s39, 16384
s_nop 0
buffer_load_dwordx4 v246, s[52:55], s62 offen offset:0 lds
buffer_load_dwordx4 v247, s[52:55], s62 offen offset:1024 lds
buffer_load_dwordx4 v246, s[52:55], s64 offen offset:2048 lds
buffer_load_dwordx4 v247, s[52:55], s64 offen offset:3072 lds
v_bfe_u32 v7, v1, 4, 1
v_lshl_add_u32 v4, v7, 2, v4
v_bfe_u32 v7, v6, 1, 3
v_xor_b32 v7, v7, v5
v_lshlrev_b32 v7, 4, v7
v_lshl_add_u32 v7, v6, 7, v7
v_and_b32 v8, 15, v1
v_lshrrev_b32 v9, 4, v1
v_lshrrev_b32 v14, 1, v8
v_xor_b32 v14, v14, v9
v_lshlrev_b32 v14, 4, v14
v_lshl_add_u32 v14, v8, 7, v14
s_lshl_b32 s60, s68, 13
s_lshl_b32 s61, s66, 13
s_add_u32 s61, s61, 16384
v_xor_b32 v15, 0, v14
v_add_u32 v128, s60, v15
v_add_u32 v130, s61, v15
v_add_u32 v132, 0x10000, v128
v_add_u32 v134, 0x10000, v130
v_xor_b32 v15, 64, v14
v_add_u32 v129, s60, v15
v_add_u32 v131, s61, v15
v_add_u32 v133, 0x10000, v129
v_add_u32 v135, 0x10000, v131
s_add_u32 s40, s32, 65536
s_addc_u32 s41, s33, 0
s_mov_b32 s42, 262144
s_mov_b32 s43, 0x20000
s_add_u32 s44, s32, 1048576
s_addc_u32 s45, s33, 0
s_mov_b32 s46, 8388608
s_mov_b32 s47, 0x20000
s_mul_i32 s60, s66, 4608
s_add_u32 s60, s60, 114752
s_lshl_b32 s61, s68, 5
s_add_u32 s61, s61, s60
v_mul_u32_u24 v14, 144, v6
v_add_u32 v14, s60, v14
v_lshl_add_u32 v14, v5, 5, v14
v_mul_u32_u24 v15, 144, v8
v_add_u32 v15, s61, v15
v_lshl_add_u32 v15, v9, 3, v15
s_lshl_b32 s60, s35, 14
v_lshl_add_u32 v16, v4, 4, s60
v_mov_b32 v17, 0x40000000
v_lshlrev_b32 v10, 14, v5
v_sub_u32 v10, v16, v10
v_subrev_u32 v136, 16384, v10
v_cmp_le_i32 vcc, 0, v136
s_nop 1
v_cndmask_b32 v136, v17, v136, vcc
v_subrev_u32 v137, 49152, v10
v_cmp_le_i32 vcc, 0, v137
s_nop 1
v_cndmask_b32 v137, v17, v137, vcc
v_subrev_u32 v138, 81920, v10
v_cmp_le_i32 vcc, 0, v138
s_nop 1
v_cndmask_b32 v138, v17, v138, vcc
v_subrev_u32 v139, 114688, v10
v_cmp_le_i32 vcc, 0, v139
s_nop 1
v_cndmask_b32 v139, v17, v139, vcc
v_subrev_u32 v140, 147456, v10
v_cmp_le_i32 vcc, 0, v140
s_nop 1
v_cndmask_b32 v140, v17, v140, vcc
v_subrev_u32 v141, 180224, v10
v_cmp_le_i32 vcc, 0, v141
s_nop 1
v_cndmask_b32 v141, v17, v141, vcc
v_subrev_u32 v142, 212992, v10
v_cmp_le_i32 vcc, 0, v142
s_nop 1
v_cndmask_b32 v142, v17, v142, vcc
v_subrev_u32 v143, 245760, v10
v_cmp_le_i32 vcc, 0, v143
s_nop 1
v_cndmask_b32 v143, v17, v143, vcc
v_lshlrev_b32 v17, 30, v5
v_or_b32 v16, v16, v17
s_lshl_b32 s60, s35, 11
s_add_u32 s60, s60, 32768
s_lshl_b32 s61, s36, 7
s_add_u32 s61, s61, s60
v_mov_b32 v195, s61
s_lshl_b32 s61, s101, 10
s_add_u32 s60, s60, s61
v_and_b32 v196, 7, v1
v_lshl_add_u32 v196, v196, 7, s60
s_lshl_b32 s60, s35, 1
s_add_u32 s60, s60, s68
s_lshl_b32 s60, s60, 12
s_add_u32 s60, s60, 393216
s_lshl_b32 s61, s101, 11
s_add_u32 s61, s61, s60
v_lshl_add_u32 v18, v8, 7, s61
s_lshl_b32 s61, s36, 8
s_add_u32 s60, s60, s61
s_lshl_b32 s61, s66, 7
s_add_u32 s60, s60, s61
v_mov_b32 v19, s60
v_lshrrev_b32 v10, 1, v9
v_lshlrev_b32 v10, 10, v10
v_and_b32 v17, 1, v9
v_lshl_add_u32 v10, v17, 9, v10
v_lshl_add_u32 v10, v8, 4, v10
s_lshl_b32 s60, s68, 2
v_add_u32 v9, s60, v9
v_cvt_f32_u32 v9, v9
v_mul_f32 v9, 0x41800000, v9
v_add_f32 v8, 0x41000000, v9
s_add_u32 s62, s38, 128
s_and_b32 s62, s62, 0x7ff
s_add_u32 s63, s62, 2048
s_add_u32 s64, s62, 6144
s_add_u32 m0, s39, 32768
s_nop 0
buffer_load_dwordx4 v244, s[48:51], s62 offen offset:0 lds
buffer_load_dwordx4 v245, s[48:51], s62 offen offset:1024 lds
buffer_load_dwordx4 v244, s[48:51], s63 offen offset:2048 lds
buffer_load_dwordx4 v245, s[48:51], s63 offen offset:3072 lds
s_add_u32 m0, s39, 49152
s_nop 0
buffer_load_dwordx4 v246, s[52:55], s62 offen offset:0 lds
buffer_load_dwordx4 v247, s[52:55], s62 offen offset:1024 lds
buffer_load_dwordx4 v246, s[52:55], s64 offen offset:2048 lds
buffer_load_dwordx4 v247, s[52:55], s64 offen offset:3072 lds
s_setprio 1
s_waitcnt vmcnt(8)
s_barrier
ds_read_b128 v[32:35], v128 offset:0
ds_read_b128 v[48:51], v130 offset:0
ds_read_b128 v[52:55], v130 offset:2048
ds_read_b128 v[56:59], v130 offset:4096
ds_read_b128 v[60:63], v130 offset:6144
ds_read_b128 v[36:39], v128 offset:2048
ds_read_b128 v[40:43], v128 offset:4096
ds_read_b128 v[44:47], v128 offset:6144
s_waitcnt lgkmcnt(6)
v_mfma_f32_16x16x32_bf16 v[64:67], v[32:35], v[48:51], 0
ds_read_b128 v[144:147], v129 offset:0
s_waitcnt lgkmcnt(6)
v_mfma_f32_16x16x32_bf16 v[96:99], v[32:35], v[52:55], 0
ds_read_b128 v[160:163], v131 offset:0
s_waitcnt lgkmcnt(6)
v_mfma_f32_16x16x32_bf16 v[80:83], v[32:35], v[56:59], 0
ds_read_b128 v[164:167], v131 offset:2048
s_waitcnt lgkmcnt(6)
v_mfma_f32_16x16x32_bf16 v[112:115], v[32:35], v[60:63], 0
ds_read_b128 v[168:171], v131 offset:4096
s_waitcnt lgkmcnt(6)
v_mfma_f32_16x16x32_bf16 v[68:71], v[36:39], v[48:51], 0
ds_read_b128 v[172:175], v131 offset:6144
v_mfma_f32_16x16x32_bf16 v[100:103], v[36:39], v[52:55], 0
ds_read_b128 v[148:151], v129 offset:2048
v_mfma_f32_16x16x32_bf16 v[84:87], v[36:39], v[56:59], 0
ds_read_b128 v[152:155], v129 offset:4096
v_mfma_f32_16x16x32_bf16 v[116:119], v[36:39], v[60:63], 0
ds_read_b128 v[156:159], v129 offset:6144
s_waitcnt lgkmcnt(9)
v_mfma_f32_16x16x32_bf16 v[72:75], v[40:43], v[48:51], 0
v_lshlrev_b32 v248, 16, v248
v_lshlrev_b32 v249, 16, v249
v_mfma_f32_16x16x32_bf16 v[104:107], v[40:43], v[52:55], 0
v_lshlrev_b32 v250, 16, v250
v_mul_f32 v250, 0x3fb8aa3b, v250
v_mfma_f32_16x16x32_bf16 v[88:91], v[40:43], v[56:59], 0
v_exp_f32 v250, v250
s_nop 0
v_cvt_pk_bf16_f32 v250, v250, v250
v_mfma_f32_16x16x32_bf16 v[120:123], v[40:43], v[60:63], 0
v_lshlrev_b32 v250, 16, v250
v_mul_f32 v204, v250, v248
s_waitcnt lgkmcnt(8)
v_mfma_f32_16x16x32_bf16 v[76:79], v[44:47], v[48:51], 0
v_mul_f32 v206, v250, v249
v_mul_f32 v204, 0x3fb8aa3b, v204
v_mfma_f32_16x16x32_bf16 v[108:111], v[44:47], v[52:55], 0
v_mul_f32 v206, 0.15915494, v206
v_mul_f32 v197, 0x3f800000, v204
v_mfma_f32_16x16x32_bf16 v[92:95], v[44:47], v[56:59], 0
v_mul_f32 v198, 0x3f800000, v206
v_exp_f32 v197, v197
v_mfma_f32_16x16x32_bf16 v[124:127], v[44:47], v[60:63], 0
v_rndne_f32 v199, v198
v_sub_f32 v198, v198, v199
s_waitcnt vmcnt(0) lgkmcnt(0)
s_barrier
v_mfma_f32_16x16x32_bf16 v[64:67], v[144:147], v[160:163], v[64:67]
ds_read_b128 v[32:35], v128 offset:32768
v_mfma_f32_16x16x32_bf16 v[96:99], v[144:147], v[164:167], v[96:99]
ds_read_b128 v[48:51], v130 offset:32768
v_mfma_f32_16x16x32_bf16 v[80:83], v[144:147], v[168:171], v[80:83]
ds_read_b128 v[52:55], v130 offset:34816
v_mfma_f32_16x16x32_bf16 v[112:115], v[144:147], v[172:175], v[112:115]
ds_read_b128 v[56:59], v130 offset:36864
v_mfma_f32_16x16x32_bf16 v[68:71], v[148:151], v[160:163], v[68:71]
ds_read_b128 v[60:63], v130 offset:38912
v_mfma_f32_16x16x32_bf16 v[100:103], v[148:151], v[164:167], v[100:103]
ds_read_b128 v[36:39], v128 offset:34816
v_mfma_f32_16x16x32_bf16 v[84:87], v[148:151], v[168:171], v[84:87]
ds_read_b128 v[40:43], v128 offset:36864
v_mfma_f32_16x16x32_bf16 v[116:119], v[148:151], v[172:175], v[116:119]
ds_read_b128 v[44:47], v128 offset:38912
v_mfma_f32_16x16x32_bf16 v[72:75], v[152:155], v[160:163], v[72:75]
v_cos_f32 v199, v198
v_sin_f32 v198, v198
v_mfma_f32_16x16x32_bf16 v[104:107], v[152:155], v[164:167], v[104:107]
v_mul_f32 v20, v197, v199
v_mul_f32 v21, v197, v198
v_mfma_f32_16x16x32_bf16 v[88:91], v[152:155], v[168:171], v[88:91]
v_add_f32 v197, -1.0, v20
v_mul_f32 v198, v248, v248
v_mfma_f32_16x16x32_bf16 v[120:123], v[152:155], v[172:175], v[120:123]
v_fma_f32 v198, v249, v249, v198
v_rcp_f32 v198, v198
v_mfma_f32_16x16x32_bf16 v[76:79], v[156:159], v[160:163], v[76:79]
v_add_f32 v198, v198, v198
v_mul_f32 v199, v197, v248
v_mfma_f32_16x16x32_bf16 v[108:111], v[156:159], v[164:167], v[108:111]
v_fma_f32 v199, v21, v249, v199
v_mul_f32 v24, v199, v198
v_mfma_f32_16x16x32_bf16 v[92:95], v[156:159], v[168:171], v[92:95]
v_mul_f32 v199, v21, v248
v_fma_f32 v199, -v197, v249, v199
v_mfma_f32_16x16x32_bf16 v[124:127], v[156:159], v[172:175], v[124:127]
v_mul_f32 v25, v199, v198
v_mul_f32 v197, 0x41000000, v204
s_waitcnt lgkmcnt(6)
v_mfma_f32_16x16x32_bf16 v[64:67], v[32:35], v[48:51], v[64:67]
ds_read_b128 v[144:147], v129 offset:32768
s_waitcnt lgkmcnt(6)
v_mfma_f32_16x16x32_bf16 v[96:99], v[32:35], v[52:55], v[96:99]
ds_read_b128 v[160:163], v131 offset:32768
s_waitcnt lgkmcnt(6)
v_mfma_f32_16x16x32_bf16 v[80:83], v[32:35], v[56:59], v[80:83]
ds_read_b128 v[164:167], v131 offset:34816
s_waitcnt lgkmcnt(6)
v_mfma_f32_16x16x32_bf16 v[112:115], v[32:35], v[60:63], v[112:115]
ds_read_b128 v[168:171], v131 offset:36864
s_waitcnt lgkmcnt(6)
v_mfma_f32_16x16x32_bf16 v[68:71], v[36:39], v[48:51], v[68:71]
ds_read_b128 v[172:175], v131 offset:38912
v_mfma_f32_16x16x32_bf16 v[100:103], v[36:39], v[52:55], v[100:103]
ds_read_b128 v[148:151], v129 offset:34816
v_mfma_f32_16x16x32_bf16 v[84:87], v[36:39], v[56:59], v[84:87]
ds_read_b128 v[152:155], v129 offset:36864
v_mfma_f32_16x16x32_bf16 v[116:119], v[36:39], v[60:63], v[116:119]
ds_read_b128 v[156:159], v129 offset:38912
s_waitcnt lgkmcnt(9)
v_mfma_f32_16x16x32_bf16 v[72:75], v[40:43], v[48:51], v[72:75]
v_mul_f32 v198, 0x41000000, v206
v_exp_f32 v197, v197
v_mfma_f32_16x16x32_bf16 v[104:107], v[40:43], v[52:55], v[104:107]
v_rndne_f32 v199, v198
v_sub_f32 v198, v198, v199
v_mfma_f32_16x16x32_bf16 v[88:91], v[40:43], v[56:59], v[88:91]
v_cos_f32 v199, v198
v_sin_f32 v198, v198
v_mfma_f32_16x16x32_bf16 v[120:123], v[40:43], v[60:63], v[120:123]
v_mul_f32 v176, v197, v199
v_mul_f32 v177, v197, v198
s_waitcnt lgkmcnt(8)
v_mfma_f32_16x16x32_bf16 v[76:79], v[44:47], v[48:51], v[76:79]
v_mul_f32 v197, 0x41800000, v204
v_mul_f32 v198, 0x41800000, v206
v_mfma_f32_16x16x32_bf16 v[108:111], v[44:47], v[52:55], v[108:111]
v_exp_f32 v197, v197
v_rndne_f32 v199, v198
v_mfma_f32_16x16x32_bf16 v[92:95], v[44:47], v[56:59], v[92:95]
v_sub_f32 v198, v198, v199
v_cos_f32 v199, v198
v_mfma_f32_16x16x32_bf16 v[124:127], v[44:47], v[60:63], v[124:127]
v_sin_f32 v198, v198
v_mul_f32 v180, v197, v199
s_waitcnt lgkmcnt(0)
s_barrier
v_mfma_f32_16x16x32_bf16 v[64:67], v[144:147], v[160:163], v[64:67]
ds_read_b128 v[32:35], v132 offset:0
v_mfma_f32_16x16x32_bf16 v[96:99], v[144:147], v[164:167], v[96:99]
ds_read_b128 v[48:51], v134 offset:0
v_mfma_f32_16x16x32_bf16 v[80:83], v[144:147], v[168:171], v[80:83]
ds_read_b128 v[52:55], v134 offset:2048
v_mfma_f32_16x16x32_bf16 v[112:115], v[144:147], v[172:175], v[112:115]
ds_read_b128 v[56:59], v134 offset:4096
v_mfma_f32_16x16x32_bf16 v[68:71], v[148:151], v[160:163], v[68:71]
ds_read_b128 v[60:63], v134 offset:6144
v_mfma_f32_16x16x32_bf16 v[100:103], v[148:151], v[164:167], v[100:103]
ds_read_b128 v[36:39], v132 offset:2048
v_mfma_f32_16x16x32_bf16 v[84:87], v[148:151], v[168:171], v[84:87]
ds_read_b128 v[40:43], v132 offset:4096
v_mfma_f32_16x16x32_bf16 v[116:119], v[148:151], v[172:175], v[116:119]
ds_read_b128 v[44:47], v132 offset:6144
v_mfma_f32_16x16x32_bf16 v[72:75], v[152:155], v[160:163], v[72:75]
v_mul_f32 v181, v197, v198
v_mul_f32 v197, v9, v204
v_mfma_f32_16x16x32_bf16 v[104:107], v[152:155], v[164:167], v[104:107]
v_mul_f32 v198, v9, v206
v_exp_f32 v197, v197
v_mfma_f32_16x16x32_bf16 v[88:91], v[152:155], v[168:171], v[88:91]
v_rndne_f32 v199, v198
v_sub_f32 v198, v198, v199
v_mfma_f32_16x16x32_bf16 v[120:123], v[152:155], v[172:175], v[120:123]
v_cos_f32 v199, v198
v_sin_f32 v198, v198
v_mfma_f32_16x16x32_bf16 v[76:79], v[156:159], v[160:163], v[76:79]
v_mul_f32 v200, v197, v199
v_mul_f32 v201, v197, v198
v_mfma_f32_16x16x32_bf16 v[108:111], v[156:159], v[164:167], v[108:111]
v_mov_b32 v184, v200
v_mov_b32 v186, v201
v_mfma_f32_16x16x32_bf16 v[92:95], v[156:159], v[168:171], v[92:95]
v_mul_f32 v197, v8, v204
v_mul_f32 v198, v8, v206
v_mfma_f32_16x16x32_bf16 v[124:127], v[156:159], v[172:175], v[124:127]
v_exp_f32 v197, v197
v_rndne_f32 v199, v198
s_waitcnt lgkmcnt(6)
v_mfma_f32_16x16x32_bf16 v[64:67], v[32:35], v[48:51], v[64:67]
ds_read_b128 v[144:147], v133 offset:0
s_waitcnt lgkmcnt(6)
v_mfma_f32_16x16x32_bf16 v[96:99], v[32:35], v[52:55], v[96:99]
ds_read_b128 v[160:163], v135 offset:0
s_waitcnt lgkmcnt(6)
v_mfma_f32_16x16x32_bf16 v[80:83], v[32:35], v[56:59], v[80:83]
ds_read_b128 v[164:167], v135 offset:2048
s_waitcnt lgkmcnt(6)
v_mfma_f32_16x16x32_bf16 v[112:115], v[32:35], v[60:63], v[112:115]
ds_read_b128 v[168:171], v135 offset:4096
s_waitcnt lgkmcnt(6)
v_mfma_f32_16x16x32_bf16 v[68:71], v[36:39], v[48:51], v[68:71]
ds_read_b128 v[172:175], v135 offset:6144
v_mfma_f32_16x16x32_bf16 v[100:103], v[36:39], v[52:55], v[100:103]
ds_read_b128 v[148:151], v133 offset:2048
v_mfma_f32_16x16x32_bf16 v[84:87], v[36:39], v[56:59], v[84:87]
ds_read_b128 v[152:155], v133 offset:4096
v_mfma_f32_16x16x32_bf16 v[116:119], v[36:39], v[60:63], v[116:119]
ds_read_b128 v[156:159], v133 offset:6144
s_waitcnt lgkmcnt(9)
v_mfma_f32_16x16x32_bf16 v[72:75], v[40:43], v[48:51], v[72:75]
v_sub_f32 v198, v198, v199
v_cos_f32 v199, v198
v_mfma_f32_16x16x32_bf16 v[104:107], v[40:43], v[52:55], v[104:107]
v_sin_f32 v198, v198
v_mul_f32 v200, v197, v199
v_mfma_f32_16x16x32_bf16 v[88:91], v[40:43], v[56:59], v[88:91]
v_mul_f32 v201, v197, v198
v_mov_b32 v185, v200
v_mfma_f32_16x16x32_bf16 v[120:123], v[40:43], v[60:63], v[120:123]
v_mov_b32 v187, v201
v_mul_f32 v197, v25, v21
s_waitcnt lgkmcnt(8)
v_mfma_f32_16x16x32_bf16 v[76:79], v[44:47], v[48:51], v[76:79]
v_mul_f32 v198, v25, v20
v_fma_f32 v208, v24, v20, -v197
v_mfma_f32_16x16x32_bf16 v[108:111], v[44:47], v[52:55], v[108:111]
v_fma_f32 v209, v24, v21, v198
v_mul_f32 v197, v209, v21
v_mfma_f32_16x16x32_bf16 v[92:95], v[44:47], v[56:59], v[92:95]
v_mul_f32 v198, v209, v20
v_fma_f32 v210, v208, v20, -v197
v_mfma_f32_16x16x32_bf16 v[124:127], v[44:47], v[60:63], v[124:127]
v_fma_f32 v211, v208, v21, v198
v_mul_f32 v197, v211, v21
s_waitcnt lgkmcnt(0)
s_barrier
v_mfma_f32_16x16x32_bf16 v[64:67], v[144:147], v[160:163], v[64:67]
ds_read_b128 v[32:35], v128 offset:0
v_mfma_f32_16x16x32_bf16 v[96:99], v[144:147], v[164:167], v[96:99]
ds_read_b128 v[48:51], v130 offset:0
v_mfma_f32_16x16x32_bf16 v[80:83], v[144:147], v[168:171], v[80:83]
ds_read_b128 v[52:55], v130 offset:2048
v_mfma_f32_16x16x32_bf16 v[112:115], v[144:147], v[172:175], v[112:115]
ds_read_b128 v[56:59], v130 offset:4096
v_mfma_f32_16x16x32_bf16 v[68:71], v[148:151], v[160:163], v[68:71]
ds_read_b128 v[60:63], v130 offset:6144
v_mfma_f32_16x16x32_bf16 v[100:103], v[148:151], v[164:167], v[100:103]
ds_read_b128 v[36:39], v128 offset:2048
v_mfma_f32_16x16x32_bf16 v[84:87], v[148:151], v[168:171], v[84:87]
ds_read_b128 v[40:43], v128 offset:4096
v_mfma_f32_16x16x32_bf16 v[116:119], v[148:151], v[172:175], v[116:119]
ds_read_b128 v[44:47], v128 offset:6144
v_mfma_f32_16x16x32_bf16 v[72:75], v[152:155], v[160:163], v[72:75]
v_mul_f32 v198, v211, v20
v_fma_f32 v212, v210, v20, -v197
v_mfma_f32_16x16x32_bf16 v[104:107], v[152:155], v[164:167], v[104:107]
v_fma_f32 v213, v210, v21, v198
v_mul_f32 v197, v213, v21
v_mfma_f32_16x16x32_bf16 v[88:91], v[152:155], v[168:171], v[88:91]
v_mul_f32 v198, v213, v20
v_fma_f32 v214, v212, v20, -v197
v_mfma_f32_16x16x32_bf16 v[120:123], v[152:155], v[172:175], v[120:123]
v_fma_f32 v215, v212, v21, v198
v_mul_f32 v197, v215, v21
v_mfma_f32_16x16x32_bf16 v[76:79], v[156:159], v[160:163], v[76:79]
v_mul_f32 v198, v215, v20
v_fma_f32 v216, v214, v20, -v197
v_mfma_f32_16x16x32_bf16 v[108:111], v[156:159], v[164:167], v[108:111]
v_fma_f32 v217, v214, v21, v198
v_mul_f32 v197, v217, v21
v_mfma_f32_16x16x32_bf16 v[92:95], v[156:159], v[168:171], v[92:95]
v_mul_f32 v198, v217, v20
v_fma_f32 v218, v216, v20, -v197
v_mfma_f32_16x16x32_bf16 v[124:127], v[156:159], v[172:175], v[124:127]
v_fma_f32 v219, v216, v21, v198
v_mul_f32 v197, v219, v21
s_waitcnt lgkmcnt(6)
v_mfma_f32_16x16x32_bf16 v[64:67], v[32:35], v[48:51], v[64:67]
ds_read_b128 v[144:147], v129 offset:0
s_waitcnt lgkmcnt(6)
v_mfma_f32_16x16x32_bf16 v[96:99], v[32:35], v[52:55], v[96:99]
ds_read_b128 v[160:163], v131 offset:0
s_waitcnt lgkmcnt(6)
v_mfma_f32_16x16x32_bf16 v[80:83], v[32:35], v[56:59], v[80:83]
ds_read_b128 v[164:167], v131 offset:2048
s_waitcnt lgkmcnt(6)
v_mfma_f32_16x16x32_bf16 v[112:115], v[32:35], v[60:63], v[112:115]
ds_read_b128 v[168:171], v131 offset:4096
s_waitcnt lgkmcnt(6)
v_mfma_f32_16x16x32_bf16 v[68:71], v[36:39], v[48:51], v[68:71]
ds_read_b128 v[172:175], v131 offset:6144
v_mfma_f32_16x16x32_bf16 v[100:103], v[36:39], v[52:55], v[100:103]
ds_read_b128 v[148:151], v129 offset:2048
v_mfma_f32_16x16x32_bf16 v[84:87], v[36:39], v[56:59], v[84:87]
ds_read_b128 v[152:155], v129 offset:4096
v_mfma_f32_16x16x32_bf16 v[116:119], v[36:39], v[60:63], v[116:119]
ds_read_b128 v[156:159], v129 offset:6144
s_waitcnt lgkmcnt(9)
v_mfma_f32_16x16x32_bf16 v[72:75], v[40:43], v[48:51], v[72:75]
v_mul_f32 v198, v219, v20
v_fma_f32 v220, v218, v20, -v197
v_mfma_f32_16x16x32_bf16 v[104:107], v[40:43], v[52:55], v[104:107]
v_fma_f32 v221, v218, v21, v198
v_mul_f32 v197, v221, v21
v_mfma_f32_16x16x32_bf16 v[88:91], v[40:43], v[56:59], v[88:91]
v_mul_f32 v198, v221, v20
v_fma_f32 v222, v220, v20, -v197
v_mfma_f32_16x16x32_bf16 v[120:123], v[40:43], v[60:63], v[120:123]
v_fma_f32 v223, v220, v21, v198
v_lshlrev_b32 v251, 16, v251
s_waitcnt lgkmcnt(8)
v_mfma_f32_16x16x32_bf16 v[76:79], v[44:47], v[48:51], v[76:79]
v_lshlrev_b32 v252, 16, v252
v_lshlrev_b32 v253, 16, v253
v_mfma_f32_16x16x32_bf16 v[108:111], v[44:47], v[52:55], v[108:111]
v_mul_f32 v253, 0x3fb8aa3b, v253
v_exp_f32 v253, v253
v_mfma_f32_16x16x32_bf16 v[92:95], v[44:47], v[56:59], v[92:95]
v_cvt_pk_bf16_f32 v253, v253, v253
v_lshlrev_b32 v253, 16, v253
v_mfma_f32_16x16x32_bf16 v[124:127], v[44:47], v[60:63], v[124:127]
v_mul_f32 v205, v253, v251
v_mul_f32 v207, v253, v252
s_waitcnt lgkmcnt(0)
s_barrier
v_mfma_f32_16x16x32_bf16 v[64:67], v[144:147], v[160:163], v[64:67]
ds_read_b128 v[32:35], v128 offset:32768
v_mfma_f32_16x16x32_bf16 v[96:99], v[144:147], v[164:167], v[96:99]
ds_read_b128 v[48:51], v130 offset:32768
v_mfma_f32_16x16x32_bf16 v[80:83], v[144:147], v[168:171], v[80:83]
ds_read_b128 v[52:55], v130 offset:34816
v_mfma_f32_16x16x32_bf16 v[112:115], v[144:147], v[172:175], v[112:115]
ds_read_b128 v[56:59], v130 offset:36864
v_mfma_f32_16x16x32_bf16 v[68:71], v[148:151], v[160:163], v[68:71]
ds_read_b128 v[60:63], v130 offset:38912
v_mfma_f32_16x16x32_bf16 v[100:103], v[148:151], v[164:167], v[100:103]
ds_read_b128 v[36:39], v128 offset:34816
v_mfma_f32_16x16x32_bf16 v[84:87], v[148:151], v[168:171], v[84:87]
ds_read_b128 v[40:43], v128 offset:36864
v_mfma_f32_16x16x32_bf16 v[116:119], v[148:151], v[172:175], v[116:119]
ds_read_b128 v[44:47], v128 offset:38912
v_mfma_f32_16x16x32_bf16 v[72:75], v[152:155], v[160:163], v[72:75]
v_mul_f32 v205, 0x3fb8aa3b, v205
v_mul_f32 v207, 0.15915494, v207
v_mfma_f32_16x16x32_bf16 v[104:107], v[152:155], v[164:167], v[104:107]
v_mul_f32 v197, 0x3f800000, v205
v_mul_f32 v198, 0x3f800000, v207
v_mfma_f32_16x16x32_bf16 v[88:91], v[152:155], v[168:171], v[88:91]
v_exp_f32 v197, v197
v_rndne_f32 v199, v198
v_mfma_f32_16x16x32_bf16 v[120:123], v[152:155], v[172:175], v[120:123]
v_sub_f32 v198, v198, v199
v_cos_f32 v199, v198
v_mfma_f32_16x16x32_bf16 v[76:79], v[156:159], v[160:163], v[76:79]
v_sin_f32 v198, v198
v_mul_f32 v22, v197, v199
v_mfma_f32_16x16x32_bf16 v[108:111], v[156:159], v[164:167], v[108:111]
v_mul_f32 v23, v197, v198
v_add_f32 v197, -1.0, v22
v_mfma_f32_16x16x32_bf16 v[92:95], v[156:159], v[168:171], v[92:95]
v_mul_f32 v198, v251, v251
v_fma_f32 v198, v252, v252, v198
v_mfma_f32_16x16x32_bf16 v[124:127], v[156:159], v[172:175], v[124:127]
v_rcp_f32 v198, v198
s_nop 0
v_add_f32 v198, v198, v198
s_waitcnt lgkmcnt(6)
v_mfma_f32_16x16x32_bf16 v[64:67], v[32:35], v[48:51], v[64:67]
ds_read_b128 v[144:147], v129 offset:32768
s_waitcnt lgkmcnt(6)
v_mfma_f32_16x16x32_bf16 v[96:99], v[32:35], v[52:55], v[96:99]
ds_read_b128 v[160:163], v131 offset:32768
s_waitcnt lgkmcnt(6)
v_mfma_f32_16x16x32_bf16 v[80:83], v[32:35], v[56:59], v[80:83]
ds_read_b128 v[164:167], v131 offset:34816
s_waitcnt lgkmcnt(6)
v_mfma_f32_16x16x32_bf16 v[112:115], v[32:35], v[60:63], v[112:115]
ds_read_b128 v[168:171], v131 offset:36864
s_waitcnt lgkmcnt(6)
v_mfma_f32_16x16x32_bf16 v[68:71], v[36:39], v[48:51], v[68:71]
ds_read_b128 v[172:175], v131 offset:38912
v_mfma_f32_16x16x32_bf16 v[100:103], v[36:39], v[52:55], v[100:103]
ds_read_b128 v[148:151], v129 offset:34816
v_mfma_f32_16x16x32_bf16 v[84:87], v[36:39], v[56:59], v[84:87]
ds_read_b128 v[152:155], v129 offset:36864
v_mfma_f32_16x16x32_bf16 v[116:119], v[36:39], v[60:63], v[116:119]
ds_read_b128 v[156:159], v129 offset:38912
s_waitcnt lgkmcnt(9)
v_mfma_f32_16x16x32_bf16 v[72:75], v[40:43], v[48:51], v[72:75]
v_mul_f32 v199, v197, v251
v_fma_f32 v199, v23, v252, v199
v_mfma_f32_16x16x32_bf16 v[104:107], v[40:43], v[52:55], v[104:107]
v_mul_f32 v26, v199, v198
v_mul_f32 v199, v23, v251
v_mfma_f32_16x16x32_bf16 v[88:91], v[40:43], v[56:59], v[88:91]
v_fma_f32 v199, -v197, v252, v199
v_mul_f32 v27, v199, v198
v_mfma_f32_16x16x32_bf16 v[120:123], v[40:43], v[60:63], v[120:123]
v_mul_f32 v197, 0x41000000, v205
v_mul_f32 v198, 0x41000000, v207
s_waitcnt lgkmcnt(8)
v_mfma_f32_16x16x32_bf16 v[76:79], v[44:47], v[48:51], v[76:79]
v_exp_f32 v197, v197
v_rndne_f32 v199, v198
v_mfma_f32_16x16x32_bf16 v[108:111], v[44:47], v[52:55], v[108:111]
v_sub_f32 v198, v198, v199
v_cos_f32 v199, v198
v_mfma_f32_16x16x32_bf16 v[92:95], v[44:47], v[56:59], v[92:95]
v_sin_f32 v198, v198
v_mul_f32 v178, v197, v199
v_mfma_f32_16x16x32_bf16 v[124:127], v[44:47], v[60:63], v[124:127]
v_mul_f32 v179, v197, v198
v_mul_f32 v197, 0x41800000, v205
s_waitcnt lgkmcnt(0)
s_barrier
v_mfma_f32_16x16x32_bf16 v[64:67], v[144:147], v[160:163], v[64:67]
ds_read_b128 v[32:35], v132 offset:0
v_mfma_f32_16x16x32_bf16 v[96:99], v[144:147], v[164:167], v[96:99]
ds_read_b128 v[48:51], v134 offset:0
v_mfma_f32_16x16x32_bf16 v[80:83], v[144:147], v[168:171], v[80:83]
ds_read_b128 v[52:55], v134 offset:2048
v_mfma_f32_16x16x32_bf16 v[112:115], v[144:147], v[172:175], v[112:115]
ds_read_b128 v[56:59], v134 offset:4096
v_mfma_f32_16x16x32_bf16 v[68:71], v[148:151], v[160:163], v[68:71]
ds_read_b128 v[60:63], v134 offset:6144
v_mfma_f32_16x16x32_bf16 v[100:103], v[148:151], v[164:167], v[100:103]
ds_read_b128 v[36:39], v132 offset:2048
v_mfma_f32_16x16x32_bf16 v[84:87], v[148:151], v[168:171], v[84:87]
ds_read_b128 v[40:43], v132 offset:4096
v_mfma_f32_16x16x32_bf16 v[116:119], v[148:151], v[172:175], v[116:119]
ds_read_b128 v[44:47], v132 offset:6144
v_mfma_f32_16x16x32_bf16 v[72:75], v[152:155], v[160:163], v[72:75]
v_mul_f32 v198, 0x41800000, v207
v_exp_f32 v197, v197
v_mfma_f32_16x16x32_bf16 v[104:107], v[152:155], v[164:167], v[104:107]
v_rndne_f32 v199, v198
v_sub_f32 v198, v198, v199
v_mfma_f32_16x16x32_bf16 v[88:91], v[152:155], v[168:171], v[88:91]
v_cos_f32 v199, v198
v_sin_f32 v198, v198
v_mfma_f32_16x16x32_bf16 v[120:123], v[152:155], v[172:175], v[120:123]
v_mul_f32 v182, v197, v199
v_mul_f32 v183, v197, v198
v_mfma_f32_16x16x32_bf16 v[76:79], v[156:159], v[160:163], v[76:79]
v_mul_f32 v197, v9, v205
v_mul_f32 v198, v9, v207
v_mfma_f32_16x16x32_bf16 v[108:111], v[156:159], v[164:167], v[108:111]
v_exp_f32 v197, v197
v_rndne_f32 v199, v198
v_mfma_f32_16x16x32_bf16 v[92:95], v[156:159], v[168:171], v[92:95]
v_sub_f32 v198, v198, v199
v_cos_f32 v199, v198
v_mfma_f32_16x16x32_bf16 v[124:127], v[156:159], v[172:175], v[124:127]
v_sin_f32 v198, v198
v_mul_f32 v200, v197, v199
s_waitcnt lgkmcnt(6)
v_mfma_f32_16x16x32_bf16 v[64:67], v[32:35], v[48:51], v[64:67]
ds_read_b128 v[144:147], v133 offset:0
s_waitcnt lgkmcnt(6)
v_mfma_f32_16x16x32_bf16 v[96:99], v[32:35], v[52:55], v[96:99]
ds_read_b128 v[160:163], v135 offset:0
s_waitcnt lgkmcnt(6)
v_mfma_f32_16x16x32_bf16 v[80:83], v[32:35], v[56:59], v[80:83]
ds_read_b128 v[164:167], v135 offset:2048
s_waitcnt lgkmcnt(6)
v_mfma_f32_16x16x32_bf16 v[112:115], v[32:35], v[60:63], v[112:115]
ds_read_b128 v[168:171], v135 offset:4096
s_waitcnt lgkmcnt(6)
v_mfma_f32_16x16x32_bf16 v[68:71], v[36:39], v[48:51], v[68:71]
ds_read_b128 v[172:175], v135 offset:6144
v_mfma_f32_16x16x32_bf16 v[100:103], v[36:39], v[52:55], v[100:103]
ds_read_b128 v[148:151], v133 offset:2048
v_mfma_f32_16x16x32_bf16 v[84:87], v[36:39], v[56:59], v[84:87]
ds_read_b128 v[152:155], v133 offset:4096
v_mfma_f32_16x16x32_bf16 v[116:119], v[36:39], v[60:63], v[116:119]
ds_read_b128 v[156:159], v133 offset:6144
s_waitcnt lgkmcnt(9)
v_mfma_f32_16x16x32_bf16 v[72:75], v[40:43], v[48:51], v[72:75]
v_mul_f32 v201, v197, v198
v_mov_b32 v188, v200
v_mfma_f32_16x16x32_bf16 v[104:107], v[40:43], v[52:55], v[104:107]
v_mov_b32 v190, v201
v_mul_f32 v197, v8, v205
v_mfma_f32_16x16x32_bf16 v[88:91], v[40:43], v[56:59], v[88:91]
v_mul_f32 v198, v8, v207
v_exp_f32 v197, v197
v_mfma_f32_16x16x32_bf16 v[120:123], v[40:43], v[60:63], v[120:123]
v_rndne_f32 v199, v198
v_sub_f32 v198, v198, v199
s_waitcnt lgkmcnt(8)
v_mfma_f32_16x16x32_bf16 v[76:79], v[44:47], v[48:51], v[76:79]
v_cos_f32 v199, v198
v_sin_f32 v198, v198
v_mfma_f32_16x16x32_bf16 v[108:111], v[44:47], v[52:55], v[108:111]
v_mul_f32 v200, v197, v199
v_mul_f32 v201, v197, v198
v_mfma_f32_16x16x32_bf16 v[92:95], v[44:47], v[56:59], v[92:95]
v_mov_b32 v189, v200
v_mov_b32 v191, v201
v_mfma_f32_16x16x32_bf16 v[124:127], v[44:47], v[60:63], v[124:127]
v_mul_f32 v197, v27, v23
v_mul_f32 v198, v27, v22
s_waitcnt lgkmcnt(0)
s_barrier
v_mfma_f32_16x16x32_bf16 v[64:67], v[144:147], v[160:163], v[64:67]
ds_read_b128 v[32:35], v128 offset:0
v_mfma_f32_16x16x32_bf16 v[96:99], v[144:147], v[164:167], v[96:99]
ds_read_b128 v[48:51], v130 offset:0
v_mfma_f32_16x16x32_bf16 v[80:83], v[144:147], v[168:171], v[80:83]
ds_read_b128 v[52:55], v130 offset:2048
v_mfma_f32_16x16x32_bf16 v[112:115], v[144:147], v[172:175], v[112:115]
ds_read_b128 v[56:59], v130 offset:4096
v_mfma_f32_16x16x32_bf16 v[68:71], v[148:151], v[160:163], v[68:71]
ds_read_b128 v[60:63], v130 offset:6144
v_mfma_f32_16x16x32_bf16 v[100:103], v[148:151], v[164:167], v[100:103]
ds_read_b128 v[36:39], v128 offset:2048
v_mfma_f32_16x16x32_bf16 v[84:87], v[148:151], v[168:171], v[84:87]
ds_read_b128 v[40:43], v128 offset:4096
v_mfma_f32_16x16x32_bf16 v[116:119], v[148:151], v[172:175], v[116:119]
ds_read_b128 v[44:47], v128 offset:6144
v_mfma_f32_16x16x32_bf16 v[72:75], v[152:155], v[160:163], v[72:75]
v_fma_f32 v224, v26, v22, -v197
v_fma_f32 v225, v26, v23, v198
v_mfma_f32_16x16x32_bf16 v[104:107], v[152:155], v[164:167], v[104:107]
v_mul_f32 v197, v225, v23
v_mul_f32 v198, v225, v22
v_mfma_f32_16x16x32_bf16 v[88:91], v[152:155], v[168:171], v[88:91]
v_fma_f32 v226, v224, v22, -v197
v_fma_f32 v227, v224, v23, v198
v_mfma_f32_16x16x32_bf16 v[120:123], v[152:155], v[172:175], v[120:123]
v_mul_f32 v197, v227, v23
v_mul_f32 v198, v227, v22
v_mfma_f32_16x16x32_bf16 v[76:79], v[156:159], v[160:163], v[76:79]
v_fma_f32 v228, v226, v22, -v197
v_fma_f32 v229, v226, v23, v198
v_mfma_f32_16x16x32_bf16 v[108:111], v[156:159], v[164:167], v[108:111]
v_mul_f32 v197, v229, v23
v_mul_f32 v198, v229, v22
v_mfma_f32_16x16x32_bf16 v[92:95], v[156:159], v[168:171], v[92:95]
v_fma_f32 v230, v228, v22, -v197
v_fma_f32 v231, v228, v23, v198
v_mfma_f32_16x16x32_bf16 v[124:127], v[156:159], v[172:175], v[124:127]
v_mul_f32 v197, v231, v23
v_mul_f32 v198, v231, v22
s_waitcnt lgkmcnt(6)
v_mfma_f32_16x16x32_bf16 v[64:67], v[32:35], v[48:51], v[64:67]
ds_read_b128 v[144:147], v129 offset:0
s_waitcnt lgkmcnt(6)
v_mfma_f32_16x16x32_bf16 v[96:99], v[32:35], v[52:55], v[96:99]
ds_read_b128 v[160:163], v131 offset:0
s_waitcnt lgkmcnt(6)
v_mfma_f32_16x16x32_bf16 v[80:83], v[32:35], v[56:59], v[80:83]
ds_read_b128 v[164:167], v131 offset:2048
s_waitcnt lgkmcnt(6)
v_mfma_f32_16x16x32_bf16 v[112:115], v[32:35], v[60:63], v[112:115]
ds_read_b128 v[168:171], v131 offset:4096
s_waitcnt lgkmcnt(6)
v_mfma_f32_16x16x32_bf16 v[68:71], v[36:39], v[48:51], v[68:71]
ds_read_b128 v[172:175], v131 offset:6144
v_mfma_f32_16x16x32_bf16 v[100:103], v[36:39], v[52:55], v[100:103]
ds_read_b128 v[148:151], v129 offset:2048
v_mfma_f32_16x16x32_bf16 v[84:87], v[36:39], v[56:59], v[84:87]
ds_read_b128 v[152:155], v129 offset:4096
v_mfma_f32_16x16x32_bf16 v[116:119], v[36:39], v[60:63], v[116:119]
ds_read_b128 v[156:159], v129 offset:6144
s_waitcnt lgkmcnt(9)
v_mfma_f32_16x16x32_bf16 v[72:75], v[40:43], v[48:51], v[72:75]
v_fma_f32 v232, v230, v22, -v197
v_fma_f32 v233, v230, v23, v198
v_mfma_f32_16x16x32_bf16 v[104:107], v[40:43], v[52:55], v[104:107]
v_mul_f32 v197, v233, v23
v_mul_f32 v198, v233, v22
v_mfma_f32_16x16x32_bf16 v[88:91], v[40:43], v[56:59], v[88:91]
v_fma_f32 v234, v232, v22, -v197
v_fma_f32 v235, v232, v23, v198
v_mfma_f32_16x16x32_bf16 v[120:123], v[40:43], v[60:63], v[120:123]
v_mul_f32 v197, v235, v23
v_mul_f32 v198, v235, v22
s_waitcnt lgkmcnt(8)
v_mfma_f32_16x16x32_bf16 v[76:79], v[44:47], v[48:51], v[76:79]
v_fma_f32 v236, v234, v22, -v197
v_fma_f32 v237, v234, v23, v198
v_mfma_f32_16x16x32_bf16 v[108:111], v[44:47], v[52:55], v[108:111]
v_mul_f32 v197, v237, v23
v_mul_f32 v198, v237, v22
v_mfma_f32_16x16x32_bf16 v[92:95], v[44:47], v[56:59], v[92:95]
v_fma_f32 v238, v236, v22, -v197
v_fma_f32 v239, v236, v23, v198
v_mfma_f32_16x16x32_bf16 v[124:127], v[44:47], v[60:63], v[124:127]
v_and_b32 v197, 16, v1
v_cmp_ne_u32 vcc, 0, v197
s_waitcnt lgkmcnt(0)
s_barrier
v_mfma_f32_16x16x32_bf16 v[64:67], v[144:147], v[160:163], v[64:67]
ds_read_b128 v[32:35], v128 offset:32768
v_mfma_f32_16x16x32_bf16 v[96:99], v[144:147], v[164:167], v[96:99]
ds_read_b128 v[48:51], v130 offset:32768
v_mfma_f32_16x16x32_bf16 v[80:83], v[144:147], v[168:171], v[80:83]
ds_read_b128 v[52:55], v130 offset:34816
v_mfma_f32_16x16x32_bf16 v[112:115], v[144:147], v[172:175], v[112:115]
ds_read_b128 v[56:59], v130 offset:36864
v_mfma_f32_16x16x32_bf16 v[68:71], v[148:151], v[160:163], v[68:71]
ds_read_b128 v[60:63], v130 offset:38912
v_mfma_f32_16x16x32_bf16 v[100:103], v[148:151], v[164:167], v[100:103]
ds_read_b128 v[36:39], v128 offset:34816
v_mfma_f32_16x16x32_bf16 v[84:87], v[148:151], v[168:171], v[84:87]
ds_read_b128 v[40:43], v128 offset:36864
v_mfma_f32_16x16x32_bf16 v[116:119], v[148:151], v[172:175], v[116:119]
ds_read_b128 v[44:47], v128 offset:38912
v_mfma_f32_16x16x32_bf16 v[72:75], v[152:155], v[160:163], v[72:75]
v_cndmask_b32 v204, v204, v205, vcc
v_cndmask_b32 v206, v206, v207, vcc
v_mfma_f32_16x16x32_bf16 v[104:107], v[152:155], v[164:167], v[104:107]
v_mul_f32 v197, 0x41800000, v204
v_mul_f32 v198, 0x41800000, v206
v_mfma_f32_16x16x32_bf16 v[88:91], v[152:155], v[168:171], v[88:91]
v_exp_f32 v197, v197
v_rndne_f32 v199, v198
v_mfma_f32_16x16x32_bf16 v[120:123], v[152:155], v[172:175], v[120:123]
v_sub_f32 v198, v198, v199
v_cos_f32 v199, v198
v_mfma_f32_16x16x32_bf16 v[76:79], v[156:159], v[160:163], v[76:79]
v_sin_f32 v198, v198
v_mul_f32 v28, v197, v199
v_mfma_f32_16x16x32_bf16 v[108:111], v[156:159], v[164:167], v[108:111]
v_mul_f32 v29, v197, v198
v_mul_f32 v197, 0x42800000, v204
v_mfma_f32_16x16x32_bf16 v[92:95], v[156:159], v[168:171], v[92:95]
v_mul_f32 v198, 0x42800000, v206
v_exp_f32 v197, v197
v_mfma_f32_16x16x32_bf16 v[124:127], v[156:159], v[172:175], v[124:127]
v_rndne_f32 v199, v198
v_sub_f32 v198, v198, v199
s_waitcnt lgkmcnt(6)
v_mfma_f32_16x16x32_bf16 v[64:67], v[32:35], v[48:51], v[64:67]
ds_read_b128 v[144:147], v129 offset:32768
s_waitcnt lgkmcnt(6)
v_mfma_f32_16x16x32_bf16 v[96:99], v[32:35], v[52:55], v[96:99]
ds_read_b128 v[160:163], v131 offset:32768
s_waitcnt lgkmcnt(6)
v_mfma_f32_16x16x32_bf16 v[80:83], v[32:35], v[56:59], v[80:83]
ds_read_b128 v[164:167], v131 offset:34816
s_waitcnt lgkmcnt(6)
v_mfma_f32_16x16x32_bf16 v[112:115], v[32:35], v[60:63], v[112:115]
ds_read_b128 v[168:171], v131 offset:36864
s_waitcnt lgkmcnt(6)
v_mfma_f32_16x16x32_bf16 v[68:71], v[36:39], v[48:51], v[68:71]
ds_read_b128 v[172:175], v131 offset:38912
v_mfma_f32_16x16x32_bf16 v[100:103], v[36:39], v[52:55], v[100:103]
ds_read_b128 v[148:151], v129 offset:34816
v_mfma_f32_16x16x32_bf16 v[84:87], v[36:39], v[56:59], v[84:87]
ds_read_b128 v[152:155], v129 offset:36864
v_mfma_f32_16x16x32_bf16 v[116:119], v[36:39], v[60:63], v[116:119]
ds_read_b128 v[156:159], v129 offset:38912
s_waitcnt lgkmcnt(9)
v_mfma_f32_16x16x32_bf16 v[72:75], v[40:43], v[48:51], v[72:75]
v_cos_f32 v199, v198
v_sin_f32 v198, v198
v_mfma_f32_16x16x32_bf16 v[104:107], v[40:43], v[52:55], v[104:107]
v_mul_f32 v192, v197, v199
v_mul_f32 v193, v197, v198
v_mfma_f32_16x16x32_bf16 v[88:91], v[40:43], v[56:59], v[88:91]
v_mul_f32 v197, 0x43000000, v204
v_mul_f32 v198, 0x43000000, v206
v_mfma_f32_16x16x32_bf16 v[120:123], v[40:43], v[60:63], v[120:123]
v_exp_f32 v197, v197
v_rndne_f32 v199, v198
s_waitcnt lgkmcnt(8)
v_mfma_f32_16x16x32_bf16 v[76:79], v[44:47], v[48:51], v[76:79]
v_sub_f32 v198, v198, v199
v_cos_f32 v199, v198
v_mfma_f32_16x16x32_bf16 v[108:111], v[44:47], v[52:55], v[108:111]
v_sin_f32 v198, v198
v_mul_f32 v30, v197, v199
v_mfma_f32_16x16x32_bf16 v[92:95], v[44:47], v[56:59], v[92:95]
v_mul_f32 v31, v197, v198
v_mul_f32 v197, 0x43800000, v204
v_mfma_f32_16x16x32_bf16 v[124:127], v[44:47], v[60:63], v[124:127]
v_mul_f32 v198, 0x43800000, v206
v_exp_f32 v197, v197
s_waitcnt lgkmcnt(0)
s_barrier
v_mfma_f32_16x16x32_bf16 v[64:67], v[144:147], v[160:163], v[64:67]
ds_read_b128 v[32:35], v132 offset:0
v_mfma_f32_16x16x32_bf16 v[96:99], v[144:147], v[164:167], v[96:99]
ds_read_b128 v[48:51], v134 offset:0
v_mfma_f32_16x16x32_bf16 v[80:83], v[144:147], v[168:171], v[80:83]
ds_read_b128 v[52:55], v134 offset:2048
v_mfma_f32_16x16x32_bf16 v[112:115], v[144:147], v[172:175], v[112:115]
ds_read_b128 v[56:59], v134 offset:4096
v_mfma_f32_16x16x32_bf16 v[68:71], v[148:151], v[160:163], v[68:71]
ds_read_b128 v[60:63], v134 offset:6144
v_mfma_f32_16x16x32_bf16 v[100:103], v[148:151], v[164:167], v[100:103]
ds_read_b128 v[36:39], v132 offset:2048
v_mfma_f32_16x16x32_bf16 v[84:87], v[148:151], v[168:171], v[84:87]
ds_read_b128 v[40:43], v132 offset:4096
v_mfma_f32_16x16x32_bf16 v[116:119], v[148:151], v[172:175], v[116:119]
ds_read_b128 v[44:47], v132 offset:6144
v_mfma_f32_16x16x32_bf16 v[72:75], v[152:155], v[160:163], v[72:75]
v_rndne_f32 v199, v198
v_sub_f32 v198, v198, v199
v_mfma_f32_16x16x32_bf16 v[104:107], v[152:155], v[164:167], v[104:107]
v_cos_f32 v199, v198
v_sin_f32 v198, v198
v_mfma_f32_16x16x32_bf16 v[88:91], v[152:155], v[168:171], v[88:91]
v_mul_f32 v2, v197, v199
v_mul_f32 v3, v197, v198
v_mfma_f32_16x16x32_bf16 v[120:123], v[152:155], v[172:175], v[120:123]
v_lshrrev_b32 v197, 4, v1
v_lshlrev_b32 v197, 2, v197
v_mfma_f32_16x16x32_bf16 v[76:79], v[156:159], v[160:163], v[76:79]
v_and_b32 v198, 15, v1
v_sub_u32 v197, v198, v197
v_mfma_f32_16x16x32_bf16 v[108:111], v[156:159], v[164:167], v[108:111]
v_mov_b32 v198, 0x3f80
v_mov_b32 v199, 1.0
v_mfma_f32_16x16x32_bf16 v[92:95], v[156:159], v[168:171], v[92:95]
v_cmp_eq_u32 vcc, 0, v197
s_nop 1
v_cndmask_b32 v248, 0, v198, vcc
v_mfma_f32_16x16x32_bf16 v[124:127], v[156:159], v[172:175], v[124:127]
v_cndmask_b32 v252, 0, v199, vcc
v_cmp_eq_u32 vcc, 1, v197
s_waitcnt lgkmcnt(6)
v_mfma_f32_16x16x32_bf16 v[64:67], v[32:35], v[48:51], v[64:67]
ds_read_b128 v[144:147], v133 offset:0
s_waitcnt lgkmcnt(6)
v_mfma_f32_16x16x32_bf16 v[96:99], v[32:35], v[52:55], v[96:99]
ds_read_b128 v[160:163], v135 offset:0
s_waitcnt lgkmcnt(6)
v_mfma_f32_16x16x32_bf16 v[80:83], v[32:35], v[56:59], v[80:83]
ds_read_b128 v[164:167], v135 offset:2048
s_waitcnt lgkmcnt(6)
v_mfma_f32_16x16x32_bf16 v[112:115], v[32:35], v[60:63], v[112:115]
ds_read_b128 v[168:171], v135 offset:4096
s_waitcnt lgkmcnt(6)
v_mfma_f32_16x16x32_bf16 v[68:71], v[36:39], v[48:51], v[68:71]
ds_read_b128 v[172:175], v135 offset:6144
v_mfma_f32_16x16x32_bf16 v[100:103], v[36:39], v[52:55], v[100:103]
ds_read_b128 v[148:151], v133 offset:2048
v_mfma_f32_16x16x32_bf16 v[84:87], v[36:39], v[56:59], v[84:87]
ds_read_b128 v[152:155], v133 offset:4096
v_mfma_f32_16x16x32_bf16 v[116:119], v[36:39], v[60:63], v[116:119]
ds_read_b128 v[156:159], v133 offset:6144
s_waitcnt lgkmcnt(9)
v_mfma_f32_16x16x32_bf16 v[72:75], v[40:43], v[48:51], v[72:75]
v_cndmask_b32 v249, 0, v198, vcc
v_cndmask_b32 v253, 0, v199, vcc
v_mfma_f32_16x16x32_bf16 v[104:107], v[40:43], v[52:55], v[104:107]
v_cmp_eq_u32 vcc, 2, v197
s_nop 1
v_cndmask_b32 v250, 0, v198, vcc
v_mfma_f32_16x16x32_bf16 v[88:91], v[40:43], v[56:59], v[88:91]
v_cndmask_b32 v254, 0, v199, vcc
v_cmp_eq_u32 vcc, 3, v197
v_mfma_f32_16x16x32_bf16 v[120:123], v[40:43], v[60:63], v[120:123]
s_nop 0
v_cndmask_b32 v251, 0, v198, vcc
v_cndmask_b32 v255, 0, v199, vcc
s_waitcnt lgkmcnt(8)
v_mfma_f32_16x16x32_bf16 v[76:79], v[44:47], v[48:51], v[76:79]
v_mfma_f32_16x16x32_bf16 v[108:111], v[44:47], v[52:55], v[108:111]
v_mfma_f32_16x16x32_bf16 v[92:95], v[44:47], v[56:59], v[92:95]
v_mfma_f32_16x16x32_bf16 v[124:127], v[44:47], v[60:63], v[124:127]
s_waitcnt lgkmcnt(0)
s_barrier
v_mfma_f32_16x16x32_bf16 v[64:67], v[144:147], v[160:163], v[64:67]
ds_read_b128 v[32:35], v128 offset:0
v_mfma_f32_16x16x32_bf16 v[96:99], v[144:147], v[164:167], v[96:99]
ds_read_b128 v[48:51], v130 offset:0
v_mfma_f32_16x16x32_bf16 v[80:83], v[144:147], v[168:171], v[80:83]
ds_read_b128 v[52:55], v130 offset:2048
v_mfma_f32_16x16x32_bf16 v[112:115], v[144:147], v[172:175], v[112:115]
ds_read_b128 v[56:59], v130 offset:4096
v_mfma_f32_16x16x32_bf16 v[68:71], v[148:151], v[160:163], v[68:71]
ds_read_b128 v[60:63], v130 offset:6144
v_mfma_f32_16x16x32_bf16 v[100:103], v[148:151], v[164:167], v[100:103]
ds_read_b128 v[36:39], v128 offset:2048
v_mfma_f32_16x16x32_bf16 v[84:87], v[148:151], v[168:171], v[84:87]
ds_read_b128 v[40:43], v128 offset:4096
v_mfma_f32_16x16x32_bf16 v[116:119], v[148:151], v[172:175], v[116:119]
ds_read_b128 v[44:47], v128 offset:6144
v_mfma_f32_16x16x32_bf16 v[72:75], v[152:155], v[160:163], v[72:75]
v_mfma_f32_16x16x32_bf16 v[104:107], v[152:155], v[164:167], v[104:107]
v_mfma_f32_16x16x32_bf16 v[88:91], v[152:155], v[168:171], v[88:91]
v_mfma_f32_16x16x32_bf16 v[120:123], v[152:155], v[172:175], v[120:123]
v_mfma_f32_16x16x32_bf16 v[76:79], v[156:159], v[160:163], v[76:79]
v_mfma_f32_16x16x32_bf16 v[108:111], v[156:159], v[164:167], v[108:111]
v_mfma_f32_16x16x32_bf16 v[92:95], v[156:159], v[168:171], v[92:95]
v_mfma_f32_16x16x32_bf16 v[124:127], v[156:159], v[172:175], v[124:127]
s_waitcnt lgkmcnt(6)
v_mfma_f32_16x16x32_bf16 v[64:67], v[32:35], v[48:51], v[64:67]
ds_read_b128 v[144:147], v129 offset:0
s_waitcnt lgkmcnt(6)
v_mfma_f32_16x16x32_bf16 v[96:99], v[32:35], v[52:55], v[96:99]
ds_read_b128 v[160:163], v131 offset:0
s_waitcnt lgkmcnt(6)
v_mfma_f32_16x16x32_bf16 v[80:83], v[32:35], v[56:59], v[80:83]
ds_read_b128 v[164:167], v131 offset:2048
s_waitcnt lgkmcnt(6)
v_mfma_f32_16x16x32_bf16 v[112:115], v[32:35], v[60:63], v[112:115]
ds_read_b128 v[168:171], v131 offset:4096
s_waitcnt lgkmcnt(6)
v_mfma_f32_16x16x32_bf16 v[68:71], v[36:39], v[48:51], v[68:71]
ds_read_b128 v[172:175], v131 offset:6144
v_mfma_f32_16x16x32_bf16 v[100:103], v[36:39], v[52:55], v[100:103]
ds_read_b128 v[148:151], v129 offset:2048
v_mfma_f32_16x16x32_bf16 v[84:87], v[36:39], v[56:59], v[84:87]
ds_read_b128 v[152:155], v129 offset:4096
v_mfma_f32_16x16x32_bf16 v[116:119], v[36:39], v[60:63], v[116:119]
ds_read_b128 v[156:159], v129 offset:6144
s_waitcnt lgkmcnt(9)
v_mfma_f32_16x16x32_bf16 v[72:75], v[40:43], v[48:51], v[72:75]
v_mfma_f32_16x16x32_bf16 v[104:107], v[40:43], v[52:55], v[104:107]
v_mfma_f32_16x16x32_bf16 v[88:91], v[40:43], v[56:59], v[88:91]
v_mfma_f32_16x16x32_bf16 v[120:123], v[40:43], v[60:63], v[120:123]
s_waitcnt lgkmcnt(8)
v_mfma_f32_16x16x32_bf16 v[76:79], v[44:47], v[48:51], v[76:79]
v_mfma_f32_16x16x32_bf16 v[108:111], v[44:47], v[52:55], v[108:111]
v_mfma_f32_16x16x32_bf16 v[92:95], v[44:47], v[56:59], v[92:95]
v_mfma_f32_16x16x32_bf16 v[124:127], v[44:47], v[60:63], v[124:127]
s_waitcnt lgkmcnt(0)
s_barrier
v_mfma_f32_16x16x32_bf16 v[64:67], v[144:147], v[160:163], v[64:67]
ds_read_b128 v[32:35], v128 offset:32768
v_mfma_f32_16x16x32_bf16 v[96:99], v[144:147], v[164:167], v[96:99]
ds_read_b128 v[48:51], v130 offset:32768
v_mfma_f32_16x16x32_bf16 v[80:83], v[144:147], v[168:171], v[80:83]
ds_read_b128 v[52:55], v130 offset:34816
v_mfma_f32_16x16x32_bf16 v[112:115], v[144:147], v[172:175], v[112:115]
ds_read_b128 v[56:59], v130 offset:36864
v_mfma_f32_16x16x32_bf16 v[68:71], v[148:151], v[160:163], v[68:71]
ds_read_b128 v[60:63], v130 offset:38912
v_mfma_f32_16x16x32_bf16 v[100:103], v[148:151], v[164:167], v[100:103]
ds_read_b128 v[36:39], v128 offset:34816
v_mfma_f32_16x16x32_bf16 v[84:87], v[148:151], v[168:171], v[84:87]
ds_read_b128 v[40:43], v128 offset:36864
v_mfma_f32_16x16x32_bf16 v[116:119], v[148:151], v[172:175], v[116:119]
ds_read_b128 v[44:47], v128 offset:38912
v_mfma_f32_16x16x32_bf16 v[72:75], v[152:155], v[160:163], v[72:75]
v_mfma_f32_16x16x32_bf16 v[104:107], v[152:155], v[164:167], v[104:107]
v_mfma_f32_16x16x32_bf16 v[88:91], v[152:155], v[168:171], v[88:91]
v_mfma_f32_16x16x32_bf16 v[120:123], v[152:155], v[172:175], v[120:123]
v_mfma_f32_16x16x32_bf16 v[76:79], v[156:159], v[160:163], v[76:79]
v_mfma_f32_16x16x32_bf16 v[108:111], v[156:159], v[164:167], v[108:111]
v_mfma_f32_16x16x32_bf16 v[92:95], v[156:159], v[168:171], v[92:95]
v_mfma_f32_16x16x32_bf16 v[124:127], v[156:159], v[172:175], v[124:127]
s_waitcnt lgkmcnt(6)
v_mfma_f32_16x16x32_bf16 v[64:67], v[32:35], v[48:51], v[64:67]
ds_read_b128 v[144:147], v129 offset:32768
s_waitcnt lgkmcnt(6)
v_mfma_f32_16x16x32_bf16 v[96:99], v[32:35], v[52:55], v[96:99]
ds_read_b128 v[160:163], v131 offset:32768
s_waitcnt lgkmcnt(6)
v_mfma_f32_16x16x32_bf16 v[80:83], v[32:35], v[56:59], v[80:83]
ds_read_b128 v[164:167], v131 offset:34816
s_waitcnt lgkmcnt(6)
v_mfma_f32_16x16x32_bf16 v[112:115], v[32:35], v[60:63], v[112:115]
ds_read_b128 v[168:171], v131 offset:36864
s_waitcnt lgkmcnt(6)
v_mfma_f32_16x16x32_bf16 v[68:71], v[36:39], v[48:51], v[68:71]
ds_read_b128 v[172:175], v131 offset:38912
v_mfma_f32_16x16x32_bf16 v[100:103], v[36:39], v[52:55], v[100:103]
ds_read_b128 v[148:151], v129 offset:34816
v_mfma_f32_16x16x32_bf16 v[84:87], v[36:39], v[56:59], v[84:87]
ds_read_b128 v[152:155], v129 offset:36864
v_mfma_f32_16x16x32_bf16 v[116:119], v[36:39], v[60:63], v[116:119]
ds_read_b128 v[156:159], v129 offset:38912
s_waitcnt lgkmcnt(9)
v_mfma_f32_16x16x32_bf16 v[72:75], v[40:43], v[48:51], v[72:75]
v_mfma_f32_16x16x32_bf16 v[104:107], v[40:43], v[52:55], v[104:107]
v_mfma_f32_16x16x32_bf16 v[88:91], v[40:43], v[56:59], v[88:91]
v_mfma_f32_16x16x32_bf16 v[120:123], v[40:43], v[60:63], v[120:123]
s_waitcnt lgkmcnt(8)
v_mfma_f32_16x16x32_bf16 v[76:79], v[44:47], v[48:51], v[76:79]
v_mfma_f32_16x16x32_bf16 v[108:111], v[44:47], v[52:55], v[108:111]
v_mfma_f32_16x16x32_bf16 v[92:95], v[44:47], v[56:59], v[92:95]
v_mfma_f32_16x16x32_bf16 v[124:127], v[44:47], v[60:63], v[124:127]
s_waitcnt lgkmcnt(0)
s_barrier
v_mfma_f32_16x16x32_bf16 v[64:67], v[144:147], v[160:163], v[64:67]
ds_read_b128 v[32:35], v132 offset:0
v_mfma_f32_16x16x32_bf16 v[96:99], v[144:147], v[164:167], v[96:99]
ds_read_b128 v[48:51], v134 offset:0
v_mfma_f32_16x16x32_bf16 v[80:83], v[144:147], v[168:171], v[80:83]
ds_read_b128 v[52:55], v134 offset:2048
v_mfma_f32_16x16x32_bf16 v[112:115], v[144:147], v[172:175], v[112:115]
ds_read_b128 v[56:59], v134 offset:4096
v_mfma_f32_16x16x32_bf16 v[68:71], v[148:151], v[160:163], v[68:71]
ds_read_b128 v[60:63], v134 offset:6144
v_mfma_f32_16x16x32_bf16 v[100:103], v[148:151], v[164:167], v[100:103]
ds_read_b128 v[36:39], v132 offset:2048
v_mfma_f32_16x16x32_bf16 v[84:87], v[148:151], v[168:171], v[84:87]
ds_read_b128 v[40:43], v132 offset:4096
v_mfma_f32_16x16x32_bf16 v[116:119], v[148:151], v[172:175], v[116:119]
ds_read_b128 v[44:47], v132 offset:6144
v_mfma_f32_16x16x32_bf16 v[72:75], v[152:155], v[160:163], v[72:75]
v_mfma_f32_16x16x32_bf16 v[104:107], v[152:155], v[164:167], v[104:107]
v_mfma_f32_16x16x32_bf16 v[88:91], v[152:155], v[168:171], v[88:91]
v_mfma_f32_16x16x32_bf16 v[120:123], v[152:155], v[172:175], v[120:123]
v_mfma_f32_16x16x32_bf16 v[76:79], v[156:159], v[160:163], v[76:79]
v_mfma_f32_16x16x32_bf16 v[108:111], v[156:159], v[164:167], v[108:111]
v_mfma_f32_16x16x32_bf16 v[92:95], v[156:159], v[168:171], v[92:95]
v_mfma_f32_16x16x32_bf16 v[124:127], v[156:159], v[172:175], v[124:127]
s_waitcnt lgkmcnt(6)
v_mfma_f32_16x16x32_bf16 v[64:67], v[32:35], v[48:51], v[64:67]
ds_read_b128 v[144:147], v133 offset:0
s_waitcnt lgkmcnt(6)
v_mfma_f32_16x16x32_bf16 v[96:99], v[32:35], v[52:55], v[96:99]
ds_read_b128 v[160:163], v135 offset:0
s_waitcnt lgkmcnt(6)
v_mfma_f32_16x16x32_bf16 v[80:83], v[32:35], v[56:59], v[80:83]
ds_read_b128 v[164:167], v135 offset:2048
s_waitcnt lgkmcnt(6)
v_mfma_f32_16x16x32_bf16 v[112:115], v[32:35], v[60:63], v[112:115]
ds_read_b128 v[168:171], v135 offset:4096
s_waitcnt lgkmcnt(6)
v_mfma_f32_16x16x32_bf16 v[68:71], v[36:39], v[48:51], v[68:71]
ds_read_b128 v[172:175], v135 offset:6144
v_mfma_f32_16x16x32_bf16 v[100:103], v[36:39], v[52:55], v[100:103]
ds_read_b128 v[148:151], v133 offset:2048
v_mfma_f32_16x16x32_bf16 v[84:87], v[36:39], v[56:59], v[84:87]
ds_read_b128 v[152:155], v133 offset:4096
v_mfma_f32_16x16x32_bf16 v[116:119], v[36:39], v[60:63], v[116:119]
ds_read_b128 v[156:159], v133 offset:6144
s_waitcnt lgkmcnt(9)
v_mfma_f32_16x16x32_bf16 v[72:75], v[40:43], v[48:51], v[72:75]
v_mfma_f32_16x16x32_bf16 v[104:107], v[40:43], v[52:55], v[104:107]
v_mfma_f32_16x16x32_bf16 v[88:91], v[40:43], v[56:59], v[88:91]
v_mfma_f32_16x16x32_bf16 v[120:123], v[40:43], v[60:63], v[120:123]
s_waitcnt lgkmcnt(8)
v_mfma_f32_16x16x32_bf16 v[76:79], v[44:47], v[48:51], v[76:79]
v_mfma_f32_16x16x32_bf16 v[108:111], v[44:47], v[52:55], v[108:111]
v_mfma_f32_16x16x32_bf16 v[92:95], v[44:47], v[56:59], v[92:95]
v_mfma_f32_16x16x32_bf16 v[124:127], v[44:47], v[60:63], v[124:127]
s_waitcnt lgkmcnt(0)
s_barrier
v_mfma_f32_16x16x32_bf16 v[64:67], v[144:147], v[160:163], v[64:67]
ds_read_b128 v[32:35], v128 offset:0
v_mfma_f32_16x16x32_bf16 v[96:99], v[144:147], v[164:167], v[96:99]
ds_read_b128 v[48:51], v130 offset:0
v_mfma_f32_16x16x32_bf16 v[80:83], v[144:147], v[168:171], v[80:83]
ds_read_b128 v[52:55], v130 offset:2048
v_mfma_f32_16x16x32_bf16 v[112:115], v[144:147], v[172:175], v[112:115]
ds_read_b128 v[56:59], v130 offset:4096
v_mfma_f32_16x16x32_bf16 v[68:71], v[148:151], v[160:163], v[68:71]
ds_read_b128 v[60:63], v130 offset:6144
v_mfma_f32_16x16x32_bf16 v[100:103], v[148:151], v[164:167], v[100:103]
ds_read_b128 v[36:39], v128 offset:2048
v_mfma_f32_16x16x32_bf16 v[84:87], v[148:151], v[168:171], v[84:87]
ds_read_b128 v[40:43], v128 offset:4096
v_mfma_f32_16x16x32_bf16 v[116:119], v[148:151], v[172:175], v[116:119]
ds_read_b128 v[44:47], v128 offset:6144
v_mfma_f32_16x16x32_bf16 v[72:75], v[152:155], v[160:163], v[72:75]
v_mfma_f32_16x16x32_bf16 v[104:107], v[152:155], v[164:167], v[104:107]
v_mfma_f32_16x16x32_bf16 v[88:91], v[152:155], v[168:171], v[88:91]
v_mfma_f32_16x16x32_bf16 v[120:123], v[152:155], v[172:175], v[120:123]
v_mfma_f32_16x16x32_bf16 v[76:79], v[156:159], v[160:163], v[76:79]
v_mfma_f32_16x16x32_bf16 v[108:111], v[156:159], v[164:167], v[108:111]
v_mfma_f32_16x16x32_bf16 v[92:95], v[156:159], v[168:171], v[92:95]
v_mfma_f32_16x16x32_bf16 v[124:127], v[156:159], v[172:175], v[124:127]
s_waitcnt lgkmcnt(6)
v_mfma_f32_16x16x32_bf16 v[64:67], v[32:35], v[48:51], v[64:67]
ds_read_b128 v[144:147], v129 offset:0
s_waitcnt lgkmcnt(6)
v_mfma_f32_16x16x32_bf16 v[96:99], v[32:35], v[52:55], v[96:99]
ds_read_b128 v[160:163], v131 offset:0
s_waitcnt lgkmcnt(6)
v_mfma_f32_16x16x32_bf16 v[80:83], v[32:35], v[56:59], v[80:83]
ds_read_b128 v[164:167], v131 offset:2048
s_waitcnt lgkmcnt(6)
v_mfma_f32_16x16x32_bf16 v[112:115], v[32:35], v[60:63], v[112:115]
ds_read_b128 v[168:171], v131 offset:4096
s_waitcnt lgkmcnt(6)
v_mfma_f32_16x16x32_bf16 v[68:71], v[36:39], v[48:51], v[68:71]
ds_read_b128 v[172:175], v131 offset:6144
v_mfma_f32_16x16x32_bf16 v[100:103], v[36:39], v[52:55], v[100:103]
ds_read_b128 v[148:151], v129 offset:2048
v_mfma_f32_16x16x32_bf16 v[84:87], v[36:39], v[56:59], v[84:87]
ds_read_b128 v[152:155], v129 offset:4096
v_mfma_f32_16x16x32_bf16 v[116:119], v[36:39], v[60:63], v[116:119]
ds_read_b128 v[156:159], v129 offset:6144
s_waitcnt lgkmcnt(9)
v_mfma_f32_16x16x32_bf16 v[72:75], v[40:43], v[48:51], v[72:75]
v_mfma_f32_16x16x32_bf16 v[104:107], v[40:43], v[52:55], v[104:107]
v_mfma_f32_16x16x32_bf16 v[88:91], v[40:43], v[56:59], v[88:91]
v_mfma_f32_16x16x32_bf16 v[120:123], v[40:43], v[60:63], v[120:123]
s_waitcnt lgkmcnt(8)
v_mfma_f32_16x16x32_bf16 v[76:79], v[44:47], v[48:51], v[76:79]
v_mfma_f32_16x16x32_bf16 v[108:111], v[44:47], v[52:55], v[108:111]
v_mfma_f32_16x16x32_bf16 v[92:95], v[44:47], v[56:59], v[92:95]
v_mfma_f32_16x16x32_bf16 v[124:127], v[44:47], v[60:63], v[124:127]
s_waitcnt lgkmcnt(0)
s_barrier
v_mfma_f32_16x16x32_bf16 v[64:67], v[144:147], v[160:163], v[64:67]
ds_read_b128 v[32:35], v128 offset:32768
v_mfma_f32_16x16x32_bf16 v[96:99], v[144:147], v[164:167], v[96:99]
ds_read_b128 v[48:51], v130 offset:32768
v_mfma_f32_16x16x32_bf16 v[80:83], v[144:147], v[168:171], v[80:83]
ds_read_b128 v[52:55], v130 offset:34816
v_mfma_f32_16x16x32_bf16 v[112:115], v[144:147], v[172:175], v[112:115]
ds_read_b128 v[56:59], v130 offset:36864
v_mfma_f32_16x16x32_bf16 v[68:71], v[148:151], v[160:163], v[68:71]
ds_read_b128 v[60:63], v130 offset:38912
v_mfma_f32_16x16x32_bf16 v[100:103], v[148:151], v[164:167], v[100:103]
ds_read_b128 v[36:39], v128 offset:34816
v_mfma_f32_16x16x32_bf16 v[84:87], v[148:151], v[168:171], v[84:87]
ds_read_b128 v[40:43], v128 offset:36864
v_mfma_f32_16x16x32_bf16 v[116:119], v[148:151], v[172:175], v[116:119]
ds_read_b128 v[44:47], v128 offset:38912
v_mfma_f32_16x16x32_bf16 v[72:75], v[152:155], v[160:163], v[72:75]
v_mfma_f32_16x16x32_bf16 v[104:107], v[152:155], v[164:167], v[104:107]
v_mfma_f32_16x16x32_bf16 v[88:91], v[152:155], v[168:171], v[88:91]
v_mfma_f32_16x16x32_bf16 v[120:123], v[152:155], v[172:175], v[120:123]
v_mfma_f32_16x16x32_bf16 v[76:79], v[156:159], v[160:163], v[76:79]
v_mfma_f32_16x16x32_bf16 v[108:111], v[156:159], v[164:167], v[108:111]
v_mfma_f32_16x16x32_bf16 v[92:95], v[156:159], v[168:171], v[92:95]
v_mfma_f32_16x16x32_bf16 v[124:127], v[156:159], v[172:175], v[124:127]
v_mov_b32 v8, 0
global_load_dword v9, v8, s[30:31] sc1
s_waitcnt lgkmcnt(6)
v_mfma_f32_16x16x32_bf16 v[64:67], v[32:35], v[48:51], v[64:67]
ds_read_b128 v[144:147], v129 offset:32768
s_waitcnt lgkmcnt(6)
v_mfma_f32_16x16x32_bf16 v[96:99], v[32:35], v[52:55], v[96:99]
ds_read_b128 v[160:163], v131 offset:32768
s_waitcnt lgkmcnt(6)
v_mfma_f32_16x16x32_bf16 v[80:83], v[32:35], v[56:59], v[80:83]
ds_read_b128 v[164:167], v131 offset:34816
s_waitcnt lgkmcnt(6)
v_mfma_f32_16x16x32_bf16 v[112:115], v[32:35], v[60:63], v[112:115]
ds_read_b128 v[168:171], v131 offset:36864
s_waitcnt lgkmcnt(6)
v_mfma_f32_16x16x32_bf16 v[68:71], v[36:39], v[48:51], v[68:71]
ds_read_b128 v[172:175], v131 offset:38912
v_mfma_f32_16x16x32_bf16 v[100:103], v[36:39], v[52:55], v[100:103]
ds_read_b128 v[148:151], v129 offset:34816
v_mfma_f32_16x16x32_bf16 v[84:87], v[36:39], v[56:59], v[84:87]
ds_read_b128 v[152:155], v129 offset:36864
v_mfma_f32_16x16x32_bf16 v[116:119], v[36:39], v[60:63], v[116:119]
ds_read_b128 v[156:159], v129 offset:38912
s_waitcnt lgkmcnt(9)
v_mfma_f32_16x16x32_bf16 v[72:75], v[40:43], v[48:51], v[72:75]
v_mfma_f32_16x16x32_bf16 v[104:107], v[40:43], v[52:55], v[104:107]
v_mfma_f32_16x16x32_bf16 v[88:91], v[40:43], v[56:59], v[88:91]
v_mfma_f32_16x16x32_bf16 v[120:123], v[40:43], v[60:63], v[120:123]
s_waitcnt lgkmcnt(8)
v_mfma_f32_16x16x32_bf16 v[76:79], v[44:47], v[48:51], v[76:79]
v_mfma_f32_16x16x32_bf16 v[108:111], v[44:47], v[52:55], v[108:111]
v_mfma_f32_16x16x32_bf16 v[92:95], v[44:47], v[56:59], v[92:95]
v_mfma_f32_16x16x32_bf16 v[124:127], v[44:47], v[60:63], v[124:127]
s_waitcnt lgkmcnt(0)
s_barrier
v_mfma_f32_16x16x32_bf16 v[64:67], v[144:147], v[160:163], v[64:67]
ds_read_b128 v[32:35], v132 offset:0
v_mfma_f32_16x16x32_bf16 v[96:99], v[144:147], v[164:167], v[96:99]
ds_read_b128 v[48:51], v134 offset:0
v_mfma_f32_16x16x32_bf16 v[80:83], v[144:147], v[168:171], v[80:83]
ds_read_b128 v[52:55], v134 offset:2048
v_mfma_f32_16x16x32_bf16 v[112:115], v[144:147], v[172:175], v[112:115]
ds_read_b128 v[56:59], v134 offset:4096
v_mfma_f32_16x16x32_bf16 v[68:71], v[148:151], v[160:163], v[68:71]
ds_read_b128 v[60:63], v134 offset:6144
v_mfma_f32_16x16x32_bf16 v[100:103], v[148:151], v[164:167], v[100:103]
ds_read_b128 v[36:39], v132 offset:2048
v_mfma_f32_16x16x32_bf16 v[84:87], v[148:151], v[168:171], v[84:87]
ds_read_b128 v[40:43], v132 offset:4096
v_mfma_f32_16x16x32_bf16 v[116:119], v[148:151], v[172:175], v[116:119]
ds_read_b128 v[44:47], v132 offset:6144
v_mfma_f32_16x16x32_bf16 v[72:75], v[152:155], v[160:163], v[72:75]
v_mfma_f32_16x16x32_bf16 v[104:107], v[152:155], v[164:167], v[104:107]
v_mfma_f32_16x16x32_bf16 v[88:91], v[152:155], v[168:171], v[88:91]
v_mfma_f32_16x16x32_bf16 v[120:123], v[152:155], v[172:175], v[120:123]
v_mfma_f32_16x16x32_bf16 v[76:79], v[156:159], v[160:163], v[76:79]
v_mfma_f32_16x16x32_bf16 v[108:111], v[156:159], v[164:167], v[108:111]
v_mfma_f32_16x16x32_bf16 v[92:95], v[156:159], v[168:171], v[92:95]
v_mfma_f32_16x16x32_bf16 v[124:127], v[156:159], v[172:175], v[124:127]
s_waitcnt lgkmcnt(6)
v_mfma_f32_16x16x32_bf16 v[64:67], v[32:35], v[48:51], v[64:67]
ds_read_b128 v[144:147], v133 offset:0
s_waitcnt lgkmcnt(6)
v_mfma_f32_16x16x32_bf16 v[96:99], v[32:35], v[52:55], v[96:99]
ds_read_b128 v[160:163], v135 offset:0
s_waitcnt lgkmcnt(6)
v_mfma_f32_16x16x32_bf16 v[80:83], v[32:35], v[56:59], v[80:83]
ds_read_b128 v[164:167], v135 offset:2048
s_waitcnt lgkmcnt(6)
v_mfma_f32_16x16x32_bf16 v[112:115], v[32:35], v[60:63], v[112:115]
ds_read_b128 v[168:171], v135 offset:4096
s_waitcnt lgkmcnt(6)
v_mfma_f32_16x16x32_bf16 v[68:71], v[36:39], v[48:51], v[68:71]
ds_read_b128 v[172:175], v135 offset:6144
v_mfma_f32_16x16x32_bf16 v[100:103], v[36:39], v[52:55], v[100:103]
ds_read_b128 v[148:151], v133 offset:2048
v_mfma_f32_16x16x32_bf16 v[84:87], v[36:39], v[56:59], v[84:87]
ds_read_b128 v[152:155], v133 offset:4096
v_mfma_f32_16x16x32_bf16 v[116:119], v[36:39], v[60:63], v[116:119]
ds_read_b128 v[156:159], v133 offset:6144
s_waitcnt lgkmcnt(9)
v_mfma_f32_16x16x32_bf16 v[72:75], v[40:43], v[48:51], v[72:75]
v_mfma_f32_16x16x32_bf16 v[104:107], v[40:43], v[52:55], v[104:107]
v_mfma_f32_16x16x32_bf16 v[88:91], v[40:43], v[56:59], v[88:91]
v_mfma_f32_16x16x32_bf16 v[120:123], v[40:43], v[60:63], v[120:123]
s_waitcnt lgkmcnt(8)
v_mfma_f32_16x16x32_bf16 v[76:79], v[44:47], v[48:51], v[76:79]
v_mfma_f32_16x16x32_bf16 v[108:111], v[44:47], v[52:55], v[108:111]
v_mfma_f32_16x16x32_bf16 v[92:95], v[44:47], v[56:59], v[92:95]
v_mfma_f32_16x16x32_bf16 v[124:127], v[44:47], v[60:63], v[124:127]
s_waitcnt lgkmcnt(0)
s_barrier
v_mfma_f32_16x16x32_bf16 v[64:67], v[144:147], v[160:163], v[64:67]
ds_read_b128 v[32:35], v128 offset:0
v_mfma_f32_16x16x32_bf16 v[96:99], v[144:147], v[164:167], v[96:99]
ds_read_b128 v[48:51], v130 offset:0
v_mfma_f32_16x16x32_bf16 v[80:83], v[144:147], v[168:171], v[80:83]
ds_read_b128 v[52:55], v130 offset:2048
v_mfma_f32_16x16x32_bf16 v[112:115], v[144:147], v[172:175], v[112:115]
ds_read_b128 v[56:59], v130 offset:4096
v_mfma_f32_16x16x32_bf16 v[68:71], v[148:151], v[160:163], v[68:71]
ds_read_b128 v[60:63], v130 offset:6144
v_mfma_f32_16x16x32_bf16 v[100:103], v[148:151], v[164:167], v[100:103]
ds_read_b128 v[36:39], v128 offset:2048
v_mfma_f32_16x16x32_bf16 v[84:87], v[148:151], v[168:171], v[84:87]
ds_read_b128 v[40:43], v128 offset:4096
v_mfma_f32_16x16x32_bf16 v[116:119], v[148:151], v[172:175], v[116:119]
ds_read_b128 v[44:47], v128 offset:6144
v_mfma_f32_16x16x32_bf16 v[72:75], v[152:155], v[160:163], v[72:75]
v_mfma_f32_16x16x32_bf16 v[104:107], v[152:155], v[164:167], v[104:107]
v_mfma_f32_16x16x32_bf16 v[88:91], v[152:155], v[168:171], v[88:91]
v_mfma_f32_16x16x32_bf16 v[120:123], v[152:155], v[172:175], v[120:123]
v_mfma_f32_16x16x32_bf16 v[76:79], v[156:159], v[160:163], v[76:79]
v_mfma_f32_16x16x32_bf16 v[108:111], v[156:159], v[164:167], v[108:111]
v_mfma_f32_16x16x32_bf16 v[92:95], v[156:159], v[168:171], v[92:95]
v_mfma_f32_16x16x32_bf16 v[124:127], v[156:159], v[172:175], v[124:127]
s_waitcnt lgkmcnt(6)
v_mfma_f32_16x16x32_bf16 v[64:67], v[32:35], v[48:51], v[64:67]
ds_read_b128 v[144:147], v129 offset:0
s_waitcnt lgkmcnt(6)
v_mfma_f32_16x16x32_bf16 v[96:99], v[32:35], v[52:55], v[96:99]
ds_read_b128 v[160:163], v131 offset:0
s_waitcnt lgkmcnt(6)
v_mfma_f32_16x16x32_bf16 v[80:83], v[32:35], v[56:59], v[80:83]
ds_read_b128 v[164:167], v131 offset:2048
s_waitcnt lgkmcnt(6)
v_mfma_f32_16x16x32_bf16 v[112:115], v[32:35], v[60:63], v[112:115]
ds_read_b128 v[168:171], v131 offset:4096
s_waitcnt lgkmcnt(6)
v_mfma_f32_16x16x32_bf16 v[68:71], v[36:39], v[48:51], v[68:71]
ds_read_b128 v[172:175], v131 offset:6144
v_mfma_f32_16x16x32_bf16 v[100:103], v[36:39], v[52:55], v[100:103]
ds_read_b128 v[148:151], v129 offset:2048
v_mfma_f32_16x16x32_bf16 v[84:87], v[36:39], v[56:59], v[84:87]
ds_read_b128 v[152:155], v129 offset:4096
v_mfma_f32_16x16x32_bf16 v[116:119], v[36:39], v[60:63], v[116:119]
ds_read_b128 v[156:159], v129 offset:6144
s_waitcnt lgkmcnt(9)
v_mfma_f32_16x16x32_bf16 v[72:75], v[40:43], v[48:51], v[72:75]
v_mfma_f32_16x16x32_bf16 v[104:107], v[40:43], v[52:55], v[104:107]
v_mfma_f32_16x16x32_bf16 v[88:91], v[40:43], v[56:59], v[88:91]
v_mfma_f32_16x16x32_bf16 v[120:123], v[40:43], v[60:63], v[120:123]
s_waitcnt lgkmcnt(8)
v_mfma_f32_16x16x32_bf16 v[76:79], v[44:47], v[48:51], v[76:79]
v_mfma_f32_16x16x32_bf16 v[108:111], v[44:47], v[52:55], v[108:111]
v_mfma_f32_16x16x32_bf16 v[92:95], v[44:47], v[56:59], v[92:95]
v_mfma_f32_16x16x32_bf16 v[124:127], v[44:47], v[60:63], v[124:127]
L_n49:
s_waitcnt vmcnt(0)
v_readfirstlane_b32 s37, v9
s_nop 0
s_cmp_lg_u32 s37, 0
s_cbranch_scc1 L_ng50
global_load_dword v9, v8, s[30:31] sc1
s_branch L_n49
L_ng50:
s_getreg_b32 s60, hwreg(HW_REG_XCC_ID, 0, 4)
s_lshl_b32 s61, s37, 4
s_or_b32 s100, s60, s61
v_mov_b32 v194, s100
v_mov_b32 v202, s37
v_mov_b32 v203, s37
s_waitcnt lgkmcnt(0)
v_mfma_f32_16x16x32_bf16 v[64:67], v[144:147], v[160:163], v[64:67]
v_mfma_f32_16x16x32_bf16 v[96:99], v[144:147], v[164:167], v[96:99]
v_mfma_f32_16x16x32_bf16 v[80:83], v[144:147], v[168:171], v[80:83]
v_mfma_f32_16x16x32_bf16 v[112:115], v[144:147], v[172:175], v[112:115]
v_mfma_f32_16x16x32_bf16 v[68:71], v[148:151], v[160:163], v[68:71]
v_mfma_f32_16x16x32_bf16 v[100:103], v[148:151], v[164:167], v[100:103]
v_mfma_f32_16x16x32_bf16 v[84:87], v[148:151], v[168:171], v[84:87]
v_mfma_f32_16x16x32_bf16 v[116:119], v[148:151], v[172:175], v[116:119]
v_mfma_f32_16x16x32_bf16 v[72:75], v[152:155], v[160:163], v[72:75]
v_mfma_f32_16x16x32_bf16 v[104:107], v[152:155], v[164:167], v[104:107]
v_mfma_f32_16x16x32_bf16 v[88:91], v[152:155], v[168:171], v[88:91]
v_mfma_f32_16x16x32_bf16 v[120:123], v[152:155], v[172:175], v[120:123]
v_mfma_f32_16x16x32_bf16 v[76:79], v[156:159], v[160:163], v[76:79]
v_mfma_f32_16x16x32_bf16 v[108:111], v[156:159], v[164:167], v[108:111]
v_mfma_f32_16x16x32_bf16 v[92:95], v[156:159], v[168:171], v[92:95]
v_mfma_f32_16x16x32_bf16 v[124:127], v[156:159], v[172:175], v[124:127]
v_pk_fma_f32 v[40:41], v[20:21], v[64:65], v[66:67] op_sel_hi:[0,1,1]
v_pk_fma_f32 v[42:43], v[20:21], v[80:81], v[82:83] op_sel_hi:[0,1,1]
v_pk_fma_f32 v[44:45], v[22:23], v[96:97], v[98:99] op_sel_hi:[0,1,1]
v_pk_fma_f32 v[46:47], v[22:23], v[112:113], v[114:115] op_sel_hi:[0,1,1]
v_pk_fma_f32 v[66:67], v[20:21], v[80:81], v[40:41] op_sel:[1,0,0] neg_lo:[1,0,0] neg_hi:[1,0,0]
v_pk_fma_f32 v[82:83], v[20:21], v[64:65], v[42:43] op_sel:[1,0,0]
v_pk_fma_f32 v[98:99], v[22:23], v[112:113], v[44:45] op_sel:[1,0,0] neg_lo:[1,0,0] neg_hi:[1,0,0]
v_pk_fma_f32 v[114:115], v[22:23], v[96:97], v[46:47] op_sel:[1,0,0]
v_pk_fma_f32 v[40:41], v[20:21], v[66:67], v[68:69] op_sel_hi:[0,1,1]
v_pk_fma_f32 v[42:43], v[20:21], v[82:83], v[84:85] op_sel_hi:[0,1,1]
v_pk_fma_f32 v[44:45], v[22:23], v[98:99], v[100:101] op_sel_hi:[0,1,1]
v_pk_fma_f32 v[46:47], v[22:23], v[114:115], v[116:117] op_sel_hi:[0,1,1]
v_pk_fma_f32 v[68:69], v[20:21], v[82:83], v[40:41] op_sel:[1,0,0] neg_lo:[1,0,0] neg_hi:[1,0,0]
v_pk_fma_f32 v[84:85], v[20:21], v[66:67], v[42:43] op_sel:[1,0,0]
v_pk_fma_f32 v[100:101], v[22:23], v[114:115], v[44:45] op_sel:[1,0,0] neg_lo:[1,0,0] neg_hi:[1,0,0]
v_pk_fma_f32 v[116:117], v[22:23], v[98:99], v[46:47] op_sel:[1,0,0]
v_pk_fma_f32 v[40:41], v[20:21], v[68:69], v[70:71] op_sel_hi:[0,1,1]
v_pk_fma_f32 v[42:43], v[20:21], v[84:85], v[86:87] op_sel_hi:[0,1,1]
v_pk_fma_f32 v[44:45], v[22:23], v[100:101], v[102:103] op_sel_hi:[0,1,1]
v_pk_fma_f32 v[46:47], v[22:23], v[116:117], v[118:119] op_sel_hi:[0,1,1]
v_pk_fma_f32 v[70:71], v[20:21], v[84:85], v[40:41] op_sel:[1,0,0] neg_lo:[1,0,0] neg_hi:[1,0,0]
v_pk_fma_f32 v[86:87], v[20:21], v[68:69], v[42:43] op_sel:[1,0,0]
v_pk_fma_f32 v[102:103], v[22:23], v[116:117], v[44:45] op_sel:[1,0,0] neg_lo:[1,0,0] neg_hi:[1,0,0]
v_pk_fma_f32 v[118:119], v[22:23], v[100:101], v[46:47] op_sel:[1,0,0]
v_pk_fma_f32 v[40:41], v[20:21], v[70:71], v[72:73] op_sel_hi:[0,1,1]
v_pk_fma_f32 v[42:43], v[20:21], v[86:87], v[88:89] op_sel_hi:[0,1,1]
v_pk_fma_f32 v[44:45], v[22:23], v[102:103], v[104:105] op_sel_hi:[0,1,1]
v_pk_fma_f32 v[46:47], v[22:23], v[118:119], v[120:121] op_sel_hi:[0,1,1]
v_pk_fma_f32 v[72:73], v[20:21], v[86:87], v[40:41] op_sel:[1,0,0] neg_lo:[1,0,0] neg_hi:[1,0,0]
v_pk_fma_f32 v[88:89], v[20:21], v[70:71], v[42:43] op_sel:[1,0,0]
v_pk_fma_f32 v[104:105], v[22:23], v[118:119], v[44:45] op_sel:[1,0,0] neg_lo:[1,0,0] neg_hi:[1,0,0]
v_pk_fma_f32 v[120:121], v[22:23], v[102:103], v[46:47] op_sel:[1,0,0]
v_pk_fma_f32 v[40:41], v[20:21], v[72:73], v[74:75] op_sel_hi:[0,1,1]
v_pk_fma_f32 v[42:43], v[20:21], v[88:89], v[90:91] op_sel_hi:[0,1,1]
v_pk_fma_f32 v[44:45], v[22:23], v[104:105], v[106:107] op_sel_hi:[0,1,1]
v_pk_fma_f32 v[46:47], v[22:23], v[120:121], v[122:123] op_sel_hi:[0,1,1]
v_pk_fma_f32 v[74:75], v[20:21], v[88:89], v[40:41] op_sel:[1,0,0] neg_lo:[1,0,0] neg_hi:[1,0,0]
v_pk_fma_f32 v[90:91], v[20:21], v[72:73], v[42:43] op_sel:[1,0,0]
v_pk_fma_f32 v[106:107], v[22:23], v[120:121], v[44:45] op_sel:[1,0,0] neg_lo:[1,0,0] neg_hi:[1,0,0]
v_pk_fma_f32 v[122:123], v[22:23], v[104:105], v[46:47] op_sel:[1,0,0]
v_pk_fma_f32 v[40:41], v[20:21], v[74:75], v[76:77] op_sel_hi:[0,1,1]
v_pk_fma_f32 v[42:43], v[20:21], v[90:91], v[92:93] op_sel_hi:[0,1,1]
v_pk_fma_f32 v[44:45], v[22:23], v[106:107], v[108:109] op_sel_hi:[0,1,1]
v_pk_fma_f32 v[46:47], v[22:23], v[122:123], v[124:125] op_sel_hi:[0,1,1]
v_pk_fma_f32 v[76:77], v[20:21], v[90:91], v[40:41] op_sel:[1,0,0] neg_lo:[1,0,0] neg_hi:[1,0,0]
v_pk_fma_f32 v[92:93], v[20:21], v[74:75], v[42:43] op_sel:[1,0,0]
v_pk_fma_f32 v[108:109], v[22:23], v[122:123], v[44:45] op_sel:[1,0,0] neg_lo:[1,0,0] neg_hi:[1,0,0]
v_pk_fma_f32 v[124:125], v[22:23], v[106:107], v[46:47] op_sel:[1,0,0]
v_pk_fma_f32 v[40:41], v[20:21], v[76:77], v[78:79] op_sel_hi:[0,1,1]
v_pk_fma_f32 v[42:43], v[20:21], v[92:93], v[94:95] op_sel_hi:[0,1,1]
v_pk_fma_f32 v[44:45], v[22:23], v[108:109], v[110:111] op_sel_hi:[0,1,1]
v_pk_fma_f32 v[46:47], v[22:23], v[124:125], v[126:127] op_sel_hi:[0,1,1]
v_pk_fma_f32 v[78:79], v[20:21], v[92:93], v[40:41] op_sel:[1,0,0] neg_lo:[1,0,0] neg_hi:[1,0,0]
v_pk_fma_f32 v[94:95], v[20:21], v[76:77], v[42:43] op_sel:[1,0,0]
v_pk_fma_f32 v[110:111], v[22:23], v[124:125], v[44:45] op_sel:[1,0,0] neg_lo:[1,0,0] neg_hi:[1,0,0]
v_pk_fma_f32 v[126:127], v[22:23], v[108:109], v[46:47] op_sel:[1,0,0]
v_fma_f32 v40, v176, v78, v79
v_fma_f32 v41, v176, v94, v95
v_fma_f32 v32, -v177, v94, v40
v_fma_f32 v33, v177, v78, v41
ds_write_b64 v15, v[32:33] offset:0
v_fma_f32 v40, v178, v110, v111
v_fma_f32 v41, v178, v126, v127
v_fma_f32 v34, -v179, v126, v40
v_fma_f32 v35, v179, v110, v41
ds_write_b64 v15, v[34:35] offset:2304
s_waitcnt lgkmcnt(0)
s_mov_b64 exec, 1
v_mov_b32 v197, 17
ds_write_b32 v13, v197 offset:32
s_mov_b64 exec, -1
L_ek51:
ds_read_b128 v[198:201], v12 offset:32
s_waitcnt lgkmcnt(0)
v_min3_u32 v197, v198, v199, v200
v_min_u32 v197, v197, v201
s_nop 0
v_readfirstlane_b32 s60, v197
s_nop 0
s_cmp_lt_u32 s60, 17
s_cbranch_scc1 L_ek51
ds_read_b128 v[48:51], v14
ds_read_b128 v[52:55], v14 offset:16
s_waitcnt lgkmcnt(1)
v_fma_f32 v40, v28, v48, v50
v_fma_f32 v41, v28, v49, v51
v_fma_f32 v32, -v29, v49, v40
v_fma_f32 v33, v29, v48, v41
s_waitcnt lgkmcnt(0)
v_fma_f32 v40, v28, v32, v52
v_fma_f32 v41, v28, v33, v53
v_fma_f32 v34, -v29, v33, v40
v_fma_f32 v35, v29, v32, v41
v_fma_f32 v40, v28, v34, v54
v_fma_f32 v41, v28, v35, v55
v_fma_f32 v32, -v29, v35, v40
v_fma_f32 v33, v29, v34, v41
v_mov_b32 v34, v32
v_mov_b32 v35, v33
s_nop 0
v_permlane32_swap_b32 v32, v34
v_permlane32_swap_b32 v33, v35
v_fma_f32 v40, v192, v32, v34
v_fma_f32 v41, v192, v33, v35
v_fma_f32 v200, -v193, v33, v40
v_fma_f32 v201, v193, v32, v41
s_cmp_lg_u32 s68, 0
s_cbranch_scc1 L_np53
buffer_store_dwordx4 v[200:203], v16, s[40:43], 0 offen sc1
s_cmp_lg_u32 s66, 0
s_cbranch_scc1 L_np53
s_mov_b64 exec, 1
global_store_dword v195, v194, s[32:33] sc1
s_mov_b64 exec, -1
L_np53:
global_load_dword v243, v18, s[32:33] sc1
v_add_u32 v15, -56, v15
ds_read_b64 v[32:33], v15 offset:0
ds_read_b64 v[34:35], v15 offset:8
ds_read_b64 v[36:37], v15 offset:16
ds_read_b64 v[38:39], v15 offset:24
ds_read_b64 v[40:41], v15 offset:32
ds_read_b64 v[42:43], v15 offset:40
ds_read_b64 v[44:45], v15 offset:48
ds_read_b64 v[46:47], v15 offset:2304
ds_read_b64 v[48:49], v15 offset:2312
ds_read_b64 v[50:51], v15 offset:2320
ds_read_b64 v[52:53], v15 offset:2328
ds_read_b64 v[54:55], v15 offset:2336
ds_read_b64 v[56:57], v15 offset:2344
ds_read_b64 v[58:59], v15 offset:2352
s_waitcnt lgkmcnt(0)
v_fma_f32 v60, v180, v32, v34
v_fma_f32 v61, v180, v33, v35
v_fma_f32 v34, -v181, v33, v60
v_fma_f32 v35, v181, v32, v61
v_fma_f32 v60, v180, v34, v36
v_fma_f32 v61, v180, v35, v37
v_fma_f32 v36, -v181, v35, v60
v_fma_f32 v37, v181, v34, v61
v_fma_f32 v60, v180, v36, v38
v_fma_f32 v61, v180, v37, v39
v_fma_f32 v38, -v181, v37, v60
v_fma_f32 v39, v181, v36, v61
v_fma_f32 v60, v180, v38, v40
v_fma_f32 v61, v180, v39, v41
v_fma_f32 v40, -v181, v39, v60
v_fma_f32 v41, v181, v38, v61
v_fma_f32 v60, v180, v40, v42
v_fma_f32 v61, v180, v41, v43
v_fma_f32 v42, -v181, v41, v60
v_fma_f32 v43, v181, v40, v61
v_fma_f32 v60, v180, v42, v44
v_fma_f32 v61, v180, v43, v45
v_fma_f32 v128, -v181, v43, v60
v_fma_f32 v130, v181, v42, v61
v_fma_f32 v60, v176, v128, v78
v_fma_f32 v61, v176, v130, v94
v_fma_f32 v129, -v177, v130, v60
v_fma_f32 v131, v177, v128, v61
v_fma_f32 v60, v182, v46, v48
v_fma_f32 v61, v182, v47, v49
v_fma_f32 v48, -v183, v47, v60
v_fma_f32 v49, v183, v46, v61
v_fma_f32 v60, v182, v48, v50
v_fma_f32 v61, v182, v49, v51
v_fma_f32 v50, -v183, v49, v60
v_fma_f32 v51, v183, v48, v61
v_fma_f32 v60, v182, v50, v52
v_fma_f32 v61, v182, v51, v53
v_fma_f32 v52, -v183, v51, v60
v_fma_f32 v53, v183, v50, v61
v_fma_f32 v60, v182, v52, v54
v_fma_f32 v61, v182, v53, v55
v_fma_f32 v54, -v183, v53, v60
v_fma_f32 v55, v183, v52, v61
v_fma_f32 v60, v182, v54, v56
v_fma_f32 v61, v182, v55, v57
v_fma_f32 v56, -v183, v55, v60
v_fma_f32 v57, v183, v54, v61
v_fma_f32 v60, v182, v56, v58
v_fma_f32 v61, v182, v57, v59
v_fma_f32 v132, -v183, v57, v60
v_fma_f32 v134, v183, v56, v61
v_fma_f32 v60, v178, v132, v110
v_fma_f32 v61, v178, v134, v126
v_fma_f32 v133, -v179, v134, v60
v_fma_f32 v135, v179, v132, v61
v_pk_mul_f32 v[32:33], v[24:25], v[64:65] op_sel_hi:[0,1]
v_pk_mul_f32 v[34:35], v[24:25], v[80:81] op_sel_hi:[0,1] neg_lo:[1,0] neg_hi:[1,0]
v_pk_fma_f32 v[34:35], v[24:25], v[64:65], v[34:35] op_sel:[1,0,0] neg_lo:[1,0,0] neg_hi:[1,0,0]
v_pk_fma_f32 v[64:65], v[24:25], v[80:81], v[32:33] op_sel:[1,0,0] neg_lo:[1,0,0] neg_hi:[1,0,0]
v_mov_b64 v[80:81], v[34:35]
v_pk_mul_f32 v[36:37], v[26:27], v[96:97] op_sel_hi:[0,1]
v_pk_mul_f32 v[38:39], v[26:27], v[112:113] op_sel_hi:[0,1] neg_lo:[1,0] neg_hi:[1,0]
v_pk_fma_f32 v[38:39], v[26:27], v[96:97], v[38:39] op_sel:[1,0,0] neg_lo:[1,0,0] neg_hi:[1,0,0]
v_pk_fma_f32 v[96:97], v[26:27], v[112:113], v[36:37] op_sel:[1,0,0] neg_lo:[1,0,0] neg_hi:[1,0,0]
v_mov_b64 v[112:113], v[38:39]
v_pk_mul_f32 v[32:33], v[24:25], v[66:67] op_sel_hi:[0,1]
v_pk_mul_f32 v[34:35], v[24:25], v[82:83] op_sel_hi:[0,1] neg_lo:[1,0] neg_hi:[1,0]
v_pk_fma_f32 v[34:35], v[24:25], v[66:67], v[34:35] op_sel:[1,0,0] neg_lo:[1,0,0] neg_hi:[1,0,0]
v_pk_fma_f32 v[66:67], v[24:25], v[82:83], v[32:33] op_sel:[1,0,0] neg_lo:[1,0,0] neg_hi:[1,0,0]
v_mov_b64 v[82:83], v[34:35]
v_pk_mul_f32 v[36:37], v[26:27], v[98:99] op_sel_hi:[0,1]
v_pk_mul_f32 v[38:39], v[26:27], v[114:115] op_sel_hi:[0,1] neg_lo:[1,0] neg_hi:[1,0]
v_pk_fma_f32 v[38:39], v[26:27], v[98:99], v[38:39] op_sel:[1,0,0] neg_lo:[1,0,0] neg_hi:[1,0,0]
v_pk_fma_f32 v[98:99], v[26:27], v[114:115], v[36:37] op_sel:[1,0,0] neg_lo:[1,0,0] neg_hi:[1,0,0]
v_mov_b64 v[114:115], v[38:39]
v_pk_mul_f32 v[32:33], v[24:25], v[68:69] op_sel_hi:[0,1]
v_pk_mul_f32 v[34:35], v[24:25], v[84:85] op_sel_hi:[0,1] neg_lo:[1,0] neg_hi:[1,0]
v_pk_fma_f32 v[34:35], v[24:25], v[68:69], v[34:35] op_sel:[1,0,0] neg_lo:[1,0,0] neg_hi:[1,0,0]
v_pk_fma_f32 v[68:69], v[24:25], v[84:85], v[32:33] op_sel:[1,0,0] neg_lo:[1,0,0] neg_hi:[1,0,0]
v_mov_b64 v[84:85], v[34:35]
v_pk_mul_f32 v[36:37], v[26:27], v[100:101] op_sel_hi:[0,1]
v_pk_mul_f32 v[38:39], v[26:27], v[116:117] op_sel_hi:[0,1] neg_lo:[1,0] neg_hi:[1,0]
v_pk_fma_f32 v[38:39], v[26:27], v[100:101], v[38:39] op_sel:[1,0,0] neg_lo:[1,0,0] neg_hi:[1,0,0]
v_pk_fma_f32 v[100:101], v[26:27], v[116:117], v[36:37] op_sel:[1,0,0] neg_lo:[1,0,0] neg_hi:[1,0,0]
v_mov_b64 v[116:117], v[38:39]
v_pk_mul_f32 v[32:33], v[24:25], v[70:71] op_sel_hi:[0,1]
v_pk_mul_f32 v[34:35], v[24:25], v[86:87] op_sel_hi:[0,1] neg_lo:[1,0] neg_hi:[1,0]
v_pk_fma_f32 v[34:35], v[24:25], v[70:71], v[34:35] op_sel:[1,0,0] neg_lo:[1,0,0] neg_hi:[1,0,0]
v_pk_fma_f32 v[70:71], v[24:25], v[86:87], v[32:33] op_sel:[1,0,0] neg_lo:[1,0,0] neg_hi:[1,0,0]
v_mov_b64 v[86:87], v[34:35]
v_pk_mul_f32 v[36:37], v[26:27], v[102:103] op_sel_hi:[0,1]
v_pk_mul_f32 v[38:39], v[26:27], v[118:119] op_sel_hi:[0,1] neg_lo:[1,0] neg_hi:[1,0]
v_pk_fma_f32 v[38:39], v[26:27], v[102:103], v[38:39] op_sel:[1,0,0] neg_lo:[1,0,0] neg_hi:[1,0,0]
v_pk_fma_f32 v[102:103], v[26:27], v[118:119], v[36:37] op_sel:[1,0,0] neg_lo:[1,0,0] neg_hi:[1,0,0]
v_mov_b64 v[118:119], v[38:39]
v_pk_mul_f32 v[32:33], v[24:25], v[72:73] op_sel_hi:[0,1]
v_pk_mul_f32 v[34:35], v[24:25], v[88:89] op_sel_hi:[0,1] neg_lo:[1,0] neg_hi:[1,0]
v_pk_fma_f32 v[34:35], v[24:25], v[72:73], v[34:35] op_sel:[1,0,0] neg_lo:[1,0,0] neg_hi:[1,0,0]
v_pk_fma_f32 v[72:73], v[24:25], v[88:89], v[32:33] op_sel:[1,0,0] neg_lo:[1,0,0] neg_hi:[1,0,0]
v_mov_b64 v[88:89], v[34:35]
v_pk_mul_f32 v[36:37], v[26:27], v[104:105] op_sel_hi:[0,1]
v_pk_mul_f32 v[38:39], v[26:27], v[120:121] op_sel_hi:[0,1] neg_lo:[1,0] neg_hi:[1,0]
v_pk_fma_f32 v[38:39], v[26:27], v[104:105], v[38:39] op_sel:[1,0,0] neg_lo:[1,0,0] neg_hi:[1,0,0]
v_pk_fma_f32 v[104:105], v[26:27], v[120:121], v[36:37] op_sel:[1,0,0] neg_lo:[1,0,0] neg_hi:[1,0,0]
v_mov_b64 v[120:121], v[38:39]
v_pk_mul_f32 v[32:33], v[24:25], v[74:75] op_sel_hi:[0,1]
v_pk_mul_f32 v[34:35], v[24:25], v[90:91] op_sel_hi:[0,1] neg_lo:[1,0] neg_hi:[1,0]
v_pk_fma_f32 v[34:35], v[24:25], v[74:75], v[34:35] op_sel:[1,0,0] neg_lo:[1,0,0] neg_hi:[1,0,0]
v_pk_fma_f32 v[74:75], v[24:25], v[90:91], v[32:33] op_sel:[1,0,0] neg_lo:[1,0,0] neg_hi:[1,0,0]
v_mov_b64 v[90:91], v[34:35]
v_pk_mul_f32 v[36:37], v[26:27], v[106:107] op_sel_hi:[0,1]
v_pk_mul_f32 v[38:39], v[26:27], v[122:123] op_sel_hi:[0,1] neg_lo:[1,0] neg_hi:[1,0]
v_pk_fma_f32 v[38:39], v[26:27], v[106:107], v[38:39] op_sel:[1,0,0] neg_lo:[1,0,0] neg_hi:[1,0,0]
v_pk_fma_f32 v[106:107], v[26:27], v[122:123], v[36:37] op_sel:[1,0,0] neg_lo:[1,0,0] neg_hi:[1,0,0]
v_mov_b64 v[122:123], v[38:39]
v_pk_mul_f32 v[32:33], v[24:25], v[76:77] op_sel_hi:[0,1]
v_pk_mul_f32 v[34:35], v[24:25], v[92:93] op_sel_hi:[0,1] neg_lo:[1,0] neg_hi:[1,0]
v_pk_fma_f32 v[34:35], v[24:25], v[76:77], v[34:35] op_sel:[1,0,0] neg_lo:[1,0,0] neg_hi:[1,0,0]
v_pk_fma_f32 v[76:77], v[24:25], v[92:93], v[32:33] op_sel:[1,0,0] neg_lo:[1,0,0] neg_hi:[1,0,0]
v_mov_b64 v[92:93], v[34:35]
v_pk_mul_f32 v[36:37], v[26:27], v[108:109] op_sel_hi:[0,1]
v_pk_mul_f32 v[38:39], v[26:27], v[124:125] op_sel_hi:[0,1] neg_lo:[1,0] neg_hi:[1,0]
v_pk_fma_f32 v[38:39], v[26:27], v[108:109], v[38:39] op_sel:[1,0,0] neg_lo:[1,0,0] neg_hi:[1,0,0]
v_pk_fma_f32 v[108:109], v[26:27], v[124:125], v[36:37] op_sel:[1,0,0] neg_lo:[1,0,0] neg_hi:[1,0,0]
v_mov_b64 v[124:125], v[38:39]
v_pk_mul_f32 v[32:33], v[24:25], v[78:79] op_sel_hi:[0,1]
v_pk_mul_f32 v[34:35], v[24:25], v[94:95] op_sel_hi:[0,1] neg_lo:[1,0] neg_hi:[1,0]
v_pk_fma_f32 v[34:35], v[24:25], v[78:79], v[34:35] op_sel:[1,0,0] neg_lo:[1,0,0] neg_hi:[1,0,0]
v_pk_fma_f32 v[78:79], v[24:25], v[94:95], v[32:33] op_sel:[1,0,0] neg_lo:[1,0,0] neg_hi:[1,0,0]
v_mov_b64 v[94:95], v[34:35]
v_pk_mul_f32 v[36:37], v[26:27], v[110:111] op_sel_hi:[0,1]
v_pk_mul_f32 v[38:39], v[26:27], v[126:127] op_sel_hi:[0,1] neg_lo:[1,0] neg_hi:[1,0]
v_pk_fma_f32 v[38:39], v[26:27], v[110:111], v[38:39] op_sel:[1,0,0] neg_lo:[1,0,0] neg_hi:[1,0,0]
v_pk_fma_f32 v[110:111], v[26:27], v[126:127], v[36:37] op_sel:[1,0,0] neg_lo:[1,0,0] neg_hi:[1,0,0]
v_mov_b64 v[126:127], v[38:39]
buffer_load_dwordx4 v[144:147], v136, s[40:43], 0 offen sc1
buffer_load_dwordx4 v[148:151], v137, s[40:43], 0 offen sc1
buffer_load_dwordx4 v[152:155], v138, s[40:43], 0 offen sc1
buffer_load_dwordx4 v[156:159], v139, s[40:43], 0 offen sc1
buffer_load_dwordx4 v[160:163], v140, s[40:43], 0 offen sc1
buffer_load_dwordx4 v[164:167], v141, s[40:43], 0 offen sc1
buffer_load_dwordx4 v[168:171], v142, s[40:43], 0 offen sc1
buffer_load_dwordx4 v[172:175], v143, s[40:43], 0 offen sc1
global_load_dword v197, v196, s[32:33] sc1
v_mov_b32 v14, 1
s_mov_b64 exec, 1
ds_write_b32 v13, v14
s_mov_b64 exec, -1
s_xor_b32 s60, s68, s101
s_xor_b32 s60, s60, 1
s_lshl_b32 s60, s60, 6
s_add_u32 s60, s60, s66
v_lshrrev_b32 v8, 3, v1
v_lshl_add_u32 v8, v8, 1, s60
v_lshlrev_b32 v8, 11, v8
v_and_b32 v14, 7, v1
v_lshrrev_b32 v15, 4, v1
v_xor_b32 v14, v14, v15
v_lshlrev_b32 v14, 4, v14
v_xor_b32 v15, 64, v14
v_add_u32 v244, v8, v14
v_add_u32 v245, v8, v15
v_add_u32 v245, 31744, v245
v_add_u32 v246, v8, v14
v_add_u32 v246, 63488, v246
v_add_u32 v247, v8, v15
v_add_u32 v247, 95232, v247
s_and_b32 s64, s36, 7
s_lshl_b32 s60, s64, 18
s_lshl_b32 s61, s101, 10
s_add_u32 s60, s60, s61
s_add_u32 s48, s20, s60
s_addc_u32 s49, s21, 0
s_sub_u32 s50, 262144, s61
s_mov_b32 s51, 0x20000
s_add_u32 s52, s22, s60
s_addc_u32 s53, s23, 0
s_sub_u32 s54, 262144, s61
s_mov_b32 s55, 0x20000
s_lshl_b32 s61, s64, 1
s_add_u32 s61, s61, s101
s_lshl_b32 s61, s61, 7
s_lshl_b32 s63, s35, 1
s_add_u32 s63, s63, s68
s_lshl_b32 s60, s63, 17
s_add_u32 s60, s60, s61
s_add_u32 s56, s10, s60
s_addc_u32 s57, s11, 0
s_sub_u32 s58, 131072, s61
s_mov_b32 s59, 0x20000
s_add_u32 s26, s26, s61
s_addc_u32 s27, s27, 0
s_lshl_b32 s61, s61, 1
s_add_u32 s61, s61, 4096
s_lshl_b32 s60, s63, 19
s_add_u32 s60, s60, s61
s_add_u32 s28, s28, s60
s_addc_u32 s29, s29, 0
s_sub_u32 s24, 0x80000, s61
s_lshl_b32 s67, s34, 12
s_lshl_b32 s65, s64, 13
s_lshl_b32 s64, s64, 7
s_lshl_b32 s60, s68, 14
s_lshl_b32 s61, s66, 11
s_add_u32 s60, s60, s61
s_add_u32 s60, s60, 65536
v_add_u32 v16, s60, v10
s_lshl_b32 s60, s34, 13
s_add_u32 s60, s60, 65536
v_add_u32 v17, s60, v11
v_xor_b32 v20, 0, v7
v_add_u32 v24, 0x10000, v20
v_xor_b32 v21, 32, v7
v_add_u32 v25, 0x10000, v21
v_xor_b32 v22, 64, v7
v_add_u32 v26, 0x10000, v22
v_xor_b32 v23, 96, v7
v_add_u32 v27, 0x10000, v23
s_mul_i32 s14, s63, 262144
s_lshl_b32 s61, s36, 13
s_add_u32 s14, s14, s61
s_lshl_b32 s61, s66, 11
s_add_u32 s14, s14, s61
v_cmp_gt_u32 vcc, 0x40000, v136
s_nop 1
v_cndmask_b32 v40, 0, v202, vcc
v_cmp_gt_u32 vcc, 0x40000, v137
s_nop 1
v_cndmask_b32 v41, 0, v202, vcc
v_cmp_gt_u32 vcc, 0x40000, v138
s_nop 1
v_cndmask_b32 v42, 0, v202, vcc
v_cmp_gt_u32 vcc, 0x40000, v139
s_nop 1
v_cndmask_b32 v43, 0, v202, vcc
v_cmp_gt_u32 vcc, 0x40000, v140
s_nop 1
v_cndmask_b32 v44, 0, v202, vcc
v_cmp_gt_u32 vcc, 0x40000, v141
s_nop 1
v_cndmask_b32 v45, 0, v202, vcc
v_cmp_gt_u32 vcc, 0x40000, v142
s_nop 1
v_cndmask_b32 v46, 0, v202, vcc
v_cmp_gt_u32 vcc, 0x40000, v143
s_nop 1
v_cndmask_b32 v47, 0, v202, vcc
s_mov_b32 s69, 0
L_poll54:
v_mov_b32 v8, 0
s_waitcnt vmcnt(8)
v_bitop3_b32 v8, v8, v146, v40 bitop3:0xf6
v_bitop3_b32 v8, v8, v147, v40 bitop3:0xf6
s_waitcnt vmcnt(7)
v_bitop3_b32 v8, v8, v150, v41 bitop3:0xf6
v_bitop3_b32 v8, v8, v151, v41 bitop3:0xf6
s_waitcnt vmcnt(6)
v_bitop3_b32 v8, v8, v154, v42 bitop3:0xf6
v_bitop3_b32 v8, v8, v155, v42 bitop3:0xf6
s_waitcnt vmcnt(5)
v_bitop3_b32 v8, v8, v158, v43 bitop3:0xf6
v_bitop3_b32 v8, v8, v159, v43 bitop3:0xf6
s_waitcnt vmcnt(4)
v_bitop3_b32 v8, v8, v162, v44 bitop3:0xf6
v_bitop3_b32 v8, v8, v163, v44 bitop3:0xf6
s_waitcnt vmcnt(3)
v_bitop3_b32 v8, v8, v166, v45 bitop3:0xf6
v_bitop3_b32 v8, v8, v167, v45 bitop3:0xf6
s_waitcnt vmcnt(2)
v_bitop3_b32 v8, v8, v170, v46 bitop3:0xf6
v_bitop3_b32 v8, v8, v171, v46 bitop3:0xf6
s_waitcnt vmcnt(1)
v_bitop3_b32 v8, v8, v174, v47 bitop3:0xf6
v_bitop3_b32 v8, v8, v175, v47 bitop3:0xf6
s_waitcnt vmcnt(0)
v_xor_b32 v197, v194, v197
v_lshrrev_b32 v9, 4, v197
v_or_b32 v8, v8, v9
v_cmp_ne_u32 vcc, 0, v8
s_nop 0
s_cbranch_vccz L_polled55
s_add_u32 s69, s69, 1
s_cmp_ge_u32 s69, 200000
s_cbranch_scc1 L_polled55
buffer_load_dwordx4 v[144:147], v136, s[40:43], 0 offen sc1
buffer_load_dwordx4 v[148:151], v137, s[40:43], 0 offen sc1
buffer_load_dwordx4 v[152:155], v138, s[40:43], 0 offen sc1
buffer_load_dwordx4 v[156:159], v139, s[40:43], 0 offen sc1
buffer_load_dwordx4 v[160:163], v140, s[40:43], 0 offen sc1
buffer_load_dwordx4 v[164:167], v141, s[40:43], 0 offen sc1
buffer_load_dwordx4 v[168:171], v142, s[40:43], 0 offen sc1
buffer_load_dwordx4 v[172:175], v143, s[40:43], 0 offen sc1
global_load_dword v197, v196, s[32:33] sc1
s_branch L_poll54
L_polled55:
v_cmp_ne_u32 vcc, 0, v197
s_nop 0
s_cmp_eq_u64 vcc, 0
s_cselect_b32 s100, 1, 0
s_add_u32 m0, s67, 0
s_add_u32 s62, s64, 0
s_and_b32 s62, s62, 0x3ff
buffer_load_dwordx4 v244, s[48:51], s62 offen offset:0 lds
buffer_load_dwordx4 v245, s[48:51], s62 offen offset:1024 lds
buffer_load_dwordx4 v246, s[48:51], s62 offen offset:2048 lds
buffer_load_dwordx4 v247, s[48:51], s62 offen offset:3072 lds
s_add_u32 m0, s67, 16384
s_nop 0
buffer_load_dwordx4 v244, s[52:55], s62 offen offset:0 lds
buffer_load_dwordx4 v245, s[52:55], s62 offen offset:1024 lds
buffer_load_dwordx4 v246, s[52:55], s62 offen offset:2048 lds
buffer_load_dwordx4 v247, s[52:55], s62 offen offset:3072 lds
v_mov_b32 v14, 2
s_mov_b64 exec, 1
ds_write_b32 v13, v14
s_mov_b64 exec, -1
v_fma_f32 v40, v2, v172, v168
v_fma_f32 v41, v2, v173, v169
v_fma_f32 v48, -v3, v173, v40
v_fma_f32 v49, v3, v172, v41
v_fma_f32 v40, v2, v48, v164
v_fma_f32 v41, v2, v49, v165
v_fma_f32 v172, -v3, v49, v40
v_fma_f32 v173, v3, v48, v41
v_fma_f32 v40, v2, v172, v160
v_fma_f32 v41, v2, v173, v161
v_fma_f32 v48, -v3, v173, v40
v_fma_f32 v49, v3, v172, v41
v_fma_f32 v40, v2, v48, v156
v_fma_f32 v41, v2, v49, v157
v_fma_f32 v172, -v3, v49, v40
v_fma_f32 v173, v3, v48, v41
v_fma_f32 v40, v2, v172, v152
v_fma_f32 v41, v2, v173, v153
v_fma_f32 v48, -v3, v173, v40
v_fma_f32 v49, v3, v172, v41
v_fma_f32 v40, v2, v48, v148
v_fma_f32 v41, v2, v49, v149
v_fma_f32 v172, -v3, v49, v40
v_fma_f32 v173, v3, v48, v41
v_fma_f32 v40, v2, v172, v144
v_fma_f32 v41, v2, v173, v145
v_fma_f32 v48, -v3, v173, v40
v_fma_f32 v49, v3, v172, v41
v_mov_b32 v50, v48
v_mov_b32 v51, v49
s_nop 0
v_permlane32_swap_b32 v48, v50
v_permlane32_swap_b32 v49, v51
v_fma_f32 v40, v30, v50, v48
v_fma_f32 v41, v30, v51, v49
v_fma_f32 v52, -v31, v51, v40
v_fma_f32 v53, v31, v50, v41
v_mov_b32 v54, v52
v_mov_b32 v55, v53
s_nop 0
v_permlane16_swap_b32 v52, v54
v_permlane16_swap_b32 v53, v55
v_pk_fma_f32 v[128:129], v[52:53], v[184:185], v[128:129] op_sel_hi:[0,1,1]
v_pk_fma_f32 v[130:131], v[52:53], v[186:187], v[130:131] op_sel_hi:[0,1,1]
v_pk_fma_f32 v[128:129], v[52:53], v[186:187], v[128:129] op_sel:[1,0,0] neg_lo:[1,0,0] neg_hi:[1,0,0]
v_pk_fma_f32 v[130:131], v[52:53], v[184:185], v[130:131] op_sel:[1,0,0]
v_pk_fma_f32 v[132:133], v[54:55], v[188:189], v[132:133] op_sel_hi:[0,1,1]
v_pk_fma_f32 v[134:135], v[54:55], v[190:191], v[134:135] op_sel_hi:[0,1,1]
v_pk_fma_f32 v[132:133], v[54:55], v[190:191], v[132:133] op_sel:[1,0,0] neg_lo:[1,0,0] neg_hi:[1,0,0]
v_pk_fma_f32 v[134:135], v[54:55], v[188:189], v[134:135] op_sel:[1,0,0]
v_pk_fma_f32 v[64:65], v[208:209], v[128:129], v[64:65] op_sel_hi:[0,1,1]
v_pk_fma_f32 v[80:81], v[208:209], v[130:131], v[80:81] op_sel_hi:[0,1,1] neg_lo:[1,0,0] neg_hi:[1,0,0]
v_pk_fma_f32 v[64:65], v[208:209], v[130:131], v[64:65] op_sel:[1,0,0] neg_lo:[1,0,0] neg_hi:[1,0,0]
v_pk_fma_f32 v[80:81], v[208:209], v[128:129], v[80:81] op_sel:[1,0,0] neg_lo:[1,0,0] neg_hi:[1,0,0]
v_cvt_pk_bf16_f32 v144, v64, v65
v_cvt_pk_bf16_f32 v152, v80, v81
v_pk_fma_f32 v[96:97], v[224:225], v[132:133], v[96:97] op_sel_hi:[0,1,1]
v_pk_fma_f32 v[112:113], v[224:225], v[134:135], v[112:113] op_sel_hi:[0,1,1] neg_lo:[1,0,0] neg_hi:[1,0,0]
v_pk_fma_f32 v[96:97], v[224:225], v[134:135], v[96:97] op_sel:[1,0,0] neg_lo:[1,0,0] neg_hi:[1,0,0]
v_pk_fma_f32 v[112:113], v[224:225], v[132:133], v[112:113] op_sel:[1,0,0] neg_lo:[1,0,0] neg_hi:[1,0,0]
v_cvt_pk_bf16_f32 v160, v96, v97
v_cvt_pk_bf16_f32 v168, v112, v113
v_pk_fma_f32 v[66:67], v[210:211], v[128:129], v[66:67] op_sel_hi:[0,1,1]
v_pk_fma_f32 v[82:83], v[210:211], v[130:131], v[82:83] op_sel_hi:[0,1,1] neg_lo:[1,0,0] neg_hi:[1,0,0]
v_pk_fma_f32 v[66:67], v[210:211], v[130:131], v[66:67] op_sel:[1,0,0] neg_lo:[1,0,0] neg_hi:[1,0,0]
v_pk_fma_f32 v[82:83], v[210:211], v[128:129], v[82:83] op_sel:[1,0,0] neg_lo:[1,0,0] neg_hi:[1,0,0]
v_cvt_pk_bf16_f32 v145, v66, v67
v_cvt_pk_bf16_f32 v153, v82, v83
v_pk_fma_f32 v[98:99], v[226:227], v[132:133], v[98:99] op_sel_hi:[0,1,1]
v_pk_fma_f32 v[114:115], v[226:227], v[134:135], v[114:115] op_sel_hi:[0,1,1] neg_lo:[1,0,0] neg_hi:[1,0,0]
v_pk_fma_f32 v[98:99], v[226:227], v[134:135], v[98:99] op_sel:[1,0,0] neg_lo:[1,0,0] neg_hi:[1,0,0]
v_pk_fma_f32 v[114:115], v[226:227], v[132:133], v[114:115] op_sel:[1,0,0] neg_lo:[1,0,0] neg_hi:[1,0,0]
v_cvt_pk_bf16_f32 v161, v98, v99
v_cvt_pk_bf16_f32 v169, v114, v115
v_pk_fma_f32 v[68:69], v[212:213], v[128:129], v[68:69] op_sel_hi:[0,1,1]
v_pk_fma_f32 v[84:85], v[212:213], v[130:131], v[84:85] op_sel_hi:[0,1,1] neg_lo:[1,0,0] neg_hi:[1,0,0]
v_pk_fma_f32 v[68:69], v[212:213], v[130:131], v[68:69] op_sel:[1,0,0] neg_lo:[1,0,0] neg_hi:[1,0,0]
v_pk_fma_f32 v[84:85], v[212:213], v[128:129], v[84:85] op_sel:[1,0,0] neg_lo:[1,0,0] neg_hi:[1,0,0]
v_cvt_pk_bf16_f32 v146, v68, v69
v_cvt_pk_bf16_f32 v154, v84, v85
v_pk_fma_f32 v[100:101], v[228:229], v[132:133], v[100:101] op_sel_hi:[0,1,1]
v_pk_fma_f32 v[116:117], v[228:229], v[134:135], v[116:117] op_sel_hi:[0,1,1] neg_lo:[1,0,0] neg_hi:[1,0,0]
v_pk_fma_f32 v[100:101], v[228:229], v[134:135], v[100:101] op_sel:[1,0,0] neg_lo:[1,0,0] neg_hi:[1,0,0]
v_pk_fma_f32 v[116:117], v[228:229], v[132:133], v[116:117] op_sel:[1,0,0] neg_lo:[1,0,0] neg_hi:[1,0,0]
v_cvt_pk_bf16_f32 v162, v100, v101
v_cvt_pk_bf16_f32 v170, v116, v117
v_pk_fma_f32 v[70:71], v[214:215], v[128:129], v[70:71] op_sel_hi:[0,1,1]
v_pk_fma_f32 v[86:87], v[214:215], v[130:131], v[86:87] op_sel_hi:[0,1,1] neg_lo:[1,0,0] neg_hi:[1,0,0]
v_pk_fma_f32 v[70:71], v[214:215], v[130:131], v[70:71] op_sel:[1,0,0] neg_lo:[1,0,0] neg_hi:[1,0,0]
v_pk_fma_f32 v[86:87], v[214:215], v[128:129], v[86:87] op_sel:[1,0,0] neg_lo:[1,0,0] neg_hi:[1,0,0]
v_cvt_pk_bf16_f32 v147, v70, v71
v_cvt_pk_bf16_f32 v155, v86, v87
v_pk_fma_f32 v[102:103], v[230:231], v[132:133], v[102:103] op_sel_hi:[0,1,1]
v_pk_fma_f32 v[118:119], v[230:231], v[134:135], v[118:119] op_sel_hi:[0,1,1] neg_lo:[1,0,0] neg_hi:[1,0,0]
v_pk_fma_f32 v[102:103], v[230:231], v[134:135], v[102:103] op_sel:[1,0,0] neg_lo:[1,0,0] neg_hi:[1,0,0]
v_pk_fma_f32 v[118:119], v[230:231], v[132:133], v[118:119] op_sel:[1,0,0] neg_lo:[1,0,0] neg_hi:[1,0,0]
v_cvt_pk_bf16_f32 v163, v102, v103
v_cvt_pk_bf16_f32 v171, v118, v119
v_mfma_f32_16x16x32_bf16 v[32:35], v[144:147], v[248:251], 0
v_mfma_f32_16x16x32_bf16 v[36:39], v[160:163], v[248:251], 0
v_mfma_f32_16x16x32_bf16 v[40:43], v[144:147], v[252:255], 0
v_mfma_f32_16x16x32_bf16 v[44:47], v[160:163], v[252:255], 0
v_mfma_f32_16x16x32_bf16 v[48:51], v[152:155], v[248:251], 0
v_mfma_f32_16x16x32_bf16 v[52:55], v[168:171], v[248:251], 0
v_mfma_f32_16x16x32_bf16 v[56:59], v[152:155], v[252:255], 0
v_mfma_f32_16x16x32_bf16 v[60:63], v[168:171], v[252:255], 0
v_pk_fma_f32 v[72:73], v[216:217], v[128:129], v[72:73] op_sel_hi:[0,1,1]
v_pk_fma_f32 v[88:89], v[216:217], v[130:131], v[88:89] op_sel_hi:[0,1,1] neg_lo:[1,0,0] neg_hi:[1,0,0]
v_pk_fma_f32 v[72:73], v[216:217], v[130:131], v[72:73] op_sel:[1,0,0] neg_lo:[1,0,0] neg_hi:[1,0,0]
v_pk_fma_f32 v[88:89], v[216:217], v[128:129], v[88:89] op_sel:[1,0,0] neg_lo:[1,0,0] neg_hi:[1,0,0]
v_cvt_pk_bf16_f32 v148, v72, v73
v_cvt_pk_bf16_f32 v156, v88, v89
v_pk_fma_f32 v[104:105], v[232:233], v[132:133], v[104:105] op_sel_hi:[0,1,1]
v_pk_fma_f32 v[120:121], v[232:233], v[134:135], v[120:121] op_sel_hi:[0,1,1] neg_lo:[1,0,0] neg_hi:[1,0,0]
v_pk_fma_f32 v[104:105], v[232:233], v[134:135], v[104:105] op_sel:[1,0,0] neg_lo:[1,0,0] neg_hi:[1,0,0]
v_pk_fma_f32 v[120:121], v[232:233], v[132:133], v[120:121] op_sel:[1,0,0] neg_lo:[1,0,0] neg_hi:[1,0,0]
v_cvt_pk_bf16_f32 v164, v104, v105
v_cvt_pk_bf16_f32 v172, v120, v121
v_pk_fma_f32 v[74:75], v[218:219], v[128:129], v[74:75] op_sel_hi:[0,1,1]
v_pk_fma_f32 v[90:91], v[218:219], v[130:131], v[90:91] op_sel_hi:[0,1,1] neg_lo:[1,0,0] neg_hi:[1,0,0]
v_pk_fma_f32 v[74:75], v[218:219], v[130:131], v[74:75] op_sel:[1,0,0] neg_lo:[1,0,0] neg_hi:[1,0,0]
v_pk_fma_f32 v[90:91], v[218:219], v[128:129], v[90:91] op_sel:[1,0,0] neg_lo:[1,0,0] neg_hi:[1,0,0]
v_cvt_pk_bf16_f32 v149, v74, v75
v_cvt_pk_bf16_f32 v157, v90, v91
v_pk_fma_f32 v[106:107], v[234:235], v[132:133], v[106:107] op_sel_hi:[0,1,1]
v_pk_fma_f32 v[122:123], v[234:235], v[134:135], v[122:123] op_sel_hi:[0,1,1] neg_lo:[1,0,0] neg_hi:[1,0,0]
v_pk_fma_f32 v[106:107], v[234:235], v[134:135], v[106:107] op_sel:[1,0,0] neg_lo:[1,0,0] neg_hi:[1,0,0]
v_pk_fma_f32 v[122:123], v[234:235], v[132:133], v[122:123] op_sel:[1,0,0] neg_lo:[1,0,0] neg_hi:[1,0,0]
v_cvt_pk_bf16_f32 v165, v106, v107
v_cvt_pk_bf16_f32 v173, v122, v123
s_add_u32 s61, s14, 0
v_cvt_pk_bf16_f32 v176, v32, v33
v_cvt_pk_bf16_f32 v177, v34, v35
v_cvt_pk_bf16_f32 v178, v36, v37
v_cvt_pk_bf16_f32 v179, v38, v39
buffer_store_dwordx4 v[176:179], v10, s[44:47], s61 offen offset:0 sc1
ds_write_b128 v16, v[176:179] offset:0
s_add_u32 s61, s14, 131072
v_cvt_pk_bf16_f32 v180, v40, v41
v_cvt_pk_bf16_f32 v181, v42, v43
v_cvt_pk_bf16_f32 v182, v44, v45
v_cvt_pk_bf16_f32 v183, v46, v47
buffer_store_dwordx4 v[180:183], v10, s[44:47], s61 offen offset:0 sc1
ds_write_b128 v16, v[180:183] offset:8192
s_add_u32 s61, s14, 4096
v_cvt_pk_bf16_f32 v184, v48, v49
v_cvt_pk_bf16_f32 v185, v50, v51
v_cvt_pk_bf16_f32 v186, v52, v53
v_cvt_pk_bf16_f32 v187, v54, v55
buffer_store_dwordx4 v[184:187], v10, s[44:47], s61 offen offset:0 sc1
ds_write_b128 v16, v[184:187] offset:4096
s_add_u32 s61, s14, 135168
v_cvt_pk_bf16_f32 v188, v56, v57
v_cvt_pk_bf16_f32 v189, v58, v59
v_cvt_pk_bf16_f32 v190, v60, v61
v_cvt_pk_bf16_f32 v191, v62, v63
buffer_store_dwordx4 v[188:191], v10, s[44:47], s61 offen offset:0 sc1
ds_write_b128 v16, v[188:191] offset:12288
v_pk_fma_f32 v[76:77], v[220:221], v[128:129], v[76:77] op_sel_hi:[0,1,1]
v_pk_fma_f32 v[92:93], v[220:221], v[130:131], v[92:93] op_sel_hi:[0,1,1] neg_lo:[1,0,0] neg_hi:[1,0,0]
v_pk_fma_f32 v[76:77], v[220:221], v[130:131], v[76:77] op_sel:[1,0,0] neg_lo:[1,0,0] neg_hi:[1,0,0]
v_pk_fma_f32 v[92:93], v[220:221], v[128:129], v[92:93] op_sel:[1,0,0] neg_lo:[1,0,0] neg_hi:[1,0,0]
v_cvt_pk_bf16_f32 v150, v76, v77
v_cvt_pk_bf16_f32 v158, v92, v93
v_pk_fma_f32 v[108:109], v[236:237], v[132:133], v[108:109] op_sel_hi:[0,1,1]
v_pk_fma_f32 v[124:125], v[236:237], v[134:135], v[124:125] op_sel_hi:[0,1,1] neg_lo:[1,0,0] neg_hi:[1,0,0]
v_pk_fma_f32 v[108:109], v[236:237], v[134:135], v[108:109] op_sel:[1,0,0] neg_lo:[1,0,0] neg_hi:[1,0,0]
v_pk_fma_f32 v[124:125], v[236:237], v[132:133], v[124:125] op_sel:[1,0,0] neg_lo:[1,0,0] neg_hi:[1,0,0]
v_cvt_pk_bf16_f32 v166, v108, v109
v_cvt_pk_bf16_f32 v174, v124, v125
v_pk_fma_f32 v[78:79], v[222:223], v[128:129], v[78:79] op_sel_hi:[0,1,1]
v_pk_fma_f32 v[94:95], v[222:223], v[130:131], v[94:95] op_sel_hi:[0,1,1] neg_lo:[1,0,0] neg_hi:[1,0,0]
v_pk_fma_f32 v[78:79], v[222:223], v[130:131], v[78:79] op_sel:[1,0,0] neg_lo:[1,0,0] neg_hi:[1,0,0]
v_pk_fma_f32 v[94:95], v[222:223], v[128:129], v[94:95] op_sel:[1,0,0] neg_lo:[1,0,0] neg_hi:[1,0,0]
v_cvt_pk_bf16_f32 v151, v78, v79
v_cvt_pk_bf16_f32 v159, v94, v95
v_pk_fma_f32 v[110:111], v[238:239], v[132:133], v[110:111] op_sel_hi:[0,1,1]
v_pk_fma_f32 v[126:127], v[238:239], v[134:135], v[126:127] op_sel_hi:[0,1,1] neg_lo:[1,0,0] neg_hi:[1,0,0]
v_pk_fma_f32 v[110:111], v[238:239], v[134:135], v[110:111] op_sel:[1,0,0] neg_lo:[1,0,0] neg_hi:[1,0,0]
v_pk_fma_f32 v[126:127], v[238:239], v[132:133], v[126:127] op_sel:[1,0,0] neg_lo:[1,0,0] neg_hi:[1,0,0]
v_cvt_pk_bf16_f32 v167, v110, v111
v_cvt_pk_bf16_f32 v175, v126, v127
v_mfma_f32_16x16x32_bf16 v[32:35], v[148:151], v[248:251], 0
v_mfma_f32_16x16x32_bf16 v[36:39], v[164:167], v[248:251], 0
v_mfma_f32_16x16x32_bf16 v[40:43], v[148:151], v[252:255], 0
v_mfma_f32_16x16x32_bf16 v[44:47], v[164:167], v[252:255], 0
v_mfma_f32_16x16x32_bf16 v[48:51], v[156:159], v[248:251], 0
v_mfma_f32_16x16x32_bf16 v[52:55], v[172:175], v[248:251], 0
v_mfma_f32_16x16x32_bf16 v[56:59], v[156:159], v[252:255], 0
v_mfma_f32_16x16x32_bf16 v[60:63], v[172:175], v[252:255], 0
s_add_u32 s61, s14, 0
v_cvt_pk_bf16_f32 v192, v32, v33
v_cvt_pk_bf16_f32 v193, v34, v35
v_cvt_pk_bf16_f32 v194, v36, v37
v_cvt_pk_bf16_f32 v195, v38, v39
buffer_store_dwordx4 v[192:195], v10, s[44:47], s61 offen offset:256 sc1
ds_write_b128 v16, v[192:195] offset:256
s_add_u32 s61, s14, 131072
v_cvt_pk_bf16_f32 v196, v40, v41
v_cvt_pk_bf16_f32 v197, v42, v43
v_cvt_pk_bf16_f32 v198, v44, v45
v_cvt_pk_bf16_f32 v199, v46, v47
buffer_store_dwordx4 v[196:199], v10, s[44:47], s61 offen offset:256 sc1
ds_write_b128 v16, v[196:199] offset:8448
s_add_u32 s61, s14, 4096
v_cvt_pk_bf16_f32 v200, v48, v49
v_cvt_pk_bf16_f32 v201, v50, v51
v_cvt_pk_bf16_f32 v202, v52, v53
v_cvt_pk_bf16_f32 v203, v54, v55
buffer_store_dwordx4 v[200:203], v10, s[44:47], s61 offen offset:256 sc1
ds_write_b128 v16, v[200:203] offset:4352
s_add_u32 s61, s14, 135168
v_cvt_pk_bf16_f32 v204, v56, v57
v_cvt_pk_bf16_f32 v205, v58, v59
v_cvt_pk_bf16_f32 v206, v60, v61
v_cvt_pk_bf16_f32 v207, v62, v63
buffer_store_dwordx4 v[204:207], v10, s[44:47], s61 offen offset:256 sc1
ds_write_b128 v16, v[204:207] offset:12544
v_mov_b32 v2, v11
s_lshl_b32 s60, s35, 2
s_add_u32 s60, s60, s34
s_mul_i32 s60, s60, 131072
s_lshl_b32 s61, s101, 16
s_add_u32 s60, s60, s61
s_add_u32 s42, s60, 1048576
s_add_u32 s40, s32, s42
s_addc_u32 s41, s33, 0
s_mov_b32 s42, 65536
s_mov_b32 s43, 0x20000
s_waitcnt vmcnt(8) lgkmcnt(0)
v_mov_b32 v14, 3
s_mov_b64 exec, 1
ds_write_b32 v13, v14
s_mov_b64 exec, -1
ds_read_b128 v[8:11], v12 offset:0
s_waitcnt lgkmcnt(0)
L_ck56:
v_min3_u32 v15, v8, v9, v10
v_min_u32 v15, v15, v11
s_nop 0
v_readfirstlane_b32 s60, v15
s_nop 0
s_cmp_ge_u32 s60, 3
s_cbranch_scc1 L_ckd57
ds_read_b128 v[8:11], v12 offset:0
s_waitcnt lgkmcnt(0)
s_branch L_ck56
L_ckd57:
ds_read_b128 v[148:151], v17 offset:0
ds_read_b128 v[152:155], v17 offset:1024
ds_read_b128 v[156:159], v17 offset:2048
ds_read_b128 v[160:163], v17 offset:3072
ds_read_b128 v[164:167], v17 offset:4096
ds_read_b128 v[168:171], v17 offset:5120
ds_read_b128 v[172:175], v17 offset:6144
ds_read_b128 v[176:179], v17 offset:7168
ds_read_b128 v[96:99], v20 offset:0
ds_read_b128 v[100:103], v20 offset:4096
ds_read_b128 v[104:107], v20 offset:8192
ds_read_b128 v[108:111], v20 offset:12288
s_waitcnt lgkmcnt(4)
v_mov_b32 v14, 4
s_mov_b64 exec, 1
ds_write_b32 v13, v14
s_mov_b64 exec, -1
s_waitcnt lgkmcnt(0)
v_mfma_f32_32x32x16_bf16 v[32:47], v[148:151], v[96:99], 0
ds_read_b128 v[112:115], v21 offset:0
ds_read_b128 v[116:119], v21 offset:4096
v_mfma_f32_32x32x16_bf16 v[48:63], v[148:151], v[100:103], 0
ds_read_b128 v[120:123], v21 offset:8192
ds_read_b128 v[124:127], v21 offset:12288
v_mfma_f32_32x32x16_bf16 v[64:79], v[148:151], v[104:107], 0
s_add_u32 m0, s67, 32768
s_add_u32 s62, s64, 128
s_and_b32 s62, s62, 0x3ff
buffer_load_dwordx4 v244, s[48:51], s62 offen offset:0 lds
v_mfma_f32_32x32x16_bf16 v[80:95], v[148:151], v[108:111], 0
s_waitcnt lgkmcnt(3)
v_mfma_f32_32x32x16_bf16 v[32:47], v[152:155], v[112:115], v[32:47]
ds_read_b128 v[96:99], v22 offset:0
ds_read_b128 v[100:103], v22 offset:4096
s_waitcnt lgkmcnt(4)
v_mfma_f32_32x32x16_bf16 v[48:63], v[152:155], v[116:119], v[48:63]
ds_read_b128 v[104:107], v22 offset:8192
ds_read_b128 v[108:111], v22 offset:12288
s_waitcnt lgkmcnt(5)
v_mfma_f32_32x32x16_bf16 v[64:79], v[152:155], v[120:123], v[64:79]
buffer_load_dwordx4 v245, s[48:51], s62 offen offset:1024 lds
s_waitcnt lgkmcnt(4)
v_mfma_f32_32x32x16_bf16 v[80:95], v[152:155], v[124:127], v[80:95]
s_waitcnt lgkmcnt(3)
v_mfma_f32_32x32x16_bf16 v[32:47], v[156:159], v[96:99], v[32:47]
ds_read_b128 v[112:115], v23 offset:0
ds_read_b128 v[116:119], v23 offset:4096
s_waitcnt lgkmcnt(4)
v_mfma_f32_32x32x16_bf16 v[48:63], v[156:159], v[100:103], v[48:63]
ds_read_b128 v[120:123], v23 offset:8192
ds_read_b128 v[124:127], v23 offset:12288
s_waitcnt lgkmcnt(5)
v_mfma_f32_32x32x16_bf16 v[64:79], v[156:159], v[104:107], v[64:79]
buffer_load_dwordx4 v246, s[48:51], s62 offen offset:2048 lds
s_waitcnt lgkmcnt(4)
v_mfma_f32_32x32x16_bf16 v[80:95], v[156:159], v[108:111], v[80:95]
s_waitcnt lgkmcnt(3)
v_mfma_f32_32x32x16_bf16 v[32:47], v[160:163], v[112:115], v[32:47]
ds_read_b128 v[96:99], v20 offset:16384
ds_read_b128 v[100:103], v20 offset:20480
s_waitcnt lgkmcnt(4)
v_mfma_f32_32x32x16_bf16 v[48:63], v[160:163], v[116:119], v[48:63]
ds_read_b128 v[104:107], v20 offset:24576
ds_read_b128 v[108:111], v20 offset:28672
s_waitcnt lgkmcnt(5)
v_mfma_f32_32x32x16_bf16 v[64:79], v[160:163], v[120:123], v[64:79]
buffer_load_dwordx4 v247, s[48:51], s62 offen offset:3072 lds
s_waitcnt lgkmcnt(4)
v_mfma_f32_32x32x16_bf16 v[80:95], v[160:163], v[124:127], v[80:95]
s_waitcnt lgkmcnt(3)
v_mfma_f32_32x32x16_bf16 v[32:47], v[164:167], v[96:99], v[32:47]
ds_read_b128 v[112:115], v21 offset:16384
ds_read_b128 v[116:119], v21 offset:20480
s_waitcnt lgkmcnt(4)
v_mfma_f32_32x32x16_bf16 v[48:63], v[164:167], v[100:103], v[48:63]
ds_read_b128 v[120:123], v21 offset:24576
ds_read_b128 v[124:127], v21 offset:28672
s_waitcnt lgkmcnt(5)
v_mfma_f32_32x32x16_bf16 v[64:79], v[164:167], v[104:107], v[64:79]
s_add_u32 m0, s67, 49152
s_nop 0
buffer_load_dwordx4 v244, s[52:55], s62 offen offset:0 lds
s_waitcnt lgkmcnt(4)
v_mfma_f32_32x32x16_bf16 v[80:95], v[164:167], v[108:111], v[80:95]
s_waitcnt lgkmcnt(3)
v_mfma_f32_32x32x16_bf16 v[32:47], v[168:171], v[112:115], v[32:47]
ds_read_b128 v[96:99], v22 offset:16384
ds_read_b128 v[100:103], v22 offset:20480
s_waitcnt lgkmcnt(4)
v_mfma_f32_32x32x16_bf16 v[48:63], v[168:171], v[116:119], v[48:63]
ds_read_b128 v[104:107], v22 offset:24576
ds_read_b128 v[108:111], v22 offset:28672
s_waitcnt lgkmcnt(5)
v_mfma_f32_32x32x16_bf16 v[64:79], v[168:171], v[120:123], v[64:79]
buffer_load_dwordx4 v245, s[52:55], s62 offen offset:1024 lds
s_waitcnt lgkmcnt(4)
v_mfma_f32_32x32x16_bf16 v[80:95], v[168:171], v[124:127], v[80:95]
s_waitcnt lgkmcnt(3)
v_mfma_f32_32x32x16_bf16 v[32:47], v[172:175], v[96:99], v[32:47]
ds_read_b128 v[112:115], v23 offset:16384
ds_read_b128 v[116:119], v23 offset:20480
s_waitcnt lgkmcnt(4)
v_mfma_f32_32x32x16_bf16 v[48:63], v[172:175], v[100:103], v[48:63]
ds_read_b128 v[120:123], v23 offset:24576
ds_read_b128 v[124:127], v23 offset:28672
s_waitcnt lgkmcnt(5)
v_mfma_f32_32x32x16_bf16 v[64:79], v[172:175], v[104:107], v[64:79]
buffer_load_dwordx4 v246, s[52:55], s62 offen offset:2048 lds
s_waitcnt lgkmcnt(4)
v_mfma_f32_32x32x16_bf16 v[80:95], v[172:175], v[108:111], v[80:95]
s_waitcnt lgkmcnt(0)
v_mfma_f32_32x32x16_bf16 v[32:47], v[176:179], v[112:115], v[32:47]
v_mfma_f32_32x32x16_bf16 v[48:63], v[176:179], v[116:119], v[48:63]
v_mfma_f32_32x32x16_bf16 v[64:79], v[176:179], v[120:123], v[64:79]
buffer_load_dwordx4 v247, s[52:55], s62 offen offset:3072 lds
v_mfma_f32_32x32x16_bf16 v[80:95], v[176:179], v[124:127], v[80:95]
s_lshl_b32 s60, s66, 3
v_lshl_add_u32 v17, v5, 4, s60
v_lshlrev_b32 v28, 11, v17
v_lshl_add_u32 v28, v6, 2, v28
v_lshlrev_b32 v29, 13, v17
v_lshl_add_u32 v29, v6, 3, v29
v_lshlrev_b32 v30, 2, v6
v_mov_b32 v15, s37
s_waitcnt vmcnt(8)
s_mov_b64 exec, 1
s_cmp_eq_u32 s100, 0
s_cbranch_scc1 L_rs58
global_store_dword v19, v15, s[32:33]
s_branch L_rd59
L_rs58:
global_store_dword v19, v15, s[32:33] sc1
L_rd59:
s_mov_b64 exec, -1
ds_read_b128 v[8:11], v12 offset:0
s_waitcnt lgkmcnt(0)
L_ck60:
v_min3_u32 v15, v8, v9, v10
v_min_u32 v15, v15, v11
s_nop 0
v_readfirstlane_b32 s60, v15
s_nop 0
s_cmp_ge_u32 s60, 4
s_cbranch_scc1 L_ckd61
ds_read_b128 v[8:11], v12 offset:0
s_waitcnt lgkmcnt(0)
s_branch L_ck60
L_ckd61:
ds_read_b128 v[8:11], v12 offset:16
s_waitcnt lgkmcnt(0)
L_ck62:
v_min3_u32 v15, v8, v9, v10
v_min_u32 v15, v15, v11
s_nop 0
v_readfirstlane_b32 s60, v15
s_nop 0
s_cmp_ge_u32 s60, 2
s_cbranch_scc1 L_ckd63
ds_read_b128 v[8:11], v12 offset:16
s_waitcnt lgkmcnt(0)
s_branch L_ck62
L_ckd63:
s_add_u32 m0, s67, 65536
s_add_u32 s62, s64, 256
s_and_b32 s62, s62, 0x3ff
buffer_load_dwordx4 v244, s[48:51], s62 offen offset:0 lds
buffer_load_dwordx4 v245, s[48:51], s62 offen offset:1024 lds
buffer_load_dwordx4 v246, s[48:51], s62 offen offset:2048 lds
buffer_load_dwordx4 v247, s[48:51], s62 offen offset:3072 lds
s_add_u32 m0, s67, 81920
s_nop 0
buffer_load_dwordx4 v244, s[52:55], s62 offen offset:0 lds
buffer_load_dwordx4 v245, s[52:55], s62 offen offset:1024 lds
buffer_load_dwordx4 v246, s[52:55], s62 offen offset:2048 lds
buffer_load_dwordx4 v247, s[52:55], s62 offen offset:3072 lds
s_mov_b32 s92, 0
L_w64:
global_load_dword v8, v18, s[32:33] sc1
s_waitcnt vmcnt(0)
v_cmp_ne_u32 vcc, s37, v8
s_nop 0
s_cbranch_vccz L_wd65
s_sleep 4
s_add_u32 s92, s92, 1
s_cmp_lt_u32 s92, 200000
s_cbranch_scc1 L_w64
L_wd65:
v_mov_b32 v14, 5
s_mov_b64 exec, 1
ds_write_b32 v13, v14
s_mov_b64 exec, -1
s_add_u32 s63, s65, 8192
s_and_b32 s63, s63, 0xffff
buffer_load_dwordx4 v[180:183], v2, s[40:43], s63 offen offset:0 sc1
buffer_load_dwordx4 v[184:187], v2, s[40:43], s63 offen offset:1024 sc1
buffer_load_dwordx4 v[188:191], v2, s[40:43], s63 offen offset:2048 sc1
buffer_load_dwordx4 v[192:195], v2, s[40:43], s63 offen offset:3072 sc1
s_add_u32 m0, s67, 98304
s_add_u32 s62, s64, 384
s_and_b32 s62, s62, 0x3ff
buffer_load_dwordx4 v244, s[48:51], s62 offen offset:0 lds
buffer_load_dwordx4 v245, s[48:51], s62 offen offset:1024 lds
buffer_load_dwordx4 v246, s[48:51], s62 offen offset:2048 lds
buffer_load_dwordx4 v247, s[48:51], s62 offen offset:3072 lds
s_add_u32 s63, s65, 12288
s_and_b32 s63, s63, 0xffff
buffer_load_dwordx4 v[196:199], v2, s[40:43], s63 offen offset:0 sc1
buffer_load_dwordx4 v[200:203], v2, s[40:43], s63 offen offset:1024 sc1
buffer_load_dwordx4 v[204:207], v2, s[40:43], s63 offen offset:2048 sc1
buffer_load_dwordx4 v[208:211], v2, s[40:43], s63 offen offset:3072 sc1
ds_read_b128 v[8:11], v12 offset:0
s_waitcnt lgkmcnt(0)
L_ck66:
v_min3_u32 v15, v8, v9, v10
v_min_u32 v15, v15, v11
s_nop 0
v_readfirstlane_b32 s60, v15
s_nop 0
s_cmp_ge_u32 s60, 5
s_cbranch_scc1 L_ckd67
ds_read_b128 v[8:11], v12 offset:0
s_waitcnt lgkmcnt(0)
s_branch L_ck66
L_ckd67:
ds_read_b128 v[96:99], v20 offset:32768
ds_read_b128 v[100:103], v20 offset:36864
ds_read_b128 v[104:107], v20 offset:40960
ds_read_b128 v[108:111], v20 offset:45056
s_waitcnt vmcnt(11) lgkmcnt(3)
v_mfma_f32_32x32x16_bf16 v[32:47], v[180:183], v[96:99], v[32:47]
ds_read_b128 v[112:115], v21 offset:32768
ds_read_b128 v[116:119], v21 offset:36864
s_waitcnt lgkmcnt(4)
v_mfma_f32_32x32x16_bf16 v[48:63], v[180:183], v[100:103], v[48:63]
ds_read_b128 v[120:123], v21 offset:40960
ds_read_b128 v[124:127], v21 offset:45056
s_waitcnt lgkmcnt(5)
v_mfma_f32_32x32x16_bf16 v[64:79], v[180:183], v[104:107], v[64:79]
s_waitcnt lgkmcnt(4)
v_mfma_f32_32x32x16_bf16 v[80:95], v[180:183], v[108:111], v[80:95]
s_add_u32 s63, s65, 16384
s_and_b32 s63, s63, 0xffff
buffer_load_dwordx4 v[212:215], v2, s[40:43], s63 offen offset:0 sc1
buffer_load_dwordx4 v[216:219], v2, s[40:43], s63 offen offset:1024 sc1
s_waitcnt vmcnt(12) lgkmcnt(3)
v_mfma_f32_32x32x16_bf16 v[32:47], v[184:187], v[112:115], v[32:47]
ds_read_b128 v[96:99], v22 offset:32768
ds_read_b128 v[100:103], v22 offset:36864
s_waitcnt lgkmcnt(4)
v_mfma_f32_32x32x16_bf16 v[48:63], v[184:187], v[116:119], v[48:63]
ds_read_b128 v[104:107], v22 offset:40960
ds_read_b128 v[108:111], v22 offset:45056
s_waitcnt lgkmcnt(5)
v_mfma_f32_32x32x16_bf16 v[64:79], v[184:187], v[120:123], v[64:79]
s_waitcnt lgkmcnt(4)
v_mfma_f32_32x32x16_bf16 v[80:95], v[184:187], v[124:127], v[80:95]
buffer_load_dwordx4 v[220:223], v2, s[40:43], s63 offen offset:2048 sc1
buffer_load_dwordx4 v[224:227], v2, s[40:43], s63 offen offset:3072 sc1
s_waitcnt vmcnt(13) lgkmcnt(3)
v_mfma_f32_32x32x16_bf16 v[32:47], v[188:191], v[96:99], v[32:47]
ds_read_b128 v[112:115], v23 offset:32768
ds_read_b128 v[116:119], v23 offset:36864
s_waitcnt lgkmcnt(4)
v_mfma_f32_32x32x16_bf16 v[48:63], v[188:191], v[100:103], v[48:63]
ds_read_b128 v[120:123], v23 offset:40960
ds_read_b128 v[124:127], v23 offset:45056
s_waitcnt lgkmcnt(5)
v_mfma_f32_32x32x16_bf16 v[64:79], v[188:191], v[104:107], v[64:79]
s_waitcnt lgkmcnt(4)
v_mfma_f32_32x32x16_bf16 v[80:95], v[188:191], v[108:111], v[80:95]
s_add_u32 s63, s65, 20480
s_and_b32 s63, s63, 0xffff
buffer_load_dwordx4 v[228:231], v2, s[40:43], s63 offen offset:0 sc1
buffer_load_dwordx4 v[232:235], v2, s[40:43], s63 offen offset:1024 sc1
s_waitcnt vmcnt(14) lgkmcnt(3)
v_mfma_f32_32x32x16_bf16 v[32:47], v[192:195], v[112:115], v[32:47]
ds_read_b128 v[96:99], v20 offset:49152
ds_read_b128 v[100:103], v20 offset:53248
s_waitcnt lgkmcnt(4)
v_mfma_f32_32x32x16_bf16 v[48:63], v[192:195], v[116:119], v[48:63]
ds_read_b128 v[104:107], v20 offset:57344
ds_read_b128 v[108:111], v20 offset:61440
s_waitcnt lgkmcnt(5)
v_mfma_f32_32x32x16_bf16 v[64:79], v[192:195], v[120:123], v[64:79]
s_waitcnt lgkmcnt(4)
v_mfma_f32_32x32x16_bf16 v[80:95], v[192:195], v[124:127], v[80:95]
buffer_load_dwordx4 v[236:239], v2, s[40:43], s63 offen offset:2048 sc1
buffer_load_dwordx4 v[240:243], v2, s[40:43], s63 offen offset:3072 sc1
s_waitcnt vmcnt(11) lgkmcnt(3)
v_mov_b32 v14, 6
s_mov_b64 exec, 1
ds_write_b32 v13, v14
s_mov_b64 exec, -1
v_mfma_f32_32x32x16_bf16 v[32:47], v[196:199], v[96:99], v[32:47]
ds_read_b128 v[112:115], v21 offset:49152
ds_read_b128 v[116:119], v21 offset:53248
s_waitcnt lgkmcnt(5)
v_mfma_f32_32x32x16_bf16 v[48:63], v[196:199], v[100:103], v[48:63]
ds_read_b128 v[120:123], v21 offset:57344
ds_read_b128 v[124:127], v21 offset:61440
s_waitcnt lgkmcnt(6)
v_mfma_f32_32x32x16_bf16 v[64:79], v[196:199], v[104:107], v[64:79]
s_add_u32 m0, s67, 0
s_nop 0
buffer_load_dwordx4 v244, s[52:55], s62 offen offset:0 lds
s_waitcnt lgkmcnt(5)
v_mfma_f32_32x32x16_bf16 v[80:95], v[196:199], v[108:111], v[80:95]
s_add_u32 s63, s65, 24576
s_and_b32 s63, s63, 0xffff
buffer_load_dwordx4 v[148:151], v2, s[40:43], s63 offen offset:0 sc1
buffer_load_dwordx4 v[152:155], v2, s[40:43], s63 offen offset:1024 sc1
s_waitcnt vmcnt(13) lgkmcnt(3)
v_mfma_f32_32x32x16_bf16 v[32:47], v[200:203], v[112:115], v[32:47]
ds_read_b128 v[96:99], v22 offset:49152
ds_read_b128 v[100:103], v22 offset:53248
s_waitcnt lgkmcnt(4)
v_mfma_f32_32x32x16_bf16 v[48:63], v[200:203], v[116:119], v[48:63]
ds_read_b128 v[104:107], v22 offset:57344
ds_read_b128 v[108:111], v22 offset:61440
s_waitcnt lgkmcnt(5)
v_mfma_f32_32x32x16_bf16 v[64:79], v[200:203], v[120:123], v[64:79]
buffer_load_dwordx4 v245, s[52:55], s62 offen offset:1024 lds
s_waitcnt lgkmcnt(4)
v_mfma_f32_32x32x16_bf16 v[80:95], v[200:203], v[124:127], v[80:95]
buffer_load_dwordx4 v[156:159], v2, s[40:43], s63 offen offset:2048 sc1
buffer_load_dwordx4 v[160:163], v2, s[40:43], s63 offen offset:3072 sc1
s_waitcnt vmcnt(15) lgkmcnt(3)
v_mfma_f32_32x32x16_bf16 v[32:47], v[204:207], v[96:99], v[32:47]
ds_read_b128 v[112:115], v23 offset:49152
ds_read_b128 v[116:119], v23 offset:53248
s_waitcnt lgkmcnt(4)
v_mfma_f32_32x32x16_bf16 v[48:63], v[204:207], v[100:103], v[48:63]
ds_read_b128 v[120:123], v23 offset:57344
ds_read_b128 v[124:127], v23 offset:61440
s_waitcnt lgkmcnt(5)
v_mfma_f32_32x32x16_bf16 v[64:79], v[204:207], v[104:107], v[64:79]
buffer_load_dwordx4 v246, s[52:55], s62 offen offset:2048 lds
s_waitcnt lgkmcnt(4)
v_mfma_f32_32x32x16_bf16 v[80:95], v[204:207], v[108:111], v[80:95]
s_add_u32 s63, s65, 28672
s_and_b32 s63, s63, 0xffff
buffer_load_dwordx4 v[164:167], v2, s[40:43], s63 offen offset:0 sc1
buffer_load_dwordx4 v[168:171], v2, s[40:43], s63 offen offset:1024 sc1
ds_read_b128 v[8:11], v12
s_waitcnt vmcnt(17) lgkmcnt(0)
L_ck68:
v_min3_u32 v15, v8, v9, v10
v_min_u32 v15, v15, v11
s_nop 0
v_readfirstlane_b32 s60, v15
s_nop 0
s_cmp_ge_u32 s60, 6
s_cbranch_scc1 L_ckd69
ds_read_b128 v[8:11], v12 offset:0
s_waitcnt lgkmcnt(0)
s_branch L_ck68
L_ckd69:
v_mfma_f32_32x32x16_bf16 v[32:47], v[208:211], v[112:115], v[32:47]
ds_read_b128 v[96:99], v24 offset:0
ds_read_b128 v[100:103], v24 offset:4096
v_mfma_f32_32x32x16_bf16 v[48:63], v[208:211], v[116:119], v[48:63]
ds_read_b128 v[104:107], v24 offset:8192
ds_read_b128 v[108:111], v24 offset:12288
v_mfma_f32_32x32x16_bf16 v[64:79], v[208:211], v[120:123], v[64:79]
buffer_load_dwordx4 v247, s[52:55], s62 offen offset:3072 lds
v_mfma_f32_32x32x16_bf16 v[80:95], v[208:211], v[124:127], v[80:95]
buffer_load_dwordx4 v[172:175], v2, s[40:43], s63 offen offset:2048 sc1
buffer_load_dwordx4 v[176:179], v2, s[40:43], s63 offen offset:3072 sc1
s_waitcnt vmcnt(19) lgkmcnt(3)
v_mfma_f32_32x32x16_bf16 v[32:47], v[212:215], v[96:99], v[32:47]
ds_read_b128 v[112:115], v25 offset:0
ds_read_b128 v[116:119], v25 offset:4096
s_waitcnt lgkmcnt(4)
v_mfma_f32_32x32x16_bf16 v[48:63], v[212:215], v[100:103], v[48:63]
ds_read_b128 v[120:123], v25 offset:8192
ds_read_b128 v[124:127], v25 offset:12288
s_waitcnt lgkmcnt(5)
v_mfma_f32_32x32x16_bf16 v[64:79], v[212:215], v[104:107], v[64:79]
s_add_u32 m0, s67, 16384
s_add_u32 s62, s64, 512
s_and_b32 s62, s62, 0x3ff
buffer_load_dwordx4 v244, s[48:51], s62 offen offset:0 lds
s_waitcnt lgkmcnt(4)
v_mfma_f32_32x32x16_bf16 v[80:95], v[212:215], v[108:111], v[80:95]
s_add_u32 s63, s65, 32768
s_and_b32 s63, s63, 0xffff
buffer_load_dwordx4 v[180:183], v2, s[40:43], s63 offen offset:0 sc1
buffer_load_dwordx4 v[184:187], v2, s[40:43], s63 offen offset:1024 sc1
s_waitcnt vmcnt(21) lgkmcnt(3)
v_mfma_f32_32x32x16_bf16 v[32:47], v[216:219], v[112:115], v[32:47]
ds_read_b128 v[96:99], v26 offset:0
ds_read_b128 v[100:103], v26 offset:4096
s_waitcnt lgkmcnt(4)
v_mfma_f32_32x32x16_bf16 v[48:63], v[216:219], v[116:119], v[48:63]
ds_read_b128 v[104:107], v26 offset:8192
ds_read_b128 v[108:111], v26 offset:12288
s_waitcnt lgkmcnt(5)
v_mfma_f32_32x32x16_bf16 v[64:79], v[216:219], v[120:123], v[64:79]
buffer_load_dwordx4 v245, s[48:51], s62 offen offset:1024 lds
s_waitcnt lgkmcnt(4)
v_mfma_f32_32x32x16_bf16 v[80:95], v[216:219], v[124:127], v[80:95]
buffer_load_dwordx4 v[188:191], v2, s[40:43], s63 offen offset:2048 sc1
buffer_load_dwordx4 v[192:195], v2, s[40:43], s63 offen offset:3072 sc1
s_waitcnt vmcnt(23) lgkmcnt(3)
v_mfma_f32_32x32x16_bf16 v[32:47], v[220:223], v[96:99], v[32:47]
ds_read_b128 v[112:115], v27 offset:0
ds_read_b128 v[116:119], v27 offset:4096
s_waitcnt lgkmcnt(4)
v_mfma_f32_32x32x16_bf16 v[48:63], v[220:223], v[100:103], v[48:63]
ds_read_b128 v[120:123], v27 offset:8192
ds_read_b128 v[124:127], v27 offset:12288
s_waitcnt lgkmcnt(5)
v_mfma_f32_32x32x16_bf16 v[64:79], v[220:223], v[104:107], v[64:79]
buffer_load_dwordx4 v246, s[48:51], s62 offen offset:2048 lds
s_waitcnt lgkmcnt(4)
v_mfma_f32_32x32x16_bf16 v[80:95], v[220:223], v[108:111], v[80:95]
s_add_u32 s63, s65, 36864
s_and_b32 s63, s63, 0xffff
buffer_load_dwordx4 v[196:199], v2, s[40:43], s63 offen offset:0 sc1
buffer_load_dwordx4 v[200:203], v2, s[40:43], s63 offen offset:1024 sc1
s_waitcnt vmcnt(25) lgkmcnt(3)
v_mfma_f32_32x32x16_bf16 v[32:47], v[224:227], v[112:115], v[32:47]
ds_read_b128 v[96:99], v24 offset:16384
ds_read_b128 v[100:103], v24 offset:20480
s_waitcnt lgkmcnt(4)
v_mfma_f32_32x32x16_bf16 v[48:63], v[224:227], v[116:119], v[48:63]
ds_read_b128 v[104:107], v24 offset:24576
ds_read_b128 v[108:111], v24 offset:28672
s_waitcnt lgkmcnt(5)
v_mfma_f32_32x32x16_bf16 v[64:79], v[224:227], v[120:123], v[64:79]
buffer_load_dwordx4 v247, s[48:51], s62 offen offset:3072 lds
s_waitcnt lgkmcnt(4)
v_mfma_f32_32x32x16_bf16 v[80:95], v[224:227], v[124:127], v[80:95]
buffer_load_dwordx4 v[204:207], v2, s[40:43], s63 offen offset:2048 sc1
buffer_load_dwordx4 v[208:211], v2, s[40:43], s63 offen offset:3072 sc1
s_waitcnt vmcnt(14) lgkmcnt(3)
v_mov_b32 v14, 7
s_mov_b64 exec, 1
ds_write_b32 v13, v14
s_mov_b64 exec, -1
v_mfma_f32_32x32x16_bf16 v[32:47], v[228:231], v[96:99], v[32:47]
ds_read_b128 v[112:115], v25 offset:16384
ds_read_b128 v[116:119], v25 offset:20480
s_waitcnt lgkmcnt(5)
v_mfma_f32_32x32x16_bf16 v[48:63], v[228:231], v[100:103], v[48:63]
ds_read_b128 v[120:123], v25 offset:24576
ds_read_b128 v[124:127], v25 offset:28672
s_waitcnt lgkmcnt(6)
v_mfma_f32_32x32x16_bf16 v[64:79], v[228:231], v[104:107], v[64:79]
s_add_u32 m0, s67, 32768
s_nop 0
buffer_load_dwordx4 v244, s[52:55], s62 offen offset:0 lds
s_waitcnt lgkmcnt(5)
v_mfma_f32_32x32x16_bf16 v[80:95], v[228:231], v[108:111], v[80:95]
s_add_u32 s63, s65, 40960
s_and_b32 s63, s63, 0xffff
buffer_load_dwordx4 v[212:215], v2, s[40:43], s63 offen offset:0 sc1
buffer_load_dwordx4 v[216:219], v2, s[40:43], s63 offen offset:1024 sc1
s_waitcnt vmcnt(29) lgkmcnt(3)
v_mfma_f32_32x32x16_bf16 v[32:47], v[232:235], v[112:115], v[32:47]
ds_read_b128 v[96:99], v26 offset:16384
ds_read_b128 v[100:103], v26 offset:20480
s_waitcnt lgkmcnt(4)
v_mfma_f32_32x32x16_bf16 v[48:63], v[232:235], v[116:119], v[48:63]
ds_read_b128 v[104:107], v26 offset:24576
ds_read_b128 v[108:111], v26 offset:28672
s_waitcnt lgkmcnt(5)
v_mfma_f32_32x32x16_bf16 v[64:79], v[232:235], v[120:123], v[64:79]
buffer_load_dwordx4 v245, s[52:55], s62 offen offset:1024 lds
s_waitcnt lgkmcnt(4)
v_mfma_f32_32x32x16_bf16 v[80:95], v[232:235], v[124:127], v[80:95]
buffer_load_dwordx4 v[220:223], v2, s[40:43], s63 offen offset:2048 sc1
buffer_load_dwordx4 v[224:227], v2, s[40:43], s63 offen offset:3072 sc1
s_waitcnt vmcnt(31) lgkmcnt(3)
v_mfma_f32_32x32x16_bf16 v[32:47], v[236:239], v[96:99], v[32:47]
ds_read_b128 v[112:115], v27 offset:16384
ds_read_b128 v[116:119], v27 offset:20480
s_waitcnt lgkmcnt(4)
v_mfma_f32_32x32x16_bf16 v[48:63], v[236:239], v[100:103], v[48:63]
ds_read_b128 v[120:123], v27 offset:24576
ds_read_b128 v[124:127], v27 offset:28672
s_waitcnt lgkmcnt(5)
v_mfma_f32_32x32x16_bf16 v[64:79], v[236:239], v[104:107], v[64:79]
buffer_load_dwordx4 v246, s[52:55], s62 offen offset:2048 lds
s_waitcnt lgkmcnt(4)
v_mfma_f32_32x32x16_bf16 v[80:95], v[236:239], v[108:111], v[80:95]
s_add_u32 s63, s65, 45056
s_and_b32 s63, s63, 0xffff
buffer_load_dwordx4 v[228:231], v2, s[40:43], s63 offen offset:0 sc1
buffer_load_dwordx4 v[232:235], v2, s[40:43], s63 offen offset:1024 sc1
ds_read_b128 v[8:11], v12
s_waitcnt vmcnt(33) lgkmcnt(0)
L_ck70:
v_min3_u32 v15, v8, v9, v10
v_min_u32 v15, v15, v11
s_nop 0
v_readfirstlane_b32 s60, v15
s_nop 0
s_cmp_ge_u32 s60, 7
s_cbranch_scc1 L_ckd71
ds_read_b128 v[8:11], v12 offset:0
s_waitcnt lgkmcnt(0)
s_branch L_ck70
L_ckd71:
v_mfma_f32_32x32x16_bf16 v[32:47], v[240:243], v[112:115], v[32:47]
ds_read_b128 v[96:99], v24 offset:32768
ds_read_b128 v[100:103], v24 offset:36864
v_mfma_f32_32x32x16_bf16 v[48:63], v[240:243], v[116:119], v[48:63]
ds_read_b128 v[104:107], v24 offset:40960
ds_read_b128 v[108:111], v24 offset:45056
v_mfma_f32_32x32x16_bf16 v[64:79], v[240:243], v[120:123], v[64:79]
buffer_load_dwordx4 v247, s[52:55], s62 offen offset:3072 lds
v_mfma_f32_32x32x16_bf16 v[80:95], v[240:243], v[124:127], v[80:95]
buffer_load_dwordx4 v[236:239], v2, s[40:43], s63 offen offset:2048 sc1
buffer_load_dwordx4 v[240:243], v2, s[40:43], s63 offen offset:3072 sc1
s_waitcnt vmcnt(34) lgkmcnt(3)
v_mfma_f32_32x32x16_bf16 v[32:47], v[148:151], v[96:99], v[32:47]
ds_read_b128 v[112:115], v25 offset:32768
ds_read_b128 v[116:119], v25 offset:36864
s_waitcnt lgkmcnt(4)
v_mfma_f32_32x32x16_bf16 v[48:63], v[148:151], v[100:103], v[48:63]
ds_read_b128 v[120:123], v25 offset:40960
ds_read_b128 v[124:127], v25 offset:45056
s_waitcnt lgkmcnt(5)
v_mfma_f32_32x32x16_bf16 v[64:79], v[148:151], v[104:107], v[64:79]
s_add_u32 m0, s67, 49152
s_add_u32 s62, s64, 640
s_and_b32 s62, s62, 0x3ff
buffer_load_dwordx4 v244, s[48:51], s62 offen offset:0 lds
s_waitcnt lgkmcnt(4)
v_mfma_f32_32x32x16_bf16 v[80:95], v[148:151], v[108:111], v[80:95]
s_add_u32 s63, s65, 49152
s_and_b32 s63, s63, 0xffff
buffer_load_dwordx4 v[148:151], v2, s[40:43], s63 offen offset:0 sc1
s_waitcnt vmcnt(35) lgkmcnt(3)
v_mfma_f32_32x32x16_bf16 v[32:47], v[152:155], v[112:115], v[32:47]
ds_read_b128 v[96:99], v26 offset:32768
ds_read_b128 v[100:103], v26 offset:36864
s_waitcnt lgkmcnt(4)
v_mfma_f32_32x32x16_bf16 v[48:63], v[152:155], v[116:119], v[48:63]
ds_read_b128 v[104:107], v26 offset:40960
ds_read_b128 v[108:111], v26 offset:45056
s_waitcnt lgkmcnt(5)
v_mfma_f32_32x32x16_bf16 v[64:79], v[152:155], v[120:123], v[64:79]
buffer_load_dwordx4 v245, s[48:51], s62 offen offset:1024 lds
s_waitcnt lgkmcnt(4)
v_mfma_f32_32x32x16_bf16 v[80:95], v[152:155], v[124:127], v[80:95]
buffer_load_dwordx4 v[152:155], v2, s[40:43], s63 offen offset:1024 sc1
s_waitcnt vmcnt(35) lgkmcnt(3)
v_mfma_f32_32x32x16_bf16 v[32:47], v[156:159], v[96:99], v[32:47]
ds_read_b128 v[112:115], v27 offset:32768
ds_read_b128 v[116:119], v27 offset:36864
s_waitcnt lgkmcnt(4)
v_mfma_f32_32x32x16_bf16 v[48:63], v[156:159], v[100:103], v[48:63]
ds_read_b128 v[120:123], v27 offset:40960
ds_read_b128 v[124:127], v27 offset:45056
s_waitcnt lgkmcnt(5)
v_mfma_f32_32x32x16_bf16 v[64:79], v[156:159], v[104:107], v[64:79]
buffer_load_dwordx4 v246, s[48:51], s62 offen offset:2048 lds
s_waitcnt lgkmcnt(4)
v_mfma_f32_32x32x16_bf16 v[80:95], v[156:159], v[108:111], v[80:95]
buffer_load_dwordx4 v[156:159], v2, s[40:43], s63 offen offset:2048 sc1
s_waitcnt vmcnt(36) lgkmcnt(3)
v_mfma_f32_32x32x16_bf16 v[32:47], v[160:163], v[112:115], v[32:47]
ds_read_b128 v[96:99], v20 offset:0
ds_read_b128 v[100:103], v20 offset:4096
s_waitcnt lgkmcnt(4)
v_mfma_f32_32x32x16_bf16 v[48:63], v[160:163], v[116:119], v[48:63]
ds_read_b128 v[104:107], v20 offset:8192
ds_read_b128 v[108:111], v20 offset:12288
s_waitcnt lgkmcnt(5)
v_mfma_f32_32x32x16_bf16 v[64:79], v[160:163], v[120:123], v[64:79]
buffer_load_dwordx4 v247, s[48:51], s62 offen offset:3072 lds
s_waitcnt lgkmcnt(4)
v_mfma_f32_32x32x16_bf16 v[80:95], v[160:163], v[124:127], v[80:95]
buffer_load_dwordx4 v[160:163], v2, s[40:43], s63 offen offset:3072 sc1
s_waitcnt vmcnt(10) lgkmcnt(3)
v_mov_b32 v14, 8
s_mov_b64 exec, 1
ds_write_b32 v13, v14
s_mov_b64 exec, -1
v_mfma_f32_32x32x16_bf16 v[32:47], v[164:167], v[96:99], v[32:47]
ds_read_b128 v[112:115], v21 offset:0
ds_read_b128 v[116:119], v21 offset:4096
s_waitcnt lgkmcnt(5)
v_mfma_f32_32x32x16_bf16 v[48:63], v[164:167], v[100:103], v[48:63]
ds_read_b128 v[120:123], v21 offset:8192
ds_read_b128 v[124:127], v21 offset:12288
s_waitcnt lgkmcnt(6)
v_mfma_f32_32x32x16_bf16 v[64:79], v[164:167], v[104:107], v[64:79]
s_add_u32 m0, s67, 65536
s_nop 0
buffer_load_dwordx4 v244, s[52:55], s62 offen offset:0 lds
s_waitcnt lgkmcnt(5)
v_mfma_f32_32x32x16_bf16 v[80:95], v[164:167], v[108:111], v[80:95]
s_add_u32 s63, s65, 53248
s_and_b32 s63, s63, 0xffff
buffer_load_dwordx4 v[164:167], v2, s[40:43], s63 offen offset:0 sc1
s_waitcnt vmcnt(37) lgkmcnt(3)
v_mfma_f32_32x32x16_bf16 v[32:47], v[168:171], v[112:115], v[32:47]
ds_read_b128 v[96:99], v22 offset:0
ds_read_b128 v[100:103], v22 offset:4096
s_waitcnt lgkmcnt(4)
v_mfma_f32_32x32x16_bf16 v[48:63], v[168:171], v[116:119], v[48:63]
ds_read_b128 v[104:107], v22 offset:8192
ds_read_b128 v[108:111], v22 offset:12288
s_waitcnt lgkmcnt(5)
v_mfma_f32_32x32x16_bf16 v[64:79], v[168:171], v[120:123], v[64:79]
buffer_load_dwordx4 v245, s[52:55], s62 offen offset:1024 lds
s_waitcnt lgkmcnt(4)
v_mfma_f32_32x32x16_bf16 v[80:95], v[168:171], v[124:127], v[80:95]
buffer_load_dwordx4 v[168:171], v2, s[40:43], s63 offen offset:1024 sc1
s_waitcnt vmcnt(37) lgkmcnt(3)
v_mfma_f32_32x32x16_bf16 v[32:47], v[172:175], v[96:99], v[32:47]
ds_read_b128 v[112:115], v23 offset:0
ds_read_b128 v[116:119], v23 offset:4096
s_waitcnt lgkmcnt(4)
v_mfma_f32_32x32x16_bf16 v[48:63], v[172:175], v[100:103], v[48:63]
ds_read_b128 v[120:123], v23 offset:8192
ds_read_b128 v[124:127], v23 offset:12288
s_waitcnt lgkmcnt(5)
v_mfma_f32_32x32x16_bf16 v[64:79], v[172:175], v[104:107], v[64:79]
buffer_load_dwordx4 v246, s[52:55], s62 offen offset:2048 lds
s_waitcnt lgkmcnt(4)
v_mfma_f32_32x32x16_bf16 v[80:95], v[172:175], v[108:111], v[80:95]
buffer_load_dwordx4 v[172:175], v2, s[40:43], s63 offen offset:2048 sc1
ds_read_b128 v[8:11], v12
s_waitcnt vmcnt(38) lgkmcnt(0)
L_ck72:
v_min3_u32 v15, v8, v9, v10
v_min_u32 v15, v15, v11
s_nop 0
v_readfirstlane_b32 s60, v15
s_nop 0
s_cmp_ge_u32 s60, 8
s_cbranch_scc1 L_ckd73
ds_read_b128 v[8:11], v12 offset:0
s_waitcnt lgkmcnt(0)
s_branch L_ck72
L_ckd73:
v_mfma_f32_32x32x16_bf16 v[32:47], v[176:179], v[112:115], v[32:47]
ds_read_b128 v[96:99], v20 offset:16384
ds_read_b128 v[100:103], v20 offset:20480
v_mfma_f32_32x32x16_bf16 v[48:63], v[176:179], v[116:119], v[48:63]
ds_read_b128 v[104:107], v20 offset:24576
ds_read_b128 v[108:111], v20 offset:28672
v_mfma_f32_32x32x16_bf16 v[64:79], v[176:179], v[120:123], v[64:79]
buffer_load_dwordx4 v247, s[52:55], s62 offen offset:3072 lds
v_mfma_f32_32x32x16_bf16 v[80:95], v[176:179], v[124:127], v[80:95]
buffer_load_dwordx4 v[176:179], v2, s[40:43], s63 offen offset:3072 sc1
s_waitcnt vmcnt(38) lgkmcnt(3)
v_mfma_f32_32x32x16_bf16 v[32:47], v[180:183], v[96:99], v[32:47]
ds_read_b128 v[112:115], v21 offset:16384
ds_read_b128 v[116:119], v21 offset:20480
s_waitcnt lgkmcnt(4)
v_mfma_f32_32x32x16_bf16 v[48:63], v[180:183], v[100:103], v[48:63]
ds_read_b128 v[120:123], v21 offset:24576
ds_read_b128 v[124:127], v21 offset:28672
s_waitcnt lgkmcnt(5)
v_mfma_f32_32x32x16_bf16 v[64:79], v[180:183], v[104:107], v[64:79]
s_add_u32 m0, s67, 81920
s_add_u32 s62, s64, 768
s_and_b32 s62, s62, 0x3ff
buffer_load_dwordx4 v244, s[48:51], s62 offen offset:0 lds
s_waitcnt lgkmcnt(4)
v_mfma_f32_32x32x16_bf16 v[80:95], v[180:183], v[108:111], v[80:95]
s_add_u32 s63, s65, 57344
s_and_b32 s63, s63, 0xffff
buffer_load_dwordx4 v[180:183], v2, s[40:43], s63 offen offset:0 sc1
s_waitcnt vmcnt(39) lgkmcnt(3)
v_mfma_f32_32x32x16_bf16 v[32:47], v[184:187], v[112:115], v[32:47]
ds_read_b128 v[96:99], v22 offset:16384
ds_read_b128 v[100:103], v22 offset:20480
s_waitcnt lgkmcnt(4)
v_mfma_f32_32x32x16_bf16 v[48:63], v[184:187], v[116:119], v[48:63]
ds_read_b128 v[104:107], v22 offset:24576
ds_read_b128 v[108:111], v22 offset:28672
s_waitcnt lgkmcnt(5)
v_mfma_f32_32x32x16_bf16 v[64:79], v[184:187], v[120:123], v[64:79]
buffer_load_dwordx4 v245, s[48:51], s62 offen offset:1024 lds
s_waitcnt lgkmcnt(4)
v_mfma_f32_32x32x16_bf16 v[80:95], v[184:187], v[124:127], v[80:95]
buffer_load_dwordx4 v[184:187], v2, s[40:43], s63 offen offset:1024 sc1
s_waitcnt vmcnt(39) lgkmcnt(3)
v_mfma_f32_32x32x16_bf16 v[32:47], v[188:191], v[96:99], v[32:47]
ds_read_b128 v[112:115], v23 offset:16384
ds_read_b128 v[116:119], v23 offset:20480
s_waitcnt lgkmcnt(4)
v_mfma_f32_32x32x16_bf16 v[48:63], v[188:191], v[100:103], v[48:63]
ds_read_b128 v[120:123], v23 offset:24576
ds_read_b128 v[124:127], v23 offset:28672
s_waitcnt lgkmcnt(5)
v_mfma_f32_32x32x16_bf16 v[64:79], v[188:191], v[104:107], v[64:79]
buffer_load_dwordx4 v246, s[48:51], s62 offen offset:2048 lds
s_waitcnt lgkmcnt(4)
v_mfma_f32_32x32x16_bf16 v[80:95], v[188:191], v[108:111], v[80:95]
buffer_load_dwordx4 v[188:191], v2, s[40:43], s63 offen offset:2048 sc1
s_waitcnt vmcnt(40) lgkmcnt(3)
v_mfma_f32_32x32x16_bf16 v[32:47], v[192:195], v[112:115], v[32:47]
ds_read_b128 v[96:99], v20 offset:32768
ds_read_b128 v[100:103], v20 offset:36864
s_waitcnt lgkmcnt(4)
v_mfma_f32_32x32x16_bf16 v[48:63], v[192:195], v[116:119], v[48:63]
ds_read_b128 v[104:107], v20 offset:40960
ds_read_b128 v[108:111], v20 offset:45056
s_waitcnt lgkmcnt(5)
v_mfma_f32_32x32x16_bf16 v[64:79], v[192:195], v[120:123], v[64:79]
buffer_load_dwordx4 v247, s[48:51], s62 offen offset:3072 lds
s_waitcnt lgkmcnt(4)
v_mfma_f32_32x32x16_bf16 v[80:95], v[192:195], v[124:127], v[80:95]
buffer_load_dwordx4 v[192:195], v2, s[40:43], s63 offen offset:3072 sc1
s_waitcnt vmcnt(9) lgkmcnt(3)
v_mov_b32 v14, 9
s_mov_b64 exec, 1
ds_write_b32 v13, v14
s_mov_b64 exec, -1
v_mfma_f32_32x32x16_bf16 v[32:47], v[196:199], v[96:99], v[32:47]
ds_read_b128 v[112:115], v21 offset:32768
ds_read_b128 v[116:119], v21 offset:36864
s_waitcnt lgkmcnt(5)
v_mfma_f32_32x32x16_bf16 v[48:63], v[196:199], v[100:103], v[48:63]
ds_read_b128 v[120:123], v21 offset:40960
ds_read_b128 v[124:127], v21 offset:45056
s_waitcnt lgkmcnt(6)
v_mfma_f32_32x32x16_bf16 v[64:79], v[196:199], v[104:107], v[64:79]
s_add_u32 m0, s67, 98304
s_nop 0
buffer_load_dwordx4 v244, s[52:55], s62 offen offset:0 lds
s_waitcnt lgkmcnt(5)
v_mfma_f32_32x32x16_bf16 v[80:95], v[196:199], v[108:111], v[80:95]
s_add_u32 s63, s65, 61440
s_and_b32 s63, s63, 0xffff
buffer_load_dwordx4 v[196:199], v2, s[40:43], s63 offen offset:0 sc1
s_waitcnt vmcnt(41) lgkmcnt(3)
v_mfma_f32_32x32x16_bf16 v[32:47], v[200:203], v[112:115], v[32:47]
ds_read_b128 v[96:99], v22 offset:32768
ds_read_b128 v[100:103], v22 offset:36864
s_waitcnt lgkmcnt(4)
v_mfma_f32_32x32x16_bf16 v[48:63], v[200:203], v[116:119], v[48:63]
ds_read_b128 v[104:107], v22 offset:40960
ds_read_b128 v[108:111], v22 offset:45056
s_waitcnt lgkmcnt(5)
v_mfma_f32_32x32x16_bf16 v[64:79], v[200:203], v[120:123], v[64:79]
buffer_load_dwordx4 v245, s[52:55], s62 offen offset:1024 lds
s_waitcnt lgkmcnt(4)
v_mfma_f32_32x32x16_bf16 v[80:95], v[200:203], v[124:127], v[80:95]
buffer_load_dwordx4 v[200:203], v2, s[40:43], s63 offen offset:1024 sc1
s_waitcnt vmcnt(41) lgkmcnt(3)
v_mfma_f32_32x32x16_bf16 v[32:47], v[204:207], v[96:99], v[32:47]
ds_read_b128 v[112:115], v23 offset:32768
ds_read_b128 v[116:119], v23 offset:36864
s_waitcnt lgkmcnt(4)
v_mfma_f32_32x32x16_bf16 v[48:63], v[204:207], v[100:103], v[48:63]
ds_read_b128 v[120:123], v23 offset:40960
ds_read_b128 v[124:127], v23 offset:45056
s_waitcnt lgkmcnt(5)
v_mfma_f32_32x32x16_bf16 v[64:79], v[204:207], v[104:107], v[64:79]
buffer_load_dwordx4 v246, s[52:55], s62 offen offset:2048 lds
s_waitcnt lgkmcnt(4)
v_mfma_f32_32x32x16_bf16 v[80:95], v[204:207], v[108:111], v[80:95]
buffer_load_dwordx4 v[204:207], v2, s[40:43], s63 offen offset:2048 sc1
ds_read_b128 v[8:11], v12
s_waitcnt vmcnt(42) lgkmcnt(0)
L_ck74:
v_min3_u32 v15, v8, v9, v10
v_min_u32 v15, v15, v11
s_nop 0
v_readfirstlane_b32 s60, v15
s_nop 0
s_cmp_ge_u32 s60, 9
s_cbranch_scc1 L_ckd75
ds_read_b128 v[8:11], v12 offset:0
s_waitcnt lgkmcnt(0)
s_branch L_ck74
L_ckd75:
v_mfma_f32_32x32x16_bf16 v[32:47], v[208:211], v[112:115], v[32:47]
ds_read_b128 v[96:99], v20 offset:49152
ds_read_b128 v[100:103], v20 offset:53248
v_mfma_f32_32x32x16_bf16 v[48:63], v[208:211], v[116:119], v[48:63]
ds_read_b128 v[104:107], v20 offset:57344
ds_read_b128 v[108:111], v20 offset:61440
v_mfma_f32_32x32x16_bf16 v[64:79], v[208:211], v[120:123], v[64:79]
buffer_load_dwordx4 v247, s[52:55], s62 offen offset:3072 lds
v_mfma_f32_32x32x16_bf16 v[80:95], v[208:211], v[124:127], v[80:95]
buffer_load_dwordx4 v[208:211], v2, s[40:43], s63 offen offset:3072 sc1
s_waitcnt vmcnt(42) lgkmcnt(3)
v_mfma_f32_32x32x16_bf16 v[32:47], v[212:215], v[96:99], v[32:47]
ds_read_b128 v[112:115], v21 offset:49152
ds_read_b128 v[116:119], v21 offset:53248
s_waitcnt lgkmcnt(4)
v_mfma_f32_32x32x16_bf16 v[48:63], v[212:215], v[100:103], v[48:63]
ds_read_b128 v[120:123], v21 offset:57344
ds_read_b128 v[124:127], v21 offset:61440
s_waitcnt lgkmcnt(5)
v_mfma_f32_32x32x16_bf16 v[64:79], v[212:215], v[104:107], v[64:79]
s_add_u32 m0, s67, 0
s_add_u32 s62, s64, 896
s_and_b32 s62, s62, 0x3ff
buffer_load_dwordx4 v244, s[48:51], s62 offen offset:0 lds
s_waitcnt lgkmcnt(4)
v_mfma_f32_32x32x16_bf16 v[80:95], v[212:215], v[108:111], v[80:95]
s_waitcnt vmcnt(42) lgkmcnt(3)
v_mfma_f32_32x32x16_bf16 v[32:47], v[216:219], v[112:115], v[32:47]
ds_read_b128 v[96:99], v22 offset:49152
ds_read_b128 v[100:103], v22 offset:53248
s_waitcnt lgkmcnt(4)
v_mfma_f32_32x32x16_bf16 v[48:63], v[216:219], v[116:119], v[48:63]
ds_read_b128 v[104:107], v22 offset:57344
ds_read_b128 v[108:111], v22 offset:61440
s_waitcnt lgkmcnt(5)
v_mfma_f32_32x32x16_bf16 v[64:79], v[216:219], v[120:123], v[64:79]
buffer_load_dwordx4 v245, s[48:51], s62 offen offset:1024 lds
s_waitcnt lgkmcnt(4)
v_mfma_f32_32x32x16_bf16 v[80:95], v[216:219], v[124:127], v[80:95]
s_waitcnt vmcnt(41) lgkmcnt(3)
v_mfma_f32_32x32x16_bf16 v[32:47], v[220:223], v[96:99], v[32:47]
ds_read_b128 v[112:115], v23 offset:49152
ds_read_b128 v[116:119], v23 offset:53248
s_waitcnt lgkmcnt(4)
v_mfma_f32_32x32x16_bf16 v[48:63], v[220:223], v[100:103], v[48:63]
ds_read_b128 v[120:123], v23 offset:57344
ds_read_b128 v[124:127], v23 offset:61440
s_waitcnt lgkmcnt(5)
v_mfma_f32_32x32x16_bf16 v[64:79], v[220:223], v[104:107], v[64:79]
buffer_load_dwordx4 v246, s[48:51], s62 offen offset:2048 lds
s_waitcnt lgkmcnt(4)
v_mfma_f32_32x32x16_bf16 v[80:95], v[220:223], v[108:111], v[80:95]
s_waitcnt vmcnt(41) lgkmcnt(3)
v_mfma_f32_32x32x16_bf16 v[32:47], v[224:227], v[112:115], v[32:47]
ds_read_b128 v[96:99], v24 offset:0
ds_read_b128 v[100:103], v24 offset:4096
s_waitcnt lgkmcnt(4)
v_mfma_f32_32x32x16_bf16 v[48:63], v[224:227], v[116:119], v[48:63]
ds_read_b128 v[104:107], v24 offset:8192
ds_read_b128 v[108:111], v24 offset:12288
s_waitcnt lgkmcnt(5)
v_mfma_f32_32x32x16_bf16 v[64:79], v[224:227], v[120:123], v[64:79]
buffer_load_dwordx4 v247, s[48:51], s62 offen offset:3072 lds
s_waitcnt lgkmcnt(4)
v_mfma_f32_32x32x16_bf16 v[80:95], v[224:227], v[124:127], v[80:95]
s_waitcnt vmcnt(5) lgkmcnt(3)
v_mov_b32 v14, 10
s_mov_b64 exec, 1
ds_write_b32 v13, v14
s_mov_b64 exec, -1
v_mfma_f32_32x32x16_bf16 v[32:47], v[228:231], v[96:99], v[32:47]
ds_read_b128 v[112:115], v25 offset:0
ds_read_b128 v[116:119], v25 offset:4096
s_waitcnt lgkmcnt(5)
v_mfma_f32_32x32x16_bf16 v[48:63], v[228:231], v[100:103], v[48:63]
ds_read_b128 v[120:123], v25 offset:8192
ds_read_b128 v[124:127], v25 offset:12288
s_waitcnt lgkmcnt(6)
v_mfma_f32_32x32x16_bf16 v[64:79], v[228:231], v[104:107], v[64:79]
s_add_u32 m0, s67, 16384
s_nop 0
buffer_load_dwordx4 v244, s[52:55], s62 offen offset:0 lds
s_waitcnt lgkmcnt(5)
v_mfma_f32_32x32x16_bf16 v[80:95], v[228:231], v[108:111], v[80:95]
s_waitcnt vmcnt(40) lgkmcnt(3)
v_mfma_f32_32x32x16_bf16 v[32:47], v[232:235], v[112:115], v[32:47]
ds_read_b128 v[96:99], v26 offset:0
ds_read_b128 v[100:103], v26 offset:4096
s_waitcnt lgkmcnt(4)
v_mfma_f32_32x32x16_bf16 v[48:63], v[232:235], v[116:119], v[48:63]
ds_read_b128 v[104:107], v26 offset:8192
ds_read_b128 v[108:111], v26 offset:12288
s_waitcnt lgkmcnt(5)
v_mfma_f32_32x32x16_bf16 v[64:79], v[232:235], v[120:123], v[64:79]
buffer_load_dwordx4 v245, s[52:55], s62 offen offset:1024 lds
s_waitcnt lgkmcnt(4)
v_mfma_f32_32x32x16_bf16 v[80:95], v[232:235], v[124:127], v[80:95]
s_waitcnt vmcnt(39) lgkmcnt(3)
v_mfma_f32_32x32x16_bf16 v[32:47], v[236:239], v[96:99], v[32:47]
ds_read_b128 v[112:115], v27 offset:0
ds_read_b128 v[116:119], v27 offset:4096
s_waitcnt lgkmcnt(4)
v_mfma_f32_32x32x16_bf16 v[48:63], v[236:239], v[100:103], v[48:63]
ds_read_b128 v[120:123], v27 offset:8192
ds_read_b128 v[124:127], v27 offset:12288
s_waitcnt lgkmcnt(5)
v_mfma_f32_32x32x16_bf16 v[64:79], v[236:239], v[104:107], v[64:79]
buffer_load_dwordx4 v246, s[52:55], s62 offen offset:2048 lds
s_waitcnt lgkmcnt(4)
v_mfma_f32_32x32x16_bf16 v[80:95], v[236:239], v[108:111], v[80:95]
ds_read_b128 v[8:11], v12
global_load_dword v31, v30, s[26:27]
s_waitcnt vmcnt(40) lgkmcnt(0)
L_ck76:
v_min3_u32 v15, v8, v9, v10
v_min_u32 v15, v15, v11
s_nop 0
v_readfirstlane_b32 s60, v15
s_nop 0
s_cmp_ge_u32 s60, 10
s_cbranch_scc1 L_ckd77
ds_read_b128 v[8:11], v12 offset:0
s_waitcnt lgkmcnt(0)
s_branch L_ck76
L_ckd77:
v_mfma_f32_32x32x16_bf16 v[32:47], v[240:243], v[112:115], v[32:47]
ds_read_b128 v[96:99], v24 offset:16384
ds_read_b128 v[100:103], v24 offset:20480
v_mfma_f32_32x32x16_bf16 v[48:63], v[240:243], v[116:119], v[48:63]
ds_read_b128 v[104:107], v24 offset:24576
ds_read_b128 v[108:111], v24 offset:28672
v_mfma_f32_32x32x16_bf16 v[64:79], v[240:243], v[120:123], v[64:79]
buffer_load_dwordx4 v247, s[52:55], s62 offen offset:3072 lds
v_mfma_f32_32x32x16_bf16 v[80:95], v[240:243], v[124:127], v[80:95]
s_mov_b32 s60, 0
buffer_load_dword v128, v28, s[56:59], s60 offen offset:0
s_waitcnt vmcnt(40) lgkmcnt(3)
v_mfma_f32_32x32x16_bf16 v[32:47], v[148:151], v[96:99], v[32:47]
ds_read_b128 v[112:115], v25 offset:16384
ds_read_b128 v[116:119], v25 offset:20480
s_waitcnt lgkmcnt(4)
v_mfma_f32_32x32x16_bf16 v[48:63], v[148:151], v[100:103], v[48:63]
ds_read_b128 v[120:123], v25 offset:24576
ds_read_b128 v[124:127], v25 offset:28672
s_waitcnt lgkmcnt(5)
v_mfma_f32_32x32x16_bf16 v[64:79], v[148:151], v[104:107], v[64:79]
s_waitcnt lgkmcnt(4)
v_mfma_f32_32x32x16_bf16 v[80:95], v[148:151], v[108:111], v[80:95]
s_mov_b32 s60, 0
buffer_load_dword v129, v28, s[56:59], s60 offen offset:2048
s_waitcnt vmcnt(39) lgkmcnt(3)
v_mfma_f32_32x32x16_bf16 v[32:47], v[152:155], v[112:115], v[32:47]
ds_read_b128 v[96:99], v26 offset:16384
ds_read_b128 v[100:103], v26 offset:20480
s_waitcnt lgkmcnt(4)
v_mfma_f32_32x32x16_bf16 v[48:63], v[152:155], v[116:119], v[48:63]
ds_read_b128 v[104:107], v26 offset:24576
ds_read_b128 v[108:111], v26 offset:28672
s_waitcnt lgkmcnt(5)
v_mfma_f32_32x32x16_bf16 v[64:79], v[152:155], v[120:123], v[64:79]
s_waitcnt lgkmcnt(4)
v_mfma_f32_32x32x16_bf16 v[80:95], v[152:155], v[124:127], v[80:95]
s_mov_b32 s60, 4096
buffer_load_dword v130, v28, s[56:59], s60 offen offset:0
s_waitcnt vmcnt(38) lgkmcnt(3)
v_mfma_f32_32x32x16_bf16 v[32:47], v[156:159], v[96:99], v[32:47]
ds_read_b128 v[112:115], v27 offset:16384
ds_read_b128 v[116:119], v27 offset:20480
s_waitcnt lgkmcnt(4)
v_mfma_f32_32x32x16_bf16 v[48:63], v[156:159], v[100:103], v[48:63]
ds_read_b128 v[120:123], v27 offset:24576
ds_read_b128 v[124:127], v27 offset:28672
s_waitcnt lgkmcnt(5)
v_mfma_f32_32x32x16_bf16 v[64:79], v[156:159], v[104:107], v[64:79]
s_waitcnt lgkmcnt(4)
v_mfma_f32_32x32x16_bf16 v[80:95], v[156:159], v[108:111], v[80:95]
s_mov_b32 s60, 4096
buffer_load_dword v131, v28, s[56:59], s60 offen offset:2048
s_waitcnt vmcnt(37) lgkmcnt(3)
v_mfma_f32_32x32x16_bf16 v[32:47], v[160:163], v[112:115], v[32:47]
ds_read_b128 v[96:99], v24 offset:32768
ds_read_b128 v[100:103], v24 offset:36864
s_waitcnt lgkmcnt(4)
v_mfma_f32_32x32x16_bf16 v[48:63], v[160:163], v[116:119], v[48:63]
s_waitcnt lgkmcnt(3)
v_mfma_f32_32x32x16_bf16 v[64:79], v[160:163], v[120:123], v[64:79]
s_waitcnt lgkmcnt(2)
v_mfma_f32_32x32x16_bf16 v[80:95], v[160:163], v[124:127], v[80:95]
s_mov_b32 s60, 65536
buffer_load_dword v132, v28, s[56:59], s60 offen offset:0
s_waitcnt vmcnt(5) lgkmcnt(1)
v_mov_b32 v14, 11
s_mov_b64 exec, 1
ds_write_b32 v13, v14
s_mov_b64 exec, -1
v_mfma_f32_32x32x16_bf16 v[32:47], v[164:167], v[96:99], v[32:47]
ds_read_b128 v[112:115], v25 offset:32768
ds_read_b128 v[116:119], v25 offset:36864
s_waitcnt lgkmcnt(3)
v_mfma_f32_32x32x16_bf16 v[48:63], v[164:167], v[100:103], v[48:63]
s_mov_b32 s60, 65536
buffer_load_dword v133, v28, s[56:59], s60 offen offset:2048
s_waitcnt vmcnt(35) lgkmcnt(1)
v_mfma_f32_32x32x16_bf16 v[32:47], v[168:171], v[112:115], v[32:47]
ds_read_b128 v[96:99], v26 offset:32768
ds_read_b128 v[100:103], v26 offset:36864
s_waitcnt lgkmcnt(2)
v_mfma_f32_32x32x16_bf16 v[48:63], v[168:171], v[116:119], v[48:63]
s_mov_b32 s60, 69632
buffer_load_dword v134, v28, s[56:59], s60 offen offset:0
s_waitcnt vmcnt(34) lgkmcnt(1)
v_mfma_f32_32x32x16_bf16 v[32:47], v[172:175], v[96:99], v[32:47]
ds_read_b128 v[112:115], v27 offset:32768
ds_read_b128 v[116:119], v27 offset:36864
s_waitcnt lgkmcnt(2)
v_mfma_f32_32x32x16_bf16 v[48:63], v[172:175], v[100:103], v[48:63]
ds_read_b128 v[8:11], v12
s_mov_b32 s60, 69632
buffer_load_dword v135, v28, s[56:59], s60 offen offset:2048
s_waitcnt vmcnt(33) lgkmcnt(0)
L_ck78:
v_min3_u32 v15, v8, v9, v10
v_min_u32 v15, v15, v11
s_nop 0
v_readfirstlane_b32 s60, v15
s_nop 0
s_cmp_ge_u32 s60, 11
s_cbranch_scc1 L_ckd79
ds_read_b128 v[8:11], v12 offset:0
s_waitcnt lgkmcnt(0)
s_branch L_ck78
L_ckd79:
v_mfma_f32_32x32x16_bf16 v[32:47], v[176:179], v[112:115], v[32:47]
ds_read_b128 v[96:99], v20 offset:0
ds_read_b128 v[100:103], v20 offset:4096
v_mfma_f32_32x32x16_bf16 v[48:63], v[176:179], v[116:119], v[48:63]
s_mov_b32 s60, 8192
buffer_load_dword v136, v28, s[56:59], s60 offen offset:0
s_waitcnt vmcnt(32) lgkmcnt(1)
v_mfma_f32_32x32x16_bf16 v[32:47], v[180:183], v[96:99], v[32:47]
ds_read_b128 v[112:115], v21 offset:0
ds_read_b128 v[116:119], v21 offset:4096
s_waitcnt lgkmcnt(2)
v_mfma_f32_32x32x16_bf16 v[48:63], v[180:183], v[100:103], v[48:63]
s_mov_b32 s60, 8192
buffer_load_dword v137, v28, s[56:59], s60 offen offset:2048
s_waitcnt vmcnt(31) lgkmcnt(1)
v_mfma_f32_32x32x16_bf16 v[32:47], v[184:187], v[112:115], v[32:47]
ds_read_b128 v[96:99], v22 offset:0
ds_read_b128 v[100:103], v22 offset:4096
s_waitcnt lgkmcnt(2)
v_mfma_f32_32x32x16_bf16 v[48:63], v[184:187], v[116:119], v[48:63]
s_mov_b32 s60, 12288
buffer_load_dword v138, v28, s[56:59], s60 offen offset:0
s_waitcnt vmcnt(30) lgkmcnt(1)
v_mfma_f32_32x32x16_bf16 v[32:47], v[188:191], v[96:99], v[32:47]
ds_read_b128 v[112:115], v23 offset:0
ds_read_b128 v[116:119], v23 offset:4096
s_waitcnt lgkmcnt(2)
v_mfma_f32_32x32x16_bf16 v[48:63], v[188:191], v[100:103], v[48:63]
s_mov_b32 s60, 12288
buffer_load_dword v139, v28, s[56:59], s60 offen offset:2048
s_waitcnt vmcnt(29) lgkmcnt(1)
v_mfma_f32_32x32x16_bf16 v[32:47], v[192:195], v[112:115], v[32:47]
ds_read_b128 v[96:99], v20 offset:16384
ds_read_b128 v[100:103], v20 offset:20480
s_waitcnt lgkmcnt(2)
v_mfma_f32_32x32x16_bf16 v[48:63], v[192:195], v[116:119], v[48:63]
s_mov_b32 s60, 73728
buffer_load_dword v140, v28, s[56:59], s60 offen offset:0
s_waitcnt vmcnt(28) lgkmcnt(1)
v_mfma_f32_32x32x16_bf16 v[32:47], v[196:199], v[96:99], v[32:47]
ds_read_b128 v[112:115], v21 offset:16384
ds_read_b128 v[116:119], v21 offset:20480
s_waitcnt lgkmcnt(2)
v_mfma_f32_32x32x16_bf16 v[48:63], v[196:199], v[100:103], v[48:63]
s_mov_b32 s60, 73728
buffer_load_dword v141, v28, s[56:59], s60 offen offset:2048
s_waitcnt vmcnt(27) lgkmcnt(1)
v_mfma_f32_32x32x16_bf16 v[32:47], v[200:203], v[112:115], v[32:47]
ds_read_b128 v[96:99], v22 offset:16384
ds_read_b128 v[100:103], v22 offset:20480
s_waitcnt lgkmcnt(2)
v_mfma_f32_32x32x16_bf16 v[48:63], v[200:203], v[116:119], v[48:63]
s_mov_b32 s60, 77824
buffer_load_dword v142, v28, s[56:59], s60 offen offset:0
s_waitcnt vmcnt(26) lgkmcnt(1)
v_mfma_f32_32x32x16_bf16 v[32:47], v[204:207], v[96:99], v[32:47]
ds_read_b128 v[112:115], v23 offset:16384
ds_read_b128 v[116:119], v23 offset:20480
s_waitcnt lgkmcnt(2)
v_mfma_f32_32x32x16_bf16 v[48:63], v[204:207], v[100:103], v[48:63]
s_mov_b32 s60, 77824
buffer_load_dword v143, v28, s[56:59], s60 offen offset:2048
s_waitcnt vmcnt(25) lgkmcnt(0)
v_mfma_f32_32x32x16_bf16 v[32:47], v[208:211], v[112:115], v[32:47]
v_mfma_f32_32x32x16_bf16 v[48:63], v[208:211], v[116:119], v[48:63]
s_mul_i32 s60, s37, 0x9e3779b1
s_and_b32 s60, s60, 0xbfff0000
s_or_b32 s60, s60, 0x20000000
s_sub_u32 s61, s37, 1
s_xor_b32 s61, s61, s60
s_cmp_lt_u32 s61, 0x10000
s_cselect_b32 s61, 0x10000, 0
s_xor_b32 s60, s60, s61
s_lshl_b32 s64, s35, 4
s_add_u32 s64, s64, s36
s_lshl_b32 s64, s64, 2
s_add_u32 s64, s64, s34
s_lshl_b32 s64, s64, 13
s_add_u32 s50, s64, 33554432
s_add_u32 s48, s32, s50
s_addc_u32 s49, s33, 0
s_mov_b32 s50, 8192
s_mov_b32 s51, 0x20000
s_xor_b32 s64, s64, 262144
s_add_u32 s54, s64, 33554432
s_add_u32 s52, s32, s54
s_addc_u32 s53, s33, 0
s_mov_b32 s54, 8192
s_mov_b32 s55, 0x20000
s_movk_i32 s64, 0x1000
v_cvt_pk_bf16_f32 v96, v32, v48
v_cvt_pk_bf16_f32 v97, v33, v49
v_cvt_pk_bf16_f32 v98, v34, v50
v_cvt_pk_bf16_f32 v99, v35, s60
buffer_store_dwordx4 v[96:99], v2, s[48:51], 0 offen offset:0 sc1
v_cvt_pk_bf16_f32 v100, v51, v36
v_cvt_pk_bf16_f32 v101, v52, v37
v_cvt_pk_bf16_f32 v102, v53, v38
v_cvt_pk_bf16_f32 v103, v54, s60
buffer_store_dwordx4 v[100:103], v2, s[48:51], 0 offen offset:1024 sc1
v_cvt_pk_bf16_f32 v244, v39, v55
v_cvt_pk_bf16_f32 v245, v40, v56
v_cvt_pk_bf16_f32 v246, v41, v57
v_cvt_pk_bf16_f32 v247, v42, s60
buffer_store_dwordx4 v[244:247], v2, s[48:51], 0 offen offset:2048 sc1
v_cvt_pk_bf16_f32 v248, v58, v43
v_cvt_pk_bf16_f32 v249, v59, v44
v_cvt_pk_bf16_f32 v250, v60, v45
v_cvt_pk_bf16_f32 v251, v61, s60
buffer_store_dwordx4 v[248:251], v2, s[48:51], 0 offen offset:3072 sc1
v_cvt_pk_bf16_f32 v252, v46, v62
v_cvt_pk_bf16_f32 v253, v47, v63
v_cvt_pk_bf16_f32 v254, v63, v63
v_cvt_pk_bf16_f32 v255, v63, s60
buffer_store_dwordx4 v[252:255], v2, s[48:51], s64 offen offset:0 sc1
ds_read_b128 v[104:107], v24 offset:40960
ds_read_b128 v[108:111], v24 offset:45056
ds_read_b128 v[120:123], v25 offset:40960
ds_read_b128 v[124:127], v25 offset:45056
s_waitcnt lgkmcnt(2)
v_mfma_f32_32x32x16_bf16 v[64:79], v[164:167], v[104:107], v[64:79]
v_mfma_f32_32x32x16_bf16 v[80:95], v[164:167], v[108:111], v[80:95]
ds_read_b128 v[104:107], v26 offset:40960
ds_read_b128 v[108:111], v26 offset:45056
s_waitcnt lgkmcnt(2)
v_mfma_f32_32x32x16_bf16 v[64:79], v[168:171], v[120:123], v[64:79]
v_mfma_f32_32x32x16_bf16 v[80:95], v[168:171], v[124:127], v[80:95]
ds_read_b128 v[120:123], v27 offset:40960
ds_read_b128 v[124:127], v27 offset:45056
s_waitcnt lgkmcnt(2)
v_mfma_f32_32x32x16_bf16 v[64:79], v[172:175], v[104:107], v[64:79]
v_mfma_f32_32x32x16_bf16 v[80:95], v[172:175], v[108:111], v[80:95]
ds_read_b128 v[104:107], v20 offset:8192
ds_read_b128 v[108:111], v20 offset:12288
s_waitcnt lgkmcnt(2)
v_mfma_f32_32x32x16_bf16 v[64:79], v[176:179], v[120:123], v[64:79]
v_mfma_f32_32x32x16_bf16 v[80:95], v[176:179], v[124:127], v[80:95]
ds_read_b128 v[120:123], v21 offset:8192
ds_read_b128 v[124:127], v21 offset:12288
s_waitcnt lgkmcnt(2)
v_mfma_f32_32x32x16_bf16 v[64:79], v[180:183], v[104:107], v[64:79]
v_mfma_f32_32x32x16_bf16 v[80:95], v[180:183], v[108:111], v[80:95]
ds_read_b128 v[104:107], v22 offset:8192
ds_read_b128 v[108:111], v22 offset:12288
s_waitcnt lgkmcnt(2)
v_mfma_f32_32x32x16_bf16 v[64:79], v[184:187], v[120:123], v[64:79]
v_mfma_f32_32x32x16_bf16 v[80:95], v[184:187], v[124:127], v[80:95]
ds_read_b128 v[120:123], v23 offset:8192
ds_read_b128 v[124:127], v23 offset:12288
s_waitcnt lgkmcnt(2)
v_mfma_f32_32x32x16_bf16 v[64:79], v[188:191], v[104:107], v[64:79]
v_mfma_f32_32x32x16_bf16 v[80:95], v[188:191], v[108:111], v[80:95]
ds_read_b128 v[104:107], v20 offset:24576
ds_read_b128 v[108:111], v20 offset:28672
s_waitcnt lgkmcnt(2)
v_mfma_f32_32x32x16_bf16 v[64:79], v[192:195], v[120:123], v[64:79]
v_mfma_f32_32x32x16_bf16 v[80:95], v[192:195], v[124:127], v[80:95]
ds_read_b128 v[120:123], v21 offset:24576
ds_read_b128 v[124:127], v21 offset:28672
s_waitcnt lgkmcnt(2)
v_mfma_f32_32x32x16_bf16 v[64:79], v[196:199], v[104:107], v[64:79]
v_mfma_f32_32x32x16_bf16 v[80:95], v[196:199], v[108:111], v[80:95]
ds_read_b128 v[104:107], v22 offset:24576
ds_read_b128 v[108:111], v22 offset:28672
s_waitcnt lgkmcnt(2)
v_mfma_f32_32x32x16_bf16 v[64:79], v[200:203], v[120:123], v[64:79]
v_mfma_f32_32x32x16_bf16 v[80:95], v[200:203], v[124:127], v[80:95]
ds_read_b128 v[120:123], v23 offset:24576
ds_read_b128 v[124:127], v23 offset:28672
s_waitcnt lgkmcnt(2)
v_mfma_f32_32x32x16_bf16 v[64:79], v[204:207], v[104:107], v[64:79]
v_mfma_f32_32x32x16_bf16 v[80:95], v[204:207], v[108:111], v[80:95]
s_waitcnt lgkmcnt(0)
v_mfma_f32_32x32x16_bf16 v[64:79], v[208:211], v[120:123], v[64:79]
v_mfma_f32_32x32x16_bf16 v[80:95], v[208:211], v[124:127], v[80:95]
s_waitcnt vmcnt(5)
v_lshlrev_b32 v8, 16, v31
v_and_b32 v9, 0xffff0000, v31
v_lshlrev_b32 v148, 16, v128
v_and_b32 v149, 0xffff0000, v128
v_pk_mul_f32 v[148:149], v[148:149], v[8:9]
v_cvt_pk_bf16_f32 v10, v148, v149
v_lshlrev_b32 v148, 16, v10
v_and_b32 v149, 0xffff0000, v10
s_nop 1
v_add_f32 v148, v148, v64
v_add_f32 v149, v149, v80
v_lshlrev_b32 v150, 16, v129
v_and_b32 v151, 0xffff0000, v129
v_pk_mul_f32 v[150:151], v[150:151], v[8:9]
v_cvt_pk_bf16_f32 v10, v150, v151
v_lshlrev_b32 v150, 16, v10
v_and_b32 v151, 0xffff0000, v10
v_add_f32 v150, v150, v65
v_add_f32 v151, v151, v81
v_lshlrev_b32 v152, 16, v130
v_and_b32 v153, 0xffff0000, v130
v_pk_mul_f32 v[152:153], v[152:153], v[8:9]
v_cvt_pk_bf16_f32 v10, v152, v153
v_lshlrev_b32 v152, 16, v10
v_and_b32 v153, 0xffff0000, v10
v_add_f32 v152, v152, v66
v_add_f32 v153, v153, v82
v_lshlrev_b32 v154, 16, v131
v_and_b32 v155, 0xffff0000, v131
v_pk_mul_f32 v[154:155], v[154:155], v[8:9]
v_cvt_pk_bf16_f32 v10, v154, v155
v_lshlrev_b32 v154, 16, v10
v_and_b32 v155, 0xffff0000, v10
v_add_f32 v154, v154, v67
v_add_f32 v155, v155, v83
v_lshlrev_b32 v156, 16, v132
v_and_b32 v157, 0xffff0000, v132
v_pk_mul_f32 v[156:157], v[156:157], v[8:9]
v_cvt_pk_bf16_f32 v10, v156, v157
v_lshlrev_b32 v156, 16, v10
v_and_b32 v157, 0xffff0000, v10
v_add_f32 v156, v156, v68
v_add_f32 v157, v157, v84
v_lshlrev_b32 v158, 16, v133
v_and_b32 v159, 0xffff0000, v133
v_pk_mul_f32 v[158:159], v[158:159], v[8:9]
v_cvt_pk_bf16_f32 v10, v158, v159
v_lshlrev_b32 v158, 16, v10
v_and_b32 v159, 0xffff0000, v10
v_add_f32 v158, v158, v69
v_add_f32 v159, v159, v85
v_lshlrev_b32 v160, 16, v134
v_and_b32 v161, 0xffff0000, v134
v_pk_mul_f32 v[160:161], v[160:161], v[8:9]
v_cvt_pk_bf16_f32 v10, v160, v161
v_lshlrev_b32 v160, 16, v10
v_and_b32 v161, 0xffff0000, v10
v_add_f32 v160, v160, v70
v_add_f32 v161, v161, v86
v_lshlrev_b32 v162, 16, v135
v_and_b32 v163, 0xffff0000, v135
v_pk_mul_f32 v[162:163], v[162:163], v[8:9]
v_cvt_pk_bf16_f32 v10, v162, v163
v_lshlrev_b32 v162, 16, v10
v_and_b32 v163, 0xffff0000, v10
v_add_f32 v162, v162, v71
v_add_f32 v163, v163, v87
v_lshlrev_b32 v164, 16, v136
v_and_b32 v165, 0xffff0000, v136
v_pk_mul_f32 v[164:165], v[164:165], v[8:9]
v_cvt_pk_bf16_f32 v10, v164, v165
v_lshlrev_b32 v164, 16, v10
v_and_b32 v165, 0xffff0000, v10
v_add_f32 v164, v164, v72
v_add_f32 v165, v165, v88
v_lshlrev_b32 v166, 16, v137
v_and_b32 v167, 0xffff0000, v137
v_pk_mul_f32 v[166:167], v[166:167], v[8:9]
v_cvt_pk_bf16_f32 v10, v166, v167
v_lshlrev_b32 v166, 16, v10
v_and_b32 v167, 0xffff0000, v10
v_add_f32 v166, v166, v73
v_add_f32 v167, v167, v89
v_lshlrev_b32 v168, 16, v138
v_and_b32 v169, 0xffff0000, v138
v_pk_mul_f32 v[168:169], v[168:169], v[8:9]
v_cvt_pk_bf16_f32 v10, v168, v169
v_lshlrev_b32 v168, 16, v10
v_and_b32 v169, 0xffff0000, v10
v_add_f32 v168, v168, v74
v_add_f32 v169, v169, v90
v_lshlrev_b32 v170, 16, v139
v_and_b32 v171, 0xffff0000, v139
v_pk_mul_f32 v[170:171], v[170:171], v[8:9]
v_cvt_pk_bf16_f32 v10, v170, v171
v_lshlrev_b32 v170, 16, v10
v_and_b32 v171, 0xffff0000, v10
v_add_f32 v170, v170, v75
v_add_f32 v171, v171, v91
v_lshlrev_b32 v172, 16, v140
v_and_b32 v173, 0xffff0000, v140
v_pk_mul_f32 v[172:173], v[172:173], v[8:9]
v_cvt_pk_bf16_f32 v10, v172, v173
v_lshlrev_b32 v172, 16, v10
v_and_b32 v173, 0xffff0000, v10
v_add_f32 v172, v172, v76
v_add_f32 v173, v173, v92
v_lshlrev_b32 v174, 16, v141
v_and_b32 v175, 0xffff0000, v141
v_pk_mul_f32 v[174:175], v[174:175], v[8:9]
v_cvt_pk_bf16_f32 v10, v174, v175
v_lshlrev_b32 v174, 16, v10
v_and_b32 v175, 0xffff0000, v10
v_add_f32 v174, v174, v77
v_add_f32 v175, v175, v93
v_lshlrev_b32 v176, 16, v142
v_and_b32 v177, 0xffff0000, v142
v_pk_mul_f32 v[176:177], v[176:177], v[8:9]
v_cvt_pk_bf16_f32 v10, v176, v177
v_lshlrev_b32 v176, 16, v10
v_and_b32 v177, 0xffff0000, v10
v_add_f32 v176, v176, v78
v_add_f32 v177, v177, v94
v_lshlrev_b32 v178, 16, v143
v_and_b32 v179, 0xffff0000, v143
v_pk_mul_f32 v[178:179], v[178:179], v[8:9]
v_cvt_pk_bf16_f32 v10, v178, v179
v_lshlrev_b32 v178, 16, v10
v_and_b32 v179, 0xffff0000, v10
v_add_f32 v178, v178, v79
v_add_f32 v179, v179, v95
s_mov_b32 s44, s28
s_mov_b32 s45, s29
s_mov_b32 s46, s24
s_mov_b32 s47, 0x20000
s_mov_b32 s92, 0
L_xw82:
s_load_dword s61, s[52:53], 5116 glc
s_add_u32 s92, s92, 1
s_waitcnt lgkmcnt(0)
s_xor_b32 s61, s61, s60
s_cmp_lt_u32 s61, 0x10000
s_cbranch_scc1 L_xwd83
s_cmp_lt_u32 s92, 200000
s_cbranch_scc1 L_xw82
L_xwd83:
s_mov_b32 s92, 0
buffer_load_dwordx4 v[180:183], v2, s[52:55], 0 offen offset:0 sc1
buffer_load_dwordx4 v[184:187], v2, s[52:55], 0 offen offset:1024 sc1
buffer_load_dwordx4 v[188:191], v2, s[52:55], 0 offen offset:2048 sc1
buffer_load_dwordx4 v[192:195], v2, s[52:55], 0 offen offset:3072 sc1
buffer_load_dwordx4 v[196:199], v2, s[52:55], s64 offen offset:0 sc1
L_xl80:
v_mov_b32 v10, 0
s_waitcnt vmcnt(4)
v_bitop3_b32 v10, v10, v183, s60 bitop3:0xf6
s_waitcnt vmcnt(3)
v_bitop3_b32 v10, v10, v187, s60 bitop3:0xf6
s_waitcnt vmcnt(2)
v_bitop3_b32 v10, v10, v191, s60 bitop3:0xf6
s_waitcnt vmcnt(1)
v_bitop3_b32 v10, v10, v195, s60 bitop3:0xf6
s_waitcnt vmcnt(0)
v_bitop3_b32 v10, v10, v199, s60 bitop3:0xf6
v_cmp_lt_u32 vcc, 0xffff, v10
s_nop 0
s_cbranch_vccz L_xd81
s_add_u32 s92, s92, 1
s_cmp_ge_u32 s92, 200000
s_cbranch_scc1 L_xd81
buffer_load_dwordx4 v[180:183], v2, s[52:55], 0 offen offset:0 sc1
buffer_load_dwordx4 v[184:187], v2, s[52:55], 0 offen offset:1024 sc1
buffer_load_dwordx4 v[188:191], v2, s[52:55], 0 offen offset:2048 sc1
buffer_load_dwordx4 v[192:195], v2, s[52:55], 0 offen offset:3072 sc1
buffer_load_dwordx4 v[196:199], v2, s[52:55], s64 offen offset:0 sc1
s_branch L_xl80
L_xd81:
v_lshlrev_b32 v10, 16, v180
v_and_b32 v11, 0xffff0000, v180
v_pk_add_f32 v[148:149], v[148:149], v[10:11]
s_mov_b32 s64, 0
buffer_store_dwordx2 v[148:149], v29, s[44:47], s64 offen nt
v_lshlrev_b32 v10, 16, v181
v_and_b32 v11, 0xffff0000, v181
v_pk_add_f32 v[150:151], v[150:151], v[10:11]
s_mov_b32 s64, 8192
buffer_store_dwordx2 v[150:151], v29, s[44:47], s64 offen nt
v_lshlrev_b32 v10, 16, v182
v_and_b32 v11, 0xffff0000, v182
v_pk_add_f32 v[152:153], v[152:153], v[10:11]
s_mov_b32 s64, 16384
buffer_store_dwordx2 v[152:153], v29, s[44:47], s64 offen nt
v_lshlrev_b32 v10, 16, v183
v_lshlrev_b32 v11, 16, v184
v_pk_add_f32 v[154:155], v[154:155], v[10:11]
s_mov_b32 s64, 24576
buffer_store_dwordx2 v[154:155], v29, s[44:47], s64 offen nt
v_and_b32 v10, 0xffff0000, v184
v_lshlrev_b32 v11, 16, v185
v_pk_add_f32 v[156:157], v[156:157], v[10:11]
s_mov_b32 s64, 262144
buffer_store_dwordx2 v[156:157], v29, s[44:47], s64 offen nt
v_and_b32 v10, 0xffff0000, v185
v_lshlrev_b32 v11, 16, v186
v_pk_add_f32 v[158:159], v[158:159], v[10:11]
s_mov_b32 s64, 270336
buffer_store_dwordx2 v[158:159], v29, s[44:47], s64 offen nt
v_and_b32 v10, 0xffff0000, v186
v_lshlrev_b32 v11, 16, v187
v_pk_add_f32 v[160:161], v[160:161], v[10:11]
s_mov_b32 s64, 278528
buffer_store_dwordx2 v[160:161], v29, s[44:47], s64 offen nt
v_lshlrev_b32 v10, 16, v188
v_and_b32 v11, 0xffff0000, v188
v_pk_add_f32 v[162:163], v[162:163], v[10:11]
s_mov_b32 s64, 286720
buffer_store_dwordx2 v[162:163], v29, s[44:47], s64 offen nt
v_lshlrev_b32 v10, 16, v189
v_and_b32 v11, 0xffff0000, v189
v_pk_add_f32 v[164:165], v[164:165], v[10:11]
s_mov_b32 s64, 32768
buffer_store_dwordx2 v[164:165], v29, s[44:47], s64 offen nt
v_lshlrev_b32 v10, 16, v190
v_and_b32 v11, 0xffff0000, v190
v_pk_add_f32 v[166:167], v[166:167], v[10:11]
s_mov_b32 s64, 40960
buffer_store_dwordx2 v[166:167], v29, s[44:47], s64 offen nt
v_lshlrev_b32 v10, 16, v191
v_lshlrev_b32 v11, 16, v192
v_pk_add_f32 v[168:169], v[168:169], v[10:11]
s_mov_b32 s64, 49152
buffer_store_dwordx2 v[168:169], v29, s[44:47], s64 offen nt
v_and_b32 v10, 0xffff0000, v192
v_lshlrev_b32 v11, 16, v193
v_pk_add_f32 v[170:171], v[170:171], v[10:11]
s_mov_b32 s64, 57344
buffer_store_dwordx2 v[170:171], v29, s[44:47], s64 offen nt
v_and_b32 v10, 0xffff0000, v193
v_lshlrev_b32 v11, 16, v194
v_pk_add_f32 v[172:173], v[172:173], v[10:11]
s_mov_b32 s64, 294912
buffer_store_dwordx2 v[172:173], v29, s[44:47], s64 offen nt
v_and_b32 v10, 0xffff0000, v194
v_lshlrev_b32 v11, 16, v195
v_pk_add_f32 v[174:175], v[174:175], v[10:11]
s_mov_b32 s64, 303104
buffer_store_dwordx2 v[174:175], v29, s[44:47], s64 offen nt
v_lshlrev_b32 v10, 16, v196
v_and_b32 v11, 0xffff0000, v196
v_pk_add_f32 v[176:177], v[176:177], v[10:11]
s_mov_b32 s64, 311296
buffer_store_dwordx2 v[176:177], v29, s[44:47], s64 offen nt
v_lshlrev_b32 v10, 16, v197
v_and_b32 v11, 0xffff0000, v197
v_pk_add_f32 v[178:179], v[178:179], v[10:11]
s_mov_b32 s64, 319488
buffer_store_dwordx2 v[178:179], v29, s[44:47], s64 offen nt
L_concat_heads__spectral_gfnet__ssm_conv_s5__prompt_kernel_end:
s_endpgm

.section .rodata,"a"
.p2align 6
.amdhsa_kernel concat_heads__spectral_gfnet__ssm_conv_s5__prompt_kernel
  .amdhsa_next_free_vgpr 256
  .amdhsa_next_free_sgpr 102
  .amdhsa_accum_offset 256
  .amdhsa_group_segment_fixed_size 0
  .amdhsa_kernarg_size 120
  .amdhsa_user_sgpr_count 2
  .amdhsa_user_sgpr_kernarg_segment_ptr 1
  .amdhsa_system_sgpr_workgroup_id_x 1
.end_amdhsa_kernel
.text
```

```asm
; @launch grid=(256,1,1) block=(512,1,1) lds=163840
.amdgcn_target "amdgcn-amd-amdhsa--gfx950"
.text
.globl concat_heads__spectral_gfnet__ssm_conv_s5__prompt_kernel
.p2align 8
.type concat_heads__spectral_gfnet__ssm_conv_s5__prompt_kernel,@function
concat_heads__spectral_gfnet__ssm_conv_s5__prompt_kernel:
s_cmp_ge_u32 s2, 256
s_cbranch_scc1 L_concat_heads__spectral_gfnet__ssm_conv_s5__prompt_kernel_end
s_load_dwordx16 s[4:19], s[0:1], 0
s_load_dwordx8 s[20:27], s[0:1], 64
s_load_dwordx4 s[28:31], s[0:1], 96
s_load_dwordx2 s[32:33], s[0:1], 112
v_lshrrev_b32 v2, 6, v0
v_and_b32 v1, 63, v0
v_readfirstlane_b32 s34, v2
s_and_b32 s60, s2, 7
s_lshr_b32 s61, s2, 3
s_lshr_b32 s35, s60, 1
s_lshr_b32 s62, s61, 3
s_lshl_b32 s62, s62, 2
s_add_u32 s35, s35, s62
s_and_b32 s36, s60, 1
s_lshl_b32 s36, s36, 3
s_and_b32 s62, s61, 7
s_add_u32 s36, s36, s62
s_xor_b32 s34, s34, 4
s_cmp_ge_u32 s34, 4
s_cbranch_scc0 L_concat_heads__spectral_gfnet__ssm_conv_s5__prompt_kernel_gemm
s_sub_u32 s66, s34, 4
s_setprio 0
s_waitcnt lgkmcnt(0)
s_mov_b32 s100, s20
s_mov_b32 s101, s21
s_bitcmp1_b32 s66, 0
s_cselect_b32 s100, s22, s20
s_cselect_b32 s101, s23, s21
s_cmp_lg_u32 s66, 1
s_cbranch_scc1 L_pf1
s_lshr_b32 s60, s2, 3
s_lshl_b32 s60, s60, 11
v_and_b32 v12, 15, v1
v_lshl_add_u32 v12, v12, 7, s60
v_min_u32 v12, L_concat_heads__spectral_gfnet__ssm_conv_s5__prompt_kernel_end-concat_heads__spectral_gfnet__ssm_conv_s5__prompt_kernel, v12
s_getpc_b64 s[60:61]
L_pc2:
s_sub_u32 s60, s60, L_pc2-concat_heads__spectral_gfnet__ssm_conv_s5__prompt_kernel
s_subb_u32 s61, s61, 0
global_load_dword v23, v12, s[60:61]
L_pf1:
s_lshl_b32 s60, s2, 3
s_add_u32 s60, s60, s34
s_cmp_lg_u32 s60, 4
s_cbranch_scc1 L_nn3
s_load_dword s3, s[32:33], 0
L_nn3:
s_mov_b32 s48, s6
s_mov_b32 s49, s7
s_mov_b32 s50, 2101248
s_mov_b32 s51, 0x20000
s_mov_b32 s52, s8
s_mov_b32 s53, s9
s_mov_b32 s54, 2101248
s_mov_b32 s55, 0x20000
s_and_b32 s60, s2, 31
s_lshr_b32 s61, s2, 5
s_lshl_b32 s61, s61, 7
s_add_u32 s60, s60, s61
s_lshl_b32 s61, s66, 5
s_add_u32 s67, s60, s61
s_lshl_b32 s60, s67, 12
s_add_u32 s4, s4, s60
s_addc_u32 s5, s5, 0
s_mov_b32 s6, 4096
s_mov_b32 s7, 0x20000
v_lshlrev_b32 v2, 4, v1
v_xor_b32 v3, 128, v2
s_lshl_b32 s68, s66, 12
s_add_u32 s68, s68, 131072
s_add_u32 m0, s68, 0
s_mov_b32 s92, 0
buffer_load_dwordx4 v2, s[4:7], s92 offen offset:0 nt lds
buffer_load_dwordx4 v2, s[4:7], s92 offen offset:1024 nt lds
s_add_u32 m0, s68, 2048
s_mov_b32 s92, 2048
buffer_load_dwordx4 v3, s[4:7], s92 offen offset:0 nt lds
buffer_load_dwordx4 v3, s[4:7], s92 offen offset:1024 nt lds
s_and_b32 s60, s2, 7
s_bfe_u32 s61, s2, 0x10003
s_bfe_u32 s62, s2, 0x20004
s_lshr_b32 s63, s2, 6
s_lshr_b32 s64, s60, 1
s_lshl_b32 s64, s64, 3
s_lshl_b32 s65, s61, 2
s_add_u32 s64, s64, s65
s_and_b32 s65, s60, 1
s_lshl_b32 s65, s65, 1
s_add_u32 s64, s64, s65
s_lshl_b32 s64, s64, 5
s_lshl_b32 s65, s62, 3
s_add_u32 s64, s64, s65
s_lshl_b32 s65, s66, 1
s_add_u32 s64, s64, s65
s_mul_i32 s64, s64, 1026
s_lshl_b32 s65, s63, 8
s_add_u32 s69, s64, s65
v_bfe_u32 v8, v1, 4, 1
v_mul_u32_u24 v8, 32832, v8
v_lshrrev_b32 v9, 5, v1
s_mov_b32 s65, 1050624
v_mul_lo_u32 v9, s65, v9
v_add_u32 v8, v8, v9
v_and_b32 v9, 15, v1
s_lshl_b32 s65, s66, 1
v_xor_b32 v9, s65, v9
v_lshl_add_u32 v18, v9, 4, v8
v_xor_b32 v9, 1, v9
v_lshl_add_u32 v19, v9, 4, v8
v_add_u32 v19, 1026, v19
s_bfe_u32 s64, s2, 0x20005
s_lshl_b32 s64, s64, 8
s_bfe_u32 s65, s2, 0x10004
s_lshl_b32 s65, s65, 6
s_add_u32 s64, s64, s65
s_bfe_u32 s65, s2, 0x10003
s_lshl_b32 s65, s65, 7
s_add_u32 s64, s64, s65
s_and_b32 s65, s2, 7
s_lshl_b32 s65, s65, 2
s_add_u32 s64, s64, s65
v_bfe_u32 v8, v1, 3, 2
v_add_u32 v8, s64, v8
v_bfe_u32 v9, v1, 2, 1
v_lshl_add_u32 v8, v9, 5, v8
v_bfe_u32 v9, v1, 1, 1
v_lshl_add_u32 v8, v9, 10, v8
v_sub_u32 v9, 2048, v8
v_and_b32 v9, 2047, v9
v_and_b32 v10, 1, v1
v_cmp_eq_u32 vcc, 1, v10
s_nop 1
v_cndmask_b32 v8, v8, v9, vcc
v_mul_u32_u24 v17, 1026, v8
s_lshr_b32 s64, s2, 7
s_lshl_b32 s64, s64, 10
v_add_u32 v17, s64, v17
s_add_u32 m0, s68, 16384
s_nop 0
buffer_load_dwordx4 v18, s[48:51], s69 offen nt lds
s_add_u32 m0, s68, 17408
s_nop 0
buffer_load_dwordx4 v18, s[52:55], s69 offen nt lds
s_add_u32 m0, s68, 18432
s_nop 0
buffer_load_dwordx4 v19, s[48:51], s69 offen nt lds
s_add_u32 m0, s68, 19456
s_nop 0
buffer_load_dwordx4 v19, s[52:55], s69 offen nt lds
s_cmp_lg_u32 s66, 3
s_cbranch_scc1 L_nw4
s_mov_b32 exec_hi, 0
buffer_load_ushort v88, v17, s[48:51], 0 offen nt
buffer_load_ushort v89, v17, s[52:55], 0 offen nt
s_mov_b64 exec, -1
L_nw4:
s_cmp_lg_u32 s2, 0
s_cbranch_scc1 L_nz5
s_lshl_b32 s24, s66, 10
s_add_u32 s24, s24, 4096
s_add_u32 s24, s32, s24
s_addc_u32 s25, s33, 0
s_mov_b32 s26, 0
s_atomic_swap s26, s[24:25], 0x0
s_atomic_swap s26, s[24:25], 0x80
s_atomic_swap s26, s[24:25], 0x100
s_atomic_swap s26, s[24:25], 0x180
s_atomic_swap s26, s[24:25], 0x200
s_atomic_swap s26, s[24:25], 0x280
s_atomic_swap s26, s[24:25], 0x300
s_atomic_swap s26, s[24:25], 0x380
L_nz5:
s_barrier
v_and_b32 v92, 31, v1
v_cvt_f32_u32 v92, v92
v_lshrrev_b32 v93, 5, v1
v_lshlrev_b32 v93, 2, v93
v_cvt_f32_u32 v93, v93
v_mul_f32 v93, v92, v93
v_mul_f32 v93, 0x3d000000, v93
v_fmamk_f32 v94, v92, 0x0, v93
v_fract_f32 v94, v94
v_cos_f32 v95, v94
v_sin_f32 v96, v94
s_nop 0
v_cvt_pk_bf16_f32 v192, v95, v96
v_cvt_pk_bf16_f32 v208, -v96, v95
v_fmamk_f32 v97, v92, 0x3d000000, v93
v_fract_f32 v97, v97
v_cos_f32 v98, v97
v_sin_f32 v99, v97
s_nop 0
v_cvt_pk_bf16_f32 v193, v98, v99
v_cvt_pk_bf16_f32 v209, -v99, v98
v_fmamk_f32 v94, v92, 0x3d800000, v93
v_fract_f32 v94, v94
v_cos_f32 v95, v94
v_sin_f32 v96, v94
s_nop 0
v_cvt_pk_bf16_f32 v194, v95, v96
v_cvt_pk_bf16_f32 v210, -v96, v95
v_fmamk_f32 v97, v92, 0x3dc00000, v93
v_fract_f32 v97, v97
v_cos_f32 v98, v97
v_sin_f32 v99, v97
s_nop 0
v_cvt_pk_bf16_f32 v195, v98, v99
v_cvt_pk_bf16_f32 v211, -v99, v98
v_fmamk_f32 v94, v92, 0x3e800000, v93
v_fract_f32 v94, v94
v_cos_f32 v95, v94
v_sin_f32 v96, v94
s_nop 0
v_cvt_pk_bf16_f32 v196, v95, v96
v_cvt_pk_bf16_f32 v212, -v96, v95
v_fmamk_f32 v97, v92, 0x3e900000, v93
v_fract_f32 v97, v97
v_cos_f32 v98, v97
v_sin_f32 v99, v97
s_nop 0
v_cvt_pk_bf16_f32 v197, v98, v99
v_cvt_pk_bf16_f32 v213, -v99, v98
v_fmamk_f32 v94, v92, 0x3ea00000, v93
v_fract_f32 v94, v94
v_cos_f32 v95, v94
v_sin_f32 v96, v94
s_nop 0
v_cvt_pk_bf16_f32 v198, v95, v96
v_cvt_pk_bf16_f32 v214, -v96, v95
v_fmamk_f32 v97, v92, 0x3eb00000, v93
v_fract_f32 v97, v97
v_cos_f32 v98, v97
v_sin_f32 v99, v97
s_nop 0
v_cvt_pk_bf16_f32 v199, v98, v99
v_cvt_pk_bf16_f32 v215, -v99, v98
v_fmamk_f32 v94, v92, 0x3f000000, v93
v_fract_f32 v94, v94
v_cos_f32 v95, v94
v_sin_f32 v96, v94
s_nop 0
v_cvt_pk_bf16_f32 v200, v95, v96
v_cvt_pk_bf16_f32 v216, -v96, v95
v_fmamk_f32 v97, v92, 0x3f080000, v93
v_fract_f32 v97, v97
v_cos_f32 v98, v97
v_sin_f32 v99, v97
s_nop 0
v_cvt_pk_bf16_f32 v201, v98, v99
v_cvt_pk_bf16_f32 v217, -v99, v98
v_fmamk_f32 v94, v92, 0x3f100000, v93
v_fract_f32 v94, v94
v_cos_f32 v95, v94
v_sin_f32 v96, v94
s_nop 0
v_cvt_pk_bf16_f32 v202, v95, v96
v_cvt_pk_bf16_f32 v218, -v96, v95
v_fmamk_f32 v97, v92, 0x3f180000, v93
v_fract_f32 v97, v97
v_cos_f32 v98, v97
v_sin_f32 v99, v97
s_nop 0
v_cvt_pk_bf16_f32 v203, v98, v99
v_cvt_pk_bf16_f32 v219, -v99, v98
v_fmamk_f32 v94, v92, 0x3f400000, v93
v_fract_f32 v94, v94
v_cos_f32 v95, v94
v_sin_f32 v96, v94
s_nop 0
v_cvt_pk_bf16_f32 v204, v95, v96
v_cvt_pk_bf16_f32 v220, -v96, v95
v_fmamk_f32 v97, v92, 0x3f480000, v93
v_fract_f32 v97, v97
v_cos_f32 v98, v97
v_sin_f32 v99, v97
s_nop 0
v_cvt_pk_bf16_f32 v205, v98, v99
v_cvt_pk_bf16_f32 v221, -v99, v98
v_fmamk_f32 v94, v92, 0x3f500000, v93
v_fract_f32 v94, v94
v_cos_f32 v95, v94
v_sin_f32 v96, v94
s_nop 0
v_cvt_pk_bf16_f32 v206, v95, v96
v_cvt_pk_bf16_f32 v222, -v96, v95
v_fmamk_f32 v97, v92, 0x3f580000, v93
v_fract_f32 v97, v97
v_cos_f32 v98, v97
v_sin_f32 v99, v97
s_nop 0
v_cvt_pk_bf16_f32 v207, v98, v99
v_cvt_pk_bf16_f32 v223, -v99, v98
v_and_b32 v92, 31, v1
v_cvt_f32_u32 v92, v92
v_lshrrev_b32 v93, 5, v1
v_lshlrev_b32 v93, 2, v93
v_cvt_f32_u32 v93, v93
v_mul_f32 v93, v92, v93
v_mul_f32 v93, 0x3a800000, v93
v_fmamk_f32 v94, v92, 0x0, v93
v_cos_f32 v224, v94
v_sin_f32 v240, -v94
v_fmamk_f32 v95, v92, 0x3a800000, v93
v_cos_f32 v225, v95
v_sin_f32 v241, -v95
v_fmamk_f32 v94, v92, 0x3b000000, v93
v_cos_f32 v226, v94
v_sin_f32 v242, -v94
v_fmamk_f32 v95, v92, 0x3b400000, v93
v_cos_f32 v227, v95
v_sin_f32 v243, -v95
v_fmamk_f32 v94, v92, 0x3c000000, v93
v_cos_f32 v228, v94
v_sin_f32 v244, -v94
v_fmamk_f32 v95, v92, 0x3c100000, v93
v_cos_f32 v229, v95
v_sin_f32 v245, -v95
v_fmamk_f32 v94, v92, 0x3c200000, v93
v_cos_f32 v230, v94
v_sin_f32 v246, -v94
v_fmamk_f32 v95, v92, 0x3c300000, v93
v_cos_f32 v231, v95
v_sin_f32 v247, -v95
v_fmamk_f32 v94, v92, 0x3c800000, v93
v_cos_f32 v232, v94
v_sin_f32 v248, -v94
v_fmamk_f32 v95, v92, 0x3c880000, v93
v_cos_f32 v233, v95
v_sin_f32 v249, -v95
v_fmamk_f32 v94, v92, 0x3c900000, v93
v_cos_f32 v234, v94
v_sin_f32 v250, -v94
v_fmamk_f32 v95, v92, 0x3c980000, v93
v_cos_f32 v235, v95
v_sin_f32 v251, -v95
v_fmamk_f32 v94, v92, 0x3cc00000, v93
v_cos_f32 v236, v94
v_sin_f32 v252, -v94
v_fmamk_f32 v95, v92, 0x3cc80000, v93
v_cos_f32 v237, v95
v_sin_f32 v253, -v95
v_fmamk_f32 v94, v92, 0x3cd00000, v93
v_cos_f32 v238, v94
v_sin_f32 v254, -v94
v_fmamk_f32 v95, v92, 0x3cd80000, v93
v_cos_f32 v239, v95
v_sin_f32 v255, -v95
v_mov_b32 v184, 126992
s_lshl_b32 s64, s66, 2
v_add_u32 v185, s64, v184
v_and_b32 v8, 31, v1
v_lshrrev_b32 v9, 5, v1
v_and_b32 v10, 1, v1
v_lshrrev_b32 v11, 1, v8
v_lshlrev_b32 v4, 6, v11
v_lshl_add_u32 v4, v10, 4, v4
v_lshl_add_u32 v4, v9, 12, v4
v_add_u32 v11, v11, v10
v_lshlrev_b32 v11, 6, v11
v_lshl_add_u32 v11, v10, 4, v11
v_lshl_add_u32 v11, v9, 12, v11
v_sub_u32 v5, 5168, v11
v_bfe_u32 v11, v4, 7, 1
v_lshlrev_b32 v11, 5, v11
v_xor_b32 v4, v4, v11
v_bfe_u32 v11, v5, 7, 1
v_lshlrev_b32 v11, 5, v11
v_xor_b32 v5, v5, v11
v_add_u32 v6, 11264, v5
v_and_b32 v6, 0x3fff, v6
s_add_u32 s64, s64, 98304
v_add_u32 v4, s64, v4
v_add_u32 v5, s64, v5
v_add_u32 v6, s64, v6
v_bfe_u32 v11, v1, 3, 1
v_lshlrev_b32 v11, 5, v11
v_xor_b32 v7, v2, v11
v_bfe_u32 v12, v1, 2, 1
v_mul_u32_u24 v12, 2176, v12
v_bfe_u32 v13, v1, 3, 1
v_lshl_add_u32 v12, v13, 6, v12
v_lshl_add_u32 v12, v9, 8, v12
v_bfe_u32 v13, v1, 4, 1
v_lshl_add_u32 v12, v13, 5, v12
v_and_b32 v13, 3, v1
v_lshl_add_u32 v12, v13, 3, v12
v_add_u32 v12, s68, v12
v_xor_b32 v13, 128, v12
s_lshl_b32 s64, s2, 14
s_lshl_b32 s65, s66, 12
s_add_u32 s64, s64, s65
s_add_u32 s42, s64, 16777216
s_add_u32 s40, s32, s42
s_addc_u32 s41, s33, 0
s_mov_b32 s42, 4096
s_mov_b32 s43, 0x20000
s_add_u32 s46, s64, 16777216
s_add_u32 s44, s32, s46
s_addc_u32 s45, s33, 0
s_mov_b32 s46, 4096
s_mov_b32 s47, 0x20000
v_and_b32 v14, 7, v1
v_lshrrev_b32 v15, 3, v1
v_xor_b32 v16, v14, v15
v_lshlrev_b32 v16, 4, v16
v_lshl_add_u32 v16, v14, 11, v16
s_lshr_b32 s64, s66, 1
s_lshl_b32 s64, s64, 7
s_and_b32 s65, s66, 1
s_lshl_b32 s65, s65, 3
s_add_u32 s64, s64, s65
s_add_u32 s64, s64, 147456
v_add_u32 v21, s64, v16
v_lshlrev_b32 v15, 16, v15
v_lshl_add_u32 v22, v14, 4, v15
s_lshl_b32 s64, s63, 7
s_lshr_b32 s65, s66, 1
s_lshl_b32 s65, s65, 6
s_add_u32 s64, s64, s65
s_and_b32 s65, s66, 1
s_lshl_b32 s65, s65, 2
s_add_u32 s64, s64, s65
s_mul_i32 s64, s64, 8192
s_lshr_b32 s65, s60, 2
s_mul_i32 s65, s65, 0
s_add_u32 s64, s64, s65
s_lshl_b32 s65, s60, 10
s_add_u32 s64, s64, s65
s_lshl_b32 s65, s61, 9
s_add_u32 s64, s64, s65
s_lshl_b32 s65, s62, 7
s_add_u32 s64, s64, s65
s_add_u32 s58, s64, 25182208
s_add_u32 s56, s32, s58
s_addc_u32 s57, s33, 0
s_sub_u32 s58, 4194304, s64
s_mov_b32 s59, 0x20000
s_lshl_b32 s64, s35, 18
s_lshl_b32 s65, s36, 17
s_add_u32 s12, s10, s64
s_addc_u32 s13, s11, 0
s_mov_b32 s14, 262144
s_mov_b32 s15, 0x20000
s_bitcmp1_b32 s66, 0
s_cselect_b32 s8, s18, s16
s_cselect_b32 s9, s19, s17
s_add_u32 s20, s8, s65
s_addc_u32 s21, s9, 0
s_mov_b32 s22, 131072
s_mov_b32 s23, 0x20000
s_bfe_u32 s16, s2, 0x20001
s_lshl_b32 s16, s16, 2
s_lshr_b32 s64, s2, 6
s_add_u32 s16, s16, s64
s_mul_i32 s16, s16, 128
s_mul_i32 s64, s36, 128
s_add_u32 s16, s16, s64
s_bfe_u32 s64, s16, 0x30007
s_cmp_eq_u32 s64, 3
s_cselect_b32 s64, 128, 0
s_add_u32 s16, s16, s64
s_lshl_b32 s17, s66, 12
s_lshr_b32 s64, s66, 1
s_and_b32 s65, s66, 1
v_lshrrev_b32 v96, 5, v1
v_bfe_u32 v97, v1, 3, 2
v_and_b32 v98, 1, v97
v_lshrrev_b32 v99, 1, v97
v_lshlrev_b32 v100, 4, v96
v_lshl_add_u32 v100, v98, 3, v100
v_add_u32 v100, v100, v99
s_lshl_b32 s92, s64, 6
s_lshl_b32 s19, s65, 2
s_add_u32 s92, s92, s19
v_add_u32 v100, s92, v100
v_lshlrev_b32 v100, 11, v100
s_lshl_b32 s92, s64, 5
v_lshl_add_u32 v101, v96, 3, v97
v_add_u32 v101, s92, v101
v_lshlrev_b32 v101, 11, v101
v_and_b32 v98, 7, v1
v_lshrrev_b32 v99, 4, v1
v_xor_b32 v98, v98, v99
v_lshlrev_b32 v98, 4, v98
v_xor_b32 v99, 64, v98
v_add_u32 v176, v100, v98
v_add_u32 v177, v100, v99
v_add_u32 v177, 64512, v177
v_add_u32 v178, v101, v98
v_add_u32 v179, v101, v99
v_add_u32 v179, 31744, v179
s_waitcnt vmcnt(4)
ds_read_b64_tr_b16 v[24:25], v12 offset:0
ds_read_b64_tr_b16 v[26:27], v13 offset:0
ds_read_b64_tr_b16 v[28:29], v12 offset:512
ds_read_b64_tr_b16 v[30:31], v13 offset:512
ds_read_b64_tr_b16 v[32:33], v12 offset:1024
ds_read_b64_tr_b16 v[34:35], v13 offset:1024
ds_read_b64_tr_b16 v[36:37], v12 offset:1536
ds_read_b64_tr_b16 v[38:39], v13 offset:1536
s_waitcnt lgkmcnt(0)
v_mfma_f32_32x32x16_bf16 v[40:55], v[24:27], v[192:195], 0
v_mfma_f32_32x32x16_bf16 v[40:55], v[28:31], v[196:199], v[40:55]
v_mfma_f32_32x32x16_bf16 v[40:55], v[32:35], v[200:203], v[40:55]
v_mfma_f32_32x32x16_bf16 v[40:55], v[36:39], v[204:207], v[40:55]
v_mfma_f32_32x32x16_bf16 v[56:71], v[24:27], v[208:211], 0
v_mfma_f32_32x32x16_bf16 v[56:71], v[28:31], v[212:215], v[56:71]
v_mfma_f32_32x32x16_bf16 v[56:71], v[32:35], v[216:219], v[56:71]
v_mfma_f32_32x32x16_bf16 v[56:71], v[36:39], v[220:223], v[56:71]
s_nop 7
v_mul_f32 v168, v40, v224
v_mul_f32 v169, v40, v240
s_nop 1
v_fma_f32 v168, -v56, v240, v168
v_fmac_f32 v169, v56, v224
v_cvt_pk_bf16_f32 v72, v168, v169
v_mul_f32 v170, v41, v225
v_mul_f32 v171, v41, v241
v_fma_f32 v170, -v57, v241, v170
v_fmac_f32 v171, v57, v225
v_cvt_pk_bf16_f32 v73, v170, v171
v_mul_f32 v172, v42, v226
v_mul_f32 v173, v42, v242
v_fma_f32 v172, -v58, v242, v172
v_fmac_f32 v173, v58, v226
v_cvt_pk_bf16_f32 v74, v172, v173
v_mul_f32 v174, v43, v227
v_mul_f32 v175, v43, v243
v_fma_f32 v174, -v59, v243, v174
v_fmac_f32 v175, v59, v227
v_cvt_pk_bf16_f32 v75, v174, v175
v_mul_f32 v168, v44, v228
v_mul_f32 v169, v44, v244
v_fma_f32 v168, -v60, v244, v168
v_fmac_f32 v169, v60, v228
v_cvt_pk_bf16_f32 v76, v168, v169
v_mul_f32 v170, v45, v229
v_mul_f32 v171, v45, v245
v_fma_f32 v170, -v61, v245, v170
v_fmac_f32 v171, v61, v229
v_cvt_pk_bf16_f32 v77, v170, v171
v_mul_f32 v172, v46, v230
v_mul_f32 v173, v46, v246
v_fma_f32 v172, -v62, v246, v172
v_fmac_f32 v173, v62, v230
v_cvt_pk_bf16_f32 v78, v172, v173
v_mul_f32 v174, v47, v231
v_mul_f32 v175, v47, v247
v_fma_f32 v174, -v63, v247, v174
v_fmac_f32 v175, v63, v231
v_cvt_pk_bf16_f32 v79, v174, v175
v_mul_f32 v168, v48, v232
v_mul_f32 v169, v48, v248
v_fma_f32 v168, -v64, v248, v168
v_fmac_f32 v169, v64, v232
v_cvt_pk_bf16_f32 v80, v168, v169
v_mul_f32 v170, v49, v233
v_mul_f32 v171, v49, v249
v_fma_f32 v170, -v65, v249, v170
v_fmac_f32 v171, v65, v233
v_cvt_pk_bf16_f32 v81, v170, v171
v_mul_f32 v172, v50, v234
v_mul_f32 v173, v50, v250
v_fma_f32 v172, -v66, v250, v172
v_fmac_f32 v173, v66, v234
v_cvt_pk_bf16_f32 v82, v172, v173
v_mul_f32 v174, v51, v235
v_mul_f32 v175, v51, v251
v_fma_f32 v174, -v67, v251, v174
v_fmac_f32 v175, v67, v235
v_cvt_pk_bf16_f32 v83, v174, v175
v_mul_f32 v168, v52, v236
v_mul_f32 v169, v52, v252
v_fma_f32 v168, -v68, v252, v168
v_fmac_f32 v169, v68, v236
v_cvt_pk_bf16_f32 v84, v168, v169
v_mul_f32 v170, v53, v237
v_mul_f32 v171, v53, v253
v_fma_f32 v170, -v69, v253, v170
v_fmac_f32 v171, v69, v237
v_cvt_pk_bf16_f32 v85, v170, v171
v_mul_f32 v172, v54, v238
v_mul_f32 v173, v54, v254
v_fma_f32 v172, -v70, v254, v172
v_fmac_f32 v173, v70, v238
v_cvt_pk_bf16_f32 v86, v172, v173
v_mul_f32 v174, v55, v239
v_mul_f32 v175, v55, v255
v_fma_f32 v174, -v71, v255, v174
v_fmac_f32 v175, v71, v239
v_cvt_pk_bf16_f32 v87, v174, v175
v_mfma_f32_32x32x16_bf16 v[40:55], v[192:195], v[72:75], 0
v_mfma_f32_32x32x16_bf16 v[40:55], v[196:199], v[76:79], v[40:55]
v_mfma_f32_32x32x16_bf16 v[40:55], v[200:203], v[80:83], v[40:55]
v_mfma_f32_32x32x16_bf16 v[40:55], v[204:207], v[84:87], v[40:55]
v_mfma_f32_32x32x16_bf16 v[56:71], v[208:211], v[72:75], 0
v_mfma_f32_32x32x16_bf16 v[56:71], v[212:215], v[76:79], v[56:71]
v_mfma_f32_32x32x16_bf16 v[56:71], v[216:219], v[80:83], v[56:71]
v_mfma_f32_32x32x16_bf16 v[56:71], v[220:223], v[84:87], v[56:71]
s_lshl_b32 s92, s66, 12
s_add_u32 s92, s92, 98304
v_add_u32 v8, s92, v7
s_nop 8
v_cvt_pk_bf16_f32 v72, v40, v56
ds_write_b32 v4, v72 offset:0
v_cvt_pk_bf16_f32 v73, v41, v57
ds_write_b32 v4, v73 offset:1024
v_cvt_pk_bf16_f32 v74, v42, v58
ds_write_b32 v4, v74 offset:2048
v_cvt_pk_bf16_f32 v75, v43, v59
ds_write_b32 v4, v75 offset:3072
v_cvt_pk_bf16_f32 v76, v44, v60
ds_write_b32 v4, v76 offset:8192
v_cvt_pk_bf16_f32 v77, v45, v61
ds_write_b32 v4, v77 offset:9216
v_cvt_pk_bf16_f32 v78, v46, v62
ds_write_b32 v4, v78 offset:10240
v_cvt_pk_bf16_f32 v79, v47, v63
ds_write_b32 v4, v79 offset:11264
v_cvt_pk_bf16_f32 v80, v48, v64
ds_write_b32 v6, v80 offset:0
v_cvt_pk_bf16_f32 v81, v49, v65
ds_write_b32 v5, v81 offset:10240
v_cvt_pk_bf16_f32 v82, v50, v66
ds_write_b32 v5, v82 offset:9216
v_cvt_pk_bf16_f32 v83, v51, v67
ds_write_b32 v5, v83 offset:8192
v_cvt_pk_bf16_f32 v84, v52, v68
ds_write_b32 v5, v84 offset:3072
v_cvt_pk_bf16_f32 v85, v53, v69
ds_write_b32 v5, v85 offset:2048
v_cvt_pk_bf16_f32 v86, v54, v70
ds_write_b32 v5, v86 offset:1024
v_cvt_pk_bf16_f32 v87, v55, v71
ds_write_b32 v5, v87 offset:0
s_waitcnt vmcnt(0)
s_waitcnt lgkmcnt(0)
v_mov_b32 v190, 1
s_mov_b64 exec, 1
ds_write_b32 v185, v190
s_mov_b64 exec, -1
L_lc6:
ds_read_b128 v[186:189], v184
s_waitcnt lgkmcnt(0)
v_min3_u32 v186, v186, v187, v188
v_min_u32 v186, v186, v189
s_nop 0
v_readfirstlane_b32 s92, v186
s_nop 0
s_cmp_ge_u32 s92, 1
s_cbranch_scc1 L_lcd7
s_sleep 1
s_branch L_lc6
L_lcd7:
ds_read_b128 v[72:75], v8 offset:0
ds_read_b128 v[76:79], v8 offset:1024
ds_read_b128 v[80:83], v8 offset:2048
ds_read_b128 v[84:87], v8 offset:3072
ds_read_b64 v[104:105], v21 offset:0
ds_read_b64 v[106:107], v21 offset:256
ds_read_b64 v[108:109], v21 offset:512
ds_read_b64 v[110:111], v21 offset:768
ds_read_b64 v[112:113], v21 offset:1024
ds_read_b64 v[114:115], v21 offset:1280
ds_read_b64 v[116:117], v21 offset:1536
ds_read_b64 v[118:119], v21 offset:1792
v_add_u32 v4, 32768, v4
v_add_u32 v5, 32768, v5
v_add_u32 v6, 32768, v6
s_waitcnt lgkmcnt(0)
v_mov_b32 v190, 2
s_mov_b64 exec, 1
ds_write_b32 v185, v190
s_mov_b64 exec, -1
s_lshl_b32 s92, s2, 3
s_add_u32 s92, s92, s34
s_cmp_lg_u32 s92, 4
s_cbranch_scc1 L_nn8
s_add_u32 s3, s3, 1
s_cmp_eq_u32 s3, 0
s_cselect_b32 s3, 1, s3
s_atomic_swap s3, s[30:31], 0x0
s_atomic_swap s3, s[32:33], 0x0
L_nn8:
s_mov_b32 s64, 0x05040100
s_mov_b32 s65, 0x07060302
v_lshlrev_b32 v88, 16, v88
v_lshlrev_b32 v89, 16, v89
v_lshlrev_b32 v23, 1, v1
v_add_f32_dpp v90, v88, v88 quad_perm:[1,0,3,2] row_mask:0xf bank_mask:0xf
v_subrev_f32_dpp v91, v89, v89 quad_perm:[1,0,3,2] row_mask:0xf bank_mask:0xf
v_mul_f32 v90, 0.5, v90
v_mul_f32 v91, 0.5, v91
v_cvt_pk_bf16_f32 v88, v90, v91
v_perm_b32 v120, v112, v104, s64
v_perm_b32 v121, v116, v108, s64
v_perm_b32 v122, v114, v106, s64
v_perm_b32 v123, v118, v110, s64
v_perm_b32 v124, v112, v104, s65
v_perm_b32 v125, v116, v108, s65
v_perm_b32 v126, v114, v106, s65
v_perm_b32 v127, v118, v110, s65
v_perm_b32 v128, v113, v105, s64
v_perm_b32 v129, v117, v109, s64
v_perm_b32 v130, v115, v107, s64
v_perm_b32 v131, v119, v111, s64
v_perm_b32 v132, v113, v105, s65
v_perm_b32 v133, v117, v109, s65
v_perm_b32 v134, v115, v107, s65
v_perm_b32 v135, v119, v111, s65
v_and_b32 v92, 31, v1
v_cvt_f32_u32 v92, v92
v_lshrrev_b32 v93, 5, v1
v_lshlrev_b32 v93, 2, v93
v_cvt_f32_u32 v93, v93
v_mul_f32 v92, 0x3a000000, v92
v_fmamk_f32 v93, v93, 0x3c800000, v92
v_add_f32 v94, 0x0, v93
v_cos_f32 v136, v94
v_sin_f32 v152, -v94
v_add_f32 v95, 0x3c800000, v93
v_cos_f32 v137, v95
v_sin_f32 v153, -v95
v_add_f32 v94, 0x3d000000, v93
v_cos_f32 v138, v94
v_sin_f32 v154, -v94
v_add_f32 v95, 0x3d400000, v93
v_cos_f32 v139, v95
v_sin_f32 v155, -v95
v_add_f32 v94, 0x3e000000, v93
v_cos_f32 v140, v94
v_sin_f32 v156, -v94
v_add_f32 v95, 0x3e100000, v93
v_cos_f32 v141, v95
v_sin_f32 v157, -v95
v_add_f32 v94, 0x3e200000, v93
v_cos_f32 v142, v94
v_sin_f32 v158, -v94
v_add_f32 v95, 0x3e300000, v93
v_cos_f32 v143, v95
v_sin_f32 v159, -v95
v_add_f32 v94, 0x3e800000, v93
v_cos_f32 v144, v94
v_sin_f32 v160, -v94
v_add_f32 v95, 0x3e880000, v93
v_cos_f32 v145, v95
v_sin_f32 v161, -v95
v_add_f32 v94, 0x3e900000, v93
v_cos_f32 v146, v94
v_sin_f32 v162, -v94
v_add_f32 v95, 0x3e980000, v93
v_cos_f32 v147, v95
v_sin_f32 v163, -v95
v_add_f32 v94, 0x3ec00000, v93
v_cos_f32 v148, v94
v_sin_f32 v164, -v94
v_add_f32 v95, 0x3ec80000, v93
v_cos_f32 v149, v95
v_sin_f32 v165, -v95
v_add_f32 v94, 0x3ed00000, v93
v_cos_f32 v150, v94
v_sin_f32 v166, -v94
v_add_f32 v95, 0x3ed80000, v93
v_cos_f32 v151, v95
v_sin_f32 v167, -v95
s_and_b32 s60, s2, 7
s_lshl_b32 s60, s60, 5
s_lshr_b32 s64, s2, 3
s_add_u32 s60, s60, s64
s_lshr_b32 s64, s66, 1
s_xor_b32 s64, s64, s66
s_and_b32 s64, s64, 1
s_or_b32 s65, s64, s60
s_cmp_eq_u32 s65, 0
s_cselect_b32 s61, 1, 0
s_lshl_b32 s65, s60, 1
s_add_u32 s64, s64, s65
s_mul_i32 s64, s64, 8192
s_add_u32 s64, s64, 25182208
s_lshr_b32 s65, s66, 1
s_mul_i32 s69, s65, 8192
s_add_u32 s69, s69, 25165824
s_cmp_eq_u32 s61, 1
s_cselect_b32 s64, s69, s64
s_cselect_b32 s65, 0, s65
s_cselect_b32 s90, s32, s32
s_cselect_b32 s91, s33, s33
s_lshl_b32 s62, s65, 31
s_or_b32 s63, s62, 0x3f800000
s_add_u32 s48, s90, s64
s_addc_u32 s49, s91, 0
s_mov_b32 s50, 8192
s_mov_b32 s51, 0x20000
s_lshl_b32 s64, s66, 20
s_lshl_b32 s65, s60, 6
s_add_u32 s64, s64, s65
s_add_u32 s54, s64, 16777216
s_add_u32 s52, s32, s54
s_addc_u32 s53, s33, 0
s_sub_u32 s54, 1048576, s65
s_mov_b32 s55, 0x20000
v_lshrrev_b32 v8, 2, v1
v_lshlrev_b32 v8, 14, v8
v_and_b32 v9, 3, v1
v_lshrrev_b32 v10, 4, v1
v_xor_b32 v9, v9, v10
v_lshl_add_u32 v14, v9, 4, v8
v_and_b32 v8, 31, v1
v_bfe_u32 v9, v1, 2, 2
v_xor_b32 v9, s66, v9
v_lshlrev_b32 v9, 4, v9
v_lshl_add_u32 v9, v8, 6, v9
v_lshrrev_b32 v8, 5, v1
v_lshl_add_u32 v9, v8, 11, v9
v_add_u32 v15, 131072, v9
s_lshl_b32 s64, s66, 13
s_add_u32 s64, s64, 131072
v_add_u32 v16, s64, v2
s_xor_b32 s65, s64, 24576
s_cmp_eq_u32 s61, 1
s_cselect_b32 s65, s64, s65
v_add_u32 v17, s65, v2
v_add_u32 v18, s68, v2
s_lshr_b32 s64, s66, 1
s_xor_b32 s64, s64, s66
s_and_b32 s64, s64, 1
s_lshl_b32 s69, s64, 13
s_add_u32 s69, s69, 147456
v_add_u32 v19, s69, v2
v_mul_f32 v136, s63, v136
v_mul_f32 v137, s63, v137
v_mul_f32 v138, s63, v138
v_mul_f32 v139, s63, v139
v_mul_f32 v140, s63, v140
v_mul_f32 v141, s63, v141
v_mul_f32 v142, s63, v142
v_mul_f32 v143, s63, v143
v_mul_f32 v144, s63, v144
v_mul_f32 v145, s63, v145
v_mul_f32 v146, s63, v146
v_mul_f32 v147, s63, v147
v_mul_f32 v148, s63, v148
v_mul_f32 v149, s63, v149
v_mul_f32 v150, s63, v150
v_mul_f32 v151, s63, v151
v_mul_f32 v152, s63, v152
v_mul_f32 v153, s63, v153
v_mul_f32 v154, s63, v154
v_mul_f32 v155, s63, v155
v_mul_f32 v156, s63, v156
v_mul_f32 v157, s63, v157
v_mul_f32 v158, s63, v158
v_mul_f32 v159, s63, v159
v_mul_f32 v160, s63, v160
v_mul_f32 v161, s63, v161
v_mul_f32 v162, s63, v162
v_mul_f32 v163, s63, v163
v_mul_f32 v164, s63, v164
v_mul_f32 v165, s63, v165
v_mul_f32 v166, s63, v166
v_mul_f32 v167, s63, v167
buffer_store_dwordx4 v[72:75], v2, s[40:43], 0 offen offset:0 sc1
buffer_store_dwordx4 v[76:79], v2, s[40:43], 0 offen offset:1024 sc1
buffer_store_dwordx4 v[80:83], v2, s[40:43], 0 offen offset:2048 sc1
buffer_store_dwordx4 v[84:87], v2, s[40:43], 0 offen offset:3072 sc1
s_setprio 3
s_barrier
s_add_u32 s8, s16, 256
s_and_b32 s8, s8, 0x7ff
s_add_u32 s9, s8, 2048
s_add_u32 s10, s8, 6144
s_add_u32 m0, s17, 65536
s_nop 0
buffer_load_dwordx4 v176, s[12:15], s8 offen offset:0 lds
buffer_load_dwordx4 v177, s[12:15], s8 offen offset:1024 lds
buffer_load_dwordx4 v176, s[12:15], s9 offen offset:2048 lds
buffer_load_dwordx4 v177, s[12:15], s9 offen offset:3072 lds
s_add_u32 m0, s17, 81920
s_nop 0
buffer_load_dwordx4 v178, s[20:23], s8 offen offset:0 lds
buffer_load_dwordx4 v179, s[20:23], s8 offen offset:1024 lds
buffer_load_dwordx4 v178, s[20:23], s10 offen offset:2048 lds
buffer_load_dwordx4 v179, s[20:23], s10 offen offset:3072 lds
s_barrier
s_add_u32 s8, s16, 384
s_and_b32 s8, s8, 0x7ff
s_add_u32 s9, s8, 2048
s_add_u32 s10, s8, 6144
s_add_u32 m0, s17, 0
s_nop 0
buffer_load_dwordx4 v176, s[12:15], s8 offen offset:0 lds
buffer_load_dwordx4 v177, s[12:15], s8 offen offset:1024 lds
buffer_load_dwordx4 v176, s[12:15], s9 offen offset:2048 lds
buffer_load_dwordx4 v177, s[12:15], s9 offen offset:3072 lds
s_add_u32 m0, s17, 16384
s_nop 0
buffer_load_dwordx4 v178, s[20:23], s8 offen offset:0 lds
buffer_load_dwordx4 v179, s[20:23], s8 offen offset:1024 lds
buffer_load_dwordx4 v178, s[20:23], s10 offen offset:2048 lds
buffer_load_dwordx4 v179, s[20:23], s10 offen offset:3072 lds
s_waitcnt vmcnt(8)
s_barrier
s_add_u32 s8, s16, 512
s_and_b32 s8, s8, 0x7ff
s_add_u32 s9, s8, 2048
s_add_u32 s10, s8, 6144
s_add_u32 m0, s17, 32768
s_nop 0
buffer_load_dwordx4 v176, s[12:15], s8 offen offset:0 lds
buffer_load_dwordx4 v177, s[12:15], s8 offen offset:1024 lds
buffer_load_dwordx4 v176, s[12:15], s9 offen offset:2048 lds
buffer_load_dwordx4 v177, s[12:15], s9 offen offset:3072 lds
s_add_u32 m0, s17, 49152
s_nop 0
buffer_load_dwordx4 v178, s[20:23], s8 offen offset:0 lds
buffer_load_dwordx4 v179, s[20:23], s8 offen offset:1024 lds
buffer_load_dwordx4 v178, s[20:23], s10 offen offset:2048 lds
buffer_load_dwordx4 v179, s[20:23], s10 offen offset:3072 lds
v_mov_b32 v20, 0
global_load_dword v21, v20, s[30:31] sc1
s_waitcnt vmcnt(9)
s_barrier
s_add_u32 s8, s16, 640
s_and_b32 s8, s8, 0x7ff
s_add_u32 s9, s8, 2048
s_add_u32 s10, s8, 6144
s_add_u32 m0, s17, 65536
s_nop 0
buffer_load_dwordx4 v176, s[12:15], s8 offen offset:0 lds
buffer_load_dwordx4 v177, s[12:15], s8 offen offset:1024 lds
buffer_load_dwordx4 v176, s[12:15], s9 offen offset:2048 lds
buffer_load_dwordx4 v177, s[12:15], s9 offen offset:3072 lds
s_add_u32 m0, s17, 81920
s_nop 0
buffer_load_dwordx4 v178, s[20:23], s8 offen offset:0 lds
buffer_load_dwordx4 v179, s[20:23], s8 offen offset:1024 lds
buffer_load_dwordx4 v178, s[20:23], s10 offen offset:2048 lds
buffer_load_dwordx4 v179, s[20:23], s10 offen offset:3072 lds
s_cmp_lg_u32 s66, 3
s_cbranch_scc1 L_nw9
s_lshr_b32 s64, s2, 7
s_mul_i32 s64, s64, 8192
s_bfe_u32 s65, s2, 0x10006
s_mul_i32 s65, s65, 4096
s_add_u32 s64, s64, s65
s_and_b32 s65, s2, 63
s_lshl_b32 s65, s65, 6
s_add_u32 s64, s64, s65
s_add_u32 s6, s64, 25165824
s_add_u32 s4, s32, s6
s_addc_u32 s5, s33, 0
s_mov_b32 s6, 64
s_mov_b32 s7, 0x20000
s_mov_b32 exec_lo, 0x55555555
s_mov_b32 exec_hi, 0
buffer_store_dword v88, v23, s[4:7], 0 offen sc1
s_mov_b64 exec, -1
L_nw9:
s_mov_b32 s92, 0
buffer_store_dwordx4 v[120:123], v22, s[56:59], s92 offen sc1
s_mov_b32 s92, 8192
buffer_store_dwordx4 v[124:127], v22, s[56:59], s92 offen sc1
s_mov_b32 s92, 16384
buffer_store_dwordx4 v[128:131], v22, s[56:59], s92 offen sc1
s_mov_b32 s92, 24576
buffer_store_dwordx4 v[132:135], v22, s[56:59], s92 offen sc1
s_waitcnt vmcnt(13)
s_barrier
s_add_u32 s8, s16, 768
s_and_b32 s8, s8, 0x7ff
s_add_u32 s9, s8, 2048
s_add_u32 s10, s8, 6144
s_add_u32 m0, s17, 0
s_nop 0
buffer_load_dwordx4 v176, s[12:15], s8 offen offset:0 lds
buffer_load_dwordx4 v177, s[12:15], s8 offen offset:1024 lds
buffer_load_dwordx4 v176, s[12:15], s9 offen offset:2048 lds
buffer_load_dwordx4 v177, s[12:15], s9 offen offset:3072 lds
s_add_u32 m0, s17, 16384
s_nop 0
buffer_load_dwordx4 v178, s[20:23], s8 offen offset:0 lds
buffer_load_dwordx4 v179, s[20:23], s8 offen offset:1024 lds
buffer_load_dwordx4 v178, s[20:23], s10 offen offset:2048 lds
buffer_load_dwordx4 v179, s[20:23], s10 offen offset:3072 lds
s_waitcnt vmcnt(12)
s_barrier
s_add_u32 s8, s16, 896
s_and_b32 s8, s8, 0x7ff
s_add_u32 s9, s8, 2048
s_add_u32 s10, s8, 6144
s_add_u32 m0, s17, 32768
s_nop 0
buffer_load_dwordx4 v176, s[12:15], s8 offen offset:0 lds
buffer_load_dwordx4 v177, s[12:15], s8 offen offset:1024 lds
buffer_load_dwordx4 v176, s[12:15], s9 offen offset:2048 lds
buffer_load_dwordx4 v177, s[12:15], s9 offen offset:3072 lds
s_add_u32 m0, s17, 49152
s_nop 0
buffer_load_dwordx4 v178, s[20:23], s8 offen offset:0 lds
buffer_load_dwordx4 v179, s[20:23], s8 offen offset:1024 lds
buffer_load_dwordx4 v178, s[20:23], s10 offen offset:2048 lds
buffer_load_dwordx4 v179, s[20:23], s10 offen offset:3072 lds
s_waitcnt vmcnt(8)
s_barrier
s_add_u32 s8, s16, 1024
s_and_b32 s8, s8, 0x7ff
s_add_u32 s9, s8, 2048
s_add_u32 s10, s8, 6144
s_add_u32 m0, s17, 65536
s_nop 0
buffer_load_dwordx4 v176, s[12:15], s8 offen offset:0 lds
buffer_load_dwordx4 v177, s[12:15], s8 offen offset:1024 lds
buffer_load_dwordx4 v176, s[12:15], s9 offen offset:2048 lds
buffer_load_dwordx4 v177, s[12:15], s9 offen offset:3072 lds
s_add_u32 m0, s17, 81920
s_nop 0
buffer_load_dwordx4 v178, s[20:23], s8 offen offset:0 lds
buffer_load_dwordx4 v179, s[20:23], s8 offen offset:1024 lds
buffer_load_dwordx4 v178, s[20:23], s10 offen offset:2048 lds
buffer_load_dwordx4 v179, s[20:23], s10 offen offset:3072 lds
v_readfirstlane_b32 s37, v21
s_nop 0
s_cmp_lg_u32 s37, 0
s_cbranch_scc1 L_sg11
v_mov_b32 v20, 0
L_n12:
global_load_dword v21, v20, s[30:31] sc1
s_waitcnt vmcnt(0)
v_readfirstlane_b32 s37, v21
s_nop 0
s_cmp_eq_u32 s37, 0
s_cbranch_scc1 L_n12
L_sg11:
s_cmp_lg_u32 s66, 0
s_cbranch_scc1 L_sg14
s_and_b32 s64, s2, 15
s_lshl_b32 s65, s64, 7
s_add_u32 s65, s65, 4096
s_add_u32 s90, s32, s65
s_addc_u32 s91, s33, 0
s_mov_b32 s18, 1
s_atomic_add s18, s[90:91], 0x0 glc
L_sg14:
s_waitcnt vmcnt(8)
s_barrier
s_add_u32 s8, s16, 1152
s_and_b32 s8, s8, 0x7ff
s_add_u32 s9, s8, 2048
s_add_u32 s10, s8, 6144
s_add_u32 m0, s17, 0
s_nop 0
buffer_load_dwordx4 v176, s[12:15], s8 offen offset:0 lds
buffer_load_dwordx4 v177, s[12:15], s8 offen offset:1024 lds
buffer_load_dwordx4 v176, s[12:15], s9 offen offset:2048 lds
buffer_load_dwordx4 v177, s[12:15], s9 offen offset:3072 lds
s_add_u32 m0, s17, 16384
s_nop 0
buffer_load_dwordx4 v178, s[20:23], s8 offen offset:0 lds
buffer_load_dwordx4 v179, s[20:23], s8 offen offset:1024 lds
buffer_load_dwordx4 v178, s[20:23], s10 offen offset:2048 lds
buffer_load_dwordx4 v179, s[20:23], s10 offen offset:3072 lds
s_waitcnt vmcnt(8)
s_barrier
s_add_u32 s8, s16, 1280
s_and_b32 s8, s8, 0x7ff
s_add_u32 s9, s8, 2048
s_add_u32 s10, s8, 6144
s_add_u32 m0, s17, 32768
s_nop 0
buffer_load_dwordx4 v176, s[12:15], s8 offen offset:0 lds
buffer_load_dwordx4 v177, s[12:15], s8 offen offset:1024 lds
buffer_load_dwordx4 v176, s[12:15], s9 offen offset:2048 lds
buffer_load_dwordx4 v177, s[12:15], s9 offen offset:3072 lds
s_add_u32 m0, s17, 49152
s_nop 0
buffer_load_dwordx4 v178, s[20:23], s8 offen offset:0 lds
buffer_load_dwordx4 v179, s[20:23], s8 offen offset:1024 lds
buffer_load_dwordx4 v178, s[20:23], s10 offen offset:2048 lds
buffer_load_dwordx4 v179, s[20:23], s10 offen offset:3072 lds
s_cmp_lg_u32 s66, 0
s_cbranch_scc1 L_sg15
s_waitcnt lgkmcnt(0)
s_cmp_lg_u32 s18, 15
s_cbranch_scc1 L_sg15
s_and_b32 s64, s2, 15
s_lshl_b32 s64, s64, 2
s_add_u32 s64, s64, 540672
v_lshl_add_u32 v22, v1, 7, s64
v_mov_b32 v23, s37
global_store_dword v22, v23, s[32:33] sc1
L_sg15:
s_waitcnt vmcnt(8)
s_barrier
s_add_u32 s8, s16, 1408
s_and_b32 s8, s8, 0x7ff
s_add_u32 s9, s8, 2048
s_add_u32 s10, s8, 6144
s_add_u32 m0, s17, 65536
s_nop 0
buffer_load_dwordx4 v176, s[12:15], s8 offen offset:0 lds
buffer_load_dwordx4 v177, s[12:15], s8 offen offset:1024 lds
buffer_load_dwordx4 v176, s[12:15], s9 offen offset:2048 lds
buffer_load_dwordx4 v177, s[12:15], s9 offen offset:3072 lds
s_add_u32 m0, s17, 81920
s_nop 0
buffer_load_dwordx4 v178, s[20:23], s8 offen offset:0 lds
buffer_load_dwordx4 v179, s[20:23], s8 offen offset:1024 lds
buffer_load_dwordx4 v178, s[20:23], s10 offen offset:2048 lds
buffer_load_dwordx4 v179, s[20:23], s10 offen offset:3072 lds
s_waitcnt vmcnt(8)
s_barrier
s_add_u32 s8, s16, 1536
s_and_b32 s8, s8, 0x7ff
s_add_u32 s9, s8, 2048
s_add_u32 s10, s8, 6144
s_add_u32 m0, s17, 0
s_nop 0
buffer_load_dwordx4 v176, s[12:15], s8 offen offset:0 lds
buffer_load_dwordx4 v177, s[12:15], s8 offen offset:1024 lds
buffer_load_dwordx4 v176, s[12:15], s9 offen offset:2048 lds
buffer_load_dwordx4 v177, s[12:15], s9 offen offset:3072 lds
s_add_u32 m0, s17, 16384
s_nop 0
buffer_load_dwordx4 v178, s[20:23], s8 offen offset:0 lds
buffer_load_dwordx4 v179, s[20:23], s8 offen offset:1024 lds
buffer_load_dwordx4 v178, s[20:23], s10 offen offset:2048 lds
buffer_load_dwordx4 v179, s[20:23], s10 offen offset:3072 lds
s_waitcnt vmcnt(8)
s_barrier
s_add_u32 s8, s16, 1664
s_and_b32 s8, s8, 0x7ff
s_add_u32 s9, s8, 2048
s_add_u32 s10, s8, 6144
s_add_u32 m0, s17, 32768
s_nop 0
buffer_load_dwordx4 v176, s[12:15], s8 offen offset:0 lds
buffer_load_dwordx4 v177, s[12:15], s8 offen offset:1024 lds
buffer_load_dwordx4 v176, s[12:15], s9 offen offset:2048 lds
buffer_load_dwordx4 v177, s[12:15], s9 offen offset:3072 lds
s_add_u32 m0, s17, 49152
s_nop 0
buffer_load_dwordx4 v178, s[20:23], s8 offen offset:0 lds
buffer_load_dwordx4 v179, s[20:23], s8 offen offset:1024 lds
buffer_load_dwordx4 v178, s[20:23], s10 offen offset:2048 lds
buffer_load_dwordx4 v179, s[20:23], s10 offen offset:3072 lds
s_waitcnt vmcnt(8)
s_barrier
s_add_u32 s8, s16, 1792
s_and_b32 s8, s8, 0x7ff
s_add_u32 s9, s8, 2048
s_add_u32 s10, s8, 6144
s_add_u32 m0, s17, 65536
s_nop 0
buffer_load_dwordx4 v176, s[12:15], s8 offen offset:0 lds
buffer_load_dwordx4 v177, s[12:15], s8 offen offset:1024 lds
buffer_load_dwordx4 v176, s[12:15], s9 offen offset:2048 lds
buffer_load_dwordx4 v177, s[12:15], s9 offen offset:3072 lds
s_add_u32 m0, s17, 81920
s_nop 0
buffer_load_dwordx4 v178, s[20:23], s8 offen offset:0 lds
buffer_load_dwordx4 v179, s[20:23], s8 offen offset:1024 lds
buffer_load_dwordx4 v178, s[20:23], s10 offen offset:2048 lds
buffer_load_dwordx4 v179, s[20:23], s10 offen offset:3072 lds
s_waitcnt vmcnt(8)
s_barrier
s_add_u32 s8, s16, 1920
s_and_b32 s8, s8, 0x7ff
s_add_u32 s9, s8, 2048
s_add_u32 s10, s8, 6144
s_add_u32 m0, s17, 0
s_nop 0
buffer_load_dwordx4 v176, s[12:15], s8 offen offset:0 lds
buffer_load_dwordx4 v177, s[12:15], s8 offen offset:1024 lds
buffer_load_dwordx4 v176, s[12:15], s9 offen offset:2048 lds
buffer_load_dwordx4 v177, s[12:15], s9 offen offset:3072 lds
s_add_u32 m0, s17, 16384
s_nop 0
buffer_load_dwordx4 v178, s[20:23], s8 offen offset:0 lds
buffer_load_dwordx4 v179, s[20:23], s8 offen offset:1024 lds
buffer_load_dwordx4 v178, s[20:23], s10 offen offset:2048 lds
buffer_load_dwordx4 v179, s[20:23], s10 offen offset:3072 lds
s_waitcnt vmcnt(8)
s_barrier
s_and_b32 s64, s2, 1
s_lshl_b32 s64, s64, 10
s_bfe_u32 s92, s2, 0x20001
s_lshl_b32 s92, s92, 19
s_add_u32 s64, s64, s92
s_lshr_b32 s92, s2, 3
s_lshl_b32 s92, s92, 14
s_add_u32 s64, s64, s92
s_lshr_b32 s92, s66, 1
s_lshl_b32 s92, s92, 13
s_add_u32 s64, s64, s92
v_bfe_u32 v22, v1, 3, 2
v_lshlrev_b32 v22, 11, v22
v_and_b32 v23, 7, v1
v_lshl_add_u32 v22, v23, 7, v22
v_add_u32 v22, s64, v22
s_mov_b32 exec_hi, 0
global_load_dword v11, v22, s[100:101]
s_mov_b64 exec, -1
s_lshl_b32 s64, s2, 2
s_add_u32 s64, s64, s66
s_lshr_b32 s64, s64, 4
s_lshl_b32 s64, s64, 7
s_add_u32 s64, s64, 540672
s_add_u32 s24, s32, s64
s_addc_u32 s25, s33, 0
s_load_dwordx16 s[4:19], s[24:25], 0x0 glc
s_waitcnt vmcnt(1)
s_barrier
s_setprio 0
s_mov_b32 s26, s37
s_mov_b32 s27, s37
s_mov_b32 s92, 0
s_branch L_sp18
L_late16:
s_add_u32 s92, s92, 1
s_cmp_ge_u32 s92, 200000
s_cbranch_scc1 L_go17
s_sleep 8
s_load_dwordx16 s[4:19], s[24:25], 0x0 glc
L_sp18:
s_waitcnt lgkmcnt(0)
s_cmp_eq_u64 s[4:5], s[26:27]
s_cbranch_scc0 L_late16
s_cmp_eq_u64 s[6:7], s[26:27]
s_cbranch_scc0 L_late16
s_cmp_eq_u64 s[8:9], s[26:27]
s_cbranch_scc0 L_late16
s_cmp_eq_u64 s[10:11], s[26:27]
s_cbranch_scc0 L_late16
s_cmp_eq_u64 s[12:13], s[26:27]
s_cbranch_scc0 L_late16
s_cmp_eq_u64 s[14:15], s[26:27]
s_cbranch_scc0 L_late16
s_cmp_eq_u64 s[16:17], s[26:27]
s_cbranch_scc0 L_late16
s_cmp_eq_u64 s[18:19], s[26:27]
s_cbranch_scc0 L_late16
L_go17:
s_setprio 0
s_add_u32 m0, s68, 0
s_mov_b32 s64, 0
buffer_load_dwordx4 v14, s[52:55], s64 offen sc1 lds
s_add_u32 m0, s68, 1024
s_mov_b32 s64, 262144
buffer_load_dwordx4 v14, s[52:55], s64 offen sc1 lds
s_add_u32 m0, s68, 2048
s_mov_b32 s64, 524288
buffer_load_dwordx4 v14, s[52:55], s64 offen sc1 lds
s_add_u32 m0, s68, 3072
s_mov_b32 s64, 786432
buffer_load_dwordx4 v14, s[52:55], s64 offen sc1 lds
s_cmp_eq_u32 s61, 1
s_cbranch_scc1 L_ws19
s_lshr_b32 s64, s66, 1
s_lshl_b32 s65, s64, 12
s_mul_i32 s64, s64, 4096
s_add_u32 m0, s69, s65
s_nop 0
buffer_load_dwordx4 v2, s[48:51], s64 offen offset:0 sc1 lds
buffer_load_dwordx4 v2, s[48:51], s64 offen offset:1024 sc1 lds
buffer_load_dwordx4 v2, s[48:51], s64 offen offset:2048 sc1 lds
buffer_load_dwordx4 v2, s[48:51], s64 offen offset:3072 sc1 lds
s_waitcnt vmcnt(0)
s_branch L_wd20
L_ws19:
s_movk_i32 s64, 4096
buffer_load_dwordx4 v[104:107], v2, s[48:51], 0 offen offset:0 sc1
buffer_load_dwordx4 v[108:111], v2, s[48:51], 0 offen offset:1024 sc1
buffer_load_dwordx4 v[112:115], v2, s[48:51], 0 offen offset:2048 sc1
buffer_load_dwordx4 v[116:119], v2, s[48:51], 0 offen offset:3072 sc1
buffer_load_dwordx4 v[120:123], v2, s[48:51], s64 offen offset:0 sc1
buffer_load_dwordx4 v[124:127], v2, s[48:51], s64 offen offset:1024 sc1
buffer_load_dwordx4 v[128:131], v2, s[48:51], s64 offen offset:2048 sc1
buffer_load_dwordx4 v[132:135], v2, s[48:51], s64 offen offset:3072 sc1
L_wd20:
s_waitcnt vmcnt(8)
v_mov_b32 v190, 3
s_mov_b64 exec, 1
ds_write_b32 v185, v190
s_mov_b64 exec, -1
L_lc21:
ds_read_b128 v[186:189], v184
s_waitcnt lgkmcnt(0)
v_min3_u32 v186, v186, v187, v188
v_min_u32 v186, v186, v189
s_nop 0
v_readfirstlane_b32 s92, v186
s_nop 0
s_cmp_ge_u32 s92, 3
s_cbranch_scc1 L_lcd22
s_sleep 1
s_branch L_lc21
L_lcd22:
ds_read_b128 v[72:75], v15 offset:0
ds_read_b128 v[76:79], v15 offset:4096
ds_read_b128 v[80:83], v15 offset:8192
ds_read_b128 v[84:87], v15 offset:12288
s_cmp_eq_u32 s61, 1
s_cbranch_scc1 L_wr23
ds_read_b128 v[104:107], v19 offset:0
ds_read_b128 v[108:111], v19 offset:1024
ds_read_b128 v[112:115], v19 offset:2048
ds_read_b128 v[116:119], v19 offset:3072
ds_read_b128 v[120:123], v19 offset:4096
ds_read_b128 v[124:127], v19 offset:5120
ds_read_b128 v[128:131], v19 offset:6144
ds_read_b128 v[132:135], v19 offset:7168
L_wr23:
s_waitcnt lgkmcnt(0)
v_mov_b32 v190, 4
s_mov_b64 exec, 1
ds_write_b32 v185, v190
s_mov_b64 exec, -1
s_lshl_b32 s64, s61, 31
s_or_b32 s64, s64, s62
L_fft24:
v_xor_b32 v24, s64, v72
v_xor_b32 v25, s64, v73
v_xor_b32 v26, s64, v74
v_xor_b32 v27, s64, v75
v_xor_b32 v28, s64, v76
v_xor_b32 v29, s64, v77
v_xor_b32 v30, s64, v78
v_xor_b32 v31, s64, v79
v_xor_b32 v32, s64, v80
v_xor_b32 v33, s64, v81
v_xor_b32 v34, s64, v82
v_xor_b32 v35, s64, v83
v_xor_b32 v36, s64, v84
v_xor_b32 v37, s64, v85
v_xor_b32 v38, s64, v86
v_xor_b32 v39, s64, v87
v_mfma_f32_32x32x16_bf16 v[40:55], v[24:27], v[192:195], 0
v_mfma_f32_32x32x16_bf16 v[40:55], v[28:31], v[196:199], v[40:55]
v_mfma_f32_32x32x16_bf16 v[40:55], v[32:35], v[200:203], v[40:55]
v_mfma_f32_32x32x16_bf16 v[40:55], v[36:39], v[204:207], v[40:55]
v_mfma_f32_32x32x16_bf16 v[56:71], v[24:27], v[208:211], 0
v_mfma_f32_32x32x16_bf16 v[56:71], v[28:31], v[212:215], v[56:71]
v_mfma_f32_32x32x16_bf16 v[56:71], v[32:35], v[216:219], v[56:71]
v_mfma_f32_32x32x16_bf16 v[56:71], v[36:39], v[220:223], v[56:71]
s_cmp_eq_u32 s61, 2
s_cbranch_scc1 L_once26
s_waitcnt vmcnt(0)
v_lshlrev_b32 v176, 16, v104
v_and_b32 v177, 0xffff0000, v104
v_lshlrev_b32 v178, 16, v105
v_and_b32 v179, 0xffff0000, v105
v_add_f32 v180, v176, v178
v_add_f32 v181, v177, v179
v_sub_f32 v176, v176, v178
v_sub_f32 v177, v177, v179
v_mul_f32 v104, v136, v176
v_mul_f32 v105, v136, v177
v_fma_f32 v136, v152, v176, v180
v_fma_f32 v152, v152, v177, v181
v_lshlrev_b32 v176, 16, v106
v_and_b32 v177, 0xffff0000, v106
v_lshlrev_b32 v178, 16, v107
v_and_b32 v179, 0xffff0000, v107
v_add_f32 v180, v176, v178
v_add_f32 v181, v177, v179
v_sub_f32 v176, v176, v178
v_sub_f32 v177, v177, v179
v_mul_f32 v106, v137, v176
v_mul_f32 v107, v137, v177
v_fma_f32 v137, v153, v176, v180
v_fma_f32 v153, v153, v177, v181
v_lshlrev_b32 v176, 16, v108
v_and_b32 v177, 0xffff0000, v108
v_lshlrev_b32 v178, 16, v109
v_and_b32 v179, 0xffff0000, v109
v_add_f32 v180, v176, v178
v_add_f32 v181, v177, v179
v_sub_f32 v176, v176, v178
v_sub_f32 v177, v177, v179
v_mul_f32 v108, v138, v176
v_mul_f32 v109, v138, v177
v_fma_f32 v138, v154, v176, v180
v_fma_f32 v154, v154, v177, v181
v_lshlrev_b32 v176, 16, v110
v_and_b32 v177, 0xffff0000, v110
v_lshlrev_b32 v178, 16, v111
v_and_b32 v179, 0xffff0000, v111
v_add_f32 v180, v176, v178
v_add_f32 v181, v177, v179
v_sub_f32 v176, v176, v178
v_sub_f32 v177, v177, v179
v_mul_f32 v110, v139, v176
v_mul_f32 v111, v139, v177
v_fma_f32 v139, v155, v176, v180
v_fma_f32 v155, v155, v177, v181
v_lshlrev_b32 v176, 16, v112
v_and_b32 v177, 0xffff0000, v112
v_lshlrev_b32 v178, 16, v113
v_and_b32 v179, 0xffff0000, v113
v_add_f32 v180, v176, v178
v_add_f32 v181, v177, v179
v_sub_f32 v176, v176, v178
v_sub_f32 v177, v177, v179
v_mul_f32 v112, v140, v176
v_mul_f32 v113, v140, v177
v_fma_f32 v140, v156, v176, v180
v_fma_f32 v156, v156, v177, v181
v_lshlrev_b32 v176, 16, v114
v_and_b32 v177, 0xffff0000, v114
v_lshlrev_b32 v178, 16, v115
v_and_b32 v179, 0xffff0000, v115
v_add_f32 v180, v176, v178
v_add_f32 v181, v177, v179
v_sub_f32 v176, v176, v178
v_sub_f32 v177, v177, v179
v_mul_f32 v114, v141, v176
v_mul_f32 v115, v141, v177
v_fma_f32 v141, v157, v176, v180
v_fma_f32 v157, v157, v177, v181
L_once26:
s_nop 5
v_mul_f32 v168, v40, v224
v_mul_f32 v169, v40, v240
s_nop 1
v_fma_f32 v168, -v56, v240, v168
v_fmac_f32 v169, v56, v224
v_cvt_pk_bf16_f32 v24, v168, v169
v_mul_f32 v170, v41, v225
v_mul_f32 v171, v41, v241
v_fma_f32 v170, -v57, v241, v170
v_fmac_f32 v171, v57, v225
v_cvt_pk_bf16_f32 v25, v170, v171
v_mul_f32 v172, v42, v226
v_mul_f32 v173, v42, v242
v_fma_f32 v172, -v58, v242, v172
v_fmac_f32 v173, v58, v226
v_cvt_pk_bf16_f32 v26, v172, v173
v_mul_f32 v174, v43, v227
v_mul_f32 v175, v43, v243
v_fma_f32 v174, -v59, v243, v174
v_fmac_f32 v175, v59, v227
v_cvt_pk_bf16_f32 v27, v174, v175
v_mul_f32 v168, v44, v228
v_mul_f32 v169, v44, v244
v_fma_f32 v168, -v60, v244, v168
v_fmac_f32 v169, v60, v228
v_cvt_pk_bf16_f32 v28, v168, v169
v_mul_f32 v170, v45, v229
v_mul_f32 v171, v45, v245
v_fma_f32 v170, -v61, v245, v170
v_fmac_f32 v171, v61, v229
v_cvt_pk_bf16_f32 v29, v170, v171
v_mul_f32 v172, v46, v230
v_mul_f32 v173, v46, v246
v_fma_f32 v172, -v62, v246, v172
v_fmac_f32 v173, v62, v230
v_cvt_pk_bf16_f32 v30, v172, v173
v_mul_f32 v174, v47, v231
v_mul_f32 v175, v47, v247
v_fma_f32 v174, -v63, v247, v174
v_fmac_f32 v175, v63, v231
v_cvt_pk_bf16_f32 v31, v174, v175
v_mul_f32 v168, v48, v232
v_mul_f32 v169, v48, v248
v_fma_f32 v168, -v64, v248, v168
v_fmac_f32 v169, v64, v232
v_cvt_pk_bf16_f32 v32, v168, v169
v_mul_f32 v170, v49, v233
v_mul_f32 v171, v49, v249
v_fma_f32 v170, -v65, v249, v170
v_fmac_f32 v171, v65, v233
v_cvt_pk_bf16_f32 v33, v170, v171
v_mul_f32 v172, v50, v234
v_mul_f32 v173, v50, v250
v_fma_f32 v172, -v66, v250, v172
v_fmac_f32 v173, v66, v234
v_cvt_pk_bf16_f32 v34, v172, v173
v_mul_f32 v174, v51, v235
v_mul_f32 v175, v51, v251
v_fma_f32 v174, -v67, v251, v174
v_fmac_f32 v175, v67, v235
v_cvt_pk_bf16_f32 v35, v174, v175
v_mul_f32 v168, v52, v236
v_mul_f32 v169, v52, v252
v_fma_f32 v168, -v68, v252, v168
v_fmac_f32 v169, v68, v236
v_cvt_pk_bf16_f32 v36, v168, v169
v_mul_f32 v170, v53, v237
v_mul_f32 v171, v53, v253
v_fma_f32 v170, -v69, v253, v170
v_fmac_f32 v171, v69, v237
v_cvt_pk_bf16_f32 v37, v170, v171
v_mul_f32 v172, v54, v238
v_mul_f32 v173, v54, v254
v_fma_f32 v172, -v70, v254, v172
v_fmac_f32 v173, v70, v238
v_cvt_pk_bf16_f32 v38, v172, v173
v_mul_f32 v174, v55, v239
v_mul_f32 v175, v55, v255
v_fma_f32 v174, -v71, v255, v174
v_fmac_f32 v175, v71, v239
v_cvt_pk_bf16_f32 v39, v174, v175
v_mfma_f32_32x32x16_bf16 v[40:55], v[192:195], v[24:27], 0
v_mfma_f32_32x32x16_bf16 v[40:55], v[196:199], v[28:31], v[40:55]
v_mfma_f32_32x32x16_bf16 v[40:55], v[200:203], v[32:35], v[40:55]
v_mfma_f32_32x32x16_bf16 v[40:55], v[204:207], v[36:39], v[40:55]
v_mfma_f32_32x32x16_bf16 v[56:71], v[208:211], v[24:27], 0
v_mfma_f32_32x32x16_bf16 v[56:71], v[212:215], v[28:31], v[56:71]
v_mfma_f32_32x32x16_bf16 v[56:71], v[216:219], v[32:35], v[56:71]
v_mfma_f32_32x32x16_bf16 v[56:71], v[220:223], v[36:39], v[56:71]
s_cmp_eq_u32 s61, 2
s_cbranch_scc1 L_once27
s_waitcnt vmcnt(0)
v_lshlrev_b32 v176, 16, v116
v_and_b32 v177, 0xffff0000, v116
v_lshlrev_b32 v178, 16, v117
v_and_b32 v179, 0xffff0000, v117
v_add_f32 v180, v176, v178
v_add_f32 v181, v177, v179
v_sub_f32 v176, v176, v178
v_sub_f32 v177, v177, v179
v_mul_f32 v116, v142, v176
v_mul_f32 v117, v142, v177
v_fma_f32 v142, v158, v176, v180
v_fma_f32 v158, v158, v177, v181
v_lshlrev_b32 v176, 16, v118
v_and_b32 v177, 0xffff0000, v118
v_lshlrev_b32 v178, 16, v119
v_and_b32 v179, 0xffff0000, v119
v_add_f32 v180, v176, v178
v_add_f32 v181, v177, v179
v_sub_f32 v176, v176, v178
v_sub_f32 v177, v177, v179
v_mul_f32 v118, v143, v176
v_mul_f32 v119, v143, v177
v_fma_f32 v143, v159, v176, v180
v_fma_f32 v159, v159, v177, v181
v_lshlrev_b32 v176, 16, v120
v_and_b32 v177, 0xffff0000, v120
v_lshlrev_b32 v178, 16, v121
v_and_b32 v179, 0xffff0000, v121
v_add_f32 v180, v176, v178
v_add_f32 v181, v177, v179
v_sub_f32 v176, v176, v178
v_sub_f32 v177, v177, v179
v_mul_f32 v120, v144, v176
v_mul_f32 v121, v144, v177
v_fma_f32 v144, v160, v176, v180
v_fma_f32 v160, v160, v177, v181
v_lshlrev_b32 v176, 16, v122
v_and_b32 v177, 0xffff0000, v122
v_lshlrev_b32 v178, 16, v123
v_and_b32 v179, 0xffff0000, v123
v_add_f32 v180, v176, v178
v_add_f32 v181, v177, v179
v_sub_f32 v176, v176, v178
v_sub_f32 v177, v177, v179
v_mul_f32 v122, v145, v176
v_mul_f32 v123, v145, v177
v_fma_f32 v145, v161, v176, v180
v_fma_f32 v161, v161, v177, v181
v_lshlrev_b32 v176, 16, v124
v_and_b32 v177, 0xffff0000, v124
v_lshlrev_b32 v178, 16, v125
v_and_b32 v179, 0xffff0000, v125
v_add_f32 v180, v176, v178
v_add_f32 v181, v177, v179
v_sub_f32 v176, v176, v178
v_sub_f32 v177, v177, v179
v_mul_f32 v124, v146, v176
v_mul_f32 v125, v146, v177
v_fma_f32 v146, v162, v176, v180
v_fma_f32 v162, v162, v177, v181
v_lshlrev_b32 v176, 16, v126
v_and_b32 v177, 0xffff0000, v126
v_lshlrev_b32 v178, 16, v127
v_and_b32 v179, 0xffff0000, v127
v_add_f32 v180, v176, v178
v_add_f32 v181, v177, v179
v_sub_f32 v176, v176, v178
v_sub_f32 v177, v177, v179
v_mul_f32 v126, v147, v176
v_mul_f32 v127, v147, v177
v_fma_f32 v147, v163, v176, v180
v_fma_f32 v163, v163, v177, v181
L_once27:
L_lc28:
ds_read_b128 v[186:189], v184
s_waitcnt lgkmcnt(0)
v_min3_u32 v186, v186, v187, v188
v_min_u32 v186, v186, v189
s_nop 0
v_readfirstlane_b32 s92, v186
s_nop 0
s_cmp_ge_u32 s92, 4
s_cbranch_scc1 L_lcd29
s_sleep 1
s_branch L_lc28
L_lcd29:
s_cmp_eq_u32 s61, 2
s_cbranch_scc1 L_nwr25
ds_write_b128 v16, v[40:43] offset:0
ds_write_b128 v16, v[44:47] offset:1024
ds_write_b128 v16, v[48:51] offset:2048
ds_write_b128 v16, v[52:55] offset:3072
ds_write_b128 v16, v[56:59] offset:4096
ds_write_b128 v16, v[60:63] offset:5120
ds_write_b128 v16, v[64:67] offset:6144
ds_write_b128 v16, v[68:71] offset:7168
s_cmp_eq_u32 s61, 0
s_cbranch_scc1 L_nwr25
s_mov_b32 s61, 2
s_mov_b32 s64, 0
s_branch L_fft24
L_nwr25:
v_lshlrev_b32 v176, 16, v128
v_and_b32 v177, 0xffff0000, v128
v_lshlrev_b32 v178, 16, v129
v_and_b32 v179, 0xffff0000, v129
v_add_f32 v180, v176, v178
v_add_f32 v181, v177, v179
v_sub_f32 v176, v176, v178
v_sub_f32 v177, v177, v179
v_mul_f32 v128, v148, v176
v_mul_f32 v129, v148, v177
v_fma_f32 v148, v164, v176, v180
v_fma_f32 v164, v164, v177, v181
v_lshlrev_b32 v176, 16, v130
v_and_b32 v177, 0xffff0000, v130
v_lshlrev_b32 v178, 16, v131
v_and_b32 v179, 0xffff0000, v131
v_add_f32 v180, v176, v178
v_add_f32 v181, v177, v179
v_sub_f32 v176, v176, v178
v_sub_f32 v177, v177, v179
v_mul_f32 v130, v149, v176
v_mul_f32 v131, v149, v177
v_fma_f32 v149, v165, v176, v180
v_fma_f32 v165, v165, v177, v181
s_waitcnt lgkmcnt(0)
v_mov_b32 v190, 5
s_mov_b64 exec, 1
ds_write_b32 v185, v190
s_mov_b64 exec, -1
v_lshlrev_b32 v176, 16, v132
v_and_b32 v177, 0xffff0000, v132
v_lshlrev_b32 v178, 16, v133
v_and_b32 v179, 0xffff0000, v133
v_add_f32 v180, v176, v178
v_add_f32 v181, v177, v179
v_sub_f32 v176, v176, v178
v_sub_f32 v177, v177, v179
v_mul_f32 v132, v150, v176
v_mul_f32 v133, v150, v177
v_fma_f32 v150, v166, v176, v180
v_fma_f32 v166, v166, v177, v181
v_lshlrev_b32 v176, 16, v134
v_and_b32 v177, 0xffff0000, v134
v_lshlrev_b32 v178, 16, v135
v_and_b32 v179, 0xffff0000, v135
v_add_f32 v180, v176, v178
v_add_f32 v181, v177, v179
v_sub_f32 v176, v176, v178
v_sub_f32 v177, v177, v179
v_mul_f32 v134, v151, v176
v_mul_f32 v135, v151, v177
v_fma_f32 v151, v167, v176, v180
v_fma_f32 v167, v167, v177, v181
v_mul_f32 v168, v152, v56
v_mul_f32 v56, v136, v56
v_fmac_f32 v56, v152, v40
v_fma_f32 v40, v136, v40, -v168
v_mul_f32 v169, v153, v57
v_mul_f32 v57, v137, v57
v_fmac_f32 v57, v153, v41
v_fma_f32 v41, v137, v41, -v169
v_mul_f32 v168, v154, v58
v_mul_f32 v58, v138, v58
v_fmac_f32 v58, v154, v42
v_fma_f32 v42, v138, v42, -v168
v_mul_f32 v169, v155, v59
v_mul_f32 v59, v139, v59
v_fmac_f32 v59, v155, v43
v_fma_f32 v43, v139, v43, -v169
v_mul_f32 v168, v156, v60
v_mul_f32 v60, v140, v60
v_fmac_f32 v60, v156, v44
v_fma_f32 v44, v140, v44, -v168
v_mul_f32 v169, v157, v61
v_mul_f32 v61, v141, v61
v_fmac_f32 v61, v157, v45
v_fma_f32 v45, v141, v45, -v169
L_lc30:
ds_read_b128 v[186:189], v184
s_waitcnt lgkmcnt(0)
v_min3_u32 v186, v186, v187, v188
v_min_u32 v186, v186, v189
s_nop 0
v_readfirstlane_b32 s92, v186
s_nop 0
s_cmp_ge_u32 s92, 5
s_cbranch_scc1 L_lcd31
s_sleep 1
s_branch L_lc30
L_lcd31:
ds_read_b128 v[72:75], v17 offset:0
ds_read_b128 v[76:79], v17 offset:1024
ds_read_b128 v[80:83], v17 offset:2048
ds_read_b128 v[84:87], v17 offset:3072
ds_read_b128 v[88:91], v17 offset:4096
ds_read_b128 v[92:95], v17 offset:5120
ds_read_b128 v[96:99], v17 offset:6144
ds_read_b128 v[100:103], v17 offset:7168
v_mul_f32 v168, v158, v62
v_mul_f32 v62, v142, v62
v_fmac_f32 v62, v158, v46
v_fma_f32 v46, v142, v46, -v168
v_mul_f32 v169, v159, v63
v_mul_f32 v63, v143, v63
v_fmac_f32 v63, v159, v47
v_fma_f32 v47, v143, v47, -v169
v_mul_f32 v168, v160, v64
v_mul_f32 v64, v144, v64
v_fmac_f32 v64, v160, v48
v_fma_f32 v48, v144, v48, -v168
v_mul_f32 v169, v161, v65
v_mul_f32 v65, v145, v65
v_fmac_f32 v65, v161, v49
v_fma_f32 v49, v145, v49, -v169
v_mul_f32 v168, v162, v66
v_mul_f32 v66, v146, v66
v_fmac_f32 v66, v162, v50
v_fma_f32 v50, v146, v50, -v168
v_mul_f32 v169, v163, v67
v_mul_f32 v67, v147, v67
v_fmac_f32 v67, v163, v51
v_fma_f32 v51, v147, v51, -v169
v_mul_f32 v168, v164, v68
v_mul_f32 v68, v148, v68
v_fmac_f32 v68, v164, v52
v_fma_f32 v52, v148, v52, -v168
v_mul_f32 v169, v165, v69
v_mul_f32 v69, v149, v69
v_fmac_f32 v69, v165, v53
v_fma_f32 v53, v149, v53, -v169
v_mul_f32 v168, v166, v70
v_mul_f32 v70, v150, v70
v_fmac_f32 v70, v166, v54
v_fma_f32 v54, v150, v54, -v168
v_mul_f32 v169, v167, v71
v_mul_f32 v71, v151, v71
v_fmac_f32 v71, v167, v55
v_fma_f32 v55, v151, v55, -v169
s_waitcnt lgkmcnt(0)
v_mov_b32 v190, 6
s_mov_b64 exec, 1
ds_write_b32 v185, v190
s_mov_b64 exec, -1
v_fma_f32 v40, -v104, v88, v40
v_fmac_f32 v56, v104, v72
v_fma_f32 v40, -v105, v72, v40
v_fma_f32 v56, -v105, v88, v56
v_cvt_pk_bf16_f32 v24, v56, v40
v_fma_f32 v41, -v106, v89, v41
v_fmac_f32 v57, v106, v73
v_fma_f32 v41, -v107, v73, v41
v_fma_f32 v57, -v107, v89, v57
v_cvt_pk_bf16_f32 v25, v57, v41
v_fma_f32 v42, -v108, v90, v42
v_fmac_f32 v58, v108, v74
v_fma_f32 v42, -v109, v74, v42
v_fma_f32 v58, -v109, v90, v58
v_cvt_pk_bf16_f32 v26, v58, v42
v_fma_f32 v43, -v110, v91, v43
v_fmac_f32 v59, v110, v75
v_fma_f32 v43, -v111, v75, v43
v_fma_f32 v59, -v111, v91, v59
v_cvt_pk_bf16_f32 v27, v59, v43
v_fma_f32 v44, -v112, v92, v44
v_fmac_f32 v60, v112, v76
v_fma_f32 v44, -v113, v76, v44
v_fma_f32 v60, -v113, v92, v60
v_cvt_pk_bf16_f32 v28, v60, v44
v_fma_f32 v45, -v114, v93, v45
v_fmac_f32 v61, v114, v77
v_fma_f32 v45, -v115, v77, v45
v_fma_f32 v61, -v115, v93, v61
v_cvt_pk_bf16_f32 v29, v61, v45
v_fma_f32 v46, -v116, v94, v46
v_fmac_f32 v62, v116, v78
v_fma_f32 v46, -v117, v78, v46
v_fma_f32 v62, -v117, v94, v62
v_cvt_pk_bf16_f32 v30, v62, v46
v_fma_f32 v47, -v118, v95, v47
v_fmac_f32 v63, v118, v79
v_fma_f32 v47, -v119, v79, v47
v_fma_f32 v63, -v119, v95, v63
v_cvt_pk_bf16_f32 v31, v63, v47
v_fma_f32 v48, -v120, v96, v48
v_fmac_f32 v64, v120, v80
v_fma_f32 v48, -v121, v80, v48
v_fma_f32 v64, -v121, v96, v64
v_cvt_pk_bf16_f32 v32, v64, v48
v_fma_f32 v49, -v122, v97, v49
v_fmac_f32 v65, v122, v81
v_fma_f32 v49, -v123, v81, v49
v_fma_f32 v65, -v123, v97, v65
v_cvt_pk_bf16_f32 v33, v65, v49
v_fma_f32 v50, -v124, v98, v50
v_fmac_f32 v66, v124, v82
v_fma_f32 v50, -v125, v82, v50
v_fma_f32 v66, -v125, v98, v66
v_cvt_pk_bf16_f32 v34, v66, v50
v_fma_f32 v51, -v126, v99, v51
v_fmac_f32 v67, v126, v83
v_fma_f32 v51, -v127, v83, v51
v_fma_f32 v67, -v127, v99, v67
v_cvt_pk_bf16_f32 v35, v67, v51
v_fma_f32 v52, -v128, v100, v52
v_fmac_f32 v68, v128, v84
v_fma_f32 v52, -v129, v84, v52
v_fma_f32 v68, -v129, v100, v68
v_cvt_pk_bf16_f32 v36, v68, v52
v_fma_f32 v53, -v130, v101, v53
v_fmac_f32 v69, v130, v85
v_fma_f32 v53, -v131, v85, v53
v_fma_f32 v69, -v131, v101, v69
v_cvt_pk_bf16_f32 v37, v69, v53
v_fma_f32 v54, -v132, v102, v54
v_fmac_f32 v70, v132, v86
v_fma_f32 v54, -v133, v86, v54
v_fma_f32 v70, -v133, v102, v70
v_cvt_pk_bf16_f32 v38, v70, v54
v_fma_f32 v55, -v134, v103, v55
v_fmac_f32 v71, v134, v87
v_fma_f32 v55, -v135, v87, v55
v_fma_f32 v71, -v135, v103, v71
v_cvt_pk_bf16_f32 v39, v71, v55
v_mfma_f32_32x32x16_bf16 v[40:55], v[24:27], v[192:195], 0
v_mfma_f32_32x32x16_bf16 v[40:55], v[28:31], v[196:199], v[40:55]
v_mfma_f32_32x32x16_bf16 v[40:55], v[32:35], v[200:203], v[40:55]
v_mfma_f32_32x32x16_bf16 v[40:55], v[36:39], v[204:207], v[40:55]
v_mfma_f32_32x32x16_bf16 v[56:71], v[24:27], v[208:211], 0
v_mfma_f32_32x32x16_bf16 v[56:71], v[28:31], v[212:215], v[56:71]
v_mfma_f32_32x32x16_bf16 v[56:71], v[32:35], v[216:219], v[56:71]
v_mfma_f32_32x32x16_bf16 v[56:71], v[36:39], v[220:223], v[56:71]
s_nop 7
v_mul_f32 v168, v40, v224
v_mul_f32 v169, v40, v240
s_nop 1
v_fma_f32 v168, -v56, v240, v168
v_fmac_f32 v169, v56, v224
v_cvt_pk_bf16_f32 v24, v168, v169
v_mul_f32 v170, v41, v225
v_mul_f32 v171, v41, v241
v_fma_f32 v170, -v57, v241, v170
v_fmac_f32 v171, v57, v225
v_cvt_pk_bf16_f32 v25, v170, v171
v_mul_f32 v172, v42, v226
v_mul_f32 v173, v42, v242
v_fma_f32 v172, -v58, v242, v172
v_fmac_f32 v173, v58, v226
v_cvt_pk_bf16_f32 v26, v172, v173
v_mul_f32 v174, v43, v227
v_mul_f32 v175, v43, v243
v_fma_f32 v174, -v59, v243, v174
v_fmac_f32 v175, v59, v227
v_cvt_pk_bf16_f32 v27, v174, v175
v_mul_f32 v168, v44, v228
v_mul_f32 v169, v44, v244
v_fma_f32 v168, -v60, v244, v168
v_fmac_f32 v169, v60, v228
v_cvt_pk_bf16_f32 v28, v168, v169
v_mul_f32 v170, v45, v229
v_mul_f32 v171, v45, v245
v_fma_f32 v170, -v61, v245, v170
v_fmac_f32 v171, v61, v229
v_cvt_pk_bf16_f32 v29, v170, v171
v_mul_f32 v172, v46, v230
v_mul_f32 v173, v46, v246
v_fma_f32 v172, -v62, v246, v172
v_fmac_f32 v173, v62, v230
v_cvt_pk_bf16_f32 v30, v172, v173
v_mul_f32 v174, v47, v231
v_mul_f32 v175, v47, v247
v_fma_f32 v174, -v63, v247, v174
v_fmac_f32 v175, v63, v231
v_cvt_pk_bf16_f32 v31, v174, v175
v_mul_f32 v168, v48, v232
v_mul_f32 v169, v48, v248
v_fma_f32 v168, -v64, v248, v168
v_fmac_f32 v169, v64, v232
v_cvt_pk_bf16_f32 v32, v168, v169
v_mul_f32 v170, v49, v233
v_mul_f32 v171, v49, v249
v_fma_f32 v170, -v65, v249, v170
v_fmac_f32 v171, v65, v233
v_cvt_pk_bf16_f32 v33, v170, v171
v_mul_f32 v172, v50, v234
v_mul_f32 v173, v50, v250
v_fma_f32 v172, -v66, v250, v172
v_fmac_f32 v173, v66, v234
v_cvt_pk_bf16_f32 v34, v172, v173
v_mul_f32 v174, v51, v235
v_mul_f32 v175, v51, v251
v_fma_f32 v174, -v67, v251, v174
v_fmac_f32 v175, v67, v235
v_cvt_pk_bf16_f32 v35, v174, v175
v_mul_f32 v168, v52, v236
v_mul_f32 v169, v52, v252
v_fma_f32 v168, -v68, v252, v168
v_fmac_f32 v169, v68, v236
v_cvt_pk_bf16_f32 v36, v168, v169
v_mul_f32 v170, v53, v237
v_mul_f32 v171, v53, v253
v_fma_f32 v170, -v69, v253, v170
v_fmac_f32 v171, v69, v237
v_cvt_pk_bf16_f32 v37, v170, v171
v_mul_f32 v172, v54, v238
v_mul_f32 v173, v54, v254
v_fma_f32 v172, -v70, v254, v172
v_fmac_f32 v173, v70, v238
v_cvt_pk_bf16_f32 v38, v172, v173
v_mul_f32 v174, v55, v239
v_mul_f32 v175, v55, v255
v_fma_f32 v174, -v71, v255, v174
v_fmac_f32 v175, v71, v239
v_cvt_pk_bf16_f32 v39, v174, v175
v_mfma_f32_32x32x16_bf16 v[40:55], v[192:195], v[24:27], 0
v_mfma_f32_32x32x16_bf16 v[40:55], v[196:199], v[28:31], v[40:55]
v_mfma_f32_32x32x16_bf16 v[40:55], v[200:203], v[32:35], v[40:55]
v_mfma_f32_32x32x16_bf16 v[40:55], v[204:207], v[36:39], v[40:55]
v_mfma_f32_32x32x16_bf16 v[56:71], v[208:211], v[24:27], 0
v_mfma_f32_32x32x16_bf16 v[56:71], v[212:215], v[28:31], v[56:71]
v_mfma_f32_32x32x16_bf16 v[56:71], v[216:219], v[32:35], v[56:71]
v_mfma_f32_32x32x16_bf16 v[56:71], v[220:223], v[36:39], v[56:71]
s_lshr_b32 s64, s62, 16
L_lc32:
ds_read_b128 v[186:189], v184
s_waitcnt lgkmcnt(0)
v_min3_u32 v186, v186, v187, v188
v_min_u32 v186, v186, v189
s_nop 0
v_readfirstlane_b32 s92, v186
s_nop 0
s_cmp_ge_u32 s92, 6
s_cbranch_scc1 L_lcd33
s_sleep 1
s_branch L_lc32
L_lcd33:
s_nop 1
v_cvt_pk_bf16_f32 v24, v40, v56
v_xor_b32 v24, s64, v24
v_cvt_pk_bf16_f32 v25, v41, v57
v_xor_b32 v25, s64, v25
v_cvt_pk_bf16_f32 v26, v42, v58
v_xor_b32 v26, s64, v26
v_cvt_pk_bf16_f32 v27, v43, v59
v_xor_b32 v27, s64, v27
ds_write_b128 v15, v[24:27] offset:0
v_cvt_pk_bf16_f32 v28, v44, v60
v_xor_b32 v28, s64, v28
v_cvt_pk_bf16_f32 v29, v45, v61
v_xor_b32 v29, s64, v29
v_cvt_pk_bf16_f32 v30, v46, v62
v_xor_b32 v30, s64, v30
v_cvt_pk_bf16_f32 v31, v47, v63
v_xor_b32 v31, s64, v31
ds_write_b128 v15, v[28:31] offset:4096
v_cvt_pk_bf16_f32 v32, v48, v64
v_xor_b32 v32, s64, v32
v_cvt_pk_bf16_f32 v33, v49, v65
v_xor_b32 v33, s64, v33
v_cvt_pk_bf16_f32 v34, v50, v66
v_xor_b32 v34, s64, v34
v_cvt_pk_bf16_f32 v35, v51, v67
v_xor_b32 v35, s64, v35
ds_write_b128 v15, v[32:35] offset:8192
v_cvt_pk_bf16_f32 v36, v52, v68
v_xor_b32 v36, s64, v36
v_cvt_pk_bf16_f32 v37, v53, v69
v_xor_b32 v37, s64, v37
v_cvt_pk_bf16_f32 v38, v54, v70
v_xor_b32 v38, s64, v38
v_cvt_pk_bf16_f32 v39, v55, v71
v_xor_b32 v39, s64, v39
ds_write_b128 v15, v[36:39] offset:12288
s_waitcnt lgkmcnt(0)
v_mov_b32 v190, 7
s_mov_b64 exec, 1
ds_write_b32 v185, v190
s_mov_b64 exec, -1
L_lc34:
ds_read_b128 v[186:189], v184
s_waitcnt lgkmcnt(0)
v_min3_u32 v186, v186, v187, v188
v_min_u32 v186, v186, v189
s_nop 0
v_readfirstlane_b32 s92, v186
s_nop 0
s_cmp_ge_u32 s92, 7
s_cbranch_scc1 L_lcd35
s_sleep 1
s_branch L_lc34
L_lcd35:
ds_read_b128 v[24:27], v18 offset:0
ds_read_b128 v[28:31], v18 offset:1024
ds_read_b128 v[32:35], v18 offset:2048
ds_read_b128 v[36:39], v18 offset:3072
s_mov_b32 s64, 0
s_waitcnt lgkmcnt(3)
buffer_store_dwordx4 v[24:27], v14, s[52:55], s64 offen sc1
s_mov_b32 s64, 262144
s_waitcnt lgkmcnt(2)
buffer_store_dwordx4 v[28:31], v14, s[52:55], s64 offen sc1
s_mov_b32 s64, 524288
s_waitcnt lgkmcnt(1)
buffer_store_dwordx4 v[32:35], v14, s[52:55], s64 offen sc1
s_mov_b32 s64, 786432
s_waitcnt lgkmcnt(0)
buffer_store_dwordx4 v[36:39], v14, s[52:55], s64 offen sc1
s_lshl_b32 s64, s67, 14
s_add_u32 s40, s28, s64
s_addc_u32 s41, s29, 0
s_mov_b32 s42, 16384
s_mov_b32 s43, 0x20000
v_and_b32 v8, 31, v1
v_lshrrev_b32 v9, 5, v1
v_lshlrev_b32 v14, 2, v8
v_lshl_add_u32 v14, v9, 9, v14
s_mov_b32 s64, 0x35000000
v_mul_f32 v224, s64, v224
v_mul_f32 v225, s64, v225
v_mul_f32 v226, s64, v226
v_mul_f32 v227, s64, v227
v_mul_f32 v228, s64, v228
v_mul_f32 v229, s64, v229
v_mul_f32 v230, s64, v230
v_mul_f32 v231, s64, v231
v_mul_f32 v232, s64, v232
v_mul_f32 v233, s64, v233
v_mul_f32 v234, s64, v234
v_mul_f32 v235, s64, v235
v_mul_f32 v236, s64, v236
v_mul_f32 v237, s64, v237
v_mul_f32 v238, s64, v238
v_mul_f32 v239, s64, v239
v_mul_f32 v240, s64, v240
v_mul_f32 v241, s64, v241
v_mul_f32 v242, s64, v242
v_mul_f32 v243, s64, v243
v_mul_f32 v244, s64, v244
v_mul_f32 v245, s64, v245
v_mul_f32 v246, s64, v246
v_mul_f32 v247, s64, v247
v_mul_f32 v248, s64, v248
v_mul_f32 v249, s64, v249
v_mul_f32 v250, s64, v250
v_mul_f32 v251, s64, v251
v_mul_f32 v252, s64, v252
v_mul_f32 v253, s64, v253
v_mul_f32 v254, s64, v254
v_mul_f32 v255, s64, v255
s_waitcnt vmcnt(0)
v_mov_b32 v190, 8
s_mov_b64 exec, 1
ds_write_b32 v185, v190
s_mov_b64 exec, -1
s_cmp_lg_u32 s66, 0
s_cbranch_scc1 L_ph36
L_lc37:
ds_read_b128 v[186:189], v184
s_waitcnt lgkmcnt(0)
v_min3_u32 v186, v186, v187, v188
v_min_u32 v186, v186, v189
s_nop 0
v_readfirstlane_b32 s92, v186
s_nop 0
s_cmp_ge_u32 s92, 8
s_cbranch_scc1 L_lcd38
s_sleep 1
s_branch L_lc37
L_lcd38:
s_and_b32 s64, s2, 15
s_lshl_b32 s65, s64, 7
s_add_u32 s65, s65, 6144
s_add_u32 s90, s32, s65
s_addc_u32 s91, s33, 0
s_mov_b32 s18, 1
s_atomic_add s18, s[90:91], 0x0 glc
L_ph36:
s_cmp_lg_u32 s66, 0
s_cbranch_scc1 L_sg39
s_and_b32 s64, s2, 15
s_lshl_b32 s64, s64, 2
s_add_u32 s64, s64, 548864
s_add_u32 s4, s32, s64
s_addc_u32 s5, s33, 0
s_waitcnt lgkmcnt(0)
s_cmp_lg_u32 s18, 15
s_cbranch_scc1 L_sg39
s_atomic_swap s37, s[4:5], 0x0
s_atomic_swap s37, s[4:5], 0x80
s_atomic_swap s37, s[4:5], 0x100
s_atomic_swap s37, s[4:5], 0x180
s_atomic_swap s37, s[4:5], 0x200
s_atomic_swap s37, s[4:5], 0x280
s_atomic_swap s37, s[4:5], 0x300
s_atomic_swap s37, s[4:5], 0x380
s_atomic_swap s37, s[4:5], 0x400
s_atomic_swap s37, s[4:5], 0x480
s_atomic_swap s37, s[4:5], 0x500
s_atomic_swap s37, s[4:5], 0x580
s_atomic_swap s37, s[4:5], 0x600
s_atomic_swap s37, s[4:5], 0x680
s_atomic_swap s37, s[4:5], 0x700
s_atomic_swap s37, s[4:5], 0x780
s_atomic_swap s37, s[4:5], 0x800
s_atomic_swap s37, s[4:5], 0x880
s_atomic_swap s37, s[4:5], 0x900
s_atomic_swap s37, s[4:5], 0x980
s_atomic_swap s37, s[4:5], 0xa00
s_atomic_swap s37, s[4:5], 0xa80
s_atomic_swap s37, s[4:5], 0xb00
s_atomic_swap s37, s[4:5], 0xb80
s_atomic_swap s37, s[4:5], 0xc00
s_atomic_swap s37, s[4:5], 0xc80
s_atomic_swap s37, s[4:5], 0xd00
s_atomic_swap s37, s[4:5], 0xd80
s_atomic_swap s37, s[4:5], 0xe00
s_atomic_swap s37, s[4:5], 0xe80
s_atomic_swap s37, s[4:5], 0xf00
s_atomic_swap s37, s[4:5], 0xf80
s_waitcnt lgkmcnt(0)
L_sg39:
s_cmp_lg_u32 s66, 0
s_cbranch_scc1 L_ph40
s_and_b32 s64, s2, 31
s_lshl_b32 s64, s64, 7
s_add_u32 s64, s64, 548864
s_add_u32 s90, s32, s64
s_addc_u32 s91, s33, 0
s_mov_b32 s64, s37
s_mov_b32 s65, s37
s_mov_b32 s92, 0
s_branch L_sp41
L_nok42:
s_add_u32 s92, s92, 1
s_cmp_ge_u32 s92, 200000
s_cbranch_scc1 L_ph40
s_sleep 10
L_sp41:
s_load_dwordx16 s[4:19], s[90:91], 0x0 glc
s_waitcnt lgkmcnt(0)
s_cmp_eq_u64 s[4:5], s[64:65]
s_cbranch_scc0 L_nok42
s_cmp_eq_u64 s[6:7], s[64:65]
s_cbranch_scc0 L_nok42
s_cmp_eq_u64 s[8:9], s[64:65]
s_cbranch_scc0 L_nok42
s_cmp_eq_u64 s[10:11], s[64:65]
s_cbranch_scc0 L_nok42
s_cmp_eq_u64 s[12:13], s[64:65]
s_cbranch_scc0 L_nok42
s_cmp_eq_u64 s[14:15], s[64:65]
s_cbranch_scc0 L_nok42
s_cmp_eq_u64 s[16:17], s[64:65]
s_cbranch_scc0 L_nok42
s_cmp_eq_u64 s[18:19], s[64:65]
s_cbranch_scc0 L_nok42
L_ph40:
v_mov_b32 v190, 9
s_mov_b64 exec, 1
ds_write_b32 v185, v190
s_mov_b64 exec, -1
L_lc43:
ds_read_b128 v[186:189], v184
s_waitcnt lgkmcnt(0)
v_min3_u32 v186, v186, v187, v188
v_min_u32 v186, v186, v189
s_nop 0
v_readfirstlane_b32 s92, v186
s_nop 0
s_cmp_ge_u32 s92, 9
s_cbranch_scc1 L_lcd44
s_sleep 1
s_branch L_lc43
L_lcd44:
s_setprio 0
v_add_u32 v191, -16, v184
L_lc45:
ds_read_b128 v[186:189], v191
s_waitcnt lgkmcnt(0)
v_min3_u32 v186, v186, v187, v188
v_min_u32 v186, v186, v189
s_nop 0
v_readfirstlane_b32 s92, v186
s_nop 0
s_cmp_ge_u32 s92, 11
s_cbranch_scc1 L_lcd46
s_sleep 1
s_branch L_lc45
L_lcd46:
s_mov_b32 m0, s68
s_nop 0
buffer_load_dwordx4 v7, s[44:47], 0 offen offset:0 sc1 lds
buffer_load_dwordx4 v7, s[44:47], 0 offen offset:1024 sc1 lds
buffer_load_dwordx4 v7, s[44:47], 0 offen offset:2048 sc1 lds
buffer_load_dwordx4 v7, s[44:47], 0 offen offset:3072 sc1 lds
s_waitcnt vmcnt(0)
v_mov_b32 v190, 10
s_mov_b64 exec, 1
ds_write_b32 v185, v190
s_mov_b64 exec, -1
L_lc47:
ds_read_b128 v[186:189], v184
s_waitcnt lgkmcnt(0)
v_min3_u32 v186, v186, v187, v188
v_min_u32 v186, v186, v189
s_nop 0
v_readfirstlane_b32 s92, v186
s_nop 0
s_cmp_ge_u32 s92, 10
s_cbranch_scc1 L_lcd48
s_sleep 1
s_branch L_lc47
L_lcd48:
ds_read_b32 v24, v4 offset:0
ds_read_b32 v25, v4 offset:1024
ds_read_b32 v26, v4 offset:2048
ds_read_b32 v27, v4 offset:3072
ds_read_b32 v28, v4 offset:8192
ds_read_b32 v29, v4 offset:9216
ds_read_b32 v30, v4 offset:10240
ds_read_b32 v31, v4 offset:11264
ds_read_b32 v32, v6 offset:0
ds_read_b32 v33, v5 offset:10240
ds_read_b32 v34, v5 offset:9216
ds_read_b32 v35, v5 offset:8192
ds_read_b32 v36, v5 offset:3072
ds_read_b32 v37, v5 offset:2048
ds_read_b32 v38, v5 offset:1024
ds_read_b32 v39, v5 offset:0
s_waitcnt lgkmcnt(0)
v_mfma_f32_32x32x16_bf16 v[40:55], v[24:27], v[192:195], 0
v_mfma_f32_32x32x16_bf16 v[40:55], v[28:31], v[196:199], v[40:55]
v_mfma_f32_32x32x16_bf16 v[40:55], v[32:35], v[200:203], v[40:55]
v_mfma_f32_32x32x16_bf16 v[40:55], v[36:39], v[204:207], v[40:55]
v_mfma_f32_32x32x16_bf16 v[56:71], v[24:27], v[208:211], 0
v_mfma_f32_32x32x16_bf16 v[56:71], v[28:31], v[212:215], v[56:71]
v_mfma_f32_32x32x16_bf16 v[56:71], v[32:35], v[216:219], v[56:71]
v_mfma_f32_32x32x16_bf16 v[56:71], v[36:39], v[220:223], v[56:71]
s_nop 7
v_mul_f32 v168, v40, v224
v_mul_f32 v169, v40, v240
s_nop 1
v_fma_f32 v168, -v56, v240, v168
v_fmac_f32 v169, v56, v224
v_cvt_pk_bf16_f32 v24, v168, v169
v_mul_f32 v170, v41, v225
v_mul_f32 v171, v41, v241
v_fma_f32 v170, -v57, v241, v170
v_fmac_f32 v171, v57, v225
v_cvt_pk_bf16_f32 v25, v170, v171
v_mul_f32 v172, v42, v226
v_mul_f32 v173, v42, v242
v_fma_f32 v172, -v58, v242, v172
v_fmac_f32 v173, v58, v226
v_cvt_pk_bf16_f32 v26, v172, v173
v_mul_f32 v174, v43, v227
v_mul_f32 v175, v43, v243
v_fma_f32 v174, -v59, v243, v174
v_fmac_f32 v175, v59, v227
v_cvt_pk_bf16_f32 v27, v174, v175
v_mul_f32 v168, v44, v228
v_mul_f32 v169, v44, v244
v_fma_f32 v168, -v60, v244, v168
v_fmac_f32 v169, v60, v228
v_cvt_pk_bf16_f32 v28, v168, v169
v_mul_f32 v170, v45, v229
v_mul_f32 v171, v45, v245
v_fma_f32 v170, -v61, v245, v170
v_fmac_f32 v171, v61, v229
v_cvt_pk_bf16_f32 v29, v170, v171
v_mul_f32 v172, v46, v230
v_mul_f32 v173, v46, v246
v_fma_f32 v172, -v62, v246, v172
v_fmac_f32 v173, v62, v230
v_cvt_pk_bf16_f32 v30, v172, v173
v_mul_f32 v174, v47, v231
v_mul_f32 v175, v47, v247
v_fma_f32 v174, -v63, v247, v174
v_fmac_f32 v175, v63, v231
v_cvt_pk_bf16_f32 v31, v174, v175
v_mul_f32 v168, v48, v232
v_mul_f32 v169, v48, v248
v_fma_f32 v168, -v64, v248, v168
v_fmac_f32 v169, v64, v232
v_cvt_pk_bf16_f32 v32, v168, v169
v_mul_f32 v170, v49, v233
v_mul_f32 v171, v49, v249
v_fma_f32 v170, -v65, v249, v170
v_fmac_f32 v171, v65, v233
v_cvt_pk_bf16_f32 v33, v170, v171
v_mul_f32 v172, v50, v234
v_mul_f32 v173, v50, v250
v_fma_f32 v172, -v66, v250, v172
v_fmac_f32 v173, v66, v234
v_cvt_pk_bf16_f32 v34, v172, v173
v_mul_f32 v174, v51, v235
v_mul_f32 v175, v51, v251
v_fma_f32 v174, -v67, v251, v174
v_fmac_f32 v175, v67, v235
v_cvt_pk_bf16_f32 v35, v174, v175
v_mul_f32 v168, v52, v236
v_mul_f32 v169, v52, v252
v_fma_f32 v168, -v68, v252, v168
v_fmac_f32 v169, v68, v236
v_cvt_pk_bf16_f32 v36, v168, v169
v_mul_f32 v170, v53, v237
v_mul_f32 v171, v53, v253
v_fma_f32 v170, -v69, v253, v170
v_fmac_f32 v171, v69, v237
v_cvt_pk_bf16_f32 v37, v170, v171
v_mul_f32 v172, v54, v238
v_mul_f32 v173, v54, v254
v_fma_f32 v172, -v70, v254, v172
v_fmac_f32 v173, v70, v238
v_cvt_pk_bf16_f32 v38, v172, v173
v_mul_f32 v174, v55, v239
v_mul_f32 v175, v55, v255
v_fma_f32 v174, -v71, v255, v174
v_fmac_f32 v175, v71, v239
v_cvt_pk_bf16_f32 v39, v174, v175
v_mfma_f32_32x32x16_bf16 v[40:55], v[192:195], v[24:27], 0
v_mfma_f32_32x32x16_bf16 v[40:55], v[196:199], v[28:31], v[40:55]
v_mfma_f32_32x32x16_bf16 v[40:55], v[200:203], v[32:35], v[40:55]
v_mfma_f32_32x32x16_bf16 v[40:55], v[204:207], v[36:39], v[40:55]
v_mfma_f32_32x32x16_bf16 v[56:71], v[208:211], v[24:27], 0
v_mfma_f32_32x32x16_bf16 v[56:71], v[212:215], v[28:31], v[56:71]
v_mfma_f32_32x32x16_bf16 v[56:71], v[216:219], v[32:35], v[56:71]
v_mfma_f32_32x32x16_bf16 v[56:71], v[220:223], v[36:39], v[56:71]
s_movk_i32 s64, 0x2000
s_nop 10
v_cvt_pk_bf16_f32 v73, v56, v40
v_lshlrev_b32 v72, 16, v73
v_and_b32 v73, 0xffff0000, v73
buffer_store_dword v72, v14, s[40:43], 0 offen offset:0 nt
buffer_store_dword v73, v14, s[40:43], s64 offen offset:0 nt
v_cvt_pk_bf16_f32 v75, v57, v41
v_lshlrev_b32 v74, 16, v75
v_and_b32 v75, 0xffff0000, v75
buffer_store_dword v74, v14, s[40:43], 0 offen offset:128 nt
buffer_store_dword v75, v14, s[40:43], s64 offen offset:128 nt
v_cvt_pk_bf16_f32 v77, v58, v42
v_lshlrev_b32 v76, 16, v77
v_and_b32 v77, 0xffff0000, v77
buffer_store_dword v76, v14, s[40:43], 0 offen offset:256 nt
buffer_store_dword v77, v14, s[40:43], s64 offen offset:256 nt
v_cvt_pk_bf16_f32 v79, v59, v43
v_lshlrev_b32 v78, 16, v79
v_and_b32 v79, 0xffff0000, v79
buffer_store_dword v78, v14, s[40:43], 0 offen offset:384 nt
buffer_store_dword v79, v14, s[40:43], s64 offen offset:384 nt
v_cvt_pk_bf16_f32 v81, v60, v44
v_lshlrev_b32 v80, 16, v81
v_and_b32 v81, 0xffff0000, v81
buffer_store_dword v80, v14, s[40:43], 0 offen offset:1024 nt
buffer_store_dword v81, v14, s[40:43], s64 offen offset:1024 nt
v_cvt_pk_bf16_f32 v83, v61, v45
v_lshlrev_b32 v82, 16, v83
v_and_b32 v83, 0xffff0000, v83
buffer_store_dword v82, v14, s[40:43], 0 offen offset:1152 nt
buffer_store_dword v83, v14, s[40:43], s64 offen offset:1152 nt
v_cvt_pk_bf16_f32 v85, v62, v46
v_lshlrev_b32 v84, 16, v85
v_and_b32 v85, 0xffff0000, v85
buffer_store_dword v84, v14, s[40:43], 0 offen offset:1280 nt
buffer_store_dword v85, v14, s[40:43], s64 offen offset:1280 nt
v_cvt_pk_bf16_f32 v87, v63, v47
v_lshlrev_b32 v86, 16, v87
v_and_b32 v87, 0xffff0000, v87
buffer_store_dword v86, v14, s[40:43], 0 offen offset:1408 nt
buffer_store_dword v87, v14, s[40:43], s64 offen offset:1408 nt
v_cvt_pk_bf16_f32 v89, v64, v48
v_lshlrev_b32 v88, 16, v89
v_and_b32 v89, 0xffff0000, v89
buffer_store_dword v88, v14, s[40:43], 0 offen offset:2048 nt
buffer_store_dword v89, v14, s[40:43], s64 offen offset:2048 nt
v_cvt_pk_bf16_f32 v91, v65, v49
v_lshlrev_b32 v90, 16, v91
v_and_b32 v91, 0xffff0000, v91
buffer_store_dword v90, v14, s[40:43], 0 offen offset:2176 nt
buffer_store_dword v91, v14, s[40:43], s64 offen offset:2176 nt
v_cvt_pk_bf16_f32 v93, v66, v50
v_lshlrev_b32 v92, 16, v93
v_and_b32 v93, 0xffff0000, v93
buffer_store_dword v92, v14, s[40:43], 0 offen offset:2304 nt
buffer_store_dword v93, v14, s[40:43], s64 offen offset:2304 nt
v_cvt_pk_bf16_f32 v95, v67, v51
v_lshlrev_b32 v94, 16, v95
v_and_b32 v95, 0xffff0000, v95
buffer_store_dword v94, v14, s[40:43], 0 offen offset:2432 nt
buffer_store_dword v95, v14, s[40:43], s64 offen offset:2432 nt
v_cvt_pk_bf16_f32 v97, v68, v52
v_lshlrev_b32 v96, 16, v97
v_and_b32 v97, 0xffff0000, v97
buffer_store_dword v96, v14, s[40:43], 0 offen offset:3072 nt
buffer_store_dword v97, v14, s[40:43], s64 offen offset:3072 nt
v_cvt_pk_bf16_f32 v99, v69, v53
v_lshlrev_b32 v98, 16, v99
v_and_b32 v99, 0xffff0000, v99
buffer_store_dword v98, v14, s[40:43], 0 offen offset:3200 nt
buffer_store_dword v99, v14, s[40:43], s64 offen offset:3200 nt
v_cvt_pk_bf16_f32 v101, v70, v54
v_lshlrev_b32 v100, 16, v101
v_and_b32 v101, 0xffff0000, v101
buffer_store_dword v100, v14, s[40:43], 0 offen offset:3328 nt
buffer_store_dword v101, v14, s[40:43], s64 offen offset:3328 nt
v_cvt_pk_bf16_f32 v103, v71, v55
v_lshlrev_b32 v102, 16, v103
v_and_b32 v103, 0xffff0000, v103
buffer_store_dword v102, v14, s[40:43], 0 offen offset:3456 nt
buffer_store_dword v103, v14, s[40:43], s64 offen offset:3456 nt
s_endpgm
L_concat_heads__spectral_gfnet__ssm_conv_s5__prompt_kernel_gemm:
s_lshr_b32 s68, s34, 1
s_and_b32 s66, s34, 1
s_lshr_b32 s101, s36, 3
v_and_b32 v6, 31, v1
v_lshrrev_b32 v5, 5, v1
v_lshlrev_b32 v11, 4, v1
v_mov_b64 v[64:65], 0
v_mov_b64 v[66:67], 0
s_mul_i32 s60, s34, 2304
s_add_u32 s60, s60, 114688
v_add_u32 v13, s60, v11
v_mov_b32 v12, 126976
ds_write_b128 v13, v[64:67]
ds_write_b128 v13, v[64:67] offset:1024
ds_write_b128 v13, v[64:67] offset:2048
s_mov_b64 exec, 1
ds_write_b128 v12, v[64:67]
ds_write_b128 v12, v[64:67] offset:16
ds_write_b128 v12, v[64:67] offset:32
ds_write_b128 v12, v[64:67] offset:48
ds_write_b128 v12, v[64:67] offset:64
s_mov_b64 exec, -1
s_lshl_b32 s60, s34, 2
v_add_u32 v13, s60, v12
s_waitcnt lgkmcnt(0)
s_barrier
v_bfe_u32 v4, v1, 2, 2
v_lshlrev_b32 v4, 3, v4
v_and_b32 v7, 3, v1
v_add_u32 v4, v4, v7
s_lshl_b32 s60, s36, 6
s_lshl_b32 s61, s66, 5
s_add_u32 s60, s60, s61
v_add_u32 v4, s60, v4
v_lshlrev_b32 v7, 1, v4
v_lshrrev_b32 v14, 5, v1
v_bfe_u32 v15, v1, 3, 2
v_and_b32 v16, 1, v15
v_lshrrev_b32 v17, 1, v15
v_lshlrev_b32 v18, 4, v14
v_lshl_add_u32 v18, v16, 3, v18
v_add_u32 v18, v18, v17
s_lshl_b32 s61, s68, 6
s_lshl_b32 s62, s66, 2
s_add_u32 s61, s61, s62
v_add_u32 v18, s61, v18
v_lshlrev_b32 v18, 11, v18
s_lshl_b32 s61, s68, 5
v_lshl_add_u32 v19, v14, 3, v15
v_add_u32 v19, s61, v19
v_lshlrev_b32 v19, 11, v19
v_and_b32 v16, 7, v1
v_lshrrev_b32 v17, 4, v1
v_xor_b32 v16, v16, v17
v_lshlrev_b32 v16, 4, v16
v_xor_b32 v17, 64, v16
v_add_u32 v244, v18, v16
v_add_u32 v245, v18, v17
v_add_u32 v245, 64512, v245
v_add_u32 v246, v19, v16
v_add_u32 v247, v19, v17
v_add_u32 v247, 31744, v247
s_bfe_u32 s38, s2, 0x20001
s_lshl_b32 s38, s38, 2
s_lshr_b32 s60, s2, 6
s_add_u32 s38, s38, s60
s_mul_i32 s38, s38, 128
s_mul_i32 s60, s36, 128
s_add_u32 s38, s38, s60
s_bfe_u32 s60, s38, 0x30007
s_cmp_eq_u32 s60, 3
s_cselect_b32 s60, 128, 0
s_add_u32 s38, s38, s60
s_lshl_b32 s60, s35, 18
s_lshl_b32 s61, s36, 17
s_lshl_b32 s39, s34, 12
s_waitcnt lgkmcnt(0)
global_load_ushort v248, v7, s[12:13] offset:0
global_load_ushort v249, v7, s[14:15] offset:0
global_load_ushort v250, v7, s[24:25] offset:0
global_load_ushort v251, v7, s[12:13] offset:8
global_load_ushort v252, v7, s[14:15] offset:8
global_load_ushort v253, v7, s[24:25] offset:8
s_add_u32 s48, s10, s60
s_addc_u32 s49, s11, 0
s_mov_b32 s50, 262144
s_mov_b32 s51, 0x20000
s_cmp_eq_u32 s66, 1
s_cselect_b32 s62, s18, s16
s_cselect_b32 s63, s19, s17
s_add_u32 s52, s62, s61
s_addc_u32 s53, s63, 0
s_mov_b32 s54, 131072
s_mov_b32 s55, 0x20000
s_add_u32 s62, s38, 0
s_and_b32 s62, s62, 0x7ff
s_add_u32 s63, s62, 2048
s_add_u32 s64, s62, 6144
s_add_u32 m0, s39, 0
s_nop 0
buffer_load_dwordx4 v244, s[48:51], s62 offen offset:0 lds
buffer_load_dwordx4 v245, s[48:51], s62 offen offset:1024 lds
buffer_load_dwordx4 v244, s[48:51], s63 offen offset:2048 lds
buffer_load_dwordx4 v245, s[48:51], s63 offen offset:3072 lds
s_add_u32 m0, s39, 16384
s_nop 0
buffer_load_dwordx4 v246, s[52:55], s62 offen offset:0 lds
buffer_load_dwordx4 v247, s[52:55], s62 offen offset:1024 lds
buffer_load_dwordx4 v246, s[52:55], s64 offen offset:2048 lds
buffer_load_dwordx4 v247, s[52:55], s64 offen offset:3072 lds
v_bfe_u32 v7, v1, 4, 1
v_lshl_add_u32 v4, v7, 2, v4
v_bfe_u32 v7, v6, 1, 3
v_xor_b32 v7, v7, v5
v_lshlrev_b32 v7, 4, v7
v_lshl_add_u32 v7, v6, 7, v7
v_and_b32 v8, 15, v1
v_lshrrev_b32 v9, 4, v1
v_lshrrev_b32 v14, 1, v8
v_xor_b32 v14, v14, v9
v_lshlrev_b32 v14, 4, v14
v_lshl_add_u32 v14, v8, 7, v14
s_lshl_b32 s60, s68, 13
s_lshl_b32 s61, s66, 13
s_add_u32 s61, s61, 16384
v_xor_b32 v15, 0, v14
v_add_u32 v128, s60, v15
v_add_u32 v130, s61, v15
v_add_u32 v132, 0x10000, v128
v_add_u32 v134, 0x10000, v130
v_xor_b32 v15, 64, v14
v_add_u32 v129, s60, v15
v_add_u32 v131, s61, v15
v_add_u32 v133, 0x10000, v129
v_add_u32 v135, 0x10000, v131
s_add_u32 s40, s32, 65536
s_addc_u32 s41, s33, 0
s_mov_b32 s42, 262144
s_mov_b32 s43, 0x20000
s_add_u32 s44, s32, 1048576
s_addc_u32 s45, s33, 0
s_mov_b32 s46, 8388608
s_mov_b32 s47, 0x20000
s_mul_i32 s60, s66, 4608
s_add_u32 s60, s60, 114752
s_lshl_b32 s61, s68, 5
s_add_u32 s61, s61, s60
v_mul_u32_u24 v14, 144, v6
v_add_u32 v14, s60, v14
v_lshl_add_u32 v14, v5, 5, v14
v_mul_u32_u24 v15, 144, v8
v_add_u32 v15, s61, v15
v_lshl_add_u32 v15, v9, 3, v15
s_lshl_b32 s60, s35, 14
v_lshl_add_u32 v16, v4, 4, s60
v_mov_b32 v17, 0x40000000
v_lshlrev_b32 v10, 14, v5
v_sub_u32 v10, v16, v10
v_subrev_u32 v136, 16384, v10
v_cmp_le_i32 vcc, 0, v136
s_nop 1
v_cndmask_b32 v136, v17, v136, vcc
v_subrev_u32 v137, 49152, v10
v_cmp_le_i32 vcc, 0, v137
s_nop 1
v_cndmask_b32 v137, v17, v137, vcc
v_subrev_u32 v138, 81920, v10
v_cmp_le_i32 vcc, 0, v138
s_nop 1
v_cndmask_b32 v138, v17, v138, vcc
v_subrev_u32 v139, 114688, v10
v_cmp_le_i32 vcc, 0, v139
s_nop 1
v_cndmask_b32 v139, v17, v139, vcc
v_subrev_u32 v140, 147456, v10
v_cmp_le_i32 vcc, 0, v140
s_nop 1
v_cndmask_b32 v140, v17, v140, vcc
v_subrev_u32 v141, 180224, v10
v_cmp_le_i32 vcc, 0, v141
s_nop 1
v_cndmask_b32 v141, v17, v141, vcc
v_subrev_u32 v142, 212992, v10
v_cmp_le_i32 vcc, 0, v142
s_nop 1
v_cndmask_b32 v142, v17, v142, vcc
v_subrev_u32 v143, 245760, v10
v_cmp_le_i32 vcc, 0, v143
s_nop 1
v_cndmask_b32 v143, v17, v143, vcc
v_lshlrev_b32 v17, 30, v5
v_or_b32 v16, v16, v17
s_lshl_b32 s60, s35, 11
s_add_u32 s60, s60, 32768
s_lshl_b32 s61, s36, 7
s_add_u32 s61, s61, s60
v_mov_b32 v195, s61
s_lshl_b32 s61, s101, 10
s_add_u32 s60, s60, s61
v_and_b32 v196, 7, v1
v_lshl_add_u32 v196, v196, 7, s60
s_lshl_b32 s60, s35, 1
s_add_u32 s60, s60, s68
s_lshl_b32 s60, s60, 12
s_add_u32 s60, s60, 393216
s_lshl_b32 s61, s101, 11
s_add_u32 s61, s61, s60
v_lshl_add_u32 v18, v8, 7, s61
s_lshl_b32 s61, s36, 8
s_add_u32 s60, s60, s61
s_lshl_b32 s61, s66, 7
s_add_u32 s60, s60, s61
v_mov_b32 v19, s60
v_lshrrev_b32 v10, 1, v9
v_lshlrev_b32 v10, 10, v10
v_and_b32 v17, 1, v9
v_lshl_add_u32 v10, v17, 9, v10
v_lshl_add_u32 v10, v8, 4, v10
s_lshl_b32 s60, s68, 2
v_add_u32 v9, s60, v9
v_cvt_f32_u32 v9, v9
v_mul_f32 v9, 0x41800000, v9
v_add_f32 v8, 0x41000000, v9
s_add_u32 s62, s38, 128
s_and_b32 s62, s62, 0x7ff
s_add_u32 s63, s62, 2048
s_add_u32 s64, s62, 6144
s_add_u32 m0, s39, 32768
s_nop 0
buffer_load_dwordx4 v244, s[48:51], s62 offen offset:0 lds
buffer_load_dwordx4 v245, s[48:51], s62 offen offset:1024 lds
buffer_load_dwordx4 v244, s[48:51], s63 offen offset:2048 lds
buffer_load_dwordx4 v245, s[48:51], s63 offen offset:3072 lds
s_add_u32 m0, s39, 49152
s_nop 0
buffer_load_dwordx4 v246, s[52:55], s62 offen offset:0 lds
buffer_load_dwordx4 v247, s[52:55], s62 offen offset:1024 lds
buffer_load_dwordx4 v246, s[52:55], s64 offen offset:2048 lds
buffer_load_dwordx4 v247, s[52:55], s64 offen offset:3072 lds
s_setprio 1
s_waitcnt vmcnt(8)
s_barrier
ds_read_b128 v[32:35], v128 offset:0
ds_read_b128 v[48:51], v130 offset:0
ds_read_b128 v[52:55], v130 offset:2048
ds_read_b128 v[56:59], v130 offset:4096
ds_read_b128 v[60:63], v130 offset:6144
ds_read_b128 v[36:39], v128 offset:2048
ds_read_b128 v[40:43], v128 offset:4096
ds_read_b128 v[44:47], v128 offset:6144
s_waitcnt lgkmcnt(6)
v_mfma_f32_16x16x32_bf16 v[64:67], v[32:35], v[48:51], 0
ds_read_b128 v[144:147], v129 offset:0
s_waitcnt lgkmcnt(6)
v_mfma_f32_16x16x32_bf16 v[96:99], v[32:35], v[52:55], 0
ds_read_b128 v[160:163], v131 offset:0
s_waitcnt lgkmcnt(6)
v_mfma_f32_16x16x32_bf16 v[80:83], v[32:35], v[56:59], 0
ds_read_b128 v[164:167], v131 offset:2048
s_waitcnt lgkmcnt(6)
v_mfma_f32_16x16x32_bf16 v[112:115], v[32:35], v[60:63], 0
ds_read_b128 v[168:171], v131 offset:4096
s_waitcnt lgkmcnt(6)
v_mfma_f32_16x16x32_bf16 v[68:71], v[36:39], v[48:51], 0
ds_read_b128 v[172:175], v131 offset:6144
v_mfma_f32_16x16x32_bf16 v[100:103], v[36:39], v[52:55], 0
ds_read_b128 v[148:151], v129 offset:2048
v_mfma_f32_16x16x32_bf16 v[84:87], v[36:39], v[56:59], 0
ds_read_b128 v[152:155], v129 offset:4096
v_mfma_f32_16x16x32_bf16 v[116:119], v[36:39], v[60:63], 0
ds_read_b128 v[156:159], v129 offset:6144
s_waitcnt lgkmcnt(9)
v_mfma_f32_16x16x32_bf16 v[72:75], v[40:43], v[48:51], 0
v_lshlrev_b32 v248, 16, v248
v_lshlrev_b32 v249, 16, v249
v_mfma_f32_16x16x32_bf16 v[104:107], v[40:43], v[52:55], 0
v_lshlrev_b32 v250, 16, v250
v_mul_f32 v250, 0x3fb8aa3b, v250
v_mfma_f32_16x16x32_bf16 v[88:91], v[40:43], v[56:59], 0
v_exp_f32 v250, v250
s_nop 0
v_cvt_pk_bf16_f32 v250, v250, v250
v_mfma_f32_16x16x32_bf16 v[120:123], v[40:43], v[60:63], 0
v_lshlrev_b32 v250, 16, v250
v_mul_f32 v204, v250, v248
s_waitcnt lgkmcnt(8)
v_mfma_f32_16x16x32_bf16 v[76:79], v[44:47], v[48:51], 0
v_mul_f32 v206, v250, v249
v_mul_f32 v204, 0x3fb8aa3b, v204
v_mfma_f32_16x16x32_bf16 v[108:111], v[44:47], v[52:55], 0
v_mul_f32 v206, 0.15915494, v206
v_mul_f32 v197, 0x3f800000, v204
v_mfma_f32_16x16x32_bf16 v[92:95], v[44:47], v[56:59], 0
v_mul_f32 v198, 0x3f800000, v206
v_exp_f32 v197, v197
v_mfma_f32_16x16x32_bf16 v[124:127], v[44:47], v[60:63], 0
v_rndne_f32 v199, v198
v_sub_f32 v198, v198, v199
s_waitcnt vmcnt(0) lgkmcnt(0)
s_barrier
v_mfma_f32_16x16x32_bf16 v[64:67], v[144:147], v[160:163], v[64:67]
ds_read_b128 v[32:35], v128 offset:32768
v_mfma_f32_16x16x32_bf16 v[96:99], v[144:147], v[164:167], v[96:99]
ds_read_b128 v[48:51], v130 offset:32768
v_mfma_f32_16x16x32_bf16 v[80:83], v[144:147], v[168:171], v[80:83]
ds_read_b128 v[52:55], v130 offset:34816
v_mfma_f32_16x16x32_bf16 v[112:115], v[144:147], v[172:175], v[112:115]
ds_read_b128 v[56:59], v130 offset:36864
v_mfma_f32_16x16x32_bf16 v[68:71], v[148:151], v[160:163], v[68:71]
ds_read_b128 v[60:63], v130 offset:38912
v_mfma_f32_16x16x32_bf16 v[100:103], v[148:151], v[164:167], v[100:103]
ds_read_b128 v[36:39], v128 offset:34816
v_mfma_f32_16x16x32_bf16 v[84:87], v[148:151], v[168:171], v[84:87]
ds_read_b128 v[40:43], v128 offset:36864
v_mfma_f32_16x16x32_bf16 v[116:119], v[148:151], v[172:175], v[116:119]
ds_read_b128 v[44:47], v128 offset:38912
v_mfma_f32_16x16x32_bf16 v[72:75], v[152:155], v[160:163], v[72:75]
v_cos_f32 v199, v198
v_sin_f32 v198, v198
v_mfma_f32_16x16x32_bf16 v[104:107], v[152:155], v[164:167], v[104:107]
v_mul_f32 v20, v197, v199
v_mul_f32 v21, v197, v198
v_mfma_f32_16x16x32_bf16 v[88:91], v[152:155], v[168:171], v[88:91]
v_add_f32 v197, -1.0, v20
v_mul_f32 v198, v248, v248
v_mfma_f32_16x16x32_bf16 v[120:123], v[152:155], v[172:175], v[120:123]
v_fma_f32 v198, v249, v249, v198
v_rcp_f32 v198, v198
v_mfma_f32_16x16x32_bf16 v[76:79], v[156:159], v[160:163], v[76:79]
v_add_f32 v198, v198, v198
v_mul_f32 v199, v197, v248
v_mfma_f32_16x16x32_bf16 v[108:111], v[156:159], v[164:167], v[108:111]
v_fma_f32 v199, v21, v249, v199
v_mul_f32 v24, v199, v198
v_mfma_f32_16x16x32_bf16 v[92:95], v[156:159], v[168:171], v[92:95]
v_mul_f32 v199, v21, v248
v_fma_f32 v199, -v197, v249, v199
v_mfma_f32_16x16x32_bf16 v[124:127], v[156:159], v[172:175], v[124:127]
v_mul_f32 v25, v199, v198
v_mul_f32 v197, 0x41000000, v204
s_waitcnt lgkmcnt(6)
v_mfma_f32_16x16x32_bf16 v[64:67], v[32:35], v[48:51], v[64:67]
ds_read_b128 v[144:147], v129 offset:32768
s_waitcnt lgkmcnt(6)
v_mfma_f32_16x16x32_bf16 v[96:99], v[32:35], v[52:55], v[96:99]
ds_read_b128 v[160:163], v131 offset:32768
s_waitcnt lgkmcnt(6)
v_mfma_f32_16x16x32_bf16 v[80:83], v[32:35], v[56:59], v[80:83]
ds_read_b128 v[164:167], v131 offset:34816
s_waitcnt lgkmcnt(6)
v_mfma_f32_16x16x32_bf16 v[112:115], v[32:35], v[60:63], v[112:115]
ds_read_b128 v[168:171], v131 offset:36864
s_waitcnt lgkmcnt(6)
v_mfma_f32_16x16x32_bf16 v[68:71], v[36:39], v[48:51], v[68:71]
ds_read_b128 v[172:175], v131 offset:38912
v_mfma_f32_16x16x32_bf16 v[100:103], v[36:39], v[52:55], v[100:103]
ds_read_b128 v[148:151], v129 offset:34816
v_mfma_f32_16x16x32_bf16 v[84:87], v[36:39], v[56:59], v[84:87]
ds_read_b128 v[152:155], v129 offset:36864
v_mfma_f32_16x16x32_bf16 v[116:119], v[36:39], v[60:63], v[116:119]
ds_read_b128 v[156:159], v129 offset:38912
s_waitcnt lgkmcnt(9)
v_mfma_f32_16x16x32_bf16 v[72:75], v[40:43], v[48:51], v[72:75]
v_mul_f32 v198, 0x41000000, v206
v_exp_f32 v197, v197
v_mfma_f32_16x16x32_bf16 v[104:107], v[40:43], v[52:55], v[104:107]
v_rndne_f32 v199, v198
v_sub_f32 v198, v198, v199
v_mfma_f32_16x16x32_bf16 v[88:91], v[40:43], v[56:59], v[88:91]
v_cos_f32 v199, v198
v_sin_f32 v198, v198
v_mfma_f32_16x16x32_bf16 v[120:123], v[40:43], v[60:63], v[120:123]
v_mul_f32 v176, v197, v199
v_mul_f32 v177, v197, v198
s_waitcnt lgkmcnt(8)
v_mfma_f32_16x16x32_bf16 v[76:79], v[44:47], v[48:51], v[76:79]
v_mul_f32 v197, 0x41800000, v204
v_mul_f32 v198, 0x41800000, v206
v_mfma_f32_16x16x32_bf16 v[108:111], v[44:47], v[52:55], v[108:111]
v_exp_f32 v197, v197
v_rndne_f32 v199, v198
v_mfma_f32_16x16x32_bf16 v[92:95], v[44:47], v[56:59], v[92:95]
v_sub_f32 v198, v198, v199
v_cos_f32 v199, v198
v_mfma_f32_16x16x32_bf16 v[124:127], v[44:47], v[60:63], v[124:127]
v_sin_f32 v198, v198
v_mul_f32 v180, v197, v199
s_waitcnt lgkmcnt(0)
s_barrier
v_mfma_f32_16x16x32_bf16 v[64:67], v[144:147], v[160:163], v[64:67]
ds_read_b128 v[32:35], v132 offset:0
v_mfma_f32_16x16x32_bf16 v[96:99], v[144:147], v[164:167], v[96:99]
ds_read_b128 v[48:51], v134 offset:0
v_mfma_f32_16x16x32_bf16 v[80:83], v[144:147], v[168:171], v[80:83]
ds_read_b128 v[52:55], v134 offset:2048
v_mfma_f32_16x16x32_bf16 v[112:115], v[144:147], v[172:175], v[112:115]
ds_read_b128 v[56:59], v134 offset:4096
v_mfma_f32_16x16x32_bf16 v[68:71], v[148:151], v[160:163], v[68:71]
ds_read_b128 v[60:63], v134 offset:6144
v_mfma_f32_16x16x32_bf16 v[100:103], v[148:151], v[164:167], v[100:103]
ds_read_b128 v[36:39], v132 offset:2048
v_mfma_f32_16x16x32_bf16 v[84:87], v[148:151], v[168:171], v[84:87]
ds_read_b128 v[40:43], v132 offset:4096
v_mfma_f32_16x16x32_bf16 v[116:119], v[148:151], v[172:175], v[116:119]
ds_read_b128 v[44:47], v132 offset:6144
v_mfma_f32_16x16x32_bf16 v[72:75], v[152:155], v[160:163], v[72:75]
v_mul_f32 v181, v197, v198
v_mul_f32 v197, v9, v204
v_mfma_f32_16x16x32_bf16 v[104:107], v[152:155], v[164:167], v[104:107]
v_mul_f32 v198, v9, v206
v_exp_f32 v197, v197
v_mfma_f32_16x16x32_bf16 v[88:91], v[152:155], v[168:171], v[88:91]
v_rndne_f32 v199, v198
v_sub_f32 v198, v198, v199
v_mfma_f32_16x16x32_bf16 v[120:123], v[152:155], v[172:175], v[120:123]
v_cos_f32 v199, v198
v_sin_f32 v198, v198
v_mfma_f32_16x16x32_bf16 v[76:79], v[156:159], v[160:163], v[76:79]
v_mul_f32 v200, v197, v199
v_mul_f32 v201, v197, v198
v_mfma_f32_16x16x32_bf16 v[108:111], v[156:159], v[164:167], v[108:111]
v_mov_b32 v184, v200
v_mov_b32 v186, v201
v_mfma_f32_16x16x32_bf16 v[92:95], v[156:159], v[168:171], v[92:95]
v_mul_f32 v197, v8, v204
v_mul_f32 v198, v8, v206
v_mfma_f32_16x16x32_bf16 v[124:127], v[156:159], v[172:175], v[124:127]
v_exp_f32 v197, v197
v_rndne_f32 v199, v198
s_waitcnt lgkmcnt(6)
v_mfma_f32_16x16x32_bf16 v[64:67], v[32:35], v[48:51], v[64:67]
ds_read_b128 v[144:147], v133 offset:0
s_waitcnt lgkmcnt(6)
v_mfma_f32_16x16x32_bf16 v[96:99], v[32:35], v[52:55], v[96:99]
ds_read_b128 v[160:163], v135 offset:0
s_waitcnt lgkmcnt(6)
v_mfma_f32_16x16x32_bf16 v[80:83], v[32:35], v[56:59], v[80:83]
ds_read_b128 v[164:167], v135 offset:2048
s_waitcnt lgkmcnt(6)
v_mfma_f32_16x16x32_bf16 v[112:115], v[32:35], v[60:63], v[112:115]
ds_read_b128 v[168:171], v135 offset:4096
s_waitcnt lgkmcnt(6)
v_mfma_f32_16x16x32_bf16 v[68:71], v[36:39], v[48:51], v[68:71]
ds_read_b128 v[172:175], v135 offset:6144
v_mfma_f32_16x16x32_bf16 v[100:103], v[36:39], v[52:55], v[100:103]
ds_read_b128 v[148:151], v133 offset:2048
v_mfma_f32_16x16x32_bf16 v[84:87], v[36:39], v[56:59], v[84:87]
ds_read_b128 v[152:155], v133 offset:4096
v_mfma_f32_16x16x32_bf16 v[116:119], v[36:39], v[60:63], v[116:119]
ds_read_b128 v[156:159], v133 offset:6144
s_waitcnt lgkmcnt(9)
v_mfma_f32_16x16x32_bf16 v[72:75], v[40:43], v[48:51], v[72:75]
v_sub_f32 v198, v198, v199
v_cos_f32 v199, v198
v_mfma_f32_16x16x32_bf16 v[104:107], v[40:43], v[52:55], v[104:107]
v_sin_f32 v198, v198
v_mul_f32 v200, v197, v199
v_mfma_f32_16x16x32_bf16 v[88:91], v[40:43], v[56:59], v[88:91]
v_mul_f32 v201, v197, v198
v_mov_b32 v185, v200
v_mfma_f32_16x16x32_bf16 v[120:123], v[40:43], v[60:63], v[120:123]
v_mov_b32 v187, v201
v_mul_f32 v197, v25, v21
s_waitcnt lgkmcnt(8)
v_mfma_f32_16x16x32_bf16 v[76:79], v[44:47], v[48:51], v[76:79]
v_mul_f32 v198, v25, v20
v_fma_f32 v208, v24, v20, -v197
v_mfma_f32_16x16x32_bf16 v[108:111], v[44:47], v[52:55], v[108:111]
v_fma_f32 v209, v24, v21, v198
v_mul_f32 v197, v209, v21
v_mfma_f32_16x16x32_bf16 v[92:95], v[44:47], v[56:59], v[92:95]
v_mul_f32 v198, v209, v20
v_fma_f32 v210, v208, v20, -v197
v_mfma_f32_16x16x32_bf16 v[124:127], v[44:47], v[60:63], v[124:127]
v_fma_f32 v211, v208, v21, v198
v_mul_f32 v197, v211, v21
s_waitcnt lgkmcnt(0)
s_barrier
v_mfma_f32_16x16x32_bf16 v[64:67], v[144:147], v[160:163], v[64:67]
ds_read_b128 v[32:35], v128 offset:0
v_mfma_f32_16x16x32_bf16 v[96:99], v[144:147], v[164:167], v[96:99]
ds_read_b128 v[48:51], v130 offset:0
v_mfma_f32_16x16x32_bf16 v[80:83], v[144:147], v[168:171], v[80:83]
ds_read_b128 v[52:55], v130 offset:2048
v_mfma_f32_16x16x32_bf16 v[112:115], v[144:147], v[172:175], v[112:115]
ds_read_b128 v[56:59], v130 offset:4096
v_mfma_f32_16x16x32_bf16 v[68:71], v[148:151], v[160:163], v[68:71]
ds_read_b128 v[60:63], v130 offset:6144
v_mfma_f32_16x16x32_bf16 v[100:103], v[148:151], v[164:167], v[100:103]
ds_read_b128 v[36:39], v128 offset:2048
v_mfma_f32_16x16x32_bf16 v[84:87], v[148:151], v[168:171], v[84:87]
ds_read_b128 v[40:43], v128 offset:4096
v_mfma_f32_16x16x32_bf16 v[116:119], v[148:151], v[172:175], v[116:119]
ds_read_b128 v[44:47], v128 offset:6144
v_mfma_f32_16x16x32_bf16 v[72:75], v[152:155], v[160:163], v[72:75]
v_mul_f32 v198, v211, v20
v_fma_f32 v212, v210, v20, -v197
v_mfma_f32_16x16x32_bf16 v[104:107], v[152:155], v[164:167], v[104:107]
v_fma_f32 v213, v210, v21, v198
v_mul_f32 v197, v213, v21
v_mfma_f32_16x16x32_bf16 v[88:91], v[152:155], v[168:171], v[88:91]
v_mul_f32 v198, v213, v20
v_fma_f32 v214, v212, v20, -v197
v_mfma_f32_16x16x32_bf16 v[120:123], v[152:155], v[172:175], v[120:123]
v_fma_f32 v215, v212, v21, v198
v_mul_f32 v197, v215, v21
v_mfma_f32_16x16x32_bf16 v[76:79], v[156:159], v[160:163], v[76:79]
v_mul_f32 v198, v215, v20
v_fma_f32 v216, v214, v20, -v197
v_mfma_f32_16x16x32_bf16 v[108:111], v[156:159], v[164:167], v[108:111]
v_fma_f32 v217, v214, v21, v198
v_mul_f32 v197, v217, v21
v_mfma_f32_16x16x32_bf16 v[92:95], v[156:159], v[168:171], v[92:95]
v_mul_f32 v198, v217, v20
v_fma_f32 v218, v216, v20, -v197
v_mfma_f32_16x16x32_bf16 v[124:127], v[156:159], v[172:175], v[124:127]
v_fma_f32 v219, v216, v21, v198
v_mul_f32 v197, v219, v21
s_waitcnt lgkmcnt(6)
v_mfma_f32_16x16x32_bf16 v[64:67], v[32:35], v[48:51], v[64:67]
ds_read_b128 v[144:147], v129 offset:0
s_waitcnt lgkmcnt(6)
v_mfma_f32_16x16x32_bf16 v[96:99], v[32:35], v[52:55], v[96:99]
ds_read_b128 v[160:163], v131 offset:0
s_waitcnt lgkmcnt(6)
v_mfma_f32_16x16x32_bf16 v[80:83], v[32:35], v[56:59], v[80:83]
ds_read_b128 v[164:167], v131 offset:2048
s_waitcnt lgkmcnt(6)
v_mfma_f32_16x16x32_bf16 v[112:115], v[32:35], v[60:63], v[112:115]
ds_read_b128 v[168:171], v131 offset:4096
s_waitcnt lgkmcnt(6)
v_mfma_f32_16x16x32_bf16 v[68:71], v[36:39], v[48:51], v[68:71]
ds_read_b128 v[172:175], v131 offset:6144
v_mfma_f32_16x16x32_bf16 v[100:103], v[36:39], v[52:55], v[100:103]
ds_read_b128 v[148:151], v129 offset:2048
v_mfma_f32_16x16x32_bf16 v[84:87], v[36:39], v[56:59], v[84:87]
ds_read_b128 v[152:155], v129 offset:4096
v_mfma_f32_16x16x32_bf16 v[116:119], v[36:39], v[60:63], v[116:119]
ds_read_b128 v[156:159], v129 offset:6144
s_waitcnt lgkmcnt(9)
v_mfma_f32_16x16x32_bf16 v[72:75], v[40:43], v[48:51], v[72:75]
v_mul_f32 v198, v219, v20
v_fma_f32 v220, v218, v20, -v197
v_mfma_f32_16x16x32_bf16 v[104:107], v[40:43], v[52:55], v[104:107]
v_fma_f32 v221, v218, v21, v198
v_mul_f32 v197, v221, v21
v_mfma_f32_16x16x32_bf16 v[88:91], v[40:43], v[56:59], v[88:91]
v_mul_f32 v198, v221, v20
v_fma_f32 v222, v220, v20, -v197
v_mfma_f32_16x16x32_bf16 v[120:123], v[40:43], v[60:63], v[120:123]
v_fma_f32 v223, v220, v21, v198
v_lshlrev_b32 v251, 16, v251
s_waitcnt lgkmcnt(8)
v_mfma_f32_16x16x32_bf16 v[76:79], v[44:47], v[48:51], v[76:79]
v_lshlrev_b32 v252, 16, v252
v_lshlrev_b32 v253, 16, v253
v_mfma_f32_16x16x32_bf16 v[108:111], v[44:47], v[52:55], v[108:111]
v_mul_f32 v253, 0x3fb8aa3b, v253
v_exp_f32 v253, v253
v_mfma_f32_16x16x32_bf16 v[92:95], v[44:47], v[56:59], v[92:95]
v_cvt_pk_bf16_f32 v253, v253, v253
v_lshlrev_b32 v253, 16, v253
v_mfma_f32_16x16x32_bf16 v[124:127], v[44:47], v[60:63], v[124:127]
v_mul_f32 v205, v253, v251
v_mul_f32 v207, v253, v252
s_waitcnt lgkmcnt(0)
s_barrier
v_mfma_f32_16x16x32_bf16 v[64:67], v[144:147], v[160:163], v[64:67]
ds_read_b128 v[32:35], v128 offset:32768
v_mfma_f32_16x16x32_bf16 v[96:99], v[144:147], v[164:167], v[96:99]
ds_read_b128 v[48:51], v130 offset:32768
v_mfma_f32_16x16x32_bf16 v[80:83], v[144:147], v[168:171], v[80:83]
ds_read_b128 v[52:55], v130 offset:34816
v_mfma_f32_16x16x32_bf16 v[112:115], v[144:147], v[172:175], v[112:115]
ds_read_b128 v[56:59], v130 offset:36864
v_mfma_f32_16x16x32_bf16 v[68:71], v[148:151], v[160:163], v[68:71]
ds_read_b128 v[60:63], v130 offset:38912
v_mfma_f32_16x16x32_bf16 v[100:103], v[148:151], v[164:167], v[100:103]
ds_read_b128 v[36:39], v128 offset:34816
v_mfma_f32_16x16x32_bf16 v[84:87], v[148:151], v[168:171], v[84:87]
ds_read_b128 v[40:43], v128 offset:36864
v_mfma_f32_16x16x32_bf16 v[116:119], v[148:151], v[172:175], v[116:119]
ds_read_b128 v[44:47], v128 offset:38912
v_mfma_f32_16x16x32_bf16 v[72:75], v[152:155], v[160:163], v[72:75]
v_mul_f32 v205, 0x3fb8aa3b, v205
v_mul_f32 v207, 0.15915494, v207
v_mfma_f32_16x16x32_bf16 v[104:107], v[152:155], v[164:167], v[104:107]
v_mul_f32 v197, 0x3f800000, v205
v_mul_f32 v198, 0x3f800000, v207
v_mfma_f32_16x16x32_bf16 v[88:91], v[152:155], v[168:171], v[88:91]
v_exp_f32 v197, v197
v_rndne_f32 v199, v198
v_mfma_f32_16x16x32_bf16 v[120:123], v[152:155], v[172:175], v[120:123]
v_sub_f32 v198, v198, v199
v_cos_f32 v199, v198
v_mfma_f32_16x16x32_bf16 v[76:79], v[156:159], v[160:163], v[76:79]
v_sin_f32 v198, v198
v_mul_f32 v22, v197, v199
v_mfma_f32_16x16x32_bf16 v[108:111], v[156:159], v[164:167], v[108:111]
v_mul_f32 v23, v197, v198
v_add_f32 v197, -1.0, v22
v_mfma_f32_16x16x32_bf16 v[92:95], v[156:159], v[168:171], v[92:95]
v_mul_f32 v198, v251, v251
v_fma_f32 v198, v252, v252, v198
v_mfma_f32_16x16x32_bf16 v[124:127], v[156:159], v[172:175], v[124:127]
v_rcp_f32 v198, v198
s_nop 0
v_add_f32 v198, v198, v198
s_waitcnt lgkmcnt(6)
v_mfma_f32_16x16x32_bf16 v[64:67], v[32:35], v[48:51], v[64:67]
ds_read_b128 v[144:147], v129 offset:32768
s_waitcnt lgkmcnt(6)
v_mfma_f32_16x16x32_bf16 v[96:99], v[32:35], v[52:55], v[96:99]
ds_read_b128 v[160:163], v131 offset:32768
s_waitcnt lgkmcnt(6)
v_mfma_f32_16x16x32_bf16 v[80:83], v[32:35], v[56:59], v[80:83]
ds_read_b128 v[164:167], v131 offset:34816
s_waitcnt lgkmcnt(6)
v_mfma_f32_16x16x32_bf16 v[112:115], v[32:35], v[60:63], v[112:115]
ds_read_b128 v[168:171], v131 offset:36864
s_waitcnt lgkmcnt(6)
v_mfma_f32_16x16x32_bf16 v[68:71], v[36:39], v[48:51], v[68:71]
ds_read_b128 v[172:175], v131 offset:38912
v_mfma_f32_16x16x32_bf16 v[100:103], v[36:39], v[52:55], v[100:103]
ds_read_b128 v[148:151], v129 offset:34816
v_mfma_f32_16x16x32_bf16 v[84:87], v[36:39], v[56:59], v[84:87]
ds_read_b128 v[152:155], v129 offset:36864
v_mfma_f32_16x16x32_bf16 v[116:119], v[36:39], v[60:63], v[116:119]
ds_read_b128 v[156:159], v129 offset:38912
s_waitcnt lgkmcnt(9)
v_mfma_f32_16x16x32_bf16 v[72:75], v[40:43], v[48:51], v[72:75]
v_mul_f32 v199, v197, v251
v_fma_f32 v199, v23, v252, v199
v_mfma_f32_16x16x32_bf16 v[104:107], v[40:43], v[52:55], v[104:107]
v_mul_f32 v26, v199, v198
v_mul_f32 v199, v23, v251
v_mfma_f32_16x16x32_bf16 v[88:91], v[40:43], v[56:59], v[88:91]
v_fma_f32 v199, -v197, v252, v199
v_mul_f32 v27, v199, v198
v_mfma_f32_16x16x32_bf16 v[120:123], v[40:43], v[60:63], v[120:123]
v_mul_f32 v197, 0x41000000, v205
v_mul_f32 v198, 0x41000000, v207
s_waitcnt lgkmcnt(8)
v_mfma_f32_16x16x32_bf16 v[76:79], v[44:47], v[48:51], v[76:79]
v_exp_f32 v197, v197
v_rndne_f32 v199, v198
v_mfma_f32_16x16x32_bf16 v[108:111], v[44:47], v[52:55], v[108:111]
v_sub_f32 v198, v198, v199
v_cos_f32 v199, v198
v_mfma_f32_16x16x32_bf16 v[92:95], v[44:47], v[56:59], v[92:95]
v_sin_f32 v198, v198
v_mul_f32 v178, v197, v199
v_mfma_f32_16x16x32_bf16 v[124:127], v[44:47], v[60:63], v[124:127]
v_mul_f32 v179, v197, v198
v_mul_f32 v197, 0x41800000, v205
s_waitcnt lgkmcnt(0)
s_barrier
v_mfma_f32_16x16x32_bf16 v[64:67], v[144:147], v[160:163], v[64:67]
ds_read_b128 v[32:35], v132 offset:0
v_mfma_f32_16x16x32_bf16 v[96:99], v[144:147], v[164:167], v[96:99]
ds_read_b128 v[48:51], v134 offset:0
v_mfma_f32_16x16x32_bf16 v[80:83], v[144:147], v[168:171], v[80:83]
ds_read_b128 v[52:55], v134 offset:2048
v_mfma_f32_16x16x32_bf16 v[112:115], v[144:147], v[172:175], v[112:115]
ds_read_b128 v[56:59], v134 offset:4096
v_mfma_f32_16x16x32_bf16 v[68:71], v[148:151], v[160:163], v[68:71]
ds_read_b128 v[60:63], v134 offset:6144
v_mfma_f32_16x16x32_bf16 v[100:103], v[148:151], v[164:167], v[100:103]
ds_read_b128 v[36:39], v132 offset:2048
v_mfma_f32_16x16x32_bf16 v[84:87], v[148:151], v[168:171], v[84:87]
ds_read_b128 v[40:43], v132 offset:4096
v_mfma_f32_16x16x32_bf16 v[116:119], v[148:151], v[172:175], v[116:119]
ds_read_b128 v[44:47], v132 offset:6144
v_mfma_f32_16x16x32_bf16 v[72:75], v[152:155], v[160:163], v[72:75]
v_mul_f32 v198, 0x41800000, v207
v_exp_f32 v197, v197
v_mfma_f32_16x16x32_bf16 v[104:107], v[152:155], v[164:167], v[104:107]
v_rndne_f32 v199, v198
v_sub_f32 v198, v198, v199
v_mfma_f32_16x16x32_bf16 v[88:91], v[152:155], v[168:171], v[88:91]
v_cos_f32 v199, v198
v_sin_f32 v198, v198
v_mfma_f32_16x16x32_bf16 v[120:123], v[152:155], v[172:175], v[120:123]
v_mul_f32 v182, v197, v199
v_mul_f32 v183, v197, v198
v_mfma_f32_16x16x32_bf16 v[76:79], v[156:159], v[160:163], v[76:79]
v_mul_f32 v197, v9, v205
v_mul_f32 v198, v9, v207
v_mfma_f32_16x16x32_bf16 v[108:111], v[156:159], v[164:167], v[108:111]
v_exp_f32 v197, v197
v_rndne_f32 v199, v198
v_mfma_f32_16x16x32_bf16 v[92:95], v[156:159], v[168:171], v[92:95]
v_sub_f32 v198, v198, v199
v_cos_f32 v199, v198
v_mfma_f32_16x16x32_bf16 v[124:127], v[156:159], v[172:175], v[124:127]
v_sin_f32 v198, v198
v_mul_f32 v200, v197, v199
s_waitcnt lgkmcnt(6)
v_mfma_f32_16x16x32_bf16 v[64:67], v[32:35], v[48:51], v[64:67]
ds_read_b128 v[144:147], v133 offset:0
s_waitcnt lgkmcnt(6)
v_mfma_f32_16x16x32_bf16 v[96:99], v[32:35], v[52:55], v[96:99]
ds_read_b128 v[160:163], v135 offset:0
s_waitcnt lgkmcnt(6)
v_mfma_f32_16x16x32_bf16 v[80:83], v[32:35], v[56:59], v[80:83]
ds_read_b128 v[164:167], v135 offset:2048
s_waitcnt lgkmcnt(6)
v_mfma_f32_16x16x32_bf16 v[112:115], v[32:35], v[60:63], v[112:115]
ds_read_b128 v[168:171], v135 offset:4096
s_waitcnt lgkmcnt(6)
v_mfma_f32_16x16x32_bf16 v[68:71], v[36:39], v[48:51], v[68:71]
ds_read_b128 v[172:175], v135 offset:6144
v_mfma_f32_16x16x32_bf16 v[100:103], v[36:39], v[52:55], v[100:103]
ds_read_b128 v[148:151], v133 offset:2048
v_mfma_f32_16x16x32_bf16 v[84:87], v[36:39], v[56:59], v[84:87]
ds_read_b128 v[152:155], v133 offset:4096
v_mfma_f32_16x16x32_bf16 v[116:119], v[36:39], v[60:63], v[116:119]
ds_read_b128 v[156:159], v133 offset:6144
s_waitcnt lgkmcnt(9)
v_mfma_f32_16x16x32_bf16 v[72:75], v[40:43], v[48:51], v[72:75]
v_mul_f32 v201, v197, v198
v_mov_b32 v188, v200
v_mfma_f32_16x16x32_bf16 v[104:107], v[40:43], v[52:55], v[104:107]
v_mov_b32 v190, v201
v_mul_f32 v197, v8, v205
v_mfma_f32_16x16x32_bf16 v[88:91], v[40:43], v[56:59], v[88:91]
v_mul_f32 v198, v8, v207
v_exp_f32 v197, v197
v_mfma_f32_16x16x32_bf16 v[120:123], v[40:43], v[60:63], v[120:123]
v_rndne_f32 v199, v198
v_sub_f32 v198, v198, v199
s_waitcnt lgkmcnt(8)
v_mfma_f32_16x16x32_bf16 v[76:79], v[44:47], v[48:51], v[76:79]
v_cos_f32 v199, v198
v_sin_f32 v198, v198
v_mfma_f32_16x16x32_bf16 v[108:111], v[44:47], v[52:55], v[108:111]
v_mul_f32 v200, v197, v199
v_mul_f32 v201, v197, v198
v_mfma_f32_16x16x32_bf16 v[92:95], v[44:47], v[56:59], v[92:95]
v_mov_b32 v189, v200
v_mov_b32 v191, v201
v_mfma_f32_16x16x32_bf16 v[124:127], v[44:47], v[60:63], v[124:127]
v_mul_f32 v197, v27, v23
v_mul_f32 v198, v27, v22
s_waitcnt lgkmcnt(0)
s_barrier
v_mfma_f32_16x16x32_bf16 v[64:67], v[144:147], v[160:163], v[64:67]
ds_read_b128 v[32:35], v128 offset:0
v_mfma_f32_16x16x32_bf16 v[96:99], v[144:147], v[164:167], v[96:99]
ds_read_b128 v[48:51], v130 offset:0
v_mfma_f32_16x16x32_bf16 v[80:83], v[144:147], v[168:171], v[80:83]
ds_read_b128 v[52:55], v130 offset:2048
v_mfma_f32_16x16x32_bf16 v[112:115], v[144:147], v[172:175], v[112:115]
ds_read_b128 v[56:59], v130 offset:4096
v_mfma_f32_16x16x32_bf16 v[68:71], v[148:151], v[160:163], v[68:71]
ds_read_b128 v[60:63], v130 offset:6144
v_mfma_f32_16x16x32_bf16 v[100:103], v[148:151], v[164:167], v[100:103]
ds_read_b128 v[36:39], v128 offset:2048
v_mfma_f32_16x16x32_bf16 v[84:87], v[148:151], v[168:171], v[84:87]
ds_read_b128 v[40:43], v128 offset:4096
v_mfma_f32_16x16x32_bf16 v[116:119], v[148:151], v[172:175], v[116:119]
ds_read_b128 v[44:47], v128 offset:6144
v_mfma_f32_16x16x32_bf16 v[72:75], v[152:155], v[160:163], v[72:75]
v_fma_f32 v224, v26, v22, -v197
v_fma_f32 v225, v26, v23, v198
v_mfma_f32_16x16x32_bf16 v[104:107], v[152:155], v[164:167], v[104:107]
v_mul_f32 v197, v225, v23
v_mul_f32 v198, v225, v22
v_mfma_f32_16x16x32_bf16 v[88:91], v[152:155], v[168:171], v[88:91]
v_fma_f32 v226, v224, v22, -v197
v_fma_f32 v227, v224, v23, v198
v_mfma_f32_16x16x32_bf16 v[120:123], v[152:155], v[172:175], v[120:123]
v_mul_f32 v197, v227, v23
v_mul_f32 v198, v227, v22
v_mfma_f32_16x16x32_bf16 v[76:79], v[156:159], v[160:163], v[76:79]
v_fma_f32 v228, v226, v22, -v197
v_fma_f32 v229, v226, v23, v198
v_mfma_f32_16x16x32_bf16 v[108:111], v[156:159], v[164:167], v[108:111]
v_mul_f32 v197, v229, v23
v_mul_f32 v198, v229, v22
v_mfma_f32_16x16x32_bf16 v[92:95], v[156:159], v[168:171], v[92:95]
v_fma_f32 v230, v228, v22, -v197
v_fma_f32 v231, v228, v23, v198
v_mfma_f32_16x16x32_bf16 v[124:127], v[156:159], v[172:175], v[124:127]
v_mul_f32 v197, v231, v23
v_mul_f32 v198, v231, v22
s_waitcnt lgkmcnt(6)
v_mfma_f32_16x16x32_bf16 v[64:67], v[32:35], v[48:51], v[64:67]
ds_read_b128 v[144:147], v129 offset:0
s_waitcnt lgkmcnt(6)
v_mfma_f32_16x16x32_bf16 v[96:99], v[32:35], v[52:55], v[96:99]
ds_read_b128 v[160:163], v131 offset:0
s_waitcnt lgkmcnt(6)
v_mfma_f32_16x16x32_bf16 v[80:83], v[32:35], v[56:59], v[80:83]
ds_read_b128 v[164:167], v131 offset:2048
s_waitcnt lgkmcnt(6)
v_mfma_f32_16x16x32_bf16 v[112:115], v[32:35], v[60:63], v[112:115]
ds_read_b128 v[168:171], v131 offset:4096
s_waitcnt lgkmcnt(6)
v_mfma_f32_16x16x32_bf16 v[68:71], v[36:39], v[48:51], v[68:71]
ds_read_b128 v[172:175], v131 offset:6144
v_mfma_f32_16x16x32_bf16 v[100:103], v[36:39], v[52:55], v[100:103]
ds_read_b128 v[148:151], v129 offset:2048
v_mfma_f32_16x16x32_bf16 v[84:87], v[36:39], v[56:59], v[84:87]
ds_read_b128 v[152:155], v129 offset:4096
v_mfma_f32_16x16x32_bf16 v[116:119], v[36:39], v[60:63], v[116:119]
ds_read_b128 v[156:159], v129 offset:6144
s_waitcnt lgkmcnt(9)
v_mfma_f32_16x16x32_bf16 v[72:75], v[40:43], v[48:51], v[72:75]
v_fma_f32 v232, v230, v22, -v197
v_fma_f32 v233, v230, v23, v198
v_mfma_f32_16x16x32_bf16 v[104:107], v[40:43], v[52:55], v[104:107]
v_mul_f32 v197, v233, v23
v_mul_f32 v198, v233, v22
v_mfma_f32_16x16x32_bf16 v[88:91], v[40:43], v[56:59], v[88:91]
v_fma_f32 v234, v232, v22, -v197
v_fma_f32 v235, v232, v23, v198
v_mfma_f32_16x16x32_bf16 v[120:123], v[40:43], v[60:63], v[120:123]
v_mul_f32 v197, v235, v23
v_mul_f32 v198, v235, v22
s_waitcnt lgkmcnt(8)
v_mfma_f32_16x16x32_bf16 v[76:79], v[44:47], v[48:51], v[76:79]
v_fma_f32 v236, v234, v22, -v197
v_fma_f32 v237, v234, v23, v198
v_mfma_f32_16x16x32_bf16 v[108:111], v[44:47], v[52:55], v[108:111]
v_mul_f32 v197, v237, v23
v_mul_f32 v198, v237, v22
v_mfma_f32_16x16x32_bf16 v[92:95], v[44:47], v[56:59], v[92:95]
v_fma_f32 v238, v236, v22, -v197
v_fma_f32 v239, v236, v23, v198
v_mfma_f32_16x16x32_bf16 v[124:127], v[44:47], v[60:63], v[124:127]
v_and_b32 v197, 16, v1
v_cmp_ne_u32 vcc, 0, v197
s_waitcnt lgkmcnt(0)
s_barrier
v_mfma_f32_16x16x32_bf16 v[64:67], v[144:147], v[160:163], v[64:67]
ds_read_b128 v[32:35], v128 offset:32768
v_mfma_f32_16x16x32_bf16 v[96:99], v[144:147], v[164:167], v[96:99]
ds_read_b128 v[48:51], v130 offset:32768
v_mfma_f32_16x16x32_bf16 v[80:83], v[144:147], v[168:171], v[80:83]
ds_read_b128 v[52:55], v130 offset:34816
v_mfma_f32_16x16x32_bf16 v[112:115], v[144:147], v[172:175], v[112:115]
ds_read_b128 v[56:59], v130 offset:36864
v_mfma_f32_16x16x32_bf16 v[68:71], v[148:151], v[160:163], v[68:71]
ds_read_b128 v[60:63], v130 offset:38912
v_mfma_f32_16x16x32_bf16 v[100:103], v[148:151], v[164:167], v[100:103]
ds_read_b128 v[36:39], v128 offset:34816
v_mfma_f32_16x16x32_bf16 v[84:87], v[148:151], v[168:171], v[84:87]
ds_read_b128 v[40:43], v128 offset:36864
v_mfma_f32_16x16x32_bf16 v[116:119], v[148:151], v[172:175], v[116:119]
ds_read_b128 v[44:47], v128 offset:38912
v_mfma_f32_16x16x32_bf16 v[72:75], v[152:155], v[160:163], v[72:75]
v_cndmask_b32 v204, v204, v205, vcc
v_cndmask_b32 v206, v206, v207, vcc
v_mfma_f32_16x16x32_bf16 v[104:107], v[152:155], v[164:167], v[104:107]
v_mul_f32 v197, 0x41800000, v204
v_mul_f32 v198, 0x41800000, v206
v_mfma_f32_16x16x32_bf16 v[88:91], v[152:155], v[168:171], v[88:91]
v_exp_f32 v197, v197
v_rndne_f32 v199, v198
v_mfma_f32_16x16x32_bf16 v[120:123], v[152:155], v[172:175], v[120:123]
v_sub_f32 v198, v198, v199
v_cos_f32 v199, v198
v_mfma_f32_16x16x32_bf16 v[76:79], v[156:159], v[160:163], v[76:79]
v_sin_f32 v198, v198
v_mul_f32 v28, v197, v199
v_mfma_f32_16x16x32_bf16 v[108:111], v[156:159], v[164:167], v[108:111]
v_mul_f32 v29, v197, v198
v_mul_f32 v197, 0x42800000, v204
v_mfma_f32_16x16x32_bf16 v[92:95], v[156:159], v[168:171], v[92:95]
v_mul_f32 v198, 0x42800000, v206
v_exp_f32 v197, v197
v_mfma_f32_16x16x32_bf16 v[124:127], v[156:159], v[172:175], v[124:127]
v_rndne_f32 v199, v198
v_sub_f32 v198, v198, v199
s_waitcnt lgkmcnt(6)
v_mfma_f32_16x16x32_bf16 v[64:67], v[32:35], v[48:51], v[64:67]
ds_read_b128 v[144:147], v129 offset:32768
s_waitcnt lgkmcnt(6)
v_mfma_f32_16x16x32_bf16 v[96:99], v[32:35], v[52:55], v[96:99]
ds_read_b128 v[160:163], v131 offset:32768
s_waitcnt lgkmcnt(6)
v_mfma_f32_16x16x32_bf16 v[80:83], v[32:35], v[56:59], v[80:83]
ds_read_b128 v[164:167], v131 offset:34816
s_waitcnt lgkmcnt(6)
v_mfma_f32_16x16x32_bf16 v[112:115], v[32:35], v[60:63], v[112:115]
ds_read_b128 v[168:171], v131 offset:36864
s_waitcnt lgkmcnt(6)
v_mfma_f32_16x16x32_bf16 v[68:71], v[36:39], v[48:51], v[68:71]
ds_read_b128 v[172:175], v131 offset:38912
v_mfma_f32_16x16x32_bf16 v[100:103], v[36:39], v[52:55], v[100:103]
ds_read_b128 v[148:151], v129 offset:34816
v_mfma_f32_16x16x32_bf16 v[84:87], v[36:39], v[56:59], v[84:87]
ds_read_b128 v[152:155], v129 offset:36864
v_mfma_f32_16x16x32_bf16 v[116:119], v[36:39], v[60:63], v[116:119]
ds_read_b128 v[156:159], v129 offset:38912
s_waitcnt lgkmcnt(9)
v_mfma_f32_16x16x32_bf16 v[72:75], v[40:43], v[48:51], v[72:75]
v_cos_f32 v199, v198
v_sin_f32 v198, v198
v_mfma_f32_16x16x32_bf16 v[104:107], v[40:43], v[52:55], v[104:107]
v_mul_f32 v192, v197, v199
v_mul_f32 v193, v197, v198
v_mfma_f32_16x16x32_bf16 v[88:91], v[40:43], v[56:59], v[88:91]
v_mul_f32 v197, 0x43000000, v204
v_mul_f32 v198, 0x43000000, v206
v_mfma_f32_16x16x32_bf16 v[120:123], v[40:43], v[60:63], v[120:123]
v_exp_f32 v197, v197
v_rndne_f32 v199, v198
s_waitcnt lgkmcnt(8)
v_mfma_f32_16x16x32_bf16 v[76:79], v[44:47], v[48:51], v[76:79]
v_sub_f32 v198, v198, v199
v_cos_f32 v199, v198
v_mfma_f32_16x16x32_bf16 v[108:111], v[44:47], v[52:55], v[108:111]
v_sin_f32 v198, v198
v_mul_f32 v30, v197, v199
v_mfma_f32_16x16x32_bf16 v[92:95], v[44:47], v[56:59], v[92:95]
v_mul_f32 v31, v197, v198
v_mul_f32 v197, 0x43800000, v204
v_mfma_f32_16x16x32_bf16 v[124:127], v[44:47], v[60:63], v[124:127]
v_mul_f32 v198, 0x43800000, v206
v_exp_f32 v197, v197
s_waitcnt lgkmcnt(0)
s_barrier
v_mfma_f32_16x16x32_bf16 v[64:67], v[144:147], v[160:163], v[64:67]
ds_read_b128 v[32:35], v132 offset:0
v_mfma_f32_16x16x32_bf16 v[96:99], v[144:147], v[164:167], v[96:99]
ds_read_b128 v[48:51], v134 offset:0
v_mfma_f32_16x16x32_bf16 v[80:83], v[144:147], v[168:171], v[80:83]
ds_read_b128 v[52:55], v134 offset:2048
v_mfma_f32_16x16x32_bf16 v[112:115], v[144:147], v[172:175], v[112:115]
ds_read_b128 v[56:59], v134 offset:4096
v_mfma_f32_16x16x32_bf16 v[68:71], v[148:151], v[160:163], v[68:71]
ds_read_b128 v[60:63], v134 offset:6144
v_mfma_f32_16x16x32_bf16 v[100:103], v[148:151], v[164:167], v[100:103]
ds_read_b128 v[36:39], v132 offset:2048
v_mfma_f32_16x16x32_bf16 v[84:87], v[148:151], v[168:171], v[84:87]
ds_read_b128 v[40:43], v132 offset:4096
v_mfma_f32_16x16x32_bf16 v[116:119], v[148:151], v[172:175], v[116:119]
ds_read_b128 v[44:47], v132 offset:6144
v_mfma_f32_16x16x32_bf16 v[72:75], v[152:155], v[160:163], v[72:75]
v_rndne_f32 v199, v198
v_sub_f32 v198, v198, v199
v_mfma_f32_16x16x32_bf16 v[104:107], v[152:155], v[164:167], v[104:107]
v_cos_f32 v199, v198
v_sin_f32 v198, v198
v_mfma_f32_16x16x32_bf16 v[88:91], v[152:155], v[168:171], v[88:91]
v_mul_f32 v2, v197, v199
v_mul_f32 v3, v197, v198
v_mfma_f32_16x16x32_bf16 v[120:123], v[152:155], v[172:175], v[120:123]
v_lshrrev_b32 v197, 4, v1
v_lshlrev_b32 v197, 2, v197
v_mfma_f32_16x16x32_bf16 v[76:79], v[156:159], v[160:163], v[76:79]
v_and_b32 v198, 15, v1
v_sub_u32 v197, v198, v197
v_mfma_f32_16x16x32_bf16 v[108:111], v[156:159], v[164:167], v[108:111]
v_mov_b32 v198, 0x3f80
v_mov_b32 v199, 1.0
v_mfma_f32_16x16x32_bf16 v[92:95], v[156:159], v[168:171], v[92:95]
v_cmp_eq_u32 vcc, 0, v197
s_nop 1
v_cndmask_b32 v248, 0, v198, vcc
v_mfma_f32_16x16x32_bf16 v[124:127], v[156:159], v[172:175], v[124:127]
v_cndmask_b32 v252, 0, v199, vcc
v_cmp_eq_u32 vcc, 1, v197
s_waitcnt lgkmcnt(6)
v_mfma_f32_16x16x32_bf16 v[64:67], v[32:35], v[48:51], v[64:67]
ds_read_b128 v[144:147], v133 offset:0
s_waitcnt lgkmcnt(6)
v_mfma_f32_16x16x32_bf16 v[96:99], v[32:35], v[52:55], v[96:99]
ds_read_b128 v[160:163], v135 offset:0
s_waitcnt lgkmcnt(6)
v_mfma_f32_16x16x32_bf16 v[80:83], v[32:35], v[56:59], v[80:83]
ds_read_b128 v[164:167], v135 offset:2048
s_waitcnt lgkmcnt(6)
v_mfma_f32_16x16x32_bf16 v[112:115], v[32:35], v[60:63], v[112:115]
ds_read_b128 v[168:171], v135 offset:4096
s_waitcnt lgkmcnt(6)
v_mfma_f32_16x16x32_bf16 v[68:71], v[36:39], v[48:51], v[68:71]
ds_read_b128 v[172:175], v135 offset:6144
v_mfma_f32_16x16x32_bf16 v[100:103], v[36:39], v[52:55], v[100:103]
ds_read_b128 v[148:151], v133 offset:2048
v_mfma_f32_16x16x32_bf16 v[84:87], v[36:39], v[56:59], v[84:87]
ds_read_b128 v[152:155], v133 offset:4096
v_mfma_f32_16x16x32_bf16 v[116:119], v[36:39], v[60:63], v[116:119]
ds_read_b128 v[156:159], v133 offset:6144
s_waitcnt lgkmcnt(9)
v_mfma_f32_16x16x32_bf16 v[72:75], v[40:43], v[48:51], v[72:75]
v_cndmask_b32 v249, 0, v198, vcc
v_cndmask_b32 v253, 0, v199, vcc
v_mfma_f32_16x16x32_bf16 v[104:107], v[40:43], v[52:55], v[104:107]
v_cmp_eq_u32 vcc, 2, v197
s_nop 1
v_cndmask_b32 v250, 0, v198, vcc
v_mfma_f32_16x16x32_bf16 v[88:91], v[40:43], v[56:59], v[88:91]
v_cndmask_b32 v254, 0, v199, vcc
v_cmp_eq_u32 vcc, 3, v197
v_mfma_f32_16x16x32_bf16 v[120:123], v[40:43], v[60:63], v[120:123]
s_nop 0
v_cndmask_b32 v251, 0, v198, vcc
v_cndmask_b32 v255, 0, v199, vcc
s_waitcnt lgkmcnt(8)
v_mfma_f32_16x16x32_bf16 v[76:79], v[44:47], v[48:51], v[76:79]
v_mfma_f32_16x16x32_bf16 v[108:111], v[44:47], v[52:55], v[108:111]
v_mfma_f32_16x16x32_bf16 v[92:95], v[44:47], v[56:59], v[92:95]
v_mfma_f32_16x16x32_bf16 v[124:127], v[44:47], v[60:63], v[124:127]
s_waitcnt lgkmcnt(0)
s_barrier
v_mfma_f32_16x16x32_bf16 v[64:67], v[144:147], v[160:163], v[64:67]
ds_read_b128 v[32:35], v128 offset:0
v_mfma_f32_16x16x32_bf16 v[96:99], v[144:147], v[164:167], v[96:99]
ds_read_b128 v[48:51], v130 offset:0
v_mfma_f32_16x16x32_bf16 v[80:83], v[144:147], v[168:171], v[80:83]
ds_read_b128 v[52:55], v130 offset:2048
v_mfma_f32_16x16x32_bf16 v[112:115], v[144:147], v[172:175], v[112:115]
ds_read_b128 v[56:59], v130 offset:4096
v_mfma_f32_16x16x32_bf16 v[68:71], v[148:151], v[160:163], v[68:71]
ds_read_b128 v[60:63], v130 offset:6144
v_mfma_f32_16x16x32_bf16 v[100:103], v[148:151], v[164:167], v[100:103]
ds_read_b128 v[36:39], v128 offset:2048
v_mfma_f32_16x16x32_bf16 v[84:87], v[148:151], v[168:171], v[84:87]
ds_read_b128 v[40:43], v128 offset:4096
v_mfma_f32_16x16x32_bf16 v[116:119], v[148:151], v[172:175], v[116:119]
ds_read_b128 v[44:47], v128 offset:6144
v_mfma_f32_16x16x32_bf16 v[72:75], v[152:155], v[160:163], v[72:75]
v_mfma_f32_16x16x32_bf16 v[104:107], v[152:155], v[164:167], v[104:107]
v_mfma_f32_16x16x32_bf16 v[88:91], v[152:155], v[168:171], v[88:91]
v_mfma_f32_16x16x32_bf16 v[120:123], v[152:155], v[172:175], v[120:123]
v_mfma_f32_16x16x32_bf16 v[76:79], v[156:159], v[160:163], v[76:79]
v_mfma_f32_16x16x32_bf16 v[108:111], v[156:159], v[164:167], v[108:111]
v_mfma_f32_16x16x32_bf16 v[92:95], v[156:159], v[168:171], v[92:95]
v_mfma_f32_16x16x32_bf16 v[124:127], v[156:159], v[172:175], v[124:127]
s_waitcnt lgkmcnt(6)
v_mfma_f32_16x16x32_bf16 v[64:67], v[32:35], v[48:51], v[64:67]
ds_read_b128 v[144:147], v129 offset:0
s_waitcnt lgkmcnt(6)
v_mfma_f32_16x16x32_bf16 v[96:99], v[32:35], v[52:55], v[96:99]
ds_read_b128 v[160:163], v131 offset:0
s_waitcnt lgkmcnt(6)
v_mfma_f32_16x16x32_bf16 v[80:83], v[32:35], v[56:59], v[80:83]
ds_read_b128 v[164:167], v131 offset:2048
s_waitcnt lgkmcnt(6)
v_mfma_f32_16x16x32_bf16 v[112:115], v[32:35], v[60:63], v[112:115]
ds_read_b128 v[168:171], v131 offset:4096
s_waitcnt lgkmcnt(6)
v_mfma_f32_16x16x32_bf16 v[68:71], v[36:39], v[48:51], v[68:71]
ds_read_b128 v[172:175], v131 offset:6144
v_mfma_f32_16x16x32_bf16 v[100:103], v[36:39], v[52:55], v[100:103]
ds_read_b128 v[148:151], v129 offset:2048
v_mfma_f32_16x16x32_bf16 v[84:87], v[36:39], v[56:59], v[84:87]
ds_read_b128 v[152:155], v129 offset:4096
v_mfma_f32_16x16x32_bf16 v[116:119], v[36:39], v[60:63], v[116:119]
ds_read_b128 v[156:159], v129 offset:6144
s_waitcnt lgkmcnt(9)
v_mfma_f32_16x16x32_bf16 v[72:75], v[40:43], v[48:51], v[72:75]
v_mfma_f32_16x16x32_bf16 v[104:107], v[40:43], v[52:55], v[104:107]
v_mfma_f32_16x16x32_bf16 v[88:91], v[40:43], v[56:59], v[88:91]
v_mfma_f32_16x16x32_bf16 v[120:123], v[40:43], v[60:63], v[120:123]
s_waitcnt lgkmcnt(8)
v_mfma_f32_16x16x32_bf16 v[76:79], v[44:47], v[48:51], v[76:79]
v_mfma_f32_16x16x32_bf16 v[108:111], v[44:47], v[52:55], v[108:111]
v_mfma_f32_16x16x32_bf16 v[92:95], v[44:47], v[56:59], v[92:95]
v_mfma_f32_16x16x32_bf16 v[124:127], v[44:47], v[60:63], v[124:127]
s_waitcnt lgkmcnt(0)
s_barrier
v_mfma_f32_16x16x32_bf16 v[64:67], v[144:147], v[160:163], v[64:67]
ds_read_b128 v[32:35], v128 offset:32768
v_mfma_f32_16x16x32_bf16 v[96:99], v[144:147], v[164:167], v[96:99]
ds_read_b128 v[48:51], v130 offset:32768
v_mfma_f32_16x16x32_bf16 v[80:83], v[144:147], v[168:171], v[80:83]
ds_read_b128 v[52:55], v130 offset:34816
v_mfma_f32_16x16x32_bf16 v[112:115], v[144:147], v[172:175], v[112:115]
ds_read_b128 v[56:59], v130 offset:36864
v_mfma_f32_16x16x32_bf16 v[68:71], v[148:151], v[160:163], v[68:71]
ds_read_b128 v[60:63], v130 offset:38912
v_mfma_f32_16x16x32_bf16 v[100:103], v[148:151], v[164:167], v[100:103]
ds_read_b128 v[36:39], v128 offset:34816
v_mfma_f32_16x16x32_bf16 v[84:87], v[148:151], v[168:171], v[84:87]
ds_read_b128 v[40:43], v128 offset:36864
v_mfma_f32_16x16x32_bf16 v[116:119], v[148:151], v[172:175], v[116:119]
ds_read_b128 v[44:47], v128 offset:38912
v_mfma_f32_16x16x32_bf16 v[72:75], v[152:155], v[160:163], v[72:75]
v_mfma_f32_16x16x32_bf16 v[104:107], v[152:155], v[164:167], v[104:107]
v_mfma_f32_16x16x32_bf16 v[88:91], v[152:155], v[168:171], v[88:91]
v_mfma_f32_16x16x32_bf16 v[120:123], v[152:155], v[172:175], v[120:123]
v_mfma_f32_16x16x32_bf16 v[76:79], v[156:159], v[160:163], v[76:79]
v_mfma_f32_16x16x32_bf16 v[108:111], v[156:159], v[164:167], v[108:111]
v_mfma_f32_16x16x32_bf16 v[92:95], v[156:159], v[168:171], v[92:95]
v_mfma_f32_16x16x32_bf16 v[124:127], v[156:159], v[172:175], v[124:127]
s_waitcnt lgkmcnt(6)
v_mfma_f32_16x16x32_bf16 v[64:67], v[32:35], v[48:51], v[64:67]
ds_read_b128 v[144:147], v129 offset:32768
s_waitcnt lgkmcnt(6)
v_mfma_f32_16x16x32_bf16 v[96:99], v[32:35], v[52:55], v[96:99]
ds_read_b128 v[160:163], v131 offset:32768
s_waitcnt lgkmcnt(6)
v_mfma_f32_16x16x32_bf16 v[80:83], v[32:35], v[56:59], v[80:83]
ds_read_b128 v[164:167], v131 offset:34816
s_waitcnt lgkmcnt(6)
v_mfma_f32_16x16x32_bf16 v[112:115], v[32:35], v[60:63], v[112:115]
ds_read_b128 v[168:171], v131 offset:36864
s_waitcnt lgkmcnt(6)
v_mfma_f32_16x16x32_bf16 v[68:71], v[36:39], v[48:51], v[68:71]
ds_read_b128 v[172:175], v131 offset:38912
v_mfma_f32_16x16x32_bf16 v[100:103], v[36:39], v[52:55], v[100:103]
ds_read_b128 v[148:151], v129 offset:34816
v_mfma_f32_16x16x32_bf16 v[84:87], v[36:39], v[56:59], v[84:87]
ds_read_b128 v[152:155], v129 offset:36864
v_mfma_f32_16x16x32_bf16 v[116:119], v[36:39], v[60:63], v[116:119]
ds_read_b128 v[156:159], v129 offset:38912
s_waitcnt lgkmcnt(9)
v_mfma_f32_16x16x32_bf16 v[72:75], v[40:43], v[48:51], v[72:75]
v_mfma_f32_16x16x32_bf16 v[104:107], v[40:43], v[52:55], v[104:107]
v_mfma_f32_16x16x32_bf16 v[88:91], v[40:43], v[56:59], v[88:91]
v_mfma_f32_16x16x32_bf16 v[120:123], v[40:43], v[60:63], v[120:123]
s_waitcnt lgkmcnt(8)
v_mfma_f32_16x16x32_bf16 v[76:79], v[44:47], v[48:51], v[76:79]
v_mfma_f32_16x16x32_bf16 v[108:111], v[44:47], v[52:55], v[108:111]
v_mfma_f32_16x16x32_bf16 v[92:95], v[44:47], v[56:59], v[92:95]
v_mfma_f32_16x16x32_bf16 v[124:127], v[44:47], v[60:63], v[124:127]
s_waitcnt lgkmcnt(0)
s_barrier
v_mfma_f32_16x16x32_bf16 v[64:67], v[144:147], v[160:163], v[64:67]
ds_read_b128 v[32:35], v132 offset:0
v_mfma_f32_16x16x32_bf16 v[96:99], v[144:147], v[164:167], v[96:99]
ds_read_b128 v[48:51], v134 offset:0
v_mfma_f32_16x16x32_bf16 v[80:83], v[144:147], v[168:171], v[80:83]
ds_read_b128 v[52:55], v134 offset:2048
v_mfma_f32_16x16x32_bf16 v[112:115], v[144:147], v[172:175], v[112:115]
ds_read_b128 v[56:59], v134 offset:4096
v_mfma_f32_16x16x32_bf16 v[68:71], v[148:151], v[160:163], v[68:71]
ds_read_b128 v[60:63], v134 offset:6144
v_mfma_f32_16x16x32_bf16 v[100:103], v[148:151], v[164:167], v[100:103]
ds_read_b128 v[36:39], v132 offset:2048
v_mfma_f32_16x16x32_bf16 v[84:87], v[148:151], v[168:171], v[84:87]
ds_read_b128 v[40:43], v132 offset:4096
v_mfma_f32_16x16x32_bf16 v[116:119], v[148:151], v[172:175], v[116:119]
ds_read_b128 v[44:47], v132 offset:6144
v_mfma_f32_16x16x32_bf16 v[72:75], v[152:155], v[160:163], v[72:75]
v_mfma_f32_16x16x32_bf16 v[104:107], v[152:155], v[164:167], v[104:107]
v_mfma_f32_16x16x32_bf16 v[88:91], v[152:155], v[168:171], v[88:91]
v_mfma_f32_16x16x32_bf16 v[120:123], v[152:155], v[172:175], v[120:123]
v_mfma_f32_16x16x32_bf16 v[76:79], v[156:159], v[160:163], v[76:79]
v_mfma_f32_16x16x32_bf16 v[108:111], v[156:159], v[164:167], v[108:111]
v_mfma_f32_16x16x32_bf16 v[92:95], v[156:159], v[168:171], v[92:95]
v_mfma_f32_16x16x32_bf16 v[124:127], v[156:159], v[172:175], v[124:127]
s_waitcnt lgkmcnt(6)
v_mfma_f32_16x16x32_bf16 v[64:67], v[32:35], v[48:51], v[64:67]
ds_read_b128 v[144:147], v133 offset:0
s_waitcnt lgkmcnt(6)
v_mfma_f32_16x16x32_bf16 v[96:99], v[32:35], v[52:55], v[96:99]
ds_read_b128 v[160:163], v135 offset:0
s_waitcnt lgkmcnt(6)
v_mfma_f32_16x16x32_bf16 v[80:83], v[32:35], v[56:59], v[80:83]
ds_read_b128 v[164:167], v135 offset:2048
s_waitcnt lgkmcnt(6)
v_mfma_f32_16x16x32_bf16 v[112:115], v[32:35], v[60:63], v[112:115]
ds_read_b128 v[168:171], v135 offset:4096
s_waitcnt lgkmcnt(6)
v_mfma_f32_16x16x32_bf16 v[68:71], v[36:39], v[48:51], v[68:71]
ds_read_b128 v[172:175], v135 offset:6144
v_mfma_f32_16x16x32_bf16 v[100:103], v[36:39], v[52:55], v[100:103]
ds_read_b128 v[148:151], v133 offset:2048
v_mfma_f32_16x16x32_bf16 v[84:87], v[36:39], v[56:59], v[84:87]
ds_read_b128 v[152:155], v133 offset:4096
v_mfma_f32_16x16x32_bf16 v[116:119], v[36:39], v[60:63], v[116:119]
ds_read_b128 v[156:159], v133 offset:6144
s_waitcnt lgkmcnt(9)
v_mfma_f32_16x16x32_bf16 v[72:75], v[40:43], v[48:51], v[72:75]
v_mfma_f32_16x16x32_bf16 v[104:107], v[40:43], v[52:55], v[104:107]
v_mfma_f32_16x16x32_bf16 v[88:91], v[40:43], v[56:59], v[88:91]
v_mfma_f32_16x16x32_bf16 v[120:123], v[40:43], v[60:63], v[120:123]
s_waitcnt lgkmcnt(8)
v_mfma_f32_16x16x32_bf16 v[76:79], v[44:47], v[48:51], v[76:79]
v_mfma_f32_16x16x32_bf16 v[108:111], v[44:47], v[52:55], v[108:111]
v_mfma_f32_16x16x32_bf16 v[92:95], v[44:47], v[56:59], v[92:95]
v_mfma_f32_16x16x32_bf16 v[124:127], v[44:47], v[60:63], v[124:127]
s_waitcnt lgkmcnt(0)
s_barrier
v_mfma_f32_16x16x32_bf16 v[64:67], v[144:147], v[160:163], v[64:67]
ds_read_b128 v[32:35], v128 offset:0
v_mfma_f32_16x16x32_bf16 v[96:99], v[144:147], v[164:167], v[96:99]
ds_read_b128 v[48:51], v130 offset:0
v_mfma_f32_16x16x32_bf16 v[80:83], v[144:147], v[168:171], v[80:83]
ds_read_b128 v[52:55], v130 offset:2048
v_mfma_f32_16x16x32_bf16 v[112:115], v[144:147], v[172:175], v[112:115]
ds_read_b128 v[56:59], v130 offset:4096
v_mfma_f32_16x16x32_bf16 v[68:71], v[148:151], v[160:163], v[68:71]
ds_read_b128 v[60:63], v130 offset:6144
v_mfma_f32_16x16x32_bf16 v[100:103], v[148:151], v[164:167], v[100:103]
ds_read_b128 v[36:39], v128 offset:2048
v_mfma_f32_16x16x32_bf16 v[84:87], v[148:151], v[168:171], v[84:87]
ds_read_b128 v[40:43], v128 offset:4096
v_mfma_f32_16x16x32_bf16 v[116:119], v[148:151], v[172:175], v[116:119]
ds_read_b128 v[44:47], v128 offset:6144
v_mfma_f32_16x16x32_bf16 v[72:75], v[152:155], v[160:163], v[72:75]
v_mfma_f32_16x16x32_bf16 v[104:107], v[152:155], v[164:167], v[104:107]
v_mfma_f32_16x16x32_bf16 v[88:91], v[152:155], v[168:171], v[88:91]
v_mfma_f32_16x16x32_bf16 v[120:123], v[152:155], v[172:175], v[120:123]
v_mfma_f32_16x16x32_bf16 v[76:79], v[156:159], v[160:163], v[76:79]
v_mfma_f32_16x16x32_bf16 v[108:111], v[156:159], v[164:167], v[108:111]
v_mfma_f32_16x16x32_bf16 v[92:95], v[156:159], v[168:171], v[92:95]
v_mfma_f32_16x16x32_bf16 v[124:127], v[156:159], v[172:175], v[124:127]
s_waitcnt lgkmcnt(6)
v_mfma_f32_16x16x32_bf16 v[64:67], v[32:35], v[48:51], v[64:67]
ds_read_b128 v[144:147], v129 offset:0
s_waitcnt lgkmcnt(6)
v_mfma_f32_16x16x32_bf16 v[96:99], v[32:35], v[52:55], v[96:99]
ds_read_b128 v[160:163], v131 offset:0
s_waitcnt lgkmcnt(6)
v_mfma_f32_16x16x32_bf16 v[80:83], v[32:35], v[56:59], v[80:83]
ds_read_b128 v[164:167], v131 offset:2048
s_waitcnt lgkmcnt(6)
v_mfma_f32_16x16x32_bf16 v[112:115], v[32:35], v[60:63], v[112:115]
ds_read_b128 v[168:171], v131 offset:4096
s_waitcnt lgkmcnt(6)
v_mfma_f32_16x16x32_bf16 v[68:71], v[36:39], v[48:51], v[68:71]
ds_read_b128 v[172:175], v131 offset:6144
v_mfma_f32_16x16x32_bf16 v[100:103], v[36:39], v[52:55], v[100:103]
ds_read_b128 v[148:151], v129 offset:2048
v_mfma_f32_16x16x32_bf16 v[84:87], v[36:39], v[56:59], v[84:87]
ds_read_b128 v[152:155], v129 offset:4096
v_mfma_f32_16x16x32_bf16 v[116:119], v[36:39], v[60:63], v[116:119]
ds_read_b128 v[156:159], v129 offset:6144
s_waitcnt lgkmcnt(9)
v_mfma_f32_16x16x32_bf16 v[72:75], v[40:43], v[48:51], v[72:75]
v_mfma_f32_16x16x32_bf16 v[104:107], v[40:43], v[52:55], v[104:107]
v_mfma_f32_16x16x32_bf16 v[88:91], v[40:43], v[56:59], v[88:91]
v_mfma_f32_16x16x32_bf16 v[120:123], v[40:43], v[60:63], v[120:123]
s_waitcnt lgkmcnt(8)
v_mfma_f32_16x16x32_bf16 v[76:79], v[44:47], v[48:51], v[76:79]
v_mfma_f32_16x16x32_bf16 v[108:111], v[44:47], v[52:55], v[108:111]
v_mfma_f32_16x16x32_bf16 v[92:95], v[44:47], v[56:59], v[92:95]
v_mfma_f32_16x16x32_bf16 v[124:127], v[44:47], v[60:63], v[124:127]
s_waitcnt lgkmcnt(0)
s_barrier
v_mfma_f32_16x16x32_bf16 v[64:67], v[144:147], v[160:163], v[64:67]
ds_read_b128 v[32:35], v128 offset:32768
v_mfma_f32_16x16x32_bf16 v[96:99], v[144:147], v[164:167], v[96:99]
ds_read_b128 v[48:51], v130 offset:32768
v_mfma_f32_16x16x32_bf16 v[80:83], v[144:147], v[168:171], v[80:83]
ds_read_b128 v[52:55], v130 offset:34816
v_mfma_f32_16x16x32_bf16 v[112:115], v[144:147], v[172:175], v[112:115]
ds_read_b128 v[56:59], v130 offset:36864
v_mfma_f32_16x16x32_bf16 v[68:71], v[148:151], v[160:163], v[68:71]
ds_read_b128 v[60:63], v130 offset:38912
v_mfma_f32_16x16x32_bf16 v[100:103], v[148:151], v[164:167], v[100:103]
ds_read_b128 v[36:39], v128 offset:34816
v_mfma_f32_16x16x32_bf16 v[84:87], v[148:151], v[168:171], v[84:87]
ds_read_b128 v[40:43], v128 offset:36864
v_mfma_f32_16x16x32_bf16 v[116:119], v[148:151], v[172:175], v[116:119]
ds_read_b128 v[44:47], v128 offset:38912
v_mfma_f32_16x16x32_bf16 v[72:75], v[152:155], v[160:163], v[72:75]
v_mfma_f32_16x16x32_bf16 v[104:107], v[152:155], v[164:167], v[104:107]
v_mfma_f32_16x16x32_bf16 v[88:91], v[152:155], v[168:171], v[88:91]
v_mfma_f32_16x16x32_bf16 v[120:123], v[152:155], v[172:175], v[120:123]
v_mfma_f32_16x16x32_bf16 v[76:79], v[156:159], v[160:163], v[76:79]
v_mfma_f32_16x16x32_bf16 v[108:111], v[156:159], v[164:167], v[108:111]
v_mfma_f32_16x16x32_bf16 v[92:95], v[156:159], v[168:171], v[92:95]
v_mfma_f32_16x16x32_bf16 v[124:127], v[156:159], v[172:175], v[124:127]
v_mov_b32 v8, 0
global_load_dword v9, v8, s[30:31] sc1
s_waitcnt lgkmcnt(6)
v_mfma_f32_16x16x32_bf16 v[64:67], v[32:35], v[48:51], v[64:67]
ds_read_b128 v[144:147], v129 offset:32768
s_waitcnt lgkmcnt(6)
v_mfma_f32_16x16x32_bf16 v[96:99], v[32:35], v[52:55], v[96:99]
ds_read_b128 v[160:163], v131 offset:32768
s_waitcnt lgkmcnt(6)
v_mfma_f32_16x16x32_bf16 v[80:83], v[32:35], v[56:59], v[80:83]
ds_read_b128 v[164:167], v131 offset:34816
s_waitcnt lgkmcnt(6)
v_mfma_f32_16x16x32_bf16 v[112:115], v[32:35], v[60:63], v[112:115]
ds_read_b128 v[168:171], v131 offset:36864
s_waitcnt lgkmcnt(6)
v_mfma_f32_16x16x32_bf16 v[68:71], v[36:39], v[48:51], v[68:71]
ds_read_b128 v[172:175], v131 offset:38912
v_mfma_f32_16x16x32_bf16 v[100:103], v[36:39], v[52:55], v[100:103]
ds_read_b128 v[148:151], v129 offset:34816
v_mfma_f32_16x16x32_bf16 v[84:87], v[36:39], v[56:59], v[84:87]
ds_read_b128 v[152:155], v129 offset:36864
v_mfma_f32_16x16x32_bf16 v[116:119], v[36:39], v[60:63], v[116:119]
ds_read_b128 v[156:159], v129 offset:38912
s_waitcnt lgkmcnt(9)
v_mfma_f32_16x16x32_bf16 v[72:75], v[40:43], v[48:51], v[72:75]
v_mfma_f32_16x16x32_bf16 v[104:107], v[40:43], v[52:55], v[104:107]
v_mfma_f32_16x16x32_bf16 v[88:91], v[40:43], v[56:59], v[88:91]
v_mfma_f32_16x16x32_bf16 v[120:123], v[40:43], v[60:63], v[120:123]
s_waitcnt lgkmcnt(8)
v_mfma_f32_16x16x32_bf16 v[76:79], v[44:47], v[48:51], v[76:79]
v_mfma_f32_16x16x32_bf16 v[108:111], v[44:47], v[52:55], v[108:111]
v_mfma_f32_16x16x32_bf16 v[92:95], v[44:47], v[56:59], v[92:95]
v_mfma_f32_16x16x32_bf16 v[124:127], v[44:47], v[60:63], v[124:127]
s_waitcnt lgkmcnt(0)
s_barrier
v_mfma_f32_16x16x32_bf16 v[64:67], v[144:147], v[160:163], v[64:67]
ds_read_b128 v[32:35], v132 offset:0
v_mfma_f32_16x16x32_bf16 v[96:99], v[144:147], v[164:167], v[96:99]
ds_read_b128 v[48:51], v134 offset:0
v_mfma_f32_16x16x32_bf16 v[80:83], v[144:147], v[168:171], v[80:83]
ds_read_b128 v[52:55], v134 offset:2048
v_mfma_f32_16x16x32_bf16 v[112:115], v[144:147], v[172:175], v[112:115]
ds_read_b128 v[56:59], v134 offset:4096
v_mfma_f32_16x16x32_bf16 v[68:71], v[148:151], v[160:163], v[68:71]
ds_read_b128 v[60:63], v134 offset:6144
v_mfma_f32_16x16x32_bf16 v[100:103], v[148:151], v[164:167], v[100:103]
ds_read_b128 v[36:39], v132 offset:2048
v_mfma_f32_16x16x32_bf16 v[84:87], v[148:151], v[168:171], v[84:87]
ds_read_b128 v[40:43], v132 offset:4096
v_mfma_f32_16x16x32_bf16 v[116:119], v[148:151], v[172:175], v[116:119]
ds_read_b128 v[44:47], v132 offset:6144
v_mfma_f32_16x16x32_bf16 v[72:75], v[152:155], v[160:163], v[72:75]
v_mfma_f32_16x16x32_bf16 v[104:107], v[152:155], v[164:167], v[104:107]
v_mfma_f32_16x16x32_bf16 v[88:91], v[152:155], v[168:171], v[88:91]
v_mfma_f32_16x16x32_bf16 v[120:123], v[152:155], v[172:175], v[120:123]
v_mfma_f32_16x16x32_bf16 v[76:79], v[156:159], v[160:163], v[76:79]
v_mfma_f32_16x16x32_bf16 v[108:111], v[156:159], v[164:167], v[108:111]
v_mfma_f32_16x16x32_bf16 v[92:95], v[156:159], v[168:171], v[92:95]
v_mfma_f32_16x16x32_bf16 v[124:127], v[156:159], v[172:175], v[124:127]
s_waitcnt lgkmcnt(6)
v_mfma_f32_16x16x32_bf16 v[64:67], v[32:35], v[48:51], v[64:67]
ds_read_b128 v[144:147], v133 offset:0
s_waitcnt lgkmcnt(6)
v_mfma_f32_16x16x32_bf16 v[96:99], v[32:35], v[52:55], v[96:99]
ds_read_b128 v[160:163], v135 offset:0
s_waitcnt lgkmcnt(6)
v_mfma_f32_16x16x32_bf16 v[80:83], v[32:35], v[56:59], v[80:83]
ds_read_b128 v[164:167], v135 offset:2048
s_waitcnt lgkmcnt(6)
v_mfma_f32_16x16x32_bf16 v[112:115], v[32:35], v[60:63], v[112:115]
ds_read_b128 v[168:171], v135 offset:4096
s_waitcnt lgkmcnt(6)
v_mfma_f32_16x16x32_bf16 v[68:71], v[36:39], v[48:51], v[68:71]
ds_read_b128 v[172:175], v135 offset:6144
v_mfma_f32_16x16x32_bf16 v[100:103], v[36:39], v[52:55], v[100:103]
ds_read_b128 v[148:151], v133 offset:2048
v_mfma_f32_16x16x32_bf16 v[84:87], v[36:39], v[56:59], v[84:87]
ds_read_b128 v[152:155], v133 offset:4096
v_mfma_f32_16x16x32_bf16 v[116:119], v[36:39], v[60:63], v[116:119]
ds_read_b128 v[156:159], v133 offset:6144
s_waitcnt lgkmcnt(9)
v_mfma_f32_16x16x32_bf16 v[72:75], v[40:43], v[48:51], v[72:75]
v_mfma_f32_16x16x32_bf16 v[104:107], v[40:43], v[52:55], v[104:107]
v_mfma_f32_16x16x32_bf16 v[88:91], v[40:43], v[56:59], v[88:91]
v_mfma_f32_16x16x32_bf16 v[120:123], v[40:43], v[60:63], v[120:123]
s_waitcnt lgkmcnt(8)
v_mfma_f32_16x16x32_bf16 v[76:79], v[44:47], v[48:51], v[76:79]
v_mfma_f32_16x16x32_bf16 v[108:111], v[44:47], v[52:55], v[108:111]
v_mfma_f32_16x16x32_bf16 v[92:95], v[44:47], v[56:59], v[92:95]
v_mfma_f32_16x16x32_bf16 v[124:127], v[44:47], v[60:63], v[124:127]
s_waitcnt lgkmcnt(0)
s_barrier
v_mfma_f32_16x16x32_bf16 v[64:67], v[144:147], v[160:163], v[64:67]
ds_read_b128 v[32:35], v128 offset:0
v_mfma_f32_16x16x32_bf16 v[96:99], v[144:147], v[164:167], v[96:99]
ds_read_b128 v[48:51], v130 offset:0
v_mfma_f32_16x16x32_bf16 v[80:83], v[144:147], v[168:171], v[80:83]
ds_read_b128 v[52:55], v130 offset:2048
v_mfma_f32_16x16x32_bf16 v[112:115], v[144:147], v[172:175], v[112:115]
ds_read_b128 v[56:59], v130 offset:4096
v_mfma_f32_16x16x32_bf16 v[68:71], v[148:151], v[160:163], v[68:71]
ds_read_b128 v[60:63], v130 offset:6144
v_mfma_f32_16x16x32_bf16 v[100:103], v[148:151], v[164:167], v[100:103]
ds_read_b128 v[36:39], v128 offset:2048
v_mfma_f32_16x16x32_bf16 v[84:87], v[148:151], v[168:171], v[84:87]
ds_read_b128 v[40:43], v128 offset:4096
v_mfma_f32_16x16x32_bf16 v[116:119], v[148:151], v[172:175], v[116:119]
ds_read_b128 v[44:47], v128 offset:6144
v_mfma_f32_16x16x32_bf16 v[72:75], v[152:155], v[160:163], v[72:75]
v_mfma_f32_16x16x32_bf16 v[104:107], v[152:155], v[164:167], v[104:107]
v_mfma_f32_16x16x32_bf16 v[88:91], v[152:155], v[168:171], v[88:91]
v_mfma_f32_16x16x32_bf16 v[120:123], v[152:155], v[172:175], v[120:123]
v_mfma_f32_16x16x32_bf16 v[76:79], v[156:159], v[160:163], v[76:79]
v_mfma_f32_16x16x32_bf16 v[108:111], v[156:159], v[164:167], v[108:111]
v_mfma_f32_16x16x32_bf16 v[92:95], v[156:159], v[168:171], v[92:95]
v_mfma_f32_16x16x32_bf16 v[124:127], v[156:159], v[172:175], v[124:127]
s_waitcnt lgkmcnt(6)
v_mfma_f32_16x16x32_bf16 v[64:67], v[32:35], v[48:51], v[64:67]
ds_read_b128 v[144:147], v129 offset:0
s_waitcnt lgkmcnt(6)
v_mfma_f32_16x16x32_bf16 v[96:99], v[32:35], v[52:55], v[96:99]
ds_read_b128 v[160:163], v131 offset:0
s_waitcnt lgkmcnt(6)
v_mfma_f32_16x16x32_bf16 v[80:83], v[32:35], v[56:59], v[80:83]
ds_read_b128 v[164:167], v131 offset:2048
s_waitcnt lgkmcnt(6)
v_mfma_f32_16x16x32_bf16 v[112:115], v[32:35], v[60:63], v[112:115]
ds_read_b128 v[168:171], v131 offset:4096
s_waitcnt lgkmcnt(6)
v_mfma_f32_16x16x32_bf16 v[68:71], v[36:39], v[48:51], v[68:71]
ds_read_b128 v[172:175], v131 offset:6144
v_mfma_f32_16x16x32_bf16 v[100:103], v[36:39], v[52:55], v[100:103]
ds_read_b128 v[148:151], v129 offset:2048
v_mfma_f32_16x16x32_bf16 v[84:87], v[36:39], v[56:59], v[84:87]
ds_read_b128 v[152:155], v129 offset:4096
v_mfma_f32_16x16x32_bf16 v[116:119], v[36:39], v[60:63], v[116:119]
ds_read_b128 v[156:159], v129 offset:6144
s_waitcnt lgkmcnt(9)
v_mfma_f32_16x16x32_bf16 v[72:75], v[40:43], v[48:51], v[72:75]
v_mfma_f32_16x16x32_bf16 v[104:107], v[40:43], v[52:55], v[104:107]
v_mfma_f32_16x16x32_bf16 v[88:91], v[40:43], v[56:59], v[88:91]
v_mfma_f32_16x16x32_bf16 v[120:123], v[40:43], v[60:63], v[120:123]
s_waitcnt lgkmcnt(8)
v_mfma_f32_16x16x32_bf16 v[76:79], v[44:47], v[48:51], v[76:79]
v_mfma_f32_16x16x32_bf16 v[108:111], v[44:47], v[52:55], v[108:111]
v_mfma_f32_16x16x32_bf16 v[92:95], v[44:47], v[56:59], v[92:95]
v_mfma_f32_16x16x32_bf16 v[124:127], v[44:47], v[60:63], v[124:127]
L_n49:
s_waitcnt vmcnt(0)
v_readfirstlane_b32 s37, v9
s_nop 0
s_cmp_lg_u32 s37, 0
s_cbranch_scc1 L_ng50
global_load_dword v9, v8, s[30:31] sc1
s_branch L_n49
L_ng50:
s_getreg_b32 s60, hwreg(HW_REG_XCC_ID, 0, 4)
s_lshl_b32 s61, s37, 4
s_or_b32 s100, s60, s61
v_mov_b32 v194, s100
v_mov_b32 v202, s37
v_mov_b32 v203, s37
s_waitcnt lgkmcnt(0)
v_mfma_f32_16x16x32_bf16 v[64:67], v[144:147], v[160:163], v[64:67]
v_mfma_f32_16x16x32_bf16 v[96:99], v[144:147], v[164:167], v[96:99]
v_mfma_f32_16x16x32_bf16 v[80:83], v[144:147], v[168:171], v[80:83]
v_mfma_f32_16x16x32_bf16 v[112:115], v[144:147], v[172:175], v[112:115]
v_mfma_f32_16x16x32_bf16 v[68:71], v[148:151], v[160:163], v[68:71]
v_mfma_f32_16x16x32_bf16 v[100:103], v[148:151], v[164:167], v[100:103]
v_mfma_f32_16x16x32_bf16 v[84:87], v[148:151], v[168:171], v[84:87]
v_mfma_f32_16x16x32_bf16 v[116:119], v[148:151], v[172:175], v[116:119]
v_mfma_f32_16x16x32_bf16 v[72:75], v[152:155], v[160:163], v[72:75]
v_mfma_f32_16x16x32_bf16 v[104:107], v[152:155], v[164:167], v[104:107]
v_mfma_f32_16x16x32_bf16 v[88:91], v[152:155], v[168:171], v[88:91]
v_mfma_f32_16x16x32_bf16 v[120:123], v[152:155], v[172:175], v[120:123]
v_mfma_f32_16x16x32_bf16 v[76:79], v[156:159], v[160:163], v[76:79]
v_mfma_f32_16x16x32_bf16 v[108:111], v[156:159], v[164:167], v[108:111]
v_mfma_f32_16x16x32_bf16 v[92:95], v[156:159], v[168:171], v[92:95]
v_mfma_f32_16x16x32_bf16 v[124:127], v[156:159], v[172:175], v[124:127]
v_pk_fma_f32 v[40:41], v[20:21], v[64:65], v[66:67] op_sel_hi:[0,1,1]
v_pk_fma_f32 v[42:43], v[20:21], v[80:81], v[82:83] op_sel_hi:[0,1,1]
v_pk_fma_f32 v[44:45], v[22:23], v[96:97], v[98:99] op_sel_hi:[0,1,1]
v_pk_fma_f32 v[46:47], v[22:23], v[112:113], v[114:115] op_sel_hi:[0,1,1]
v_pk_fma_f32 v[66:67], v[20:21], v[80:81], v[40:41] op_sel:[1,0,0] neg_lo:[1,0,0] neg_hi:[1,0,0]
v_pk_fma_f32 v[82:83], v[20:21], v[64:65], v[42:43] op_sel:[1,0,0]
v_pk_fma_f32 v[98:99], v[22:23], v[112:113], v[44:45] op_sel:[1,0,0] neg_lo:[1,0,0] neg_hi:[1,0,0]
v_pk_fma_f32 v[114:115], v[22:23], v[96:97], v[46:47] op_sel:[1,0,0]
v_pk_fma_f32 v[40:41], v[20:21], v[66:67], v[68:69] op_sel_hi:[0,1,1]
v_pk_fma_f32 v[42:43], v[20:21], v[82:83], v[84:85] op_sel_hi:[0,1,1]
v_pk_fma_f32 v[44:45], v[22:23], v[98:99], v[100:101] op_sel_hi:[0,1,1]
v_pk_fma_f32 v[46:47], v[22:23], v[114:115], v[116:117] op_sel_hi:[0,1,1]
v_pk_fma_f32 v[68:69], v[20:21], v[82:83], v[40:41] op_sel:[1,0,0] neg_lo:[1,0,0] neg_hi:[1,0,0]
v_pk_fma_f32 v[84:85], v[20:21], v[66:67], v[42:43] op_sel:[1,0,0]
v_pk_fma_f32 v[100:101], v[22:23], v[114:115], v[44:45] op_sel:[1,0,0] neg_lo:[1,0,0] neg_hi:[1,0,0]
v_pk_fma_f32 v[116:117], v[22:23], v[98:99], v[46:47] op_sel:[1,0,0]
v_pk_fma_f32 v[40:41], v[20:21], v[68:69], v[70:71] op_sel_hi:[0,1,1]
v_pk_fma_f32 v[42:43], v[20:21], v[84:85], v[86:87] op_sel_hi:[0,1,1]
v_pk_fma_f32 v[44:45], v[22:23], v[100:101], v[102:103] op_sel_hi:[0,1,1]
v_pk_fma_f32 v[46:47], v[22:23], v[116:117], v[118:119] op_sel_hi:[0,1,1]
v_pk_fma_f32 v[70:71], v[20:21], v[84:85], v[40:41] op_sel:[1,0,0] neg_lo:[1,0,0] neg_hi:[1,0,0]
v_pk_fma_f32 v[86:87], v[20:21], v[68:69], v[42:43] op_sel:[1,0,0]
v_pk_fma_f32 v[102:103], v[22:23], v[116:117], v[44:45] op_sel:[1,0,0] neg_lo:[1,0,0] neg_hi:[1,0,0]
v_pk_fma_f32 v[118:119], v[22:23], v[100:101], v[46:47] op_sel:[1,0,0]
v_pk_fma_f32 v[40:41], v[20:21], v[70:71], v[72:73] op_sel_hi:[0,1,1]
v_pk_fma_f32 v[42:43], v[20:21], v[86:87], v[88:89] op_sel_hi:[0,1,1]
v_pk_fma_f32 v[44:45], v[22:23], v[102:103], v[104:105] op_sel_hi:[0,1,1]
v_pk_fma_f32 v[46:47], v[22:23], v[118:119], v[120:121] op_sel_hi:[0,1,1]
v_pk_fma_f32 v[72:73], v[20:21], v[86:87], v[40:41] op_sel:[1,0,0] neg_lo:[1,0,0] neg_hi:[1,0,0]
v_pk_fma_f32 v[88:89], v[20:21], v[70:71], v[42:43] op_sel:[1,0,0]
v_pk_fma_f32 v[104:105], v[22:23], v[118:119], v[44:45] op_sel:[1,0,0] neg_lo:[1,0,0] neg_hi:[1,0,0]
v_pk_fma_f32 v[120:121], v[22:23], v[102:103], v[46:47] op_sel:[1,0,0]
v_pk_fma_f32 v[40:41], v[20:21], v[72:73], v[74:75] op_sel_hi:[0,1,1]
v_pk_fma_f32 v[42:43], v[20:21], v[88:89], v[90:91] op_sel_hi:[0,1,1]
v_pk_fma_f32 v[44:45], v[22:23], v[104:105], v[106:107] op_sel_hi:[0,1,1]
v_pk_fma_f32 v[46:47], v[22:23], v[120:121], v[122:123] op_sel_hi:[0,1,1]
v_pk_fma_f32 v[74:75], v[20:21], v[88:89], v[40:41] op_sel:[1,0,0] neg_lo:[1,0,0] neg_hi:[1,0,0]
v_pk_fma_f32 v[90:91], v[20:21], v[72:73], v[42:43] op_sel:[1,0,0]
v_pk_fma_f32 v[106:107], v[22:23], v[120:121], v[44:45] op_sel:[1,0,0] neg_lo:[1,0,0] neg_hi:[1,0,0]
v_pk_fma_f32 v[122:123], v[22:23], v[104:105], v[46:47] op_sel:[1,0,0]
v_pk_fma_f32 v[40:41], v[20:21], v[74:75], v[76:77] op_sel_hi:[0,1,1]
v_pk_fma_f32 v[42:43], v[20:21], v[90:91], v[92:93] op_sel_hi:[0,1,1]
v_pk_fma_f32 v[44:45], v[22:23], v[106:107], v[108:109] op_sel_hi:[0,1,1]
v_pk_fma_f32 v[46:47], v[22:23], v[122:123], v[124:125] op_sel_hi:[0,1,1]
v_pk_fma_f32 v[76:77], v[20:21], v[90:91], v[40:41] op_sel:[1,0,0] neg_lo:[1,0,0] neg_hi:[1,0,0]
v_pk_fma_f32 v[92:93], v[20:21], v[74:75], v[42:43] op_sel:[1,0,0]
v_pk_fma_f32 v[108:109], v[22:23], v[122:123], v[44:45] op_sel:[1,0,0] neg_lo:[1,0,0] neg_hi:[1,0,0]
v_pk_fma_f32 v[124:125], v[22:23], v[106:107], v[46:47] op_sel:[1,0,0]
v_pk_fma_f32 v[40:41], v[20:21], v[76:77], v[78:79] op_sel_hi:[0,1,1]
v_pk_fma_f32 v[42:43], v[20:21], v[92:93], v[94:95] op_sel_hi:[0,1,1]
v_pk_fma_f32 v[44:45], v[22:23], v[108:109], v[110:111] op_sel_hi:[0,1,1]
v_pk_fma_f32 v[46:47], v[22:23], v[124:125], v[126:127] op_sel_hi:[0,1,1]
v_pk_fma_f32 v[78:79], v[20:21], v[92:93], v[40:41] op_sel:[1,0,0] neg_lo:[1,0,0] neg_hi:[1,0,0]
v_pk_fma_f32 v[94:95], v[20:21], v[76:77], v[42:43] op_sel:[1,0,0]
v_pk_fma_f32 v[110:111], v[22:23], v[124:125], v[44:45] op_sel:[1,0,0] neg_lo:[1,0,0] neg_hi:[1,0,0]
v_pk_fma_f32 v[126:127], v[22:23], v[108:109], v[46:47] op_sel:[1,0,0]
v_fma_f32 v40, v176, v78, v79
v_fma_f32 v41, v176, v94, v95
v_fma_f32 v32, -v177, v94, v40
v_fma_f32 v33, v177, v78, v41
ds_write_b64 v15, v[32:33] offset:0
v_fma_f32 v40, v178, v110, v111
v_fma_f32 v41, v178, v126, v127
v_fma_f32 v34, -v179, v126, v40
v_fma_f32 v35, v179, v110, v41
ds_write_b64 v15, v[34:35] offset:2304
s_waitcnt lgkmcnt(0)
s_mov_b64 exec, 1
v_mov_b32 v197, 17
ds_write_b32 v13, v197 offset:32
s_mov_b64 exec, -1
L_ek51:
ds_read_b128 v[198:201], v12 offset:32
s_waitcnt lgkmcnt(0)
v_min3_u32 v197, v198, v199, v200
v_min_u32 v197, v197, v201
s_nop 0
v_readfirstlane_b32 s60, v197
s_nop 0
s_cmp_lt_u32 s60, 17
s_cbranch_scc1 L_ek51
ds_read_b128 v[48:51], v14
ds_read_b128 v[52:55], v14 offset:16
s_waitcnt lgkmcnt(1)
v_fma_f32 v40, v28, v48, v50
v_fma_f32 v41, v28, v49, v51
v_fma_f32 v32, -v29, v49, v40
v_fma_f32 v33, v29, v48, v41
s_waitcnt lgkmcnt(0)
v_fma_f32 v40, v28, v32, v52
v_fma_f32 v41, v28, v33, v53
v_fma_f32 v34, -v29, v33, v40
v_fma_f32 v35, v29, v32, v41
v_fma_f32 v40, v28, v34, v54
v_fma_f32 v41, v28, v35, v55
v_fma_f32 v32, -v29, v35, v40
v_fma_f32 v33, v29, v34, v41
v_mov_b32 v34, v32
v_mov_b32 v35, v33
s_nop 0
v_permlane32_swap_b32 v32, v34
v_permlane32_swap_b32 v33, v35
v_fma_f32 v40, v192, v32, v34
v_fma_f32 v41, v192, v33, v35
v_fma_f32 v200, -v193, v33, v40
v_fma_f32 v201, v193, v32, v41
s_cmp_lg_u32 s68, 0
s_cbranch_scc1 L_np53
buffer_store_dwordx4 v[200:203], v16, s[40:43], 0 offen sc1
s_cmp_lg_u32 s66, 0
s_cbranch_scc1 L_np53
s_mov_b64 exec, 1
global_store_dword v195, v194, s[32:33] sc1
s_mov_b64 exec, -1
L_np53:
global_load_dword v243, v18, s[32:33] sc1
v_add_u32 v15, -56, v15
ds_read_b64 v[32:33], v15 offset:0
ds_read_b64 v[34:35], v15 offset:8
ds_read_b64 v[36:37], v15 offset:16
ds_read_b64 v[38:39], v15 offset:24
ds_read_b64 v[40:41], v15 offset:32
ds_read_b64 v[42:43], v15 offset:40
ds_read_b64 v[44:45], v15 offset:48
ds_read_b64 v[46:47], v15 offset:2304
ds_read_b64 v[48:49], v15 offset:2312
ds_read_b64 v[50:51], v15 offset:2320
ds_read_b64 v[52:53], v15 offset:2328
ds_read_b64 v[54:55], v15 offset:2336
ds_read_b64 v[56:57], v15 offset:2344
ds_read_b64 v[58:59], v15 offset:2352
s_waitcnt lgkmcnt(0)
v_fma_f32 v60, v180, v32, v34
v_fma_f32 v61, v180, v33, v35
v_fma_f32 v34, -v181, v33, v60
v_fma_f32 v35, v181, v32, v61
v_fma_f32 v60, v180, v34, v36
v_fma_f32 v61, v180, v35, v37
v_fma_f32 v36, -v181, v35, v60
v_fma_f32 v37, v181, v34, v61
v_fma_f32 v60, v180, v36, v38
v_fma_f32 v61, v180, v37, v39
v_fma_f32 v38, -v181, v37, v60
v_fma_f32 v39, v181, v36, v61
v_fma_f32 v60, v180, v38, v40
v_fma_f32 v61, v180, v39, v41
v_fma_f32 v40, -v181, v39, v60
v_fma_f32 v41, v181, v38, v61
v_fma_f32 v60, v180, v40, v42
v_fma_f32 v61, v180, v41, v43
v_fma_f32 v42, -v181, v41, v60
v_fma_f32 v43, v181, v40, v61
v_fma_f32 v60, v180, v42, v44
v_fma_f32 v61, v180, v43, v45
v_fma_f32 v128, -v181, v43, v60
v_fma_f32 v130, v181, v42, v61
v_fma_f32 v60, v176, v128, v78
v_fma_f32 v61, v176, v130, v94
v_fma_f32 v129, -v177, v130, v60
v_fma_f32 v131, v177, v128, v61
v_fma_f32 v60, v182, v46, v48
v_fma_f32 v61, v182, v47, v49
v_fma_f32 v48, -v183, v47, v60
v_fma_f32 v49, v183, v46, v61
v_fma_f32 v60, v182, v48, v50
v_fma_f32 v61, v182, v49, v51
v_fma_f32 v50, -v183, v49, v60
v_fma_f32 v51, v183, v48, v61
v_fma_f32 v60, v182, v50, v52
v_fma_f32 v61, v182, v51, v53
v_fma_f32 v52, -v183, v51, v60
v_fma_f32 v53, v183, v50, v61
v_fma_f32 v60, v182, v52, v54
v_fma_f32 v61, v182, v53, v55
v_fma_f32 v54, -v183, v53, v60
v_fma_f32 v55, v183, v52, v61
v_fma_f32 v60, v182, v54, v56
v_fma_f32 v61, v182, v55, v57
v_fma_f32 v56, -v183, v55, v60
v_fma_f32 v57, v183, v54, v61
v_fma_f32 v60, v182, v56, v58
v_fma_f32 v61, v182, v57, v59
v_fma_f32 v132, -v183, v57, v60
v_fma_f32 v134, v183, v56, v61
v_fma_f32 v60, v178, v132, v110
v_fma_f32 v61, v178, v134, v126
v_fma_f32 v133, -v179, v134, v60
v_fma_f32 v135, v179, v132, v61
v_pk_mul_f32 v[32:33], v[24:25], v[64:65] op_sel_hi:[0,1]
v_pk_mul_f32 v[34:35], v[24:25], v[80:81] op_sel_hi:[0,1] neg_lo:[1,0] neg_hi:[1,0]
v_pk_fma_f32 v[34:35], v[24:25], v[64:65], v[34:35] op_sel:[1,0,0] neg_lo:[1,0,0] neg_hi:[1,0,0]
v_pk_fma_f32 v[64:65], v[24:25], v[80:81], v[32:33] op_sel:[1,0,0] neg_lo:[1,0,0] neg_hi:[1,0,0]
v_mov_b64 v[80:81], v[34:35]
v_pk_mul_f32 v[36:37], v[26:27], v[96:97] op_sel_hi:[0,1]
v_pk_mul_f32 v[38:39], v[26:27], v[112:113] op_sel_hi:[0,1] neg_lo:[1,0] neg_hi:[1,0]
v_pk_fma_f32 v[38:39], v[26:27], v[96:97], v[38:39] op_sel:[1,0,0] neg_lo:[1,0,0] neg_hi:[1,0,0]
v_pk_fma_f32 v[96:97], v[26:27], v[112:113], v[36:37] op_sel:[1,0,0] neg_lo:[1,0,0] neg_hi:[1,0,0]
v_mov_b64 v[112:113], v[38:39]
v_pk_mul_f32 v[32:33], v[24:25], v[66:67] op_sel_hi:[0,1]
v_pk_mul_f32 v[34:35], v[24:25], v[82:83] op_sel_hi:[0,1] neg_lo:[1,0] neg_hi:[1,0]
v_pk_fma_f32 v[34:35], v[24:25], v[66:67], v[34:35] op_sel:[1,0,0] neg_lo:[1,0,0] neg_hi:[1,0,0]
v_pk_fma_f32 v[66:67], v[24:25], v[82:83], v[32:33] op_sel:[1,0,0] neg_lo:[1,0,0] neg_hi:[1,0,0]
v_mov_b64 v[82:83], v[34:35]
v_pk_mul_f32 v[36:37], v[26:27], v[98:99] op_sel_hi:[0,1]
v_pk_mul_f32 v[38:39], v[26:27], v[114:115] op_sel_hi:[0,1] neg_lo:[1,0] neg_hi:[1,0]
v_pk_fma_f32 v[38:39], v[26:27], v[98:99], v[38:39] op_sel:[1,0,0] neg_lo:[1,0,0] neg_hi:[1,0,0]
v_pk_fma_f32 v[98:99], v[26:27], v[114:115], v[36:37] op_sel:[1,0,0] neg_lo:[1,0,0] neg_hi:[1,0,0]
v_mov_b64 v[114:115], v[38:39]
v_pk_mul_f32 v[32:33], v[24:25], v[68:69] op_sel_hi:[0,1]
v_pk_mul_f32 v[34:35], v[24:25], v[84:85] op_sel_hi:[0,1] neg_lo:[1,0] neg_hi:[1,0]
v_pk_fma_f32 v[34:35], v[24:25], v[68:69], v[34:35] op_sel:[1,0,0] neg_lo:[1,0,0] neg_hi:[1,0,0]
v_pk_fma_f32 v[68:69], v[24:25], v[84:85], v[32:33] op_sel:[1,0,0] neg_lo:[1,0,0] neg_hi:[1,0,0]
v_mov_b64 v[84:85], v[34:35]
v_pk_mul_f32 v[36:37], v[26:27], v[100:101] op_sel_hi:[0,1]
v_pk_mul_f32 v[38:39], v[26:27], v[116:117] op_sel_hi:[0,1] neg_lo:[1,0] neg_hi:[1,0]
v_pk_fma_f32 v[38:39], v[26:27], v[100:101], v[38:39] op_sel:[1,0,0] neg_lo:[1,0,0] neg_hi:[1,0,0]
v_pk_fma_f32 v[100:101], v[26:27], v[116:117], v[36:37] op_sel:[1,0,0] neg_lo:[1,0,0] neg_hi:[1,0,0]
v_mov_b64 v[116:117], v[38:39]
v_pk_mul_f32 v[32:33], v[24:25], v[70:71] op_sel_hi:[0,1]
v_pk_mul_f32 v[34:35], v[24:25], v[86:87] op_sel_hi:[0,1] neg_lo:[1,0] neg_hi:[1,0]
v_pk_fma_f32 v[34:35], v[24:25], v[70:71], v[34:35] op_sel:[1,0,0] neg_lo:[1,0,0] neg_hi:[1,0,0]
v_pk_fma_f32 v[70:71], v[24:25], v[86:87], v[32:33] op_sel:[1,0,0] neg_lo:[1,0,0] neg_hi:[1,0,0]
v_mov_b64 v[86:87], v[34:35]
v_pk_mul_f32 v[36:37], v[26:27], v[102:103] op_sel_hi:[0,1]
v_pk_mul_f32 v[38:39], v[26:27], v[118:119] op_sel_hi:[0,1] neg_lo:[1,0] neg_hi:[1,0]
v_pk_fma_f32 v[38:39], v[26:27], v[102:103], v[38:39] op_sel:[1,0,0] neg_lo:[1,0,0] neg_hi:[1,0,0]
v_pk_fma_f32 v[102:103], v[26:27], v[118:119], v[36:37] op_sel:[1,0,0] neg_lo:[1,0,0] neg_hi:[1,0,0]
v_mov_b64 v[118:119], v[38:39]
v_pk_mul_f32 v[32:33], v[24:25], v[72:73] op_sel_hi:[0,1]
v_pk_mul_f32 v[34:35], v[24:25], v[88:89] op_sel_hi:[0,1] neg_lo:[1,0] neg_hi:[1,0]
v_pk_fma_f32 v[34:35], v[24:25], v[72:73], v[34:35] op_sel:[1,0,0] neg_lo:[1,0,0] neg_hi:[1,0,0]
v_pk_fma_f32 v[72:73], v[24:25], v[88:89], v[32:33] op_sel:[1,0,0] neg_lo:[1,0,0] neg_hi:[1,0,0]
v_mov_b64 v[88:89], v[34:35]
v_pk_mul_f32 v[36:37], v[26:27], v[104:105] op_sel_hi:[0,1]
v_pk_mul_f32 v[38:39], v[26:27], v[120:121] op_sel_hi:[0,1] neg_lo:[1,0] neg_hi:[1,0]
v_pk_fma_f32 v[38:39], v[26:27], v[104:105], v[38:39] op_sel:[1,0,0] neg_lo:[1,0,0] neg_hi:[1,0,0]
v_pk_fma_f32 v[104:105], v[26:27], v[120:121], v[36:37] op_sel:[1,0,0] neg_lo:[1,0,0] neg_hi:[1,0,0]
v_mov_b64 v[120:121], v[38:39]
v_pk_mul_f32 v[32:33], v[24:25], v[74:75] op_sel_hi:[0,1]
v_pk_mul_f32 v[34:35], v[24:25], v[90:91] op_sel_hi:[0,1] neg_lo:[1,0] neg_hi:[1,0]
v_pk_fma_f32 v[34:35], v[24:25], v[74:75], v[34:35] op_sel:[1,0,0] neg_lo:[1,0,0] neg_hi:[1,0,0]
v_pk_fma_f32 v[74:75], v[24:25], v[90:91], v[32:33] op_sel:[1,0,0] neg_lo:[1,0,0] neg_hi:[1,0,0]
v_mov_b64 v[90:91], v[34:35]
v_pk_mul_f32 v[36:37], v[26:27], v[106:107] op_sel_hi:[0,1]
v_pk_mul_f32 v[38:39], v[26:27], v[122:123] op_sel_hi:[0,1] neg_lo:[1,0] neg_hi:[1,0]
v_pk_fma_f32 v[38:39], v[26:27], v[106:107], v[38:39] op_sel:[1,0,0] neg_lo:[1,0,0] neg_hi:[1,0,0]
v_pk_fma_f32 v[106:107], v[26:27], v[122:123], v[36:37] op_sel:[1,0,0] neg_lo:[1,0,0] neg_hi:[1,0,0]
v_mov_b64 v[122:123], v[38:39]
v_pk_mul_f32 v[32:33], v[24:25], v[76:77] op_sel_hi:[0,1]
v_pk_mul_f32 v[34:35], v[24:25], v[92:93] op_sel_hi:[0,1] neg_lo:[1,0] neg_hi:[1,0]
v_pk_fma_f32 v[34:35], v[24:25], v[76:77], v[34:35] op_sel:[1,0,0] neg_lo:[1,0,0] neg_hi:[1,0,0]
v_pk_fma_f32 v[76:77], v[24:25], v[92:93], v[32:33] op_sel:[1,0,0] neg_lo:[1,0,0] neg_hi:[1,0,0]
v_mov_b64 v[92:93], v[34:35]
v_pk_mul_f32 v[36:37], v[26:27], v[108:109] op_sel_hi:[0,1]
v_pk_mul_f32 v[38:39], v[26:27], v[124:125] op_sel_hi:[0,1] neg_lo:[1,0] neg_hi:[1,0]
v_pk_fma_f32 v[38:39], v[26:27], v[108:109], v[38:39] op_sel:[1,0,0] neg_lo:[1,0,0] neg_hi:[1,0,0]
v_pk_fma_f32 v[108:109], v[26:27], v[124:125], v[36:37] op_sel:[1,0,0] neg_lo:[1,0,0] neg_hi:[1,0,0]
v_mov_b64 v[124:125], v[38:39]
v_pk_mul_f32 v[32:33], v[24:25], v[78:79] op_sel_hi:[0,1]
v_pk_mul_f32 v[34:35], v[24:25], v[94:95] op_sel_hi:[0,1] neg_lo:[1,0] neg_hi:[1,0]
v_pk_fma_f32 v[34:35], v[24:25], v[78:79], v[34:35] op_sel:[1,0,0] neg_lo:[1,0,0] neg_hi:[1,0,0]
v_pk_fma_f32 v[78:79], v[24:25], v[94:95], v[32:33] op_sel:[1,0,0] neg_lo:[1,0,0] neg_hi:[1,0,0]
v_mov_b64 v[94:95], v[34:35]
v_pk_mul_f32 v[36:37], v[26:27], v[110:111] op_sel_hi:[0,1]
v_pk_mul_f32 v[38:39], v[26:27], v[126:127] op_sel_hi:[0,1] neg_lo:[1,0] neg_hi:[1,0]
v_pk_fma_f32 v[38:39], v[26:27], v[110:111], v[38:39] op_sel:[1,0,0] neg_lo:[1,0,0] neg_hi:[1,0,0]
v_pk_fma_f32 v[110:111], v[26:27], v[126:127], v[36:37] op_sel:[1,0,0] neg_lo:[1,0,0] neg_hi:[1,0,0]
v_mov_b64 v[126:127], v[38:39]
buffer_load_dwordx4 v[144:147], v136, s[40:43], 0 offen sc1
buffer_load_dwordx4 v[148:151], v137, s[40:43], 0 offen sc1
buffer_load_dwordx4 v[152:155], v138, s[40:43], 0 offen sc1
buffer_load_dwordx4 v[156:159], v139, s[40:43], 0 offen sc1
buffer_load_dwordx4 v[160:163], v140, s[40:43], 0 offen sc1
buffer_load_dwordx4 v[164:167], v141, s[40:43], 0 offen sc1
buffer_load_dwordx4 v[168:171], v142, s[40:43], 0 offen sc1
buffer_load_dwordx4 v[172:175], v143, s[40:43], 0 offen sc1
global_load_dword v197, v196, s[32:33] sc1
v_mov_b32 v14, 1
s_mov_b64 exec, 1
ds_write_b32 v13, v14
s_mov_b64 exec, -1
s_xor_b32 s60, s68, s101
s_xor_b32 s60, s60, 1
s_lshl_b32 s60, s60, 6
s_add_u32 s60, s60, s66
v_lshrrev_b32 v8, 3, v1
v_lshl_add_u32 v8, v8, 1, s60
v_lshlrev_b32 v8, 11, v8
v_and_b32 v14, 7, v1
v_lshrrev_b32 v15, 4, v1
v_xor_b32 v14, v14, v15
v_lshlrev_b32 v14, 4, v14
v_xor_b32 v15, 64, v14
v_add_u32 v244, v8, v14
v_add_u32 v245, v8, v15
v_add_u32 v245, 31744, v245
v_add_u32 v246, v8, v14
v_add_u32 v246, 63488, v246
v_add_u32 v247, v8, v15
v_add_u32 v247, 95232, v247
s_and_b32 s64, s36, 7
s_lshl_b32 s60, s64, 18
s_lshl_b32 s61, s101, 10
s_add_u32 s60, s60, s61
s_add_u32 s48, s20, s60
s_addc_u32 s49, s21, 0
s_sub_u32 s50, 262144, s61
s_mov_b32 s51, 0x20000
s_add_u32 s52, s22, s60
s_addc_u32 s53, s23, 0
s_sub_u32 s54, 262144, s61
s_mov_b32 s55, 0x20000
s_lshl_b32 s61, s64, 1
s_add_u32 s61, s61, s101
s_lshl_b32 s61, s61, 7
s_lshl_b32 s63, s35, 1
s_add_u32 s63, s63, s68
s_lshl_b32 s60, s63, 17
s_add_u32 s60, s60, s61
s_add_u32 s56, s10, s60
s_addc_u32 s57, s11, 0
s_sub_u32 s58, 131072, s61
s_mov_b32 s59, 0x20000
s_add_u32 s26, s26, s61
s_addc_u32 s27, s27, 0
s_lshl_b32 s61, s61, 1
s_add_u32 s61, s61, 4096
s_lshl_b32 s60, s63, 19
s_add_u32 s60, s60, s61
s_add_u32 s28, s28, s60
s_addc_u32 s29, s29, 0
s_sub_u32 s24, 0x80000, s61
s_lshl_b32 s67, s34, 12
s_lshl_b32 s65, s64, 13
s_lshl_b32 s64, s64, 7
s_lshl_b32 s60, s68, 14
s_lshl_b32 s61, s66, 11
s_add_u32 s60, s60, s61
s_add_u32 s60, s60, 65536
v_add_u32 v16, s60, v10
s_lshl_b32 s60, s34, 13
s_add_u32 s60, s60, 65536
v_add_u32 v17, s60, v11
v_xor_b32 v20, 0, v7
v_add_u32 v24, 0x10000, v20
v_xor_b32 v21, 32, v7
v_add_u32 v25, 0x10000, v21
v_xor_b32 v22, 64, v7
v_add_u32 v26, 0x10000, v22
v_xor_b32 v23, 96, v7
v_add_u32 v27, 0x10000, v23
s_mul_i32 s14, s63, 262144
s_lshl_b32 s61, s36, 13
s_add_u32 s14, s14, s61
s_lshl_b32 s61, s66, 11
s_add_u32 s14, s14, s61
v_cmp_gt_u32 vcc, 0x40000, v136
s_nop 1
v_cndmask_b32 v40, 0, v202, vcc
v_cmp_gt_u32 vcc, 0x40000, v137
s_nop 1
v_cndmask_b32 v41, 0, v202, vcc
v_cmp_gt_u32 vcc, 0x40000, v138
s_nop 1
v_cndmask_b32 v42, 0, v202, vcc
v_cmp_gt_u32 vcc, 0x40000, v139
s_nop 1
v_cndmask_b32 v43, 0, v202, vcc
v_cmp_gt_u32 vcc, 0x40000, v140
s_nop 1
v_cndmask_b32 v44, 0, v202, vcc
v_cmp_gt_u32 vcc, 0x40000, v141
s_nop 1
v_cndmask_b32 v45, 0, v202, vcc
v_cmp_gt_u32 vcc, 0x40000, v142
s_nop 1
v_cndmask_b32 v46, 0, v202, vcc
v_cmp_gt_u32 vcc, 0x40000, v143
s_nop 1
v_cndmask_b32 v47, 0, v202, vcc
s_mov_b32 s69, 0
L_poll54:
v_mov_b32 v8, 0
s_waitcnt vmcnt(8)
v_bitop3_b32 v8, v8, v146, v40 bitop3:0xf6
v_bitop3_b32 v8, v8, v147, v40 bitop3:0xf6
s_waitcnt vmcnt(7)
v_bitop3_b32 v8, v8, v150, v41 bitop3:0xf6
v_bitop3_b32 v8, v8, v151, v41 bitop3:0xf6
s_waitcnt vmcnt(6)
v_bitop3_b32 v8, v8, v154, v42 bitop3:0xf6
v_bitop3_b32 v8, v8, v155, v42 bitop3:0xf6
s_waitcnt vmcnt(5)
v_bitop3_b32 v8, v8, v158, v43 bitop3:0xf6
v_bitop3_b32 v8, v8, v159, v43 bitop3:0xf6
s_waitcnt vmcnt(4)
v_bitop3_b32 v8, v8, v162, v44 bitop3:0xf6
v_bitop3_b32 v8, v8, v163, v44 bitop3:0xf6
s_waitcnt vmcnt(3)
v_bitop3_b32 v8, v8, v166, v45 bitop3:0xf6
v_bitop3_b32 v8, v8, v167, v45 bitop3:0xf6
s_waitcnt vmcnt(2)
v_bitop3_b32 v8, v8, v170, v46 bitop3:0xf6
v_bitop3_b32 v8, v8, v171, v46 bitop3:0xf6
s_waitcnt vmcnt(1)
v_bitop3_b32 v8, v8, v174, v47 bitop3:0xf6
v_bitop3_b32 v8, v8, v175, v47 bitop3:0xf6
s_waitcnt vmcnt(0)
v_xor_b32 v197, v194, v197
v_lshrrev_b32 v9, 4, v197
v_or_b32 v8, v8, v9
v_cmp_ne_u32 vcc, 0, v8
s_nop 0
s_cbranch_vccz L_polled55
s_add_u32 s69, s69, 1
s_cmp_ge_u32 s69, 200000
s_cbranch_scc1 L_polled55
buffer_load_dwordx4 v[144:147], v136, s[40:43], 0 offen sc1
buffer_load_dwordx4 v[148:151], v137, s[40:43], 0 offen sc1
buffer_load_dwordx4 v[152:155], v138, s[40:43], 0 offen sc1
buffer_load_dwordx4 v[156:159], v139, s[40:43], 0 offen sc1
buffer_load_dwordx4 v[160:163], v140, s[40:43], 0 offen sc1
buffer_load_dwordx4 v[164:167], v141, s[40:43], 0 offen sc1
buffer_load_dwordx4 v[168:171], v142, s[40:43], 0 offen sc1
buffer_load_dwordx4 v[172:175], v143, s[40:43], 0 offen sc1
global_load_dword v197, v196, s[32:33] sc1
s_branch L_poll54
L_polled55:
v_cmp_ne_u32 vcc, 0, v197
s_nop 0
s_cmp_eq_u64 vcc, 0
s_cselect_b32 s100, 1, 0
s_add_u32 m0, s67, 0
s_add_u32 s62, s64, 0
s_and_b32 s62, s62, 0x3ff
buffer_load_dwordx4 v244, s[48:51], s62 offen offset:0 lds
buffer_load_dwordx4 v245, s[48:51], s62 offen offset:1024 lds
buffer_load_dwordx4 v246, s[48:51], s62 offen offset:2048 lds
buffer_load_dwordx4 v247, s[48:51], s62 offen offset:3072 lds
s_add_u32 m0, s67, 16384
s_nop 0
buffer_load_dwordx4 v244, s[52:55], s62 offen offset:0 lds
buffer_load_dwordx4 v245, s[52:55], s62 offen offset:1024 lds
buffer_load_dwordx4 v246, s[52:55], s62 offen offset:2048 lds
buffer_load_dwordx4 v247, s[52:55], s62 offen offset:3072 lds
v_mov_b32 v14, 2
s_mov_b64 exec, 1
ds_write_b32 v13, v14
s_mov_b64 exec, -1
v_fma_f32 v40, v2, v172, v168
v_fma_f32 v41, v2, v173, v169
v_fma_f32 v48, -v3, v173, v40
v_fma_f32 v49, v3, v172, v41
v_fma_f32 v40, v2, v48, v164
v_fma_f32 v41, v2, v49, v165
v_fma_f32 v172, -v3, v49, v40
v_fma_f32 v173, v3, v48, v41
v_fma_f32 v40, v2, v172, v160
v_fma_f32 v41, v2, v173, v161
v_fma_f32 v48, -v3, v173, v40
v_fma_f32 v49, v3, v172, v41
v_fma_f32 v40, v2, v48, v156
v_fma_f32 v41, v2, v49, v157
v_fma_f32 v172, -v3, v49, v40
v_fma_f32 v173, v3, v48, v41
v_fma_f32 v40, v2, v172, v152
v_fma_f32 v41, v2, v173, v153
v_fma_f32 v48, -v3, v173, v40
v_fma_f32 v49, v3, v172, v41
v_fma_f32 v40, v2, v48, v148
v_fma_f32 v41, v2, v49, v149
v_fma_f32 v172, -v3, v49, v40
v_fma_f32 v173, v3, v48, v41
v_fma_f32 v40, v2, v172, v144
v_fma_f32 v41, v2, v173, v145
v_fma_f32 v48, -v3, v173, v40
v_fma_f32 v49, v3, v172, v41
v_mov_b32 v50, v48
v_mov_b32 v51, v49
s_nop 0
v_permlane32_swap_b32 v48, v50
v_permlane32_swap_b32 v49, v51
v_fma_f32 v40, v30, v50, v48
v_fma_f32 v41, v30, v51, v49
v_fma_f32 v52, -v31, v51, v40
v_fma_f32 v53, v31, v50, v41
v_mov_b32 v54, v52
v_mov_b32 v55, v53
s_nop 0
v_permlane16_swap_b32 v52, v54
v_permlane16_swap_b32 v53, v55
v_pk_fma_f32 v[128:129], v[52:53], v[184:185], v[128:129] op_sel_hi:[0,1,1]
v_pk_fma_f32 v[130:131], v[52:53], v[186:187], v[130:131] op_sel_hi:[0,1,1]
v_pk_fma_f32 v[128:129], v[52:53], v[186:187], v[128:129] op_sel:[1,0,0] neg_lo:[1,0,0] neg_hi:[1,0,0]
v_pk_fma_f32 v[130:131], v[52:53], v[184:185], v[130:131] op_sel:[1,0,0]
v_pk_fma_f32 v[132:133], v[54:55], v[188:189], v[132:133] op_sel_hi:[0,1,1]
v_pk_fma_f32 v[134:135], v[54:55], v[190:191], v[134:135] op_sel_hi:[0,1,1]
v_pk_fma_f32 v[132:133], v[54:55], v[190:191], v[132:133] op_sel:[1,0,0] neg_lo:[1,0,0] neg_hi:[1,0,0]
v_pk_fma_f32 v[134:135], v[54:55], v[188:189], v[134:135] op_sel:[1,0,0]
v_pk_fma_f32 v[64:65], v[208:209], v[128:129], v[64:65] op_sel_hi:[0,1,1]
v_pk_fma_f32 v[80:81], v[208:209], v[130:131], v[80:81] op_sel_hi:[0,1,1] neg_lo:[1,0,0] neg_hi:[1,0,0]
v_pk_fma_f32 v[64:65], v[208:209], v[130:131], v[64:65] op_sel:[1,0,0] neg_lo:[1,0,0] neg_hi:[1,0,0]
v_pk_fma_f32 v[80:81], v[208:209], v[128:129], v[80:81] op_sel:[1,0,0] neg_lo:[1,0,0] neg_hi:[1,0,0]
v_cvt_pk_bf16_f32 v144, v64, v65
v_cvt_pk_bf16_f32 v152, v80, v81
v_pk_fma_f32 v[96:97], v[224:225], v[132:133], v[96:97] op_sel_hi:[0,1,1]
v_pk_fma_f32 v[112:113], v[224:225], v[134:135], v[112:113] op_sel_hi:[0,1,1] neg_lo:[1,0,0] neg_hi:[1,0,0]
v_pk_fma_f32 v[96:97], v[224:225], v[134:135], v[96:97] op_sel:[1,0,0] neg_lo:[1,0,0] neg_hi:[1,0,0]
v_pk_fma_f32 v[112:113], v[224:225], v[132:133], v[112:113] op_sel:[1,0,0] neg_lo:[1,0,0] neg_hi:[1,0,0]
v_cvt_pk_bf16_f32 v160, v96, v97
v_cvt_pk_bf16_f32 v168, v112, v113
v_pk_fma_f32 v[66:67], v[210:211], v[128:129], v[66:67] op_sel_hi:[0,1,1]
v_pk_fma_f32 v[82:83], v[210:211], v[130:131], v[82:83] op_sel_hi:[0,1,1] neg_lo:[1,0,0] neg_hi:[1,0,0]
v_pk_fma_f32 v[66:67], v[210:211], v[130:131], v[66:67] op_sel:[1,0,0] neg_lo:[1,0,0] neg_hi:[1,0,0]
v_pk_fma_f32 v[82:83], v[210:211], v[128:129], v[82:83] op_sel:[1,0,0] neg_lo:[1,0,0] neg_hi:[1,0,0]
v_cvt_pk_bf16_f32 v145, v66, v67
v_cvt_pk_bf16_f32 v153, v82, v83
v_pk_fma_f32 v[98:99], v[226:227], v[132:133], v[98:99] op_sel_hi:[0,1,1]
v_pk_fma_f32 v[114:115], v[226:227], v[134:135], v[114:115] op_sel_hi:[0,1,1] neg_lo:[1,0,0] neg_hi:[1,0,0]
v_pk_fma_f32 v[98:99], v[226:227], v[134:135], v[98:99] op_sel:[1,0,0] neg_lo:[1,0,0] neg_hi:[1,0,0]
v_pk_fma_f32 v[114:115], v[226:227], v[132:133], v[114:115] op_sel:[1,0,0] neg_lo:[1,0,0] neg_hi:[1,0,0]
v_cvt_pk_bf16_f32 v161, v98, v99
v_cvt_pk_bf16_f32 v169, v114, v115
v_pk_fma_f32 v[68:69], v[212:213], v[128:129], v[68:69] op_sel_hi:[0,1,1]
v_pk_fma_f32 v[84:85], v[212:213], v[130:131], v[84:85] op_sel_hi:[0,1,1] neg_lo:[1,0,0] neg_hi:[1,0,0]
v_pk_fma_f32 v[68:69], v[212:213], v[130:131], v[68:69] op_sel:[1,0,0] neg_lo:[1,0,0] neg_hi:[1,0,0]
v_pk_fma_f32 v[84:85], v[212:213], v[128:129], v[84:85] op_sel:[1,0,0] neg_lo:[1,0,0] neg_hi:[1,0,0]
v_cvt_pk_bf16_f32 v146, v68, v69
v_cvt_pk_bf16_f32 v154, v84, v85
v_pk_fma_f32 v[100:101], v[228:229], v[132:133], v[100:101] op_sel_hi:[0,1,1]
v_pk_fma_f32 v[116:117], v[228:229], v[134:135], v[116:117] op_sel_hi:[0,1,1] neg_lo:[1,0,0] neg_hi:[1,0,0]
v_pk_fma_f32 v[100:101], v[228:229], v[134:135], v[100:101] op_sel:[1,0,0] neg_lo:[1,0,0] neg_hi:[1,0,0]
v_pk_fma_f32 v[116:117], v[228:229], v[132:133], v[116:117] op_sel:[1,0,0] neg_lo:[1,0,0] neg_hi:[1,0,0]
v_cvt_pk_bf16_f32 v162, v100, v101
v_cvt_pk_bf16_f32 v170, v116, v117
v_pk_fma_f32 v[70:71], v[214:215], v[128:129], v[70:71] op_sel_hi:[0,1,1]
v_pk_fma_f32 v[86:87], v[214:215], v[130:131], v[86:87] op_sel_hi:[0,1,1] neg_lo:[1,0,0] neg_hi:[1,0,0]
v_pk_fma_f32 v[70:71], v[214:215], v[130:131], v[70:71] op_sel:[1,0,0] neg_lo:[1,0,0] neg_hi:[1,0,0]
v_pk_fma_f32 v[86:87], v[214:215], v[128:129], v[86:87] op_sel:[1,0,0] neg_lo:[1,0,0] neg_hi:[1,0,0]
v_cvt_pk_bf16_f32 v147, v70, v71
v_cvt_pk_bf16_f32 v155, v86, v87
v_pk_fma_f32 v[102:103], v[230:231], v[132:133], v[102:103] op_sel_hi:[0,1,1]
v_pk_fma_f32 v[118:119], v[230:231], v[134:135], v[118:119] op_sel_hi:[0,1,1] neg_lo:[1,0,0] neg_hi:[1,0,0]
v_pk_fma_f32 v[102:103], v[230:231], v[134:135], v[102:103] op_sel:[1,0,0] neg_lo:[1,0,0] neg_hi:[1,0,0]
v_pk_fma_f32 v[118:119], v[230:231], v[132:133], v[118:119] op_sel:[1,0,0] neg_lo:[1,0,0] neg_hi:[1,0,0]
v_cvt_pk_bf16_f32 v163, v102, v103
v_cvt_pk_bf16_f32 v171, v118, v119
v_mfma_f32_16x16x32_bf16 v[32:35], v[144:147], v[248:251], 0
v_mfma_f32_16x16x32_bf16 v[36:39], v[160:163], v[248:251], 0
v_mfma_f32_16x16x32_bf16 v[40:43], v[144:147], v[252:255], 0
v_mfma_f32_16x16x32_bf16 v[44:47], v[160:163], v[252:255], 0
v_mfma_f32_16x16x32_bf16 v[48:51], v[152:155], v[248:251], 0
v_mfma_f32_16x16x32_bf16 v[52:55], v[168:171], v[248:251], 0
v_mfma_f32_16x16x32_bf16 v[56:59], v[152:155], v[252:255], 0
v_mfma_f32_16x16x32_bf16 v[60:63], v[168:171], v[252:255], 0
v_pk_fma_f32 v[72:73], v[216:217], v[128:129], v[72:73] op_sel_hi:[0,1,1]
v_pk_fma_f32 v[88:89], v[216:217], v[130:131], v[88:89] op_sel_hi:[0,1,1] neg_lo:[1,0,0] neg_hi:[1,0,0]
v_pk_fma_f32 v[72:73], v[216:217], v[130:131], v[72:73] op_sel:[1,0,0] neg_lo:[1,0,0] neg_hi:[1,0,0]
v_pk_fma_f32 v[88:89], v[216:217], v[128:129], v[88:89] op_sel:[1,0,0] neg_lo:[1,0,0] neg_hi:[1,0,0]
v_cvt_pk_bf16_f32 v148, v72, v73
v_cvt_pk_bf16_f32 v156, v88, v89
v_pk_fma_f32 v[104:105], v[232:233], v[132:133], v[104:105] op_sel_hi:[0,1,1]
v_pk_fma_f32 v[120:121], v[232:233], v[134:135], v[120:121] op_sel_hi:[0,1,1] neg_lo:[1,0,0] neg_hi:[1,0,0]
v_pk_fma_f32 v[104:105], v[232:233], v[134:135], v[104:105] op_sel:[1,0,0] neg_lo:[1,0,0] neg_hi:[1,0,0]
v_pk_fma_f32 v[120:121], v[232:233], v[132:133], v[120:121] op_sel:[1,0,0] neg_lo:[1,0,0] neg_hi:[1,0,0]
v_cvt_pk_bf16_f32 v164, v104, v105
v_cvt_pk_bf16_f32 v172, v120, v121
v_pk_fma_f32 v[74:75], v[218:219], v[128:129], v[74:75] op_sel_hi:[0,1,1]
v_pk_fma_f32 v[90:91], v[218:219], v[130:131], v[90:91] op_sel_hi:[0,1,1] neg_lo:[1,0,0] neg_hi:[1,0,0]
v_pk_fma_f32 v[74:75], v[218:219], v[130:131], v[74:75] op_sel:[1,0,0] neg_lo:[1,0,0] neg_hi:[1,0,0]
v_pk_fma_f32 v[90:91], v[218:219], v[128:129], v[90:91] op_sel:[1,0,0] neg_lo:[1,0,0] neg_hi:[1,0,0]
v_cvt_pk_bf16_f32 v149, v74, v75
v_cvt_pk_bf16_f32 v157, v90, v91
v_pk_fma_f32 v[106:107], v[234:235], v[132:133], v[106:107] op_sel_hi:[0,1,1]
v_pk_fma_f32 v[122:123], v[234:235], v[134:135], v[122:123] op_sel_hi:[0,1,1] neg_lo:[1,0,0] neg_hi:[1,0,0]
v_pk_fma_f32 v[106:107], v[234:235], v[134:135], v[106:107] op_sel:[1,0,0] neg_lo:[1,0,0] neg_hi:[1,0,0]
v_pk_fma_f32 v[122:123], v[234:235], v[132:133], v[122:123] op_sel:[1,0,0] neg_lo:[1,0,0] neg_hi:[1,0,0]
v_cvt_pk_bf16_f32 v165, v106, v107
v_cvt_pk_bf16_f32 v173, v122, v123
s_add_u32 s61, s14, 0
v_cvt_pk_bf16_f32 v176, v32, v33
v_cvt_pk_bf16_f32 v177, v34, v35
v_cvt_pk_bf16_f32 v178, v36, v37
v_cvt_pk_bf16_f32 v179, v38, v39
buffer_store_dwordx4 v[176:179], v10, s[44:47], s61 offen offset:0 sc1
ds_write_b128 v16, v[176:179] offset:0
s_add_u32 s61, s14, 131072
v_cvt_pk_bf16_f32 v180, v40, v41
v_cvt_pk_bf16_f32 v181, v42, v43
v_cvt_pk_bf16_f32 v182, v44, v45
v_cvt_pk_bf16_f32 v183, v46, v47
buffer_store_dwordx4 v[180:183], v10, s[44:47], s61 offen offset:0 sc1
ds_write_b128 v16, v[180:183] offset:8192
s_add_u32 s61, s14, 4096
v_cvt_pk_bf16_f32 v184, v48, v49
v_cvt_pk_bf16_f32 v185, v50, v51
v_cvt_pk_bf16_f32 v186, v52, v53
v_cvt_pk_bf16_f32 v187, v54, v55
buffer_store_dwordx4 v[184:187], v10, s[44:47], s61 offen offset:0 sc1
ds_write_b128 v16, v[184:187] offset:4096
s_add_u32 s61, s14, 135168
v_cvt_pk_bf16_f32 v188, v56, v57
v_cvt_pk_bf16_f32 v189, v58, v59
v_cvt_pk_bf16_f32 v190, v60, v61
v_cvt_pk_bf16_f32 v191, v62, v63
buffer_store_dwordx4 v[188:191], v10, s[44:47], s61 offen offset:0 sc1
ds_write_b128 v16, v[188:191] offset:12288
v_pk_fma_f32 v[76:77], v[220:221], v[128:129], v[76:77] op_sel_hi:[0,1,1]
v_pk_fma_f32 v[92:93], v[220:221], v[130:131], v[92:93] op_sel_hi:[0,1,1] neg_lo:[1,0,0] neg_hi:[1,0,0]
v_pk_fma_f32 v[76:77], v[220:221], v[130:131], v[76:77] op_sel:[1,0,0] neg_lo:[1,0,0] neg_hi:[1,0,0]
v_pk_fma_f32 v[92:93], v[220:221], v[128:129], v[92:93] op_sel:[1,0,0] neg_lo:[1,0,0] neg_hi:[1,0,0]
v_cvt_pk_bf16_f32 v150, v76, v77
v_cvt_pk_bf16_f32 v158, v92, v93
v_pk_fma_f32 v[108:109], v[236:237], v[132:133], v[108:109] op_sel_hi:[0,1,1]
v_pk_fma_f32 v[124:125], v[236:237], v[134:135], v[124:125] op_sel_hi:[0,1,1] neg_lo:[1,0,0] neg_hi:[1,0,0]
v_pk_fma_f32 v[108:109], v[236:237], v[134:135], v[108:109] op_sel:[1,0,0] neg_lo:[1,0,0] neg_hi:[1,0,0]
v_pk_fma_f32 v[124:125], v[236:237], v[132:133], v[124:125] op_sel:[1,0,0] neg_lo:[1,0,0] neg_hi:[1,0,0]
v_cvt_pk_bf16_f32 v166, v108, v109
v_cvt_pk_bf16_f32 v174, v124, v125
v_pk_fma_f32 v[78:79], v[222:223], v[128:129], v[78:79] op_sel_hi:[0,1,1]
v_pk_fma_f32 v[94:95], v[222:223], v[130:131], v[94:95] op_sel_hi:[0,1,1] neg_lo:[1,0,0] neg_hi:[1,0,0]
v_pk_fma_f32 v[78:79], v[222:223], v[130:131], v[78:79] op_sel:[1,0,0] neg_lo:[1,0,0] neg_hi:[1,0,0]
v_pk_fma_f32 v[94:95], v[222:223], v[128:129], v[94:95] op_sel:[1,0,0] neg_lo:[1,0,0] neg_hi:[1,0,0]
v_cvt_pk_bf16_f32 v151, v78, v79
v_cvt_pk_bf16_f32 v159, v94, v95
v_pk_fma_f32 v[110:111], v[238:239], v[132:133], v[110:111] op_sel_hi:[0,1,1]
v_pk_fma_f32 v[126:127], v[238:239], v[134:135], v[126:127] op_sel_hi:[0,1,1] neg_lo:[1,0,0] neg_hi:[1,0,0]
v_pk_fma_f32 v[110:111], v[238:239], v[134:135], v[110:111] op_sel:[1,0,0] neg_lo:[1,0,0] neg_hi:[1,0,0]
v_pk_fma_f32 v[126:127], v[238:239], v[132:133], v[126:127] op_sel:[1,0,0] neg_lo:[1,0,0] neg_hi:[1,0,0]
v_cvt_pk_bf16_f32 v167, v110, v111
v_cvt_pk_bf16_f32 v175, v126, v127
v_mfma_f32_16x16x32_bf16 v[32:35], v[148:151], v[248:251], 0
v_mfma_f32_16x16x32_bf16 v[36:39], v[164:167], v[248:251], 0
v_mfma_f32_16x16x32_bf16 v[40:43], v[148:151], v[252:255], 0
v_mfma_f32_16x16x32_bf16 v[44:47], v[164:167], v[252:255], 0
v_mfma_f32_16x16x32_bf16 v[48:51], v[156:159], v[248:251], 0
v_mfma_f32_16x16x32_bf16 v[52:55], v[172:175], v[248:251], 0
v_mfma_f32_16x16x32_bf16 v[56:59], v[156:159], v[252:255], 0
v_mfma_f32_16x16x32_bf16 v[60:63], v[172:175], v[252:255], 0
s_add_u32 s61, s14, 0
v_cvt_pk_bf16_f32 v192, v32, v33
v_cvt_pk_bf16_f32 v193, v34, v35
v_cvt_pk_bf16_f32 v194, v36, v37
v_cvt_pk_bf16_f32 v195, v38, v39
buffer_store_dwordx4 v[192:195], v10, s[44:47], s61 offen offset:256 sc1
ds_write_b128 v16, v[192:195] offset:256
s_add_u32 s61, s14, 131072
v_cvt_pk_bf16_f32 v196, v40, v41
v_cvt_pk_bf16_f32 v197, v42, v43
v_cvt_pk_bf16_f32 v198, v44, v45
v_cvt_pk_bf16_f32 v199, v46, v47
buffer_store_dwordx4 v[196:199], v10, s[44:47], s61 offen offset:256 sc1
ds_write_b128 v16, v[196:199] offset:8448
s_add_u32 s61, s14, 4096
v_cvt_pk_bf16_f32 v200, v48, v49
v_cvt_pk_bf16_f32 v201, v50, v51
v_cvt_pk_bf16_f32 v202, v52, v53
v_cvt_pk_bf16_f32 v203, v54, v55
buffer_store_dwordx4 v[200:203], v10, s[44:47], s61 offen offset:256 sc1
ds_write_b128 v16, v[200:203] offset:4352
s_add_u32 s61, s14, 135168
v_cvt_pk_bf16_f32 v204, v56, v57
v_cvt_pk_bf16_f32 v205, v58, v59
v_cvt_pk_bf16_f32 v206, v60, v61
v_cvt_pk_bf16_f32 v207, v62, v63
buffer_store_dwordx4 v[204:207], v10, s[44:47], s61 offen offset:256 sc1
ds_write_b128 v16, v[204:207] offset:12544
v_mov_b32 v2, v11
s_lshl_b32 s60, s35, 2
s_add_u32 s60, s60, s34
s_mul_i32 s60, s60, 131072
s_lshl_b32 s61, s101, 16
s_add_u32 s60, s60, s61
s_add_u32 s42, s60, 1048576
s_add_u32 s40, s32, s42
s_addc_u32 s41, s33, 0
s_mov_b32 s42, 65536
s_mov_b32 s43, 0x20000
s_waitcnt vmcnt(8) lgkmcnt(0)
v_mov_b32 v14, 3
s_mov_b64 exec, 1
ds_write_b32 v13, v14
s_mov_b64 exec, -1
ds_read_b128 v[8:11], v12 offset:0
s_waitcnt lgkmcnt(0)
L_ck56:
v_min3_u32 v15, v8, v9, v10
v_min_u32 v15, v15, v11
s_nop 0
v_readfirstlane_b32 s60, v15
s_nop 0
s_cmp_ge_u32 s60, 3
s_cbranch_scc1 L_ckd57
ds_read_b128 v[8:11], v12 offset:0
s_waitcnt lgkmcnt(0)
s_branch L_ck56
L_ckd57:
ds_read_b128 v[148:151], v17 offset:0
ds_read_b128 v[152:155], v17 offset:1024
ds_read_b128 v[156:159], v17 offset:2048
ds_read_b128 v[160:163], v17 offset:3072
ds_read_b128 v[164:167], v17 offset:4096
ds_read_b128 v[168:171], v17 offset:5120
ds_read_b128 v[172:175], v17 offset:6144
ds_read_b128 v[176:179], v17 offset:7168
ds_read_b128 v[96:99], v20 offset:0
ds_read_b128 v[100:103], v20 offset:4096
ds_read_b128 v[104:107], v20 offset:8192
ds_read_b128 v[108:111], v20 offset:12288
s_waitcnt lgkmcnt(4)
v_mov_b32 v14, 4
s_mov_b64 exec, 1
ds_write_b32 v13, v14
s_mov_b64 exec, -1
s_waitcnt lgkmcnt(0)
v_mfma_f32_32x32x16_bf16 v[32:47], v[148:151], v[96:99], 0
ds_read_b128 v[112:115], v21 offset:0
ds_read_b128 v[116:119], v21 offset:4096
v_mfma_f32_32x32x16_bf16 v[48:63], v[148:151], v[100:103], 0
ds_read_b128 v[120:123], v21 offset:8192
ds_read_b128 v[124:127], v21 offset:12288
v_mfma_f32_32x32x16_bf16 v[64:79], v[148:151], v[104:107], 0
s_add_u32 m0, s67, 32768
s_add_u32 s62, s64, 128
s_and_b32 s62, s62, 0x3ff
buffer_load_dwordx4 v244, s[48:51], s62 offen offset:0 lds
v_mfma_f32_32x32x16_bf16 v[80:95], v[148:151], v[108:111], 0
s_waitcnt lgkmcnt(3)
v_mfma_f32_32x32x16_bf16 v[32:47], v[152:155], v[112:115], v[32:47]
ds_read_b128 v[96:99], v22 offset:0
ds_read_b128 v[100:103], v22 offset:4096
s_waitcnt lgkmcnt(4)
v_mfma_f32_32x32x16_bf16 v[48:63], v[152:155], v[116:119], v[48:63]
ds_read_b128 v[104:107], v22 offset:8192
ds_read_b128 v[108:111], v22 offset:12288
s_waitcnt lgkmcnt(5)
v_mfma_f32_32x32x16_bf16 v[64:79], v[152:155], v[120:123], v[64:79]
buffer_load_dwordx4 v245, s[48:51], s62 offen offset:1024 lds
s_waitcnt lgkmcnt(4)
v_mfma_f32_32x32x16_bf16 v[80:95], v[152:155], v[124:127], v[80:95]
s_waitcnt lgkmcnt(3)
v_mfma_f32_32x32x16_bf16 v[32:47], v[156:159], v[96:99], v[32:47]
ds_read_b128 v[112:115], v23 offset:0
ds_read_b128 v[116:119], v23 offset:4096
s_waitcnt lgkmcnt(4)
v_mfma_f32_32x32x16_bf16 v[48:63], v[156:159], v[100:103], v[48:63]
ds_read_b128 v[120:123], v23 offset:8192
ds_read_b128 v[124:127], v23 offset:12288
s_waitcnt lgkmcnt(5)
v_mfma_f32_32x32x16_bf16 v[64:79], v[156:159], v[104:107], v[64:79]
buffer_load_dwordx4 v246, s[48:51], s62 offen offset:2048 lds
s_waitcnt lgkmcnt(4)
v_mfma_f32_32x32x16_bf16 v[80:95], v[156:159], v[108:111], v[80:95]
s_waitcnt lgkmcnt(3)
v_mfma_f32_32x32x16_bf16 v[32:47], v[160:163], v[112:115], v[32:47]
ds_read_b128 v[96:99], v20 offset:16384
ds_read_b128 v[100:103], v20 offset:20480
s_waitcnt lgkmcnt(4)
v_mfma_f32_32x32x16_bf16 v[48:63], v[160:163], v[116:119], v[48:63]
ds_read_b128 v[104:107], v20 offset:24576
ds_read_b128 v[108:111], v20 offset:28672
s_waitcnt lgkmcnt(5)
v_mfma_f32_32x32x16_bf16 v[64:79], v[160:163], v[120:123], v[64:79]
buffer_load_dwordx4 v247, s[48:51], s62 offen offset:3072 lds
s_waitcnt lgkmcnt(4)
v_mfma_f32_32x32x16_bf16 v[80:95], v[160:163], v[124:127], v[80:95]
s_waitcnt lgkmcnt(3)
v_mfma_f32_32x32x16_bf16 v[32:47], v[164:167], v[96:99], v[32:47]
ds_read_b128 v[112:115], v21 offset:16384
ds_read_b128 v[116:119], v21 offset:20480
s_waitcnt lgkmcnt(4)
v_mfma_f32_32x32x16_bf16 v[48:63], v[164:167], v[100:103], v[48:63]
ds_read_b128 v[120:123], v21 offset:24576
ds_read_b128 v[124:127], v21 offset:28672
s_waitcnt lgkmcnt(5)
v_mfma_f32_32x32x16_bf16 v[64:79], v[164:167], v[104:107], v[64:79]
s_add_u32 m0, s67, 49152
s_nop 0
buffer_load_dwordx4 v244, s[52:55], s62 offen offset:0 lds
s_waitcnt lgkmcnt(4)
v_mfma_f32_32x32x16_bf16 v[80:95], v[164:167], v[108:111], v[80:95]
s_waitcnt lgkmcnt(3)
v_mfma_f32_32x32x16_bf16 v[32:47], v[168:171], v[112:115], v[32:47]
ds_read_b128 v[96:99], v22 offset:16384
ds_read_b128 v[100:103], v22 offset:20480
s_waitcnt lgkmcnt(4)
v_mfma_f32_32x32x16_bf16 v[48:63], v[168:171], v[116:119], v[48:63]
ds_read_b128 v[104:107], v22 offset:24576
ds_read_b128 v[108:111], v22 offset:28672
s_waitcnt lgkmcnt(5)
v_mfma_f32_32x32x16_bf16 v[64:79], v[168:171], v[120:123], v[64:79]
buffer_load_dwordx4 v245, s[52:55], s62 offen offset:1024 lds
s_waitcnt lgkmcnt(4)
v_mfma_f32_32x32x16_bf16 v[80:95], v[168:171], v[124:127], v[80:95]
s_waitcnt lgkmcnt(3)
v_mfma_f32_32x32x16_bf16 v[32:47], v[172:175], v[96:99], v[32:47]
ds_read_b128 v[112:115], v23 offset:16384
ds_read_b128 v[116:119], v23 offset:20480
s_waitcnt lgkmcnt(4)
v_mfma_f32_32x32x16_bf16 v[48:63], v[172:175], v[100:103], v[48:63]
ds_read_b128 v[120:123], v23 offset:24576
ds_read_b128 v[124:127], v23 offset:28672
s_waitcnt lgkmcnt(5)
v_mfma_f32_32x32x16_bf16 v[64:79], v[172:175], v[104:107], v[64:79]
buffer_load_dwordx4 v246, s[52:55], s62 offen offset:2048 lds
s_waitcnt lgkmcnt(4)
v_mfma_f32_32x32x16_bf16 v[80:95], v[172:175], v[108:111], v[80:95]
s_waitcnt lgkmcnt(0)
v_mfma_f32_32x32x16_bf16 v[32:47], v[176:179], v[112:115], v[32:47]
v_mfma_f32_32x32x16_bf16 v[48:63], v[176:179], v[116:119], v[48:63]
v_mfma_f32_32x32x16_bf16 v[64:79], v[176:179], v[120:123], v[64:79]
buffer_load_dwordx4 v247, s[52:55], s62 offen offset:3072 lds
v_mfma_f32_32x32x16_bf16 v[80:95], v[176:179], v[124:127], v[80:95]
s_lshl_b32 s60, s66, 3
v_lshl_add_u32 v17, v5, 4, s60
v_lshlrev_b32 v28, 11, v17
v_lshl_add_u32 v28, v6, 2, v28
v_lshlrev_b32 v29, 13, v17
v_lshl_add_u32 v29, v6, 3, v29
v_lshlrev_b32 v30, 2, v6
v_mov_b32 v15, s37
s_waitcnt vmcnt(8)
s_mov_b64 exec, 1
s_cmp_eq_u32 s100, 0
s_cbranch_scc1 L_rs58
global_store_dword v19, v15, s[32:33]
s_branch L_rd59
L_rs58:
global_store_dword v19, v15, s[32:33] sc1
L_rd59:
s_mov_b64 exec, -1
ds_read_b128 v[8:11], v12 offset:0
s_waitcnt lgkmcnt(0)
L_ck60:
v_min3_u32 v15, v8, v9, v10
v_min_u32 v15, v15, v11
s_nop 0
v_readfirstlane_b32 s60, v15
s_nop 0
s_cmp_ge_u32 s60, 4
s_cbranch_scc1 L_ckd61
ds_read_b128 v[8:11], v12 offset:0
s_waitcnt lgkmcnt(0)
s_branch L_ck60
L_ckd61:
ds_read_b128 v[8:11], v12 offset:16
s_waitcnt lgkmcnt(0)
L_ck62:
v_min3_u32 v15, v8, v9, v10
v_min_u32 v15, v15, v11
s_nop 0
v_readfirstlane_b32 s60, v15
s_nop 0
s_cmp_ge_u32 s60, 2
s_cbranch_scc1 L_ckd63
ds_read_b128 v[8:11], v12 offset:16
s_waitcnt lgkmcnt(0)
s_branch L_ck62
L_ckd63:
s_add_u32 m0, s67, 65536
s_add_u32 s62, s64, 256
s_and_b32 s62, s62, 0x3ff
buffer_load_dwordx4 v244, s[48:51], s62 offen offset:0 lds
buffer_load_dwordx4 v245, s[48:51], s62 offen offset:1024 lds
buffer_load_dwordx4 v246, s[48:51], s62 offen offset:2048 lds
buffer_load_dwordx4 v247, s[48:51], s62 offen offset:3072 lds
s_add_u32 m0, s67, 81920
s_nop 0
buffer_load_dwordx4 v244, s[52:55], s62 offen offset:0 lds
buffer_load_dwordx4 v245, s[52:55], s62 offen offset:1024 lds
buffer_load_dwordx4 v246, s[52:55], s62 offen offset:2048 lds
buffer_load_dwordx4 v247, s[52:55], s62 offen offset:3072 lds
s_mov_b32 s92, 0
L_w64:
global_load_dword v8, v18, s[32:33] sc1
s_waitcnt vmcnt(0)
v_cmp_ne_u32 vcc, s37, v8
s_nop 0
s_cbranch_vccz L_wd65
s_sleep 4
s_add_u32 s92, s92, 1
s_cmp_lt_u32 s92, 200000
s_cbranch_scc1 L_w64
L_wd65:
v_mov_b32 v14, 5
s_mov_b64 exec, 1
ds_write_b32 v13, v14
s_mov_b64 exec, -1
s_add_u32 s63, s65, 8192
s_and_b32 s63, s63, 0xffff
buffer_load_dwordx4 v[180:183], v2, s[40:43], s63 offen offset:0 sc1
buffer_load_dwordx4 v[184:187], v2, s[40:43], s63 offen offset:1024 sc1
buffer_load_dwordx4 v[188:191], v2, s[40:43], s63 offen offset:2048 sc1
buffer_load_dwordx4 v[192:195], v2, s[40:43], s63 offen offset:3072 sc1
s_add_u32 m0, s67, 98304
s_add_u32 s62, s64, 384
s_and_b32 s62, s62, 0x3ff
buffer_load_dwordx4 v244, s[48:51], s62 offen offset:0 lds
buffer_load_dwordx4 v245, s[48:51], s62 offen offset:1024 lds
buffer_load_dwordx4 v246, s[48:51], s62 offen offset:2048 lds
buffer_load_dwordx4 v247, s[48:51], s62 offen offset:3072 lds
s_add_u32 s63, s65, 12288
s_and_b32 s63, s63, 0xffff
buffer_load_dwordx4 v[196:199], v2, s[40:43], s63 offen offset:0 sc1
buffer_load_dwordx4 v[200:203], v2, s[40:43], s63 offen offset:1024 sc1
buffer_load_dwordx4 v[204:207], v2, s[40:43], s63 offen offset:2048 sc1
buffer_load_dwordx4 v[208:211], v2, s[40:43], s63 offen offset:3072 sc1
ds_read_b128 v[8:11], v12 offset:0
s_waitcnt lgkmcnt(0)
L_ck66:
v_min3_u32 v15, v8, v9, v10
v_min_u32 v15, v15, v11
s_nop 0
v_readfirstlane_b32 s60, v15
s_nop 0
s_cmp_ge_u32 s60, 5
s_cbranch_scc1 L_ckd67
ds_read_b128 v[8:11], v12 offset:0
s_waitcnt lgkmcnt(0)
s_branch L_ck66
L_ckd67:
ds_read_b128 v[96:99], v20 offset:32768
ds_read_b128 v[100:103], v20 offset:36864
ds_read_b128 v[104:107], v20 offset:40960
ds_read_b128 v[108:111], v20 offset:45056
s_waitcnt vmcnt(11) lgkmcnt(3)
v_mfma_f32_32x32x16_bf16 v[32:47], v[180:183], v[96:99], v[32:47]
ds_read_b128 v[112:115], v21 offset:32768
ds_read_b128 v[116:119], v21 offset:36864
s_waitcnt lgkmcnt(4)
v_mfma_f32_32x32x16_bf16 v[48:63], v[180:183], v[100:103], v[48:63]
ds_read_b128 v[120:123], v21 offset:40960
ds_read_b128 v[124:127], v21 offset:45056
s_waitcnt lgkmcnt(5)
v_mfma_f32_32x32x16_bf16 v[64:79], v[180:183], v[104:107], v[64:79]
s_waitcnt lgkmcnt(4)
v_mfma_f32_32x32x16_bf16 v[80:95], v[180:183], v[108:111], v[80:95]
s_add_u32 s63, s65, 16384
s_and_b32 s63, s63, 0xffff
buffer_load_dwordx4 v[212:215], v2, s[40:43], s63 offen offset:0 sc1
buffer_load_dwordx4 v[216:219], v2, s[40:43], s63 offen offset:1024 sc1
s_waitcnt vmcnt(12) lgkmcnt(3)
v_mfma_f32_32x32x16_bf16 v[32:47], v[184:187], v[112:115], v[32:47]
ds_read_b128 v[96:99], v22 offset:32768
ds_read_b128 v[100:103], v22 offset:36864
s_waitcnt lgkmcnt(4)
v_mfma_f32_32x32x16_bf16 v[48:63], v[184:187], v[116:119], v[48:63]
ds_read_b128 v[104:107], v22 offset:40960
ds_read_b128 v[108:111], v22 offset:45056
s_waitcnt lgkmcnt(5)
v_mfma_f32_32x32x16_bf16 v[64:79], v[184:187], v[120:123], v[64:79]
s_waitcnt lgkmcnt(4)
v_mfma_f32_32x32x16_bf16 v[80:95], v[184:187], v[124:127], v[80:95]
buffer_load_dwordx4 v[220:223], v2, s[40:43], s63 offen offset:2048 sc1
buffer_load_dwordx4 v[224:227], v2, s[40:43], s63 offen offset:3072 sc1
s_waitcnt vmcnt(13) lgkmcnt(3)
v_mfma_f32_32x32x16_bf16 v[32:47], v[188:191], v[96:99], v[32:47]
ds_read_b128 v[112:115], v23 offset:32768
ds_read_b128 v[116:119], v23 offset:36864
s_waitcnt lgkmcnt(4)
v_mfma_f32_32x32x16_bf16 v[48:63], v[188:191], v[100:103], v[48:63]
ds_read_b128 v[120:123], v23 offset:40960
ds_read_b128 v[124:127], v23 offset:45056
s_waitcnt lgkmcnt(5)
v_mfma_f32_32x32x16_bf16 v[64:79], v[188:191], v[104:107], v[64:79]
s_waitcnt lgkmcnt(4)
v_mfma_f32_32x32x16_bf16 v[80:95], v[188:191], v[108:111], v[80:95]
s_add_u32 s63, s65, 20480
s_and_b32 s63, s63, 0xffff
buffer_load_dwordx4 v[228:231], v2, s[40:43], s63 offen offset:0 sc1
buffer_load_dwordx4 v[232:235], v2, s[40:43], s63 offen offset:1024 sc1
s_waitcnt vmcnt(14) lgkmcnt(3)
v_mfma_f32_32x32x16_bf16 v[32:47], v[192:195], v[112:115], v[32:47]
ds_read_b128 v[96:99], v20 offset:49152
ds_read_b128 v[100:103], v20 offset:53248
s_waitcnt lgkmcnt(4)
v_mfma_f32_32x32x16_bf16 v[48:63], v[192:195], v[116:119], v[48:63]
ds_read_b128 v[104:107], v20 offset:57344
ds_read_b128 v[108:111], v20 offset:61440
s_waitcnt lgkmcnt(5)
v_mfma_f32_32x32x16_bf16 v[64:79], v[192:195], v[120:123], v[64:79]
s_waitcnt lgkmcnt(4)
v_mfma_f32_32x32x16_bf16 v[80:95], v[192:195], v[124:127], v[80:95]
buffer_load_dwordx4 v[236:239], v2, s[40:43], s63 offen offset:2048 sc1
buffer_load_dwordx4 v[240:243], v2, s[40:43], s63 offen offset:3072 sc1
s_waitcnt vmcnt(11) lgkmcnt(3)
v_mov_b32 v14, 6
s_mov_b64 exec, 1
ds_write_b32 v13, v14
s_mov_b64 exec, -1
v_mfma_f32_32x32x16_bf16 v[32:47], v[196:199], v[96:99], v[32:47]
ds_read_b128 v[112:115], v21 offset:49152
ds_read_b128 v[116:119], v21 offset:53248
s_waitcnt lgkmcnt(5)
v_mfma_f32_32x32x16_bf16 v[48:63], v[196:199], v[100:103], v[48:63]
ds_read_b128 v[120:123], v21 offset:57344
ds_read_b128 v[124:127], v21 offset:61440
s_waitcnt lgkmcnt(6)
v_mfma_f32_32x32x16_bf16 v[64:79], v[196:199], v[104:107], v[64:79]
s_add_u32 m0, s67, 0
s_nop 0
buffer_load_dwordx4 v244, s[52:55], s62 offen offset:0 lds
s_waitcnt lgkmcnt(5)
v_mfma_f32_32x32x16_bf16 v[80:95], v[196:199], v[108:111], v[80:95]
s_add_u32 s63, s65, 24576
s_and_b32 s63, s63, 0xffff
buffer_load_dwordx4 v[148:151], v2, s[40:43], s63 offen offset:0 sc1
buffer_load_dwordx4 v[152:155], v2, s[40:43], s63 offen offset:1024 sc1
s_waitcnt vmcnt(13) lgkmcnt(3)
v_mfma_f32_32x32x16_bf16 v[32:47], v[200:203], v[112:115], v[32:47]
ds_read_b128 v[96:99], v22 offset:49152
ds_read_b128 v[100:103], v22 offset:53248
s_waitcnt lgkmcnt(4)
v_mfma_f32_32x32x16_bf16 v[48:63], v[200:203], v[116:119], v[48:63]
ds_read_b128 v[104:107], v22 offset:57344
ds_read_b128 v[108:111], v22 offset:61440
s_waitcnt lgkmcnt(5)
v_mfma_f32_32x32x16_bf16 v[64:79], v[200:203], v[120:123], v[64:79]
buffer_load_dwordx4 v245, s[52:55], s62 offen offset:1024 lds
s_waitcnt lgkmcnt(4)
v_mfma_f32_32x32x16_bf16 v[80:95], v[200:203], v[124:127], v[80:95]
buffer_load_dwordx4 v[156:159], v2, s[40:43], s63 offen offset:2048 sc1
buffer_load_dwordx4 v[160:163], v2, s[40:43], s63 offen offset:3072 sc1
s_waitcnt vmcnt(15) lgkmcnt(3)
v_mfma_f32_32x32x16_bf16 v[32:47], v[204:207], v[96:99], v[32:47]
ds_read_b128 v[112:115], v23 offset:49152
ds_read_b128 v[116:119], v23 offset:53248
s_waitcnt lgkmcnt(4)
v_mfma_f32_32x32x16_bf16 v[48:63], v[204:207], v[100:103], v[48:63]
ds_read_b128 v[120:123], v23 offset:57344
ds_read_b128 v[124:127], v23 offset:61440
s_waitcnt lgkmcnt(5)
v_mfma_f32_32x32x16_bf16 v[64:79], v[204:207], v[104:107], v[64:79]
buffer_load_dwordx4 v246, s[52:55], s62 offen offset:2048 lds
s_waitcnt lgkmcnt(4)
v_mfma_f32_32x32x16_bf16 v[80:95], v[204:207], v[108:111], v[80:95]
s_add_u32 s63, s65, 28672
s_and_b32 s63, s63, 0xffff
buffer_load_dwordx4 v[164:167], v2, s[40:43], s63 offen offset:0 sc1
buffer_load_dwordx4 v[168:171], v2, s[40:43], s63 offen offset:1024 sc1
ds_read_b128 v[8:11], v12
s_waitcnt vmcnt(17) lgkmcnt(0)
L_ck68:
v_min3_u32 v15, v8, v9, v10
v_min_u32 v15, v15, v11
s_nop 0
v_readfirstlane_b32 s60, v15
s_nop 0
s_cmp_ge_u32 s60, 6
s_cbranch_scc1 L_ckd69
ds_read_b128 v[8:11], v12 offset:0
s_waitcnt lgkmcnt(0)
s_branch L_ck68
L_ckd69:
v_mfma_f32_32x32x16_bf16 v[32:47], v[208:211], v[112:115], v[32:47]
ds_read_b128 v[96:99], v24 offset:0
ds_read_b128 v[100:103], v24 offset:4096
v_mfma_f32_32x32x16_bf16 v[48:63], v[208:211], v[116:119], v[48:63]
ds_read_b128 v[104:107], v24 offset:8192
ds_read_b128 v[108:111], v24 offset:12288
v_mfma_f32_32x32x16_bf16 v[64:79], v[208:211], v[120:123], v[64:79]
buffer_load_dwordx4 v247, s[52:55], s62 offen offset:3072 lds
v_mfma_f32_32x32x16_bf16 v[80:95], v[208:211], v[124:127], v[80:95]
buffer_load_dwordx4 v[172:175], v2, s[40:43], s63 offen offset:2048 sc1
buffer_load_dwordx4 v[176:179], v2, s[40:43], s63 offen offset:3072 sc1
s_waitcnt vmcnt(19) lgkmcnt(3)
v_mfma_f32_32x32x16_bf16 v[32:47], v[212:215], v[96:99], v[32:47]
ds_read_b128 v[112:115], v25 offset:0
ds_read_b128 v[116:119], v25 offset:4096
s_waitcnt lgkmcnt(4)
v_mfma_f32_32x32x16_bf16 v[48:63], v[212:215], v[100:103], v[48:63]
ds_read_b128 v[120:123], v25 offset:8192
ds_read_b128 v[124:127], v25 offset:12288
s_waitcnt lgkmcnt(5)
v_mfma_f32_32x32x16_bf16 v[64:79], v[212:215], v[104:107], v[64:79]
s_add_u32 m0, s67, 16384
s_add_u32 s62, s64, 512
s_and_b32 s62, s62, 0x3ff
buffer_load_dwordx4 v244, s[48:51], s62 offen offset:0 lds
s_waitcnt lgkmcnt(4)
v_mfma_f32_32x32x16_bf16 v[80:95], v[212:215], v[108:111], v[80:95]
s_add_u32 s63, s65, 32768
s_and_b32 s63, s63, 0xffff
buffer_load_dwordx4 v[180:183], v2, s[40:43], s63 offen offset:0 sc1
buffer_load_dwordx4 v[184:187], v2, s[40:43], s63 offen offset:1024 sc1
s_waitcnt vmcnt(21) lgkmcnt(3)
v_mfma_f32_32x32x16_bf16 v[32:47], v[216:219], v[112:115], v[32:47]
ds_read_b128 v[96:99], v26 offset:0
ds_read_b128 v[100:103], v26 offset:4096
s_waitcnt lgkmcnt(4)
v_mfma_f32_32x32x16_bf16 v[48:63], v[216:219], v[116:119], v[48:63]
ds_read_b128 v[104:107], v26 offset:8192
ds_read_b128 v[108:111], v26 offset:12288
s_waitcnt lgkmcnt(5)
v_mfma_f32_32x32x16_bf16 v[64:79], v[216:219], v[120:123], v[64:79]
buffer_load_dwordx4 v245, s[48:51], s62 offen offset:1024 lds
s_waitcnt lgkmcnt(4)
v_mfma_f32_32x32x16_bf16 v[80:95], v[216:219], v[124:127], v[80:95]
buffer_load_dwordx4 v[188:191], v2, s[40:43], s63 offen offset:2048 sc1
buffer_load_dwordx4 v[192:195], v2, s[40:43], s63 offen offset:3072 sc1
s_waitcnt vmcnt(23) lgkmcnt(3)
v_mfma_f32_32x32x16_bf16 v[32:47], v[220:223], v[96:99], v[32:47]
ds_read_b128 v[112:115], v27 offset:0
ds_read_b128 v[116:119], v27 offset:4096
s_waitcnt lgkmcnt(4)
v_mfma_f32_32x32x16_bf16 v[48:63], v[220:223], v[100:103], v[48:63]
ds_read_b128 v[120:123], v27 offset:8192
ds_read_b128 v[124:127], v27 offset:12288
s_waitcnt lgkmcnt(5)
v_mfma_f32_32x32x16_bf16 v[64:79], v[220:223], v[104:107], v[64:79]
buffer_load_dwordx4 v246, s[48:51], s62 offen offset:2048 lds
s_waitcnt lgkmcnt(4)
v_mfma_f32_32x32x16_bf16 v[80:95], v[220:223], v[108:111], v[80:95]
s_add_u32 s63, s65, 36864
s_and_b32 s63, s63, 0xffff
buffer_load_dwordx4 v[196:199], v2, s[40:43], s63 offen offset:0 sc1
buffer_load_dwordx4 v[200:203], v2, s[40:43], s63 offen offset:1024 sc1
s_waitcnt vmcnt(25) lgkmcnt(3)
v_mfma_f32_32x32x16_bf16 v[32:47], v[224:227], v[112:115], v[32:47]
ds_read_b128 v[96:99], v24 offset:16384
ds_read_b128 v[100:103], v24 offset:20480
s_waitcnt lgkmcnt(4)
v_mfma_f32_32x32x16_bf16 v[48:63], v[224:227], v[116:119], v[48:63]
ds_read_b128 v[104:107], v24 offset:24576
ds_read_b128 v[108:111], v24 offset:28672
s_waitcnt lgkmcnt(5)
v_mfma_f32_32x32x16_bf16 v[64:79], v[224:227], v[120:123], v[64:79]
buffer_load_dwordx4 v247, s[48:51], s62 offen offset:3072 lds
s_waitcnt lgkmcnt(4)
v_mfma_f32_32x32x16_bf16 v[80:95], v[224:227], v[124:127], v[80:95]
buffer_load_dwordx4 v[204:207], v2, s[40:43], s63 offen offset:2048 sc1
buffer_load_dwordx4 v[208:211], v2, s[40:43], s63 offen offset:3072 sc1
s_waitcnt vmcnt(14) lgkmcnt(3)
v_mov_b32 v14, 7
s_mov_b64 exec, 1
ds_write_b32 v13, v14
s_mov_b64 exec, -1
v_mfma_f32_32x32x16_bf16 v[32:47], v[228:231], v[96:99], v[32:47]
ds_read_b128 v[112:115], v25 offset:16384
ds_read_b128 v[116:119], v25 offset:20480
s_waitcnt lgkmcnt(5)
v_mfma_f32_32x32x16_bf16 v[48:63], v[228:231], v[100:103], v[48:63]
ds_read_b128 v[120:123], v25 offset:24576
ds_read_b128 v[124:127], v25 offset:28672
s_waitcnt lgkmcnt(6)
v_mfma_f32_32x32x16_bf16 v[64:79], v[228:231], v[104:107], v[64:79]
s_add_u32 m0, s67, 32768
s_nop 0
buffer_load_dwordx4 v244, s[52:55], s62 offen offset:0 lds
s_waitcnt lgkmcnt(5)
v_mfma_f32_32x32x16_bf16 v[80:95], v[228:231], v[108:111], v[80:95]
s_add_u32 s63, s65, 40960
s_and_b32 s63, s63, 0xffff
buffer_load_dwordx4 v[212:215], v2, s[40:43], s63 offen offset:0 sc1
buffer_load_dwordx4 v[216:219], v2, s[40:43], s63 offen offset:1024 sc1
s_waitcnt vmcnt(29) lgkmcnt(3)
v_mfma_f32_32x32x16_bf16 v[32:47], v[232:235], v[112:115], v[32:47]
ds_read_b128 v[96:99], v26 offset:16384
ds_read_b128 v[100:103], v26 offset:20480
s_waitcnt lgkmcnt(4)
v_mfma_f32_32x32x16_bf16 v[48:63], v[232:235], v[116:119], v[48:63]
ds_read_b128 v[104:107], v26 offset:24576
ds_read_b128 v[108:111], v26 offset:28672
s_waitcnt lgkmcnt(5)
v_mfma_f32_32x32x16_bf16 v[64:79], v[232:235], v[120:123], v[64:79]
buffer_load_dwordx4 v245, s[52:55], s62 offen offset:1024 lds
s_waitcnt lgkmcnt(4)
v_mfma_f32_32x32x16_bf16 v[80:95], v[232:235], v[124:127], v[80:95]
buffer_load_dwordx4 v[220:223], v2, s[40:43], s63 offen offset:2048 sc1
buffer_load_dwordx4 v[224:227], v2, s[40:43], s63 offen offset:3072 sc1
s_waitcnt vmcnt(31) lgkmcnt(3)
v_mfma_f32_32x32x16_bf16 v[32:47], v[236:239], v[96:99], v[32:47]
ds_read_b128 v[112:115], v27 offset:16384
ds_read_b128 v[116:119], v27 offset:20480
s_waitcnt lgkmcnt(4)
v_mfma_f32_32x32x16_bf16 v[48:63], v[236:239], v[100:103], v[48:63]
ds_read_b128 v[120:123], v27 offset:24576
ds_read_b128 v[124:127], v27 offset:28672
s_waitcnt lgkmcnt(5)
v_mfma_f32_32x32x16_bf16 v[64:79], v[236:239], v[104:107], v[64:79]
buffer_load_dwordx4 v246, s[52:55], s62 offen offset:2048 lds
s_waitcnt lgkmcnt(4)
v_mfma_f32_32x32x16_bf16 v[80:95], v[236:239], v[108:111], v[80:95]
s_add_u32 s63, s65, 45056
s_and_b32 s63, s63, 0xffff
buffer_load_dwordx4 v[228:231], v2, s[40:43], s63 offen offset:0 sc1
buffer_load_dwordx4 v[232:235], v2, s[40:43], s63 offen offset:1024 sc1
ds_read_b128 v[8:11], v12
s_waitcnt vmcnt(33) lgkmcnt(0)
L_ck70:
v_min3_u32 v15, v8, v9, v10
v_min_u32 v15, v15, v11
s_nop 0
v_readfirstlane_b32 s60, v15
s_nop 0
s_cmp_ge_u32 s60, 7
s_cbranch_scc1 L_ckd71
ds_read_b128 v[8:11], v12 offset:0
s_waitcnt lgkmcnt(0)
s_branch L_ck70
L_ckd71:
v_mfma_f32_32x32x16_bf16 v[32:47], v[240:243], v[112:115], v[32:47]
ds_read_b128 v[96:99], v24 offset:32768
ds_read_b128 v[100:103], v24 offset:36864
v_mfma_f32_32x32x16_bf16 v[48:63], v[240:243], v[116:119], v[48:63]
ds_read_b128 v[104:107], v24 offset:40960
ds_read_b128 v[108:111], v24 offset:45056
v_mfma_f32_32x32x16_bf16 v[64:79], v[240:243], v[120:123], v[64:79]
buffer_load_dwordx4 v247, s[52:55], s62 offen offset:3072 lds
v_mfma_f32_32x32x16_bf16 v[80:95], v[240:243], v[124:127], v[80:95]
buffer_load_dwordx4 v[236:239], v2, s[40:43], s63 offen offset:2048 sc1
buffer_load_dwordx4 v[240:243], v2, s[40:43], s63 offen offset:3072 sc1
s_waitcnt vmcnt(34) lgkmcnt(3)
v_mfma_f32_32x32x16_bf16 v[32:47], v[148:151], v[96:99], v[32:47]
ds_read_b128 v[112:115], v25 offset:32768
ds_read_b128 v[116:119], v25 offset:36864
s_waitcnt lgkmcnt(4)
v_mfma_f32_32x32x16_bf16 v[48:63], v[148:151], v[100:103], v[48:63]
ds_read_b128 v[120:123], v25 offset:40960
ds_read_b128 v[124:127], v25 offset:45056
s_waitcnt lgkmcnt(5)
v_mfma_f32_32x32x16_bf16 v[64:79], v[148:151], v[104:107], v[64:79]
s_add_u32 m0, s67, 49152
s_add_u32 s62, s64, 640
s_and_b32 s62, s62, 0x3ff
buffer_load_dwordx4 v244, s[48:51], s62 offen offset:0 lds
s_waitcnt lgkmcnt(4)
v_mfma_f32_32x32x16_bf16 v[80:95], v[148:151], v[108:111], v[80:95]
s_add_u32 s63, s65, 49152
s_and_b32 s63, s63, 0xffff
buffer_load_dwordx4 v[148:151], v2, s[40:43], s63 offen offset:0 sc1
s_waitcnt vmcnt(35) lgkmcnt(3)
v_mfma_f32_32x32x16_bf16 v[32:47], v[152:155], v[112:115], v[32:47]
ds_read_b128 v[96:99], v26 offset:32768
ds_read_b128 v[100:103], v26 offset:36864
s_waitcnt lgkmcnt(4)
v_mfma_f32_32x32x16_bf16 v[48:63], v[152:155], v[116:119], v[48:63]
ds_read_b128 v[104:107], v26 offset:40960
ds_read_b128 v[108:111], v26 offset:45056
s_waitcnt lgkmcnt(5)
v_mfma_f32_32x32x16_bf16 v[64:79], v[152:155], v[120:123], v[64:79]
buffer_load_dwordx4 v245, s[48:51], s62 offen offset:1024 lds
s_waitcnt lgkmcnt(4)
v_mfma_f32_32x32x16_bf16 v[80:95], v[152:155], v[124:127], v[80:95]
buffer_load_dwordx4 v[152:155], v2, s[40:43], s63 offen offset:1024 sc1
s_waitcnt vmcnt(35) lgkmcnt(3)
v_mfma_f32_32x32x16_bf16 v[32:47], v[156:159], v[96:99], v[32:47]
ds_read_b128 v[112:115], v27 offset:32768
ds_read_b128 v[116:119], v27 offset:36864
s_waitcnt lgkmcnt(4)
v_mfma_f32_32x32x16_bf16 v[48:63], v[156:159], v[100:103], v[48:63]
ds_read_b128 v[120:123], v27 offset:40960
ds_read_b128 v[124:127], v27 offset:45056
s_waitcnt lgkmcnt(5)
v_mfma_f32_32x32x16_bf16 v[64:79], v[156:159], v[104:107], v[64:79]
buffer_load_dwordx4 v246, s[48:51], s62 offen offset:2048 lds
s_waitcnt lgkmcnt(4)
v_mfma_f32_32x32x16_bf16 v[80:95], v[156:159], v[108:111], v[80:95]
buffer_load_dwordx4 v[156:159], v2, s[40:43], s63 offen offset:2048 sc1
s_waitcnt vmcnt(36) lgkmcnt(3)
v_mfma_f32_32x32x16_bf16 v[32:47], v[160:163], v[112:115], v[32:47]
ds_read_b128 v[96:99], v20 offset:0
ds_read_b128 v[100:103], v20 offset:4096
s_waitcnt lgkmcnt(4)
v_mfma_f32_32x32x16_bf16 v[48:63], v[160:163], v[116:119], v[48:63]
ds_read_b128 v[104:107], v20 offset:8192
ds_read_b128 v[108:111], v20 offset:12288
s_waitcnt lgkmcnt(5)
v_mfma_f32_32x32x16_bf16 v[64:79], v[160:163], v[120:123], v[64:79]
buffer_load_dwordx4 v247, s[48:51], s62 offen offset:3072 lds
s_waitcnt lgkmcnt(4)
v_mfma_f32_32x32x16_bf16 v[80:95], v[160:163], v[124:127], v[80:95]
buffer_load_dwordx4 v[160:163], v2, s[40:43], s63 offen offset:3072 sc1
s_waitcnt vmcnt(10) lgkmcnt(3)
v_mov_b32 v14, 8
s_mov_b64 exec, 1
ds_write_b32 v13, v14
s_mov_b64 exec, -1
v_mfma_f32_32x32x16_bf16 v[32:47], v[164:167], v[96:99], v[32:47]
ds_read_b128 v[112:115], v21 offset:0
ds_read_b128 v[116:119], v21 offset:4096
s_waitcnt lgkmcnt(5)
v_mfma_f32_32x32x16_bf16 v[48:63], v[164:167], v[100:103], v[48:63]
ds_read_b128 v[120:123], v21 offset:8192
ds_read_b128 v[124:127], v21 offset:12288
s_waitcnt lgkmcnt(6)
v_mfma_f32_32x32x16_bf16 v[64:79], v[164:167], v[104:107], v[64:79]
s_add_u32 m0, s67, 65536
s_nop 0
buffer_load_dwordx4 v244, s[52:55], s62 offen offset:0 lds
s_waitcnt lgkmcnt(5)
v_mfma_f32_32x32x16_bf16 v[80:95], v[164:167], v[108:111], v[80:95]
s_add_u32 s63, s65, 53248
s_and_b32 s63, s63, 0xffff
buffer_load_dwordx4 v[164:167], v2, s[40:43], s63 offen offset:0 sc1
s_waitcnt vmcnt(37) lgkmcnt(3)
v_mfma_f32_32x32x16_bf16 v[32:47], v[168:171], v[112:115], v[32:47]
ds_read_b128 v[96:99], v22 offset:0
ds_read_b128 v[100:103], v22 offset:4096
s_waitcnt lgkmcnt(4)
v_mfma_f32_32x32x16_bf16 v[48:63], v[168:171], v[116:119], v[48:63]
ds_read_b128 v[104:107], v22 offset:8192
ds_read_b128 v[108:111], v22 offset:12288
s_waitcnt lgkmcnt(5)
v_mfma_f32_32x32x16_bf16 v[64:79], v[168:171], v[120:123], v[64:79]
buffer_load_dwordx4 v245, s[52:55], s62 offen offset:1024 lds
s_waitcnt lgkmcnt(4)
v_mfma_f32_32x32x16_bf16 v[80:95], v[168:171], v[124:127], v[80:95]
buffer_load_dwordx4 v[168:171], v2, s[40:43], s63 offen offset:1024 sc1
s_waitcnt vmcnt(37) lgkmcnt(3)
v_mfma_f32_32x32x16_bf16 v[32:47], v[172:175], v[96:99], v[32:47]
ds_read_b128 v[112:115], v23 offset:0
ds_read_b128 v[116:119], v23 offset:4096
s_waitcnt lgkmcnt(4)
v_mfma_f32_32x32x16_bf16 v[48:63], v[172:175], v[100:103], v[48:63]
ds_read_b128 v[120:123], v23 offset:8192
ds_read_b128 v[124:127], v23 offset:12288
s_waitcnt lgkmcnt(5)
v_mfma_f32_32x32x16_bf16 v[64:79], v[172:175], v[104:107], v[64:79]
buffer_load_dwordx4 v246, s[52:55], s62 offen offset:2048 lds
s_waitcnt lgkmcnt(4)
v_mfma_f32_32x32x16_bf16 v[80:95], v[172:175], v[108:111], v[80:95]
buffer_load_dwordx4 v[172:175], v2, s[40:43], s63 offen offset:2048 sc1
ds_read_b128 v[8:11], v12
s_waitcnt vmcnt(38) lgkmcnt(0)
L_ck72:
v_min3_u32 v15, v8, v9, v10
v_min_u32 v15, v15, v11
s_nop 0
v_readfirstlane_b32 s60, v15
s_nop 0
s_cmp_ge_u32 s60, 8
s_cbranch_scc1 L_ckd73
ds_read_b128 v[8:11], v12 offset:0
s_waitcnt lgkmcnt(0)
s_branch L_ck72
L_ckd73:
v_mfma_f32_32x32x16_bf16 v[32:47], v[176:179], v[112:115], v[32:47]
ds_read_b128 v[96:99], v20 offset:16384
ds_read_b128 v[100:103], v20 offset:20480
v_mfma_f32_32x32x16_bf16 v[48:63], v[176:179], v[116:119], v[48:63]
ds_read_b128 v[104:107], v20 offset:24576
ds_read_b128 v[108:111], v20 offset:28672
v_mfma_f32_32x32x16_bf16 v[64:79], v[176:179], v[120:123], v[64:79]
buffer_load_dwordx4 v247, s[52:55], s62 offen offset:3072 lds
v_mfma_f32_32x32x16_bf16 v[80:95], v[176:179], v[124:127], v[80:95]
buffer_load_dwordx4 v[176:179], v2, s[40:43], s63 offen offset:3072 sc1
s_waitcnt vmcnt(38) lgkmcnt(3)
v_mfma_f32_32x32x16_bf16 v[32:47], v[180:183], v[96:99], v[32:47]
ds_read_b128 v[112:115], v21 offset:16384
ds_read_b128 v[116:119], v21 offset:20480
s_waitcnt lgkmcnt(4)
v_mfma_f32_32x32x16_bf16 v[48:63], v[180:183], v[100:103], v[48:63]
ds_read_b128 v[120:123], v21 offset:24576
ds_read_b128 v[124:127], v21 offset:28672
s_waitcnt lgkmcnt(5)
v_mfma_f32_32x32x16_bf16 v[64:79], v[180:183], v[104:107], v[64:79]
s_add_u32 m0, s67, 81920
s_add_u32 s62, s64, 768
s_and_b32 s62, s62, 0x3ff
buffer_load_dwordx4 v244, s[48:51], s62 offen offset:0 lds
s_waitcnt lgkmcnt(4)
v_mfma_f32_32x32x16_bf16 v[80:95], v[180:183], v[108:111], v[80:95]
s_add_u32 s63, s65, 57344
s_and_b32 s63, s63, 0xffff
buffer_load_dwordx4 v[180:183], v2, s[40:43], s63 offen offset:0 sc1
s_waitcnt vmcnt(39) lgkmcnt(3)
v_mfma_f32_32x32x16_bf16 v[32:47], v[184:187], v[112:115], v[32:47]
ds_read_b128 v[96:99], v22 offset:16384
ds_read_b128 v[100:103], v22 offset:20480
s_waitcnt lgkmcnt(4)
v_mfma_f32_32x32x16_bf16 v[48:63], v[184:187], v[116:119], v[48:63]
ds_read_b128 v[104:107], v22 offset:24576
ds_read_b128 v[108:111], v22 offset:28672
s_waitcnt lgkmcnt(5)
v_mfma_f32_32x32x16_bf16 v[64:79], v[184:187], v[120:123], v[64:79]
buffer_load_dwordx4 v245, s[48:51], s62 offen offset:1024 lds
s_waitcnt lgkmcnt(4)
v_mfma_f32_32x32x16_bf16 v[80:95], v[184:187], v[124:127], v[80:95]
buffer_load_dwordx4 v[184:187], v2, s[40:43], s63 offen offset:1024 sc1
s_waitcnt vmcnt(39) lgkmcnt(3)
v_mfma_f32_32x32x16_bf16 v[32:47], v[188:191], v[96:99], v[32:47]
ds_read_b128 v[112:115], v23 offset:16384
ds_read_b128 v[116:119], v23 offset:20480
s_waitcnt lgkmcnt(4)
v_mfma_f32_32x32x16_bf16 v[48:63], v[188:191], v[100:103], v[48:63]
ds_read_b128 v[120:123], v23 offset:24576
ds_read_b128 v[124:127], v23 offset:28672
s_waitcnt lgkmcnt(5)
v_mfma_f32_32x32x16_bf16 v[64:79], v[188:191], v[104:107], v[64:79]
buffer_load_dwordx4 v246, s[48:51], s62 offen offset:2048 lds
s_waitcnt lgkmcnt(4)
v_mfma_f32_32x32x16_bf16 v[80:95], v[188:191], v[108:111], v[80:95]
buffer_load_dwordx4 v[188:191], v2, s[40:43], s63 offen offset:2048 sc1
s_waitcnt vmcnt(40) lgkmcnt(3)
v_mfma_f32_32x32x16_bf16 v[32:47], v[192:195], v[112:115], v[32:47]
ds_read_b128 v[96:99], v20 offset:32768
ds_read_b128 v[100:103], v20 offset:36864
s_waitcnt lgkmcnt(4)
v_mfma_f32_32x32x16_bf16 v[48:63], v[192:195], v[116:119], v[48:63]
ds_read_b128 v[104:107], v20 offset:40960
ds_read_b128 v[108:111], v20 offset:45056
s_waitcnt lgkmcnt(5)
v_mfma_f32_32x32x16_bf16 v[64:79], v[192:195], v[120:123], v[64:79]
buffer_load_dwordx4 v247, s[48:51], s62 offen offset:3072 lds
s_waitcnt lgkmcnt(4)
v_mfma_f32_32x32x16_bf16 v[80:95], v[192:195], v[124:127], v[80:95]
buffer_load_dwordx4 v[192:195], v2, s[40:43], s63 offen offset:3072 sc1
s_waitcnt vmcnt(9) lgkmcnt(3)
v_mov_b32 v14, 9
s_mov_b64 exec, 1
ds_write_b32 v13, v14
s_mov_b64 exec, -1
v_mfma_f32_32x32x16_bf16 v[32:47], v[196:199], v[96:99], v[32:47]
ds_read_b128 v[112:115], v21 offset:32768
ds_read_b128 v[116:119], v21 offset:36864
s_waitcnt lgkmcnt(5)
v_mfma_f32_32x32x16_bf16 v[48:63], v[196:199], v[100:103], v[48:63]
ds_read_b128 v[120:123], v21 offset:40960
ds_read_b128 v[124:127], v21 offset:45056
s_waitcnt lgkmcnt(6)
v_mfma_f32_32x32x16_bf16 v[64:79], v[196:199], v[104:107], v[64:79]
s_add_u32 m0, s67, 98304
s_nop 0
buffer_load_dwordx4 v244, s[52:55], s62 offen offset:0 lds
s_waitcnt lgkmcnt(5)
v_mfma_f32_32x32x16_bf16 v[80:95], v[196:199], v[108:111], v[80:95]
s_add_u32 s63, s65, 61440
s_and_b32 s63, s63, 0xffff
buffer_load_dwordx4 v[196:199], v2, s[40:43], s63 offen offset:0 sc1
s_waitcnt vmcnt(41) lgkmcnt(3)
v_mfma_f32_32x32x16_bf16 v[32:47], v[200:203], v[112:115], v[32:47]
ds_read_b128 v[96:99], v22 offset:32768
ds_read_b128 v[100:103], v22 offset:36864
s_waitcnt lgkmcnt(4)
v_mfma_f32_32x32x16_bf16 v[48:63], v[200:203], v[116:119], v[48:63]
ds_read_b128 v[104:107], v22 offset:40960
ds_read_b128 v[108:111], v22 offset:45056
s_waitcnt lgkmcnt(5)
v_mfma_f32_32x32x16_bf16 v[64:79], v[200:203], v[120:123], v[64:79]
buffer_load_dwordx4 v245, s[52:55], s62 offen offset:1024 lds
s_waitcnt lgkmcnt(4)
v_mfma_f32_32x32x16_bf16 v[80:95], v[200:203], v[124:127], v[80:95]
buffer_load_dwordx4 v[200:203], v2, s[40:43], s63 offen offset:1024 sc1
s_waitcnt vmcnt(41) lgkmcnt(3)
v_mfma_f32_32x32x16_bf16 v[32:47], v[204:207], v[96:99], v[32:47]
ds_read_b128 v[112:115], v23 offset:32768
ds_read_b128 v[116:119], v23 offset:36864
s_waitcnt lgkmcnt(4)
v_mfma_f32_32x32x16_bf16 v[48:63], v[204:207], v[100:103], v[48:63]
ds_read_b128 v[120:123], v23 offset:40960
ds_read_b128 v[124:127], v23 offset:45056
s_waitcnt lgkmcnt(5)
v_mfma_f32_32x32x16_bf16 v[64:79], v[204:207], v[104:107], v[64:79]
buffer_load_dwordx4 v246, s[52:55], s62 offen offset:2048 lds
s_waitcnt lgkmcnt(4)
v_mfma_f32_32x32x16_bf16 v[80:95], v[204:207], v[108:111], v[80:95]
buffer_load_dwordx4 v[204:207], v2, s[40:43], s63 offen offset:2048 sc1
ds_read_b128 v[8:11], v12
s_waitcnt vmcnt(42) lgkmcnt(0)
L_ck74:
v_min3_u32 v15, v8, v9, v10
v_min_u32 v15, v15, v11
s_nop 0
v_readfirstlane_b32 s60, v15
s_nop 0
s_cmp_ge_u32 s60, 9
s_cbranch_scc1 L_ckd75
ds_read_b128 v[8:11], v12 offset:0
s_waitcnt lgkmcnt(0)
s_branch L_ck74
L_ckd75:
v_mfma_f32_32x32x16_bf16 v[32:47], v[208:211], v[112:115], v[32:47]
ds_read_b128 v[96:99], v20 offset:49152
ds_read_b128 v[100:103], v20 offset:53248
v_mfma_f32_32x32x16_bf16 v[48:63], v[208:211], v[116:119], v[48:63]
ds_read_b128 v[104:107], v20 offset:57344
ds_read_b128 v[108:111], v20 offset:61440
v_mfma_f32_32x32x16_bf16 v[64:79], v[208:211], v[120:123], v[64:79]
buffer_load_dwordx4 v247, s[52:55], s62 offen offset:3072 lds
v_mfma_f32_32x32x16_bf16 v[80:95], v[208:211], v[124:127], v[80:95]
buffer_load_dwordx4 v[208:211], v2, s[40:43], s63 offen offset:3072 sc1
s_waitcnt vmcnt(42) lgkmcnt(3)
v_mfma_f32_32x32x16_bf16 v[32:47], v[212:215], v[96:99], v[32:47]
ds_read_b128 v[112:115], v21 offset:49152
ds_read_b128 v[116:119], v21 offset:53248
s_waitcnt lgkmcnt(4)
v_mfma_f32_32x32x16_bf16 v[48:63], v[212:215], v[100:103], v[48:63]
ds_read_b128 v[120:123], v21 offset:57344
ds_read_b128 v[124:127], v21 offset:61440
s_waitcnt lgkmcnt(5)
v_mfma_f32_32x32x16_bf16 v[64:79], v[212:215], v[104:107], v[64:79]
s_add_u32 m0, s67, 0
s_add_u32 s62, s64, 896
s_and_b32 s62, s62, 0x3ff
buffer_load_dwordx4 v244, s[48:51], s62 offen offset:0 lds
s_waitcnt lgkmcnt(4)
v_mfma_f32_32x32x16_bf16 v[80:95], v[212:215], v[108:111], v[80:95]
s_waitcnt vmcnt(42) lgkmcnt(3)
v_mfma_f32_32x32x16_bf16 v[32:47], v[216:219], v[112:115], v[32:47]
ds_read_b128 v[96:99], v22 offset:49152
ds_read_b128 v[100:103], v22 offset:53248
s_waitcnt lgkmcnt(4)
v_mfma_f32_32x32x16_bf16 v[48:63], v[216:219], v[116:119], v[48:63]
ds_read_b128 v[104:107], v22 offset:57344
ds_read_b128 v[108:111], v22 offset:61440
s_waitcnt lgkmcnt(5)
v_mfma_f32_32x32x16_bf16 v[64:79], v[216:219], v[120:123], v[64:79]
buffer_load_dwordx4 v245, s[48:51], s62 offen offset:1024 lds
s_waitcnt lgkmcnt(4)
v_mfma_f32_32x32x16_bf16 v[80:95], v[216:219], v[124:127], v[80:95]
s_waitcnt vmcnt(41) lgkmcnt(3)
v_mfma_f32_32x32x16_bf16 v[32:47], v[220:223], v[96:99], v[32:47]
ds_read_b128 v[112:115], v23 offset:49152
ds_read_b128 v[116:119], v23 offset:53248
s_waitcnt lgkmcnt(4)
v_mfma_f32_32x32x16_bf16 v[48:63], v[220:223], v[100:103], v[48:63]
ds_read_b128 v[120:123], v23 offset:57344
ds_read_b128 v[124:127], v23 offset:61440
s_waitcnt lgkmcnt(5)
v_mfma_f32_32x32x16_bf16 v[64:79], v[220:223], v[104:107], v[64:79]
buffer_load_dwordx4 v246, s[48:51], s62 offen offset:2048 lds
s_waitcnt lgkmcnt(4)
v_mfma_f32_32x32x16_bf16 v[80:95], v[220:223], v[108:111], v[80:95]
s_waitcnt vmcnt(41) lgkmcnt(3)
v_mfma_f32_32x32x16_bf16 v[32:47], v[224:227], v[112:115], v[32:47]
ds_read_b128 v[96:99], v24 offset:0
ds_read_b128 v[100:103], v24 offset:4096
s_waitcnt lgkmcnt(4)
v_mfma_f32_32x32x16_bf16 v[48:63], v[224:227], v[116:119], v[48:63]
ds_read_b128 v[104:107], v24 offset:8192
ds_read_b128 v[108:111], v24 offset:12288
s_waitcnt lgkmcnt(5)
v_mfma_f32_32x32x16_bf16 v[64:79], v[224:227], v[120:123], v[64:79]
buffer_load_dwordx4 v247, s[48:51], s62 offen offset:3072 lds
s_waitcnt lgkmcnt(4)
v_mfma_f32_32x32x16_bf16 v[80:95], v[224:227], v[124:127], v[80:95]
s_waitcnt vmcnt(5) lgkmcnt(3)
v_mov_b32 v14, 10
s_mov_b64 exec, 1
ds_write_b32 v13, v14
s_mov_b64 exec, -1
v_mfma_f32_32x32x16_bf16 v[32:47], v[228:231], v[96:99], v[32:47]
ds_read_b128 v[112:115], v25 offset:0
ds_read_b128 v[116:119], v25 offset:4096
s_waitcnt lgkmcnt(5)
v_mfma_f32_32x32x16_bf16 v[48:63], v[228:231], v[100:103], v[48:63]
ds_read_b128 v[120:123], v25 offset:8192
ds_read_b128 v[124:127], v25 offset:12288
s_waitcnt lgkmcnt(6)
v_mfma_f32_32x32x16_bf16 v[64:79], v[228:231], v[104:107], v[64:79]
s_add_u32 m0, s67, 16384
s_nop 0
buffer_load_dwordx4 v244, s[52:55], s62 offen offset:0 lds
s_waitcnt lgkmcnt(5)
v_mfma_f32_32x32x16_bf16 v[80:95], v[228:231], v[108:111], v[80:95]
s_waitcnt vmcnt(40) lgkmcnt(3)
v_mfma_f32_32x32x16_bf16 v[32:47], v[232:235], v[112:115], v[32:47]
ds_read_b128 v[96:99], v26 offset:0
ds_read_b128 v[100:103], v26 offset:4096
s_waitcnt lgkmcnt(4)
v_mfma_f32_32x32x16_bf16 v[48:63], v[232:235], v[116:119], v[48:63]
ds_read_b128 v[104:107], v26 offset:8192
ds_read_b128 v[108:111], v26 offset:12288
s_waitcnt lgkmcnt(5)
v_mfma_f32_32x32x16_bf16 v[64:79], v[232:235], v[120:123], v[64:79]
buffer_load_dwordx4 v245, s[52:55], s62 offen offset:1024 lds
s_waitcnt lgkmcnt(4)
v_mfma_f32_32x32x16_bf16 v[80:95], v[232:235], v[124:127], v[80:95]
s_waitcnt vmcnt(39) lgkmcnt(3)
v_mfma_f32_32x32x16_bf16 v[32:47], v[236:239], v[96:99], v[32:47]
ds_read_b128 v[112:115], v27 offset:0
ds_read_b128 v[116:119], v27 offset:4096
s_waitcnt lgkmcnt(4)
v_mfma_f32_32x32x16_bf16 v[48:63], v[236:239], v[100:103], v[48:63]
ds_read_b128 v[120:123], v27 offset:8192
ds_read_b128 v[124:127], v27 offset:12288
s_waitcnt lgkmcnt(5)
v_mfma_f32_32x32x16_bf16 v[64:79], v[236:239], v[104:107], v[64:79]
buffer_load_dwordx4 v246, s[52:55], s62 offen offset:2048 lds
s_waitcnt lgkmcnt(4)
v_mfma_f32_32x32x16_bf16 v[80:95], v[236:239], v[108:111], v[80:95]
ds_read_b128 v[8:11], v12
s_waitcnt vmcnt(39) lgkmcnt(0)
L_ck76:
v_min3_u32 v15, v8, v9, v10
v_min_u32 v15, v15, v11
s_nop 0
v_readfirstlane_b32 s60, v15
s_nop 0
s_cmp_ge_u32 s60, 10
s_cbranch_scc1 L_ckd77
ds_read_b128 v[8:11], v12 offset:0
s_waitcnt lgkmcnt(0)
s_branch L_ck76
L_ckd77:
v_mfma_f32_32x32x16_bf16 v[32:47], v[240:243], v[112:115], v[32:47]
ds_read_b128 v[96:99], v24 offset:16384
ds_read_b128 v[100:103], v24 offset:20480
v_mfma_f32_32x32x16_bf16 v[48:63], v[240:243], v[116:119], v[48:63]
ds_read_b128 v[104:107], v24 offset:24576
ds_read_b128 v[108:111], v24 offset:28672
v_mfma_f32_32x32x16_bf16 v[64:79], v[240:243], v[120:123], v[64:79]
buffer_load_dwordx4 v247, s[52:55], s62 offen offset:3072 lds
v_mfma_f32_32x32x16_bf16 v[80:95], v[240:243], v[124:127], v[80:95]
s_waitcnt vmcnt(38) lgkmcnt(3)
v_mfma_f32_32x32x16_bf16 v[32:47], v[148:151], v[96:99], v[32:47]
ds_read_b128 v[112:115], v25 offset:16384
ds_read_b128 v[116:119], v25 offset:20480
s_waitcnt lgkmcnt(4)
v_mfma_f32_32x32x16_bf16 v[48:63], v[148:151], v[100:103], v[48:63]
ds_read_b128 v[120:123], v25 offset:24576
ds_read_b128 v[124:127], v25 offset:28672
s_waitcnt lgkmcnt(5)
v_mfma_f32_32x32x16_bf16 v[64:79], v[148:151], v[104:107], v[64:79]
s_waitcnt lgkmcnt(4)
v_mfma_f32_32x32x16_bf16 v[80:95], v[148:151], v[108:111], v[80:95]
global_load_dword v31, v30, s[26:27]
s_mov_b32 s60, 0
buffer_load_dword v128, v28, s[56:59], s60 offen offset:0
s_mov_b32 s60, 0
buffer_load_dword v129, v28, s[56:59], s60 offen offset:2048
s_mov_b32 s60, 4096
buffer_load_dword v130, v28, s[56:59], s60 offen offset:0
s_mov_b32 s60, 4096
buffer_load_dword v131, v28, s[56:59], s60 offen offset:2048
s_mov_b32 s60, 65536
buffer_load_dword v132, v28, s[56:59], s60 offen offset:0
s_mov_b32 s60, 65536
buffer_load_dword v133, v28, s[56:59], s60 offen offset:2048
s_mov_b32 s60, 69632
buffer_load_dword v134, v28, s[56:59], s60 offen offset:0
s_mov_b32 s60, 69632
buffer_load_dword v135, v28, s[56:59], s60 offen offset:2048
s_mov_b32 s60, 8192
buffer_load_dword v136, v28, s[56:59], s60 offen offset:0
s_mov_b32 s60, 8192
buffer_load_dword v137, v28, s[56:59], s60 offen offset:2048
s_mov_b32 s60, 12288
buffer_load_dword v138, v28, s[56:59], s60 offen offset:0
s_mov_b32 s60, 12288
buffer_load_dword v139, v28, s[56:59], s60 offen offset:2048
s_mov_b32 s60, 73728
buffer_load_dword v140, v28, s[56:59], s60 offen offset:0
s_mov_b32 s60, 73728
buffer_load_dword v141, v28, s[56:59], s60 offen offset:2048
s_mov_b32 s60, 77824
buffer_load_dword v142, v28, s[56:59], s60 offen offset:0
s_mov_b32 s60, 77824
buffer_load_dword v143, v28, s[56:59], s60 offen offset:2048
s_waitcnt vmcnt(53) lgkmcnt(3)
v_mfma_f32_32x32x16_bf16 v[32:47], v[152:155], v[112:115], v[32:47]
ds_read_b128 v[96:99], v26 offset:16384
ds_read_b128 v[100:103], v26 offset:20480
s_waitcnt lgkmcnt(4)
v_mfma_f32_32x32x16_bf16 v[48:63], v[152:155], v[116:119], v[48:63]
ds_read_b128 v[104:107], v26 offset:24576
ds_read_b128 v[108:111], v26 offset:28672
s_waitcnt lgkmcnt(5)
v_mfma_f32_32x32x16_bf16 v[64:79], v[152:155], v[120:123], v[64:79]
s_waitcnt lgkmcnt(4)
v_mfma_f32_32x32x16_bf16 v[80:95], v[152:155], v[124:127], v[80:95]
s_waitcnt vmcnt(51) lgkmcnt(3)
v_mfma_f32_32x32x16_bf16 v[32:47], v[156:159], v[96:99], v[32:47]
ds_read_b128 v[112:115], v27 offset:16384
ds_read_b128 v[116:119], v27 offset:20480
s_waitcnt lgkmcnt(4)
v_mfma_f32_32x32x16_bf16 v[48:63], v[156:159], v[100:103], v[48:63]
ds_read_b128 v[120:123], v27 offset:24576
ds_read_b128 v[124:127], v27 offset:28672
s_waitcnt lgkmcnt(5)
v_mfma_f32_32x32x16_bf16 v[64:79], v[156:159], v[104:107], v[64:79]
s_waitcnt lgkmcnt(4)
v_mfma_f32_32x32x16_bf16 v[80:95], v[156:159], v[108:111], v[80:95]
s_waitcnt vmcnt(49) lgkmcnt(3)
v_mfma_f32_32x32x16_bf16 v[32:47], v[160:163], v[112:115], v[32:47]
ds_read_b128 v[96:99], v24 offset:32768
ds_read_b128 v[100:103], v24 offset:36864
s_waitcnt lgkmcnt(4)
v_mfma_f32_32x32x16_bf16 v[48:63], v[160:163], v[116:119], v[48:63]
s_waitcnt lgkmcnt(3)
v_mfma_f32_32x32x16_bf16 v[64:79], v[160:163], v[120:123], v[64:79]
s_waitcnt lgkmcnt(2)
v_mfma_f32_32x32x16_bf16 v[80:95], v[160:163], v[124:127], v[80:95]
s_waitcnt vmcnt(17) lgkmcnt(1)
v_mov_b32 v14, 11
s_mov_b64 exec, 1
ds_write_b32 v13, v14
s_mov_b64 exec, -1
v_mfma_f32_32x32x16_bf16 v[32:47], v[164:167], v[96:99], v[32:47]
ds_read_b128 v[112:115], v25 offset:32768
ds_read_b128 v[116:119], v25 offset:36864
s_waitcnt lgkmcnt(3)
v_mfma_f32_32x32x16_bf16 v[48:63], v[164:167], v[100:103], v[48:63]
s_waitcnt vmcnt(45) lgkmcnt(1)
v_mfma_f32_32x32x16_bf16 v[32:47], v[168:171], v[112:115], v[32:47]
ds_read_b128 v[96:99], v26 offset:32768
ds_read_b128 v[100:103], v26 offset:36864
s_waitcnt lgkmcnt(2)
v_mfma_f32_32x32x16_bf16 v[48:63], v[168:171], v[116:119], v[48:63]
s_waitcnt vmcnt(43) lgkmcnt(1)
v_mfma_f32_32x32x16_bf16 v[32:47], v[172:175], v[96:99], v[32:47]
ds_read_b128 v[112:115], v27 offset:32768
ds_read_b128 v[116:119], v27 offset:36864
s_waitcnt lgkmcnt(2)
v_mfma_f32_32x32x16_bf16 v[48:63], v[172:175], v[100:103], v[48:63]
ds_read_b128 v[8:11], v12
s_waitcnt vmcnt(41) lgkmcnt(0)
L_ck78:
v_min3_u32 v15, v8, v9, v10
v_min_u32 v15, v15, v11
s_nop 0
v_readfirstlane_b32 s60, v15
s_nop 0
s_cmp_ge_u32 s60, 11
s_cbranch_scc1 L_ckd79
ds_read_b128 v[8:11], v12 offset:0
s_waitcnt lgkmcnt(0)
s_branch L_ck78
L_ckd79:
v_mfma_f32_32x32x16_bf16 v[32:47], v[176:179], v[112:115], v[32:47]
ds_read_b128 v[96:99], v20 offset:0
ds_read_b128 v[100:103], v20 offset:4096
v_mfma_f32_32x32x16_bf16 v[48:63], v[176:179], v[116:119], v[48:63]
s_waitcnt vmcnt(39) lgkmcnt(1)
v_mfma_f32_32x32x16_bf16 v[32:47], v[180:183], v[96:99], v[32:47]
ds_read_b128 v[112:115], v21 offset:0
ds_read_b128 v[116:119], v21 offset:4096
s_waitcnt lgkmcnt(2)
v_mfma_f32_32x32x16_bf16 v[48:63], v[180:183], v[100:103], v[48:63]
s_waitcnt vmcnt(37) lgkmcnt(1)
v_mfma_f32_32x32x16_bf16 v[32:47], v[184:187], v[112:115], v[32:47]
ds_read_b128 v[96:99], v22 offset:0
ds_read_b128 v[100:103], v22 offset:4096
s_waitcnt lgkmcnt(2)
v_mfma_f32_32x32x16_bf16 v[48:63], v[184:187], v[116:119], v[48:63]
s_waitcnt vmcnt(35) lgkmcnt(1)
v_mfma_f32_32x32x16_bf16 v[32:47], v[188:191], v[96:99], v[32:47]
ds_read_b128 v[112:115], v23 offset:0
ds_read_b128 v[116:119], v23 offset:4096
s_waitcnt lgkmcnt(2)
v_mfma_f32_32x32x16_bf16 v[48:63], v[188:191], v[100:103], v[48:63]
s_waitcnt vmcnt(33) lgkmcnt(1)
v_mfma_f32_32x32x16_bf16 v[32:47], v[192:195], v[112:115], v[32:47]
ds_read_b128 v[96:99], v20 offset:16384
ds_read_b128 v[100:103], v20 offset:20480
s_waitcnt lgkmcnt(2)
v_mfma_f32_32x32x16_bf16 v[48:63], v[192:195], v[116:119], v[48:63]
s_waitcnt vmcnt(31) lgkmcnt(1)
v_mfma_f32_32x32x16_bf16 v[32:47], v[196:199], v[96:99], v[32:47]
ds_read_b128 v[112:115], v21 offset:16384
ds_read_b128 v[116:119], v21 offset:20480
s_waitcnt lgkmcnt(2)
v_mfma_f32_32x32x16_bf16 v[48:63], v[196:199], v[100:103], v[48:63]
s_waitcnt vmcnt(29) lgkmcnt(1)
v_mfma_f32_32x32x16_bf16 v[32:47], v[200:203], v[112:115], v[32:47]
ds_read_b128 v[96:99], v22 offset:16384
ds_read_b128 v[100:103], v22 offset:20480
s_waitcnt lgkmcnt(2)
v_mfma_f32_32x32x16_bf16 v[48:63], v[200:203], v[116:119], v[48:63]
s_waitcnt vmcnt(27) lgkmcnt(1)
v_mfma_f32_32x32x16_bf16 v[32:47], v[204:207], v[96:99], v[32:47]
ds_read_b128 v[112:115], v23 offset:16384
ds_read_b128 v[116:119], v23 offset:20480
s_waitcnt lgkmcnt(2)
v_mfma_f32_32x32x16_bf16 v[48:63], v[204:207], v[100:103], v[48:63]
s_waitcnt vmcnt(25) lgkmcnt(0)
v_mfma_f32_32x32x16_bf16 v[32:47], v[208:211], v[112:115], v[32:47]
v_mfma_f32_32x32x16_bf16 v[48:63], v[208:211], v[116:119], v[48:63]
s_mul_i32 s60, s37, 0x9e3779b1
s_and_b32 s60, s60, 0xbfff0000
s_or_b32 s60, s60, 0x20000000
s_sub_u32 s61, s37, 1
s_xor_b32 s61, s61, s60
s_cmp_lt_u32 s61, 0x10000
s_cselect_b32 s61, 0x10000, 0
s_xor_b32 s60, s60, s61
s_lshl_b32 s64, s35, 4
s_add_u32 s64, s64, s36
s_lshl_b32 s64, s64, 2
s_add_u32 s64, s64, s34
s_lshl_b32 s64, s64, 13
s_add_u32 s50, s64, 33554432
s_add_u32 s48, s32, s50
s_addc_u32 s49, s33, 0
s_mov_b32 s50, 8192
s_mov_b32 s51, 0x20000
s_xor_b32 s64, s64, 262144
s_add_u32 s54, s64, 33554432
s_add_u32 s52, s32, s54
s_addc_u32 s53, s33, 0
s_mov_b32 s54, 8192
s_mov_b32 s55, 0x20000
s_movk_i32 s64, 0x1000
v_cvt_pk_bf16_f32 v96, v32, v48
v_cvt_pk_bf16_f32 v97, v33, v49
v_cvt_pk_bf16_f32 v98, v34, v50
v_cvt_pk_bf16_f32 v99, v35, s60
buffer_store_dwordx4 v[96:99], v2, s[48:51], 0 offen offset:0 sc1
v_cvt_pk_bf16_f32 v100, v51, v36
v_cvt_pk_bf16_f32 v101, v52, v37
v_cvt_pk_bf16_f32 v102, v53, v38
v_cvt_pk_bf16_f32 v103, v54, s60
buffer_store_dwordx4 v[100:103], v2, s[48:51], 0 offen offset:1024 sc1
v_cvt_pk_bf16_f32 v244, v39, v55
v_cvt_pk_bf16_f32 v245, v40, v56
v_cvt_pk_bf16_f32 v246, v41, v57
v_cvt_pk_bf16_f32 v247, v42, s60
buffer_store_dwordx4 v[244:247], v2, s[48:51], 0 offen offset:2048 sc1
v_cvt_pk_bf16_f32 v248, v58, v43
v_cvt_pk_bf16_f32 v249, v59, v44
v_cvt_pk_bf16_f32 v250, v60, v45
v_cvt_pk_bf16_f32 v251, v61, s60
buffer_store_dwordx4 v[248:251], v2, s[48:51], 0 offen offset:3072 sc1
v_cvt_pk_bf16_f32 v252, v46, v62
v_cvt_pk_bf16_f32 v253, v47, v63
v_cvt_pk_bf16_f32 v254, v63, v63
v_cvt_pk_bf16_f32 v255, v63, s60
buffer_store_dwordx4 v[252:255], v2, s[48:51], s64 offen offset:0 sc1
ds_read_b128 v[104:107], v24 offset:40960
ds_read_b128 v[108:111], v24 offset:45056
ds_read_b128 v[120:123], v25 offset:40960
ds_read_b128 v[124:127], v25 offset:45056
s_waitcnt lgkmcnt(2)
v_mfma_f32_32x32x16_bf16 v[64:79], v[164:167], v[104:107], v[64:79]
v_mfma_f32_32x32x16_bf16 v[80:95], v[164:167], v[108:111], v[80:95]
ds_read_b128 v[104:107], v26 offset:40960
ds_read_b128 v[108:111], v26 offset:45056
s_waitcnt lgkmcnt(2)
v_mfma_f32_32x32x16_bf16 v[64:79], v[168:171], v[120:123], v[64:79]
v_mfma_f32_32x32x16_bf16 v[80:95], v[168:171], v[124:127], v[80:95]
ds_read_b128 v[120:123], v27 offset:40960
ds_read_b128 v[124:127], v27 offset:45056
s_waitcnt lgkmcnt(2)
v_mfma_f32_32x32x16_bf16 v[64:79], v[172:175], v[104:107], v[64:79]
v_mfma_f32_32x32x16_bf16 v[80:95], v[172:175], v[108:111], v[80:95]
ds_read_b128 v[104:107], v20 offset:8192
ds_read_b128 v[108:111], v20 offset:12288
s_waitcnt lgkmcnt(2)
v_mfma_f32_32x32x16_bf16 v[64:79], v[176:179], v[120:123], v[64:79]
v_mfma_f32_32x32x16_bf16 v[80:95], v[176:179], v[124:127], v[80:95]
ds_read_b128 v[120:123], v21 offset:8192
ds_read_b128 v[124:127], v21 offset:12288
s_waitcnt lgkmcnt(2)
v_mfma_f32_32x32x16_bf16 v[64:79], v[180:183], v[104:107], v[64:79]
v_mfma_f32_32x32x16_bf16 v[80:95], v[180:183], v[108:111], v[80:95]
ds_read_b128 v[104:107], v22 offset:8192
ds_read_b128 v[108:111], v22 offset:12288
s_waitcnt lgkmcnt(2)
v_mfma_f32_32x32x16_bf16 v[64:79], v[184:187], v[120:123], v[64:79]
v_mfma_f32_32x32x16_bf16 v[80:95], v[184:187], v[124:127], v[80:95]
ds_read_b128 v[120:123], v23 offset:8192
ds_read_b128 v[124:127], v23 offset:12288
s_waitcnt lgkmcnt(2)
v_mfma_f32_32x32x16_bf16 v[64:79], v[188:191], v[104:107], v[64:79]
v_mfma_f32_32x32x16_bf16 v[80:95], v[188:191], v[108:111], v[80:95]
ds_read_b128 v[104:107], v20 offset:24576
ds_read_b128 v[108:111], v20 offset:28672
s_waitcnt lgkmcnt(2)
v_mfma_f32_32x32x16_bf16 v[64:79], v[192:195], v[120:123], v[64:79]
v_mfma_f32_32x32x16_bf16 v[80:95], v[192:195], v[124:127], v[80:95]
ds_read_b128 v[120:123], v21 offset:24576
ds_read_b128 v[124:127], v21 offset:28672
s_waitcnt lgkmcnt(2)
v_mfma_f32_32x32x16_bf16 v[64:79], v[196:199], v[104:107], v[64:79]
v_mfma_f32_32x32x16_bf16 v[80:95], v[196:199], v[108:111], v[80:95]
ds_read_b128 v[104:107], v22 offset:24576
ds_read_b128 v[108:111], v22 offset:28672
s_waitcnt lgkmcnt(2)
v_mfma_f32_32x32x16_bf16 v[64:79], v[200:203], v[120:123], v[64:79]
v_mfma_f32_32x32x16_bf16 v[80:95], v[200:203], v[124:127], v[80:95]
ds_read_b128 v[120:123], v23 offset:24576
ds_read_b128 v[124:127], v23 offset:28672
s_waitcnt lgkmcnt(2)
v_mfma_f32_32x32x16_bf16 v[64:79], v[204:207], v[104:107], v[64:79]
v_mfma_f32_32x32x16_bf16 v[80:95], v[204:207], v[108:111], v[80:95]
s_waitcnt lgkmcnt(0)
v_mfma_f32_32x32x16_bf16 v[64:79], v[208:211], v[120:123], v[64:79]
v_mfma_f32_32x32x16_bf16 v[80:95], v[208:211], v[124:127], v[80:95]
s_waitcnt vmcnt(5)
v_lshlrev_b32 v8, 16, v31
v_and_b32 v9, 0xffff0000, v31
v_lshlrev_b32 v148, 16, v128
v_and_b32 v149, 0xffff0000, v128
v_pk_mul_f32 v[148:149], v[148:149], v[8:9]
v_cvt_pk_bf16_f32 v10, v148, v149
v_lshlrev_b32 v148, 16, v10
v_and_b32 v149, 0xffff0000, v10
s_nop 1
v_add_f32 v148, v148, v64
v_add_f32 v149, v149, v80
v_lshlrev_b32 v150, 16, v129
v_and_b32 v151, 0xffff0000, v129
v_pk_mul_f32 v[150:151], v[150:151], v[8:9]
v_cvt_pk_bf16_f32 v10, v150, v151
v_lshlrev_b32 v150, 16, v10
v_and_b32 v151, 0xffff0000, v10
v_add_f32 v150, v150, v65
v_add_f32 v151, v151, v81
v_lshlrev_b32 v152, 16, v130
v_and_b32 v153, 0xffff0000, v130
v_pk_mul_f32 v[152:153], v[152:153], v[8:9]
v_cvt_pk_bf16_f32 v10, v152, v153
v_lshlrev_b32 v152, 16, v10
v_and_b32 v153, 0xffff0000, v10
v_add_f32 v152, v152, v66
v_add_f32 v153, v153, v82
v_lshlrev_b32 v154, 16, v131
v_and_b32 v155, 0xffff0000, v131
v_pk_mul_f32 v[154:155], v[154:155], v[8:9]
v_cvt_pk_bf16_f32 v10, v154, v155
v_lshlrev_b32 v154, 16, v10
v_and_b32 v155, 0xffff0000, v10
v_add_f32 v154, v154, v67
v_add_f32 v155, v155, v83
v_lshlrev_b32 v156, 16, v132
v_and_b32 v157, 0xffff0000, v132
v_pk_mul_f32 v[156:157], v[156:157], v[8:9]
v_cvt_pk_bf16_f32 v10, v156, v157
v_lshlrev_b32 v156, 16, v10
v_and_b32 v157, 0xffff0000, v10
v_add_f32 v156, v156, v68
v_add_f32 v157, v157, v84
v_lshlrev_b32 v158, 16, v133
v_and_b32 v159, 0xffff0000, v133
v_pk_mul_f32 v[158:159], v[158:159], v[8:9]
v_cvt_pk_bf16_f32 v10, v158, v159
v_lshlrev_b32 v158, 16, v10
v_and_b32 v159, 0xffff0000, v10
v_add_f32 v158, v158, v69
v_add_f32 v159, v159, v85
v_lshlrev_b32 v160, 16, v134
v_and_b32 v161, 0xffff0000, v134
v_pk_mul_f32 v[160:161], v[160:161], v[8:9]
v_cvt_pk_bf16_f32 v10, v160, v161
v_lshlrev_b32 v160, 16, v10
v_and_b32 v161, 0xffff0000, v10
v_add_f32 v160, v160, v70
v_add_f32 v161, v161, v86
v_lshlrev_b32 v162, 16, v135
v_and_b32 v163, 0xffff0000, v135
v_pk_mul_f32 v[162:163], v[162:163], v[8:9]
v_cvt_pk_bf16_f32 v10, v162, v163
v_lshlrev_b32 v162, 16, v10
v_and_b32 v163, 0xffff0000, v10
v_add_f32 v162, v162, v71
v_add_f32 v163, v163, v87
v_lshlrev_b32 v164, 16, v136
v_and_b32 v165, 0xffff0000, v136
v_pk_mul_f32 v[164:165], v[164:165], v[8:9]
v_cvt_pk_bf16_f32 v10, v164, v165
v_lshlrev_b32 v164, 16, v10
v_and_b32 v165, 0xffff0000, v10
v_add_f32 v164, v164, v72
v_add_f32 v165, v165, v88
v_lshlrev_b32 v166, 16, v137
v_and_b32 v167, 0xffff0000, v137
v_pk_mul_f32 v[166:167], v[166:167], v[8:9]
v_cvt_pk_bf16_f32 v10, v166, v167
v_lshlrev_b32 v166, 16, v10
v_and_b32 v167, 0xffff0000, v10
v_add_f32 v166, v166, v73
v_add_f32 v167, v167, v89
v_lshlrev_b32 v168, 16, v138
v_and_b32 v169, 0xffff0000, v138
v_pk_mul_f32 v[168:169], v[168:169], v[8:9]
v_cvt_pk_bf16_f32 v10, v168, v169
v_lshlrev_b32 v168, 16, v10
v_and_b32 v169, 0xffff0000, v10
v_add_f32 v168, v168, v74
v_add_f32 v169, v169, v90
v_lshlrev_b32 v170, 16, v139
v_and_b32 v171, 0xffff0000, v139
v_pk_mul_f32 v[170:171], v[170:171], v[8:9]
v_cvt_pk_bf16_f32 v10, v170, v171
v_lshlrev_b32 v170, 16, v10
v_and_b32 v171, 0xffff0000, v10
v_add_f32 v170, v170, v75
v_add_f32 v171, v171, v91
v_lshlrev_b32 v172, 16, v140
v_and_b32 v173, 0xffff0000, v140
v_pk_mul_f32 v[172:173], v[172:173], v[8:9]
v_cvt_pk_bf16_f32 v10, v172, v173
v_lshlrev_b32 v172, 16, v10
v_and_b32 v173, 0xffff0000, v10
v_add_f32 v172, v172, v76
v_add_f32 v173, v173, v92
v_lshlrev_b32 v174, 16, v141
v_and_b32 v175, 0xffff0000, v141
v_pk_mul_f32 v[174:175], v[174:175], v[8:9]
v_cvt_pk_bf16_f32 v10, v174, v175
v_lshlrev_b32 v174, 16, v10
v_and_b32 v175, 0xffff0000, v10
v_add_f32 v174, v174, v77
v_add_f32 v175, v175, v93
v_lshlrev_b32 v176, 16, v142
v_and_b32 v177, 0xffff0000, v142
v_pk_mul_f32 v[176:177], v[176:177], v[8:9]
v_cvt_pk_bf16_f32 v10, v176, v177
v_lshlrev_b32 v176, 16, v10
v_and_b32 v177, 0xffff0000, v10
v_add_f32 v176, v176, v78
v_add_f32 v177, v177, v94
v_lshlrev_b32 v178, 16, v143
v_and_b32 v179, 0xffff0000, v143
v_pk_mul_f32 v[178:179], v[178:179], v[8:9]
v_cvt_pk_bf16_f32 v10, v178, v179
v_lshlrev_b32 v178, 16, v10
v_and_b32 v179, 0xffff0000, v10
v_add_f32 v178, v178, v79
v_add_f32 v179, v179, v95
s_mov_b32 s44, s28
s_mov_b32 s45, s29
s_mov_b32 s46, s24
s_mov_b32 s47, 0x20000
s_mov_b32 s92, 0
L_xw82:
s_load_dword s61, s[52:53], 5116 glc
s_add_u32 s92, s92, 1
s_waitcnt lgkmcnt(0)
s_xor_b32 s61, s61, s60
s_cmp_lt_u32 s61, 0x10000
s_cbranch_scc1 L_xwd83
s_cmp_lt_u32 s92, 200000
s_cbranch_scc1 L_xw82
L_xwd83:
s_mov_b32 s92, 0
buffer_load_dwordx4 v[180:183], v2, s[52:55], 0 offen offset:0 sc1
buffer_load_dwordx4 v[184:187], v2, s[52:55], 0 offen offset:1024 sc1
buffer_load_dwordx4 v[188:191], v2, s[52:55], 0 offen offset:2048 sc1
buffer_load_dwordx4 v[192:195], v2, s[52:55], 0 offen offset:3072 sc1
buffer_load_dwordx4 v[196:199], v2, s[52:55], s64 offen offset:0 sc1
L_xl80:
v_mov_b32 v10, 0
s_waitcnt vmcnt(4)
v_bitop3_b32 v10, v10, v183, s60 bitop3:0xf6
s_waitcnt vmcnt(3)
v_bitop3_b32 v10, v10, v187, s60 bitop3:0xf6
s_waitcnt vmcnt(2)
v_bitop3_b32 v10, v10, v191, s60 bitop3:0xf6
s_waitcnt vmcnt(1)
v_bitop3_b32 v10, v10, v195, s60 bitop3:0xf6
s_waitcnt vmcnt(0)
v_bitop3_b32 v10, v10, v199, s60 bitop3:0xf6
v_cmp_lt_u32 vcc, 0xffff, v10
s_nop 0
s_cbranch_vccz L_xd81
s_add_u32 s92, s92, 1
s_cmp_ge_u32 s92, 200000
s_cbranch_scc1 L_xd81
buffer_load_dwordx4 v[180:183], v2, s[52:55], 0 offen offset:0 sc1
buffer_load_dwordx4 v[184:187], v2, s[52:55], 0 offen offset:1024 sc1
buffer_load_dwordx4 v[188:191], v2, s[52:55], 0 offen offset:2048 sc1
buffer_load_dwordx4 v[192:195], v2, s[52:55], 0 offen offset:3072 sc1
buffer_load_dwordx4 v[196:199], v2, s[52:55], s64 offen offset:0 sc1
s_branch L_xl80
L_xd81:
v_lshlrev_b32 v10, 16, v180
v_and_b32 v11, 0xffff0000, v180
v_pk_add_f32 v[148:149], v[148:149], v[10:11]
s_mov_b32 s64, 0
buffer_store_dwordx2 v[148:149], v29, s[44:47], s64 offen nt
v_lshlrev_b32 v10, 16, v181
v_and_b32 v11, 0xffff0000, v181
v_pk_add_f32 v[150:151], v[150:151], v[10:11]
s_mov_b32 s64, 8192
buffer_store_dwordx2 v[150:151], v29, s[44:47], s64 offen nt
v_lshlrev_b32 v10, 16, v182
v_and_b32 v11, 0xffff0000, v182
v_pk_add_f32 v[152:153], v[152:153], v[10:11]
s_mov_b32 s64, 16384
buffer_store_dwordx2 v[152:153], v29, s[44:47], s64 offen nt
v_lshlrev_b32 v10, 16, v183
v_lshlrev_b32 v11, 16, v184
v_pk_add_f32 v[154:155], v[154:155], v[10:11]
s_mov_b32 s64, 24576
buffer_store_dwordx2 v[154:155], v29, s[44:47], s64 offen nt
v_and_b32 v10, 0xffff0000, v184
v_lshlrev_b32 v11, 16, v185
v_pk_add_f32 v[156:157], v[156:157], v[10:11]
s_mov_b32 s64, 262144
buffer_store_dwordx2 v[156:157], v29, s[44:47], s64 offen nt
v_and_b32 v10, 0xffff0000, v185
v_lshlrev_b32 v11, 16, v186
v_pk_add_f32 v[158:159], v[158:159], v[10:11]
s_mov_b32 s64, 270336
buffer_store_dwordx2 v[158:159], v29, s[44:47], s64 offen nt
v_and_b32 v10, 0xffff0000, v186
v_lshlrev_b32 v11, 16, v187
v_pk_add_f32 v[160:161], v[160:161], v[10:11]
s_mov_b32 s64, 278528
buffer_store_dwordx2 v[160:161], v29, s[44:47], s64 offen nt
v_lshlrev_b32 v10, 16, v188
v_and_b32 v11, 0xffff0000, v188
v_pk_add_f32 v[162:163], v[162:163], v[10:11]
s_mov_b32 s64, 286720
buffer_store_dwordx2 v[162:163], v29, s[44:47], s64 offen nt
v_lshlrev_b32 v10, 16, v189
v_and_b32 v11, 0xffff0000, v189
v_pk_add_f32 v[164:165], v[164:165], v[10:11]
s_mov_b32 s64, 32768
buffer_store_dwordx2 v[164:165], v29, s[44:47], s64 offen nt
v_lshlrev_b32 v10, 16, v190
v_and_b32 v11, 0xffff0000, v190
v_pk_add_f32 v[166:167], v[166:167], v[10:11]
s_mov_b32 s64, 40960
buffer_store_dwordx2 v[166:167], v29, s[44:47], s64 offen nt
v_lshlrev_b32 v10, 16, v191
v_lshlrev_b32 v11, 16, v192
v_pk_add_f32 v[168:169], v[168:169], v[10:11]
s_mov_b32 s64, 49152
buffer_store_dwordx2 v[168:169], v29, s[44:47], s64 offen nt
v_and_b32 v10, 0xffff0000, v192
v_lshlrev_b32 v11, 16, v193
v_pk_add_f32 v[170:171], v[170:171], v[10:11]
s_mov_b32 s64, 57344
buffer_store_dwordx2 v[170:171], v29, s[44:47], s64 offen nt
v_and_b32 v10, 0xffff0000, v193
v_lshlrev_b32 v11, 16, v194
v_pk_add_f32 v[172:173], v[172:173], v[10:11]
s_mov_b32 s64, 294912
buffer_store_dwordx2 v[172:173], v29, s[44:47], s64 offen nt
v_and_b32 v10, 0xffff0000, v194
v_lshlrev_b32 v11, 16, v195
v_pk_add_f32 v[174:175], v[174:175], v[10:11]
s_mov_b32 s64, 303104
buffer_store_dwordx2 v[174:175], v29, s[44:47], s64 offen nt
v_lshlrev_b32 v10, 16, v196
v_and_b32 v11, 0xffff0000, v196
v_pk_add_f32 v[176:177], v[176:177], v[10:11]
s_mov_b32 s64, 311296
buffer_store_dwordx2 v[176:177], v29, s[44:47], s64 offen nt
v_lshlrev_b32 v10, 16, v197
v_and_b32 v11, 0xffff0000, v197
v_pk_add_f32 v[178:179], v[178:179], v[10:11]
s_mov_b32 s64, 319488
buffer_store_dwordx2 v[178:179], v29, s[44:47], s64 offen nt
L_concat_heads__spectral_gfnet__ssm_conv_s5__prompt_kernel_end:
s_endpgm

.section .rodata,"a"
.p2align 6
.amdhsa_kernel concat_heads__spectral_gfnet__ssm_conv_s5__prompt_kernel
  .amdhsa_next_free_vgpr 256
  .amdhsa_next_free_sgpr 102
  .amdhsa_accum_offset 256
  .amdhsa_group_segment_fixed_size 0
  .amdhsa_kernarg_size 120
  .amdhsa_user_sgpr_count 2
  .amdhsa_user_sgpr_kernarg_segment_ptr 1
  .amdhsa_system_sgpr_workgroup_id_x 1
.end_amdhsa_kernel
.text
```

```asm
; @launch grid=(256,1,1) block=(512,1,1) lds=163840
.amdgcn_target "amdgcn-amd-amdhsa--gfx950"
.text
.globl concat_heads__spectral_gfnet__ssm_conv_s5__prompt_kernel
.p2align 8
.type concat_heads__spectral_gfnet__ssm_conv_s5__prompt_kernel,@function
concat_heads__spectral_gfnet__ssm_conv_s5__prompt_kernel:
s_cmp_ge_u32 s2, 256
s_cbranch_scc1 L_concat_heads__spectral_gfnet__ssm_conv_s5__prompt_kernel_end
s_load_dwordx16 s[4:19], s[0:1], 0
s_load_dwordx8 s[20:27], s[0:1], 64
s_load_dwordx4 s[28:31], s[0:1], 96
s_load_dwordx2 s[32:33], s[0:1], 112
v_lshrrev_b32 v2, 6, v0
v_and_b32 v1, 63, v0
v_readfirstlane_b32 s34, v2
s_and_b32 s60, s2, 7
s_lshr_b32 s61, s2, 3
s_lshr_b32 s35, s60, 1
s_lshr_b32 s62, s61, 3
s_lshl_b32 s62, s62, 2
s_add_u32 s35, s35, s62
s_and_b32 s36, s60, 1
s_lshl_b32 s36, s36, 3
s_and_b32 s62, s61, 7
s_add_u32 s36, s36, s62
s_xor_b32 s34, s34, 4
s_cmp_ge_u32 s34, 4
s_cbranch_scc0 L_concat_heads__spectral_gfnet__ssm_conv_s5__prompt_kernel_gemm
s_sub_u32 s66, s34, 4
s_setprio 0
s_waitcnt lgkmcnt(0)
s_mov_b32 s100, s20
s_mov_b32 s101, s21
s_bitcmp1_b32 s66, 0
s_cselect_b32 s100, s22, s20
s_cselect_b32 s101, s23, s21
s_cmp_lg_u32 s66, 1
s_cbranch_scc1 L_pf1
s_lshr_b32 s60, s2, 3
s_lshl_b32 s60, s60, 11
v_and_b32 v12, 15, v1
v_lshl_add_u32 v12, v12, 7, s60
v_min_u32 v12, L_concat_heads__spectral_gfnet__ssm_conv_s5__prompt_kernel_end-concat_heads__spectral_gfnet__ssm_conv_s5__prompt_kernel, v12
s_getpc_b64 s[60:61]
L_pc2:
s_sub_u32 s60, s60, L_pc2-concat_heads__spectral_gfnet__ssm_conv_s5__prompt_kernel
s_subb_u32 s61, s61, 0
global_load_dword v23, v12, s[60:61]
L_pf1:
s_lshl_b32 s60, s2, 3
s_add_u32 s60, s60, s34
s_cmp_lg_u32 s60, 4
s_cbranch_scc1 L_nn3
s_load_dword s3, s[32:33], 0
L_nn3:
s_mov_b32 s48, s6
s_mov_b32 s49, s7
s_mov_b32 s50, 2101248
s_mov_b32 s51, 0x20000
s_mov_b32 s52, s8
s_mov_b32 s53, s9
s_mov_b32 s54, 2101248
s_mov_b32 s55, 0x20000
s_and_b32 s60, s2, 31
s_lshr_b32 s61, s2, 5
s_lshl_b32 s61, s61, 7
s_add_u32 s60, s60, s61
s_lshl_b32 s61, s66, 5
s_add_u32 s67, s60, s61
s_lshl_b32 s60, s67, 12
s_add_u32 s4, s4, s60
s_addc_u32 s5, s5, 0
s_mov_b32 s6, 4096
s_mov_b32 s7, 0x20000
v_lshlrev_b32 v2, 4, v1
v_xor_b32 v3, 128, v2
s_lshl_b32 s68, s66, 12
s_add_u32 s68, s68, 131072
s_add_u32 m0, s68, 0
s_mov_b32 s92, 0
buffer_load_dwordx4 v2, s[4:7], s92 offen offset:0 nt lds
buffer_load_dwordx4 v2, s[4:7], s92 offen offset:1024 nt lds
s_add_u32 m0, s68, 2048
s_mov_b32 s92, 2048
buffer_load_dwordx4 v3, s[4:7], s92 offen offset:0 nt lds
buffer_load_dwordx4 v3, s[4:7], s92 offen offset:1024 nt lds
s_and_b32 s60, s2, 7
s_bfe_u32 s61, s2, 0x10003
s_bfe_u32 s62, s2, 0x20004
s_lshr_b32 s63, s2, 6
s_lshr_b32 s64, s60, 1
s_lshl_b32 s64, s64, 3
s_lshl_b32 s65, s61, 2
s_add_u32 s64, s64, s65
s_and_b32 s65, s60, 1
s_lshl_b32 s65, s65, 1
s_add_u32 s64, s64, s65
s_lshl_b32 s64, s64, 5
s_lshl_b32 s65, s62, 3
s_add_u32 s64, s64, s65
s_lshl_b32 s65, s66, 1
s_add_u32 s64, s64, s65
s_mul_i32 s64, s64, 1026
s_lshl_b32 s65, s63, 8
s_add_u32 s69, s64, s65
v_bfe_u32 v8, v1, 4, 1
v_mul_u32_u24 v8, 32832, v8
v_lshrrev_b32 v9, 5, v1
s_mov_b32 s65, 1050624
v_mul_lo_u32 v9, s65, v9
v_add_u32 v8, v8, v9
v_and_b32 v9, 15, v1
s_lshl_b32 s65, s66, 1
v_xor_b32 v9, s65, v9
v_lshl_add_u32 v18, v9, 4, v8
v_xor_b32 v9, 1, v9
v_lshl_add_u32 v19, v9, 4, v8
v_add_u32 v19, 1026, v19
s_bfe_u32 s64, s2, 0x20005
s_lshl_b32 s64, s64, 8
s_bfe_u32 s65, s2, 0x10004
s_lshl_b32 s65, s65, 6
s_add_u32 s64, s64, s65
s_bfe_u32 s65, s2, 0x10003
s_lshl_b32 s65, s65, 7
s_add_u32 s64, s64, s65
s_and_b32 s65, s2, 7
s_lshl_b32 s65, s65, 2
s_add_u32 s64, s64, s65
v_bfe_u32 v8, v1, 3, 2
v_add_u32 v8, s64, v8
v_bfe_u32 v9, v1, 2, 1
v_lshl_add_u32 v8, v9, 5, v8
v_bfe_u32 v9, v1, 1, 1
v_lshl_add_u32 v8, v9, 10, v8
v_sub_u32 v9, 2048, v8
v_and_b32 v9, 2047, v9
v_and_b32 v10, 1, v1
v_cmp_eq_u32 vcc, 1, v10
s_nop 1
v_cndmask_b32 v8, v8, v9, vcc
v_mul_u32_u24 v17, 1026, v8
s_lshr_b32 s64, s2, 7
s_lshl_b32 s64, s64, 10
v_add_u32 v17, s64, v17
s_add_u32 m0, s68, 16384
s_nop 0
buffer_load_dwordx4 v18, s[48:51], s69 offen nt lds
s_add_u32 m0, s68, 17408
s_nop 0
buffer_load_dwordx4 v18, s[52:55], s69 offen nt lds
s_add_u32 m0, s68, 18432
s_nop 0
buffer_load_dwordx4 v19, s[48:51], s69 offen nt lds
s_add_u32 m0, s68, 19456
s_nop 0
buffer_load_dwordx4 v19, s[52:55], s69 offen nt lds
s_cmp_lg_u32 s66, 3
s_cbranch_scc1 L_nw4
s_mov_b32 exec_hi, 0
buffer_load_ushort v88, v17, s[48:51], 0 offen nt
buffer_load_ushort v89, v17, s[52:55], 0 offen nt
s_mov_b64 exec, -1
L_nw4:
s_cmp_lg_u32 s2, 0
s_cbranch_scc1 L_nz5
s_lshl_b32 s24, s66, 10
s_add_u32 s24, s24, 4096
s_add_u32 s24, s32, s24
s_addc_u32 s25, s33, 0
s_mov_b32 s26, 0
s_atomic_swap s26, s[24:25], 0x0
s_atomic_swap s26, s[24:25], 0x80
s_atomic_swap s26, s[24:25], 0x100
s_atomic_swap s26, s[24:25], 0x180
s_atomic_swap s26, s[24:25], 0x200
s_atomic_swap s26, s[24:25], 0x280
s_atomic_swap s26, s[24:25], 0x300
s_atomic_swap s26, s[24:25], 0x380
L_nz5:
s_barrier
v_and_b32 v92, 31, v1
v_cvt_f32_u32 v92, v92
v_lshrrev_b32 v93, 5, v1
v_lshlrev_b32 v93, 2, v93
v_cvt_f32_u32 v93, v93
v_mul_f32 v93, v92, v93
v_mul_f32 v93, 0x3d000000, v93
v_fmamk_f32 v94, v92, 0x0, v93
v_fract_f32 v94, v94
v_cos_f32 v95, v94
v_sin_f32 v96, v94
s_nop 0
v_cvt_pk_bf16_f32 v192, v95, v96
v_cvt_pk_bf16_f32 v208, -v96, v95
v_fmamk_f32 v97, v92, 0x3d000000, v93
v_fract_f32 v97, v97
v_cos_f32 v98, v97
v_sin_f32 v99, v97
s_nop 0
v_cvt_pk_bf16_f32 v193, v98, v99
v_cvt_pk_bf16_f32 v209, -v99, v98
v_fmamk_f32 v94, v92, 0x3d800000, v93
v_fract_f32 v94, v94
v_cos_f32 v95, v94
v_sin_f32 v96, v94
s_nop 0
v_cvt_pk_bf16_f32 v194, v95, v96
v_cvt_pk_bf16_f32 v210, -v96, v95
v_fmamk_f32 v97, v92, 0x3dc00000, v93
v_fract_f32 v97, v97
v_cos_f32 v98, v97
v_sin_f32 v99, v97
s_nop 0
v_cvt_pk_bf16_f32 v195, v98, v99
v_cvt_pk_bf16_f32 v211, -v99, v98
v_fmamk_f32 v94, v92, 0x3e800000, v93
v_fract_f32 v94, v94
v_cos_f32 v95, v94
v_sin_f32 v96, v94
s_nop 0
v_cvt_pk_bf16_f32 v196, v95, v96
v_cvt_pk_bf16_f32 v212, -v96, v95
v_fmamk_f32 v97, v92, 0x3e900000, v93
v_fract_f32 v97, v97
v_cos_f32 v98, v97
v_sin_f32 v99, v97
s_nop 0
v_cvt_pk_bf16_f32 v197, v98, v99
v_cvt_pk_bf16_f32 v213, -v99, v98
v_fmamk_f32 v94, v92, 0x3ea00000, v93
v_fract_f32 v94, v94
v_cos_f32 v95, v94
v_sin_f32 v96, v94
s_nop 0
v_cvt_pk_bf16_f32 v198, v95, v96
v_cvt_pk_bf16_f32 v214, -v96, v95
v_fmamk_f32 v97, v92, 0x3eb00000, v93
v_fract_f32 v97, v97
v_cos_f32 v98, v97
v_sin_f32 v99, v97
s_nop 0
v_cvt_pk_bf16_f32 v199, v98, v99
v_cvt_pk_bf16_f32 v215, -v99, v98
v_fmamk_f32 v94, v92, 0x3f000000, v93
v_fract_f32 v94, v94
v_cos_f32 v95, v94
v_sin_f32 v96, v94
s_nop 0
v_cvt_pk_bf16_f32 v200, v95, v96
v_cvt_pk_bf16_f32 v216, -v96, v95
v_fmamk_f32 v97, v92, 0x3f080000, v93
v_fract_f32 v97, v97
v_cos_f32 v98, v97
v_sin_f32 v99, v97
s_nop 0
v_cvt_pk_bf16_f32 v201, v98, v99
v_cvt_pk_bf16_f32 v217, -v99, v98
v_fmamk_f32 v94, v92, 0x3f100000, v93
v_fract_f32 v94, v94
v_cos_f32 v95, v94
v_sin_f32 v96, v94
s_nop 0
v_cvt_pk_bf16_f32 v202, v95, v96
v_cvt_pk_bf16_f32 v218, -v96, v95
v_fmamk_f32 v97, v92, 0x3f180000, v93
v_fract_f32 v97, v97
v_cos_f32 v98, v97
v_sin_f32 v99, v97
s_nop 0
v_cvt_pk_bf16_f32 v203, v98, v99
v_cvt_pk_bf16_f32 v219, -v99, v98
v_fmamk_f32 v94, v92, 0x3f400000, v93
v_fract_f32 v94, v94
v_cos_f32 v95, v94
v_sin_f32 v96, v94
s_nop 0
v_cvt_pk_bf16_f32 v204, v95, v96
v_cvt_pk_bf16_f32 v220, -v96, v95
v_fmamk_f32 v97, v92, 0x3f480000, v93
v_fract_f32 v97, v97
v_cos_f32 v98, v97
v_sin_f32 v99, v97
s_nop 0
v_cvt_pk_bf16_f32 v205, v98, v99
v_cvt_pk_bf16_f32 v221, -v99, v98
v_fmamk_f32 v94, v92, 0x3f500000, v93
v_fract_f32 v94, v94
v_cos_f32 v95, v94
v_sin_f32 v96, v94
s_nop 0
v_cvt_pk_bf16_f32 v206, v95, v96
v_cvt_pk_bf16_f32 v222, -v96, v95
v_fmamk_f32 v97, v92, 0x3f580000, v93
v_fract_f32 v97, v97
v_cos_f32 v98, v97
v_sin_f32 v99, v97
s_nop 0
v_cvt_pk_bf16_f32 v207, v98, v99
v_cvt_pk_bf16_f32 v223, -v99, v98
v_and_b32 v92, 31, v1
v_cvt_f32_u32 v92, v92
v_lshrrev_b32 v93, 5, v1
v_lshlrev_b32 v93, 2, v93
v_cvt_f32_u32 v93, v93
v_mul_f32 v93, v92, v93
v_mul_f32 v93, 0x3a800000, v93
v_fmamk_f32 v94, v92, 0x0, v93
v_cos_f32 v224, v94
v_sin_f32 v240, -v94
v_fmamk_f32 v95, v92, 0x3a800000, v93
v_cos_f32 v225, v95
v_sin_f32 v241, -v95
v_fmamk_f32 v94, v92, 0x3b000000, v93
v_cos_f32 v226, v94
v_sin_f32 v242, -v94
v_fmamk_f32 v95, v92, 0x3b400000, v93
v_cos_f32 v227, v95
v_sin_f32 v243, -v95
v_fmamk_f32 v94, v92, 0x3c000000, v93
v_cos_f32 v228, v94
v_sin_f32 v244, -v94
v_fmamk_f32 v95, v92, 0x3c100000, v93
v_cos_f32 v229, v95
v_sin_f32 v245, -v95
v_fmamk_f32 v94, v92, 0x3c200000, v93
v_cos_f32 v230, v94
v_sin_f32 v246, -v94
v_fmamk_f32 v95, v92, 0x3c300000, v93
v_cos_f32 v231, v95
v_sin_f32 v247, -v95
v_fmamk_f32 v94, v92, 0x3c800000, v93
v_cos_f32 v232, v94
v_sin_f32 v248, -v94
v_fmamk_f32 v95, v92, 0x3c880000, v93
v_cos_f32 v233, v95
v_sin_f32 v249, -v95
v_fmamk_f32 v94, v92, 0x3c900000, v93
v_cos_f32 v234, v94
v_sin_f32 v250, -v94
v_fmamk_f32 v95, v92, 0x3c980000, v93
v_cos_f32 v235, v95
v_sin_f32 v251, -v95
v_fmamk_f32 v94, v92, 0x3cc00000, v93
v_cos_f32 v236, v94
v_sin_f32 v252, -v94
v_fmamk_f32 v95, v92, 0x3cc80000, v93
v_cos_f32 v237, v95
v_sin_f32 v253, -v95
v_fmamk_f32 v94, v92, 0x3cd00000, v93
v_cos_f32 v238, v94
v_sin_f32 v254, -v94
v_fmamk_f32 v95, v92, 0x3cd80000, v93
v_cos_f32 v239, v95
v_sin_f32 v255, -v95
v_mov_b32 v184, 126992
s_lshl_b32 s64, s66, 2
v_add_u32 v185, s64, v184
v_and_b32 v8, 31, v1
v_lshrrev_b32 v9, 5, v1
v_and_b32 v10, 1, v1
v_lshrrev_b32 v11, 1, v8
v_lshlrev_b32 v4, 6, v11
v_lshl_add_u32 v4, v10, 4, v4
v_lshl_add_u32 v4, v9, 12, v4
v_add_u32 v11, v11, v10
v_lshlrev_b32 v11, 6, v11
v_lshl_add_u32 v11, v10, 4, v11
v_lshl_add_u32 v11, v9, 12, v11
v_sub_u32 v5, 5168, v11
v_bfe_u32 v11, v4, 7, 1
v_lshlrev_b32 v11, 5, v11
v_xor_b32 v4, v4, v11
v_bfe_u32 v11, v5, 7, 1
v_lshlrev_b32 v11, 5, v11
v_xor_b32 v5, v5, v11
v_add_u32 v6, 11264, v5
v_and_b32 v6, 0x3fff, v6
s_add_u32 s64, s64, 98304
v_add_u32 v4, s64, v4
v_add_u32 v5, s64, v5
v_add_u32 v6, s64, v6
v_bfe_u32 v11, v1, 3, 1
v_lshlrev_b32 v11, 5, v11
v_xor_b32 v7, v2, v11
v_bfe_u32 v12, v1, 2, 1
v_mul_u32_u24 v12, 2176, v12
v_bfe_u32 v13, v1, 3, 1
v_lshl_add_u32 v12, v13, 6, v12
v_lshl_add_u32 v12, v9, 8, v12
v_bfe_u32 v13, v1, 4, 1
v_lshl_add_u32 v12, v13, 5, v12
v_and_b32 v13, 3, v1
v_lshl_add_u32 v12, v13, 3, v12
v_add_u32 v12, s68, v12
v_xor_b32 v13, 128, v12
s_lshl_b32 s64, s2, 14
s_lshl_b32 s65, s66, 12
s_add_u32 s64, s64, s65
s_add_u32 s42, s64, 16777216
s_add_u32 s40, s32, s42
s_addc_u32 s41, s33, 0
s_mov_b32 s42, 4096
s_mov_b32 s43, 0x20000
s_add_u32 s46, s64, 16777216
s_add_u32 s44, s32, s46
s_addc_u32 s45, s33, 0
s_mov_b32 s46, 4096
s_mov_b32 s47, 0x20000
v_and_b32 v14, 7, v1
v_lshrrev_b32 v15, 3, v1
v_xor_b32 v16, v14, v15
v_lshlrev_b32 v16, 4, v16
v_lshl_add_u32 v16, v14, 11, v16
s_lshr_b32 s64, s66, 1
s_lshl_b32 s64, s64, 7
s_and_b32 s65, s66, 1
s_lshl_b32 s65, s65, 3
s_add_u32 s64, s64, s65
s_add_u32 s64, s64, 147456
v_add_u32 v21, s64, v16
v_lshlrev_b32 v15, 16, v15
v_lshl_add_u32 v22, v14, 4, v15
s_lshl_b32 s64, s63, 7
s_lshr_b32 s65, s66, 1
s_lshl_b32 s65, s65, 6
s_add_u32 s64, s64, s65
s_and_b32 s65, s66, 1
s_lshl_b32 s65, s65, 2
s_add_u32 s64, s64, s65
s_mul_i32 s64, s64, 8192
s_lshr_b32 s65, s60, 2
s_mul_i32 s65, s65, 0
s_add_u32 s64, s64, s65
s_lshl_b32 s65, s60, 10
s_add_u32 s64, s64, s65
s_lshl_b32 s65, s61, 9
s_add_u32 s64, s64, s65
s_lshl_b32 s65, s62, 7
s_add_u32 s64, s64, s65
s_add_u32 s58, s64, 25182208
s_add_u32 s56, s32, s58
s_addc_u32 s57, s33, 0
s_sub_u32 s58, 4194304, s64
s_mov_b32 s59, 0x20000
s_lshl_b32 s64, s35, 18
s_lshl_b32 s65, s36, 17
s_add_u32 s12, s10, s64
s_addc_u32 s13, s11, 0
s_mov_b32 s14, 262144
s_mov_b32 s15, 0x20000
s_bitcmp1_b32 s66, 0
s_cselect_b32 s8, s18, s16
s_cselect_b32 s9, s19, s17
s_add_u32 s20, s8, s65
s_addc_u32 s21, s9, 0
s_mov_b32 s22, 131072
s_mov_b32 s23, 0x20000
s_bfe_u32 s16, s2, 0x20001
s_lshl_b32 s16, s16, 2
s_lshr_b32 s64, s2, 6
s_add_u32 s16, s16, s64
s_mul_i32 s16, s16, 128
s_mul_i32 s64, s36, 128
s_add_u32 s16, s16, s64
s_bfe_u32 s64, s16, 0x30007
s_cmp_eq_u32 s64, 3
s_cselect_b32 s64, 128, 0
s_add_u32 s16, s16, s64
s_lshl_b32 s17, s66, 12
s_lshr_b32 s64, s66, 1
s_and_b32 s65, s66, 1
v_lshrrev_b32 v96, 5, v1
v_bfe_u32 v97, v1, 3, 2
v_and_b32 v98, 1, v97
v_lshrrev_b32 v99, 1, v97
v_lshlrev_b32 v100, 4, v96
v_lshl_add_u32 v100, v98, 3, v100
v_add_u32 v100, v100, v99
s_lshl_b32 s92, s64, 6
s_lshl_b32 s19, s65, 2
s_add_u32 s92, s92, s19
v_add_u32 v100, s92, v100
v_lshlrev_b32 v100, 11, v100
s_lshl_b32 s92, s64, 5
v_lshl_add_u32 v101, v96, 3, v97
v_add_u32 v101, s92, v101
v_lshlrev_b32 v101, 11, v101
v_and_b32 v98, 7, v1
v_lshrrev_b32 v99, 4, v1
v_xor_b32 v98, v98, v99
v_lshlrev_b32 v98, 4, v98
v_xor_b32 v99, 64, v98
v_add_u32 v176, v100, v98
v_add_u32 v177, v100, v99
v_add_u32 v177, 64512, v177
v_add_u32 v178, v101, v98
v_add_u32 v179, v101, v99
v_add_u32 v179, 31744, v179
s_waitcnt vmcnt(4)
ds_read_b64_tr_b16 v[24:25], v12 offset:0
ds_read_b64_tr_b16 v[26:27], v13 offset:0
ds_read_b64_tr_b16 v[28:29], v12 offset:512
ds_read_b64_tr_b16 v[30:31], v13 offset:512
ds_read_b64_tr_b16 v[32:33], v12 offset:1024
ds_read_b64_tr_b16 v[34:35], v13 offset:1024
ds_read_b64_tr_b16 v[36:37], v12 offset:1536
ds_read_b64_tr_b16 v[38:39], v13 offset:1536
s_waitcnt lgkmcnt(0)
v_mfma_f32_32x32x16_bf16 v[40:55], v[24:27], v[192:195], 0
v_mfma_f32_32x32x16_bf16 v[40:55], v[28:31], v[196:199], v[40:55]
v_mfma_f32_32x32x16_bf16 v[40:55], v[32:35], v[200:203], v[40:55]
v_mfma_f32_32x32x16_bf16 v[40:55], v[36:39], v[204:207], v[40:55]
v_mfma_f32_32x32x16_bf16 v[56:71], v[24:27], v[208:211], 0
v_mfma_f32_32x32x16_bf16 v[56:71], v[28:31], v[212:215], v[56:71]
v_mfma_f32_32x32x16_bf16 v[56:71], v[32:35], v[216:219], v[56:71]
v_mfma_f32_32x32x16_bf16 v[56:71], v[36:39], v[220:223], v[56:71]
s_nop 7
v_mul_f32 v168, v40, v224
v_mul_f32 v169, v40, v240
s_nop 1
v_fma_f32 v168, -v56, v240, v168
v_fmac_f32 v169, v56, v224
v_cvt_pk_bf16_f32 v72, v168, v169
v_mul_f32 v170, v41, v225
v_mul_f32 v171, v41, v241
v_fma_f32 v170, -v57, v241, v170
v_fmac_f32 v171, v57, v225
v_cvt_pk_bf16_f32 v73, v170, v171
v_mul_f32 v172, v42, v226
v_mul_f32 v173, v42, v242
v_fma_f32 v172, -v58, v242, v172
v_fmac_f32 v173, v58, v226
v_cvt_pk_bf16_f32 v74, v172, v173
v_mul_f32 v174, v43, v227
v_mul_f32 v175, v43, v243
v_fma_f32 v174, -v59, v243, v174
v_fmac_f32 v175, v59, v227
v_cvt_pk_bf16_f32 v75, v174, v175
v_mul_f32 v168, v44, v228
v_mul_f32 v169, v44, v244
v_fma_f32 v168, -v60, v244, v168
v_fmac_f32 v169, v60, v228
v_cvt_pk_bf16_f32 v76, v168, v169
v_mul_f32 v170, v45, v229
v_mul_f32 v171, v45, v245
v_fma_f32 v170, -v61, v245, v170
v_fmac_f32 v171, v61, v229
v_cvt_pk_bf16_f32 v77, v170, v171
v_mul_f32 v172, v46, v230
v_mul_f32 v173, v46, v246
v_fma_f32 v172, -v62, v246, v172
v_fmac_f32 v173, v62, v230
v_cvt_pk_bf16_f32 v78, v172, v173
v_mul_f32 v174, v47, v231
v_mul_f32 v175, v47, v247
v_fma_f32 v174, -v63, v247, v174
v_fmac_f32 v175, v63, v231
v_cvt_pk_bf16_f32 v79, v174, v175
v_mul_f32 v168, v48, v232
v_mul_f32 v169, v48, v248
v_fma_f32 v168, -v64, v248, v168
v_fmac_f32 v169, v64, v232
v_cvt_pk_bf16_f32 v80, v168, v169
v_mul_f32 v170, v49, v233
v_mul_f32 v171, v49, v249
v_fma_f32 v170, -v65, v249, v170
v_fmac_f32 v171, v65, v233
v_cvt_pk_bf16_f32 v81, v170, v171
v_mul_f32 v172, v50, v234
v_mul_f32 v173, v50, v250
v_fma_f32 v172, -v66, v250, v172
v_fmac_f32 v173, v66, v234
v_cvt_pk_bf16_f32 v82, v172, v173
v_mul_f32 v174, v51, v235
v_mul_f32 v175, v51, v251
v_fma_f32 v174, -v67, v251, v174
v_fmac_f32 v175, v67, v235
v_cvt_pk_bf16_f32 v83, v174, v175
v_mul_f32 v168, v52, v236
v_mul_f32 v169, v52, v252
v_fma_f32 v168, -v68, v252, v168
v_fmac_f32 v169, v68, v236
v_cvt_pk_bf16_f32 v84, v168, v169
v_mul_f32 v170, v53, v237
v_mul_f32 v171, v53, v253
v_fma_f32 v170, -v69, v253, v170
v_fmac_f32 v171, v69, v237
v_cvt_pk_bf16_f32 v85, v170, v171
v_mul_f32 v172, v54, v238
v_mul_f32 v173, v54, v254
v_fma_f32 v172, -v70, v254, v172
v_fmac_f32 v173, v70, v238
v_cvt_pk_bf16_f32 v86, v172, v173
v_mul_f32 v174, v55, v239
v_mul_f32 v175, v55, v255
v_fma_f32 v174, -v71, v255, v174
v_fmac_f32 v175, v71, v239
v_cvt_pk_bf16_f32 v87, v174, v175
v_mfma_f32_32x32x16_bf16 v[40:55], v[192:195], v[72:75], 0
v_mfma_f32_32x32x16_bf16 v[40:55], v[196:199], v[76:79], v[40:55]
v_mfma_f32_32x32x16_bf16 v[40:55], v[200:203], v[80:83], v[40:55]
v_mfma_f32_32x32x16_bf16 v[40:55], v[204:207], v[84:87], v[40:55]
v_mfma_f32_32x32x16_bf16 v[56:71], v[208:211], v[72:75], 0
v_mfma_f32_32x32x16_bf16 v[56:71], v[212:215], v[76:79], v[56:71]
v_mfma_f32_32x32x16_bf16 v[56:71], v[216:219], v[80:83], v[56:71]
v_mfma_f32_32x32x16_bf16 v[56:71], v[220:223], v[84:87], v[56:71]
s_lshl_b32 s92, s66, 12
s_add_u32 s92, s92, 98304
v_add_u32 v8, s92, v7
s_nop 8
v_cvt_pk_bf16_f32 v72, v40, v56
ds_write_b32 v4, v72 offset:0
v_cvt_pk_bf16_f32 v73, v41, v57
ds_write_b32 v4, v73 offset:1024
v_cvt_pk_bf16_f32 v74, v42, v58
ds_write_b32 v4, v74 offset:2048
v_cvt_pk_bf16_f32 v75, v43, v59
ds_write_b32 v4, v75 offset:3072
v_cvt_pk_bf16_f32 v76, v44, v60
ds_write_b32 v4, v76 offset:8192
v_cvt_pk_bf16_f32 v77, v45, v61
ds_write_b32 v4, v77 offset:9216
v_cvt_pk_bf16_f32 v78, v46, v62
ds_write_b32 v4, v78 offset:10240
v_cvt_pk_bf16_f32 v79, v47, v63
ds_write_b32 v4, v79 offset:11264
v_cvt_pk_bf16_f32 v80, v48, v64
ds_write_b32 v6, v80 offset:0
v_cvt_pk_bf16_f32 v81, v49, v65
ds_write_b32 v5, v81 offset:10240
v_cvt_pk_bf16_f32 v82, v50, v66
ds_write_b32 v5, v82 offset:9216
v_cvt_pk_bf16_f32 v83, v51, v67
ds_write_b32 v5, v83 offset:8192
v_cvt_pk_bf16_f32 v84, v52, v68
ds_write_b32 v5, v84 offset:3072
v_cvt_pk_bf16_f32 v85, v53, v69
ds_write_b32 v5, v85 offset:2048
v_cvt_pk_bf16_f32 v86, v54, v70
ds_write_b32 v5, v86 offset:1024
v_cvt_pk_bf16_f32 v87, v55, v71
ds_write_b32 v5, v87 offset:0
s_waitcnt vmcnt(0)
s_waitcnt lgkmcnt(0)
v_mov_b32 v190, 1
s_mov_b64 exec, 1
ds_write_b32 v185, v190
s_mov_b64 exec, -1
L_lc6:
ds_read_b128 v[186:189], v184
s_waitcnt lgkmcnt(0)
v_min3_u32 v186, v186, v187, v188
v_min_u32 v186, v186, v189
s_nop 0
v_readfirstlane_b32 s92, v186
s_nop 0
s_cmp_ge_u32 s92, 1
s_cbranch_scc1 L_lcd7
s_sleep 1
s_branch L_lc6
L_lcd7:
ds_read_b128 v[72:75], v8 offset:0
ds_read_b128 v[76:79], v8 offset:1024
ds_read_b128 v[80:83], v8 offset:2048
ds_read_b128 v[84:87], v8 offset:3072
ds_read_b64 v[104:105], v21 offset:0
ds_read_b64 v[106:107], v21 offset:256
ds_read_b64 v[108:109], v21 offset:512
ds_read_b64 v[110:111], v21 offset:768
ds_read_b64 v[112:113], v21 offset:1024
ds_read_b64 v[114:115], v21 offset:1280
ds_read_b64 v[116:117], v21 offset:1536
ds_read_b64 v[118:119], v21 offset:1792
v_add_u32 v4, 32768, v4
v_add_u32 v5, 32768, v5
v_add_u32 v6, 32768, v6
s_waitcnt lgkmcnt(0)
v_mov_b32 v190, 2
s_mov_b64 exec, 1
ds_write_b32 v185, v190
s_mov_b64 exec, -1
s_lshl_b32 s92, s2, 3
s_add_u32 s92, s92, s34
s_cmp_lg_u32 s92, 4
s_cbranch_scc1 L_nn8
s_add_u32 s3, s3, 1
s_cmp_eq_u32 s3, 0
s_cselect_b32 s3, 1, s3
s_atomic_swap s3, s[30:31], 0x0
s_atomic_swap s3, s[32:33], 0x0
L_nn8:
s_mov_b32 s64, 0x05040100
s_mov_b32 s65, 0x07060302
v_lshlrev_b32 v88, 16, v88
v_lshlrev_b32 v89, 16, v89
v_lshlrev_b32 v23, 1, v1
v_add_f32_dpp v90, v88, v88 quad_perm:[1,0,3,2] row_mask:0xf bank_mask:0xf
v_subrev_f32_dpp v91, v89, v89 quad_perm:[1,0,3,2] row_mask:0xf bank_mask:0xf
v_mul_f32 v90, 0.5, v90
v_mul_f32 v91, 0.5, v91
v_cvt_pk_bf16_f32 v88, v90, v91
v_perm_b32 v120, v112, v104, s64
v_perm_b32 v121, v116, v108, s64
v_perm_b32 v122, v114, v106, s64
v_perm_b32 v123, v118, v110, s64
v_perm_b32 v124, v112, v104, s65
v_perm_b32 v125, v116, v108, s65
v_perm_b32 v126, v114, v106, s65
v_perm_b32 v127, v118, v110, s65
v_perm_b32 v128, v113, v105, s64
v_perm_b32 v129, v117, v109, s64
v_perm_b32 v130, v115, v107, s64
v_perm_b32 v131, v119, v111, s64
v_perm_b32 v132, v113, v105, s65
v_perm_b32 v133, v117, v109, s65
v_perm_b32 v134, v115, v107, s65
v_perm_b32 v135, v119, v111, s65
v_and_b32 v92, 31, v1
v_cvt_f32_u32 v92, v92
v_lshrrev_b32 v93, 5, v1
v_lshlrev_b32 v93, 2, v93
v_cvt_f32_u32 v93, v93
v_mul_f32 v92, 0x3a000000, v92
v_fmamk_f32 v93, v93, 0x3c800000, v92
v_add_f32 v94, 0x0, v93
v_cos_f32 v136, v94
v_sin_f32 v152, -v94
v_add_f32 v95, 0x3c800000, v93
v_cos_f32 v137, v95
v_sin_f32 v153, -v95
v_add_f32 v94, 0x3d000000, v93
v_cos_f32 v138, v94
v_sin_f32 v154, -v94
v_add_f32 v95, 0x3d400000, v93
v_cos_f32 v139, v95
v_sin_f32 v155, -v95
v_add_f32 v94, 0x3e000000, v93
v_cos_f32 v140, v94
v_sin_f32 v156, -v94
v_add_f32 v95, 0x3e100000, v93
v_cos_f32 v141, v95
v_sin_f32 v157, -v95
v_add_f32 v94, 0x3e200000, v93
v_cos_f32 v142, v94
v_sin_f32 v158, -v94
v_add_f32 v95, 0x3e300000, v93
v_cos_f32 v143, v95
v_sin_f32 v159, -v95
v_add_f32 v94, 0x3e800000, v93
v_cos_f32 v144, v94
v_sin_f32 v160, -v94
v_add_f32 v95, 0x3e880000, v93
v_cos_f32 v145, v95
v_sin_f32 v161, -v95
v_add_f32 v94, 0x3e900000, v93
v_cos_f32 v146, v94
v_sin_f32 v162, -v94
v_add_f32 v95, 0x3e980000, v93
v_cos_f32 v147, v95
v_sin_f32 v163, -v95
v_add_f32 v94, 0x3ec00000, v93
v_cos_f32 v148, v94
v_sin_f32 v164, -v94
v_add_f32 v95, 0x3ec80000, v93
v_cos_f32 v149, v95
v_sin_f32 v165, -v95
v_add_f32 v94, 0x3ed00000, v93
v_cos_f32 v150, v94
v_sin_f32 v166, -v94
v_add_f32 v95, 0x3ed80000, v93
v_cos_f32 v151, v95
v_sin_f32 v167, -v95
s_and_b32 s60, s2, 7
s_lshl_b32 s60, s60, 5
s_lshr_b32 s64, s2, 3
s_add_u32 s60, s60, s64
s_lshr_b32 s64, s66, 1
s_xor_b32 s64, s64, s66
s_and_b32 s64, s64, 1
s_or_b32 s65, s64, s60
s_cmp_eq_u32 s65, 0
s_cselect_b32 s61, 1, 0
s_lshl_b32 s65, s60, 1
s_add_u32 s64, s64, s65
s_mul_i32 s64, s64, 8192
s_add_u32 s64, s64, 25182208
s_lshr_b32 s65, s66, 1
s_mul_i32 s69, s65, 8192
s_add_u32 s69, s69, 25165824
s_cmp_eq_u32 s61, 1
s_cselect_b32 s64, s69, s64
s_cselect_b32 s65, 0, s65
s_cselect_b32 s90, s32, s32
s_cselect_b32 s91, s33, s33
s_lshl_b32 s62, s65, 31
s_or_b32 s63, s62, 0x3f800000
s_add_u32 s48, s90, s64
s_addc_u32 s49, s91, 0
s_mov_b32 s50, 8192
s_mov_b32 s51, 0x20000
s_lshl_b32 s64, s66, 20
s_lshl_b32 s65, s60, 6
s_add_u32 s64, s64, s65
s_add_u32 s54, s64, 16777216
s_add_u32 s52, s32, s54
s_addc_u32 s53, s33, 0
s_sub_u32 s54, 1048576, s65
s_mov_b32 s55, 0x20000
v_lshrrev_b32 v8, 2, v1
v_lshlrev_b32 v8, 14, v8
v_and_b32 v9, 3, v1
v_lshrrev_b32 v10, 4, v1
v_xor_b32 v9, v9, v10
v_lshl_add_u32 v14, v9, 4, v8
v_and_b32 v8, 31, v1
v_bfe_u32 v9, v1, 2, 2
v_xor_b32 v9, s66, v9
v_lshlrev_b32 v9, 4, v9
v_lshl_add_u32 v9, v8, 6, v9
v_lshrrev_b32 v8, 5, v1
v_lshl_add_u32 v9, v8, 11, v9
v_add_u32 v15, 131072, v9
s_lshl_b32 s64, s66, 13
s_add_u32 s64, s64, 131072
v_add_u32 v16, s64, v2
s_xor_b32 s65, s64, 24576
s_cmp_eq_u32 s61, 1
s_cselect_b32 s65, s64, s65
v_add_u32 v17, s65, v2
v_add_u32 v18, s68, v2
s_lshr_b32 s64, s66, 1
s_xor_b32 s64, s64, s66
s_and_b32 s64, s64, 1
s_lshl_b32 s69, s64, 13
s_add_u32 s69, s69, 147456
v_add_u32 v19, s69, v2
v_mul_f32 v136, s63, v136
v_mul_f32 v137, s63, v137
v_mul_f32 v138, s63, v138
v_mul_f32 v139, s63, v139
v_mul_f32 v140, s63, v140
v_mul_f32 v141, s63, v141
v_mul_f32 v142, s63, v142
v_mul_f32 v143, s63, v143
v_mul_f32 v144, s63, v144
v_mul_f32 v145, s63, v145
v_mul_f32 v146, s63, v146
v_mul_f32 v147, s63, v147
v_mul_f32 v148, s63, v148
v_mul_f32 v149, s63, v149
v_mul_f32 v150, s63, v150
v_mul_f32 v151, s63, v151
v_mul_f32 v152, s63, v152
v_mul_f32 v153, s63, v153
v_mul_f32 v154, s63, v154
v_mul_f32 v155, s63, v155
v_mul_f32 v156, s63, v156
v_mul_f32 v157, s63, v157
v_mul_f32 v158, s63, v158
v_mul_f32 v159, s63, v159
v_mul_f32 v160, s63, v160
v_mul_f32 v161, s63, v161
v_mul_f32 v162, s63, v162
v_mul_f32 v163, s63, v163
v_mul_f32 v164, s63, v164
v_mul_f32 v165, s63, v165
v_mul_f32 v166, s63, v166
v_mul_f32 v167, s63, v167
buffer_store_dwordx4 v[72:75], v2, s[40:43], 0 offen offset:0 sc1
buffer_store_dwordx4 v[76:79], v2, s[40:43], 0 offen offset:1024 sc1
buffer_store_dwordx4 v[80:83], v2, s[40:43], 0 offen offset:2048 sc1
buffer_store_dwordx4 v[84:87], v2, s[40:43], 0 offen offset:3072 sc1
s_setprio 3
s_barrier
s_add_u32 s8, s16, 256
s_and_b32 s8, s8, 0x7ff
s_add_u32 s9, s8, 2048
s_add_u32 s10, s8, 6144
s_add_u32 m0, s17, 65536
s_nop 0
buffer_load_dwordx4 v176, s[12:15], s8 offen offset:0 lds
buffer_load_dwordx4 v177, s[12:15], s8 offen offset:1024 lds
buffer_load_dwordx4 v176, s[12:15], s9 offen offset:2048 lds
buffer_load_dwordx4 v177, s[12:15], s9 offen offset:3072 lds
s_add_u32 m0, s17, 81920
s_nop 0
buffer_load_dwordx4 v178, s[20:23], s8 offen offset:0 lds
buffer_load_dwordx4 v179, s[20:23], s8 offen offset:1024 lds
buffer_load_dwordx4 v178, s[20:23], s10 offen offset:2048 lds
buffer_load_dwordx4 v179, s[20:23], s10 offen offset:3072 lds
s_barrier
s_add_u32 s8, s16, 384
s_and_b32 s8, s8, 0x7ff
s_add_u32 s9, s8, 2048
s_add_u32 s10, s8, 6144
s_add_u32 m0, s17, 0
s_nop 0
buffer_load_dwordx4 v176, s[12:15], s8 offen offset:0 lds
buffer_load_dwordx4 v177, s[12:15], s8 offen offset:1024 lds
buffer_load_dwordx4 v176, s[12:15], s9 offen offset:2048 lds
buffer_load_dwordx4 v177, s[12:15], s9 offen offset:3072 lds
s_add_u32 m0, s17, 16384
s_nop 0
buffer_load_dwordx4 v178, s[20:23], s8 offen offset:0 lds
buffer_load_dwordx4 v179, s[20:23], s8 offen offset:1024 lds
buffer_load_dwordx4 v178, s[20:23], s10 offen offset:2048 lds
buffer_load_dwordx4 v179, s[20:23], s10 offen offset:3072 lds
s_waitcnt vmcnt(8)
s_barrier
s_add_u32 s8, s16, 512
s_and_b32 s8, s8, 0x7ff
s_add_u32 s9, s8, 2048
s_add_u32 s10, s8, 6144
s_add_u32 m0, s17, 32768
s_nop 0
buffer_load_dwordx4 v176, s[12:15], s8 offen offset:0 lds
buffer_load_dwordx4 v177, s[12:15], s8 offen offset:1024 lds
buffer_load_dwordx4 v176, s[12:15], s9 offen offset:2048 lds
buffer_load_dwordx4 v177, s[12:15], s9 offen offset:3072 lds
s_add_u32 m0, s17, 49152
s_nop 0
buffer_load_dwordx4 v178, s[20:23], s8 offen offset:0 lds
buffer_load_dwordx4 v179, s[20:23], s8 offen offset:1024 lds
buffer_load_dwordx4 v178, s[20:23], s10 offen offset:2048 lds
buffer_load_dwordx4 v179, s[20:23], s10 offen offset:3072 lds
s_cmp_lg_u32 s66, 0
s_cbranch_scc1 L_nl9
v_mov_b32 v20, 0
global_load_dword v21, v20, s[30:31] sc1
L_nl9:
s_waitcnt vmcnt(8)
s_barrier
s_add_u32 s8, s16, 640
s_and_b32 s8, s8, 0x7ff
s_add_u32 s9, s8, 2048
s_add_u32 s10, s8, 6144
s_add_u32 m0, s17, 65536
s_nop 0
buffer_load_dwordx4 v176, s[12:15], s8 offen offset:0 lds
buffer_load_dwordx4 v177, s[12:15], s8 offen offset:1024 lds
buffer_load_dwordx4 v176, s[12:15], s9 offen offset:2048 lds
buffer_load_dwordx4 v177, s[12:15], s9 offen offset:3072 lds
s_add_u32 m0, s17, 81920
s_nop 0
buffer_load_dwordx4 v178, s[20:23], s8 offen offset:0 lds
buffer_load_dwordx4 v179, s[20:23], s8 offen offset:1024 lds
buffer_load_dwordx4 v178, s[20:23], s10 offen offset:2048 lds
buffer_load_dwordx4 v179, s[20:23], s10 offen offset:3072 lds
s_cmp_lg_u32 s66, 3
s_cbranch_scc1 L_nw10
s_lshr_b32 s64, s2, 7
s_mul_i32 s64, s64, 8192
s_bfe_u32 s65, s2, 0x10006
s_mul_i32 s65, s65, 4096
s_add_u32 s64, s64, s65
s_and_b32 s65, s2, 63
s_lshl_b32 s65, s65, 6
s_add_u32 s64, s64, s65
s_add_u32 s6, s64, 25165824
s_add_u32 s4, s32, s6
s_addc_u32 s5, s33, 0
s_mov_b32 s6, 64
s_mov_b32 s7, 0x20000
s_mov_b32 exec_lo, 0x55555555
s_mov_b32 exec_hi, 0
buffer_store_dword v88, v23, s[4:7], 0 offen sc1
s_mov_b64 exec, -1
L_nw10:
s_mov_b32 s92, 0
buffer_store_dwordx4 v[120:123], v22, s[56:59], s92 offen sc1
s_mov_b32 s92, 8192
buffer_store_dwordx4 v[124:127], v22, s[56:59], s92 offen sc1
s_mov_b32 s92, 16384
buffer_store_dwordx4 v[128:131], v22, s[56:59], s92 offen sc1
s_mov_b32 s92, 24576
buffer_store_dwordx4 v[132:135], v22, s[56:59], s92 offen sc1
s_waitcnt vmcnt(12)
s_barrier
s_add_u32 s8, s16, 768
s_and_b32 s8, s8, 0x7ff
s_add_u32 s9, s8, 2048
s_add_u32 s10, s8, 6144
s_add_u32 m0, s17, 0
s_nop 0
buffer_load_dwordx4 v176, s[12:15], s8 offen offset:0 lds
buffer_load_dwordx4 v177, s[12:15], s8 offen offset:1024 lds
buffer_load_dwordx4 v176, s[12:15], s9 offen offset:2048 lds
buffer_load_dwordx4 v177, s[12:15], s9 offen offset:3072 lds
s_add_u32 m0, s17, 16384
s_nop 0
buffer_load_dwordx4 v178, s[20:23], s8 offen offset:0 lds
buffer_load_dwordx4 v179, s[20:23], s8 offen offset:1024 lds
buffer_load_dwordx4 v178, s[20:23], s10 offen offset:2048 lds
buffer_load_dwordx4 v179, s[20:23], s10 offen offset:3072 lds
s_waitcnt vmcnt(12)
s_barrier
s_add_u32 s8, s16, 896
s_and_b32 s8, s8, 0x7ff
s_add_u32 s9, s8, 2048
s_add_u32 s10, s8, 6144
s_add_u32 m0, s17, 32768
s_nop 0
buffer_load_dwordx4 v176, s[12:15], s8 offen offset:0 lds
buffer_load_dwordx4 v177, s[12:15], s8 offen offset:1024 lds
buffer_load_dwordx4 v176, s[12:15], s9 offen offset:2048 lds
buffer_load_dwordx4 v177, s[12:15], s9 offen offset:3072 lds
s_add_u32 m0, s17, 49152
s_nop 0
buffer_load_dwordx4 v178, s[20:23], s8 offen offset:0 lds
buffer_load_dwordx4 v179, s[20:23], s8 offen offset:1024 lds
buffer_load_dwordx4 v178, s[20:23], s10 offen offset:2048 lds
buffer_load_dwordx4 v179, s[20:23], s10 offen offset:3072 lds
s_waitcnt vmcnt(8)
s_barrier
s_add_u32 s8, s16, 1024
s_and_b32 s8, s8, 0x7ff
s_add_u32 s9, s8, 2048
s_add_u32 s10, s8, 6144
s_add_u32 m0, s17, 65536
s_nop 0
buffer_load_dwordx4 v176, s[12:15], s8 offen offset:0 lds
buffer_load_dwordx4 v177, s[12:15], s8 offen offset:1024 lds
buffer_load_dwordx4 v176, s[12:15], s9 offen offset:2048 lds
buffer_load_dwordx4 v177, s[12:15], s9 offen offset:3072 lds
s_add_u32 m0, s17, 81920
s_nop 0
buffer_load_dwordx4 v178, s[20:23], s8 offen offset:0 lds
buffer_load_dwordx4 v179, s[20:23], s8 offen offset:1024 lds
buffer_load_dwordx4 v178, s[20:23], s10 offen offset:2048 lds
buffer_load_dwordx4 v179, s[20:23], s10 offen offset:3072 lds
s_cmp_lg_u32 s66, 0
s_cbranch_scc1 L_sg12
v_readfirstlane_b32 s37, v21
s_nop 0
s_cmp_lg_u32 s37, 0
s_cbranch_scc1 L_nl13
v_mov_b32 v20, 0
L_n14:
global_load_dword v21, v20, s[30:31] sc1
s_waitcnt vmcnt(0)
v_readfirstlane_b32 s37, v21
s_nop 0
s_cmp_eq_u32 s37, 0
s_cbranch_scc1 L_n14
L_nl13:
v_mov_b32 v20, s37
s_mov_b64 exec, 1
ds_write_b32 v184, v20 offset:64
s_mov_b64 exec, -1
s_waitcnt lgkmcnt(0)
L_sg12:
s_cmp_lg_u32 s66, 0
s_cbranch_scc1 L_sg16
s_and_b32 s64, s2, 15
s_lshl_b32 s65, s64, 7
s_add_u32 s65, s65, 4096
s_add_u32 s90, s32, s65
s_addc_u32 s91, s33, 0
s_mov_b32 s18, 1
s_atomic_add s18, s[90:91], 0x0 glc
L_sg16:
s_waitcnt vmcnt(8)
s_barrier
s_add_u32 s8, s16, 1152
s_and_b32 s8, s8, 0x7ff
s_add_u32 s9, s8, 2048
s_add_u32 s10, s8, 6144
s_add_u32 m0, s17, 0
s_nop 0
buffer_load_dwordx4 v176, s[12:15], s8 offen offset:0 lds
buffer_load_dwordx4 v177, s[12:15], s8 offen offset:1024 lds
buffer_load_dwordx4 v176, s[12:15], s9 offen offset:2048 lds
buffer_load_dwordx4 v177, s[12:15], s9 offen offset:3072 lds
s_add_u32 m0, s17, 16384
s_nop 0
buffer_load_dwordx4 v178, s[20:23], s8 offen offset:0 lds
buffer_load_dwordx4 v179, s[20:23], s8 offen offset:1024 lds
buffer_load_dwordx4 v178, s[20:23], s10 offen offset:2048 lds
buffer_load_dwordx4 v179, s[20:23], s10 offen offset:3072 lds
s_waitcnt vmcnt(8)
s_barrier
s_add_u32 s8, s16, 1280
s_and_b32 s8, s8, 0x7ff
s_add_u32 s9, s8, 2048
s_add_u32 s10, s8, 6144
s_add_u32 m0, s17, 32768
s_nop 0
buffer_load_dwordx4 v176, s[12:15], s8 offen offset:0 lds
buffer_load_dwordx4 v177, s[12:15], s8 offen offset:1024 lds
buffer_load_dwordx4 v176, s[12:15], s9 offen offset:2048 lds
buffer_load_dwordx4 v177, s[12:15], s9 offen offset:3072 lds
s_add_u32 m0, s17, 49152
s_nop 0
buffer_load_dwordx4 v178, s[20:23], s8 offen offset:0 lds
buffer_load_dwordx4 v179, s[20:23], s8 offen offset:1024 lds
buffer_load_dwordx4 v178, s[20:23], s10 offen offset:2048 lds
buffer_load_dwordx4 v179, s[20:23], s10 offen offset:3072 lds
s_cmp_lg_u32 s66, 0
s_cbranch_scc1 L_sg17
s_waitcnt lgkmcnt(0)
s_cmp_lg_u32 s18, 15
s_cbranch_scc1 L_sg17
s_and_b32 s64, s2, 15
s_lshl_b32 s64, s64, 2
s_add_u32 s64, s64, 540672
v_lshl_add_u32 v22, v1, 7, s64
v_mov_b32 v23, s37
global_store_dword v22, v23, s[32:33] sc1
L_sg17:
s_waitcnt vmcnt(8)
s_barrier
s_add_u32 s8, s16, 1408
s_and_b32 s8, s8, 0x7ff
s_add_u32 s9, s8, 2048
s_add_u32 s10, s8, 6144
s_add_u32 m0, s17, 65536
s_nop 0
buffer_load_dwordx4 v176, s[12:15], s8 offen offset:0 lds
buffer_load_dwordx4 v177, s[12:15], s8 offen offset:1024 lds
buffer_load_dwordx4 v176, s[12:15], s9 offen offset:2048 lds
buffer_load_dwordx4 v177, s[12:15], s9 offen offset:3072 lds
s_add_u32 m0, s17, 81920
s_nop 0
buffer_load_dwordx4 v178, s[20:23], s8 offen offset:0 lds
buffer_load_dwordx4 v179, s[20:23], s8 offen offset:1024 lds
buffer_load_dwordx4 v178, s[20:23], s10 offen offset:2048 lds
buffer_load_dwordx4 v179, s[20:23], s10 offen offset:3072 lds
s_waitcnt vmcnt(8)
s_barrier
s_add_u32 s8, s16, 1536
s_and_b32 s8, s8, 0x7ff
s_add_u32 s9, s8, 2048
s_add_u32 s10, s8, 6144
s_add_u32 m0, s17, 0
s_nop 0
buffer_load_dwordx4 v176, s[12:15], s8 offen offset:0 lds
buffer_load_dwordx4 v177, s[12:15], s8 offen offset:1024 lds
buffer_load_dwordx4 v176, s[12:15], s9 offen offset:2048 lds
buffer_load_dwordx4 v177, s[12:15], s9 offen offset:3072 lds
s_add_u32 m0, s17, 16384
s_nop 0
buffer_load_dwordx4 v178, s[20:23], s8 offen offset:0 lds
buffer_load_dwordx4 v179, s[20:23], s8 offen offset:1024 lds
buffer_load_dwordx4 v178, s[20:23], s10 offen offset:2048 lds
buffer_load_dwordx4 v179, s[20:23], s10 offen offset:3072 lds
s_waitcnt vmcnt(8)
s_barrier
s_add_u32 s8, s16, 1664
s_and_b32 s8, s8, 0x7ff
s_add_u32 s9, s8, 2048
s_add_u32 s10, s8, 6144
s_add_u32 m0, s17, 32768
s_nop 0
buffer_load_dwordx4 v176, s[12:15], s8 offen offset:0 lds
buffer_load_dwordx4 v177, s[12:15], s8 offen offset:1024 lds
buffer_load_dwordx4 v176, s[12:15], s9 offen offset:2048 lds
buffer_load_dwordx4 v177, s[12:15], s9 offen offset:3072 lds
s_add_u32 m0, s17, 49152
s_nop 0
buffer_load_dwordx4 v178, s[20:23], s8 offen offset:0 lds
buffer_load_dwordx4 v179, s[20:23], s8 offen offset:1024 lds
buffer_load_dwordx4 v178, s[20:23], s10 offen offset:2048 lds
buffer_load_dwordx4 v179, s[20:23], s10 offen offset:3072 lds
s_waitcnt vmcnt(8)
s_barrier
s_add_u32 s8, s16, 1792
s_and_b32 s8, s8, 0x7ff
s_add_u32 s9, s8, 2048
s_add_u32 s10, s8, 6144
s_add_u32 m0, s17, 65536
s_nop 0
buffer_load_dwordx4 v176, s[12:15], s8 offen offset:0 lds
buffer_load_dwordx4 v177, s[12:15], s8 offen offset:1024 lds
buffer_load_dwordx4 v176, s[12:15], s9 offen offset:2048 lds
buffer_load_dwordx4 v177, s[12:15], s9 offen offset:3072 lds
s_add_u32 m0, s17, 81920
s_nop 0
buffer_load_dwordx4 v178, s[20:23], s8 offen offset:0 lds
buffer_load_dwordx4 v179, s[20:23], s8 offen offset:1024 lds
buffer_load_dwordx4 v178, s[20:23], s10 offen offset:2048 lds
buffer_load_dwordx4 v179, s[20:23], s10 offen offset:3072 lds
s_waitcnt vmcnt(8)
s_barrier
s_add_u32 s8, s16, 1920
s_and_b32 s8, s8, 0x7ff
s_add_u32 s9, s8, 2048
s_add_u32 s10, s8, 6144
s_add_u32 m0, s17, 0
s_nop 0
buffer_load_dwordx4 v176, s[12:15], s8 offen offset:0 lds
buffer_load_dwordx4 v177, s[12:15], s8 offen offset:1024 lds
buffer_load_dwordx4 v176, s[12:15], s9 offen offset:2048 lds
buffer_load_dwordx4 v177, s[12:15], s9 offen offset:3072 lds
s_add_u32 m0, s17, 16384
s_nop 0
buffer_load_dwordx4 v178, s[20:23], s8 offen offset:0 lds
buffer_load_dwordx4 v179, s[20:23], s8 offen offset:1024 lds
buffer_load_dwordx4 v178, s[20:23], s10 offen offset:2048 lds
buffer_load_dwordx4 v179, s[20:23], s10 offen offset:3072 lds
s_cmp_eq_u32 s66, 0
s_cbranch_scc1 L_nl18
ds_read_b32 v20, v184 offset:64
s_waitcnt lgkmcnt(0)
v_readfirstlane_b32 s37, v20
L_nl18:
s_waitcnt vmcnt(8)
s_barrier
s_and_b32 s64, s2, 1
s_lshl_b32 s64, s64, 10
s_bfe_u32 s92, s2, 0x20001
s_lshl_b32 s92, s92, 19
s_add_u32 s64, s64, s92
s_lshr_b32 s92, s2, 3
s_lshl_b32 s92, s92, 14
s_add_u32 s64, s64, s92
s_lshr_b32 s92, s66, 1
s_lshl_b32 s92, s92, 13
s_add_u32 s64, s64, s92
v_bfe_u32 v22, v1, 3, 2
v_lshlrev_b32 v22, 11, v22
v_and_b32 v23, 7, v1
v_lshl_add_u32 v22, v23, 7, v22
v_add_u32 v22, s64, v22
s_mov_b32 exec_hi, 0
global_load_dword v11, v22, s[100:101]
s_mov_b64 exec, -1
s_lshl_b32 s64, s2, 2
s_add_u32 s64, s64, s66
s_lshr_b32 s64, s64, 4
s_lshl_b32 s64, s64, 7
s_add_u32 s64, s64, 540672
s_add_u32 s24, s32, s64
s_addc_u32 s25, s33, 0
s_load_dwordx16 s[4:19], s[24:25], 0x0 glc
s_waitcnt vmcnt(1)
s_barrier
s_setprio 0
s_mov_b32 s26, s37
s_mov_b32 s27, s37
s_mov_b32 s92, 0
s_branch L_sp21
L_late19:
s_add_u32 s92, s92, 1
s_cmp_ge_u32 s92, 200000
s_cbranch_scc1 L_go20
s_sleep 8
s_load_dwordx16 s[4:19], s[24:25], 0x0 glc
L_sp21:
s_waitcnt lgkmcnt(0)
s_cmp_eq_u64 s[4:5], s[26:27]
s_cbranch_scc0 L_late19
s_cmp_eq_u64 s[6:7], s[26:27]
s_cbranch_scc0 L_late19
s_cmp_eq_u64 s[8:9], s[26:27]
s_cbranch_scc0 L_late19
s_cmp_eq_u64 s[10:11], s[26:27]
s_cbranch_scc0 L_late19
s_cmp_eq_u64 s[12:13], s[26:27]
s_cbranch_scc0 L_late19
s_cmp_eq_u64 s[14:15], s[26:27]
s_cbranch_scc0 L_late19
s_cmp_eq_u64 s[16:17], s[26:27]
s_cbranch_scc0 L_late19
s_cmp_eq_u64 s[18:19], s[26:27]
s_cbranch_scc0 L_late19
L_go20:
s_setprio 0
s_add_u32 m0, s68, 0
s_mov_b32 s64, 0
buffer_load_dwordx4 v14, s[52:55], s64 offen sc1 lds
s_add_u32 m0, s68, 1024
s_mov_b32 s64, 262144
buffer_load_dwordx4 v14, s[52:55], s64 offen sc1 lds
s_add_u32 m0, s68, 2048
s_mov_b32 s64, 524288
buffer_load_dwordx4 v14, s[52:55], s64 offen sc1 lds
s_add_u32 m0, s68, 3072
s_mov_b32 s64, 786432
buffer_load_dwordx4 v14, s[52:55], s64 offen sc1 lds
s_cmp_eq_u32 s61, 1
s_cbranch_scc1 L_ws22
s_lshr_b32 s64, s66, 1
s_lshl_b32 s65, s64, 12
s_mul_i32 s64, s64, 4096
s_add_u32 m0, s69, s65
s_nop 0
buffer_load_dwordx4 v2, s[48:51], s64 offen offset:0 sc1 lds
buffer_load_dwordx4 v2, s[48:51], s64 offen offset:1024 sc1 lds
buffer_load_dwordx4 v2, s[48:51], s64 offen offset:2048 sc1 lds
buffer_load_dwordx4 v2, s[48:51], s64 offen offset:3072 sc1 lds
s_waitcnt vmcnt(0)
s_branch L_wd23
L_ws22:
s_movk_i32 s64, 4096
buffer_load_dwordx4 v[104:107], v2, s[48:51], 0 offen offset:0 sc1
buffer_load_dwordx4 v[108:111], v2, s[48:51], 0 offen offset:1024 sc1
buffer_load_dwordx4 v[112:115], v2, s[48:51], 0 offen offset:2048 sc1
buffer_load_dwordx4 v[116:119], v2, s[48:51], 0 offen offset:3072 sc1
buffer_load_dwordx4 v[120:123], v2, s[48:51], s64 offen offset:0 sc1
buffer_load_dwordx4 v[124:127], v2, s[48:51], s64 offen offset:1024 sc1
buffer_load_dwordx4 v[128:131], v2, s[48:51], s64 offen offset:2048 sc1
buffer_load_dwordx4 v[132:135], v2, s[48:51], s64 offen offset:3072 sc1
L_wd23:
s_waitcnt vmcnt(8)
v_mov_b32 v190, 3
s_mov_b64 exec, 1
ds_write_b32 v185, v190
s_mov_b64 exec, -1
L_lc24:
ds_read_b128 v[186:189], v184
s_waitcnt lgkmcnt(0)
v_min3_u32 v186, v186, v187, v188
v_min_u32 v186, v186, v189
s_nop 0
v_readfirstlane_b32 s92, v186
s_nop 0
s_cmp_ge_u32 s92, 3
s_cbranch_scc1 L_lcd25
s_sleep 1
s_branch L_lc24
L_lcd25:
ds_read_b128 v[72:75], v15 offset:0
ds_read_b128 v[76:79], v15 offset:4096
ds_read_b128 v[80:83], v15 offset:8192
ds_read_b128 v[84:87], v15 offset:12288
s_cmp_eq_u32 s61, 1
s_cbranch_scc1 L_wr26
ds_read_b128 v[104:107], v19 offset:0
ds_read_b128 v[108:111], v19 offset:1024
ds_read_b128 v[112:115], v19 offset:2048
ds_read_b128 v[116:119], v19 offset:3072
ds_read_b128 v[120:123], v19 offset:4096
ds_read_b128 v[124:127], v19 offset:5120
ds_read_b128 v[128:131], v19 offset:6144
ds_read_b128 v[132:135], v19 offset:7168
L_wr26:
s_waitcnt lgkmcnt(0)
v_mov_b32 v190, 4
s_mov_b64 exec, 1
ds_write_b32 v185, v190
s_mov_b64 exec, -1
s_lshl_b32 s64, s61, 31
s_or_b32 s64, s64, s62
L_fft27:
v_xor_b32 v24, s64, v72
v_xor_b32 v25, s64, v73
v_xor_b32 v26, s64, v74
v_xor_b32 v27, s64, v75
v_xor_b32 v28, s64, v76
v_xor_b32 v29, s64, v77
v_xor_b32 v30, s64, v78
v_xor_b32 v31, s64, v79
v_xor_b32 v32, s64, v80
v_xor_b32 v33, s64, v81
v_xor_b32 v34, s64, v82
v_xor_b32 v35, s64, v83
v_xor_b32 v36, s64, v84
v_xor_b32 v37, s64, v85
v_xor_b32 v38, s64, v86
v_xor_b32 v39, s64, v87
v_mfma_f32_32x32x16_bf16 v[40:55], v[24:27], v[192:195], 0
v_mfma_f32_32x32x16_bf16 v[40:55], v[28:31], v[196:199], v[40:55]
v_mfma_f32_32x32x16_bf16 v[40:55], v[32:35], v[200:203], v[40:55]
v_mfma_f32_32x32x16_bf16 v[40:55], v[36:39], v[204:207], v[40:55]
v_mfma_f32_32x32x16_bf16 v[56:71], v[24:27], v[208:211], 0
v_mfma_f32_32x32x16_bf16 v[56:71], v[28:31], v[212:215], v[56:71]
v_mfma_f32_32x32x16_bf16 v[56:71], v[32:35], v[216:219], v[56:71]
v_mfma_f32_32x32x16_bf16 v[56:71], v[36:39], v[220:223], v[56:71]
s_cmp_eq_u32 s61, 2
s_cbranch_scc1 L_once29
s_waitcnt vmcnt(0)
v_lshlrev_b32 v176, 16, v104
v_and_b32 v177, 0xffff0000, v104
v_lshlrev_b32 v178, 16, v105
v_and_b32 v179, 0xffff0000, v105
v_add_f32 v180, v176, v178
v_add_f32 v181, v177, v179
v_sub_f32 v176, v176, v178
v_sub_f32 v177, v177, v179
v_mul_f32 v104, v136, v176
v_mul_f32 v105, v136, v177
v_fma_f32 v136, v152, v176, v180
v_fma_f32 v152, v152, v177, v181
v_lshlrev_b32 v176, 16, v106
v_and_b32 v177, 0xffff0000, v106
v_lshlrev_b32 v178, 16, v107
v_and_b32 v179, 0xffff0000, v107
v_add_f32 v180, v176, v178
v_add_f32 v181, v177, v179
v_sub_f32 v176, v176, v178
v_sub_f32 v177, v177, v179
v_mul_f32 v106, v137, v176
v_mul_f32 v107, v137, v177
v_fma_f32 v137, v153, v176, v180
v_fma_f32 v153, v153, v177, v181
v_lshlrev_b32 v176, 16, v108
v_and_b32 v177, 0xffff0000, v108
v_lshlrev_b32 v178, 16, v109
v_and_b32 v179, 0xffff0000, v109
v_add_f32 v180, v176, v178
v_add_f32 v181, v177, v179
v_sub_f32 v176, v176, v178
v_sub_f32 v177, v177, v179
v_mul_f32 v108, v138, v176
v_mul_f32 v109, v138, v177
v_fma_f32 v138, v154, v176, v180
v_fma_f32 v154, v154, v177, v181
v_lshlrev_b32 v176, 16, v110
v_and_b32 v177, 0xffff0000, v110
v_lshlrev_b32 v178, 16, v111
v_and_b32 v179, 0xffff0000, v111
v_add_f32 v180, v176, v178
v_add_f32 v181, v177, v179
v_sub_f32 v176, v176, v178
v_sub_f32 v177, v177, v179
v_mul_f32 v110, v139, v176
v_mul_f32 v111, v139, v177
v_fma_f32 v139, v155, v176, v180
v_fma_f32 v155, v155, v177, v181
v_lshlrev_b32 v176, 16, v112
v_and_b32 v177, 0xffff0000, v112
v_lshlrev_b32 v178, 16, v113
v_and_b32 v179, 0xffff0000, v113
v_add_f32 v180, v176, v178
v_add_f32 v181, v177, v179
v_sub_f32 v176, v176, v178
v_sub_f32 v177, v177, v179
v_mul_f32 v112, v140, v176
v_mul_f32 v113, v140, v177
v_fma_f32 v140, v156, v176, v180
v_fma_f32 v156, v156, v177, v181
v_lshlrev_b32 v176, 16, v114
v_and_b32 v177, 0xffff0000, v114
v_lshlrev_b32 v178, 16, v115
v_and_b32 v179, 0xffff0000, v115
v_add_f32 v180, v176, v178
v_add_f32 v181, v177, v179
v_sub_f32 v176, v176, v178
v_sub_f32 v177, v177, v179
v_mul_f32 v114, v141, v176
v_mul_f32 v115, v141, v177
v_fma_f32 v141, v157, v176, v180
v_fma_f32 v157, v157, v177, v181
L_once29:
s_nop 5
v_mul_f32 v168, v40, v224
v_mul_f32 v169, v40, v240
s_nop 1
v_fma_f32 v168, -v56, v240, v168
v_fmac_f32 v169, v56, v224
v_cvt_pk_bf16_f32 v24, v168, v169
v_mul_f32 v170, v41, v225
v_mul_f32 v171, v41, v241
v_fma_f32 v170, -v57, v241, v170
v_fmac_f32 v171, v57, v225
v_cvt_pk_bf16_f32 v25, v170, v171
v_mul_f32 v172, v42, v226
v_mul_f32 v173, v42, v242
v_fma_f32 v172, -v58, v242, v172
v_fmac_f32 v173, v58, v226
v_cvt_pk_bf16_f32 v26, v172, v173
v_mul_f32 v174, v43, v227
v_mul_f32 v175, v43, v243
v_fma_f32 v174, -v59, v243, v174
v_fmac_f32 v175, v59, v227
v_cvt_pk_bf16_f32 v27, v174, v175
v_mul_f32 v168, v44, v228
v_mul_f32 v169, v44, v244
v_fma_f32 v168, -v60, v244, v168
v_fmac_f32 v169, v60, v228
v_cvt_pk_bf16_f32 v28, v168, v169
v_mul_f32 v170, v45, v229
v_mul_f32 v171, v45, v245
v_fma_f32 v170, -v61, v245, v170
v_fmac_f32 v171, v61, v229
v_cvt_pk_bf16_f32 v29, v170, v171
v_mul_f32 v172, v46, v230
v_mul_f32 v173, v46, v246
v_fma_f32 v172, -v62, v246, v172
v_fmac_f32 v173, v62, v230
v_cvt_pk_bf16_f32 v30, v172, v173
v_mul_f32 v174, v47, v231
v_mul_f32 v175, v47, v247
v_fma_f32 v174, -v63, v247, v174
v_fmac_f32 v175, v63, v231
v_cvt_pk_bf16_f32 v31, v174, v175
v_mul_f32 v168, v48, v232
v_mul_f32 v169, v48, v248
v_fma_f32 v168, -v64, v248, v168
v_fmac_f32 v169, v64, v232
v_cvt_pk_bf16_f32 v32, v168, v169
v_mul_f32 v170, v49, v233
v_mul_f32 v171, v49, v249
v_fma_f32 v170, -v65, v249, v170
v_fmac_f32 v171, v65, v233
v_cvt_pk_bf16_f32 v33, v170, v171
v_mul_f32 v172, v50, v234
v_mul_f32 v173, v50, v250
v_fma_f32 v172, -v66, v250, v172
v_fmac_f32 v173, v66, v234
v_cvt_pk_bf16_f32 v34, v172, v173
v_mul_f32 v174, v51, v235
v_mul_f32 v175, v51, v251
v_fma_f32 v174, -v67, v251, v174
v_fmac_f32 v175, v67, v235
v_cvt_pk_bf16_f32 v35, v174, v175
v_mul_f32 v168, v52, v236
v_mul_f32 v169, v52, v252
v_fma_f32 v168, -v68, v252, v168
v_fmac_f32 v169, v68, v236
v_cvt_pk_bf16_f32 v36, v168, v169
v_mul_f32 v170, v53, v237
v_mul_f32 v171, v53, v253
v_fma_f32 v170, -v69, v253, v170
v_fmac_f32 v171, v69, v237
v_cvt_pk_bf16_f32 v37, v170, v171
v_mul_f32 v172, v54, v238
v_mul_f32 v173, v54, v254
v_fma_f32 v172, -v70, v254, v172
v_fmac_f32 v173, v70, v238
v_cvt_pk_bf16_f32 v38, v172, v173
v_mul_f32 v174, v55, v239
v_mul_f32 v175, v55, v255
v_fma_f32 v174, -v71, v255, v174
v_fmac_f32 v175, v71, v239
v_cvt_pk_bf16_f32 v39, v174, v175
v_mfma_f32_32x32x16_bf16 v[40:55], v[192:195], v[24:27], 0
v_mfma_f32_32x32x16_bf16 v[40:55], v[196:199], v[28:31], v[40:55]
v_mfma_f32_32x32x16_bf16 v[40:55], v[200:203], v[32:35], v[40:55]
v_mfma_f32_32x32x16_bf16 v[40:55], v[204:207], v[36:39], v[40:55]
v_mfma_f32_32x32x16_bf16 v[56:71], v[208:211], v[24:27], 0
v_mfma_f32_32x32x16_bf16 v[56:71], v[212:215], v[28:31], v[56:71]
v_mfma_f32_32x32x16_bf16 v[56:71], v[216:219], v[32:35], v[56:71]
v_mfma_f32_32x32x16_bf16 v[56:71], v[220:223], v[36:39], v[56:71]
s_cmp_eq_u32 s61, 2
s_cbranch_scc1 L_once30
s_waitcnt vmcnt(0)
v_lshlrev_b32 v176, 16, v116
v_and_b32 v177, 0xffff0000, v116
v_lshlrev_b32 v178, 16, v117
v_and_b32 v179, 0xffff0000, v117
v_add_f32 v180, v176, v178
v_add_f32 v181, v177, v179
v_sub_f32 v176, v176, v178
v_sub_f32 v177, v177, v179
v_mul_f32 v116, v142, v176
v_mul_f32 v117, v142, v177
v_fma_f32 v142, v158, v176, v180
v_fma_f32 v158, v158, v177, v181
v_lshlrev_b32 v176, 16, v118
v_and_b32 v177, 0xffff0000, v118
v_lshlrev_b32 v178, 16, v119
v_and_b32 v179, 0xffff0000, v119
v_add_f32 v180, v176, v178
v_add_f32 v181, v177, v179
v_sub_f32 v176, v176, v178
v_sub_f32 v177, v177, v179
v_mul_f32 v118, v143, v176
v_mul_f32 v119, v143, v177
v_fma_f32 v143, v159, v176, v180
v_fma_f32 v159, v159, v177, v181
v_lshlrev_b32 v176, 16, v120
v_and_b32 v177, 0xffff0000, v120
v_lshlrev_b32 v178, 16, v121
v_and_b32 v179, 0xffff0000, v121
v_add_f32 v180, v176, v178
v_add_f32 v181, v177, v179
v_sub_f32 v176, v176, v178
v_sub_f32 v177, v177, v179
v_mul_f32 v120, v144, v176
v_mul_f32 v121, v144, v177
v_fma_f32 v144, v160, v176, v180
v_fma_f32 v160, v160, v177, v181
v_lshlrev_b32 v176, 16, v122
v_and_b32 v177, 0xffff0000, v122
v_lshlrev_b32 v178, 16, v123
v_and_b32 v179, 0xffff0000, v123
v_add_f32 v180, v176, v178
v_add_f32 v181, v177, v179
v_sub_f32 v176, v176, v178
v_sub_f32 v177, v177, v179
v_mul_f32 v122, v145, v176
v_mul_f32 v123, v145, v177
v_fma_f32 v145, v161, v176, v180
v_fma_f32 v161, v161, v177, v181
v_lshlrev_b32 v176, 16, v124
v_and_b32 v177, 0xffff0000, v124
v_lshlrev_b32 v178, 16, v125
v_and_b32 v179, 0xffff0000, v125
v_add_f32 v180, v176, v178
v_add_f32 v181, v177, v179
v_sub_f32 v176, v176, v178
v_sub_f32 v177, v177, v179
v_mul_f32 v124, v146, v176
v_mul_f32 v125, v146, v177
v_fma_f32 v146, v162, v176, v180
v_fma_f32 v162, v162, v177, v181
v_lshlrev_b32 v176, 16, v126
v_and_b32 v177, 0xffff0000, v126
v_lshlrev_b32 v178, 16, v127
v_and_b32 v179, 0xffff0000, v127
v_add_f32 v180, v176, v178
v_add_f32 v181, v177, v179
v_sub_f32 v176, v176, v178
v_sub_f32 v177, v177, v179
v_mul_f32 v126, v147, v176
v_mul_f32 v127, v147, v177
v_fma_f32 v147, v163, v176, v180
v_fma_f32 v163, v163, v177, v181
L_once30:
L_lc31:
ds_read_b128 v[186:189], v184
s_waitcnt lgkmcnt(0)
v_min3_u32 v186, v186, v187, v188
v_min_u32 v186, v186, v189
s_nop 0
v_readfirstlane_b32 s92, v186
s_nop 0
s_cmp_ge_u32 s92, 4
s_cbranch_scc1 L_lcd32
s_sleep 1
s_branch L_lc31
L_lcd32:
s_cmp_eq_u32 s61, 2
s_cbranch_scc1 L_nwr28
ds_write_b128 v16, v[40:43] offset:0
ds_write_b128 v16, v[44:47] offset:1024
ds_write_b128 v16, v[48:51] offset:2048
ds_write_b128 v16, v[52:55] offset:3072
ds_write_b128 v16, v[56:59] offset:4096
ds_write_b128 v16, v[60:63] offset:5120
ds_write_b128 v16, v[64:67] offset:6144
ds_write_b128 v16, v[68:71] offset:7168
s_cmp_eq_u32 s61, 0
s_cbranch_scc1 L_nwr28
s_mov_b32 s61, 2
s_mov_b32 s64, 0
s_branch L_fft27
L_nwr28:
v_lshlrev_b32 v176, 16, v128
v_and_b32 v177, 0xffff0000, v128
v_lshlrev_b32 v178, 16, v129
v_and_b32 v179, 0xffff0000, v129
v_add_f32 v180, v176, v178
v_add_f32 v181, v177, v179
v_sub_f32 v176, v176, v178
v_sub_f32 v177, v177, v179
v_mul_f32 v128, v148, v176
v_mul_f32 v129, v148, v177
v_fma_f32 v148, v164, v176, v180
v_fma_f32 v164, v164, v177, v181
v_lshlrev_b32 v176, 16, v130
v_and_b32 v177, 0xffff0000, v130
v_lshlrev_b32 v178, 16, v131
v_and_b32 v179, 0xffff0000, v131
v_add_f32 v180, v176, v178
v_add_f32 v181, v177, v179
v_sub_f32 v176, v176, v178
v_sub_f32 v177, v177, v179
v_mul_f32 v130, v149, v176
v_mul_f32 v131, v149, v177
v_fma_f32 v149, v165, v176, v180
v_fma_f32 v165, v165, v177, v181
s_waitcnt lgkmcnt(0)
v_mov_b32 v190, 5
s_mov_b64 exec, 1
ds_write_b32 v185, v190
s_mov_b64 exec, -1
v_lshlrev_b32 v176, 16, v132
v_and_b32 v177, 0xffff0000, v132
v_lshlrev_b32 v178, 16, v133
v_and_b32 v179, 0xffff0000, v133
v_add_f32 v180, v176, v178
v_add_f32 v181, v177, v179
v_sub_f32 v176, v176, v178
v_sub_f32 v177, v177, v179
v_mul_f32 v132, v150, v176
v_mul_f32 v133, v150, v177
v_fma_f32 v150, v166, v176, v180
v_fma_f32 v166, v166, v177, v181
v_lshlrev_b32 v176, 16, v134
v_and_b32 v177, 0xffff0000, v134
v_lshlrev_b32 v178, 16, v135
v_and_b32 v179, 0xffff0000, v135
v_add_f32 v180, v176, v178
v_add_f32 v181, v177, v179
v_sub_f32 v176, v176, v178
v_sub_f32 v177, v177, v179
v_mul_f32 v134, v151, v176
v_mul_f32 v135, v151, v177
v_fma_f32 v151, v167, v176, v180
v_fma_f32 v167, v167, v177, v181
v_mul_f32 v168, v152, v56
v_mul_f32 v56, v136, v56
v_fmac_f32 v56, v152, v40
v_fma_f32 v40, v136, v40, -v168
v_mul_f32 v169, v153, v57
v_mul_f32 v57, v137, v57
v_fmac_f32 v57, v153, v41
v_fma_f32 v41, v137, v41, -v169
v_mul_f32 v168, v154, v58
v_mul_f32 v58, v138, v58
v_fmac_f32 v58, v154, v42
v_fma_f32 v42, v138, v42, -v168
v_mul_f32 v169, v155, v59
v_mul_f32 v59, v139, v59
v_fmac_f32 v59, v155, v43
v_fma_f32 v43, v139, v43, -v169
v_mul_f32 v168, v156, v60
v_mul_f32 v60, v140, v60
v_fmac_f32 v60, v156, v44
v_fma_f32 v44, v140, v44, -v168
v_mul_f32 v169, v157, v61
v_mul_f32 v61, v141, v61
v_fmac_f32 v61, v157, v45
v_fma_f32 v45, v141, v45, -v169
L_lc33:
ds_read_b128 v[186:189], v184
s_waitcnt lgkmcnt(0)
v_min3_u32 v186, v186, v187, v188
v_min_u32 v186, v186, v189
s_nop 0
v_readfirstlane_b32 s92, v186
s_nop 0
s_cmp_ge_u32 s92, 5
s_cbranch_scc1 L_lcd34
s_sleep 1
s_branch L_lc33
L_lcd34:
ds_read_b128 v[72:75], v17 offset:0
ds_read_b128 v[76:79], v17 offset:1024
ds_read_b128 v[80:83], v17 offset:2048
ds_read_b128 v[84:87], v17 offset:3072
ds_read_b128 v[88:91], v17 offset:4096
ds_read_b128 v[92:95], v17 offset:5120
ds_read_b128 v[96:99], v17 offset:6144
ds_read_b128 v[100:103], v17 offset:7168
v_mul_f32 v168, v158, v62
v_mul_f32 v62, v142, v62
v_fmac_f32 v62, v158, v46
v_fma_f32 v46, v142, v46, -v168
v_mul_f32 v169, v159, v63
v_mul_f32 v63, v143, v63
v_fmac_f32 v63, v159, v47
v_fma_f32 v47, v143, v47, -v169
v_mul_f32 v168, v160, v64
v_mul_f32 v64, v144, v64
v_fmac_f32 v64, v160, v48
v_fma_f32 v48, v144, v48, -v168
v_mul_f32 v169, v161, v65
v_mul_f32 v65, v145, v65
v_fmac_f32 v65, v161, v49
v_fma_f32 v49, v145, v49, -v169
v_mul_f32 v168, v162, v66
v_mul_f32 v66, v146, v66
v_fmac_f32 v66, v162, v50
v_fma_f32 v50, v146, v50, -v168
v_mul_f32 v169, v163, v67
v_mul_f32 v67, v147, v67
v_fmac_f32 v67, v163, v51
v_fma_f32 v51, v147, v51, -v169
v_mul_f32 v168, v164, v68
v_mul_f32 v68, v148, v68
v_fmac_f32 v68, v164, v52
v_fma_f32 v52, v148, v52, -v168
v_mul_f32 v169, v165, v69
v_mul_f32 v69, v149, v69
v_fmac_f32 v69, v165, v53
v_fma_f32 v53, v149, v53, -v169
v_mul_f32 v168, v166, v70
v_mul_f32 v70, v150, v70
v_fmac_f32 v70, v166, v54
v_fma_f32 v54, v150, v54, -v168
v_mul_f32 v169, v167, v71
v_mul_f32 v71, v151, v71
v_fmac_f32 v71, v167, v55
v_fma_f32 v55, v151, v55, -v169
s_waitcnt lgkmcnt(0)
v_mov_b32 v190, 6
s_mov_b64 exec, 1
ds_write_b32 v185, v190
s_mov_b64 exec, -1
v_fma_f32 v40, -v104, v88, v40
v_fmac_f32 v56, v104, v72
v_fma_f32 v40, -v105, v72, v40
v_fma_f32 v56, -v105, v88, v56
v_cvt_pk_bf16_f32 v24, v56, v40
v_fma_f32 v41, -v106, v89, v41
v_fmac_f32 v57, v106, v73
v_fma_f32 v41, -v107, v73, v41
v_fma_f32 v57, -v107, v89, v57
v_cvt_pk_bf16_f32 v25, v57, v41
v_fma_f32 v42, -v108, v90, v42
v_fmac_f32 v58, v108, v74
v_fma_f32 v42, -v109, v74, v42
v_fma_f32 v58, -v109, v90, v58
v_cvt_pk_bf16_f32 v26, v58, v42
v_fma_f32 v43, -v110, v91, v43
v_fmac_f32 v59, v110, v75
v_fma_f32 v43, -v111, v75, v43
v_fma_f32 v59, -v111, v91, v59
v_cvt_pk_bf16_f32 v27, v59, v43
v_fma_f32 v44, -v112, v92, v44
v_fmac_f32 v60, v112, v76
v_fma_f32 v44, -v113, v76, v44
v_fma_f32 v60, -v113, v92, v60
v_cvt_pk_bf16_f32 v28, v60, v44
v_fma_f32 v45, -v114, v93, v45
v_fmac_f32 v61, v114, v77
v_fma_f32 v45, -v115, v77, v45
v_fma_f32 v61, -v115, v93, v61
v_cvt_pk_bf16_f32 v29, v61, v45
v_fma_f32 v46, -v116, v94, v46
v_fmac_f32 v62, v116, v78
v_fma_f32 v46, -v117, v78, v46
v_fma_f32 v62, -v117, v94, v62
v_cvt_pk_bf16_f32 v30, v62, v46
v_fma_f32 v47, -v118, v95, v47
v_fmac_f32 v63, v118, v79
v_fma_f32 v47, -v119, v79, v47
v_fma_f32 v63, -v119, v95, v63
v_cvt_pk_bf16_f32 v31, v63, v47
v_fma_f32 v48, -v120, v96, v48
v_fmac_f32 v64, v120, v80
v_fma_f32 v48, -v121, v80, v48
v_fma_f32 v64, -v121, v96, v64
v_cvt_pk_bf16_f32 v32, v64, v48
v_fma_f32 v49, -v122, v97, v49
v_fmac_f32 v65, v122, v81
v_fma_f32 v49, -v123, v81, v49
v_fma_f32 v65, -v123, v97, v65
v_cvt_pk_bf16_f32 v33, v65, v49
v_fma_f32 v50, -v124, v98, v50
v_fmac_f32 v66, v124, v82
v_fma_f32 v50, -v125, v82, v50
v_fma_f32 v66, -v125, v98, v66
v_cvt_pk_bf16_f32 v34, v66, v50
v_fma_f32 v51, -v126, v99, v51
v_fmac_f32 v67, v126, v83
v_fma_f32 v51, -v127, v83, v51
v_fma_f32 v67, -v127, v99, v67
v_cvt_pk_bf16_f32 v35, v67, v51
v_fma_f32 v52, -v128, v100, v52
v_fmac_f32 v68, v128, v84
v_fma_f32 v52, -v129, v84, v52
v_fma_f32 v68, -v129, v100, v68
v_cvt_pk_bf16_f32 v36, v68, v52
v_fma_f32 v53, -v130, v101, v53
v_fmac_f32 v69, v130, v85
v_fma_f32 v53, -v131, v85, v53
v_fma_f32 v69, -v131, v101, v69
v_cvt_pk_bf16_f32 v37, v69, v53
v_fma_f32 v54, -v132, v102, v54
v_fmac_f32 v70, v132, v86
v_fma_f32 v54, -v133, v86, v54
v_fma_f32 v70, -v133, v102, v70
v_cvt_pk_bf16_f32 v38, v70, v54
v_fma_f32 v55, -v134, v103, v55
v_fmac_f32 v71, v134, v87
v_fma_f32 v55, -v135, v87, v55
v_fma_f32 v71, -v135, v103, v71
v_cvt_pk_bf16_f32 v39, v71, v55
v_mfma_f32_32x32x16_bf16 v[40:55], v[24:27], v[192:195], 0
v_mfma_f32_32x32x16_bf16 v[40:55], v[28:31], v[196:199], v[40:55]
v_mfma_f32_32x32x16_bf16 v[40:55], v[32:35], v[200:203], v[40:55]
v_mfma_f32_32x32x16_bf16 v[40:55], v[36:39], v[204:207], v[40:55]
v_mfma_f32_32x32x16_bf16 v[56:71], v[24:27], v[208:211], 0
v_mfma_f32_32x32x16_bf16 v[56:71], v[28:31], v[212:215], v[56:71]
v_mfma_f32_32x32x16_bf16 v[56:71], v[32:35], v[216:219], v[56:71]
v_mfma_f32_32x32x16_bf16 v[56:71], v[36:39], v[220:223], v[56:71]
s_nop 7
v_mul_f32 v168, v40, v224
v_mul_f32 v169, v40, v240
s_nop 1
v_fma_f32 v168, -v56, v240, v168
v_fmac_f32 v169, v56, v224
v_cvt_pk_bf16_f32 v24, v168, v169
v_mul_f32 v170, v41, v225
v_mul_f32 v171, v41, v241
v_fma_f32 v170, -v57, v241, v170
v_fmac_f32 v171, v57, v225
v_cvt_pk_bf16_f32 v25, v170, v171
v_mul_f32 v172, v42, v226
v_mul_f32 v173, v42, v242
v_fma_f32 v172, -v58, v242, v172
v_fmac_f32 v173, v58, v226
v_cvt_pk_bf16_f32 v26, v172, v173
v_mul_f32 v174, v43, v227
v_mul_f32 v175, v43, v243
v_fma_f32 v174, -v59, v243, v174
v_fmac_f32 v175, v59, v227
v_cvt_pk_bf16_f32 v27, v174, v175
v_mul_f32 v168, v44, v228
v_mul_f32 v169, v44, v244
v_fma_f32 v168, -v60, v244, v168
v_fmac_f32 v169, v60, v228
v_cvt_pk_bf16_f32 v28, v168, v169
v_mul_f32 v170, v45, v229
v_mul_f32 v171, v45, v245
v_fma_f32 v170, -v61, v245, v170
v_fmac_f32 v171, v61, v229
v_cvt_pk_bf16_f32 v29, v170, v171
v_mul_f32 v172, v46, v230
v_mul_f32 v173, v46, v246
v_fma_f32 v172, -v62, v246, v172
v_fmac_f32 v173, v62, v230
v_cvt_pk_bf16_f32 v30, v172, v173
v_mul_f32 v174, v47, v231
v_mul_f32 v175, v47, v247
v_fma_f32 v174, -v63, v247, v174
v_fmac_f32 v175, v63, v231
v_cvt_pk_bf16_f32 v31, v174, v175
v_mul_f32 v168, v48, v232
v_mul_f32 v169, v48, v248
v_fma_f32 v168, -v64, v248, v168
v_fmac_f32 v169, v64, v232
v_cvt_pk_bf16_f32 v32, v168, v169
v_mul_f32 v170, v49, v233
v_mul_f32 v171, v49, v249
v_fma_f32 v170, -v65, v249, v170
v_fmac_f32 v171, v65, v233
v_cvt_pk_bf16_f32 v33, v170, v171
v_mul_f32 v172, v50, v234
v_mul_f32 v173, v50, v250
v_fma_f32 v172, -v66, v250, v172
v_fmac_f32 v173, v66, v234
v_cvt_pk_bf16_f32 v34, v172, v173
v_mul_f32 v174, v51, v235
v_mul_f32 v175, v51, v251
v_fma_f32 v174, -v67, v251, v174
v_fmac_f32 v175, v67, v235
v_cvt_pk_bf16_f32 v35, v174, v175
v_mul_f32 v168, v52, v236
v_mul_f32 v169, v52, v252
v_fma_f32 v168, -v68, v252, v168
v_fmac_f32 v169, v68, v236
v_cvt_pk_bf16_f32 v36, v168, v169
v_mul_f32 v170, v53, v237
v_mul_f32 v171, v53, v253
v_fma_f32 v170, -v69, v253, v170
v_fmac_f32 v171, v69, v237
v_cvt_pk_bf16_f32 v37, v170, v171
v_mul_f32 v172, v54, v238
v_mul_f32 v173, v54, v254
v_fma_f32 v172, -v70, v254, v172
v_fmac_f32 v173, v70, v238
v_cvt_pk_bf16_f32 v38, v172, v173
v_mul_f32 v174, v55, v239
v_mul_f32 v175, v55, v255
v_fma_f32 v174, -v71, v255, v174
v_fmac_f32 v175, v71, v239
v_cvt_pk_bf16_f32 v39, v174, v175
v_mfma_f32_32x32x16_bf16 v[40:55], v[192:195], v[24:27], 0
v_mfma_f32_32x32x16_bf16 v[40:55], v[196:199], v[28:31], v[40:55]
v_mfma_f32_32x32x16_bf16 v[40:55], v[200:203], v[32:35], v[40:55]
v_mfma_f32_32x32x16_bf16 v[40:55], v[204:207], v[36:39], v[40:55]
v_mfma_f32_32x32x16_bf16 v[56:71], v[208:211], v[24:27], 0
v_mfma_f32_32x32x16_bf16 v[56:71], v[212:215], v[28:31], v[56:71]
v_mfma_f32_32x32x16_bf16 v[56:71], v[216:219], v[32:35], v[56:71]
v_mfma_f32_32x32x16_bf16 v[56:71], v[220:223], v[36:39], v[56:71]
s_lshr_b32 s64, s62, 16
L_lc35:
ds_read_b128 v[186:189], v184
s_waitcnt lgkmcnt(0)
v_min3_u32 v186, v186, v187, v188
v_min_u32 v186, v186, v189
s_nop 0
v_readfirstlane_b32 s92, v186
s_nop 0
s_cmp_ge_u32 s92, 6
s_cbranch_scc1 L_lcd36
s_sleep 1
s_branch L_lc35
L_lcd36:
s_nop 1
v_cvt_pk_bf16_f32 v24, v40, v56
v_xor_b32 v24, s64, v24
v_cvt_pk_bf16_f32 v25, v41, v57
v_xor_b32 v25, s64, v25
v_cvt_pk_bf16_f32 v26, v42, v58
v_xor_b32 v26, s64, v26
v_cvt_pk_bf16_f32 v27, v43, v59
v_xor_b32 v27, s64, v27
ds_write_b128 v15, v[24:27] offset:0
v_cvt_pk_bf16_f32 v28, v44, v60
v_xor_b32 v28, s64, v28
v_cvt_pk_bf16_f32 v29, v45, v61
v_xor_b32 v29, s64, v29
v_cvt_pk_bf16_f32 v30, v46, v62
v_xor_b32 v30, s64, v30
v_cvt_pk_bf16_f32 v31, v47, v63
v_xor_b32 v31, s64, v31
ds_write_b128 v15, v[28:31] offset:4096
v_cvt_pk_bf16_f32 v32, v48, v64
v_xor_b32 v32, s64, v32
v_cvt_pk_bf16_f32 v33, v49, v65
v_xor_b32 v33, s64, v33
v_cvt_pk_bf16_f32 v34, v50, v66
v_xor_b32 v34, s64, v34
v_cvt_pk_bf16_f32 v35, v51, v67
v_xor_b32 v35, s64, v35
ds_write_b128 v15, v[32:35] offset:8192
v_cvt_pk_bf16_f32 v36, v52, v68
v_xor_b32 v36, s64, v36
v_cvt_pk_bf16_f32 v37, v53, v69
v_xor_b32 v37, s64, v37
v_cvt_pk_bf16_f32 v38, v54, v70
v_xor_b32 v38, s64, v38
v_cvt_pk_bf16_f32 v39, v55, v71
v_xor_b32 v39, s64, v39
ds_write_b128 v15, v[36:39] offset:12288
s_waitcnt lgkmcnt(0)
v_mov_b32 v190, 7
s_mov_b64 exec, 1
ds_write_b32 v185, v190
s_mov_b64 exec, -1
L_lc37:
ds_read_b128 v[186:189], v184
s_waitcnt lgkmcnt(0)
v_min3_u32 v186, v186, v187, v188
v_min_u32 v186, v186, v189
s_nop 0
v_readfirstlane_b32 s92, v186
s_nop 0
s_cmp_ge_u32 s92, 7
s_cbranch_scc1 L_lcd38
s_sleep 1
s_branch L_lc37
L_lcd38:
ds_read_b128 v[24:27], v18 offset:0
ds_read_b128 v[28:31], v18 offset:1024
ds_read_b128 v[32:35], v18 offset:2048
ds_read_b128 v[36:39], v18 offset:3072
s_mov_b32 s64, 0
s_waitcnt lgkmcnt(3)
buffer_store_dwordx4 v[24:27], v14, s[52:55], s64 offen sc1
s_mov_b32 s64, 262144
s_waitcnt lgkmcnt(2)
buffer_store_dwordx4 v[28:31], v14, s[52:55], s64 offen sc1
s_mov_b32 s64, 524288
s_waitcnt lgkmcnt(1)
buffer_store_dwordx4 v[32:35], v14, s[52:55], s64 offen sc1
s_mov_b32 s64, 786432
s_waitcnt lgkmcnt(0)
buffer_store_dwordx4 v[36:39], v14, s[52:55], s64 offen sc1
s_lshl_b32 s64, s67, 14
s_add_u32 s40, s28, s64
s_addc_u32 s41, s29, 0
s_mov_b32 s42, 16384
s_mov_b32 s43, 0x20000
v_and_b32 v8, 31, v1
v_lshrrev_b32 v9, 5, v1
v_lshlrev_b32 v14, 2, v8
v_lshl_add_u32 v14, v9, 9, v14
s_mov_b32 s64, 0x35000000
v_mul_f32 v224, s64, v224
v_mul_f32 v225, s64, v225
v_mul_f32 v226, s64, v226
v_mul_f32 v227, s64, v227
v_mul_f32 v228, s64, v228
v_mul_f32 v229, s64, v229
v_mul_f32 v230, s64, v230
v_mul_f32 v231, s64, v231
v_mul_f32 v232, s64, v232
v_mul_f32 v233, s64, v233
v_mul_f32 v234, s64, v234
v_mul_f32 v235, s64, v235
v_mul_f32 v236, s64, v236
v_mul_f32 v237, s64, v237
v_mul_f32 v238, s64, v238
v_mul_f32 v239, s64, v239
v_mul_f32 v240, s64, v240
v_mul_f32 v241, s64, v241
v_mul_f32 v242, s64, v242
v_mul_f32 v243, s64, v243
v_mul_f32 v244, s64, v244
v_mul_f32 v245, s64, v245
v_mul_f32 v246, s64, v246
v_mul_f32 v247, s64, v247
v_mul_f32 v248, s64, v248
v_mul_f32 v249, s64, v249
v_mul_f32 v250, s64, v250
v_mul_f32 v251, s64, v251
v_mul_f32 v252, s64, v252
v_mul_f32 v253, s64, v253
v_mul_f32 v254, s64, v254
v_mul_f32 v255, s64, v255
s_waitcnt vmcnt(0)
v_mov_b32 v190, 8
s_mov_b64 exec, 1
ds_write_b32 v185, v190
s_mov_b64 exec, -1
s_cmp_lg_u32 s66, 0
s_cbranch_scc1 L_ph39
L_lc40:
ds_read_b128 v[186:189], v184
s_waitcnt lgkmcnt(0)
v_min3_u32 v186, v186, v187, v188
v_min_u32 v186, v186, v189
s_nop 0
v_readfirstlane_b32 s92, v186
s_nop 0
s_cmp_ge_u32 s92, 8
s_cbranch_scc1 L_lcd41
s_sleep 1
s_branch L_lc40
L_lcd41:
s_and_b32 s64, s2, 15
s_lshl_b32 s65, s64, 7
s_add_u32 s65, s65, 6144
s_add_u32 s90, s32, s65
s_addc_u32 s91, s33, 0
s_mov_b32 s18, 1
s_atomic_add s18, s[90:91], 0x0 glc
L_ph39:
s_cmp_lg_u32 s66, 0
s_cbranch_scc1 L_sg42
s_and_b32 s64, s2, 15
s_lshl_b32 s64, s64, 2
s_add_u32 s64, s64, 548864
s_add_u32 s4, s32, s64
s_addc_u32 s5, s33, 0
s_waitcnt lgkmcnt(0)
s_cmp_lg_u32 s18, 15
s_cbranch_scc1 L_sg42
s_atomic_swap s37, s[4:5], 0x0
s_atomic_swap s37, s[4:5], 0x80
s_atomic_swap s37, s[4:5], 0x100
s_atomic_swap s37, s[4:5], 0x180
s_atomic_swap s37, s[4:5], 0x200
s_atomic_swap s37, s[4:5], 0x280
s_atomic_swap s37, s[4:5], 0x300
s_atomic_swap s37, s[4:5], 0x380
s_atomic_swap s37, s[4:5], 0x400
s_atomic_swap s37, s[4:5], 0x480
s_atomic_swap s37, s[4:5], 0x500
s_atomic_swap s37, s[4:5], 0x580
s_atomic_swap s37, s[4:5], 0x600
s_atomic_swap s37, s[4:5], 0x680
s_atomic_swap s37, s[4:5], 0x700
s_atomic_swap s37, s[4:5], 0x780
s_atomic_swap s37, s[4:5], 0x800
s_atomic_swap s37, s[4:5], 0x880
s_atomic_swap s37, s[4:5], 0x900
s_atomic_swap s37, s[4:5], 0x980
s_atomic_swap s37, s[4:5], 0xa00
s_atomic_swap s37, s[4:5], 0xa80
s_atomic_swap s37, s[4:5], 0xb00
s_atomic_swap s37, s[4:5], 0xb80
s_atomic_swap s37, s[4:5], 0xc00
s_atomic_swap s37, s[4:5], 0xc80
s_atomic_swap s37, s[4:5], 0xd00
s_atomic_swap s37, s[4:5], 0xd80
s_atomic_swap s37, s[4:5], 0xe00
s_atomic_swap s37, s[4:5], 0xe80
s_atomic_swap s37, s[4:5], 0xf00
s_atomic_swap s37, s[4:5], 0xf80
s_waitcnt lgkmcnt(0)
L_sg42:
s_cmp_lg_u32 s66, 0
s_cbranch_scc1 L_ph43
s_and_b32 s64, s2, 31
s_lshl_b32 s64, s64, 7
s_add_u32 s64, s64, 548864
s_add_u32 s90, s32, s64
s_addc_u32 s91, s33, 0
s_mov_b32 s64, s37
s_mov_b32 s65, s37
s_mov_b32 s92, 0
s_branch L_sp44
L_nok45:
s_add_u32 s92, s92, 1
s_cmp_ge_u32 s92, 200000
s_cbranch_scc1 L_ph43
s_sleep 10
L_sp44:
s_load_dwordx16 s[4:19], s[90:91], 0x0 glc
s_waitcnt lgkmcnt(0)
s_cmp_eq_u64 s[4:5], s[64:65]
s_cbranch_scc0 L_nok45
s_cmp_eq_u64 s[6:7], s[64:65]
s_cbranch_scc0 L_nok45
s_cmp_eq_u64 s[8:9], s[64:65]
s_cbranch_scc0 L_nok45
s_cmp_eq_u64 s[10:11], s[64:65]
s_cbranch_scc0 L_nok45
s_cmp_eq_u64 s[12:13], s[64:65]
s_cbranch_scc0 L_nok45
s_cmp_eq_u64 s[14:15], s[64:65]
s_cbranch_scc0 L_nok45
s_cmp_eq_u64 s[16:17], s[64:65]
s_cbranch_scc0 L_nok45
s_cmp_eq_u64 s[18:19], s[64:65]
s_cbranch_scc0 L_nok45
L_ph43:
v_mov_b32 v190, 9
s_mov_b64 exec, 1
ds_write_b32 v185, v190
s_mov_b64 exec, -1
L_lc46:
ds_read_b128 v[186:189], v184
s_waitcnt lgkmcnt(0)
v_min3_u32 v186, v186, v187, v188
v_min_u32 v186, v186, v189
s_nop 0
v_readfirstlane_b32 s92, v186
s_nop 0
s_cmp_ge_u32 s92, 9
s_cbranch_scc1 L_lcd47
s_sleep 1
s_branch L_lc46
L_lcd47:
s_setprio 0
v_add_u32 v191, -16, v184
L_lc48:
ds_read_b128 v[186:189], v191
s_waitcnt lgkmcnt(0)
v_min3_u32 v186, v186, v187, v188
v_min_u32 v186, v186, v189
s_nop 0
v_readfirstlane_b32 s92, v186
s_nop 0
s_cmp_ge_u32 s92, 11
s_cbranch_scc1 L_lcd49
s_sleep 1
s_branch L_lc48
L_lcd49:
s_mov_b32 m0, s68
s_nop 0
buffer_load_dwordx4 v7, s[44:47], 0 offen offset:0 sc1 lds
buffer_load_dwordx4 v7, s[44:47], 0 offen offset:1024 sc1 lds
buffer_load_dwordx4 v7, s[44:47], 0 offen offset:2048 sc1 lds
buffer_load_dwordx4 v7, s[44:47], 0 offen offset:3072 sc1 lds
s_waitcnt vmcnt(0)
v_mov_b32 v190, 10
s_mov_b64 exec, 1
ds_write_b32 v185, v190
s_mov_b64 exec, -1
L_lc50:
ds_read_b128 v[186:189], v184
s_waitcnt lgkmcnt(0)
v_min3_u32 v186, v186, v187, v188
v_min_u32 v186, v186, v189
s_nop 0
v_readfirstlane_b32 s92, v186
s_nop 0
s_cmp_ge_u32 s92, 10
s_cbranch_scc1 L_lcd51
s_sleep 1
s_branch L_lc50
L_lcd51:
ds_read_b32 v24, v4 offset:0
ds_read_b32 v25, v4 offset:1024
ds_read_b32 v26, v4 offset:2048
ds_read_b32 v27, v4 offset:3072
ds_read_b32 v28, v4 offset:8192
ds_read_b32 v29, v4 offset:9216
ds_read_b32 v30, v4 offset:10240
ds_read_b32 v31, v4 offset:11264
ds_read_b32 v32, v6 offset:0
ds_read_b32 v33, v5 offset:10240
ds_read_b32 v34, v5 offset:9216
ds_read_b32 v35, v5 offset:8192
ds_read_b32 v36, v5 offset:3072
ds_read_b32 v37, v5 offset:2048
ds_read_b32 v38, v5 offset:1024
ds_read_b32 v39, v5 offset:0
s_waitcnt lgkmcnt(0)
v_mfma_f32_32x32x16_bf16 v[40:55], v[24:27], v[192:195], 0
v_mfma_f32_32x32x16_bf16 v[40:55], v[28:31], v[196:199], v[40:55]
v_mfma_f32_32x32x16_bf16 v[40:55], v[32:35], v[200:203], v[40:55]
v_mfma_f32_32x32x16_bf16 v[40:55], v[36:39], v[204:207], v[40:55]
v_mfma_f32_32x32x16_bf16 v[56:71], v[24:27], v[208:211], 0
v_mfma_f32_32x32x16_bf16 v[56:71], v[28:31], v[212:215], v[56:71]
v_mfma_f32_32x32x16_bf16 v[56:71], v[32:35], v[216:219], v[56:71]
v_mfma_f32_32x32x16_bf16 v[56:71], v[36:39], v[220:223], v[56:71]
s_nop 7
v_mul_f32 v168, v40, v224
v_mul_f32 v169, v40, v240
s_nop 1
v_fma_f32 v168, -v56, v240, v168
v_fmac_f32 v169, v56, v224
v_cvt_pk_bf16_f32 v24, v168, v169
v_mul_f32 v170, v41, v225
v_mul_f32 v171, v41, v241
v_fma_f32 v170, -v57, v241, v170
v_fmac_f32 v171, v57, v225
v_cvt_pk_bf16_f32 v25, v170, v171
v_mul_f32 v172, v42, v226
v_mul_f32 v173, v42, v242
v_fma_f32 v172, -v58, v242, v172
v_fmac_f32 v173, v58, v226
v_cvt_pk_bf16_f32 v26, v172, v173
v_mul_f32 v174, v43, v227
v_mul_f32 v175, v43, v243
v_fma_f32 v174, -v59, v243, v174
v_fmac_f32 v175, v59, v227
v_cvt_pk_bf16_f32 v27, v174, v175
v_mul_f32 v168, v44, v228
v_mul_f32 v169, v44, v244
v_fma_f32 v168, -v60, v244, v168
v_fmac_f32 v169, v60, v228
v_cvt_pk_bf16_f32 v28, v168, v169
v_mul_f32 v170, v45, v229
v_mul_f32 v171, v45, v245
v_fma_f32 v170, -v61, v245, v170
v_fmac_f32 v171, v61, v229
v_cvt_pk_bf16_f32 v29, v170, v171
v_mul_f32 v172, v46, v230
v_mul_f32 v173, v46, v246
v_fma_f32 v172, -v62, v246, v172
v_fmac_f32 v173, v62, v230
v_cvt_pk_bf16_f32 v30, v172, v173
v_mul_f32 v174, v47, v231
v_mul_f32 v175, v47, v247
v_fma_f32 v174, -v63, v247, v174
v_fmac_f32 v175, v63, v231
v_cvt_pk_bf16_f32 v31, v174, v175
v_mul_f32 v168, v48, v232
v_mul_f32 v169, v48, v248
v_fma_f32 v168, -v64, v248, v168
v_fmac_f32 v169, v64, v232
v_cvt_pk_bf16_f32 v32, v168, v169
v_mul_f32 v170, v49, v233
v_mul_f32 v171, v49, v249
v_fma_f32 v170, -v65, v249, v170
v_fmac_f32 v171, v65, v233
v_cvt_pk_bf16_f32 v33, v170, v171
v_mul_f32 v172, v50, v234
v_mul_f32 v173, v50, v250
v_fma_f32 v172, -v66, v250, v172
v_fmac_f32 v173, v66, v234
v_cvt_pk_bf16_f32 v34, v172, v173
v_mul_f32 v174, v51, v235
v_mul_f32 v175, v51, v251
v_fma_f32 v174, -v67, v251, v174
v_fmac_f32 v175, v67, v235
v_cvt_pk_bf16_f32 v35, v174, v175
v_mul_f32 v168, v52, v236
v_mul_f32 v169, v52, v252
v_fma_f32 v168, -v68, v252, v168
v_fmac_f32 v169, v68, v236
v_cvt_pk_bf16_f32 v36, v168, v169
v_mul_f32 v170, v53, v237
v_mul_f32 v171, v53, v253
v_fma_f32 v170, -v69, v253, v170
v_fmac_f32 v171, v69, v237
v_cvt_pk_bf16_f32 v37, v170, v171
v_mul_f32 v172, v54, v238
v_mul_f32 v173, v54, v254
v_fma_f32 v172, -v70, v254, v172
v_fmac_f32 v173, v70, v238
v_cvt_pk_bf16_f32 v38, v172, v173
v_mul_f32 v174, v55, v239
v_mul_f32 v175, v55, v255
v_fma_f32 v174, -v71, v255, v174
v_fmac_f32 v175, v71, v239
v_cvt_pk_bf16_f32 v39, v174, v175
v_mfma_f32_32x32x16_bf16 v[40:55], v[192:195], v[24:27], 0
v_mfma_f32_32x32x16_bf16 v[40:55], v[196:199], v[28:31], v[40:55]
v_mfma_f32_32x32x16_bf16 v[40:55], v[200:203], v[32:35], v[40:55]
v_mfma_f32_32x32x16_bf16 v[40:55], v[204:207], v[36:39], v[40:55]
v_mfma_f32_32x32x16_bf16 v[56:71], v[208:211], v[24:27], 0
v_mfma_f32_32x32x16_bf16 v[56:71], v[212:215], v[28:31], v[56:71]
v_mfma_f32_32x32x16_bf16 v[56:71], v[216:219], v[32:35], v[56:71]
v_mfma_f32_32x32x16_bf16 v[56:71], v[220:223], v[36:39], v[56:71]
s_movk_i32 s64, 0x2000
s_nop 10
v_cvt_pk_bf16_f32 v73, v56, v40
v_lshlrev_b32 v72, 16, v73
v_and_b32 v73, 0xffff0000, v73
buffer_store_dword v72, v14, s[40:43], 0 offen offset:0 nt
buffer_store_dword v73, v14, s[40:43], s64 offen offset:0 nt
v_cvt_pk_bf16_f32 v75, v57, v41
v_lshlrev_b32 v74, 16, v75
v_and_b32 v75, 0xffff0000, v75
buffer_store_dword v74, v14, s[40:43], 0 offen offset:128 nt
buffer_store_dword v75, v14, s[40:43], s64 offen offset:128 nt
v_cvt_pk_bf16_f32 v77, v58, v42
v_lshlrev_b32 v76, 16, v77
v_and_b32 v77, 0xffff0000, v77
buffer_store_dword v76, v14, s[40:43], 0 offen offset:256 nt
buffer_store_dword v77, v14, s[40:43], s64 offen offset:256 nt
v_cvt_pk_bf16_f32 v79, v59, v43
v_lshlrev_b32 v78, 16, v79
v_and_b32 v79, 0xffff0000, v79
buffer_store_dword v78, v14, s[40:43], 0 offen offset:384 nt
buffer_store_dword v79, v14, s[40:43], s64 offen offset:384 nt
v_cvt_pk_bf16_f32 v81, v60, v44
v_lshlrev_b32 v80, 16, v81
v_and_b32 v81, 0xffff0000, v81
buffer_store_dword v80, v14, s[40:43], 0 offen offset:1024 nt
buffer_store_dword v81, v14, s[40:43], s64 offen offset:1024 nt
v_cvt_pk_bf16_f32 v83, v61, v45
v_lshlrev_b32 v82, 16, v83
v_and_b32 v83, 0xffff0000, v83
buffer_store_dword v82, v14, s[40:43], 0 offen offset:1152 nt
buffer_store_dword v83, v14, s[40:43], s64 offen offset:1152 nt
v_cvt_pk_bf16_f32 v85, v62, v46
v_lshlrev_b32 v84, 16, v85
v_and_b32 v85, 0xffff0000, v85
buffer_store_dword v84, v14, s[40:43], 0 offen offset:1280 nt
buffer_store_dword v85, v14, s[40:43], s64 offen offset:1280 nt
v_cvt_pk_bf16_f32 v87, v63, v47
v_lshlrev_b32 v86, 16, v87
v_and_b32 v87, 0xffff0000, v87
buffer_store_dword v86, v14, s[40:43], 0 offen offset:1408 nt
buffer_store_dword v87, v14, s[40:43], s64 offen offset:1408 nt
v_cvt_pk_bf16_f32 v89, v64, v48
v_lshlrev_b32 v88, 16, v89
v_and_b32 v89, 0xffff0000, v89
buffer_store_dword v88, v14, s[40:43], 0 offen offset:2048 nt
buffer_store_dword v89, v14, s[40:43], s64 offen offset:2048 nt
v_cvt_pk_bf16_f32 v91, v65, v49
v_lshlrev_b32 v90, 16, v91
v_and_b32 v91, 0xffff0000, v91
buffer_store_dword v90, v14, s[40:43], 0 offen offset:2176 nt
buffer_store_dword v91, v14, s[40:43], s64 offen offset:2176 nt
v_cvt_pk_bf16_f32 v93, v66, v50
v_lshlrev_b32 v92, 16, v93
v_and_b32 v93, 0xffff0000, v93
buffer_store_dword v92, v14, s[40:43], 0 offen offset:2304 nt
buffer_store_dword v93, v14, s[40:43], s64 offen offset:2304 nt
v_cvt_pk_bf16_f32 v95, v67, v51
v_lshlrev_b32 v94, 16, v95
v_and_b32 v95, 0xffff0000, v95
buffer_store_dword v94, v14, s[40:43], 0 offen offset:2432 nt
buffer_store_dword v95, v14, s[40:43], s64 offen offset:2432 nt
v_cvt_pk_bf16_f32 v97, v68, v52
v_lshlrev_b32 v96, 16, v97
v_and_b32 v97, 0xffff0000, v97
buffer_store_dword v96, v14, s[40:43], 0 offen offset:3072 nt
buffer_store_dword v97, v14, s[40:43], s64 offen offset:3072 nt
v_cvt_pk_bf16_f32 v99, v69, v53
v_lshlrev_b32 v98, 16, v99
v_and_b32 v99, 0xffff0000, v99
buffer_store_dword v98, v14, s[40:43], 0 offen offset:3200 nt
buffer_store_dword v99, v14, s[40:43], s64 offen offset:3200 nt
v_cvt_pk_bf16_f32 v101, v70, v54
v_lshlrev_b32 v100, 16, v101
v_and_b32 v101, 0xffff0000, v101
buffer_store_dword v100, v14, s[40:43], 0 offen offset:3328 nt
buffer_store_dword v101, v14, s[40:43], s64 offen offset:3328 nt
v_cvt_pk_bf16_f32 v103, v71, v55
v_lshlrev_b32 v102, 16, v103
v_and_b32 v103, 0xffff0000, v103
buffer_store_dword v102, v14, s[40:43], 0 offen offset:3456 nt
buffer_store_dword v103, v14, s[40:43], s64 offen offset:3456 nt
s_endpgm
L_concat_heads__spectral_gfnet__ssm_conv_s5__prompt_kernel_gemm:
s_lshr_b32 s68, s34, 1
s_and_b32 s66, s34, 1
s_lshr_b32 s101, s36, 3
v_and_b32 v6, 31, v1
v_lshrrev_b32 v5, 5, v1
v_lshlrev_b32 v11, 4, v1
v_mov_b64 v[64:65], 0
v_mov_b64 v[66:67], 0
s_mul_i32 s60, s34, 2304
s_add_u32 s60, s60, 114688
v_add_u32 v13, s60, v11
v_mov_b32 v12, 126976
ds_write_b128 v13, v[64:67]
ds_write_b128 v13, v[64:67] offset:1024
ds_write_b128 v13, v[64:67] offset:2048
s_mov_b64 exec, 1
ds_write_b128 v12, v[64:67]
ds_write_b128 v12, v[64:67] offset:16
ds_write_b128 v12, v[64:67] offset:32
ds_write_b128 v12, v[64:67] offset:48
ds_write_b128 v12, v[64:67] offset:64
s_mov_b64 exec, -1
s_lshl_b32 s60, s34, 2
v_add_u32 v13, s60, v12
s_waitcnt lgkmcnt(0)
s_barrier
v_bfe_u32 v4, v1, 2, 2
v_lshlrev_b32 v4, 3, v4
v_and_b32 v7, 3, v1
v_add_u32 v4, v4, v7
s_lshl_b32 s60, s36, 6
s_lshl_b32 s61, s66, 5
s_add_u32 s60, s60, s61
v_add_u32 v4, s60, v4
v_lshlrev_b32 v7, 1, v4
v_lshrrev_b32 v14, 5, v1
v_bfe_u32 v15, v1, 3, 2
v_and_b32 v16, 1, v15
v_lshrrev_b32 v17, 1, v15
v_lshlrev_b32 v18, 4, v14
v_lshl_add_u32 v18, v16, 3, v18
v_add_u32 v18, v18, v17
s_lshl_b32 s61, s68, 6
s_lshl_b32 s62, s66, 2
s_add_u32 s61, s61, s62
v_add_u32 v18, s61, v18
v_lshlrev_b32 v18, 11, v18
s_lshl_b32 s61, s68, 5
v_lshl_add_u32 v19, v14, 3, v15
v_add_u32 v19, s61, v19
v_lshlrev_b32 v19, 11, v19
v_and_b32 v16, 7, v1
v_lshrrev_b32 v17, 4, v1
v_xor_b32 v16, v16, v17
v_lshlrev_b32 v16, 4, v16
v_xor_b32 v17, 64, v16
v_add_u32 v244, v18, v16
v_add_u32 v245, v18, v17
v_add_u32 v245, 64512, v245
v_add_u32 v246, v19, v16
v_add_u32 v247, v19, v17
v_add_u32 v247, 31744, v247
s_bfe_u32 s38, s2, 0x20001
s_lshl_b32 s38, s38, 2
s_lshr_b32 s60, s2, 6
s_add_u32 s38, s38, s60
s_mul_i32 s38, s38, 128
s_mul_i32 s60, s36, 128
s_add_u32 s38, s38, s60
s_bfe_u32 s60, s38, 0x30007
s_cmp_eq_u32 s60, 3
s_cselect_b32 s60, 128, 0
s_add_u32 s38, s38, s60
s_lshl_b32 s60, s35, 18
s_lshl_b32 s61, s36, 17
s_lshl_b32 s39, s34, 12
s_waitcnt lgkmcnt(0)
global_load_ushort v248, v7, s[12:13] offset:0
global_load_ushort v249, v7, s[14:15] offset:0
global_load_ushort v250, v7, s[24:25] offset:0
global_load_ushort v251, v7, s[12:13] offset:8
global_load_ushort v252, v7, s[14:15] offset:8
global_load_ushort v253, v7, s[24:25] offset:8
s_add_u32 s48, s10, s60
s_addc_u32 s49, s11, 0
s_mov_b32 s50, 262144
s_mov_b32 s51, 0x20000
s_cmp_eq_u32 s66, 1
s_cselect_b32 s62, s18, s16
s_cselect_b32 s63, s19, s17
s_add_u32 s52, s62, s61
s_addc_u32 s53, s63, 0
s_mov_b32 s54, 131072
s_mov_b32 s55, 0x20000
s_add_u32 s62, s38, 0
s_and_b32 s62, s62, 0x7ff
s_add_u32 s63, s62, 2048
s_add_u32 s64, s62, 6144
s_add_u32 m0, s39, 0
s_nop 0
buffer_load_dwordx4 v244, s[48:51], s62 offen offset:0 lds
buffer_load_dwordx4 v245, s[48:51], s62 offen offset:1024 lds
buffer_load_dwordx4 v244, s[48:51], s63 offen offset:2048 lds
buffer_load_dwordx4 v245, s[48:51], s63 offen offset:3072 lds
s_add_u32 m0, s39, 16384
s_nop 0
buffer_load_dwordx4 v246, s[52:55], s62 offen offset:0 lds
buffer_load_dwordx4 v247, s[52:55], s62 offen offset:1024 lds
buffer_load_dwordx4 v246, s[52:55], s64 offen offset:2048 lds
buffer_load_dwordx4 v247, s[52:55], s64 offen offset:3072 lds
v_bfe_u32 v7, v1, 4, 1
v_lshl_add_u32 v4, v7, 2, v4
v_bfe_u32 v7, v6, 1, 3
v_xor_b32 v7, v7, v5
v_lshlrev_b32 v7, 4, v7
v_lshl_add_u32 v7, v6, 7, v7
v_and_b32 v8, 15, v1
v_lshrrev_b32 v9, 4, v1
v_lshrrev_b32 v14, 1, v8
v_xor_b32 v14, v14, v9
v_lshlrev_b32 v14, 4, v14
v_lshl_add_u32 v14, v8, 7, v14
s_lshl_b32 s60, s68, 13
s_lshl_b32 s61, s66, 13
s_add_u32 s61, s61, 16384
v_xor_b32 v15, 0, v14
v_add_u32 v128, s60, v15
v_add_u32 v130, s61, v15
v_add_u32 v132, 0x10000, v128
v_add_u32 v134, 0x10000, v130
v_xor_b32 v15, 64, v14
v_add_u32 v129, s60, v15
v_add_u32 v131, s61, v15
v_add_u32 v133, 0x10000, v129
v_add_u32 v135, 0x10000, v131
s_add_u32 s40, s32, 65536
s_addc_u32 s41, s33, 0
s_mov_b32 s42, 262144
s_mov_b32 s43, 0x20000
s_add_u32 s44, s32, 1048576
s_addc_u32 s45, s33, 0
s_mov_b32 s46, 8388608
s_mov_b32 s47, 0x20000
s_mul_i32 s60, s66, 4608
s_add_u32 s60, s60, 114752
s_lshl_b32 s61, s68, 5
s_add_u32 s61, s61, s60
v_mul_u32_u24 v14, 144, v6
v_add_u32 v14, s60, v14
v_lshl_add_u32 v14, v5, 5, v14
v_mul_u32_u24 v15, 144, v8
v_add_u32 v15, s61, v15
v_lshl_add_u32 v15, v9, 3, v15
s_lshl_b32 s60, s35, 14
v_lshl_add_u32 v16, v4, 4, s60
v_mov_b32 v17, 0x40000000
v_lshlrev_b32 v10, 14, v5
v_sub_u32 v10, v16, v10
v_subrev_u32 v136, 16384, v10
v_cmp_le_i32 vcc, 0, v136
s_nop 1
v_cndmask_b32 v136, v17, v136, vcc
v_subrev_u32 v137, 49152, v10
v_cmp_le_i32 vcc, 0, v137
s_nop 1
v_cndmask_b32 v137, v17, v137, vcc
v_subrev_u32 v138, 81920, v10
v_cmp_le_i32 vcc, 0, v138
s_nop 1
v_cndmask_b32 v138, v17, v138, vcc
v_subrev_u32 v139, 114688, v10
v_cmp_le_i32 vcc, 0, v139
s_nop 1
v_cndmask_b32 v139, v17, v139, vcc
v_subrev_u32 v140, 147456, v10
v_cmp_le_i32 vcc, 0, v140
s_nop 1
v_cndmask_b32 v140, v17, v140, vcc
v_subrev_u32 v141, 180224, v10
v_cmp_le_i32 vcc, 0, v141
s_nop 1
v_cndmask_b32 v141, v17, v141, vcc
v_subrev_u32 v142, 212992, v10
v_cmp_le_i32 vcc, 0, v142
s_nop 1
v_cndmask_b32 v142, v17, v142, vcc
v_subrev_u32 v143, 245760, v10
v_cmp_le_i32 vcc, 0, v143
s_nop 1
v_cndmask_b32 v143, v17, v143, vcc
v_lshlrev_b32 v17, 30, v5
v_or_b32 v16, v16, v17
s_lshl_b32 s60, s35, 11
s_add_u32 s60, s60, 32768
s_lshl_b32 s61, s36, 7
s_add_u32 s61, s61, s60
v_mov_b32 v195, s61
s_lshl_b32 s61, s101, 10
s_add_u32 s60, s60, s61
v_and_b32 v196, 7, v1
v_lshl_add_u32 v196, v196, 7, s60
s_lshl_b32 s60, s35, 1
s_add_u32 s60, s60, s68
s_lshl_b32 s60, s60, 12
s_add_u32 s60, s60, 393216
s_lshl_b32 s61, s101, 11
s_add_u32 s61, s61, s60
v_lshl_add_u32 v18, v8, 7, s61
s_lshl_b32 s61, s36, 8
s_add_u32 s60, s60, s61
s_lshl_b32 s61, s66, 7
s_add_u32 s60, s60, s61
v_mov_b32 v19, s60
v_lshrrev_b32 v10, 1, v9
v_lshlrev_b32 v10, 10, v10
v_and_b32 v17, 1, v9
v_lshl_add_u32 v10, v17, 9, v10
v_lshl_add_u32 v10, v8, 4, v10
s_lshl_b32 s60, s68, 2
v_add_u32 v9, s60, v9
v_cvt_f32_u32 v9, v9
v_mul_f32 v9, 0x41800000, v9
v_add_f32 v8, 0x41000000, v9
s_add_u32 s62, s38, 128
s_and_b32 s62, s62, 0x7ff
s_add_u32 s63, s62, 2048
s_add_u32 s64, s62, 6144
s_add_u32 m0, s39, 32768
s_nop 0
buffer_load_dwordx4 v244, s[48:51], s62 offen offset:0 lds
buffer_load_dwordx4 v245, s[48:51], s62 offen offset:1024 lds
buffer_load_dwordx4 v244, s[48:51], s63 offen offset:2048 lds
buffer_load_dwordx4 v245, s[48:51], s63 offen offset:3072 lds
s_add_u32 m0, s39, 49152
s_nop 0
buffer_load_dwordx4 v246, s[52:55], s62 offen offset:0 lds
buffer_load_dwordx4 v247, s[52:55], s62 offen offset:1024 lds
buffer_load_dwordx4 v246, s[52:55], s64 offen offset:2048 lds
buffer_load_dwordx4 v247, s[52:55], s64 offen offset:3072 lds
s_setprio 1
s_waitcnt vmcnt(8)
s_barrier
ds_read_b128 v[32:35], v128 offset:0
ds_read_b128 v[48:51], v130 offset:0
ds_read_b128 v[52:55], v130 offset:2048
ds_read_b128 v[56:59], v130 offset:4096
ds_read_b128 v[60:63], v130 offset:6144
ds_read_b128 v[36:39], v128 offset:2048
ds_read_b128 v[40:43], v128 offset:4096
ds_read_b128 v[44:47], v128 offset:6144
s_waitcnt lgkmcnt(6)
v_mfma_f32_16x16x32_bf16 v[64:67], v[32:35], v[48:51], 0
ds_read_b128 v[144:147], v129 offset:0
s_waitcnt lgkmcnt(6)
v_mfma_f32_16x16x32_bf16 v[96:99], v[32:35], v[52:55], 0
ds_read_b128 v[160:163], v131 offset:0
s_waitcnt lgkmcnt(6)
v_mfma_f32_16x16x32_bf16 v[80:83], v[32:35], v[56:59], 0
ds_read_b128 v[164:167], v131 offset:2048
s_waitcnt lgkmcnt(6)
v_mfma_f32_16x16x32_bf16 v[112:115], v[32:35], v[60:63], 0
ds_read_b128 v[168:171], v131 offset:4096
s_waitcnt lgkmcnt(6)
v_mfma_f32_16x16x32_bf16 v[68:71], v[36:39], v[48:51], 0
ds_read_b128 v[172:175], v131 offset:6144
v_mfma_f32_16x16x32_bf16 v[100:103], v[36:39], v[52:55], 0
ds_read_b128 v[148:151], v129 offset:2048
v_mfma_f32_16x16x32_bf16 v[84:87], v[36:39], v[56:59], 0
ds_read_b128 v[152:155], v129 offset:4096
v_mfma_f32_16x16x32_bf16 v[116:119], v[36:39], v[60:63], 0
ds_read_b128 v[156:159], v129 offset:6144
s_waitcnt lgkmcnt(9)
v_mfma_f32_16x16x32_bf16 v[72:75], v[40:43], v[48:51], 0
v_lshlrev_b32 v248, 16, v248
v_lshlrev_b32 v249, 16, v249
v_mfma_f32_16x16x32_bf16 v[104:107], v[40:43], v[52:55], 0
v_lshlrev_b32 v250, 16, v250
v_mul_f32 v250, 0x3fb8aa3b, v250
v_mfma_f32_16x16x32_bf16 v[88:91], v[40:43], v[56:59], 0
v_exp_f32 v250, v250
s_nop 0
v_cvt_pk_bf16_f32 v250, v250, v250
v_mfma_f32_16x16x32_bf16 v[120:123], v[40:43], v[60:63], 0
v_lshlrev_b32 v250, 16, v250
v_mul_f32 v204, v250, v248
s_waitcnt lgkmcnt(8)
v_mfma_f32_16x16x32_bf16 v[76:79], v[44:47], v[48:51], 0
v_mul_f32 v206, v250, v249
v_mul_f32 v204, 0x3fb8aa3b, v204
v_mfma_f32_16x16x32_bf16 v[108:111], v[44:47], v[52:55], 0
v_mul_f32 v206, 0.15915494, v206
v_mul_f32 v197, 0x3f800000, v204
v_mfma_f32_16x16x32_bf16 v[92:95], v[44:47], v[56:59], 0
v_mul_f32 v198, 0x3f800000, v206
v_exp_f32 v197, v197
v_mfma_f32_16x16x32_bf16 v[124:127], v[44:47], v[60:63], 0
v_rndne_f32 v199, v198
v_sub_f32 v198, v198, v199
s_waitcnt vmcnt(0) lgkmcnt(0)
s_barrier
v_mfma_f32_16x16x32_bf16 v[64:67], v[144:147], v[160:163], v[64:67]
ds_read_b128 v[32:35], v128 offset:32768
v_mfma_f32_16x16x32_bf16 v[96:99], v[144:147], v[164:167], v[96:99]
ds_read_b128 v[48:51], v130 offset:32768
v_mfma_f32_16x16x32_bf16 v[80:83], v[144:147], v[168:171], v[80:83]
ds_read_b128 v[52:55], v130 offset:34816
v_mfma_f32_16x16x32_bf16 v[112:115], v[144:147], v[172:175], v[112:115]
ds_read_b128 v[56:59], v130 offset:36864
v_mfma_f32_16x16x32_bf16 v[68:71], v[148:151], v[160:163], v[68:71]
ds_read_b128 v[60:63], v130 offset:38912
v_mfma_f32_16x16x32_bf16 v[100:103], v[148:151], v[164:167], v[100:103]
ds_read_b128 v[36:39], v128 offset:34816
v_mfma_f32_16x16x32_bf16 v[84:87], v[148:151], v[168:171], v[84:87]
ds_read_b128 v[40:43], v128 offset:36864
v_mfma_f32_16x16x32_bf16 v[116:119], v[148:151], v[172:175], v[116:119]
ds_read_b128 v[44:47], v128 offset:38912
v_mfma_f32_16x16x32_bf16 v[72:75], v[152:155], v[160:163], v[72:75]
v_cos_f32 v199, v198
v_sin_f32 v198, v198
v_mfma_f32_16x16x32_bf16 v[104:107], v[152:155], v[164:167], v[104:107]
v_mul_f32 v20, v197, v199
v_mul_f32 v21, v197, v198
v_mfma_f32_16x16x32_bf16 v[88:91], v[152:155], v[168:171], v[88:91]
v_add_f32 v197, -1.0, v20
v_mul_f32 v198, v248, v248
v_mfma_f32_16x16x32_bf16 v[120:123], v[152:155], v[172:175], v[120:123]
v_fma_f32 v198, v249, v249, v198
v_rcp_f32 v198, v198
v_mfma_f32_16x16x32_bf16 v[76:79], v[156:159], v[160:163], v[76:79]
v_add_f32 v198, v198, v198
v_mul_f32 v199, v197, v248
v_mfma_f32_16x16x32_bf16 v[108:111], v[156:159], v[164:167], v[108:111]
v_fma_f32 v199, v21, v249, v199
v_mul_f32 v24, v199, v198
v_mfma_f32_16x16x32_bf16 v[92:95], v[156:159], v[168:171], v[92:95]
v_mul_f32 v199, v21, v248
v_fma_f32 v199, -v197, v249, v199
v_mfma_f32_16x16x32_bf16 v[124:127], v[156:159], v[172:175], v[124:127]
v_mul_f32 v25, v199, v198
v_mul_f32 v197, 0x41000000, v204
s_waitcnt lgkmcnt(6)
v_mfma_f32_16x16x32_bf16 v[64:67], v[32:35], v[48:51], v[64:67]
ds_read_b128 v[144:147], v129 offset:32768
s_waitcnt lgkmcnt(6)
v_mfma_f32_16x16x32_bf16 v[96:99], v[32:35], v[52:55], v[96:99]
ds_read_b128 v[160:163], v131 offset:32768
s_waitcnt lgkmcnt(6)
v_mfma_f32_16x16x32_bf16 v[80:83], v[32:35], v[56:59], v[80:83]
ds_read_b128 v[164:167], v131 offset:34816
s_waitcnt lgkmcnt(6)
v_mfma_f32_16x16x32_bf16 v[112:115], v[32:35], v[60:63], v[112:115]
ds_read_b128 v[168:171], v131 offset:36864
s_waitcnt lgkmcnt(6)
v_mfma_f32_16x16x32_bf16 v[68:71], v[36:39], v[48:51], v[68:71]
ds_read_b128 v[172:175], v131 offset:38912
v_mfma_f32_16x16x32_bf16 v[100:103], v[36:39], v[52:55], v[100:103]
ds_read_b128 v[148:151], v129 offset:34816
v_mfma_f32_16x16x32_bf16 v[84:87], v[36:39], v[56:59], v[84:87]
ds_read_b128 v[152:155], v129 offset:36864
v_mfma_f32_16x16x32_bf16 v[116:119], v[36:39], v[60:63], v[116:119]
ds_read_b128 v[156:159], v129 offset:38912
s_waitcnt lgkmcnt(9)
v_mfma_f32_16x16x32_bf16 v[72:75], v[40:43], v[48:51], v[72:75]
v_mul_f32 v198, 0x41000000, v206
v_exp_f32 v197, v197
v_mfma_f32_16x16x32_bf16 v[104:107], v[40:43], v[52:55], v[104:107]
v_rndne_f32 v199, v198
v_sub_f32 v198, v198, v199
v_mfma_f32_16x16x32_bf16 v[88:91], v[40:43], v[56:59], v[88:91]
v_cos_f32 v199, v198
v_sin_f32 v198, v198
v_mfma_f32_16x16x32_bf16 v[120:123], v[40:43], v[60:63], v[120:123]
v_mul_f32 v176, v197, v199
v_mul_f32 v177, v197, v198
s_waitcnt lgkmcnt(8)
v_mfma_f32_16x16x32_bf16 v[76:79], v[44:47], v[48:51], v[76:79]
v_mul_f32 v197, 0x41800000, v204
v_mul_f32 v198, 0x41800000, v206
v_mfma_f32_16x16x32_bf16 v[108:111], v[44:47], v[52:55], v[108:111]
v_exp_f32 v197, v197
v_rndne_f32 v199, v198
v_mfma_f32_16x16x32_bf16 v[92:95], v[44:47], v[56:59], v[92:95]
v_sub_f32 v198, v198, v199
v_cos_f32 v199, v198
v_mfma_f32_16x16x32_bf16 v[124:127], v[44:47], v[60:63], v[124:127]
v_sin_f32 v198, v198
v_mul_f32 v180, v197, v199
s_waitcnt lgkmcnt(0)
s_barrier
v_mfma_f32_16x16x32_bf16 v[64:67], v[144:147], v[160:163], v[64:67]
ds_read_b128 v[32:35], v132 offset:0
v_mfma_f32_16x16x32_bf16 v[96:99], v[144:147], v[164:167], v[96:99]
ds_read_b128 v[48:51], v134 offset:0
v_mfma_f32_16x16x32_bf16 v[80:83], v[144:147], v[168:171], v[80:83]
ds_read_b128 v[52:55], v134 offset:2048
v_mfma_f32_16x16x32_bf16 v[112:115], v[144:147], v[172:175], v[112:115]
ds_read_b128 v[56:59], v134 offset:4096
v_mfma_f32_16x16x32_bf16 v[68:71], v[148:151], v[160:163], v[68:71]
ds_read_b128 v[60:63], v134 offset:6144
v_mfma_f32_16x16x32_bf16 v[100:103], v[148:151], v[164:167], v[100:103]
ds_read_b128 v[36:39], v132 offset:2048
v_mfma_f32_16x16x32_bf16 v[84:87], v[148:151], v[168:171], v[84:87]
ds_read_b128 v[40:43], v132 offset:4096
v_mfma_f32_16x16x32_bf16 v[116:119], v[148:151], v[172:175], v[116:119]
ds_read_b128 v[44:47], v132 offset:6144
v_mfma_f32_16x16x32_bf16 v[72:75], v[152:155], v[160:163], v[72:75]
v_mul_f32 v181, v197, v198
v_mul_f32 v197, v9, v204
v_mfma_f32_16x16x32_bf16 v[104:107], v[152:155], v[164:167], v[104:107]
v_mul_f32 v198, v9, v206
v_exp_f32 v197, v197
v_mfma_f32_16x16x32_bf16 v[88:91], v[152:155], v[168:171], v[88:91]
v_rndne_f32 v199, v198
v_sub_f32 v198, v198, v199
v_mfma_f32_16x16x32_bf16 v[120:123], v[152:155], v[172:175], v[120:123]
v_cos_f32 v199, v198
v_sin_f32 v198, v198
v_mfma_f32_16x16x32_bf16 v[76:79], v[156:159], v[160:163], v[76:79]
v_mul_f32 v200, v197, v199
v_mul_f32 v201, v197, v198
v_mfma_f32_16x16x32_bf16 v[108:111], v[156:159], v[164:167], v[108:111]
v_mov_b32 v184, v200
v_mov_b32 v186, v201
v_mfma_f32_16x16x32_bf16 v[92:95], v[156:159], v[168:171], v[92:95]
v_mul_f32 v197, v8, v204
v_mul_f32 v198, v8, v206
v_mfma_f32_16x16x32_bf16 v[124:127], v[156:159], v[172:175], v[124:127]
v_exp_f32 v197, v197
v_rndne_f32 v199, v198
s_waitcnt lgkmcnt(6)
v_mfma_f32_16x16x32_bf16 v[64:67], v[32:35], v[48:51], v[64:67]
ds_read_b128 v[144:147], v133 offset:0
s_waitcnt lgkmcnt(6)
v_mfma_f32_16x16x32_bf16 v[96:99], v[32:35], v[52:55], v[96:99]
ds_read_b128 v[160:163], v135 offset:0
s_waitcnt lgkmcnt(6)
v_mfma_f32_16x16x32_bf16 v[80:83], v[32:35], v[56:59], v[80:83]
ds_read_b128 v[164:167], v135 offset:2048
s_waitcnt lgkmcnt(6)
v_mfma_f32_16x16x32_bf16 v[112:115], v[32:35], v[60:63], v[112:115]
ds_read_b128 v[168:171], v135 offset:4096
s_waitcnt lgkmcnt(6)
v_mfma_f32_16x16x32_bf16 v[68:71], v[36:39], v[48:51], v[68:71]
ds_read_b128 v[172:175], v135 offset:6144
v_mfma_f32_16x16x32_bf16 v[100:103], v[36:39], v[52:55], v[100:103]
ds_read_b128 v[148:151], v133 offset:2048
v_mfma_f32_16x16x32_bf16 v[84:87], v[36:39], v[56:59], v[84:87]
ds_read_b128 v[152:155], v133 offset:4096
v_mfma_f32_16x16x32_bf16 v[116:119], v[36:39], v[60:63], v[116:119]
ds_read_b128 v[156:159], v133 offset:6144
s_waitcnt lgkmcnt(9)
v_mfma_f32_16x16x32_bf16 v[72:75], v[40:43], v[48:51], v[72:75]
v_sub_f32 v198, v198, v199
v_cos_f32 v199, v198
v_mfma_f32_16x16x32_bf16 v[104:107], v[40:43], v[52:55], v[104:107]
v_sin_f32 v198, v198
v_mul_f32 v200, v197, v199
v_mfma_f32_16x16x32_bf16 v[88:91], v[40:43], v[56:59], v[88:91]
v_mul_f32 v201, v197, v198
v_mov_b32 v185, v200
v_mfma_f32_16x16x32_bf16 v[120:123], v[40:43], v[60:63], v[120:123]
v_mov_b32 v187, v201
v_mul_f32 v197, v25, v21
s_waitcnt lgkmcnt(8)
v_mfma_f32_16x16x32_bf16 v[76:79], v[44:47], v[48:51], v[76:79]
v_mul_f32 v198, v25, v20
v_fma_f32 v208, v24, v20, -v197
v_mfma_f32_16x16x32_bf16 v[108:111], v[44:47], v[52:55], v[108:111]
v_fma_f32 v209, v24, v21, v198
v_mul_f32 v197, v209, v21
v_mfma_f32_16x16x32_bf16 v[92:95], v[44:47], v[56:59], v[92:95]
v_mul_f32 v198, v209, v20
v_fma_f32 v210, v208, v20, -v197
v_mfma_f32_16x16x32_bf16 v[124:127], v[44:47], v[60:63], v[124:127]
v_fma_f32 v211, v208, v21, v198
v_mul_f32 v197, v211, v21
s_waitcnt lgkmcnt(0)
s_barrier
v_mfma_f32_16x16x32_bf16 v[64:67], v[144:147], v[160:163], v[64:67]
ds_read_b128 v[32:35], v128 offset:0
v_mfma_f32_16x16x32_bf16 v[96:99], v[144:147], v[164:167], v[96:99]
ds_read_b128 v[48:51], v130 offset:0
v_mfma_f32_16x16x32_bf16 v[80:83], v[144:147], v[168:171], v[80:83]
ds_read_b128 v[52:55], v130 offset:2048
v_mfma_f32_16x16x32_bf16 v[112:115], v[144:147], v[172:175], v[112:115]
ds_read_b128 v[56:59], v130 offset:4096
v_mfma_f32_16x16x32_bf16 v[68:71], v[148:151], v[160:163], v[68:71]
ds_read_b128 v[60:63], v130 offset:6144
v_mfma_f32_16x16x32_bf16 v[100:103], v[148:151], v[164:167], v[100:103]
ds_read_b128 v[36:39], v128 offset:2048
v_mfma_f32_16x16x32_bf16 v[84:87], v[148:151], v[168:171], v[84:87]
ds_read_b128 v[40:43], v128 offset:4096
v_mfma_f32_16x16x32_bf16 v[116:119], v[148:151], v[172:175], v[116:119]
ds_read_b128 v[44:47], v128 offset:6144
v_mfma_f32_16x16x32_bf16 v[72:75], v[152:155], v[160:163], v[72:75]
v_mul_f32 v198, v211, v20
v_fma_f32 v212, v210, v20, -v197
v_mfma_f32_16x16x32_bf16 v[104:107], v[152:155], v[164:167], v[104:107]
v_fma_f32 v213, v210, v21, v198
v_mul_f32 v197, v213, v21
v_mfma_f32_16x16x32_bf16 v[88:91], v[152:155], v[168:171], v[88:91]
v_mul_f32 v198, v213, v20
v_fma_f32 v214, v212, v20, -v197
v_mfma_f32_16x16x32_bf16 v[120:123], v[152:155], v[172:175], v[120:123]
v_fma_f32 v215, v212, v21, v198
v_mul_f32 v197, v215, v21
v_mfma_f32_16x16x32_bf16 v[76:79], v[156:159], v[160:163], v[76:79]
v_mul_f32 v198, v215, v20
v_fma_f32 v216, v214, v20, -v197
v_mfma_f32_16x16x32_bf16 v[108:111], v[156:159], v[164:167], v[108:111]
v_fma_f32 v217, v214, v21, v198
v_mul_f32 v197, v217, v21
v_mfma_f32_16x16x32_bf16 v[92:95], v[156:159], v[168:171], v[92:95]
v_mul_f32 v198, v217, v20
v_fma_f32 v218, v216, v20, -v197
v_mfma_f32_16x16x32_bf16 v[124:127], v[156:159], v[172:175], v[124:127]
v_fma_f32 v219, v216, v21, v198
v_mul_f32 v197, v219, v21
s_waitcnt lgkmcnt(6)
v_mfma_f32_16x16x32_bf16 v[64:67], v[32:35], v[48:51], v[64:67]
ds_read_b128 v[144:147], v129 offset:0
s_waitcnt lgkmcnt(6)
v_mfma_f32_16x16x32_bf16 v[96:99], v[32:35], v[52:55], v[96:99]
ds_read_b128 v[160:163], v131 offset:0
s_waitcnt lgkmcnt(6)
v_mfma_f32_16x16x32_bf16 v[80:83], v[32:35], v[56:59], v[80:83]
ds_read_b128 v[164:167], v131 offset:2048
s_waitcnt lgkmcnt(6)
v_mfma_f32_16x16x32_bf16 v[112:115], v[32:35], v[60:63], v[112:115]
ds_read_b128 v[168:171], v131 offset:4096
s_waitcnt lgkmcnt(6)
v_mfma_f32_16x16x32_bf16 v[68:71], v[36:39], v[48:51], v[68:71]
ds_read_b128 v[172:175], v131 offset:6144
v_mfma_f32_16x16x32_bf16 v[100:103], v[36:39], v[52:55], v[100:103]
ds_read_b128 v[148:151], v129 offset:2048
v_mfma_f32_16x16x32_bf16 v[84:87], v[36:39], v[56:59], v[84:87]
ds_read_b128 v[152:155], v129 offset:4096
v_mfma_f32_16x16x32_bf16 v[116:119], v[36:39], v[60:63], v[116:119]
ds_read_b128 v[156:159], v129 offset:6144
s_waitcnt lgkmcnt(9)
v_mfma_f32_16x16x32_bf16 v[72:75], v[40:43], v[48:51], v[72:75]
v_mul_f32 v198, v219, v20
v_fma_f32 v220, v218, v20, -v197
v_mfma_f32_16x16x32_bf16 v[104:107], v[40:43], v[52:55], v[104:107]
v_fma_f32 v221, v218, v21, v198
v_mul_f32 v197, v221, v21
v_mfma_f32_16x16x32_bf16 v[88:91], v[40:43], v[56:59], v[88:91]
v_mul_f32 v198, v221, v20
v_fma_f32 v222, v220, v20, -v197
v_mfma_f32_16x16x32_bf16 v[120:123], v[40:43], v[60:63], v[120:123]
v_fma_f32 v223, v220, v21, v198
v_lshlrev_b32 v251, 16, v251
s_waitcnt lgkmcnt(8)
v_mfma_f32_16x16x32_bf16 v[76:79], v[44:47], v[48:51], v[76:79]
v_lshlrev_b32 v252, 16, v252
v_lshlrev_b32 v253, 16, v253
v_mfma_f32_16x16x32_bf16 v[108:111], v[44:47], v[52:55], v[108:111]
v_mul_f32 v253, 0x3fb8aa3b, v253
v_exp_f32 v253, v253
v_mfma_f32_16x16x32_bf16 v[92:95], v[44:47], v[56:59], v[92:95]
v_cvt_pk_bf16_f32 v253, v253, v253
v_lshlrev_b32 v253, 16, v253
v_mfma_f32_16x16x32_bf16 v[124:127], v[44:47], v[60:63], v[124:127]
v_mul_f32 v205, v253, v251
v_mul_f32 v207, v253, v252
s_waitcnt lgkmcnt(0)
s_barrier
v_mfma_f32_16x16x32_bf16 v[64:67], v[144:147], v[160:163], v[64:67]
ds_read_b128 v[32:35], v128 offset:32768
v_mfma_f32_16x16x32_bf16 v[96:99], v[144:147], v[164:167], v[96:99]
ds_read_b128 v[48:51], v130 offset:32768
v_mfma_f32_16x16x32_bf16 v[80:83], v[144:147], v[168:171], v[80:83]
ds_read_b128 v[52:55], v130 offset:34816
v_mfma_f32_16x16x32_bf16 v[112:115], v[144:147], v[172:175], v[112:115]
ds_read_b128 v[56:59], v130 offset:36864
v_mfma_f32_16x16x32_bf16 v[68:71], v[148:151], v[160:163], v[68:71]
ds_read_b128 v[60:63], v130 offset:38912
v_mfma_f32_16x16x32_bf16 v[100:103], v[148:151], v[164:167], v[100:103]
ds_read_b128 v[36:39], v128 offset:34816
v_mfma_f32_16x16x32_bf16 v[84:87], v[148:151], v[168:171], v[84:87]
ds_read_b128 v[40:43], v128 offset:36864
v_mfma_f32_16x16x32_bf16 v[116:119], v[148:151], v[172:175], v[116:119]
ds_read_b128 v[44:47], v128 offset:38912
v_mfma_f32_16x16x32_bf16 v[72:75], v[152:155], v[160:163], v[72:75]
v_mul_f32 v205, 0x3fb8aa3b, v205
v_mul_f32 v207, 0.15915494, v207
v_mfma_f32_16x16x32_bf16 v[104:107], v[152:155], v[164:167], v[104:107]
v_mul_f32 v197, 0x3f800000, v205
v_mul_f32 v198, 0x3f800000, v207
v_mfma_f32_16x16x32_bf16 v[88:91], v[152:155], v[168:171], v[88:91]
v_exp_f32 v197, v197
v_rndne_f32 v199, v198
v_mfma_f32_16x16x32_bf16 v[120:123], v[152:155], v[172:175], v[120:123]
v_sub_f32 v198, v198, v199
v_cos_f32 v199, v198
v_mfma_f32_16x16x32_bf16 v[76:79], v[156:159], v[160:163], v[76:79]
v_sin_f32 v198, v198
v_mul_f32 v22, v197, v199
v_mfma_f32_16x16x32_bf16 v[108:111], v[156:159], v[164:167], v[108:111]
v_mul_f32 v23, v197, v198
v_add_f32 v197, -1.0, v22
v_mfma_f32_16x16x32_bf16 v[92:95], v[156:159], v[168:171], v[92:95]
v_mul_f32 v198, v251, v251
v_fma_f32 v198, v252, v252, v198
v_mfma_f32_16x16x32_bf16 v[124:127], v[156:159], v[172:175], v[124:127]
v_rcp_f32 v198, v198
s_nop 0
v_add_f32 v198, v198, v198
s_waitcnt lgkmcnt(6)
v_mfma_f32_16x16x32_bf16 v[64:67], v[32:35], v[48:51], v[64:67]
ds_read_b128 v[144:147], v129 offset:32768
s_waitcnt lgkmcnt(6)
v_mfma_f32_16x16x32_bf16 v[96:99], v[32:35], v[52:55], v[96:99]
ds_read_b128 v[160:163], v131 offset:32768
s_waitcnt lgkmcnt(6)
v_mfma_f32_16x16x32_bf16 v[80:83], v[32:35], v[56:59], v[80:83]
ds_read_b128 v[164:167], v131 offset:34816
s_waitcnt lgkmcnt(6)
v_mfma_f32_16x16x32_bf16 v[112:115], v[32:35], v[60:63], v[112:115]
ds_read_b128 v[168:171], v131 offset:36864
s_waitcnt lgkmcnt(6)
v_mfma_f32_16x16x32_bf16 v[68:71], v[36:39], v[48:51], v[68:71]
ds_read_b128 v[172:175], v131 offset:38912
v_mfma_f32_16x16x32_bf16 v[100:103], v[36:39], v[52:55], v[100:103]
ds_read_b128 v[148:151], v129 offset:34816
v_mfma_f32_16x16x32_bf16 v[84:87], v[36:39], v[56:59], v[84:87]
ds_read_b128 v[152:155], v129 offset:36864
v_mfma_f32_16x16x32_bf16 v[116:119], v[36:39], v[60:63], v[116:119]
ds_read_b128 v[156:159], v129 offset:38912
s_waitcnt lgkmcnt(9)
v_mfma_f32_16x16x32_bf16 v[72:75], v[40:43], v[48:51], v[72:75]
v_mul_f32 v199, v197, v251
v_fma_f32 v199, v23, v252, v199
v_mfma_f32_16x16x32_bf16 v[104:107], v[40:43], v[52:55], v[104:107]
v_mul_f32 v26, v199, v198
v_mul_f32 v199, v23, v251
v_mfma_f32_16x16x32_bf16 v[88:91], v[40:43], v[56:59], v[88:91]
v_fma_f32 v199, -v197, v252, v199
v_mul_f32 v27, v199, v198
v_mfma_f32_16x16x32_bf16 v[120:123], v[40:43], v[60:63], v[120:123]
v_mul_f32 v197, 0x41000000, v205
v_mul_f32 v198, 0x41000000, v207
s_waitcnt lgkmcnt(8)
v_mfma_f32_16x16x32_bf16 v[76:79], v[44:47], v[48:51], v[76:79]
v_exp_f32 v197, v197
v_rndne_f32 v199, v198
v_mfma_f32_16x16x32_bf16 v[108:111], v[44:47], v[52:55], v[108:111]
v_sub_f32 v198, v198, v199
v_cos_f32 v199, v198
v_mfma_f32_16x16x32_bf16 v[92:95], v[44:47], v[56:59], v[92:95]
v_sin_f32 v198, v198
v_mul_f32 v178, v197, v199
v_mfma_f32_16x16x32_bf16 v[124:127], v[44:47], v[60:63], v[124:127]
v_mul_f32 v179, v197, v198
v_mul_f32 v197, 0x41800000, v205
s_waitcnt lgkmcnt(0)
s_barrier
v_mfma_f32_16x16x32_bf16 v[64:67], v[144:147], v[160:163], v[64:67]
ds_read_b128 v[32:35], v132 offset:0
v_mfma_f32_16x16x32_bf16 v[96:99], v[144:147], v[164:167], v[96:99]
ds_read_b128 v[48:51], v134 offset:0
v_mfma_f32_16x16x32_bf16 v[80:83], v[144:147], v[168:171], v[80:83]
ds_read_b128 v[52:55], v134 offset:2048
v_mfma_f32_16x16x32_bf16 v[112:115], v[144:147], v[172:175], v[112:115]
ds_read_b128 v[56:59], v134 offset:4096
v_mfma_f32_16x16x32_bf16 v[68:71], v[148:151], v[160:163], v[68:71]
ds_read_b128 v[60:63], v134 offset:6144
v_mfma_f32_16x16x32_bf16 v[100:103], v[148:151], v[164:167], v[100:103]
ds_read_b128 v[36:39], v132 offset:2048
v_mfma_f32_16x16x32_bf16 v[84:87], v[148:151], v[168:171], v[84:87]
ds_read_b128 v[40:43], v132 offset:4096
v_mfma_f32_16x16x32_bf16 v[116:119], v[148:151], v[172:175], v[116:119]
ds_read_b128 v[44:47], v132 offset:6144
v_mfma_f32_16x16x32_bf16 v[72:75], v[152:155], v[160:163], v[72:75]
v_mul_f32 v198, 0x41800000, v207
v_exp_f32 v197, v197
v_mfma_f32_16x16x32_bf16 v[104:107], v[152:155], v[164:167], v[104:107]
v_rndne_f32 v199, v198
v_sub_f32 v198, v198, v199
v_mfma_f32_16x16x32_bf16 v[88:91], v[152:155], v[168:171], v[88:91]
v_cos_f32 v199, v198
v_sin_f32 v198, v198
v_mfma_f32_16x16x32_bf16 v[120:123], v[152:155], v[172:175], v[120:123]
v_mul_f32 v182, v197, v199
v_mul_f32 v183, v197, v198
v_mfma_f32_16x16x32_bf16 v[76:79], v[156:159], v[160:163], v[76:79]
v_mul_f32 v197, v9, v205
v_mul_f32 v198, v9, v207
v_mfma_f32_16x16x32_bf16 v[108:111], v[156:159], v[164:167], v[108:111]
v_exp_f32 v197, v197
v_rndne_f32 v199, v198
v_mfma_f32_16x16x32_bf16 v[92:95], v[156:159], v[168:171], v[92:95]
v_sub_f32 v198, v198, v199
v_cos_f32 v199, v198
v_mfma_f32_16x16x32_bf16 v[124:127], v[156:159], v[172:175], v[124:127]
v_sin_f32 v198, v198
v_mul_f32 v200, v197, v199
s_waitcnt lgkmcnt(6)
v_mfma_f32_16x16x32_bf16 v[64:67], v[32:35], v[48:51], v[64:67]
ds_read_b128 v[144:147], v133 offset:0
s_waitcnt lgkmcnt(6)
v_mfma_f32_16x16x32_bf16 v[96:99], v[32:35], v[52:55], v[96:99]
ds_read_b128 v[160:163], v135 offset:0
s_waitcnt lgkmcnt(6)
v_mfma_f32_16x16x32_bf16 v[80:83], v[32:35], v[56:59], v[80:83]
ds_read_b128 v[164:167], v135 offset:2048
s_waitcnt lgkmcnt(6)
v_mfma_f32_16x16x32_bf16 v[112:115], v[32:35], v[60:63], v[112:115]
ds_read_b128 v[168:171], v135 offset:4096
s_waitcnt lgkmcnt(6)
v_mfma_f32_16x16x32_bf16 v[68:71], v[36:39], v[48:51], v[68:71]
ds_read_b128 v[172:175], v135 offset:6144
v_mfma_f32_16x16x32_bf16 v[100:103], v[36:39], v[52:55], v[100:103]
ds_read_b128 v[148:151], v133 offset:2048
v_mfma_f32_16x16x32_bf16 v[84:87], v[36:39], v[56:59], v[84:87]
ds_read_b128 v[152:155], v133 offset:4096
v_mfma_f32_16x16x32_bf16 v[116:119], v[36:39], v[60:63], v[116:119]
ds_read_b128 v[156:159], v133 offset:6144
s_waitcnt lgkmcnt(9)
v_mfma_f32_16x16x32_bf16 v[72:75], v[40:43], v[48:51], v[72:75]
v_mul_f32 v201, v197, v198
v_mov_b32 v188, v200
v_mfma_f32_16x16x32_bf16 v[104:107], v[40:43], v[52:55], v[104:107]
v_mov_b32 v190, v201
v_mul_f32 v197, v8, v205
v_mfma_f32_16x16x32_bf16 v[88:91], v[40:43], v[56:59], v[88:91]
v_mul_f32 v198, v8, v207
v_exp_f32 v197, v197
v_mfma_f32_16x16x32_bf16 v[120:123], v[40:43], v[60:63], v[120:123]
v_rndne_f32 v199, v198
v_sub_f32 v198, v198, v199
s_waitcnt lgkmcnt(8)
v_mfma_f32_16x16x32_bf16 v[76:79], v[44:47], v[48:51], v[76:79]
v_cos_f32 v199, v198
v_sin_f32 v198, v198
v_mfma_f32_16x16x32_bf16 v[108:111], v[44:47], v[52:55], v[108:111]
v_mul_f32 v200, v197, v199
v_mul_f32 v201, v197, v198
v_mfma_f32_16x16x32_bf16 v[92:95], v[44:47], v[56:59], v[92:95]
v_mov_b32 v189, v200
v_mov_b32 v191, v201
v_mfma_f32_16x16x32_bf16 v[124:127], v[44:47], v[60:63], v[124:127]
v_mul_f32 v197, v27, v23
v_mul_f32 v198, v27, v22
s_waitcnt lgkmcnt(0)
s_barrier
v_mfma_f32_16x16x32_bf16 v[64:67], v[144:147], v[160:163], v[64:67]
ds_read_b128 v[32:35], v128 offset:0
v_mfma_f32_16x16x32_bf16 v[96:99], v[144:147], v[164:167], v[96:99]
ds_read_b128 v[48:51], v130 offset:0
v_mfma_f32_16x16x32_bf16 v[80:83], v[144:147], v[168:171], v[80:83]
ds_read_b128 v[52:55], v130 offset:2048
v_mfma_f32_16x16x32_bf16 v[112:115], v[144:147], v[172:175], v[112:115]
ds_read_b128 v[56:59], v130 offset:4096
v_mfma_f32_16x16x32_bf16 v[68:71], v[148:151], v[160:163], v[68:71]
ds_read_b128 v[60:63], v130 offset:6144
v_mfma_f32_16x16x32_bf16 v[100:103], v[148:151], v[164:167], v[100:103]
ds_read_b128 v[36:39], v128 offset:2048
v_mfma_f32_16x16x32_bf16 v[84:87], v[148:151], v[168:171], v[84:87]
ds_read_b128 v[40:43], v128 offset:4096
v_mfma_f32_16x16x32_bf16 v[116:119], v[148:151], v[172:175], v[116:119]
ds_read_b128 v[44:47], v128 offset:6144
v_mfma_f32_16x16x32_bf16 v[72:75], v[152:155], v[160:163], v[72:75]
v_fma_f32 v224, v26, v22, -v197
v_fma_f32 v225, v26, v23, v198
v_mfma_f32_16x16x32_bf16 v[104:107], v[152:155], v[164:167], v[104:107]
v_mul_f32 v197, v225, v23
v_mul_f32 v198, v225, v22
v_mfma_f32_16x16x32_bf16 v[88:91], v[152:155], v[168:171], v[88:91]
v_fma_f32 v226, v224, v22, -v197
v_fma_f32 v227, v224, v23, v198
v_mfma_f32_16x16x32_bf16 v[120:123], v[152:155], v[172:175], v[120:123]
v_mul_f32 v197, v227, v23
v_mul_f32 v198, v227, v22
v_mfma_f32_16x16x32_bf16 v[76:79], v[156:159], v[160:163], v[76:79]
v_fma_f32 v228, v226, v22, -v197
v_fma_f32 v229, v226, v23, v198
v_mfma_f32_16x16x32_bf16 v[108:111], v[156:159], v[164:167], v[108:111]
v_mul_f32 v197, v229, v23
v_mul_f32 v198, v229, v22
v_mfma_f32_16x16x32_bf16 v[92:95], v[156:159], v[168:171], v[92:95]
v_fma_f32 v230, v228, v22, -v197
v_fma_f32 v231, v228, v23, v198
v_mfma_f32_16x16x32_bf16 v[124:127], v[156:159], v[172:175], v[124:127]
v_mul_f32 v197, v231, v23
v_mul_f32 v198, v231, v22
s_waitcnt lgkmcnt(6)
v_mfma_f32_16x16x32_bf16 v[64:67], v[32:35], v[48:51], v[64:67]
ds_read_b128 v[144:147], v129 offset:0
s_waitcnt lgkmcnt(6)
v_mfma_f32_16x16x32_bf16 v[96:99], v[32:35], v[52:55], v[96:99]
ds_read_b128 v[160:163], v131 offset:0
s_waitcnt lgkmcnt(6)
v_mfma_f32_16x16x32_bf16 v[80:83], v[32:35], v[56:59], v[80:83]
ds_read_b128 v[164:167], v131 offset:2048
s_waitcnt lgkmcnt(6)
v_mfma_f32_16x16x32_bf16 v[112:115], v[32:35], v[60:63], v[112:115]
ds_read_b128 v[168:171], v131 offset:4096
s_waitcnt lgkmcnt(6)
v_mfma_f32_16x16x32_bf16 v[68:71], v[36:39], v[48:51], v[68:71]
ds_read_b128 v[172:175], v131 offset:6144
v_mfma_f32_16x16x32_bf16 v[100:103], v[36:39], v[52:55], v[100:103]
ds_read_b128 v[148:151], v129 offset:2048
v_mfma_f32_16x16x32_bf16 v[84:87], v[36:39], v[56:59], v[84:87]
ds_read_b128 v[152:155], v129 offset:4096
v_mfma_f32_16x16x32_bf16 v[116:119], v[36:39], v[60:63], v[116:119]
ds_read_b128 v[156:159], v129 offset:6144
s_waitcnt lgkmcnt(9)
v_mfma_f32_16x16x32_bf16 v[72:75], v[40:43], v[48:51], v[72:75]
v_fma_f32 v232, v230, v22, -v197
v_fma_f32 v233, v230, v23, v198
v_mfma_f32_16x16x32_bf16 v[104:107], v[40:43], v[52:55], v[104:107]
v_mul_f32 v197, v233, v23
v_mul_f32 v198, v233, v22
v_mfma_f32_16x16x32_bf16 v[88:91], v[40:43], v[56:59], v[88:91]
v_fma_f32 v234, v232, v22, -v197
v_fma_f32 v235, v232, v23, v198
v_mfma_f32_16x16x32_bf16 v[120:123], v[40:43], v[60:63], v[120:123]
v_mul_f32 v197, v235, v23
v_mul_f32 v198, v235, v22
s_waitcnt lgkmcnt(8)
v_mfma_f32_16x16x32_bf16 v[76:79], v[44:47], v[48:51], v[76:79]
v_fma_f32 v236, v234, v22, -v197
v_fma_f32 v237, v234, v23, v198
v_mfma_f32_16x16x32_bf16 v[108:111], v[44:47], v[52:55], v[108:111]
v_mul_f32 v197, v237, v23
v_mul_f32 v198, v237, v22
v_mfma_f32_16x16x32_bf16 v[92:95], v[44:47], v[56:59], v[92:95]
v_fma_f32 v238, v236, v22, -v197
v_fma_f32 v239, v236, v23, v198
v_mfma_f32_16x16x32_bf16 v[124:127], v[44:47], v[60:63], v[124:127]
v_and_b32 v197, 16, v1
v_cmp_ne_u32 vcc, 0, v197
s_waitcnt lgkmcnt(0)
s_barrier
v_mfma_f32_16x16x32_bf16 v[64:67], v[144:147], v[160:163], v[64:67]
ds_read_b128 v[32:35], v128 offset:32768
v_mfma_f32_16x16x32_bf16 v[96:99], v[144:147], v[164:167], v[96:99]
ds_read_b128 v[48:51], v130 offset:32768
v_mfma_f32_16x16x32_bf16 v[80:83], v[144:147], v[168:171], v[80:83]
ds_read_b128 v[52:55], v130 offset:34816
v_mfma_f32_16x16x32_bf16 v[112:115], v[144:147], v[172:175], v[112:115]
ds_read_b128 v[56:59], v130 offset:36864
v_mfma_f32_16x16x32_bf16 v[68:71], v[148:151], v[160:163], v[68:71]
ds_read_b128 v[60:63], v130 offset:38912
v_mfma_f32_16x16x32_bf16 v[100:103], v[148:151], v[164:167], v[100:103]
ds_read_b128 v[36:39], v128 offset:34816
v_mfma_f32_16x16x32_bf16 v[84:87], v[148:151], v[168:171], v[84:87]
ds_read_b128 v[40:43], v128 offset:36864
v_mfma_f32_16x16x32_bf16 v[116:119], v[148:151], v[172:175], v[116:119]
ds_read_b128 v[44:47], v128 offset:38912
v_mfma_f32_16x16x32_bf16 v[72:75], v[152:155], v[160:163], v[72:75]
v_cndmask_b32 v204, v204, v205, vcc
v_cndmask_b32 v206, v206, v207, vcc
v_mfma_f32_16x16x32_bf16 v[104:107], v[152:155], v[164:167], v[104:107]
v_mul_f32 v197, 0x41800000, v204
v_mul_f32 v198, 0x41800000, v206
v_mfma_f32_16x16x32_bf16 v[88:91], v[152:155], v[168:171], v[88:91]
v_exp_f32 v197, v197
v_rndne_f32 v199, v198
v_mfma_f32_16x16x32_bf16 v[120:123], v[152:155], v[172:175], v[120:123]
v_sub_f32 v198, v198, v199
v_cos_f32 v199, v198
v_mfma_f32_16x16x32_bf16 v[76:79], v[156:159], v[160:163], v[76:79]
v_sin_f32 v198, v198
v_mul_f32 v28, v197, v199
v_mfma_f32_16x16x32_bf16 v[108:111], v[156:159], v[164:167], v[108:111]
v_mul_f32 v29, v197, v198
v_mul_f32 v197, 0x42800000, v204
v_mfma_f32_16x16x32_bf16 v[92:95], v[156:159], v[168:171], v[92:95]
v_mul_f32 v198, 0x42800000, v206
v_exp_f32 v197, v197
v_mfma_f32_16x16x32_bf16 v[124:127], v[156:159], v[172:175], v[124:127]
v_rndne_f32 v199, v198
v_sub_f32 v198, v198, v199
s_waitcnt lgkmcnt(6)
v_mfma_f32_16x16x32_bf16 v[64:67], v[32:35], v[48:51], v[64:67]
ds_read_b128 v[144:147], v129 offset:32768
s_waitcnt lgkmcnt(6)
v_mfma_f32_16x16x32_bf16 v[96:99], v[32:35], v[52:55], v[96:99]
ds_read_b128 v[160:163], v131 offset:32768
s_waitcnt lgkmcnt(6)
v_mfma_f32_16x16x32_bf16 v[80:83], v[32:35], v[56:59], v[80:83]
ds_read_b128 v[164:167], v131 offset:34816
s_waitcnt lgkmcnt(6)
v_mfma_f32_16x16x32_bf16 v[112:115], v[32:35], v[60:63], v[112:115]
ds_read_b128 v[168:171], v131 offset:36864
s_waitcnt lgkmcnt(6)
v_mfma_f32_16x16x32_bf16 v[68:71], v[36:39], v[48:51], v[68:71]
ds_read_b128 v[172:175], v131 offset:38912
v_mfma_f32_16x16x32_bf16 v[100:103], v[36:39], v[52:55], v[100:103]
ds_read_b128 v[148:151], v129 offset:34816
v_mfma_f32_16x16x32_bf16 v[84:87], v[36:39], v[56:59], v[84:87]
ds_read_b128 v[152:155], v129 offset:36864
v_mfma_f32_16x16x32_bf16 v[116:119], v[36:39], v[60:63], v[116:119]
ds_read_b128 v[156:159], v129 offset:38912
s_waitcnt lgkmcnt(9)
v_mfma_f32_16x16x32_bf16 v[72:75], v[40:43], v[48:51], v[72:75]
v_cos_f32 v199, v198
v_sin_f32 v198, v198
v_mfma_f32_16x16x32_bf16 v[104:107], v[40:43], v[52:55], v[104:107]
v_mul_f32 v192, v197, v199
v_mul_f32 v193, v197, v198
v_mfma_f32_16x16x32_bf16 v[88:91], v[40:43], v[56:59], v[88:91]
v_mul_f32 v197, 0x43000000, v204
v_mul_f32 v198, 0x43000000, v206
v_mfma_f32_16x16x32_bf16 v[120:123], v[40:43], v[60:63], v[120:123]
v_exp_f32 v197, v197
v_rndne_f32 v199, v198
s_waitcnt lgkmcnt(8)
v_mfma_f32_16x16x32_bf16 v[76:79], v[44:47], v[48:51], v[76:79]
v_sub_f32 v198, v198, v199
v_cos_f32 v199, v198
v_mfma_f32_16x16x32_bf16 v[108:111], v[44:47], v[52:55], v[108:111]
v_sin_f32 v198, v198
v_mul_f32 v30, v197, v199
v_mfma_f32_16x16x32_bf16 v[92:95], v[44:47], v[56:59], v[92:95]
v_mul_f32 v31, v197, v198
v_mul_f32 v197, 0x43800000, v204
v_mfma_f32_16x16x32_bf16 v[124:127], v[44:47], v[60:63], v[124:127]
v_mul_f32 v198, 0x43800000, v206
v_exp_f32 v197, v197
s_waitcnt lgkmcnt(0)
s_barrier
v_mfma_f32_16x16x32_bf16 v[64:67], v[144:147], v[160:163], v[64:67]
ds_read_b128 v[32:35], v132 offset:0
v_mfma_f32_16x16x32_bf16 v[96:99], v[144:147], v[164:167], v[96:99]
ds_read_b128 v[48:51], v134 offset:0
v_mfma_f32_16x16x32_bf16 v[80:83], v[144:147], v[168:171], v[80:83]
ds_read_b128 v[52:55], v134 offset:2048
v_mfma_f32_16x16x32_bf16 v[112:115], v[144:147], v[172:175], v[112:115]
ds_read_b128 v[56:59], v134 offset:4096
v_mfma_f32_16x16x32_bf16 v[68:71], v[148:151], v[160:163], v[68:71]
ds_read_b128 v[60:63], v134 offset:6144
v_mfma_f32_16x16x32_bf16 v[100:103], v[148:151], v[164:167], v[100:103]
ds_read_b128 v[36:39], v132 offset:2048
v_mfma_f32_16x16x32_bf16 v[84:87], v[148:151], v[168:171], v[84:87]
ds_read_b128 v[40:43], v132 offset:4096
v_mfma_f32_16x16x32_bf16 v[116:119], v[148:151], v[172:175], v[116:119]
ds_read_b128 v[44:47], v132 offset:6144
v_mfma_f32_16x16x32_bf16 v[72:75], v[152:155], v[160:163], v[72:75]
v_rndne_f32 v199, v198
v_sub_f32 v198, v198, v199
v_mfma_f32_16x16x32_bf16 v[104:107], v[152:155], v[164:167], v[104:107]
v_cos_f32 v199, v198
v_sin_f32 v198, v198
v_mfma_f32_16x16x32_bf16 v[88:91], v[152:155], v[168:171], v[88:91]
v_mul_f32 v2, v197, v199
v_mul_f32 v3, v197, v198
v_mfma_f32_16x16x32_bf16 v[120:123], v[152:155], v[172:175], v[120:123]
v_lshrrev_b32 v197, 4, v1
v_lshlrev_b32 v197, 2, v197
v_mfma_f32_16x16x32_bf16 v[76:79], v[156:159], v[160:163], v[76:79]
v_and_b32 v198, 15, v1
v_sub_u32 v197, v198, v197
v_mfma_f32_16x16x32_bf16 v[108:111], v[156:159], v[164:167], v[108:111]
v_mov_b32 v198, 0x3f80
v_mov_b32 v199, 1.0
v_mfma_f32_16x16x32_bf16 v[92:95], v[156:159], v[168:171], v[92:95]
v_cmp_eq_u32 vcc, 0, v197
s_nop 1
v_cndmask_b32 v248, 0, v198, vcc
v_mfma_f32_16x16x32_bf16 v[124:127], v[156:159], v[172:175], v[124:127]
v_cndmask_b32 v252, 0, v199, vcc
v_cmp_eq_u32 vcc, 1, v197
s_waitcnt lgkmcnt(6)
v_mfma_f32_16x16x32_bf16 v[64:67], v[32:35], v[48:51], v[64:67]
ds_read_b128 v[144:147], v133 offset:0
s_waitcnt lgkmcnt(6)
v_mfma_f32_16x16x32_bf16 v[96:99], v[32:35], v[52:55], v[96:99]
ds_read_b128 v[160:163], v135 offset:0
s_waitcnt lgkmcnt(6)
v_mfma_f32_16x16x32_bf16 v[80:83], v[32:35], v[56:59], v[80:83]
ds_read_b128 v[164:167], v135 offset:2048
s_waitcnt lgkmcnt(6)
v_mfma_f32_16x16x32_bf16 v[112:115], v[32:35], v[60:63], v[112:115]
ds_read_b128 v[168:171], v135 offset:4096
s_waitcnt lgkmcnt(6)
v_mfma_f32_16x16x32_bf16 v[68:71], v[36:39], v[48:51], v[68:71]
ds_read_b128 v[172:175], v135 offset:6144
v_mfma_f32_16x16x32_bf16 v[100:103], v[36:39], v[52:55], v[100:103]
ds_read_b128 v[148:151], v133 offset:2048
v_mfma_f32_16x16x32_bf16 v[84:87], v[36:39], v[56:59], v[84:87]
ds_read_b128 v[152:155], v133 offset:4096
v_mfma_f32_16x16x32_bf16 v[116:119], v[36:39], v[60:63], v[116:119]
ds_read_b128 v[156:159], v133 offset:6144
s_waitcnt lgkmcnt(9)
v_mfma_f32_16x16x32_bf16 v[72:75], v[40:43], v[48:51], v[72:75]
v_cndmask_b32 v249, 0, v198, vcc
v_cndmask_b32 v253, 0, v199, vcc
v_mfma_f32_16x16x32_bf16 v[104:107], v[40:43], v[52:55], v[104:107]
v_cmp_eq_u32 vcc, 2, v197
s_nop 1
v_cndmask_b32 v250, 0, v198, vcc
v_mfma_f32_16x16x32_bf16 v[88:91], v[40:43], v[56:59], v[88:91]
v_cndmask_b32 v254, 0, v199, vcc
v_cmp_eq_u32 vcc, 3, v197
v_mfma_f32_16x16x32_bf16 v[120:123], v[40:43], v[60:63], v[120:123]
s_nop 0
v_cndmask_b32 v251, 0, v198, vcc
v_cndmask_b32 v255, 0, v199, vcc
s_waitcnt lgkmcnt(8)
v_mfma_f32_16x16x32_bf16 v[76:79], v[44:47], v[48:51], v[76:79]
v_mfma_f32_16x16x32_bf16 v[108:111], v[44:47], v[52:55], v[108:111]
v_mfma_f32_16x16x32_bf16 v[92:95], v[44:47], v[56:59], v[92:95]
v_mfma_f32_16x16x32_bf16 v[124:127], v[44:47], v[60:63], v[124:127]
s_waitcnt lgkmcnt(0)
s_barrier
v_mfma_f32_16x16x32_bf16 v[64:67], v[144:147], v[160:163], v[64:67]
ds_read_b128 v[32:35], v128 offset:0
v_mfma_f32_16x16x32_bf16 v[96:99], v[144:147], v[164:167], v[96:99]
ds_read_b128 v[48:51], v130 offset:0
v_mfma_f32_16x16x32_bf16 v[80:83], v[144:147], v[168:171], v[80:83]
ds_read_b128 v[52:55], v130 offset:2048
v_mfma_f32_16x16x32_bf16 v[112:115], v[144:147], v[172:175], v[112:115]
ds_read_b128 v[56:59], v130 offset:4096
v_mfma_f32_16x16x32_bf16 v[68:71], v[148:151], v[160:163], v[68:71]
ds_read_b128 v[60:63], v130 offset:6144
v_mfma_f32_16x16x32_bf16 v[100:103], v[148:151], v[164:167], v[100:103]
ds_read_b128 v[36:39], v128 offset:2048
v_mfma_f32_16x16x32_bf16 v[84:87], v[148:151], v[168:171], v[84:87]
ds_read_b128 v[40:43], v128 offset:4096
v_mfma_f32_16x16x32_bf16 v[116:119], v[148:151], v[172:175], v[116:119]
ds_read_b128 v[44:47], v128 offset:6144
v_mfma_f32_16x16x32_bf16 v[72:75], v[152:155], v[160:163], v[72:75]
v_mfma_f32_16x16x32_bf16 v[104:107], v[152:155], v[164:167], v[104:107]
v_mfma_f32_16x16x32_bf16 v[88:91], v[152:155], v[168:171], v[88:91]
v_mfma_f32_16x16x32_bf16 v[120:123], v[152:155], v[172:175], v[120:123]
v_mfma_f32_16x16x32_bf16 v[76:79], v[156:159], v[160:163], v[76:79]
v_mfma_f32_16x16x32_bf16 v[108:111], v[156:159], v[164:167], v[108:111]
v_mfma_f32_16x16x32_bf16 v[92:95], v[156:159], v[168:171], v[92:95]
v_mfma_f32_16x16x32_bf16 v[124:127], v[156:159], v[172:175], v[124:127]
s_waitcnt lgkmcnt(6)
v_mfma_f32_16x16x32_bf16 v[64:67], v[32:35], v[48:51], v[64:67]
ds_read_b128 v[144:147], v129 offset:0
s_waitcnt lgkmcnt(6)
v_mfma_f32_16x16x32_bf16 v[96:99], v[32:35], v[52:55], v[96:99]
ds_read_b128 v[160:163], v131 offset:0
s_waitcnt lgkmcnt(6)
v_mfma_f32_16x16x32_bf16 v[80:83], v[32:35], v[56:59], v[80:83]
ds_read_b128 v[164:167], v131 offset:2048
s_waitcnt lgkmcnt(6)
v_mfma_f32_16x16x32_bf16 v[112:115], v[32:35], v[60:63], v[112:115]
ds_read_b128 v[168:171], v131 offset:4096
s_waitcnt lgkmcnt(6)
v_mfma_f32_16x16x32_bf16 v[68:71], v[36:39], v[48:51], v[68:71]
ds_read_b128 v[172:175], v131 offset:6144
v_mfma_f32_16x16x32_bf16 v[100:103], v[36:39], v[52:55], v[100:103]
ds_read_b128 v[148:151], v129 offset:2048
v_mfma_f32_16x16x32_bf16 v[84:87], v[36:39], v[56:59], v[84:87]
ds_read_b128 v[152:155], v129 offset:4096
v_mfma_f32_16x16x32_bf16 v[116:119], v[36:39], v[60:63], v[116:119]
ds_read_b128 v[156:159], v129 offset:6144
s_waitcnt lgkmcnt(9)
v_mfma_f32_16x16x32_bf16 v[72:75], v[40:43], v[48:51], v[72:75]
v_mfma_f32_16x16x32_bf16 v[104:107], v[40:43], v[52:55], v[104:107]
v_mfma_f32_16x16x32_bf16 v[88:91], v[40:43], v[56:59], v[88:91]
v_mfma_f32_16x16x32_bf16 v[120:123], v[40:43], v[60:63], v[120:123]
s_waitcnt lgkmcnt(8)
v_mfma_f32_16x16x32_bf16 v[76:79], v[44:47], v[48:51], v[76:79]
v_mfma_f32_16x16x32_bf16 v[108:111], v[44:47], v[52:55], v[108:111]
v_mfma_f32_16x16x32_bf16 v[92:95], v[44:47], v[56:59], v[92:95]
v_mfma_f32_16x16x32_bf16 v[124:127], v[44:47], v[60:63], v[124:127]
s_waitcnt lgkmcnt(0)
s_barrier
v_mfma_f32_16x16x32_bf16 v[64:67], v[144:147], v[160:163], v[64:67]
ds_read_b128 v[32:35], v128 offset:32768
v_mfma_f32_16x16x32_bf16 v[96:99], v[144:147], v[164:167], v[96:99]
ds_read_b128 v[48:51], v130 offset:32768
v_mfma_f32_16x16x32_bf16 v[80:83], v[144:147], v[168:171], v[80:83]
ds_read_b128 v[52:55], v130 offset:34816
v_mfma_f32_16x16x32_bf16 v[112:115], v[144:147], v[172:175], v[112:115]
ds_read_b128 v[56:59], v130 offset:36864
v_mfma_f32_16x16x32_bf16 v[68:71], v[148:151], v[160:163], v[68:71]
ds_read_b128 v[60:63], v130 offset:38912
v_mfma_f32_16x16x32_bf16 v[100:103], v[148:151], v[164:167], v[100:103]
ds_read_b128 v[36:39], v128 offset:34816
v_mfma_f32_16x16x32_bf16 v[84:87], v[148:151], v[168:171], v[84:87]
ds_read_b128 v[40:43], v128 offset:36864
v_mfma_f32_16x16x32_bf16 v[116:119], v[148:151], v[172:175], v[116:119]
ds_read_b128 v[44:47], v128 offset:38912
v_mfma_f32_16x16x32_bf16 v[72:75], v[152:155], v[160:163], v[72:75]
v_mfma_f32_16x16x32_bf16 v[104:107], v[152:155], v[164:167], v[104:107]
v_mfma_f32_16x16x32_bf16 v[88:91], v[152:155], v[168:171], v[88:91]
v_mfma_f32_16x16x32_bf16 v[120:123], v[152:155], v[172:175], v[120:123]
v_mfma_f32_16x16x32_bf16 v[76:79], v[156:159], v[160:163], v[76:79]
v_mfma_f32_16x16x32_bf16 v[108:111], v[156:159], v[164:167], v[108:111]
v_mfma_f32_16x16x32_bf16 v[92:95], v[156:159], v[168:171], v[92:95]
v_mfma_f32_16x16x32_bf16 v[124:127], v[156:159], v[172:175], v[124:127]
s_waitcnt lgkmcnt(6)
v_mfma_f32_16x16x32_bf16 v[64:67], v[32:35], v[48:51], v[64:67]
ds_read_b128 v[144:147], v129 offset:32768
s_waitcnt lgkmcnt(6)
v_mfma_f32_16x16x32_bf16 v[96:99], v[32:35], v[52:55], v[96:99]
ds_read_b128 v[160:163], v131 offset:32768
s_waitcnt lgkmcnt(6)
v_mfma_f32_16x16x32_bf16 v[80:83], v[32:35], v[56:59], v[80:83]
ds_read_b128 v[164:167], v131 offset:34816
s_waitcnt lgkmcnt(6)
v_mfma_f32_16x16x32_bf16 v[112:115], v[32:35], v[60:63], v[112:115]
ds_read_b128 v[168:171], v131 offset:36864
s_waitcnt lgkmcnt(6)
v_mfma_f32_16x16x32_bf16 v[68:71], v[36:39], v[48:51], v[68:71]
ds_read_b128 v[172:175], v131 offset:38912
v_mfma_f32_16x16x32_bf16 v[100:103], v[36:39], v[52:55], v[100:103]
ds_read_b128 v[148:151], v129 offset:34816
v_mfma_f32_16x16x32_bf16 v[84:87], v[36:39], v[56:59], v[84:87]
ds_read_b128 v[152:155], v129 offset:36864
v_mfma_f32_16x16x32_bf16 v[116:119], v[36:39], v[60:63], v[116:119]
ds_read_b128 v[156:159], v129 offset:38912
s_waitcnt lgkmcnt(9)
v_mfma_f32_16x16x32_bf16 v[72:75], v[40:43], v[48:51], v[72:75]
v_mfma_f32_16x16x32_bf16 v[104:107], v[40:43], v[52:55], v[104:107]
v_mfma_f32_16x16x32_bf16 v[88:91], v[40:43], v[56:59], v[88:91]
v_mfma_f32_16x16x32_bf16 v[120:123], v[40:43], v[60:63], v[120:123]
s_waitcnt lgkmcnt(8)
v_mfma_f32_16x16x32_bf16 v[76:79], v[44:47], v[48:51], v[76:79]
v_mfma_f32_16x16x32_bf16 v[108:111], v[44:47], v[52:55], v[108:111]
v_mfma_f32_16x16x32_bf16 v[92:95], v[44:47], v[56:59], v[92:95]
v_mfma_f32_16x16x32_bf16 v[124:127], v[44:47], v[60:63], v[124:127]
s_waitcnt lgkmcnt(0)
s_barrier
v_mfma_f32_16x16x32_bf16 v[64:67], v[144:147], v[160:163], v[64:67]
ds_read_b128 v[32:35], v132 offset:0
v_mfma_f32_16x16x32_bf16 v[96:99], v[144:147], v[164:167], v[96:99]
ds_read_b128 v[48:51], v134 offset:0
v_mfma_f32_16x16x32_bf16 v[80:83], v[144:147], v[168:171], v[80:83]
ds_read_b128 v[52:55], v134 offset:2048
v_mfma_f32_16x16x32_bf16 v[112:115], v[144:147], v[172:175], v[112:115]
ds_read_b128 v[56:59], v134 offset:4096
v_mfma_f32_16x16x32_bf16 v[68:71], v[148:151], v[160:163], v[68:71]
ds_read_b128 v[60:63], v134 offset:6144
v_mfma_f32_16x16x32_bf16 v[100:103], v[148:151], v[164:167], v[100:103]
ds_read_b128 v[36:39], v132 offset:2048
v_mfma_f32_16x16x32_bf16 v[84:87], v[148:151], v[168:171], v[84:87]
ds_read_b128 v[40:43], v132 offset:4096
v_mfma_f32_16x16x32_bf16 v[116:119], v[148:151], v[172:175], v[116:119]
ds_read_b128 v[44:47], v132 offset:6144
v_mfma_f32_16x16x32_bf16 v[72:75], v[152:155], v[160:163], v[72:75]
v_mfma_f32_16x16x32_bf16 v[104:107], v[152:155], v[164:167], v[104:107]
v_mfma_f32_16x16x32_bf16 v[88:91], v[152:155], v[168:171], v[88:91]
v_mfma_f32_16x16x32_bf16 v[120:123], v[152:155], v[172:175], v[120:123]
v_mfma_f32_16x16x32_bf16 v[76:79], v[156:159], v[160:163], v[76:79]
v_mfma_f32_16x16x32_bf16 v[108:111], v[156:159], v[164:167], v[108:111]
v_mfma_f32_16x16x32_bf16 v[92:95], v[156:159], v[168:171], v[92:95]
v_mfma_f32_16x16x32_bf16 v[124:127], v[156:159], v[172:175], v[124:127]
s_waitcnt lgkmcnt(6)
v_mfma_f32_16x16x32_bf16 v[64:67], v[32:35], v[48:51], v[64:67]
ds_read_b128 v[144:147], v133 offset:0
s_waitcnt lgkmcnt(6)
v_mfma_f32_16x16x32_bf16 v[96:99], v[32:35], v[52:55], v[96:99]
ds_read_b128 v[160:163], v135 offset:0
s_waitcnt lgkmcnt(6)
v_mfma_f32_16x16x32_bf16 v[80:83], v[32:35], v[56:59], v[80:83]
ds_read_b128 v[164:167], v135 offset:2048
s_waitcnt lgkmcnt(6)
v_mfma_f32_16x16x32_bf16 v[112:115], v[32:35], v[60:63], v[112:115]
ds_read_b128 v[168:171], v135 offset:4096
s_waitcnt lgkmcnt(6)
v_mfma_f32_16x16x32_bf16 v[68:71], v[36:39], v[48:51], v[68:71]
ds_read_b128 v[172:175], v135 offset:6144
v_mfma_f32_16x16x32_bf16 v[100:103], v[36:39], v[52:55], v[100:103]
ds_read_b128 v[148:151], v133 offset:2048
v_mfma_f32_16x16x32_bf16 v[84:87], v[36:39], v[56:59], v[84:87]
ds_read_b128 v[152:155], v133 offset:4096
v_mfma_f32_16x16x32_bf16 v[116:119], v[36:39], v[60:63], v[116:119]
ds_read_b128 v[156:159], v133 offset:6144
s_waitcnt lgkmcnt(9)
v_mfma_f32_16x16x32_bf16 v[72:75], v[40:43], v[48:51], v[72:75]
v_mfma_f32_16x16x32_bf16 v[104:107], v[40:43], v[52:55], v[104:107]
v_mfma_f32_16x16x32_bf16 v[88:91], v[40:43], v[56:59], v[88:91]
v_mfma_f32_16x16x32_bf16 v[120:123], v[40:43], v[60:63], v[120:123]
s_waitcnt lgkmcnt(8)
v_mfma_f32_16x16x32_bf16 v[76:79], v[44:47], v[48:51], v[76:79]
v_mfma_f32_16x16x32_bf16 v[108:111], v[44:47], v[52:55], v[108:111]
v_mfma_f32_16x16x32_bf16 v[92:95], v[44:47], v[56:59], v[92:95]
v_mfma_f32_16x16x32_bf16 v[124:127], v[44:47], v[60:63], v[124:127]
s_waitcnt lgkmcnt(0)
s_barrier
v_mfma_f32_16x16x32_bf16 v[64:67], v[144:147], v[160:163], v[64:67]
ds_read_b128 v[32:35], v128 offset:0
v_mfma_f32_16x16x32_bf16 v[96:99], v[144:147], v[164:167], v[96:99]
ds_read_b128 v[48:51], v130 offset:0
v_mfma_f32_16x16x32_bf16 v[80:83], v[144:147], v[168:171], v[80:83]
ds_read_b128 v[52:55], v130 offset:2048
v_mfma_f32_16x16x32_bf16 v[112:115], v[144:147], v[172:175], v[112:115]
ds_read_b128 v[56:59], v130 offset:4096
v_mfma_f32_16x16x32_bf16 v[68:71], v[148:151], v[160:163], v[68:71]
ds_read_b128 v[60:63], v130 offset:6144
v_mfma_f32_16x16x32_bf16 v[100:103], v[148:151], v[164:167], v[100:103]
ds_read_b128 v[36:39], v128 offset:2048
v_mfma_f32_16x16x32_bf16 v[84:87], v[148:151], v[168:171], v[84:87]
ds_read_b128 v[40:43], v128 offset:4096
v_mfma_f32_16x16x32_bf16 v[116:119], v[148:151], v[172:175], v[116:119]
ds_read_b128 v[44:47], v128 offset:6144
v_mfma_f32_16x16x32_bf16 v[72:75], v[152:155], v[160:163], v[72:75]
v_mfma_f32_16x16x32_bf16 v[104:107], v[152:155], v[164:167], v[104:107]
v_mfma_f32_16x16x32_bf16 v[88:91], v[152:155], v[168:171], v[88:91]
v_mfma_f32_16x16x32_bf16 v[120:123], v[152:155], v[172:175], v[120:123]
v_mfma_f32_16x16x32_bf16 v[76:79], v[156:159], v[160:163], v[76:79]
v_mfma_f32_16x16x32_bf16 v[108:111], v[156:159], v[164:167], v[108:111]
v_mfma_f32_16x16x32_bf16 v[92:95], v[156:159], v[168:171], v[92:95]
v_mfma_f32_16x16x32_bf16 v[124:127], v[156:159], v[172:175], v[124:127]
s_waitcnt lgkmcnt(6)
v_mfma_f32_16x16x32_bf16 v[64:67], v[32:35], v[48:51], v[64:67]
ds_read_b128 v[144:147], v129 offset:0
s_waitcnt lgkmcnt(6)
v_mfma_f32_16x16x32_bf16 v[96:99], v[32:35], v[52:55], v[96:99]
ds_read_b128 v[160:163], v131 offset:0
s_waitcnt lgkmcnt(6)
v_mfma_f32_16x16x32_bf16 v[80:83], v[32:35], v[56:59], v[80:83]
ds_read_b128 v[164:167], v131 offset:2048
s_waitcnt lgkmcnt(6)
v_mfma_f32_16x16x32_bf16 v[112:115], v[32:35], v[60:63], v[112:115]
ds_read_b128 v[168:171], v131 offset:4096
s_waitcnt lgkmcnt(6)
v_mfma_f32_16x16x32_bf16 v[68:71], v[36:39], v[48:51], v[68:71]
ds_read_b128 v[172:175], v131 offset:6144
v_mfma_f32_16x16x32_bf16 v[100:103], v[36:39], v[52:55], v[100:103]
ds_read_b128 v[148:151], v129 offset:2048
v_mfma_f32_16x16x32_bf16 v[84:87], v[36:39], v[56:59], v[84:87]
ds_read_b128 v[152:155], v129 offset:4096
v_mfma_f32_16x16x32_bf16 v[116:119], v[36:39], v[60:63], v[116:119]
ds_read_b128 v[156:159], v129 offset:6144
s_waitcnt lgkmcnt(9)
v_mfma_f32_16x16x32_bf16 v[72:75], v[40:43], v[48:51], v[72:75]
v_mfma_f32_16x16x32_bf16 v[104:107], v[40:43], v[52:55], v[104:107]
v_mfma_f32_16x16x32_bf16 v[88:91], v[40:43], v[56:59], v[88:91]
v_mfma_f32_16x16x32_bf16 v[120:123], v[40:43], v[60:63], v[120:123]
s_waitcnt lgkmcnt(8)
v_mfma_f32_16x16x32_bf16 v[76:79], v[44:47], v[48:51], v[76:79]
v_mfma_f32_16x16x32_bf16 v[108:111], v[44:47], v[52:55], v[108:111]
v_mfma_f32_16x16x32_bf16 v[92:95], v[44:47], v[56:59], v[92:95]
v_mfma_f32_16x16x32_bf16 v[124:127], v[44:47], v[60:63], v[124:127]
s_waitcnt lgkmcnt(0)
s_barrier
v_mfma_f32_16x16x32_bf16 v[64:67], v[144:147], v[160:163], v[64:67]
ds_read_b128 v[32:35], v128 offset:32768
v_mfma_f32_16x16x32_bf16 v[96:99], v[144:147], v[164:167], v[96:99]
ds_read_b128 v[48:51], v130 offset:32768
v_mfma_f32_16x16x32_bf16 v[80:83], v[144:147], v[168:171], v[80:83]
ds_read_b128 v[52:55], v130 offset:34816
v_mfma_f32_16x16x32_bf16 v[112:115], v[144:147], v[172:175], v[112:115]
ds_read_b128 v[56:59], v130 offset:36864
v_mfma_f32_16x16x32_bf16 v[68:71], v[148:151], v[160:163], v[68:71]
ds_read_b128 v[60:63], v130 offset:38912
v_mfma_f32_16x16x32_bf16 v[100:103], v[148:151], v[164:167], v[100:103]
ds_read_b128 v[36:39], v128 offset:34816
v_mfma_f32_16x16x32_bf16 v[84:87], v[148:151], v[168:171], v[84:87]
ds_read_b128 v[40:43], v128 offset:36864
v_mfma_f32_16x16x32_bf16 v[116:119], v[148:151], v[172:175], v[116:119]
ds_read_b128 v[44:47], v128 offset:38912
v_mfma_f32_16x16x32_bf16 v[72:75], v[152:155], v[160:163], v[72:75]
v_mfma_f32_16x16x32_bf16 v[104:107], v[152:155], v[164:167], v[104:107]
v_mfma_f32_16x16x32_bf16 v[88:91], v[152:155], v[168:171], v[88:91]
v_mfma_f32_16x16x32_bf16 v[120:123], v[152:155], v[172:175], v[120:123]
v_mfma_f32_16x16x32_bf16 v[76:79], v[156:159], v[160:163], v[76:79]
v_mfma_f32_16x16x32_bf16 v[108:111], v[156:159], v[164:167], v[108:111]
v_mfma_f32_16x16x32_bf16 v[92:95], v[156:159], v[168:171], v[92:95]
v_mfma_f32_16x16x32_bf16 v[124:127], v[156:159], v[172:175], v[124:127]
s_waitcnt lgkmcnt(6)
v_mfma_f32_16x16x32_bf16 v[64:67], v[32:35], v[48:51], v[64:67]
ds_read_b128 v[144:147], v129 offset:32768
s_waitcnt lgkmcnt(6)
v_mfma_f32_16x16x32_bf16 v[96:99], v[32:35], v[52:55], v[96:99]
ds_read_b128 v[160:163], v131 offset:32768
s_waitcnt lgkmcnt(6)
v_mfma_f32_16x16x32_bf16 v[80:83], v[32:35], v[56:59], v[80:83]
ds_read_b128 v[164:167], v131 offset:34816
s_waitcnt lgkmcnt(6)
v_mfma_f32_16x16x32_bf16 v[112:115], v[32:35], v[60:63], v[112:115]
ds_read_b128 v[168:171], v131 offset:36864
s_waitcnt lgkmcnt(6)
v_mfma_f32_16x16x32_bf16 v[68:71], v[36:39], v[48:51], v[68:71]
ds_read_b128 v[172:175], v131 offset:38912
v_mfma_f32_16x16x32_bf16 v[100:103], v[36:39], v[52:55], v[100:103]
ds_read_b128 v[148:151], v129 offset:34816
v_mfma_f32_16x16x32_bf16 v[84:87], v[36:39], v[56:59], v[84:87]
ds_read_b128 v[152:155], v129 offset:36864
v_mfma_f32_16x16x32_bf16 v[116:119], v[36:39], v[60:63], v[116:119]
ds_read_b128 v[156:159], v129 offset:38912
s_waitcnt lgkmcnt(9)
v_mfma_f32_16x16x32_bf16 v[72:75], v[40:43], v[48:51], v[72:75]
v_mfma_f32_16x16x32_bf16 v[104:107], v[40:43], v[52:55], v[104:107]
v_mfma_f32_16x16x32_bf16 v[88:91], v[40:43], v[56:59], v[88:91]
v_mfma_f32_16x16x32_bf16 v[120:123], v[40:43], v[60:63], v[120:123]
s_waitcnt lgkmcnt(8)
v_mfma_f32_16x16x32_bf16 v[76:79], v[44:47], v[48:51], v[76:79]
v_mfma_f32_16x16x32_bf16 v[108:111], v[44:47], v[52:55], v[108:111]
v_mfma_f32_16x16x32_bf16 v[92:95], v[44:47], v[56:59], v[92:95]
v_mfma_f32_16x16x32_bf16 v[124:127], v[44:47], v[60:63], v[124:127]
s_waitcnt lgkmcnt(0)
s_barrier
v_mfma_f32_16x16x32_bf16 v[64:67], v[144:147], v[160:163], v[64:67]
ds_read_b128 v[32:35], v132 offset:0
v_mfma_f32_16x16x32_bf16 v[96:99], v[144:147], v[164:167], v[96:99]
ds_read_b128 v[48:51], v134 offset:0
v_mfma_f32_16x16x32_bf16 v[80:83], v[144:147], v[168:171], v[80:83]
ds_read_b128 v[52:55], v134 offset:2048
v_mfma_f32_16x16x32_bf16 v[112:115], v[144:147], v[172:175], v[112:115]
ds_read_b128 v[56:59], v134 offset:4096
v_mfma_f32_16x16x32_bf16 v[68:71], v[148:151], v[160:163], v[68:71]
ds_read_b128 v[60:63], v134 offset:6144
v_mfma_f32_16x16x32_bf16 v[100:103], v[148:151], v[164:167], v[100:103]
ds_read_b128 v[36:39], v132 offset:2048
v_mfma_f32_16x16x32_bf16 v[84:87], v[148:151], v[168:171], v[84:87]
ds_read_b128 v[40:43], v132 offset:4096
v_mfma_f32_16x16x32_bf16 v[116:119], v[148:151], v[172:175], v[116:119]
ds_read_b128 v[44:47], v132 offset:6144
v_mfma_f32_16x16x32_bf16 v[72:75], v[152:155], v[160:163], v[72:75]
v_mfma_f32_16x16x32_bf16 v[104:107], v[152:155], v[164:167], v[104:107]
v_mfma_f32_16x16x32_bf16 v[88:91], v[152:155], v[168:171], v[88:91]
v_mfma_f32_16x16x32_bf16 v[120:123], v[152:155], v[172:175], v[120:123]
v_mfma_f32_16x16x32_bf16 v[76:79], v[156:159], v[160:163], v[76:79]
v_mfma_f32_16x16x32_bf16 v[108:111], v[156:159], v[164:167], v[108:111]
v_mfma_f32_16x16x32_bf16 v[92:95], v[156:159], v[168:171], v[92:95]
v_mfma_f32_16x16x32_bf16 v[124:127], v[156:159], v[172:175], v[124:127]
s_waitcnt lgkmcnt(6)
v_mfma_f32_16x16x32_bf16 v[64:67], v[32:35], v[48:51], v[64:67]
ds_read_b128 v[144:147], v133 offset:0
s_waitcnt lgkmcnt(6)
v_mfma_f32_16x16x32_bf16 v[96:99], v[32:35], v[52:55], v[96:99]
ds_read_b128 v[160:163], v135 offset:0
s_waitcnt lgkmcnt(6)
v_mfma_f32_16x16x32_bf16 v[80:83], v[32:35], v[56:59], v[80:83]
ds_read_b128 v[164:167], v135 offset:2048
s_waitcnt lgkmcnt(6)
v_mfma_f32_16x16x32_bf16 v[112:115], v[32:35], v[60:63], v[112:115]
ds_read_b128 v[168:171], v135 offset:4096
s_waitcnt lgkmcnt(6)
v_mfma_f32_16x16x32_bf16 v[68:71], v[36:39], v[48:51], v[68:71]
ds_read_b128 v[172:175], v135 offset:6144
v_mfma_f32_16x16x32_bf16 v[100:103], v[36:39], v[52:55], v[100:103]
ds_read_b128 v[148:151], v133 offset:2048
v_mfma_f32_16x16x32_bf16 v[84:87], v[36:39], v[56:59], v[84:87]
ds_read_b128 v[152:155], v133 offset:4096
v_mfma_f32_16x16x32_bf16 v[116:119], v[36:39], v[60:63], v[116:119]
ds_read_b128 v[156:159], v133 offset:6144
s_waitcnt lgkmcnt(9)
v_mfma_f32_16x16x32_bf16 v[72:75], v[40:43], v[48:51], v[72:75]
v_mfma_f32_16x16x32_bf16 v[104:107], v[40:43], v[52:55], v[104:107]
v_mfma_f32_16x16x32_bf16 v[88:91], v[40:43], v[56:59], v[88:91]
v_mfma_f32_16x16x32_bf16 v[120:123], v[40:43], v[60:63], v[120:123]
s_waitcnt lgkmcnt(8)
v_mfma_f32_16x16x32_bf16 v[76:79], v[44:47], v[48:51], v[76:79]
v_mfma_f32_16x16x32_bf16 v[108:111], v[44:47], v[52:55], v[108:111]
v_mfma_f32_16x16x32_bf16 v[92:95], v[44:47], v[56:59], v[92:95]
v_mfma_f32_16x16x32_bf16 v[124:127], v[44:47], v[60:63], v[124:127]
s_waitcnt lgkmcnt(0)
s_barrier
v_mfma_f32_16x16x32_bf16 v[64:67], v[144:147], v[160:163], v[64:67]
ds_read_b128 v[32:35], v128 offset:0
v_mfma_f32_16x16x32_bf16 v[96:99], v[144:147], v[164:167], v[96:99]
ds_read_b128 v[48:51], v130 offset:0
v_mfma_f32_16x16x32_bf16 v[80:83], v[144:147], v[168:171], v[80:83]
ds_read_b128 v[52:55], v130 offset:2048
v_mfma_f32_16x16x32_bf16 v[112:115], v[144:147], v[172:175], v[112:115]
ds_read_b128 v[56:59], v130 offset:4096
v_mfma_f32_16x16x32_bf16 v[68:71], v[148:151], v[160:163], v[68:71]
ds_read_b128 v[60:63], v130 offset:6144
v_mfma_f32_16x16x32_bf16 v[100:103], v[148:151], v[164:167], v[100:103]
ds_read_b128 v[36:39], v128 offset:2048
v_mfma_f32_16x16x32_bf16 v[84:87], v[148:151], v[168:171], v[84:87]
ds_read_b128 v[40:43], v128 offset:4096
v_mfma_f32_16x16x32_bf16 v[116:119], v[148:151], v[172:175], v[116:119]
ds_read_b128 v[44:47], v128 offset:6144
v_mfma_f32_16x16x32_bf16 v[72:75], v[152:155], v[160:163], v[72:75]
v_mfma_f32_16x16x32_bf16 v[104:107], v[152:155], v[164:167], v[104:107]
v_mfma_f32_16x16x32_bf16 v[88:91], v[152:155], v[168:171], v[88:91]
v_mfma_f32_16x16x32_bf16 v[120:123], v[152:155], v[172:175], v[120:123]
v_mfma_f32_16x16x32_bf16 v[76:79], v[156:159], v[160:163], v[76:79]
v_mfma_f32_16x16x32_bf16 v[108:111], v[156:159], v[164:167], v[108:111]
v_mfma_f32_16x16x32_bf16 v[92:95], v[156:159], v[168:171], v[92:95]
v_mfma_f32_16x16x32_bf16 v[124:127], v[156:159], v[172:175], v[124:127]
s_waitcnt lgkmcnt(6)
v_mfma_f32_16x16x32_bf16 v[64:67], v[32:35], v[48:51], v[64:67]
ds_read_b128 v[144:147], v129 offset:0
s_waitcnt lgkmcnt(6)
v_mfma_f32_16x16x32_bf16 v[96:99], v[32:35], v[52:55], v[96:99]
ds_read_b128 v[160:163], v131 offset:0
s_waitcnt lgkmcnt(6)
v_mfma_f32_16x16x32_bf16 v[80:83], v[32:35], v[56:59], v[80:83]
ds_read_b128 v[164:167], v131 offset:2048
s_waitcnt lgkmcnt(6)
v_mfma_f32_16x16x32_bf16 v[112:115], v[32:35], v[60:63], v[112:115]
ds_read_b128 v[168:171], v131 offset:4096
s_waitcnt lgkmcnt(6)
v_mfma_f32_16x16x32_bf16 v[68:71], v[36:39], v[48:51], v[68:71]
ds_read_b128 v[172:175], v131 offset:6144
v_mfma_f32_16x16x32_bf16 v[100:103], v[36:39], v[52:55], v[100:103]
ds_read_b128 v[148:151], v129 offset:2048
v_mfma_f32_16x16x32_bf16 v[84:87], v[36:39], v[56:59], v[84:87]
ds_read_b128 v[152:155], v129 offset:4096
v_mfma_f32_16x16x32_bf16 v[116:119], v[36:39], v[60:63], v[116:119]
ds_read_b128 v[156:159], v129 offset:6144
s_waitcnt lgkmcnt(9)
v_mfma_f32_16x16x32_bf16 v[72:75], v[40:43], v[48:51], v[72:75]
v_mfma_f32_16x16x32_bf16 v[104:107], v[40:43], v[52:55], v[104:107]
v_mfma_f32_16x16x32_bf16 v[88:91], v[40:43], v[56:59], v[88:91]
v_mfma_f32_16x16x32_bf16 v[120:123], v[40:43], v[60:63], v[120:123]
s_waitcnt lgkmcnt(8)
v_mfma_f32_16x16x32_bf16 v[76:79], v[44:47], v[48:51], v[76:79]
v_mfma_f32_16x16x32_bf16 v[108:111], v[44:47], v[52:55], v[108:111]
v_mfma_f32_16x16x32_bf16 v[92:95], v[44:47], v[56:59], v[92:95]
v_mfma_f32_16x16x32_bf16 v[124:127], v[44:47], v[60:63], v[124:127]
ds_read_b32 v9, v12 offset:80
s_waitcnt lgkmcnt(0)
v_mfma_f32_16x16x32_bf16 v[64:67], v[144:147], v[160:163], v[64:67]
v_mfma_f32_16x16x32_bf16 v[96:99], v[144:147], v[164:167], v[96:99]
v_mfma_f32_16x16x32_bf16 v[80:83], v[144:147], v[168:171], v[80:83]
v_mfma_f32_16x16x32_bf16 v[112:115], v[144:147], v[172:175], v[112:115]
v_mfma_f32_16x16x32_bf16 v[68:71], v[148:151], v[160:163], v[68:71]
v_mfma_f32_16x16x32_bf16 v[100:103], v[148:151], v[164:167], v[100:103]
v_mfma_f32_16x16x32_bf16 v[84:87], v[148:151], v[168:171], v[84:87]
v_mfma_f32_16x16x32_bf16 v[116:119], v[148:151], v[172:175], v[116:119]
v_mfma_f32_16x16x32_bf16 v[72:75], v[152:155], v[160:163], v[72:75]
v_mfma_f32_16x16x32_bf16 v[104:107], v[152:155], v[164:167], v[104:107]
v_mfma_f32_16x16x32_bf16 v[88:91], v[152:155], v[168:171], v[88:91]
v_mfma_f32_16x16x32_bf16 v[120:123], v[152:155], v[172:175], v[120:123]
v_mfma_f32_16x16x32_bf16 v[76:79], v[156:159], v[160:163], v[76:79]
v_mfma_f32_16x16x32_bf16 v[108:111], v[156:159], v[164:167], v[108:111]
v_mfma_f32_16x16x32_bf16 v[92:95], v[156:159], v[168:171], v[92:95]
v_mfma_f32_16x16x32_bf16 v[124:127], v[156:159], v[172:175], v[124:127]
v_readfirstlane_b32 s37, v9
s_getreg_b32 s60, hwreg(HW_REG_XCC_ID, 0, 4)
s_lshl_b32 s61, s37, 4
s_or_b32 s100, s60, s61
v_mov_b32 v194, s100
v_mov_b32 v202, s37
v_mov_b32 v203, s37
v_pk_fma_f32 v[40:41], v[20:21], v[64:65], v[66:67] op_sel_hi:[0,1,1]
v_pk_fma_f32 v[42:43], v[20:21], v[80:81], v[82:83] op_sel_hi:[0,1,1]
v_pk_fma_f32 v[44:45], v[22:23], v[96:97], v[98:99] op_sel_hi:[0,1,1]
v_pk_fma_f32 v[46:47], v[22:23], v[112:113], v[114:115] op_sel_hi:[0,1,1]
v_pk_fma_f32 v[66:67], v[20:21], v[80:81], v[40:41] op_sel:[1,0,0] neg_lo:[1,0,0] neg_hi:[1,0,0]
v_pk_fma_f32 v[82:83], v[20:21], v[64:65], v[42:43] op_sel:[1,0,0]
v_pk_fma_f32 v[98:99], v[22:23], v[112:113], v[44:45] op_sel:[1,0,0] neg_lo:[1,0,0] neg_hi:[1,0,0]
v_pk_fma_f32 v[114:115], v[22:23], v[96:97], v[46:47] op_sel:[1,0,0]
v_pk_fma_f32 v[40:41], v[20:21], v[66:67], v[68:69] op_sel_hi:[0,1,1]
v_pk_fma_f32 v[42:43], v[20:21], v[82:83], v[84:85] op_sel_hi:[0,1,1]
v_pk_fma_f32 v[44:45], v[22:23], v[98:99], v[100:101] op_sel_hi:[0,1,1]
v_pk_fma_f32 v[46:47], v[22:23], v[114:115], v[116:117] op_sel_hi:[0,1,1]
v_pk_fma_f32 v[68:69], v[20:21], v[82:83], v[40:41] op_sel:[1,0,0] neg_lo:[1,0,0] neg_hi:[1,0,0]
v_pk_fma_f32 v[84:85], v[20:21], v[66:67], v[42:43] op_sel:[1,0,0]
v_pk_fma_f32 v[100:101], v[22:23], v[114:115], v[44:45] op_sel:[1,0,0] neg_lo:[1,0,0] neg_hi:[1,0,0]
v_pk_fma_f32 v[116:117], v[22:23], v[98:99], v[46:47] op_sel:[1,0,0]
v_pk_fma_f32 v[40:41], v[20:21], v[68:69], v[70:71] op_sel_hi:[0,1,1]
v_pk_fma_f32 v[42:43], v[20:21], v[84:85], v[86:87] op_sel_hi:[0,1,1]
v_pk_fma_f32 v[44:45], v[22:23], v[100:101], v[102:103] op_sel_hi:[0,1,1]
v_pk_fma_f32 v[46:47], v[22:23], v[116:117], v[118:119] op_sel_hi:[0,1,1]
v_pk_fma_f32 v[70:71], v[20:21], v[84:85], v[40:41] op_sel:[1,0,0] neg_lo:[1,0,0] neg_hi:[1,0,0]
v_pk_fma_f32 v[86:87], v[20:21], v[68:69], v[42:43] op_sel:[1,0,0]
v_pk_fma_f32 v[102:103], v[22:23], v[116:117], v[44:45] op_sel:[1,0,0] neg_lo:[1,0,0] neg_hi:[1,0,0]
v_pk_fma_f32 v[118:119], v[22:23], v[100:101], v[46:47] op_sel:[1,0,0]
v_pk_fma_f32 v[40:41], v[20:21], v[70:71], v[72:73] op_sel_hi:[0,1,1]
v_pk_fma_f32 v[42:43], v[20:21], v[86:87], v[88:89] op_sel_hi:[0,1,1]
v_pk_fma_f32 v[44:45], v[22:23], v[102:103], v[104:105] op_sel_hi:[0,1,1]
v_pk_fma_f32 v[46:47], v[22:23], v[118:119], v[120:121] op_sel_hi:[0,1,1]
v_pk_fma_f32 v[72:73], v[20:21], v[86:87], v[40:41] op_sel:[1,0,0] neg_lo:[1,0,0] neg_hi:[1,0,0]
v_pk_fma_f32 v[88:89], v[20:21], v[70:71], v[42:43] op_sel:[1,0,0]
v_pk_fma_f32 v[104:105], v[22:23], v[118:119], v[44:45] op_sel:[1,0,0] neg_lo:[1,0,0] neg_hi:[1,0,0]
v_pk_fma_f32 v[120:121], v[22:23], v[102:103], v[46:47] op_sel:[1,0,0]
v_pk_fma_f32 v[40:41], v[20:21], v[72:73], v[74:75] op_sel_hi:[0,1,1]
v_pk_fma_f32 v[42:43], v[20:21], v[88:89], v[90:91] op_sel_hi:[0,1,1]
v_pk_fma_f32 v[44:45], v[22:23], v[104:105], v[106:107] op_sel_hi:[0,1,1]
v_pk_fma_f32 v[46:47], v[22:23], v[120:121], v[122:123] op_sel_hi:[0,1,1]
v_pk_fma_f32 v[74:75], v[20:21], v[88:89], v[40:41] op_sel:[1,0,0] neg_lo:[1,0,0] neg_hi:[1,0,0]
v_pk_fma_f32 v[90:91], v[20:21], v[72:73], v[42:43] op_sel:[1,0,0]
v_pk_fma_f32 v[106:107], v[22:23], v[120:121], v[44:45] op_sel:[1,0,0] neg_lo:[1,0,0] neg_hi:[1,0,0]
v_pk_fma_f32 v[122:123], v[22:23], v[104:105], v[46:47] op_sel:[1,0,0]
v_pk_fma_f32 v[40:41], v[20:21], v[74:75], v[76:77] op_sel_hi:[0,1,1]
v_pk_fma_f32 v[42:43], v[20:21], v[90:91], v[92:93] op_sel_hi:[0,1,1]
v_pk_fma_f32 v[44:45], v[22:23], v[106:107], v[108:109] op_sel_hi:[0,1,1]
v_pk_fma_f32 v[46:47], v[22:23], v[122:123], v[124:125] op_sel_hi:[0,1,1]
v_pk_fma_f32 v[76:77], v[20:21], v[90:91], v[40:41] op_sel:[1,0,0] neg_lo:[1,0,0] neg_hi:[1,0,0]
v_pk_fma_f32 v[92:93], v[20:21], v[74:75], v[42:43] op_sel:[1,0,0]
v_pk_fma_f32 v[108:109], v[22:23], v[122:123], v[44:45] op_sel:[1,0,0] neg_lo:[1,0,0] neg_hi:[1,0,0]
v_pk_fma_f32 v[124:125], v[22:23], v[106:107], v[46:47] op_sel:[1,0,0]
v_pk_fma_f32 v[40:41], v[20:21], v[76:77], v[78:79] op_sel_hi:[0,1,1]
v_pk_fma_f32 v[42:43], v[20:21], v[92:93], v[94:95] op_sel_hi:[0,1,1]
v_pk_fma_f32 v[44:45], v[22:23], v[108:109], v[110:111] op_sel_hi:[0,1,1]
v_pk_fma_f32 v[46:47], v[22:23], v[124:125], v[126:127] op_sel_hi:[0,1,1]
v_pk_fma_f32 v[78:79], v[20:21], v[92:93], v[40:41] op_sel:[1,0,0] neg_lo:[1,0,0] neg_hi:[1,0,0]
v_pk_fma_f32 v[94:95], v[20:21], v[76:77], v[42:43] op_sel:[1,0,0]
v_pk_fma_f32 v[110:111], v[22:23], v[124:125], v[44:45] op_sel:[1,0,0] neg_lo:[1,0,0] neg_hi:[1,0,0]
v_pk_fma_f32 v[126:127], v[22:23], v[108:109], v[46:47] op_sel:[1,0,0]
v_fma_f32 v40, v176, v78, v79
v_fma_f32 v41, v176, v94, v95
v_fma_f32 v32, -v177, v94, v40
v_fma_f32 v33, v177, v78, v41
ds_write_b64 v15, v[32:33] offset:0
v_fma_f32 v40, v178, v110, v111
v_fma_f32 v41, v178, v126, v127
v_fma_f32 v34, -v179, v126, v40
v_fma_f32 v35, v179, v110, v41
ds_write_b64 v15, v[34:35] offset:2304
s_waitcnt lgkmcnt(0)
s_mov_b64 exec, 1
v_mov_b32 v197, 17
ds_write_b32 v13, v197 offset:32
s_mov_b64 exec, -1
L_ek52:
ds_read_b128 v[198:201], v12 offset:32
s_waitcnt lgkmcnt(0)
v_min3_u32 v197, v198, v199, v200
v_min_u32 v197, v197, v201
s_nop 0
v_readfirstlane_b32 s60, v197
s_nop 0
s_cmp_lt_u32 s60, 17
s_cbranch_scc1 L_ek52
ds_read_b128 v[48:51], v14
ds_read_b128 v[52:55], v14 offset:16
s_waitcnt lgkmcnt(1)
v_fma_f32 v40, v28, v48, v50
v_fma_f32 v41, v28, v49, v51
v_fma_f32 v32, -v29, v49, v40
v_fma_f32 v33, v29, v48, v41
s_waitcnt lgkmcnt(0)
v_fma_f32 v40, v28, v32, v52
v_fma_f32 v41, v28, v33, v53
v_fma_f32 v34, -v29, v33, v40
v_fma_f32 v35, v29, v32, v41
v_fma_f32 v40, v28, v34, v54
v_fma_f32 v41, v28, v35, v55
v_fma_f32 v32, -v29, v35, v40
v_fma_f32 v33, v29, v34, v41
v_mov_b32 v34, v32
v_mov_b32 v35, v33
s_nop 0
v_permlane32_swap_b32 v32, v34
v_permlane32_swap_b32 v33, v35
v_fma_f32 v40, v192, v32, v34
v_fma_f32 v41, v192, v33, v35
v_fma_f32 v200, -v193, v33, v40
v_fma_f32 v201, v193, v32, v41
s_cmp_lg_u32 s68, 0
s_cbranch_scc1 L_np54
buffer_store_dwordx4 v[200:203], v16, s[40:43], 0 offen sc1
s_cmp_lg_u32 s66, 0
s_cbranch_scc1 L_np54
s_mov_b64 exec, 1
global_store_dword v195, v194, s[32:33] sc1
s_mov_b64 exec, -1
L_np54:
global_load_dword v243, v18, s[32:33] sc1
v_add_u32 v15, -56, v15
ds_read_b64 v[32:33], v15 offset:0
ds_read_b64 v[34:35], v15 offset:8
ds_read_b64 v[36:37], v15 offset:16
ds_read_b64 v[38:39], v15 offset:24
ds_read_b64 v[40:41], v15 offset:32
ds_read_b64 v[42:43], v15 offset:40
ds_read_b64 v[44:45], v15 offset:48
ds_read_b64 v[46:47], v15 offset:2304
ds_read_b64 v[48:49], v15 offset:2312
ds_read_b64 v[50:51], v15 offset:2320
ds_read_b64 v[52:53], v15 offset:2328
ds_read_b64 v[54:55], v15 offset:2336
ds_read_b64 v[56:57], v15 offset:2344
ds_read_b64 v[58:59], v15 offset:2352
s_waitcnt lgkmcnt(0)
v_fma_f32 v60, v180, v32, v34
v_fma_f32 v61, v180, v33, v35
v_fma_f32 v34, -v181, v33, v60
v_fma_f32 v35, v181, v32, v61
v_fma_f32 v60, v180, v34, v36
v_fma_f32 v61, v180, v35, v37
v_fma_f32 v36, -v181, v35, v60
v_fma_f32 v37, v181, v34, v61
v_fma_f32 v60, v180, v36, v38
v_fma_f32 v61, v180, v37, v39
v_fma_f32 v38, -v181, v37, v60
v_fma_f32 v39, v181, v36, v61
v_fma_f32 v60, v180, v38, v40
v_fma_f32 v61, v180, v39, v41
v_fma_f32 v40, -v181, v39, v60
v_fma_f32 v41, v181, v38, v61
v_fma_f32 v60, v180, v40, v42
v_fma_f32 v61, v180, v41, v43
v_fma_f32 v42, -v181, v41, v60
v_fma_f32 v43, v181, v40, v61
v_fma_f32 v60, v180, v42, v44
v_fma_f32 v61, v180, v43, v45
v_fma_f32 v128, -v181, v43, v60
v_fma_f32 v130, v181, v42, v61
v_fma_f32 v60, v176, v128, v78
v_fma_f32 v61, v176, v130, v94
v_fma_f32 v129, -v177, v130, v60
v_fma_f32 v131, v177, v128, v61
v_fma_f32 v60, v182, v46, v48
v_fma_f32 v61, v182, v47, v49
v_fma_f32 v48, -v183, v47, v60
v_fma_f32 v49, v183, v46, v61
v_fma_f32 v60, v182, v48, v50
v_fma_f32 v61, v182, v49, v51
v_fma_f32 v50, -v183, v49, v60
v_fma_f32 v51, v183, v48, v61
v_fma_f32 v60, v182, v50, v52
v_fma_f32 v61, v182, v51, v53
v_fma_f32 v52, -v183, v51, v60
v_fma_f32 v53, v183, v50, v61
v_fma_f32 v60, v182, v52, v54
v_fma_f32 v61, v182, v53, v55
v_fma_f32 v54, -v183, v53, v60
v_fma_f32 v55, v183, v52, v61
v_fma_f32 v60, v182, v54, v56
v_fma_f32 v61, v182, v55, v57
v_fma_f32 v56, -v183, v55, v60
v_fma_f32 v57, v183, v54, v61
v_fma_f32 v60, v182, v56, v58
v_fma_f32 v61, v182, v57, v59
v_fma_f32 v132, -v183, v57, v60
v_fma_f32 v134, v183, v56, v61
v_fma_f32 v60, v178, v132, v110
v_fma_f32 v61, v178, v134, v126
v_fma_f32 v133, -v179, v134, v60
v_fma_f32 v135, v179, v132, v61
v_pk_mul_f32 v[32:33], v[24:25], v[64:65] op_sel_hi:[0,1]
v_pk_mul_f32 v[34:35], v[24:25], v[80:81] op_sel_hi:[0,1] neg_lo:[1,0] neg_hi:[1,0]
v_pk_fma_f32 v[34:35], v[24:25], v[64:65], v[34:35] op_sel:[1,0,0] neg_lo:[1,0,0] neg_hi:[1,0,0]
v_pk_fma_f32 v[64:65], v[24:25], v[80:81], v[32:33] op_sel:[1,0,0] neg_lo:[1,0,0] neg_hi:[1,0,0]
v_mov_b64 v[80:81], v[34:35]
v_pk_mul_f32 v[36:37], v[26:27], v[96:97] op_sel_hi:[0,1]
v_pk_mul_f32 v[38:39], v[26:27], v[112:113] op_sel_hi:[0,1] neg_lo:[1,0] neg_hi:[1,0]
v_pk_fma_f32 v[38:39], v[26:27], v[96:97], v[38:39] op_sel:[1,0,0] neg_lo:[1,0,0] neg_hi:[1,0,0]
v_pk_fma_f32 v[96:97], v[26:27], v[112:113], v[36:37] op_sel:[1,0,0] neg_lo:[1,0,0] neg_hi:[1,0,0]
v_mov_b64 v[112:113], v[38:39]
v_pk_mul_f32 v[32:33], v[24:25], v[66:67] op_sel_hi:[0,1]
v_pk_mul_f32 v[34:35], v[24:25], v[82:83] op_sel_hi:[0,1] neg_lo:[1,0] neg_hi:[1,0]
v_pk_fma_f32 v[34:35], v[24:25], v[66:67], v[34:35] op_sel:[1,0,0] neg_lo:[1,0,0] neg_hi:[1,0,0]
v_pk_fma_f32 v[66:67], v[24:25], v[82:83], v[32:33] op_sel:[1,0,0] neg_lo:[1,0,0] neg_hi:[1,0,0]
v_mov_b64 v[82:83], v[34:35]
v_pk_mul_f32 v[36:37], v[26:27], v[98:99] op_sel_hi:[0,1]
v_pk_mul_f32 v[38:39], v[26:27], v[114:115] op_sel_hi:[0,1] neg_lo:[1,0] neg_hi:[1,0]
v_pk_fma_f32 v[38:39], v[26:27], v[98:99], v[38:39] op_sel:[1,0,0] neg_lo:[1,0,0] neg_hi:[1,0,0]
v_pk_fma_f32 v[98:99], v[26:27], v[114:115], v[36:37] op_sel:[1,0,0] neg_lo:[1,0,0] neg_hi:[1,0,0]
v_mov_b64 v[114:115], v[38:39]
v_pk_mul_f32 v[32:33], v[24:25], v[68:69] op_sel_hi:[0,1]
v_pk_mul_f32 v[34:35], v[24:25], v[84:85] op_sel_hi:[0,1] neg_lo:[1,0] neg_hi:[1,0]
v_pk_fma_f32 v[34:35], v[24:25], v[68:69], v[34:35] op_sel:[1,0,0] neg_lo:[1,0,0] neg_hi:[1,0,0]
v_pk_fma_f32 v[68:69], v[24:25], v[84:85], v[32:33] op_sel:[1,0,0] neg_lo:[1,0,0] neg_hi:[1,0,0]
v_mov_b64 v[84:85], v[34:35]
v_pk_mul_f32 v[36:37], v[26:27], v[100:101] op_sel_hi:[0,1]
v_pk_mul_f32 v[38:39], v[26:27], v[116:117] op_sel_hi:[0,1] neg_lo:[1,0] neg_hi:[1,0]
v_pk_fma_f32 v[38:39], v[26:27], v[100:101], v[38:39] op_sel:[1,0,0] neg_lo:[1,0,0] neg_hi:[1,0,0]
v_pk_fma_f32 v[100:101], v[26:27], v[116:117], v[36:37] op_sel:[1,0,0] neg_lo:[1,0,0] neg_hi:[1,0,0]
v_mov_b64 v[116:117], v[38:39]
v_pk_mul_f32 v[32:33], v[24:25], v[70:71] op_sel_hi:[0,1]
v_pk_mul_f32 v[34:35], v[24:25], v[86:87] op_sel_hi:[0,1] neg_lo:[1,0] neg_hi:[1,0]
v_pk_fma_f32 v[34:35], v[24:25], v[70:71], v[34:35] op_sel:[1,0,0] neg_lo:[1,0,0] neg_hi:[1,0,0]
v_pk_fma_f32 v[70:71], v[24:25], v[86:87], v[32:33] op_sel:[1,0,0] neg_lo:[1,0,0] neg_hi:[1,0,0]
v_mov_b64 v[86:87], v[34:35]
v_pk_mul_f32 v[36:37], v[26:27], v[102:103] op_sel_hi:[0,1]
v_pk_mul_f32 v[38:39], v[26:27], v[118:119] op_sel_hi:[0,1] neg_lo:[1,0] neg_hi:[1,0]
v_pk_fma_f32 v[38:39], v[26:27], v[102:103], v[38:39] op_sel:[1,0,0] neg_lo:[1,0,0] neg_hi:[1,0,0]
v_pk_fma_f32 v[102:103], v[26:27], v[118:119], v[36:37] op_sel:[1,0,0] neg_lo:[1,0,0] neg_hi:[1,0,0]
v_mov_b64 v[118:119], v[38:39]
v_pk_mul_f32 v[32:33], v[24:25], v[72:73] op_sel_hi:[0,1]
v_pk_mul_f32 v[34:35], v[24:25], v[88:89] op_sel_hi:[0,1] neg_lo:[1,0] neg_hi:[1,0]
v_pk_fma_f32 v[34:35], v[24:25], v[72:73], v[34:35] op_sel:[1,0,0] neg_lo:[1,0,0] neg_hi:[1,0,0]
v_pk_fma_f32 v[72:73], v[24:25], v[88:89], v[32:33] op_sel:[1,0,0] neg_lo:[1,0,0] neg_hi:[1,0,0]
v_mov_b64 v[88:89], v[34:35]
v_pk_mul_f32 v[36:37], v[26:27], v[104:105] op_sel_hi:[0,1]
v_pk_mul_f32 v[38:39], v[26:27], v[120:121] op_sel_hi:[0,1] neg_lo:[1,0] neg_hi:[1,0]
v_pk_fma_f32 v[38:39], v[26:27], v[104:105], v[38:39] op_sel:[1,0,0] neg_lo:[1,0,0] neg_hi:[1,0,0]
v_pk_fma_f32 v[104:105], v[26:27], v[120:121], v[36:37] op_sel:[1,0,0] neg_lo:[1,0,0] neg_hi:[1,0,0]
v_mov_b64 v[120:121], v[38:39]
v_pk_mul_f32 v[32:33], v[24:25], v[74:75] op_sel_hi:[0,1]
v_pk_mul_f32 v[34:35], v[24:25], v[90:91] op_sel_hi:[0,1] neg_lo:[1,0] neg_hi:[1,0]
v_pk_fma_f32 v[34:35], v[24:25], v[74:75], v[34:35] op_sel:[1,0,0] neg_lo:[1,0,0] neg_hi:[1,0,0]
v_pk_fma_f32 v[74:75], v[24:25], v[90:91], v[32:33] op_sel:[1,0,0] neg_lo:[1,0,0] neg_hi:[1,0,0]
v_mov_b64 v[90:91], v[34:35]
v_pk_mul_f32 v[36:37], v[26:27], v[106:107] op_sel_hi:[0,1]
v_pk_mul_f32 v[38:39], v[26:27], v[122:123] op_sel_hi:[0,1] neg_lo:[1,0] neg_hi:[1,0]
v_pk_fma_f32 v[38:39], v[26:27], v[106:107], v[38:39] op_sel:[1,0,0] neg_lo:[1,0,0] neg_hi:[1,0,0]
v_pk_fma_f32 v[106:107], v[26:27], v[122:123], v[36:37] op_sel:[1,0,0] neg_lo:[1,0,0] neg_hi:[1,0,0]
v_mov_b64 v[122:123], v[38:39]
v_pk_mul_f32 v[32:33], v[24:25], v[76:77] op_sel_hi:[0,1]
v_pk_mul_f32 v[34:35], v[24:25], v[92:93] op_sel_hi:[0,1] neg_lo:[1,0] neg_hi:[1,0]
v_pk_fma_f32 v[34:35], v[24:25], v[76:77], v[34:35] op_sel:[1,0,0] neg_lo:[1,0,0] neg_hi:[1,0,0]
v_pk_fma_f32 v[76:77], v[24:25], v[92:93], v[32:33] op_sel:[1,0,0] neg_lo:[1,0,0] neg_hi:[1,0,0]
v_mov_b64 v[92:93], v[34:35]
v_pk_mul_f32 v[36:37], v[26:27], v[108:109] op_sel_hi:[0,1]
v_pk_mul_f32 v[38:39], v[26:27], v[124:125] op_sel_hi:[0,1] neg_lo:[1,0] neg_hi:[1,0]
v_pk_fma_f32 v[38:39], v[26:27], v[108:109], v[38:39] op_sel:[1,0,0] neg_lo:[1,0,0] neg_hi:[1,0,0]
v_pk_fma_f32 v[108:109], v[26:27], v[124:125], v[36:37] op_sel:[1,0,0] neg_lo:[1,0,0] neg_hi:[1,0,0]
v_mov_b64 v[124:125], v[38:39]
v_pk_mul_f32 v[32:33], v[24:25], v[78:79] op_sel_hi:[0,1]
v_pk_mul_f32 v[34:35], v[24:25], v[94:95] op_sel_hi:[0,1] neg_lo:[1,0] neg_hi:[1,0]
v_pk_fma_f32 v[34:35], v[24:25], v[78:79], v[34:35] op_sel:[1,0,0] neg_lo:[1,0,0] neg_hi:[1,0,0]
v_pk_fma_f32 v[78:79], v[24:25], v[94:95], v[32:33] op_sel:[1,0,0] neg_lo:[1,0,0] neg_hi:[1,0,0]
v_mov_b64 v[94:95], v[34:35]
v_pk_mul_f32 v[36:37], v[26:27], v[110:111] op_sel_hi:[0,1]
v_pk_mul_f32 v[38:39], v[26:27], v[126:127] op_sel_hi:[0,1] neg_lo:[1,0] neg_hi:[1,0]
v_pk_fma_f32 v[38:39], v[26:27], v[110:111], v[38:39] op_sel:[1,0,0] neg_lo:[1,0,0] neg_hi:[1,0,0]
v_pk_fma_f32 v[110:111], v[26:27], v[126:127], v[36:37] op_sel:[1,0,0] neg_lo:[1,0,0] neg_hi:[1,0,0]
v_mov_b64 v[126:127], v[38:39]
buffer_load_dwordx4 v[144:147], v136, s[40:43], 0 offen sc1
buffer_load_dwordx4 v[148:151], v137, s[40:43], 0 offen sc1
buffer_load_dwordx4 v[152:155], v138, s[40:43], 0 offen sc1
buffer_load_dwordx4 v[156:159], v139, s[40:43], 0 offen sc1
buffer_load_dwordx4 v[160:163], v140, s[40:43], 0 offen sc1
buffer_load_dwordx4 v[164:167], v141, s[40:43], 0 offen sc1
buffer_load_dwordx4 v[168:171], v142, s[40:43], 0 offen sc1
buffer_load_dwordx4 v[172:175], v143, s[40:43], 0 offen sc1
global_load_dword v197, v196, s[32:33] sc1
v_mov_b32 v14, 1
s_mov_b64 exec, 1
ds_write_b32 v13, v14
s_mov_b64 exec, -1
s_xor_b32 s60, s68, s101
s_xor_b32 s60, s60, 1
s_lshl_b32 s60, s60, 6
s_add_u32 s60, s60, s66
v_lshrrev_b32 v8, 3, v1
v_lshl_add_u32 v8, v8, 1, s60
v_lshlrev_b32 v8, 11, v8
v_and_b32 v14, 7, v1
v_lshrrev_b32 v15, 4, v1
v_xor_b32 v14, v14, v15
v_lshlrev_b32 v14, 4, v14
v_xor_b32 v15, 64, v14
v_add_u32 v244, v8, v14
v_add_u32 v245, v8, v15
v_add_u32 v245, 31744, v245
v_add_u32 v246, v8, v14
v_add_u32 v246, 63488, v246
v_add_u32 v247, v8, v15
v_add_u32 v247, 95232, v247
s_and_b32 s64, s36, 7
s_lshl_b32 s60, s64, 18
s_lshl_b32 s61, s101, 10
s_add_u32 s60, s60, s61
s_add_u32 s48, s20, s60
s_addc_u32 s49, s21, 0
s_sub_u32 s50, 262144, s61
s_mov_b32 s51, 0x20000
s_add_u32 s52, s22, s60
s_addc_u32 s53, s23, 0
s_sub_u32 s54, 262144, s61
s_mov_b32 s55, 0x20000
s_lshl_b32 s61, s64, 1
s_add_u32 s61, s61, s101
s_lshl_b32 s61, s61, 7
s_lshl_b32 s63, s35, 1
s_add_u32 s63, s63, s68
s_lshl_b32 s60, s63, 17
s_add_u32 s60, s60, s61
s_add_u32 s56, s10, s60
s_addc_u32 s57, s11, 0
s_sub_u32 s58, 131072, s61
s_mov_b32 s59, 0x20000
s_add_u32 s26, s26, s61
s_addc_u32 s27, s27, 0
s_lshl_b32 s61, s61, 1
s_add_u32 s61, s61, 4096
s_lshl_b32 s60, s63, 19
s_add_u32 s60, s60, s61
s_add_u32 s28, s28, s60
s_addc_u32 s29, s29, 0
s_sub_u32 s24, 0x80000, s61
s_lshl_b32 s67, s34, 12
s_lshl_b32 s65, s64, 13
s_lshl_b32 s64, s64, 7
s_lshl_b32 s60, s68, 14
s_lshl_b32 s61, s66, 11
s_add_u32 s60, s60, s61
s_add_u32 s60, s60, 65536
v_add_u32 v16, s60, v10
s_lshl_b32 s60, s34, 13
s_add_u32 s60, s60, 65536
v_add_u32 v17, s60, v11
v_xor_b32 v20, 0, v7
v_add_u32 v24, 0x10000, v20
v_xor_b32 v21, 32, v7
v_add_u32 v25, 0x10000, v21
v_xor_b32 v22, 64, v7
v_add_u32 v26, 0x10000, v22
v_xor_b32 v23, 96, v7
v_add_u32 v27, 0x10000, v23
s_mul_i32 s14, s63, 262144
s_lshl_b32 s61, s36, 13
s_add_u32 s14, s14, s61
s_lshl_b32 s61, s66, 11
s_add_u32 s14, s14, s61
v_cmp_gt_u32 vcc, 0x40000, v136
s_nop 1
v_cndmask_b32 v40, 0, v202, vcc
v_cmp_gt_u32 vcc, 0x40000, v137
s_nop 1
v_cndmask_b32 v41, 0, v202, vcc
v_cmp_gt_u32 vcc, 0x40000, v138
s_nop 1
v_cndmask_b32 v42, 0, v202, vcc
v_cmp_gt_u32 vcc, 0x40000, v139
s_nop 1
v_cndmask_b32 v43, 0, v202, vcc
v_cmp_gt_u32 vcc, 0x40000, v140
s_nop 1
v_cndmask_b32 v44, 0, v202, vcc
v_cmp_gt_u32 vcc, 0x40000, v141
s_nop 1
v_cndmask_b32 v45, 0, v202, vcc
v_cmp_gt_u32 vcc, 0x40000, v142
s_nop 1
v_cndmask_b32 v46, 0, v202, vcc
v_cmp_gt_u32 vcc, 0x40000, v143
s_nop 1
v_cndmask_b32 v47, 0, v202, vcc
s_mov_b32 s69, 0
L_poll55:
v_mov_b32 v8, 0
s_waitcnt vmcnt(8)
v_bitop3_b32 v8, v8, v146, v40 bitop3:0xf6
v_bitop3_b32 v8, v8, v147, v40 bitop3:0xf6
s_waitcnt vmcnt(7)
v_bitop3_b32 v8, v8, v150, v41 bitop3:0xf6
v_bitop3_b32 v8, v8, v151, v41 bitop3:0xf6
s_waitcnt vmcnt(6)
v_bitop3_b32 v8, v8, v154, v42 bitop3:0xf6
v_bitop3_b32 v8, v8, v155, v42 bitop3:0xf6
s_waitcnt vmcnt(5)
v_bitop3_b32 v8, v8, v158, v43 bitop3:0xf6
v_bitop3_b32 v8, v8, v159, v43 bitop3:0xf6
s_waitcnt vmcnt(4)
v_bitop3_b32 v8, v8, v162, v44 bitop3:0xf6
v_bitop3_b32 v8, v8, v163, v44 bitop3:0xf6
s_waitcnt vmcnt(3)
v_bitop3_b32 v8, v8, v166, v45 bitop3:0xf6
v_bitop3_b32 v8, v8, v167, v45 bitop3:0xf6
s_waitcnt vmcnt(2)
v_bitop3_b32 v8, v8, v170, v46 bitop3:0xf6
v_bitop3_b32 v8, v8, v171, v46 bitop3:0xf6
s_waitcnt vmcnt(1)
v_bitop3_b32 v8, v8, v174, v47 bitop3:0xf6
v_bitop3_b32 v8, v8, v175, v47 bitop3:0xf6
s_waitcnt vmcnt(0)
v_xor_b32 v197, v194, v197
v_lshrrev_b32 v9, 4, v197
v_or_b32 v8, v8, v9
v_cmp_ne_u32 vcc, 0, v8
s_nop 0
s_cbranch_vccz L_polled56
s_add_u32 s69, s69, 1
s_cmp_ge_u32 s69, 200000
s_cbranch_scc1 L_polled56
buffer_load_dwordx4 v[144:147], v136, s[40:43], 0 offen sc1
buffer_load_dwordx4 v[148:151], v137, s[40:43], 0 offen sc1
buffer_load_dwordx4 v[152:155], v138, s[40:43], 0 offen sc1
buffer_load_dwordx4 v[156:159], v139, s[40:43], 0 offen sc1
buffer_load_dwordx4 v[160:163], v140, s[40:43], 0 offen sc1
buffer_load_dwordx4 v[164:167], v141, s[40:43], 0 offen sc1
buffer_load_dwordx4 v[168:171], v142, s[40:43], 0 offen sc1
buffer_load_dwordx4 v[172:175], v143, s[40:43], 0 offen sc1
global_load_dword v197, v196, s[32:33] sc1
s_branch L_poll55
L_polled56:
v_cmp_ne_u32 vcc, 0, v197
s_nop 0
s_cmp_eq_u64 vcc, 0
s_cselect_b32 s100, 1, 0
s_add_u32 m0, s67, 0
s_add_u32 s62, s64, 0
s_and_b32 s62, s62, 0x3ff
buffer_load_dwordx4 v244, s[48:51], s62 offen offset:0 lds
buffer_load_dwordx4 v245, s[48:51], s62 offen offset:1024 lds
buffer_load_dwordx4 v246, s[48:51], s62 offen offset:2048 lds
buffer_load_dwordx4 v247, s[48:51], s62 offen offset:3072 lds
s_add_u32 m0, s67, 16384
s_nop 0
buffer_load_dwordx4 v244, s[52:55], s62 offen offset:0 lds
buffer_load_dwordx4 v245, s[52:55], s62 offen offset:1024 lds
buffer_load_dwordx4 v246, s[52:55], s62 offen offset:2048 lds
buffer_load_dwordx4 v247, s[52:55], s62 offen offset:3072 lds
v_mov_b32 v14, 2
s_mov_b64 exec, 1
ds_write_b32 v13, v14
s_mov_b64 exec, -1
v_fma_f32 v40, v2, v172, v168
v_fma_f32 v41, v2, v173, v169
v_fma_f32 v48, -v3, v173, v40
v_fma_f32 v49, v3, v172, v41
v_fma_f32 v40, v2, v48, v164
v_fma_f32 v41, v2, v49, v165
v_fma_f32 v172, -v3, v49, v40
v_fma_f32 v173, v3, v48, v41
v_fma_f32 v40, v2, v172, v160
v_fma_f32 v41, v2, v173, v161
v_fma_f32 v48, -v3, v173, v40
v_fma_f32 v49, v3, v172, v41
v_fma_f32 v40, v2, v48, v156
v_fma_f32 v41, v2, v49, v157
v_fma_f32 v172, -v3, v49, v40
v_fma_f32 v173, v3, v48, v41
v_fma_f32 v40, v2, v172, v152
v_fma_f32 v41, v2, v173, v153
v_fma_f32 v48, -v3, v173, v40
v_fma_f32 v49, v3, v172, v41
v_fma_f32 v40, v2, v48, v148
v_fma_f32 v41, v2, v49, v149
v_fma_f32 v172, -v3, v49, v40
v_fma_f32 v173, v3, v48, v41
v_fma_f32 v40, v2, v172, v144
v_fma_f32 v41, v2, v173, v145
v_fma_f32 v48, -v3, v173, v40
v_fma_f32 v49, v3, v172, v41
v_mov_b32 v50, v48
v_mov_b32 v51, v49
s_nop 0
v_permlane32_swap_b32 v48, v50
v_permlane32_swap_b32 v49, v51
v_fma_f32 v40, v30, v50, v48
v_fma_f32 v41, v30, v51, v49
v_fma_f32 v52, -v31, v51, v40
v_fma_f32 v53, v31, v50, v41
v_mov_b32 v54, v52
v_mov_b32 v55, v53
s_nop 0
v_permlane16_swap_b32 v52, v54
v_permlane16_swap_b32 v53, v55
v_pk_fma_f32 v[128:129], v[52:53], v[184:185], v[128:129] op_sel_hi:[0,1,1]
v_pk_fma_f32 v[130:131], v[52:53], v[186:187], v[130:131] op_sel_hi:[0,1,1]
v_pk_fma_f32 v[128:129], v[52:53], v[186:187], v[128:129] op_sel:[1,0,0] neg_lo:[1,0,0] neg_hi:[1,0,0]
v_pk_fma_f32 v[130:131], v[52:53], v[184:185], v[130:131] op_sel:[1,0,0]
v_pk_fma_f32 v[132:133], v[54:55], v[188:189], v[132:133] op_sel_hi:[0,1,1]
v_pk_fma_f32 v[134:135], v[54:55], v[190:191], v[134:135] op_sel_hi:[0,1,1]
v_pk_fma_f32 v[132:133], v[54:55], v[190:191], v[132:133] op_sel:[1,0,0] neg_lo:[1,0,0] neg_hi:[1,0,0]
v_pk_fma_f32 v[134:135], v[54:55], v[188:189], v[134:135] op_sel:[1,0,0]
v_pk_fma_f32 v[64:65], v[208:209], v[128:129], v[64:65] op_sel_hi:[0,1,1]
v_pk_fma_f32 v[80:81], v[208:209], v[130:131], v[80:81] op_sel_hi:[0,1,1] neg_lo:[1,0,0] neg_hi:[1,0,0]
v_pk_fma_f32 v[64:65], v[208:209], v[130:131], v[64:65] op_sel:[1,0,0] neg_lo:[1,0,0] neg_hi:[1,0,0]
v_pk_fma_f32 v[80:81], v[208:209], v[128:129], v[80:81] op_sel:[1,0,0] neg_lo:[1,0,0] neg_hi:[1,0,0]
v_cvt_pk_bf16_f32 v144, v64, v65
v_cvt_pk_bf16_f32 v152, v80, v81
v_pk_fma_f32 v[96:97], v[224:225], v[132:133], v[96:97] op_sel_hi:[0,1,1]
v_pk_fma_f32 v[112:113], v[224:225], v[134:135], v[112:113] op_sel_hi:[0,1,1] neg_lo:[1,0,0] neg_hi:[1,0,0]
v_pk_fma_f32 v[96:97], v[224:225], v[134:135], v[96:97] op_sel:[1,0,0] neg_lo:[1,0,0] neg_hi:[1,0,0]
v_pk_fma_f32 v[112:113], v[224:225], v[132:133], v[112:113] op_sel:[1,0,0] neg_lo:[1,0,0] neg_hi:[1,0,0]
v_cvt_pk_bf16_f32 v160, v96, v97
v_cvt_pk_bf16_f32 v168, v112, v113
v_pk_fma_f32 v[66:67], v[210:211], v[128:129], v[66:67] op_sel_hi:[0,1,1]
v_pk_fma_f32 v[82:83], v[210:211], v[130:131], v[82:83] op_sel_hi:[0,1,1] neg_lo:[1,0,0] neg_hi:[1,0,0]
v_pk_fma_f32 v[66:67], v[210:211], v[130:131], v[66:67] op_sel:[1,0,0] neg_lo:[1,0,0] neg_hi:[1,0,0]
v_pk_fma_f32 v[82:83], v[210:211], v[128:129], v[82:83] op_sel:[1,0,0] neg_lo:[1,0,0] neg_hi:[1,0,0]
v_cvt_pk_bf16_f32 v145, v66, v67
v_cvt_pk_bf16_f32 v153, v82, v83
v_pk_fma_f32 v[98:99], v[226:227], v[132:133], v[98:99] op_sel_hi:[0,1,1]
v_pk_fma_f32 v[114:115], v[226:227], v[134:135], v[114:115] op_sel_hi:[0,1,1] neg_lo:[1,0,0] neg_hi:[1,0,0]
v_pk_fma_f32 v[98:99], v[226:227], v[134:135], v[98:99] op_sel:[1,0,0] neg_lo:[1,0,0] neg_hi:[1,0,0]
v_pk_fma_f32 v[114:115], v[226:227], v[132:133], v[114:115] op_sel:[1,0,0] neg_lo:[1,0,0] neg_hi:[1,0,0]
v_cvt_pk_bf16_f32 v161, v98, v99
v_cvt_pk_bf16_f32 v169, v114, v115
v_pk_fma_f32 v[68:69], v[212:213], v[128:129], v[68:69] op_sel_hi:[0,1,1]
v_pk_fma_f32 v[84:85], v[212:213], v[130:131], v[84:85] op_sel_hi:[0,1,1] neg_lo:[1,0,0] neg_hi:[1,0,0]
v_pk_fma_f32 v[68:69], v[212:213], v[130:131], v[68:69] op_sel:[1,0,0] neg_lo:[1,0,0] neg_hi:[1,0,0]
v_pk_fma_f32 v[84:85], v[212:213], v[128:129], v[84:85] op_sel:[1,0,0] neg_lo:[1,0,0] neg_hi:[1,0,0]
v_cvt_pk_bf16_f32 v146, v68, v69
v_cvt_pk_bf16_f32 v154, v84, v85
v_pk_fma_f32 v[100:101], v[228:229], v[132:133], v[100:101] op_sel_hi:[0,1,1]
v_pk_fma_f32 v[116:117], v[228:229], v[134:135], v[116:117] op_sel_hi:[0,1,1] neg_lo:[1,0,0] neg_hi:[1,0,0]
v_pk_fma_f32 v[100:101], v[228:229], v[134:135], v[100:101] op_sel:[1,0,0] neg_lo:[1,0,0] neg_hi:[1,0,0]
v_pk_fma_f32 v[116:117], v[228:229], v[132:133], v[116:117] op_sel:[1,0,0] neg_lo:[1,0,0] neg_hi:[1,0,0]
v_cvt_pk_bf16_f32 v162, v100, v101
v_cvt_pk_bf16_f32 v170, v116, v117
v_pk_fma_f32 v[70:71], v[214:215], v[128:129], v[70:71] op_sel_hi:[0,1,1]
v_pk_fma_f32 v[86:87], v[214:215], v[130:131], v[86:87] op_sel_hi:[0,1,1] neg_lo:[1,0,0] neg_hi:[1,0,0]
v_pk_fma_f32 v[70:71], v[214:215], v[130:131], v[70:71] op_sel:[1,0,0] neg_lo:[1,0,0] neg_hi:[1,0,0]
v_pk_fma_f32 v[86:87], v[214:215], v[128:129], v[86:87] op_sel:[1,0,0] neg_lo:[1,0,0] neg_hi:[1,0,0]
v_cvt_pk_bf16_f32 v147, v70, v71
v_cvt_pk_bf16_f32 v155, v86, v87
v_pk_fma_f32 v[102:103], v[230:231], v[132:133], v[102:103] op_sel_hi:[0,1,1]
v_pk_fma_f32 v[118:119], v[230:231], v[134:135], v[118:119] op_sel_hi:[0,1,1] neg_lo:[1,0,0] neg_hi:[1,0,0]
v_pk_fma_f32 v[102:103], v[230:231], v[134:135], v[102:103] op_sel:[1,0,0] neg_lo:[1,0,0] neg_hi:[1,0,0]
v_pk_fma_f32 v[118:119], v[230:231], v[132:133], v[118:119] op_sel:[1,0,0] neg_lo:[1,0,0] neg_hi:[1,0,0]
v_cvt_pk_bf16_f32 v163, v102, v103
v_cvt_pk_bf16_f32 v171, v118, v119
v_mfma_f32_16x16x32_bf16 v[32:35], v[144:147], v[248:251], 0
v_mfma_f32_16x16x32_bf16 v[36:39], v[160:163], v[248:251], 0
v_mfma_f32_16x16x32_bf16 v[40:43], v[144:147], v[252:255], 0
v_mfma_f32_16x16x32_bf16 v[44:47], v[160:163], v[252:255], 0
v_mfma_f32_16x16x32_bf16 v[48:51], v[152:155], v[248:251], 0
v_mfma_f32_16x16x32_bf16 v[52:55], v[168:171], v[248:251], 0
v_mfma_f32_16x16x32_bf16 v[56:59], v[152:155], v[252:255], 0
v_mfma_f32_16x16x32_bf16 v[60:63], v[168:171], v[252:255], 0
v_pk_fma_f32 v[72:73], v[216:217], v[128:129], v[72:73] op_sel_hi:[0,1,1]
v_pk_fma_f32 v[88:89], v[216:217], v[130:131], v[88:89] op_sel_hi:[0,1,1] neg_lo:[1,0,0] neg_hi:[1,0,0]
v_pk_fma_f32 v[72:73], v[216:217], v[130:131], v[72:73] op_sel:[1,0,0] neg_lo:[1,0,0] neg_hi:[1,0,0]
v_pk_fma_f32 v[88:89], v[216:217], v[128:129], v[88:89] op_sel:[1,0,0] neg_lo:[1,0,0] neg_hi:[1,0,0]
v_cvt_pk_bf16_f32 v148, v72, v73
v_cvt_pk_bf16_f32 v156, v88, v89
v_pk_fma_f32 v[104:105], v[232:233], v[132:133], v[104:105] op_sel_hi:[0,1,1]
v_pk_fma_f32 v[120:121], v[232:233], v[134:135], v[120:121] op_sel_hi:[0,1,1] neg_lo:[1,0,0] neg_hi:[1,0,0]
v_pk_fma_f32 v[104:105], v[232:233], v[134:135], v[104:105] op_sel:[1,0,0] neg_lo:[1,0,0] neg_hi:[1,0,0]
v_pk_fma_f32 v[120:121], v[232:233], v[132:133], v[120:121] op_sel:[1,0,0] neg_lo:[1,0,0] neg_hi:[1,0,0]
v_cvt_pk_bf16_f32 v164, v104, v105
v_cvt_pk_bf16_f32 v172, v120, v121
v_pk_fma_f32 v[74:75], v[218:219], v[128:129], v[74:75] op_sel_hi:[0,1,1]
v_pk_fma_f32 v[90:91], v[218:219], v[130:131], v[90:91] op_sel_hi:[0,1,1] neg_lo:[1,0,0] neg_hi:[1,0,0]
v_pk_fma_f32 v[74:75], v[218:219], v[130:131], v[74:75] op_sel:[1,0,0] neg_lo:[1,0,0] neg_hi:[1,0,0]
v_pk_fma_f32 v[90:91], v[218:219], v[128:129], v[90:91] op_sel:[1,0,0] neg_lo:[1,0,0] neg_hi:[1,0,0]
v_cvt_pk_bf16_f32 v149, v74, v75
v_cvt_pk_bf16_f32 v157, v90, v91
v_pk_fma_f32 v[106:107], v[234:235], v[132:133], v[106:107] op_sel_hi:[0,1,1]
v_pk_fma_f32 v[122:123], v[234:235], v[134:135], v[122:123] op_sel_hi:[0,1,1] neg_lo:[1,0,0] neg_hi:[1,0,0]
v_pk_fma_f32 v[106:107], v[234:235], v[134:135], v[106:107] op_sel:[1,0,0] neg_lo:[1,0,0] neg_hi:[1,0,0]
v_pk_fma_f32 v[122:123], v[234:235], v[132:133], v[122:123] op_sel:[1,0,0] neg_lo:[1,0,0] neg_hi:[1,0,0]
v_cvt_pk_bf16_f32 v165, v106, v107
v_cvt_pk_bf16_f32 v173, v122, v123
s_add_u32 s61, s14, 0
v_cvt_pk_bf16_f32 v176, v32, v33
v_cvt_pk_bf16_f32 v177, v34, v35
v_cvt_pk_bf16_f32 v178, v36, v37
v_cvt_pk_bf16_f32 v179, v38, v39
buffer_store_dwordx4 v[176:179], v10, s[44:47], s61 offen offset:0 sc1
ds_write_b128 v16, v[176:179] offset:0
s_add_u32 s61, s14, 131072
v_cvt_pk_bf16_f32 v180, v40, v41
v_cvt_pk_bf16_f32 v181, v42, v43
v_cvt_pk_bf16_f32 v182, v44, v45
v_cvt_pk_bf16_f32 v183, v46, v47
buffer_store_dwordx4 v[180:183], v10, s[44:47], s61 offen offset:0 sc1
ds_write_b128 v16, v[180:183] offset:8192
s_add_u32 s61, s14, 4096
v_cvt_pk_bf16_f32 v184, v48, v49
v_cvt_pk_bf16_f32 v185, v50, v51
v_cvt_pk_bf16_f32 v186, v52, v53
v_cvt_pk_bf16_f32 v187, v54, v55
buffer_store_dwordx4 v[184:187], v10, s[44:47], s61 offen offset:0 sc1
ds_write_b128 v16, v[184:187] offset:4096
s_add_u32 s61, s14, 135168
v_cvt_pk_bf16_f32 v188, v56, v57
v_cvt_pk_bf16_f32 v189, v58, v59
v_cvt_pk_bf16_f32 v190, v60, v61
v_cvt_pk_bf16_f32 v191, v62, v63
buffer_store_dwordx4 v[188:191], v10, s[44:47], s61 offen offset:0 sc1
ds_write_b128 v16, v[188:191] offset:12288
v_pk_fma_f32 v[76:77], v[220:221], v[128:129], v[76:77] op_sel_hi:[0,1,1]
v_pk_fma_f32 v[92:93], v[220:221], v[130:131], v[92:93] op_sel_hi:[0,1,1] neg_lo:[1,0,0] neg_hi:[1,0,0]
v_pk_fma_f32 v[76:77], v[220:221], v[130:131], v[76:77] op_sel:[1,0,0] neg_lo:[1,0,0] neg_hi:[1,0,0]
v_pk_fma_f32 v[92:93], v[220:221], v[128:129], v[92:93] op_sel:[1,0,0] neg_lo:[1,0,0] neg_hi:[1,0,0]
v_cvt_pk_bf16_f32 v150, v76, v77
v_cvt_pk_bf16_f32 v158, v92, v93
v_pk_fma_f32 v[108:109], v[236:237], v[132:133], v[108:109] op_sel_hi:[0,1,1]
v_pk_fma_f32 v[124:125], v[236:237], v[134:135], v[124:125] op_sel_hi:[0,1,1] neg_lo:[1,0,0] neg_hi:[1,0,0]
v_pk_fma_f32 v[108:109], v[236:237], v[134:135], v[108:109] op_sel:[1,0,0] neg_lo:[1,0,0] neg_hi:[1,0,0]
v_pk_fma_f32 v[124:125], v[236:237], v[132:133], v[124:125] op_sel:[1,0,0] neg_lo:[1,0,0] neg_hi:[1,0,0]
v_cvt_pk_bf16_f32 v166, v108, v109
v_cvt_pk_bf16_f32 v174, v124, v125
v_pk_fma_f32 v[78:79], v[222:223], v[128:129], v[78:79] op_sel_hi:[0,1,1]
v_pk_fma_f32 v[94:95], v[222:223], v[130:131], v[94:95] op_sel_hi:[0,1,1] neg_lo:[1,0,0] neg_hi:[1,0,0]
v_pk_fma_f32 v[78:79], v[222:223], v[130:131], v[78:79] op_sel:[1,0,0] neg_lo:[1,0,0] neg_hi:[1,0,0]
v_pk_fma_f32 v[94:95], v[222:223], v[128:129], v[94:95] op_sel:[1,0,0] neg_lo:[1,0,0] neg_hi:[1,0,0]
v_cvt_pk_bf16_f32 v151, v78, v79
v_cvt_pk_bf16_f32 v159, v94, v95
v_pk_fma_f32 v[110:111], v[238:239], v[132:133], v[110:111] op_sel_hi:[0,1,1]
v_pk_fma_f32 v[126:127], v[238:239], v[134:135], v[126:127] op_sel_hi:[0,1,1] neg_lo:[1,0,0] neg_hi:[1,0,0]
v_pk_fma_f32 v[110:111], v[238:239], v[134:135], v[110:111] op_sel:[1,0,0] neg_lo:[1,0,0] neg_hi:[1,0,0]
v_pk_fma_f32 v[126:127], v[238:239], v[132:133], v[126:127] op_sel:[1,0,0] neg_lo:[1,0,0] neg_hi:[1,0,0]
v_cvt_pk_bf16_f32 v167, v110, v111
v_cvt_pk_bf16_f32 v175, v126, v127
v_mfma_f32_16x16x32_bf16 v[32:35], v[148:151], v[248:251], 0
v_mfma_f32_16x16x32_bf16 v[36:39], v[164:167], v[248:251], 0
v_mfma_f32_16x16x32_bf16 v[40:43], v[148:151], v[252:255], 0
v_mfma_f32_16x16x32_bf16 v[44:47], v[164:167], v[252:255], 0
v_mfma_f32_16x16x32_bf16 v[48:51], v[156:159], v[248:251], 0
v_mfma_f32_16x16x32_bf16 v[52:55], v[172:175], v[248:251], 0
v_mfma_f32_16x16x32_bf16 v[56:59], v[156:159], v[252:255], 0
v_mfma_f32_16x16x32_bf16 v[60:63], v[172:175], v[252:255], 0
s_add_u32 s61, s14, 0
v_cvt_pk_bf16_f32 v192, v32, v33
v_cvt_pk_bf16_f32 v193, v34, v35
v_cvt_pk_bf16_f32 v194, v36, v37
v_cvt_pk_bf16_f32 v195, v38, v39
buffer_store_dwordx4 v[192:195], v10, s[44:47], s61 offen offset:256 sc1
ds_write_b128 v16, v[192:195] offset:256
s_add_u32 s61, s14, 131072
v_cvt_pk_bf16_f32 v196, v40, v41
v_cvt_pk_bf16_f32 v197, v42, v43
v_cvt_pk_bf16_f32 v198, v44, v45
v_cvt_pk_bf16_f32 v199, v46, v47
buffer_store_dwordx4 v[196:199], v10, s[44:47], s61 offen offset:256 sc1
ds_write_b128 v16, v[196:199] offset:8448
s_add_u32 s61, s14, 4096
v_cvt_pk_bf16_f32 v200, v48, v49
v_cvt_pk_bf16_f32 v201, v50, v51
v_cvt_pk_bf16_f32 v202, v52, v53
v_cvt_pk_bf16_f32 v203, v54, v55
buffer_store_dwordx4 v[200:203], v10, s[44:47], s61 offen offset:256 sc1
ds_write_b128 v16, v[200:203] offset:4352
s_add_u32 s61, s14, 135168
v_cvt_pk_bf16_f32 v204, v56, v57
v_cvt_pk_bf16_f32 v205, v58, v59
v_cvt_pk_bf16_f32 v206, v60, v61
v_cvt_pk_bf16_f32 v207, v62, v63
buffer_store_dwordx4 v[204:207], v10, s[44:47], s61 offen offset:256 sc1
ds_write_b128 v16, v[204:207] offset:12544
v_mov_b32 v2, v11
s_lshl_b32 s60, s35, 2
s_add_u32 s60, s60, s34
s_mul_i32 s60, s60, 131072
s_lshl_b32 s61, s101, 16
s_add_u32 s60, s60, s61
s_add_u32 s42, s60, 1048576
s_add_u32 s40, s32, s42
s_addc_u32 s41, s33, 0
s_mov_b32 s42, 65536
s_mov_b32 s43, 0x20000
s_waitcnt vmcnt(8) lgkmcnt(0)
v_mov_b32 v14, 3
s_mov_b64 exec, 1
ds_write_b32 v13, v14
s_mov_b64 exec, -1
ds_read_b128 v[8:11], v12 offset:0
s_waitcnt lgkmcnt(0)
L_ck57:
v_min3_u32 v15, v8, v9, v10
v_min_u32 v15, v15, v11
s_nop 0
v_readfirstlane_b32 s60, v15
s_nop 0
s_cmp_ge_u32 s60, 3
s_cbranch_scc1 L_ckd58
ds_read_b128 v[8:11], v12 offset:0
s_waitcnt lgkmcnt(0)
s_branch L_ck57
L_ckd58:
ds_read_b128 v[148:151], v17 offset:0
ds_read_b128 v[152:155], v17 offset:1024
ds_read_b128 v[156:159], v17 offset:2048
ds_read_b128 v[160:163], v17 offset:3072
ds_read_b128 v[164:167], v17 offset:4096
ds_read_b128 v[168:171], v17 offset:5120
ds_read_b128 v[172:175], v17 offset:6144
ds_read_b128 v[176:179], v17 offset:7168
ds_read_b128 v[96:99], v20 offset:0
ds_read_b128 v[100:103], v20 offset:4096
ds_read_b128 v[104:107], v20 offset:8192
ds_read_b128 v[108:111], v20 offset:12288
s_waitcnt lgkmcnt(4)
v_mov_b32 v14, 4
s_mov_b64 exec, 1
ds_write_b32 v13, v14
s_mov_b64 exec, -1
s_waitcnt lgkmcnt(0)
v_mfma_f32_32x32x16_bf16 v[32:47], v[148:151], v[96:99], 0
ds_read_b128 v[112:115], v21 offset:0
ds_read_b128 v[116:119], v21 offset:4096
v_mfma_f32_32x32x16_bf16 v[48:63], v[148:151], v[100:103], 0
ds_read_b128 v[120:123], v21 offset:8192
ds_read_b128 v[124:127], v21 offset:12288
v_mfma_f32_32x32x16_bf16 v[64:79], v[148:151], v[104:107], 0
s_add_u32 m0, s67, 32768
s_add_u32 s62, s64, 128
s_and_b32 s62, s62, 0x3ff
buffer_load_dwordx4 v244, s[48:51], s62 offen offset:0 lds
v_mfma_f32_32x32x16_bf16 v[80:95], v[148:151], v[108:111], 0
s_waitcnt lgkmcnt(3)
v_mfma_f32_32x32x16_bf16 v[32:47], v[152:155], v[112:115], v[32:47]
ds_read_b128 v[96:99], v22 offset:0
ds_read_b128 v[100:103], v22 offset:4096
s_waitcnt lgkmcnt(4)
v_mfma_f32_32x32x16_bf16 v[48:63], v[152:155], v[116:119], v[48:63]
ds_read_b128 v[104:107], v22 offset:8192
ds_read_b128 v[108:111], v22 offset:12288
s_waitcnt lgkmcnt(5)
v_mfma_f32_32x32x16_bf16 v[64:79], v[152:155], v[120:123], v[64:79]
buffer_load_dwordx4 v245, s[48:51], s62 offen offset:1024 lds
s_waitcnt lgkmcnt(4)
v_mfma_f32_32x32x16_bf16 v[80:95], v[152:155], v[124:127], v[80:95]
s_waitcnt lgkmcnt(3)
v_mfma_f32_32x32x16_bf16 v[32:47], v[156:159], v[96:99], v[32:47]
ds_read_b128 v[112:115], v23 offset:0
ds_read_b128 v[116:119], v23 offset:4096
s_waitcnt lgkmcnt(4)
v_mfma_f32_32x32x16_bf16 v[48:63], v[156:159], v[100:103], v[48:63]
ds_read_b128 v[120:123], v23 offset:8192
ds_read_b128 v[124:127], v23 offset:12288
s_waitcnt lgkmcnt(5)
v_mfma_f32_32x32x16_bf16 v[64:79], v[156:159], v[104:107], v[64:79]
buffer_load_dwordx4 v246, s[48:51], s62 offen offset:2048 lds
s_waitcnt lgkmcnt(4)
v_mfma_f32_32x32x16_bf16 v[80:95], v[156:159], v[108:111], v[80:95]
s_waitcnt lgkmcnt(3)
v_mfma_f32_32x32x16_bf16 v[32:47], v[160:163], v[112:115], v[32:47]
ds_read_b128 v[96:99], v20 offset:16384
ds_read_b128 v[100:103], v20 offset:20480
s_waitcnt lgkmcnt(4)
v_mfma_f32_32x32x16_bf16 v[48:63], v[160:163], v[116:119], v[48:63]
ds_read_b128 v[104:107], v20 offset:24576
ds_read_b128 v[108:111], v20 offset:28672
s_waitcnt lgkmcnt(5)
v_mfma_f32_32x32x16_bf16 v[64:79], v[160:163], v[120:123], v[64:79]
buffer_load_dwordx4 v247, s[48:51], s62 offen offset:3072 lds
s_waitcnt lgkmcnt(4)
v_mfma_f32_32x32x16_bf16 v[80:95], v[160:163], v[124:127], v[80:95]
s_waitcnt lgkmcnt(3)
v_mfma_f32_32x32x16_bf16 v[32:47], v[164:167], v[96:99], v[32:47]
ds_read_b128 v[112:115], v21 offset:16384
ds_read_b128 v[116:119], v21 offset:20480
s_waitcnt lgkmcnt(4)
v_mfma_f32_32x32x16_bf16 v[48:63], v[164:167], v[100:103], v[48:63]
ds_read_b128 v[120:123], v21 offset:24576
ds_read_b128 v[124:127], v21 offset:28672
s_waitcnt lgkmcnt(5)
v_mfma_f32_32x32x16_bf16 v[64:79], v[164:167], v[104:107], v[64:79]
s_add_u32 m0, s67, 49152
s_nop 0
buffer_load_dwordx4 v244, s[52:55], s62 offen offset:0 lds
s_waitcnt lgkmcnt(4)
v_mfma_f32_32x32x16_bf16 v[80:95], v[164:167], v[108:111], v[80:95]
s_waitcnt lgkmcnt(3)
v_mfma_f32_32x32x16_bf16 v[32:47], v[168:171], v[112:115], v[32:47]
ds_read_b128 v[96:99], v22 offset:16384
ds_read_b128 v[100:103], v22 offset:20480
s_waitcnt lgkmcnt(4)
v_mfma_f32_32x32x16_bf16 v[48:63], v[168:171], v[116:119], v[48:63]
ds_read_b128 v[104:107], v22 offset:24576
ds_read_b128 v[108:111], v22 offset:28672
s_waitcnt lgkmcnt(5)
v_mfma_f32_32x32x16_bf16 v[64:79], v[168:171], v[120:123], v[64:79]
buffer_load_dwordx4 v245, s[52:55], s62 offen offset:1024 lds
s_waitcnt lgkmcnt(4)
v_mfma_f32_32x32x16_bf16 v[80:95], v[168:171], v[124:127], v[80:95]
s_waitcnt lgkmcnt(3)
v_mfma_f32_32x32x16_bf16 v[32:47], v[172:175], v[96:99], v[32:47]
ds_read_b128 v[112:115], v23 offset:16384
ds_read_b128 v[116:119], v23 offset:20480
s_waitcnt lgkmcnt(4)
v_mfma_f32_32x32x16_bf16 v[48:63], v[172:175], v[100:103], v[48:63]
ds_read_b128 v[120:123], v23 offset:24576
ds_read_b128 v[124:127], v23 offset:28672
s_waitcnt lgkmcnt(5)
v_mfma_f32_32x32x16_bf16 v[64:79], v[172:175], v[104:107], v[64:79]
buffer_load_dwordx4 v246, s[52:55], s62 offen offset:2048 lds
s_waitcnt lgkmcnt(4)
v_mfma_f32_32x32x16_bf16 v[80:95], v[172:175], v[108:111], v[80:95]
s_waitcnt lgkmcnt(0)
v_mfma_f32_32x32x16_bf16 v[32:47], v[176:179], v[112:115], v[32:47]
v_mfma_f32_32x32x16_bf16 v[48:63], v[176:179], v[116:119], v[48:63]
v_mfma_f32_32x32x16_bf16 v[64:79], v[176:179], v[120:123], v[64:79]
buffer_load_dwordx4 v247, s[52:55], s62 offen offset:3072 lds
v_mfma_f32_32x32x16_bf16 v[80:95], v[176:179], v[124:127], v[80:95]
s_lshl_b32 s60, s66, 3
v_lshl_add_u32 v17, v5, 4, s60
v_lshlrev_b32 v28, 11, v17
v_lshl_add_u32 v28, v6, 2, v28
v_lshlrev_b32 v29, 13, v17
v_lshl_add_u32 v29, v6, 3, v29
v_lshlrev_b32 v30, 2, v6
v_mov_b32 v15, s37
s_waitcnt vmcnt(8)
s_mov_b64 exec, 1
s_cmp_eq_u32 s100, 0
s_cbranch_scc1 L_rs59
global_store_dword v19, v15, s[32:33]
s_branch L_rd60
L_rs59:
global_store_dword v19, v15, s[32:33] sc1
L_rd60:
s_mov_b64 exec, -1
ds_read_b128 v[8:11], v12 offset:0
s_waitcnt lgkmcnt(0)
L_ck61:
v_min3_u32 v15, v8, v9, v10
v_min_u32 v15, v15, v11
s_nop 0
v_readfirstlane_b32 s60, v15
s_nop 0
s_cmp_ge_u32 s60, 4
s_cbranch_scc1 L_ckd62
ds_read_b128 v[8:11], v12 offset:0
s_waitcnt lgkmcnt(0)
s_branch L_ck61
L_ckd62:
ds_read_b128 v[8:11], v12 offset:16
s_waitcnt lgkmcnt(0)
L_ck63:
v_min3_u32 v15, v8, v9, v10
v_min_u32 v15, v15, v11
s_nop 0
v_readfirstlane_b32 s60, v15
s_nop 0
s_cmp_ge_u32 s60, 2
s_cbranch_scc1 L_ckd64
ds_read_b128 v[8:11], v12 offset:16
s_waitcnt lgkmcnt(0)
s_branch L_ck63
L_ckd64:
s_add_u32 m0, s67, 65536
s_add_u32 s62, s64, 256
s_and_b32 s62, s62, 0x3ff
buffer_load_dwordx4 v244, s[48:51], s62 offen offset:0 lds
buffer_load_dwordx4 v245, s[48:51], s62 offen offset:1024 lds
buffer_load_dwordx4 v246, s[48:51], s62 offen offset:2048 lds
buffer_load_dwordx4 v247, s[48:51], s62 offen offset:3072 lds
s_add_u32 m0, s67, 81920
s_nop 0
buffer_load_dwordx4 v244, s[52:55], s62 offen offset:0 lds
buffer_load_dwordx4 v245, s[52:55], s62 offen offset:1024 lds
buffer_load_dwordx4 v246, s[52:55], s62 offen offset:2048 lds
buffer_load_dwordx4 v247, s[52:55], s62 offen offset:3072 lds
s_mov_b32 s92, 0
L_w65:
global_load_dword v8, v18, s[32:33] sc1
s_waitcnt vmcnt(0)
v_cmp_ne_u32 vcc, s37, v8
s_nop 0
s_cbranch_vccz L_wd66
s_sleep 4
s_add_u32 s92, s92, 1
s_cmp_lt_u32 s92, 200000
s_cbranch_scc1 L_w65
L_wd66:
v_mov_b32 v14, 5
s_mov_b64 exec, 1
ds_write_b32 v13, v14
s_mov_b64 exec, -1
s_add_u32 s63, s65, 8192
s_and_b32 s63, s63, 0xffff
buffer_load_dwordx4 v[180:183], v2, s[40:43], s63 offen offset:0 sc1
buffer_load_dwordx4 v[184:187], v2, s[40:43], s63 offen offset:1024 sc1
buffer_load_dwordx4 v[188:191], v2, s[40:43], s63 offen offset:2048 sc1
buffer_load_dwordx4 v[192:195], v2, s[40:43], s63 offen offset:3072 sc1
s_add_u32 m0, s67, 98304
s_add_u32 s62, s64, 384
s_and_b32 s62, s62, 0x3ff
buffer_load_dwordx4 v244, s[48:51], s62 offen offset:0 lds
buffer_load_dwordx4 v245, s[48:51], s62 offen offset:1024 lds
buffer_load_dwordx4 v246, s[48:51], s62 offen offset:2048 lds
buffer_load_dwordx4 v247, s[48:51], s62 offen offset:3072 lds
s_add_u32 s63, s65, 12288
s_and_b32 s63, s63, 0xffff
buffer_load_dwordx4 v[196:199], v2, s[40:43], s63 offen offset:0 sc1
buffer_load_dwordx4 v[200:203], v2, s[40:43], s63 offen offset:1024 sc1
buffer_load_dwordx4 v[204:207], v2, s[40:43], s63 offen offset:2048 sc1
buffer_load_dwordx4 v[208:211], v2, s[40:43], s63 offen offset:3072 sc1
ds_read_b128 v[8:11], v12 offset:0
s_waitcnt lgkmcnt(0)
L_ck67:
v_min3_u32 v15, v8, v9, v10
v_min_u32 v15, v15, v11
s_nop 0
v_readfirstlane_b32 s60, v15
s_nop 0
s_cmp_ge_u32 s60, 5
s_cbranch_scc1 L_ckd68
ds_read_b128 v[8:11], v12 offset:0
s_waitcnt lgkmcnt(0)
s_branch L_ck67
L_ckd68:
ds_read_b128 v[96:99], v20 offset:32768
ds_read_b128 v[100:103], v20 offset:36864
ds_read_b128 v[104:107], v20 offset:40960
ds_read_b128 v[108:111], v20 offset:45056
s_waitcnt vmcnt(11) lgkmcnt(3)
v_mfma_f32_32x32x16_bf16 v[32:47], v[180:183], v[96:99], v[32:47]
ds_read_b128 v[112:115], v21 offset:32768
ds_read_b128 v[116:119], v21 offset:36864
s_waitcnt lgkmcnt(4)
v_mfma_f32_32x32x16_bf16 v[48:63], v[180:183], v[100:103], v[48:63]
ds_read_b128 v[120:123], v21 offset:40960
ds_read_b128 v[124:127], v21 offset:45056
s_waitcnt lgkmcnt(5)
v_mfma_f32_32x32x16_bf16 v[64:79], v[180:183], v[104:107], v[64:79]
s_waitcnt lgkmcnt(4)
v_mfma_f32_32x32x16_bf16 v[80:95], v[180:183], v[108:111], v[80:95]
s_add_u32 s63, s65, 16384
s_and_b32 s63, s63, 0xffff
buffer_load_dwordx4 v[212:215], v2, s[40:43], s63 offen offset:0 sc1
buffer_load_dwordx4 v[216:219], v2, s[40:43], s63 offen offset:1024 sc1
s_waitcnt vmcnt(12) lgkmcnt(3)
v_mfma_f32_32x32x16_bf16 v[32:47], v[184:187], v[112:115], v[32:47]
ds_read_b128 v[96:99], v22 offset:32768
ds_read_b128 v[100:103], v22 offset:36864
s_waitcnt lgkmcnt(4)
v_mfma_f32_32x32x16_bf16 v[48:63], v[184:187], v[116:119], v[48:63]
ds_read_b128 v[104:107], v22 offset:40960
ds_read_b128 v[108:111], v22 offset:45056
s_waitcnt lgkmcnt(5)
v_mfma_f32_32x32x16_bf16 v[64:79], v[184:187], v[120:123], v[64:79]
s_waitcnt lgkmcnt(4)
v_mfma_f32_32x32x16_bf16 v[80:95], v[184:187], v[124:127], v[80:95]
buffer_load_dwordx4 v[220:223], v2, s[40:43], s63 offen offset:2048 sc1
buffer_load_dwordx4 v[224:227], v2, s[40:43], s63 offen offset:3072 sc1
s_waitcnt vmcnt(13) lgkmcnt(3)
v_mfma_f32_32x32x16_bf16 v[32:47], v[188:191], v[96:99], v[32:47]
ds_read_b128 v[112:115], v23 offset:32768
ds_read_b128 v[116:119], v23 offset:36864
s_waitcnt lgkmcnt(4)
v_mfma_f32_32x32x16_bf16 v[48:63], v[188:191], v[100:103], v[48:63]
ds_read_b128 v[120:123], v23 offset:40960
ds_read_b128 v[124:127], v23 offset:45056
s_waitcnt lgkmcnt(5)
v_mfma_f32_32x32x16_bf16 v[64:79], v[188:191], v[104:107], v[64:79]
s_waitcnt lgkmcnt(4)
v_mfma_f32_32x32x16_bf16 v[80:95], v[188:191], v[108:111], v[80:95]
s_add_u32 s63, s65, 20480
s_and_b32 s63, s63, 0xffff
buffer_load_dwordx4 v[228:231], v2, s[40:43], s63 offen offset:0 sc1
buffer_load_dwordx4 v[232:235], v2, s[40:43], s63 offen offset:1024 sc1
s_waitcnt vmcnt(14) lgkmcnt(3)
v_mfma_f32_32x32x16_bf16 v[32:47], v[192:195], v[112:115], v[32:47]
ds_read_b128 v[96:99], v20 offset:49152
ds_read_b128 v[100:103], v20 offset:53248
s_waitcnt lgkmcnt(4)
v_mfma_f32_32x32x16_bf16 v[48:63], v[192:195], v[116:119], v[48:63]
ds_read_b128 v[104:107], v20 offset:57344
ds_read_b128 v[108:111], v20 offset:61440
s_waitcnt lgkmcnt(5)
v_mfma_f32_32x32x16_bf16 v[64:79], v[192:195], v[120:123], v[64:79]
s_waitcnt lgkmcnt(4)
v_mfma_f32_32x32x16_bf16 v[80:95], v[192:195], v[124:127], v[80:95]
buffer_load_dwordx4 v[236:239], v2, s[40:43], s63 offen offset:2048 sc1
buffer_load_dwordx4 v[240:243], v2, s[40:43], s63 offen offset:3072 sc1
s_waitcnt vmcnt(11) lgkmcnt(3)
v_mov_b32 v14, 6
s_mov_b64 exec, 1
ds_write_b32 v13, v14
s_mov_b64 exec, -1
v_mfma_f32_32x32x16_bf16 v[32:47], v[196:199], v[96:99], v[32:47]
ds_read_b128 v[112:115], v21 offset:49152
ds_read_b128 v[116:119], v21 offset:53248
s_waitcnt lgkmcnt(5)
v_mfma_f32_32x32x16_bf16 v[48:63], v[196:199], v[100:103], v[48:63]
ds_read_b128 v[120:123], v21 offset:57344
ds_read_b128 v[124:127], v21 offset:61440
s_waitcnt lgkmcnt(6)
v_mfma_f32_32x32x16_bf16 v[64:79], v[196:199], v[104:107], v[64:79]
s_add_u32 m0, s67, 0
s_nop 0
buffer_load_dwordx4 v244, s[52:55], s62 offen offset:0 lds
s_waitcnt lgkmcnt(5)
v_mfma_f32_32x32x16_bf16 v[80:95], v[196:199], v[108:111], v[80:95]
s_add_u32 s63, s65, 24576
s_and_b32 s63, s63, 0xffff
buffer_load_dwordx4 v[148:151], v2, s[40:43], s63 offen offset:0 sc1
buffer_load_dwordx4 v[152:155], v2, s[40:43], s63 offen offset:1024 sc1
s_waitcnt vmcnt(13) lgkmcnt(3)
v_mfma_f32_32x32x16_bf16 v[32:47], v[200:203], v[112:115], v[32:47]
ds_read_b128 v[96:99], v22 offset:49152
ds_read_b128 v[100:103], v22 offset:53248
s_waitcnt lgkmcnt(4)
v_mfma_f32_32x32x16_bf16 v[48:63], v[200:203], v[116:119], v[48:63]
ds_read_b128 v[104:107], v22 offset:57344
ds_read_b128 v[108:111], v22 offset:61440
s_waitcnt lgkmcnt(5)
v_mfma_f32_32x32x16_bf16 v[64:79], v[200:203], v[120:123], v[64:79]
buffer_load_dwordx4 v245, s[52:55], s62 offen offset:1024 lds
s_waitcnt lgkmcnt(4)
v_mfma_f32_32x32x16_bf16 v[80:95], v[200:203], v[124:127], v[80:95]
buffer_load_dwordx4 v[156:159], v2, s[40:43], s63 offen offset:2048 sc1
buffer_load_dwordx4 v[160:163], v2, s[40:43], s63 offen offset:3072 sc1
s_waitcnt vmcnt(15) lgkmcnt(3)
v_mfma_f32_32x32x16_bf16 v[32:47], v[204:207], v[96:99], v[32:47]
ds_read_b128 v[112:115], v23 offset:49152
ds_read_b128 v[116:119], v23 offset:53248
s_waitcnt lgkmcnt(4)
v_mfma_f32_32x32x16_bf16 v[48:63], v[204:207], v[100:103], v[48:63]
ds_read_b128 v[120:123], v23 offset:57344
ds_read_b128 v[124:127], v23 offset:61440
s_waitcnt lgkmcnt(5)
v_mfma_f32_32x32x16_bf16 v[64:79], v[204:207], v[104:107], v[64:79]
buffer_load_dwordx4 v246, s[52:55], s62 offen offset:2048 lds
s_waitcnt lgkmcnt(4)
v_mfma_f32_32x32x16_bf16 v[80:95], v[204:207], v[108:111], v[80:95]
s_add_u32 s63, s65, 28672
s_and_b32 s63, s63, 0xffff
buffer_load_dwordx4 v[164:167], v2, s[40:43], s63 offen offset:0 sc1
buffer_load_dwordx4 v[168:171], v2, s[40:43], s63 offen offset:1024 sc1
ds_read_b128 v[8:11], v12
s_waitcnt vmcnt(17) lgkmcnt(0)
L_ck69:
v_min3_u32 v15, v8, v9, v10
v_min_u32 v15, v15, v11
s_nop 0
v_readfirstlane_b32 s60, v15
s_nop 0
s_cmp_ge_u32 s60, 6
s_cbranch_scc1 L_ckd70
ds_read_b128 v[8:11], v12 offset:0
s_waitcnt lgkmcnt(0)
s_branch L_ck69
L_ckd70:
v_mfma_f32_32x32x16_bf16 v[32:47], v[208:211], v[112:115], v[32:47]
ds_read_b128 v[96:99], v24 offset:0
ds_read_b128 v[100:103], v24 offset:4096
v_mfma_f32_32x32x16_bf16 v[48:63], v[208:211], v[116:119], v[48:63]
ds_read_b128 v[104:107], v24 offset:8192
ds_read_b128 v[108:111], v24 offset:12288
v_mfma_f32_32x32x16_bf16 v[64:79], v[208:211], v[120:123], v[64:79]
buffer_load_dwordx4 v247, s[52:55], s62 offen offset:3072 lds
v_mfma_f32_32x32x16_bf16 v[80:95], v[208:211], v[124:127], v[80:95]
buffer_load_dwordx4 v[172:175], v2, s[40:43], s63 offen offset:2048 sc1
buffer_load_dwordx4 v[176:179], v2, s[40:43], s63 offen offset:3072 sc1
s_waitcnt vmcnt(19) lgkmcnt(3)
v_mfma_f32_32x32x16_bf16 v[32:47], v[212:215], v[96:99], v[32:47]
ds_read_b128 v[112:115], v25 offset:0
ds_read_b128 v[116:119], v25 offset:4096
s_waitcnt lgkmcnt(4)
v_mfma_f32_32x32x16_bf16 v[48:63], v[212:215], v[100:103], v[48:63]
ds_read_b128 v[120:123], v25 offset:8192
ds_read_b128 v[124:127], v25 offset:12288
s_waitcnt lgkmcnt(5)
v_mfma_f32_32x32x16_bf16 v[64:79], v[212:215], v[104:107], v[64:79]
s_add_u32 m0, s67, 16384
s_add_u32 s62, s64, 512
s_and_b32 s62, s62, 0x3ff
buffer_load_dwordx4 v244, s[48:51], s62 offen offset:0 lds
s_waitcnt lgkmcnt(4)
v_mfma_f32_32x32x16_bf16 v[80:95], v[212:215], v[108:111], v[80:95]
s_add_u32 s63, s65, 32768
s_and_b32 s63, s63, 0xffff
buffer_load_dwordx4 v[180:183], v2, s[40:43], s63 offen offset:0 sc1
buffer_load_dwordx4 v[184:187], v2, s[40:43], s63 offen offset:1024 sc1
s_waitcnt vmcnt(21) lgkmcnt(3)
v_mfma_f32_32x32x16_bf16 v[32:47], v[216:219], v[112:115], v[32:47]
ds_read_b128 v[96:99], v26 offset:0
ds_read_b128 v[100:103], v26 offset:4096
s_waitcnt lgkmcnt(4)
v_mfma_f32_32x32x16_bf16 v[48:63], v[216:219], v[116:119], v[48:63]
ds_read_b128 v[104:107], v26 offset:8192
ds_read_b128 v[108:111], v26 offset:12288
s_waitcnt lgkmcnt(5)
v_mfma_f32_32x32x16_bf16 v[64:79], v[216:219], v[120:123], v[64:79]
buffer_load_dwordx4 v245, s[48:51], s62 offen offset:1024 lds
s_waitcnt lgkmcnt(4)
v_mfma_f32_32x32x16_bf16 v[80:95], v[216:219], v[124:127], v[80:95]
buffer_load_dwordx4 v[188:191], v2, s[40:43], s63 offen offset:2048 sc1
buffer_load_dwordx4 v[192:195], v2, s[40:43], s63 offen offset:3072 sc1
s_waitcnt vmcnt(23) lgkmcnt(3)
v_mfma_f32_32x32x16_bf16 v[32:47], v[220:223], v[96:99], v[32:47]
ds_read_b128 v[112:115], v27 offset:0
ds_read_b128 v[116:119], v27 offset:4096
s_waitcnt lgkmcnt(4)
v_mfma_f32_32x32x16_bf16 v[48:63], v[220:223], v[100:103], v[48:63]
ds_read_b128 v[120:123], v27 offset:8192
ds_read_b128 v[124:127], v27 offset:12288
s_waitcnt lgkmcnt(5)
v_mfma_f32_32x32x16_bf16 v[64:79], v[220:223], v[104:107], v[64:79]
buffer_load_dwordx4 v246, s[48:51], s62 offen offset:2048 lds
s_waitcnt lgkmcnt(4)
v_mfma_f32_32x32x16_bf16 v[80:95], v[220:223], v[108:111], v[80:95]
s_add_u32 s63, s65, 36864
s_and_b32 s63, s63, 0xffff
buffer_load_dwordx4 v[196:199], v2, s[40:43], s63 offen offset:0 sc1
buffer_load_dwordx4 v[200:203], v2, s[40:43], s63 offen offset:1024 sc1
s_waitcnt vmcnt(25) lgkmcnt(3)
v_mfma_f32_32x32x16_bf16 v[32:47], v[224:227], v[112:115], v[32:47]
ds_read_b128 v[96:99], v24 offset:16384
ds_read_b128 v[100:103], v24 offset:20480
s_waitcnt lgkmcnt(4)
v_mfma_f32_32x32x16_bf16 v[48:63], v[224:227], v[116:119], v[48:63]
ds_read_b128 v[104:107], v24 offset:24576
ds_read_b128 v[108:111], v24 offset:28672
s_waitcnt lgkmcnt(5)
v_mfma_f32_32x32x16_bf16 v[64:79], v[224:227], v[120:123], v[64:79]
buffer_load_dwordx4 v247, s[48:51], s62 offen offset:3072 lds
s_waitcnt lgkmcnt(4)
v_mfma_f32_32x32x16_bf16 v[80:95], v[224:227], v[124:127], v[80:95]
buffer_load_dwordx4 v[204:207], v2, s[40:43], s63 offen offset:2048 sc1
buffer_load_dwordx4 v[208:211], v2, s[40:43], s63 offen offset:3072 sc1
s_waitcnt vmcnt(14) lgkmcnt(3)
v_mov_b32 v14, 7
s_mov_b64 exec, 1
ds_write_b32 v13, v14
s_mov_b64 exec, -1
v_mfma_f32_32x32x16_bf16 v[32:47], v[228:231], v[96:99], v[32:47]
ds_read_b128 v[112:115], v25 offset:16384
ds_read_b128 v[116:119], v25 offset:20480
s_waitcnt lgkmcnt(5)
v_mfma_f32_32x32x16_bf16 v[48:63], v[228:231], v[100:103], v[48:63]
ds_read_b128 v[120:123], v25 offset:24576
ds_read_b128 v[124:127], v25 offset:28672
s_waitcnt lgkmcnt(6)
v_mfma_f32_32x32x16_bf16 v[64:79], v[228:231], v[104:107], v[64:79]
s_add_u32 m0, s67, 32768
s_nop 0
buffer_load_dwordx4 v244, s[52:55], s62 offen offset:0 lds
s_waitcnt lgkmcnt(5)
v_mfma_f32_32x32x16_bf16 v[80:95], v[228:231], v[108:111], v[80:95]
s_add_u32 s63, s65, 40960
s_and_b32 s63, s63, 0xffff
buffer_load_dwordx4 v[212:215], v2, s[40:43], s63 offen offset:0 sc1
buffer_load_dwordx4 v[216:219], v2, s[40:43], s63 offen offset:1024 sc1
s_waitcnt vmcnt(29) lgkmcnt(3)
v_mfma_f32_32x32x16_bf16 v[32:47], v[232:235], v[112:115], v[32:47]
ds_read_b128 v[96:99], v26 offset:16384
ds_read_b128 v[100:103], v26 offset:20480
s_waitcnt lgkmcnt(4)
v_mfma_f32_32x32x16_bf16 v[48:63], v[232:235], v[116:119], v[48:63]
ds_read_b128 v[104:107], v26 offset:24576
ds_read_b128 v[108:111], v26 offset:28672
s_waitcnt lgkmcnt(5)
v_mfma_f32_32x32x16_bf16 v[64:79], v[232:235], v[120:123], v[64:79]
buffer_load_dwordx4 v245, s[52:55], s62 offen offset:1024 lds
s_waitcnt lgkmcnt(4)
v_mfma_f32_32x32x16_bf16 v[80:95], v[232:235], v[124:127], v[80:95]
buffer_load_dwordx4 v[220:223], v2, s[40:43], s63 offen offset:2048 sc1
buffer_load_dwordx4 v[224:227], v2, s[40:43], s63 offen offset:3072 sc1
s_waitcnt vmcnt(31) lgkmcnt(3)
v_mfma_f32_32x32x16_bf16 v[32:47], v[236:239], v[96:99], v[32:47]
ds_read_b128 v[112:115], v27 offset:16384
ds_read_b128 v[116:119], v27 offset:20480
s_waitcnt lgkmcnt(4)
v_mfma_f32_32x32x16_bf16 v[48:63], v[236:239], v[100:103], v[48:63]
ds_read_b128 v[120:123], v27 offset:24576
ds_read_b128 v[124:127], v27 offset:28672
s_waitcnt lgkmcnt(5)
v_mfma_f32_32x32x16_bf16 v[64:79], v[236:239], v[104:107], v[64:79]
buffer_load_dwordx4 v246, s[52:55], s62 offen offset:2048 lds
s_waitcnt lgkmcnt(4)
v_mfma_f32_32x32x16_bf16 v[80:95], v[236:239], v[108:111], v[80:95]
s_add_u32 s63, s65, 45056
s_and_b32 s63, s63, 0xffff
buffer_load_dwordx4 v[228:231], v2, s[40:43], s63 offen offset:0 sc1
buffer_load_dwordx4 v[232:235], v2, s[40:43], s63 offen offset:1024 sc1
ds_read_b128 v[8:11], v12
s_waitcnt vmcnt(33) lgkmcnt(0)
L_ck71:
v_min3_u32 v15, v8, v9, v10
v_min_u32 v15, v15, v11
s_nop 0
v_readfirstlane_b32 s60, v15
s_nop 0
s_cmp_ge_u32 s60, 7
s_cbranch_scc1 L_ckd72
ds_read_b128 v[8:11], v12 offset:0
s_waitcnt lgkmcnt(0)
s_branch L_ck71
L_ckd72:
v_mfma_f32_32x32x16_bf16 v[32:47], v[240:243], v[112:115], v[32:47]
ds_read_b128 v[96:99], v24 offset:32768
ds_read_b128 v[100:103], v24 offset:36864
v_mfma_f32_32x32x16_bf16 v[48:63], v[240:243], v[116:119], v[48:63]
ds_read_b128 v[104:107], v24 offset:40960
ds_read_b128 v[108:111], v24 offset:45056
v_mfma_f32_32x32x16_bf16 v[64:79], v[240:243], v[120:123], v[64:79]
buffer_load_dwordx4 v247, s[52:55], s62 offen offset:3072 lds
v_mfma_f32_32x32x16_bf16 v[80:95], v[240:243], v[124:127], v[80:95]
buffer_load_dwordx4 v[236:239], v2, s[40:43], s63 offen offset:2048 sc1
buffer_load_dwordx4 v[240:243], v2, s[40:43], s63 offen offset:3072 sc1
s_waitcnt vmcnt(34) lgkmcnt(3)
v_mfma_f32_32x32x16_bf16 v[32:47], v[148:151], v[96:99], v[32:47]
ds_read_b128 v[112:115], v25 offset:32768
ds_read_b128 v[116:119], v25 offset:36864
s_waitcnt lgkmcnt(4)
v_mfma_f32_32x32x16_bf16 v[48:63], v[148:151], v[100:103], v[48:63]
ds_read_b128 v[120:123], v25 offset:40960
ds_read_b128 v[124:127], v25 offset:45056
s_waitcnt lgkmcnt(5)
v_mfma_f32_32x32x16_bf16 v[64:79], v[148:151], v[104:107], v[64:79]
s_add_u32 m0, s67, 49152
s_add_u32 s62, s64, 640
s_and_b32 s62, s62, 0x3ff
buffer_load_dwordx4 v244, s[48:51], s62 offen offset:0 lds
s_waitcnt lgkmcnt(4)
v_mfma_f32_32x32x16_bf16 v[80:95], v[148:151], v[108:111], v[80:95]
s_add_u32 s63, s65, 49152
s_and_b32 s63, s63, 0xffff
buffer_load_dwordx4 v[148:151], v2, s[40:43], s63 offen offset:0 sc1
s_waitcnt vmcnt(35) lgkmcnt(3)
v_mfma_f32_32x32x16_bf16 v[32:47], v[152:155], v[112:115], v[32:47]
ds_read_b128 v[96:99], v26 offset:32768
ds_read_b128 v[100:103], v26 offset:36864
s_waitcnt lgkmcnt(4)
v_mfma_f32_32x32x16_bf16 v[48:63], v[152:155], v[116:119], v[48:63]
ds_read_b128 v[104:107], v26 offset:40960
ds_read_b128 v[108:111], v26 offset:45056
s_waitcnt lgkmcnt(5)
v_mfma_f32_32x32x16_bf16 v[64:79], v[152:155], v[120:123], v[64:79]
buffer_load_dwordx4 v245, s[48:51], s62 offen offset:1024 lds
s_waitcnt lgkmcnt(4)
v_mfma_f32_32x32x16_bf16 v[80:95], v[152:155], v[124:127], v[80:95]
buffer_load_dwordx4 v[152:155], v2, s[40:43], s63 offen offset:1024 sc1
s_waitcnt vmcnt(35) lgkmcnt(3)
v_mfma_f32_32x32x16_bf16 v[32:47], v[156:159], v[96:99], v[32:47]
ds_read_b128 v[112:115], v27 offset:32768
ds_read_b128 v[116:119], v27 offset:36864
s_waitcnt lgkmcnt(4)
v_mfma_f32_32x32x16_bf16 v[48:63], v[156:159], v[100:103], v[48:63]
ds_read_b128 v[120:123], v27 offset:40960
ds_read_b128 v[124:127], v27 offset:45056
s_waitcnt lgkmcnt(5)
v_mfma_f32_32x32x16_bf16 v[64:79], v[156:159], v[104:107], v[64:79]
buffer_load_dwordx4 v246, s[48:51], s62 offen offset:2048 lds
s_waitcnt lgkmcnt(4)
v_mfma_f32_32x32x16_bf16 v[80:95], v[156:159], v[108:111], v[80:95]
buffer_load_dwordx4 v[156:159], v2, s[40:43], s63 offen offset:2048 sc1
s_waitcnt vmcnt(36) lgkmcnt(3)
v_mfma_f32_32x32x16_bf16 v[32:47], v[160:163], v[112:115], v[32:47]
ds_read_b128 v[96:99], v20 offset:0
ds_read_b128 v[100:103], v20 offset:4096
s_waitcnt lgkmcnt(4)
v_mfma_f32_32x32x16_bf16 v[48:63], v[160:163], v[116:119], v[48:63]
ds_read_b128 v[104:107], v20 offset:8192
ds_read_b128 v[108:111], v20 offset:12288
s_waitcnt lgkmcnt(5)
v_mfma_f32_32x32x16_bf16 v[64:79], v[160:163], v[120:123], v[64:79]
buffer_load_dwordx4 v247, s[48:51], s62 offen offset:3072 lds
s_waitcnt lgkmcnt(4)
v_mfma_f32_32x32x16_bf16 v[80:95], v[160:163], v[124:127], v[80:95]
buffer_load_dwordx4 v[160:163], v2, s[40:43], s63 offen offset:3072 sc1
s_waitcnt vmcnt(10) lgkmcnt(3)
v_mov_b32 v14, 8
s_mov_b64 exec, 1
ds_write_b32 v13, v14
s_mov_b64 exec, -1
v_mfma_f32_32x32x16_bf16 v[32:47], v[164:167], v[96:99], v[32:47]
ds_read_b128 v[112:115], v21 offset:0
ds_read_b128 v[116:119], v21 offset:4096
s_waitcnt lgkmcnt(5)
v_mfma_f32_32x32x16_bf16 v[48:63], v[164:167], v[100:103], v[48:63]
ds_read_b128 v[120:123], v21 offset:8192
ds_read_b128 v[124:127], v21 offset:12288
s_waitcnt lgkmcnt(6)
v_mfma_f32_32x32x16_bf16 v[64:79], v[164:167], v[104:107], v[64:79]
s_add_u32 m0, s67, 65536
s_nop 0
buffer_load_dwordx4 v244, s[52:55], s62 offen offset:0 lds
s_waitcnt lgkmcnt(5)
v_mfma_f32_32x32x16_bf16 v[80:95], v[164:167], v[108:111], v[80:95]
s_add_u32 s63, s65, 53248
s_and_b32 s63, s63, 0xffff
buffer_load_dwordx4 v[164:167], v2, s[40:43], s63 offen offset:0 sc1
s_waitcnt vmcnt(37) lgkmcnt(3)
v_mfma_f32_32x32x16_bf16 v[32:47], v[168:171], v[112:115], v[32:47]
ds_read_b128 v[96:99], v22 offset:0
ds_read_b128 v[100:103], v22 offset:4096
s_waitcnt lgkmcnt(4)
v_mfma_f32_32x32x16_bf16 v[48:63], v[168:171], v[116:119], v[48:63]
ds_read_b128 v[104:107], v22 offset:8192
ds_read_b128 v[108:111], v22 offset:12288
s_waitcnt lgkmcnt(5)
v_mfma_f32_32x32x16_bf16 v[64:79], v[168:171], v[120:123], v[64:79]
buffer_load_dwordx4 v245, s[52:55], s62 offen offset:1024 lds
s_waitcnt lgkmcnt(4)
v_mfma_f32_32x32x16_bf16 v[80:95], v[168:171], v[124:127], v[80:95]
buffer_load_dwordx4 v[168:171], v2, s[40:43], s63 offen offset:1024 sc1
s_waitcnt vmcnt(37) lgkmcnt(3)
v_mfma_f32_32x32x16_bf16 v[32:47], v[172:175], v[96:99], v[32:47]
ds_read_b128 v[112:115], v23 offset:0
ds_read_b128 v[116:119], v23 offset:4096
s_waitcnt lgkmcnt(4)
v_mfma_f32_32x32x16_bf16 v[48:63], v[172:175], v[100:103], v[48:63]
ds_read_b128 v[120:123], v23 offset:8192
ds_read_b128 v[124:127], v23 offset:12288
s_waitcnt lgkmcnt(5)
v_mfma_f32_32x32x16_bf16 v[64:79], v[172:175], v[104:107], v[64:79]
buffer_load_dwordx4 v246, s[52:55], s62 offen offset:2048 lds
s_waitcnt lgkmcnt(4)
v_mfma_f32_32x32x16_bf16 v[80:95], v[172:175], v[108:111], v[80:95]
buffer_load_dwordx4 v[172:175], v2, s[40:43], s63 offen offset:2048 sc1
ds_read_b128 v[8:11], v12
s_waitcnt vmcnt(38) lgkmcnt(0)
L_ck73:
v_min3_u32 v15, v8, v9, v10
v_min_u32 v15, v15, v11
s_nop 0
v_readfirstlane_b32 s60, v15
s_nop 0
s_cmp_ge_u32 s60, 8
s_cbranch_scc1 L_ckd74
ds_read_b128 v[8:11], v12 offset:0
s_waitcnt lgkmcnt(0)
s_branch L_ck73
L_ckd74:
v_mfma_f32_32x32x16_bf16 v[32:47], v[176:179], v[112:115], v[32:47]
ds_read_b128 v[96:99], v20 offset:16384
ds_read_b128 v[100:103], v20 offset:20480
v_mfma_f32_32x32x16_bf16 v[48:63], v[176:179], v[116:119], v[48:63]
ds_read_b128 v[104:107], v20 offset:24576
ds_read_b128 v[108:111], v20 offset:28672
v_mfma_f32_32x32x16_bf16 v[64:79], v[176:179], v[120:123], v[64:79]
buffer_load_dwordx4 v247, s[52:55], s62 offen offset:3072 lds
v_mfma_f32_32x32x16_bf16 v[80:95], v[176:179], v[124:127], v[80:95]
buffer_load_dwordx4 v[176:179], v2, s[40:43], s63 offen offset:3072 sc1
s_waitcnt vmcnt(38) lgkmcnt(3)
v_mfma_f32_32x32x16_bf16 v[32:47], v[180:183], v[96:99], v[32:47]
ds_read_b128 v[112:115], v21 offset:16384
ds_read_b128 v[116:119], v21 offset:20480
s_waitcnt lgkmcnt(4)
v_mfma_f32_32x32x16_bf16 v[48:63], v[180:183], v[100:103], v[48:63]
ds_read_b128 v[120:123], v21 offset:24576
ds_read_b128 v[124:127], v21 offset:28672
s_waitcnt lgkmcnt(5)
v_mfma_f32_32x32x16_bf16 v[64:79], v[180:183], v[104:107], v[64:79]
s_add_u32 m0, s67, 81920
s_add_u32 s62, s64, 768
s_and_b32 s62, s62, 0x3ff
buffer_load_dwordx4 v244, s[48:51], s62 offen offset:0 lds
s_waitcnt lgkmcnt(4)
v_mfma_f32_32x32x16_bf16 v[80:95], v[180:183], v[108:111], v[80:95]
s_add_u32 s63, s65, 57344
s_and_b32 s63, s63, 0xffff
buffer_load_dwordx4 v[180:183], v2, s[40:43], s63 offen offset:0 sc1
s_waitcnt vmcnt(39) lgkmcnt(3)
v_mfma_f32_32x32x16_bf16 v[32:47], v[184:187], v[112:115], v[32:47]
ds_read_b128 v[96:99], v22 offset:16384
ds_read_b128 v[100:103], v22 offset:20480
s_waitcnt lgkmcnt(4)
v_mfma_f32_32x32x16_bf16 v[48:63], v[184:187], v[116:119], v[48:63]
ds_read_b128 v[104:107], v22 offset:24576
ds_read_b128 v[108:111], v22 offset:28672
s_waitcnt lgkmcnt(5)
v_mfma_f32_32x32x16_bf16 v[64:79], v[184:187], v[120:123], v[64:79]
buffer_load_dwordx4 v245, s[48:51], s62 offen offset:1024 lds
s_waitcnt lgkmcnt(4)
v_mfma_f32_32x32x16_bf16 v[80:95], v[184:187], v[124:127], v[80:95]
buffer_load_dwordx4 v[184:187], v2, s[40:43], s63 offen offset:1024 sc1
s_waitcnt vmcnt(39) lgkmcnt(3)
v_mfma_f32_32x32x16_bf16 v[32:47], v[188:191], v[96:99], v[32:47]
ds_read_b128 v[112:115], v23 offset:16384
ds_read_b128 v[116:119], v23 offset:20480
s_waitcnt lgkmcnt(4)
v_mfma_f32_32x32x16_bf16 v[48:63], v[188:191], v[100:103], v[48:63]
ds_read_b128 v[120:123], v23 offset:24576
ds_read_b128 v[124:127], v23 offset:28672
s_waitcnt lgkmcnt(5)
v_mfma_f32_32x32x16_bf16 v[64:79], v[188:191], v[104:107], v[64:79]
buffer_load_dwordx4 v246, s[48:51], s62 offen offset:2048 lds
s_waitcnt lgkmcnt(4)
v_mfma_f32_32x32x16_bf16 v[80:95], v[188:191], v[108:111], v[80:95]
buffer_load_dwordx4 v[188:191], v2, s[40:43], s63 offen offset:2048 sc1
s_waitcnt vmcnt(40) lgkmcnt(3)
v_mfma_f32_32x32x16_bf16 v[32:47], v[192:195], v[112:115], v[32:47]
ds_read_b128 v[96:99], v20 offset:32768
ds_read_b128 v[100:103], v20 offset:36864
s_waitcnt lgkmcnt(4)
v_mfma_f32_32x32x16_bf16 v[48:63], v[192:195], v[116:119], v[48:63]
ds_read_b128 v[104:107], v20 offset:40960
ds_read_b128 v[108:111], v20 offset:45056
s_waitcnt lgkmcnt(5)
v_mfma_f32_32x32x16_bf16 v[64:79], v[192:195], v[120:123], v[64:79]
buffer_load_dwordx4 v247, s[48:51], s62 offen offset:3072 lds
s_waitcnt lgkmcnt(4)
v_mfma_f32_32x32x16_bf16 v[80:95], v[192:195], v[124:127], v[80:95]
buffer_load_dwordx4 v[192:195], v2, s[40:43], s63 offen offset:3072 sc1
s_waitcnt vmcnt(9) lgkmcnt(3)
v_mov_b32 v14, 9
s_mov_b64 exec, 1
ds_write_b32 v13, v14
s_mov_b64 exec, -1
v_mfma_f32_32x32x16_bf16 v[32:47], v[196:199], v[96:99], v[32:47]
ds_read_b128 v[112:115], v21 offset:32768
ds_read_b128 v[116:119], v21 offset:36864
s_waitcnt lgkmcnt(5)
v_mfma_f32_32x32x16_bf16 v[48:63], v[196:199], v[100:103], v[48:63]
ds_read_b128 v[120:123], v21 offset:40960
ds_read_b128 v[124:127], v21 offset:45056
s_waitcnt lgkmcnt(6)
v_mfma_f32_32x32x16_bf16 v[64:79], v[196:199], v[104:107], v[64:79]
s_add_u32 m0, s67, 98304
s_nop 0
buffer_load_dwordx4 v244, s[52:55], s62 offen offset:0 lds
s_waitcnt lgkmcnt(5)
v_mfma_f32_32x32x16_bf16 v[80:95], v[196:199], v[108:111], v[80:95]
s_add_u32 s63, s65, 61440
s_and_b32 s63, s63, 0xffff
buffer_load_dwordx4 v[196:199], v2, s[40:43], s63 offen offset:0 sc1
s_waitcnt vmcnt(41) lgkmcnt(3)
v_mfma_f32_32x32x16_bf16 v[32:47], v[200:203], v[112:115], v[32:47]
ds_read_b128 v[96:99], v22 offset:32768
ds_read_b128 v[100:103], v22 offset:36864
s_waitcnt lgkmcnt(4)
v_mfma_f32_32x32x16_bf16 v[48:63], v[200:203], v[116:119], v[48:63]
ds_read_b128 v[104:107], v22 offset:40960
ds_read_b128 v[108:111], v22 offset:45056
s_waitcnt lgkmcnt(5)
v_mfma_f32_32x32x16_bf16 v[64:79], v[200:203], v[120:123], v[64:79]
buffer_load_dwordx4 v245, s[52:55], s62 offen offset:1024 lds
s_waitcnt lgkmcnt(4)
v_mfma_f32_32x32x16_bf16 v[80:95], v[200:203], v[124:127], v[80:95]
buffer_load_dwordx4 v[200:203], v2, s[40:43], s63 offen offset:1024 sc1
s_waitcnt vmcnt(41) lgkmcnt(3)
v_mfma_f32_32x32x16_bf16 v[32:47], v[204:207], v[96:99], v[32:47]
ds_read_b128 v[112:115], v23 offset:32768
ds_read_b128 v[116:119], v23 offset:36864
s_waitcnt lgkmcnt(4)
v_mfma_f32_32x32x16_bf16 v[48:63], v[204:207], v[100:103], v[48:63]
ds_read_b128 v[120:123], v23 offset:40960
ds_read_b128 v[124:127], v23 offset:45056
s_waitcnt lgkmcnt(5)
v_mfma_f32_32x32x16_bf16 v[64:79], v[204:207], v[104:107], v[64:79]
buffer_load_dwordx4 v246, s[52:55], s62 offen offset:2048 lds
s_waitcnt lgkmcnt(4)
v_mfma_f32_32x32x16_bf16 v[80:95], v[204:207], v[108:111], v[80:95]
buffer_load_dwordx4 v[204:207], v2, s[40:43], s63 offen offset:2048 sc1
ds_read_b128 v[8:11], v12
s_waitcnt vmcnt(42) lgkmcnt(0)
L_ck75:
v_min3_u32 v15, v8, v9, v10
v_min_u32 v15, v15, v11
s_nop 0
v_readfirstlane_b32 s60, v15
s_nop 0
s_cmp_ge_u32 s60, 9
s_cbranch_scc1 L_ckd76
ds_read_b128 v[8:11], v12 offset:0
s_waitcnt lgkmcnt(0)
s_branch L_ck75
L_ckd76:
v_mfma_f32_32x32x16_bf16 v[32:47], v[208:211], v[112:115], v[32:47]
ds_read_b128 v[96:99], v20 offset:49152
ds_read_b128 v[100:103], v20 offset:53248
v_mfma_f32_32x32x16_bf16 v[48:63], v[208:211], v[116:119], v[48:63]
ds_read_b128 v[104:107], v20 offset:57344
ds_read_b128 v[108:111], v20 offset:61440
v_mfma_f32_32x32x16_bf16 v[64:79], v[208:211], v[120:123], v[64:79]
buffer_load_dwordx4 v247, s[52:55], s62 offen offset:3072 lds
v_mfma_f32_32x32x16_bf16 v[80:95], v[208:211], v[124:127], v[80:95]
buffer_load_dwordx4 v[208:211], v2, s[40:43], s63 offen offset:3072 sc1
s_waitcnt vmcnt(42) lgkmcnt(3)
v_mfma_f32_32x32x16_bf16 v[32:47], v[212:215], v[96:99], v[32:47]
ds_read_b128 v[112:115], v21 offset:49152
ds_read_b128 v[116:119], v21 offset:53248
s_waitcnt lgkmcnt(4)
v_mfma_f32_32x32x16_bf16 v[48:63], v[212:215], v[100:103], v[48:63]
ds_read_b128 v[120:123], v21 offset:57344
ds_read_b128 v[124:127], v21 offset:61440
s_waitcnt lgkmcnt(5)
v_mfma_f32_32x32x16_bf16 v[64:79], v[212:215], v[104:107], v[64:79]
s_add_u32 m0, s67, 0
s_add_u32 s62, s64, 896
s_and_b32 s62, s62, 0x3ff
buffer_load_dwordx4 v244, s[48:51], s62 offen offset:0 lds
s_waitcnt lgkmcnt(4)
v_mfma_f32_32x32x16_bf16 v[80:95], v[212:215], v[108:111], v[80:95]
s_waitcnt vmcnt(42) lgkmcnt(3)
v_mfma_f32_32x32x16_bf16 v[32:47], v[216:219], v[112:115], v[32:47]
ds_read_b128 v[96:99], v22 offset:49152
ds_read_b128 v[100:103], v22 offset:53248
s_waitcnt lgkmcnt(4)
v_mfma_f32_32x32x16_bf16 v[48:63], v[216:219], v[116:119], v[48:63]
ds_read_b128 v[104:107], v22 offset:57344
ds_read_b128 v[108:111], v22 offset:61440
s_waitcnt lgkmcnt(5)
v_mfma_f32_32x32x16_bf16 v[64:79], v[216:219], v[120:123], v[64:79]
buffer_load_dwordx4 v245, s[48:51], s62 offen offset:1024 lds
s_waitcnt lgkmcnt(4)
v_mfma_f32_32x32x16_bf16 v[80:95], v[216:219], v[124:127], v[80:95]
s_waitcnt vmcnt(41) lgkmcnt(3)
v_mfma_f32_32x32x16_bf16 v[32:47], v[220:223], v[96:99], v[32:47]
ds_read_b128 v[112:115], v23 offset:49152
ds_read_b128 v[116:119], v23 offset:53248
s_waitcnt lgkmcnt(4)
v_mfma_f32_32x32x16_bf16 v[48:63], v[220:223], v[100:103], v[48:63]
ds_read_b128 v[120:123], v23 offset:57344
ds_read_b128 v[124:127], v23 offset:61440
s_waitcnt lgkmcnt(5)
v_mfma_f32_32x32x16_bf16 v[64:79], v[220:223], v[104:107], v[64:79]
buffer_load_dwordx4 v246, s[48:51], s62 offen offset:2048 lds
s_waitcnt lgkmcnt(4)
v_mfma_f32_32x32x16_bf16 v[80:95], v[220:223], v[108:111], v[80:95]
s_waitcnt vmcnt(41) lgkmcnt(3)
v_mfma_f32_32x32x16_bf16 v[32:47], v[224:227], v[112:115], v[32:47]
ds_read_b128 v[96:99], v24 offset:0
ds_read_b128 v[100:103], v24 offset:4096
s_waitcnt lgkmcnt(4)
v_mfma_f32_32x32x16_bf16 v[48:63], v[224:227], v[116:119], v[48:63]
ds_read_b128 v[104:107], v24 offset:8192
ds_read_b128 v[108:111], v24 offset:12288
s_waitcnt lgkmcnt(5)
v_mfma_f32_32x32x16_bf16 v[64:79], v[224:227], v[120:123], v[64:79]
buffer_load_dwordx4 v247, s[48:51], s62 offen offset:3072 lds
s_waitcnt lgkmcnt(4)
v_mfma_f32_32x32x16_bf16 v[80:95], v[224:227], v[124:127], v[80:95]
s_waitcnt vmcnt(5) lgkmcnt(3)
v_mov_b32 v14, 10
s_mov_b64 exec, 1
ds_write_b32 v13, v14
s_mov_b64 exec, -1
v_mfma_f32_32x32x16_bf16 v[32:47], v[228:231], v[96:99], v[32:47]
ds_read_b128 v[112:115], v25 offset:0
ds_read_b128 v[116:119], v25 offset:4096
s_waitcnt lgkmcnt(5)
v_mfma_f32_32x32x16_bf16 v[48:63], v[228:231], v[100:103], v[48:63]
ds_read_b128 v[120:123], v25 offset:8192
ds_read_b128 v[124:127], v25 offset:12288
s_waitcnt lgkmcnt(6)
v_mfma_f32_32x32x16_bf16 v[64:79], v[228:231], v[104:107], v[64:79]
s_add_u32 m0, s67, 16384
s_nop 0
buffer_load_dwordx4 v244, s[52:55], s62 offen offset:0 lds
s_waitcnt lgkmcnt(5)
v_mfma_f32_32x32x16_bf16 v[80:95], v[228:231], v[108:111], v[80:95]
s_waitcnt vmcnt(40) lgkmcnt(3)
v_mfma_f32_32x32x16_bf16 v[32:47], v[232:235], v[112:115], v[32:47]
ds_read_b128 v[96:99], v26 offset:0
ds_read_b128 v[100:103], v26 offset:4096
s_waitcnt lgkmcnt(4)
v_mfma_f32_32x32x16_bf16 v[48:63], v[232:235], v[116:119], v[48:63]
ds_read_b128 v[104:107], v26 offset:8192
ds_read_b128 v[108:111], v26 offset:12288
s_waitcnt lgkmcnt(5)
v_mfma_f32_32x32x16_bf16 v[64:79], v[232:235], v[120:123], v[64:79]
buffer_load_dwordx4 v245, s[52:55], s62 offen offset:1024 lds
s_waitcnt lgkmcnt(4)
v_mfma_f32_32x32x16_bf16 v[80:95], v[232:235], v[124:127], v[80:95]
s_waitcnt vmcnt(39) lgkmcnt(3)
v_mfma_f32_32x32x16_bf16 v[32:47], v[236:239], v[96:99], v[32:47]
ds_read_b128 v[112:115], v27 offset:0
ds_read_b128 v[116:119], v27 offset:4096
s_waitcnt lgkmcnt(4)
v_mfma_f32_32x32x16_bf16 v[48:63], v[236:239], v[100:103], v[48:63]
ds_read_b128 v[120:123], v27 offset:8192
ds_read_b128 v[124:127], v27 offset:12288
s_waitcnt lgkmcnt(5)
v_mfma_f32_32x32x16_bf16 v[64:79], v[236:239], v[104:107], v[64:79]
buffer_load_dwordx4 v246, s[52:55], s62 offen offset:2048 lds
s_waitcnt lgkmcnt(4)
v_mfma_f32_32x32x16_bf16 v[80:95], v[236:239], v[108:111], v[80:95]
ds_read_b128 v[8:11], v12
s_waitcnt vmcnt(39) lgkmcnt(0)
L_ck77:
v_min3_u32 v15, v8, v9, v10
v_min_u32 v15, v15, v11
s_nop 0
v_readfirstlane_b32 s60, v15
s_nop 0
s_cmp_ge_u32 s60, 10
s_cbranch_scc1 L_ckd78
ds_read_b128 v[8:11], v12 offset:0
s_waitcnt lgkmcnt(0)
s_branch L_ck77
L_ckd78:
v_mfma_f32_32x32x16_bf16 v[32:47], v[240:243], v[112:115], v[32:47]
ds_read_b128 v[96:99], v24 offset:16384
ds_read_b128 v[100:103], v24 offset:20480
v_mfma_f32_32x32x16_bf16 v[48:63], v[240:243], v[116:119], v[48:63]
ds_read_b128 v[104:107], v24 offset:24576
ds_read_b128 v[108:111], v24 offset:28672
v_mfma_f32_32x32x16_bf16 v[64:79], v[240:243], v[120:123], v[64:79]
buffer_load_dwordx4 v247, s[52:55], s62 offen offset:3072 lds
v_mfma_f32_32x32x16_bf16 v[80:95], v[240:243], v[124:127], v[80:95]
s_waitcnt vmcnt(38) lgkmcnt(3)
v_mfma_f32_32x32x16_bf16 v[32:47], v[148:151], v[96:99], v[32:47]
ds_read_b128 v[112:115], v25 offset:16384
ds_read_b128 v[116:119], v25 offset:20480
s_waitcnt lgkmcnt(4)
v_mfma_f32_32x32x16_bf16 v[48:63], v[148:151], v[100:103], v[48:63]
ds_read_b128 v[120:123], v25 offset:24576
ds_read_b128 v[124:127], v25 offset:28672
s_waitcnt lgkmcnt(5)
v_mfma_f32_32x32x16_bf16 v[64:79], v[148:151], v[104:107], v[64:79]
s_waitcnt lgkmcnt(4)
v_mfma_f32_32x32x16_bf16 v[80:95], v[148:151], v[108:111], v[80:95]
global_load_dword v31, v30, s[26:27]
s_mov_b32 s60, 0
buffer_load_dword v128, v28, s[56:59], s60 offen offset:0
s_mov_b32 s60, 0
buffer_load_dword v129, v28, s[56:59], s60 offen offset:2048
s_mov_b32 s60, 4096
buffer_load_dword v130, v28, s[56:59], s60 offen offset:0
s_mov_b32 s60, 4096
buffer_load_dword v131, v28, s[56:59], s60 offen offset:2048
s_mov_b32 s60, 65536
buffer_load_dword v132, v28, s[56:59], s60 offen offset:0
s_mov_b32 s60, 65536
buffer_load_dword v133, v28, s[56:59], s60 offen offset:2048
s_mov_b32 s60, 69632
buffer_load_dword v134, v28, s[56:59], s60 offen offset:0
s_mov_b32 s60, 69632
buffer_load_dword v135, v28, s[56:59], s60 offen offset:2048
s_mov_b32 s60, 8192
buffer_load_dword v136, v28, s[56:59], s60 offen offset:0
s_mov_b32 s60, 8192
buffer_load_dword v137, v28, s[56:59], s60 offen offset:2048
s_mov_b32 s60, 12288
buffer_load_dword v138, v28, s[56:59], s60 offen offset:0
s_mov_b32 s60, 12288
buffer_load_dword v139, v28, s[56:59], s60 offen offset:2048
s_mov_b32 s60, 73728
buffer_load_dword v140, v28, s[56:59], s60 offen offset:0
s_mov_b32 s60, 73728
buffer_load_dword v141, v28, s[56:59], s60 offen offset:2048
s_mov_b32 s60, 77824
buffer_load_dword v142, v28, s[56:59], s60 offen offset:0
s_mov_b32 s60, 77824
buffer_load_dword v143, v28, s[56:59], s60 offen offset:2048
s_waitcnt vmcnt(53) lgkmcnt(3)
v_mfma_f32_32x32x16_bf16 v[32:47], v[152:155], v[112:115], v[32:47]
ds_read_b128 v[96:99], v26 offset:16384
ds_read_b128 v[100:103], v26 offset:20480
s_waitcnt lgkmcnt(4)
v_mfma_f32_32x32x16_bf16 v[48:63], v[152:155], v[116:119], v[48:63]
ds_read_b128 v[104:107], v26 offset:24576
ds_read_b128 v[108:111], v26 offset:28672
s_waitcnt lgkmcnt(5)
v_mfma_f32_32x32x16_bf16 v[64:79], v[152:155], v[120:123], v[64:79]
s_waitcnt lgkmcnt(4)
v_mfma_f32_32x32x16_bf16 v[80:95], v[152:155], v[124:127], v[80:95]
s_waitcnt vmcnt(51) lgkmcnt(3)
v_mfma_f32_32x32x16_bf16 v[32:47], v[156:159], v[96:99], v[32:47]
ds_read_b128 v[112:115], v27 offset:16384
ds_read_b128 v[116:119], v27 offset:20480
s_waitcnt lgkmcnt(4)
v_mfma_f32_32x32x16_bf16 v[48:63], v[156:159], v[100:103], v[48:63]
ds_read_b128 v[120:123], v27 offset:24576
ds_read_b128 v[124:127], v27 offset:28672
s_waitcnt lgkmcnt(5)
v_mfma_f32_32x32x16_bf16 v[64:79], v[156:159], v[104:107], v[64:79]
s_waitcnt lgkmcnt(4)
v_mfma_f32_32x32x16_bf16 v[80:95], v[156:159], v[108:111], v[80:95]
s_waitcnt vmcnt(49) lgkmcnt(3)
v_mfma_f32_32x32x16_bf16 v[32:47], v[160:163], v[112:115], v[32:47]
ds_read_b128 v[96:99], v24 offset:32768
ds_read_b128 v[100:103], v24 offset:36864
s_waitcnt lgkmcnt(4)
v_mfma_f32_32x32x16_bf16 v[48:63], v[160:163], v[116:119], v[48:63]
s_waitcnt lgkmcnt(3)
v_mfma_f32_32x32x16_bf16 v[64:79], v[160:163], v[120:123], v[64:79]
s_waitcnt lgkmcnt(2)
v_mfma_f32_32x32x16_bf16 v[80:95], v[160:163], v[124:127], v[80:95]
s_waitcnt vmcnt(17) lgkmcnt(1)
v_mov_b32 v14, 11
s_mov_b64 exec, 1
ds_write_b32 v13, v14
s_mov_b64 exec, -1
v_mfma_f32_32x32x16_bf16 v[32:47], v[164:167], v[96:99], v[32:47]
ds_read_b128 v[112:115], v25 offset:32768
ds_read_b128 v[116:119], v25 offset:36864
s_waitcnt lgkmcnt(3)
v_mfma_f32_32x32x16_bf16 v[48:63], v[164:167], v[100:103], v[48:63]
s_waitcnt vmcnt(45) lgkmcnt(1)
v_mfma_f32_32x32x16_bf16 v[32:47], v[168:171], v[112:115], v[32:47]
ds_read_b128 v[96:99], v26 offset:32768
ds_read_b128 v[100:103], v26 offset:36864
s_waitcnt lgkmcnt(2)
v_mfma_f32_32x32x16_bf16 v[48:63], v[168:171], v[116:119], v[48:63]
s_waitcnt vmcnt(43) lgkmcnt(1)
v_mfma_f32_32x32x16_bf16 v[32:47], v[172:175], v[96:99], v[32:47]
ds_read_b128 v[112:115], v27 offset:32768
ds_read_b128 v[116:119], v27 offset:36864
s_waitcnt lgkmcnt(2)
v_mfma_f32_32x32x16_bf16 v[48:63], v[172:175], v[100:103], v[48:63]
ds_read_b128 v[8:11], v12
s_waitcnt vmcnt(41) lgkmcnt(0)
L_ck79:
v_min3_u32 v15, v8, v9, v10
v_min_u32 v15, v15, v11
s_nop 0
v_readfirstlane_b32 s60, v15
s_nop 0
s_cmp_ge_u32 s60, 11
s_cbranch_scc1 L_ckd80
ds_read_b128 v[8:11], v12 offset:0
s_waitcnt lgkmcnt(0)
s_branch L_ck79
L_ckd80:
v_mfma_f32_32x32x16_bf16 v[32:47], v[176:179], v[112:115], v[32:47]
ds_read_b128 v[96:99], v20 offset:0
ds_read_b128 v[100:103], v20 offset:4096
v_mfma_f32_32x32x16_bf16 v[48:63], v[176:179], v[116:119], v[48:63]
s_waitcnt vmcnt(39) lgkmcnt(1)
v_mfma_f32_32x32x16_bf16 v[32:47], v[180:183], v[96:99], v[32:47]
ds_read_b128 v[112:115], v21 offset:0
ds_read_b128 v[116:119], v21 offset:4096
s_waitcnt lgkmcnt(2)
v_mfma_f32_32x32x16_bf16 v[48:63], v[180:183], v[100:103], v[48:63]
s_waitcnt vmcnt(37) lgkmcnt(1)
v_mfma_f32_32x32x16_bf16 v[32:47], v[184:187], v[112:115], v[32:47]
ds_read_b128 v[96:99], v22 offset:0
ds_read_b128 v[100:103], v22 offset:4096
s_waitcnt lgkmcnt(2)
v_mfma_f32_32x32x16_bf16 v[48:63], v[184:187], v[116:119], v[48:63]
s_waitcnt vmcnt(35) lgkmcnt(1)
v_mfma_f32_32x32x16_bf16 v[32:47], v[188:191], v[96:99], v[32:47]
ds_read_b128 v[112:115], v23 offset:0
ds_read_b128 v[116:119], v23 offset:4096
s_waitcnt lgkmcnt(2)
v_mfma_f32_32x32x16_bf16 v[48:63], v[188:191], v[100:103], v[48:63]
s_waitcnt vmcnt(33) lgkmcnt(1)
v_mfma_f32_32x32x16_bf16 v[32:47], v[192:195], v[112:115], v[32:47]
ds_read_b128 v[96:99], v20 offset:16384
ds_read_b128 v[100:103], v20 offset:20480
s_waitcnt lgkmcnt(2)
v_mfma_f32_32x32x16_bf16 v[48:63], v[192:195], v[116:119], v[48:63]
s_waitcnt vmcnt(31) lgkmcnt(1)
v_mfma_f32_32x32x16_bf16 v[32:47], v[196:199], v[96:99], v[32:47]
ds_read_b128 v[112:115], v21 offset:16384
ds_read_b128 v[116:119], v21 offset:20480
s_waitcnt lgkmcnt(2)
v_mfma_f32_32x32x16_bf16 v[48:63], v[196:199], v[100:103], v[48:63]
s_waitcnt vmcnt(29) lgkmcnt(1)
v_mfma_f32_32x32x16_bf16 v[32:47], v[200:203], v[112:115], v[32:47]
ds_read_b128 v[96:99], v22 offset:16384
ds_read_b128 v[100:103], v22 offset:20480
s_waitcnt lgkmcnt(2)
v_mfma_f32_32x32x16_bf16 v[48:63], v[200:203], v[116:119], v[48:63]
s_waitcnt vmcnt(27) lgkmcnt(1)
v_mfma_f32_32x32x16_bf16 v[32:47], v[204:207], v[96:99], v[32:47]
ds_read_b128 v[112:115], v23 offset:16384
ds_read_b128 v[116:119], v23 offset:20480
s_waitcnt lgkmcnt(2)
v_mfma_f32_32x32x16_bf16 v[48:63], v[204:207], v[100:103], v[48:63]
s_waitcnt vmcnt(25) lgkmcnt(0)
v_mfma_f32_32x32x16_bf16 v[32:47], v[208:211], v[112:115], v[32:47]
v_mfma_f32_32x32x16_bf16 v[48:63], v[208:211], v[116:119], v[48:63]
s_mul_i32 s60, s37, 0x9e3779b1
s_and_b32 s60, s60, 0xbfff0000
s_or_b32 s60, s60, 0x20000000
s_sub_u32 s61, s37, 1
s_xor_b32 s61, s61, s60
s_cmp_lt_u32 s61, 0x10000
s_cselect_b32 s61, 0x10000, 0
s_xor_b32 s60, s60, s61
s_lshl_b32 s64, s35, 4
s_add_u32 s64, s64, s36
s_lshl_b32 s64, s64, 2
s_add_u32 s64, s64, s34
s_lshl_b32 s64, s64, 13
s_add_u32 s50, s64, 33554432
s_add_u32 s48, s32, s50
s_addc_u32 s49, s33, 0
s_mov_b32 s50, 8192
s_mov_b32 s51, 0x20000
s_xor_b32 s64, s64, 262144
s_add_u32 s54, s64, 33554432
s_add_u32 s52, s32, s54
s_addc_u32 s53, s33, 0
s_mov_b32 s54, 8192
s_mov_b32 s55, 0x20000
s_movk_i32 s64, 0x1000
v_cvt_pk_bf16_f32 v96, v32, v48
v_cvt_pk_bf16_f32 v97, v33, v49
v_cvt_pk_bf16_f32 v98, v34, v50
v_cvt_pk_bf16_f32 v99, v35, s60
buffer_store_dwordx4 v[96:99], v2, s[48:51], 0 offen offset:0 sc1
v_cvt_pk_bf16_f32 v100, v51, v36
v_cvt_pk_bf16_f32 v101, v52, v37
v_cvt_pk_bf16_f32 v102, v53, v38
v_cvt_pk_bf16_f32 v103, v54, s60
buffer_store_dwordx4 v[100:103], v2, s[48:51], 0 offen offset:1024 sc1
v_cvt_pk_bf16_f32 v244, v39, v55
v_cvt_pk_bf16_f32 v245, v40, v56
v_cvt_pk_bf16_f32 v246, v41, v57
v_cvt_pk_bf16_f32 v247, v42, s60
buffer_store_dwordx4 v[244:247], v2, s[48:51], 0 offen offset:2048 sc1
v_cvt_pk_bf16_f32 v248, v58, v43
v_cvt_pk_bf16_f32 v249, v59, v44
v_cvt_pk_bf16_f32 v250, v60, v45
v_cvt_pk_bf16_f32 v251, v61, s60
buffer_store_dwordx4 v[248:251], v2, s[48:51], 0 offen offset:3072 sc1
v_cvt_pk_bf16_f32 v252, v46, v62
v_cvt_pk_bf16_f32 v253, v47, v63
v_cvt_pk_bf16_f32 v254, v63, v63
v_cvt_pk_bf16_f32 v255, v63, s60
buffer_store_dwordx4 v[252:255], v2, s[48:51], s64 offen offset:0 sc1
ds_read_b128 v[104:107], v24 offset:40960
ds_read_b128 v[108:111], v24 offset:45056
ds_read_b128 v[120:123], v25 offset:40960
ds_read_b128 v[124:127], v25 offset:45056
s_waitcnt lgkmcnt(2)
v_mfma_f32_32x32x16_bf16 v[64:79], v[164:167], v[104:107], v[64:79]
v_mfma_f32_32x32x16_bf16 v[80:95], v[164:167], v[108:111], v[80:95]
ds_read_b128 v[104:107], v26 offset:40960
ds_read_b128 v[108:111], v26 offset:45056
s_waitcnt lgkmcnt(2)
v_mfma_f32_32x32x16_bf16 v[64:79], v[168:171], v[120:123], v[64:79]
v_mfma_f32_32x32x16_bf16 v[80:95], v[168:171], v[124:127], v[80:95]
ds_read_b128 v[120:123], v27 offset:40960
ds_read_b128 v[124:127], v27 offset:45056
s_waitcnt lgkmcnt(2)
v_mfma_f32_32x32x16_bf16 v[64:79], v[172:175], v[104:107], v[64:79]
v_mfma_f32_32x32x16_bf16 v[80:95], v[172:175], v[108:111], v[80:95]
ds_read_b128 v[104:107], v20 offset:8192
ds_read_b128 v[108:111], v20 offset:12288
s_waitcnt lgkmcnt(2)
v_mfma_f32_32x32x16_bf16 v[64:79], v[176:179], v[120:123], v[64:79]
v_mfma_f32_32x32x16_bf16 v[80:95], v[176:179], v[124:127], v[80:95]
ds_read_b128 v[120:123], v21 offset:8192
ds_read_b128 v[124:127], v21 offset:12288
s_waitcnt lgkmcnt(2)
v_mfma_f32_32x32x16_bf16 v[64:79], v[180:183], v[104:107], v[64:79]
v_mfma_f32_32x32x16_bf16 v[80:95], v[180:183], v[108:111], v[80:95]
ds_read_b128 v[104:107], v22 offset:8192
ds_read_b128 v[108:111], v22 offset:12288
s_waitcnt lgkmcnt(2)
v_mfma_f32_32x32x16_bf16 v[64:79], v[184:187], v[120:123], v[64:79]
v_mfma_f32_32x32x16_bf16 v[80:95], v[184:187], v[124:127], v[80:95]
ds_read_b128 v[120:123], v23 offset:8192
ds_read_b128 v[124:127], v23 offset:12288
s_waitcnt lgkmcnt(2)
v_mfma_f32_32x32x16_bf16 v[64:79], v[188:191], v[104:107], v[64:79]
v_mfma_f32_32x32x16_bf16 v[80:95], v[188:191], v[108:111], v[80:95]
ds_read_b128 v[104:107], v20 offset:24576
ds_read_b128 v[108:111], v20 offset:28672
s_waitcnt lgkmcnt(2)
v_mfma_f32_32x32x16_bf16 v[64:79], v[192:195], v[120:123], v[64:79]
v_mfma_f32_32x32x16_bf16 v[80:95], v[192:195], v[124:127], v[80:95]
ds_read_b128 v[120:123], v21 offset:24576
ds_read_b128 v[124:127], v21 offset:28672
s_waitcnt lgkmcnt(2)
v_mfma_f32_32x32x16_bf16 v[64:79], v[196:199], v[104:107], v[64:79]
v_mfma_f32_32x32x16_bf16 v[80:95], v[196:199], v[108:111], v[80:95]
ds_read_b128 v[104:107], v22 offset:24576
ds_read_b128 v[108:111], v22 offset:28672
s_waitcnt lgkmcnt(2)
v_mfma_f32_32x32x16_bf16 v[64:79], v[200:203], v[120:123], v[64:79]
v_mfma_f32_32x32x16_bf16 v[80:95], v[200:203], v[124:127], v[80:95]
ds_read_b128 v[120:123], v23 offset:24576
ds_read_b128 v[124:127], v23 offset:28672
s_waitcnt lgkmcnt(2)
v_mfma_f32_32x32x16_bf16 v[64:79], v[204:207], v[104:107], v[64:79]
v_mfma_f32_32x32x16_bf16 v[80:95], v[204:207], v[108:111], v[80:95]
s_waitcnt lgkmcnt(0)
v_mfma_f32_32x32x16_bf16 v[64:79], v[208:211], v[120:123], v[64:79]
v_mfma_f32_32x32x16_bf16 v[80:95], v[208:211], v[124:127], v[80:95]
s_waitcnt vmcnt(5)
v_lshlrev_b32 v8, 16, v31
v_and_b32 v9, 0xffff0000, v31
v_lshlrev_b32 v148, 16, v128
v_and_b32 v149, 0xffff0000, v128
v_pk_mul_f32 v[148:149], v[148:149], v[8:9]
v_cvt_pk_bf16_f32 v10, v148, v149
v_lshlrev_b32 v148, 16, v10
v_and_b32 v149, 0xffff0000, v10
s_nop 1
v_add_f32 v148, v148, v64
v_add_f32 v149, v149, v80
v_lshlrev_b32 v150, 16, v129
v_and_b32 v151, 0xffff0000, v129
v_pk_mul_f32 v[150:151], v[150:151], v[8:9]
v_cvt_pk_bf16_f32 v10, v150, v151
v_lshlrev_b32 v150, 16, v10
v_and_b32 v151, 0xffff0000, v10
v_add_f32 v150, v150, v65
v_add_f32 v151, v151, v81
v_lshlrev_b32 v152, 16, v130
v_and_b32 v153, 0xffff0000, v130
v_pk_mul_f32 v[152:153], v[152:153], v[8:9]
v_cvt_pk_bf16_f32 v10, v152, v153
v_lshlrev_b32 v152, 16, v10
v_and_b32 v153, 0xffff0000, v10
v_add_f32 v152, v152, v66
v_add_f32 v153, v153, v82
v_lshlrev_b32 v154, 16, v131
v_and_b32 v155, 0xffff0000, v131
v_pk_mul_f32 v[154:155], v[154:155], v[8:9]
v_cvt_pk_bf16_f32 v10, v154, v155
v_lshlrev_b32 v154, 16, v10
v_and_b32 v155, 0xffff0000, v10
v_add_f32 v154, v154, v67
v_add_f32 v155, v155, v83
v_lshlrev_b32 v156, 16, v132
v_and_b32 v157, 0xffff0000, v132
v_pk_mul_f32 v[156:157], v[156:157], v[8:9]
v_cvt_pk_bf16_f32 v10, v156, v157
v_lshlrev_b32 v156, 16, v10
v_and_b32 v157, 0xffff0000, v10
v_add_f32 v156, v156, v68
v_add_f32 v157, v157, v84
v_lshlrev_b32 v158, 16, v133
v_and_b32 v159, 0xffff0000, v133
v_pk_mul_f32 v[158:159], v[158:159], v[8:9]
v_cvt_pk_bf16_f32 v10, v158, v159
v_lshlrev_b32 v158, 16, v10
v_and_b32 v159, 0xffff0000, v10
v_add_f32 v158, v158, v69
v_add_f32 v159, v159, v85
v_lshlrev_b32 v160, 16, v134
v_and_b32 v161, 0xffff0000, v134
v_pk_mul_f32 v[160:161], v[160:161], v[8:9]
v_cvt_pk_bf16_f32 v10, v160, v161
v_lshlrev_b32 v160, 16, v10
v_and_b32 v161, 0xffff0000, v10
v_add_f32 v160, v160, v70
v_add_f32 v161, v161, v86
v_lshlrev_b32 v162, 16, v135
v_and_b32 v163, 0xffff0000, v135
v_pk_mul_f32 v[162:163], v[162:163], v[8:9]
v_cvt_pk_bf16_f32 v10, v162, v163
v_lshlrev_b32 v162, 16, v10
v_and_b32 v163, 0xffff0000, v10
v_add_f32 v162, v162, v71
v_add_f32 v163, v163, v87
v_lshlrev_b32 v164, 16, v136
v_and_b32 v165, 0xffff0000, v136
v_pk_mul_f32 v[164:165], v[164:165], v[8:9]
v_cvt_pk_bf16_f32 v10, v164, v165
v_lshlrev_b32 v164, 16, v10
v_and_b32 v165, 0xffff0000, v10
v_add_f32 v164, v164, v72
v_add_f32 v165, v165, v88
v_lshlrev_b32 v166, 16, v137
v_and_b32 v167, 0xffff0000, v137
v_pk_mul_f32 v[166:167], v[166:167], v[8:9]
v_cvt_pk_bf16_f32 v10, v166, v167
v_lshlrev_b32 v166, 16, v10
v_and_b32 v167, 0xffff0000, v10
v_add_f32 v166, v166, v73
v_add_f32 v167, v167, v89
v_lshlrev_b32 v168, 16, v138
v_and_b32 v169, 0xffff0000, v138
v_pk_mul_f32 v[168:169], v[168:169], v[8:9]
v_cvt_pk_bf16_f32 v10, v168, v169
v_lshlrev_b32 v168, 16, v10
v_and_b32 v169, 0xffff0000, v10
v_add_f32 v168, v168, v74
v_add_f32 v169, v169, v90
v_lshlrev_b32 v170, 16, v139
v_and_b32 v171, 0xffff0000, v139
v_pk_mul_f32 v[170:171], v[170:171], v[8:9]
v_cvt_pk_bf16_f32 v10, v170, v171
v_lshlrev_b32 v170, 16, v10
v_and_b32 v171, 0xffff0000, v10
v_add_f32 v170, v170, v75
v_add_f32 v171, v171, v91
v_lshlrev_b32 v172, 16, v140
v_and_b32 v173, 0xffff0000, v140
v_pk_mul_f32 v[172:173], v[172:173], v[8:9]
v_cvt_pk_bf16_f32 v10, v172, v173
v_lshlrev_b32 v172, 16, v10
v_and_b32 v173, 0xffff0000, v10
v_add_f32 v172, v172, v76
v_add_f32 v173, v173, v92
v_lshlrev_b32 v174, 16, v141
v_and_b32 v175, 0xffff0000, v141
v_pk_mul_f32 v[174:175], v[174:175], v[8:9]
v_cvt_pk_bf16_f32 v10, v174, v175
v_lshlrev_b32 v174, 16, v10
v_and_b32 v175, 0xffff0000, v10
v_add_f32 v174, v174, v77
v_add_f32 v175, v175, v93
v_lshlrev_b32 v176, 16, v142
v_and_b32 v177, 0xffff0000, v142
v_pk_mul_f32 v[176:177], v[176:177], v[8:9]
v_cvt_pk_bf16_f32 v10, v176, v177
v_lshlrev_b32 v176, 16, v10
v_and_b32 v177, 0xffff0000, v10
v_add_f32 v176, v176, v78
v_add_f32 v177, v177, v94
v_lshlrev_b32 v178, 16, v143
v_and_b32 v179, 0xffff0000, v143
v_pk_mul_f32 v[178:179], v[178:179], v[8:9]
v_cvt_pk_bf16_f32 v10, v178, v179
v_lshlrev_b32 v178, 16, v10
v_and_b32 v179, 0xffff0000, v10
v_add_f32 v178, v178, v79
v_add_f32 v179, v179, v95
s_mov_b32 s44, s28
s_mov_b32 s45, s29
s_mov_b32 s46, s24
s_mov_b32 s47, 0x20000
s_mov_b32 s92, 0
L_xw83:
s_load_dword s61, s[52:53], 5116 glc
s_add_u32 s92, s92, 1
s_waitcnt lgkmcnt(0)
s_xor_b32 s61, s61, s60
s_cmp_lt_u32 s61, 0x10000
s_cbranch_scc1 L_xwd84
s_cmp_lt_u32 s92, 200000
s_cbranch_scc1 L_xw83
L_xwd84:
s_mov_b32 s92, 0
buffer_load_dwordx4 v[180:183], v2, s[52:55], 0 offen offset:0 sc1
buffer_load_dwordx4 v[184:187], v2, s[52:55], 0 offen offset:1024 sc1
buffer_load_dwordx4 v[188:191], v2, s[52:55], 0 offen offset:2048 sc1
buffer_load_dwordx4 v[192:195], v2, s[52:55], 0 offen offset:3072 sc1
buffer_load_dwordx4 v[196:199], v2, s[52:55], s64 offen offset:0 sc1
L_xl81:
v_mov_b32 v10, 0
s_waitcnt vmcnt(4)
v_bitop3_b32 v10, v10, v183, s60 bitop3:0xf6
s_waitcnt vmcnt(3)
v_bitop3_b32 v10, v10, v187, s60 bitop3:0xf6
s_waitcnt vmcnt(2)
v_bitop3_b32 v10, v10, v191, s60 bitop3:0xf6
s_waitcnt vmcnt(1)
v_bitop3_b32 v10, v10, v195, s60 bitop3:0xf6
s_waitcnt vmcnt(0)
v_bitop3_b32 v10, v10, v199, s60 bitop3:0xf6
v_cmp_lt_u32 vcc, 0xffff, v10
s_nop 0
s_cbranch_vccz L_xd82
s_add_u32 s92, s92, 1
s_cmp_ge_u32 s92, 200000
s_cbranch_scc1 L_xd82
buffer_load_dwordx4 v[180:183], v2, s[52:55], 0 offen offset:0 sc1
buffer_load_dwordx4 v[184:187], v2, s[52:55], 0 offen offset:1024 sc1
buffer_load_dwordx4 v[188:191], v2, s[52:55], 0 offen offset:2048 sc1
buffer_load_dwordx4 v[192:195], v2, s[52:55], 0 offen offset:3072 sc1
buffer_load_dwordx4 v[196:199], v2, s[52:55], s64 offen offset:0 sc1
s_branch L_xl81
L_xd82:
v_lshlrev_b32 v10, 16, v180
v_and_b32 v11, 0xffff0000, v180
v_pk_add_f32 v[148:149], v[148:149], v[10:11]
s_mov_b32 s64, 0
buffer_store_dwordx2 v[148:149], v29, s[44:47], s64 offen nt
v_lshlrev_b32 v10, 16, v181
v_and_b32 v11, 0xffff0000, v181
v_pk_add_f32 v[150:151], v[150:151], v[10:11]
s_mov_b32 s64, 8192
buffer_store_dwordx2 v[150:151], v29, s[44:47], s64 offen nt
v_lshlrev_b32 v10, 16, v182
v_and_b32 v11, 0xffff0000, v182
v_pk_add_f32 v[152:153], v[152:153], v[10:11]
s_mov_b32 s64, 16384
buffer_store_dwordx2 v[152:153], v29, s[44:47], s64 offen nt
v_lshlrev_b32 v10, 16, v183
v_lshlrev_b32 v11, 16, v184
v_pk_add_f32 v[154:155], v[154:155], v[10:11]
s_mov_b32 s64, 24576
buffer_store_dwordx2 v[154:155], v29, s[44:47], s64 offen nt
v_and_b32 v10, 0xffff0000, v184
v_lshlrev_b32 v11, 16, v185
v_pk_add_f32 v[156:157], v[156:157], v[10:11]
s_mov_b32 s64, 262144
buffer_store_dwordx2 v[156:157], v29, s[44:47], s64 offen nt
v_and_b32 v10, 0xffff0000, v185
v_lshlrev_b32 v11, 16, v186
v_pk_add_f32 v[158:159], v[158:159], v[10:11]
s_mov_b32 s64, 270336
buffer_store_dwordx2 v[158:159], v29, s[44:47], s64 offen nt
v_and_b32 v10, 0xffff0000, v186
v_lshlrev_b32 v11, 16, v187
v_pk_add_f32 v[160:161], v[160:161], v[10:11]
s_mov_b32 s64, 278528
buffer_store_dwordx2 v[160:161], v29, s[44:47], s64 offen nt
v_lshlrev_b32 v10, 16, v188
v_and_b32 v11, 0xffff0000, v188
v_pk_add_f32 v[162:163], v[162:163], v[10:11]
s_mov_b32 s64, 286720
buffer_store_dwordx2 v[162:163], v29, s[44:47], s64 offen nt
v_lshlrev_b32 v10, 16, v189
v_and_b32 v11, 0xffff0000, v189
v_pk_add_f32 v[164:165], v[164:165], v[10:11]
s_mov_b32 s64, 32768
buffer_store_dwordx2 v[164:165], v29, s[44:47], s64 offen nt
v_lshlrev_b32 v10, 16, v190
v_and_b32 v11, 0xffff0000, v190
v_pk_add_f32 v[166:167], v[166:167], v[10:11]
s_mov_b32 s64, 40960
buffer_store_dwordx2 v[166:167], v29, s[44:47], s64 offen nt
v_lshlrev_b32 v10, 16, v191
v_lshlrev_b32 v11, 16, v192
v_pk_add_f32 v[168:169], v[168:169], v[10:11]
s_mov_b32 s64, 49152
buffer_store_dwordx2 v[168:169], v29, s[44:47], s64 offen nt
v_and_b32 v10, 0xffff0000, v192
v_lshlrev_b32 v11, 16, v193
v_pk_add_f32 v[170:171], v[170:171], v[10:11]
s_mov_b32 s64, 57344
buffer_store_dwordx2 v[170:171], v29, s[44:47], s64 offen nt
v_and_b32 v10, 0xffff0000, v193
v_lshlrev_b32 v11, 16, v194
v_pk_add_f32 v[172:173], v[172:173], v[10:11]
s_mov_b32 s64, 294912
buffer_store_dwordx2 v[172:173], v29, s[44:47], s64 offen nt
v_and_b32 v10, 0xffff0000, v194
v_lshlrev_b32 v11, 16, v195
v_pk_add_f32 v[174:175], v[174:175], v[10:11]
s_mov_b32 s64, 303104
buffer_store_dwordx2 v[174:175], v29, s[44:47], s64 offen nt
v_lshlrev_b32 v10, 16, v196
v_and_b32 v11, 0xffff0000, v196
v_pk_add_f32 v[176:177], v[176:177], v[10:11]
s_mov_b32 s64, 311296
buffer_store_dwordx2 v[176:177], v29, s[44:47], s64 offen nt
v_lshlrev_b32 v10, 16, v197
v_and_b32 v11, 0xffff0000, v197
v_pk_add_f32 v[178:179], v[178:179], v[10:11]
s_mov_b32 s64, 319488
buffer_store_dwordx2 v[178:179], v29, s[44:47], s64 offen nt
L_concat_heads__spectral_gfnet__ssm_conv_s5__prompt_kernel_end:
s_endpgm

.section .rodata,"a"
.p2align 6
.amdhsa_kernel concat_heads__spectral_gfnet__ssm_conv_s5__prompt_kernel
  .amdhsa_next_free_vgpr 256
  .amdhsa_next_free_sgpr 102
  .amdhsa_accum_offset 256
  .amdhsa_group_segment_fixed_size 0
  .amdhsa_kernarg_size 120
  .amdhsa_user_sgpr_count 2
  .amdhsa_user_sgpr_kernarg_segment_ptr 1
  .amdhsa_system_sgpr_workgroup_id_x 1
.end_amdhsa_kernel
.text
```

```asm
; @launch grid=(256,1,1) block=(512,1,1) lds=163840
.amdgcn_target "amdgcn-amd-amdhsa--gfx950"
.text
.globl concat_heads__spectral_gfnet__ssm_conv_s5__prompt_kernel
.p2align 8
.type concat_heads__spectral_gfnet__ssm_conv_s5__prompt_kernel,@function
concat_heads__spectral_gfnet__ssm_conv_s5__prompt_kernel:
s_cmp_ge_u32 s2, 256
s_cbranch_scc1 L_concat_heads__spectral_gfnet__ssm_conv_s5__prompt_kernel_end
s_load_dwordx16 s[4:19], s[0:1], 0
s_load_dwordx8 s[20:27], s[0:1], 64
s_load_dwordx4 s[28:31], s[0:1], 96
s_load_dwordx2 s[32:33], s[0:1], 112
v_lshrrev_b32 v2, 6, v0
v_and_b32 v1, 63, v0
v_readfirstlane_b32 s34, v2
s_and_b32 s60, s2, 7
s_lshr_b32 s61, s2, 3
s_lshr_b32 s35, s60, 1
s_lshr_b32 s62, s61, 3
s_lshl_b32 s62, s62, 2
s_add_u32 s35, s35, s62
s_and_b32 s36, s60, 1
s_lshl_b32 s36, s36, 3
s_and_b32 s62, s61, 7
s_add_u32 s36, s36, s62
s_xor_b32 s34, s34, 4
s_cmp_ge_u32 s34, 4
s_cbranch_scc0 L_concat_heads__spectral_gfnet__ssm_conv_s5__prompt_kernel_gemm
s_sub_u32 s66, s34, 4
s_setprio 0
s_waitcnt lgkmcnt(0)
s_mov_b32 s100, s20
s_mov_b32 s101, s21
s_bitcmp1_b32 s66, 0
s_cselect_b32 s100, s22, s20
s_cselect_b32 s101, s23, s21
s_cmp_lg_u32 s66, 1
s_cbranch_scc1 L_pf1
s_lshr_b32 s60, s2, 3
s_lshl_b32 s60, s60, 11
v_and_b32 v12, 15, v1
v_lshl_add_u32 v12, v12, 7, s60
v_min_u32 v12, L_concat_heads__spectral_gfnet__ssm_conv_s5__prompt_kernel_end-concat_heads__spectral_gfnet__ssm_conv_s5__prompt_kernel, v12
s_getpc_b64 s[60:61]
L_pc2:
s_sub_u32 s60, s60, L_pc2-concat_heads__spectral_gfnet__ssm_conv_s5__prompt_kernel
s_subb_u32 s61, s61, 0
global_load_dword v23, v12, s[60:61]
L_pf1:
s_lshl_b32 s60, s2, 3
s_add_u32 s60, s60, s34
s_cmp_lg_u32 s60, 4
s_cbranch_scc1 L_nn3
s_load_dword s3, s[32:33], 0
L_nn3:
s_mov_b32 s48, s6
s_mov_b32 s49, s7
s_mov_b32 s50, 2101248
s_mov_b32 s51, 0x20000
s_mov_b32 s52, s8
s_mov_b32 s53, s9
s_mov_b32 s54, 2101248
s_mov_b32 s55, 0x20000
s_and_b32 s60, s2, 31
s_lshr_b32 s61, s2, 5
s_lshl_b32 s61, s61, 7
s_add_u32 s60, s60, s61
s_lshl_b32 s61, s66, 5
s_add_u32 s67, s60, s61
s_lshl_b32 s60, s67, 12
s_add_u32 s4, s4, s60
s_addc_u32 s5, s5, 0
s_mov_b32 s6, 4096
s_mov_b32 s7, 0x20000
v_lshlrev_b32 v2, 4, v1
v_xor_b32 v3, 128, v2
s_lshl_b32 s68, s66, 12
s_add_u32 s68, s68, 131072
s_add_u32 m0, s68, 0
s_mov_b32 s92, 0
buffer_load_dwordx4 v2, s[4:7], s92 offen offset:0 nt lds
buffer_load_dwordx4 v2, s[4:7], s92 offen offset:1024 nt lds
s_add_u32 m0, s68, 2048
s_mov_b32 s92, 2048
buffer_load_dwordx4 v3, s[4:7], s92 offen offset:0 nt lds
buffer_load_dwordx4 v3, s[4:7], s92 offen offset:1024 nt lds
s_lshl_b32 s69, s2, 2
s_add_u32 s69, s69, s66
s_mul_i32 s69, s69, 1026
s_add_u32 s92, s69, 0
s_lshl_b32 s64, s66, 12
s_add_u32 m0, s64, 147456
s_nop 0
buffer_load_dwordx4 v2, s[48:51], s92 offen nt lds
s_lshl_b32 s64, s66, 12
s_add_u32 m0, s64, 148480
s_nop 0
buffer_load_dwordx4 v2, s[52:55], s92 offen nt lds
s_add_u32 s92, s69, 1050624
s_lshl_b32 s64, s66, 12
s_add_u32 m0, s64, 149504
s_nop 0
buffer_load_dwordx4 v2, s[48:51], s92 offen nt lds
s_lshl_b32 s64, s66, 12
s_add_u32 m0, s64, 150528
s_nop 0
buffer_load_dwordx4 v2, s[52:55], s92 offen nt lds
s_bfe_u32 s64, s2, 0x20005
s_lshl_b32 s64, s64, 8
s_bfe_u32 s65, s2, 0x10004
s_lshl_b32 s65, s65, 6
s_add_u32 s64, s64, s65
s_bfe_u32 s65, s2, 0x10003
s_lshl_b32 s65, s65, 7
s_add_u32 s64, s64, s65
s_and_b32 s65, s2, 7
s_lshl_b32 s65, s65, 2
s_add_u32 s64, s64, s65
v_bfe_u32 v8, v1, 3, 2
v_add_u32 v8, s64, v8
v_bfe_u32 v9, v1, 2, 1
v_lshl_add_u32 v8, v9, 5, v8
v_bfe_u32 v9, v1, 1, 1
v_lshl_add_u32 v8, v9, 10, v8
v_sub_u32 v9, 2048, v8
v_and_b32 v9, 2047, v9
v_and_b32 v10, 1, v1
v_cmp_eq_u32 vcc, 1, v10
s_nop 1
v_cndmask_b32 v8, v8, v9, vcc
v_mul_u32_u24 v17, 1026, v8
s_lshr_b32 s64, s2, 7
s_lshl_b32 s64, s64, 10
v_add_u32 v17, s64, v17
s_cmp_lg_u32 s66, 3
s_cbranch_scc1 L_nw4
s_mov_b32 exec_hi, 0
buffer_load_ushort v88, v17, s[48:51], 0 offen nt
buffer_load_ushort v89, v17, s[52:55], 0 offen nt
s_mov_b64 exec, -1
L_nw4:
s_cmp_lg_u32 s2, 0
s_cbranch_scc1 L_nz5
s_lshl_b32 s24, s66, 10
s_add_u32 s24, s24, 4096
s_add_u32 s24, s32, s24
s_addc_u32 s25, s33, 0
s_mov_b32 s26, 0
s_atomic_swap s26, s[24:25], 0x0
s_atomic_swap s26, s[24:25], 0x80
s_atomic_swap s26, s[24:25], 0x100
s_atomic_swap s26, s[24:25], 0x180
s_atomic_swap s26, s[24:25], 0x200
s_atomic_swap s26, s[24:25], 0x280
s_atomic_swap s26, s[24:25], 0x300
s_atomic_swap s26, s[24:25], 0x380
L_nz5:
s_barrier
v_and_b32 v92, 31, v1
v_cvt_f32_u32 v92, v92
v_lshrrev_b32 v93, 5, v1
v_lshlrev_b32 v93, 2, v93
v_cvt_f32_u32 v93, v93
v_mul_f32 v93, v92, v93
v_mul_f32 v93, 0x3d000000, v93
v_fmamk_f32 v94, v92, 0x0, v93
v_fract_f32 v94, v94
v_cos_f32 v95, v94
v_sin_f32 v96, v94
s_nop 0
v_cvt_pk_bf16_f32 v192, v95, v96
v_cvt_pk_bf16_f32 v208, -v96, v95
v_fmamk_f32 v97, v92, 0x3d000000, v93
v_fract_f32 v97, v97
v_cos_f32 v98, v97
v_sin_f32 v99, v97
s_nop 0
v_cvt_pk_bf16_f32 v193, v98, v99
v_cvt_pk_bf16_f32 v209, -v99, v98
v_fmamk_f32 v94, v92, 0x3d800000, v93
v_fract_f32 v94, v94
v_cos_f32 v95, v94
v_sin_f32 v96, v94
s_nop 0
v_cvt_pk_bf16_f32 v194, v95, v96
v_cvt_pk_bf16_f32 v210, -v96, v95
v_fmamk_f32 v97, v92, 0x3dc00000, v93
v_fract_f32 v97, v97
v_cos_f32 v98, v97
v_sin_f32 v99, v97
s_nop 0
v_cvt_pk_bf16_f32 v195, v98, v99
v_cvt_pk_bf16_f32 v211, -v99, v98
v_fmamk_f32 v94, v92, 0x3e800000, v93
v_fract_f32 v94, v94
v_cos_f32 v95, v94
v_sin_f32 v96, v94
s_nop 0
v_cvt_pk_bf16_f32 v196, v95, v96
v_cvt_pk_bf16_f32 v212, -v96, v95
v_fmamk_f32 v97, v92, 0x3e900000, v93
v_fract_f32 v97, v97
v_cos_f32 v98, v97
v_sin_f32 v99, v97
s_nop 0
v_cvt_pk_bf16_f32 v197, v98, v99
v_cvt_pk_bf16_f32 v213, -v99, v98
v_fmamk_f32 v94, v92, 0x3ea00000, v93
v_fract_f32 v94, v94
v_cos_f32 v95, v94
v_sin_f32 v96, v94
s_nop 0
v_cvt_pk_bf16_f32 v198, v95, v96
v_cvt_pk_bf16_f32 v214, -v96, v95
v_fmamk_f32 v97, v92, 0x3eb00000, v93
v_fract_f32 v97, v97
v_cos_f32 v98, v97
v_sin_f32 v99, v97
s_nop 0
v_cvt_pk_bf16_f32 v199, v98, v99
v_cvt_pk_bf16_f32 v215, -v99, v98
v_fmamk_f32 v94, v92, 0x3f000000, v93
v_fract_f32 v94, v94
v_cos_f32 v95, v94
v_sin_f32 v96, v94
s_nop 0
v_cvt_pk_bf16_f32 v200, v95, v96
v_cvt_pk_bf16_f32 v216, -v96, v95
v_fmamk_f32 v97, v92, 0x3f080000, v93
v_fract_f32 v97, v97
v_cos_f32 v98, v97
v_sin_f32 v99, v97
s_nop 0
v_cvt_pk_bf16_f32 v201, v98, v99
v_cvt_pk_bf16_f32 v217, -v99, v98
v_fmamk_f32 v94, v92, 0x3f100000, v93
v_fract_f32 v94, v94
v_cos_f32 v95, v94
v_sin_f32 v96, v94
s_nop 0
v_cvt_pk_bf16_f32 v202, v95, v96
v_cvt_pk_bf16_f32 v218, -v96, v95
v_fmamk_f32 v97, v92, 0x3f180000, v93
v_fract_f32 v97, v97
v_cos_f32 v98, v97
v_sin_f32 v99, v97
s_nop 0
v_cvt_pk_bf16_f32 v203, v98, v99
v_cvt_pk_bf16_f32 v219, -v99, v98
v_fmamk_f32 v94, v92, 0x3f400000, v93
v_fract_f32 v94, v94
v_cos_f32 v95, v94
v_sin_f32 v96, v94
s_nop 0
v_cvt_pk_bf16_f32 v204, v95, v96
v_cvt_pk_bf16_f32 v220, -v96, v95
v_fmamk_f32 v97, v92, 0x3f480000, v93
v_fract_f32 v97, v97
v_cos_f32 v98, v97
v_sin_f32 v99, v97
s_nop 0
v_cvt_pk_bf16_f32 v205, v98, v99
v_cvt_pk_bf16_f32 v221, -v99, v98
v_fmamk_f32 v94, v92, 0x3f500000, v93
v_fract_f32 v94, v94
v_cos_f32 v95, v94
v_sin_f32 v96, v94
s_nop 0
v_cvt_pk_bf16_f32 v206, v95, v96
v_cvt_pk_bf16_f32 v222, -v96, v95
v_fmamk_f32 v97, v92, 0x3f580000, v93
v_fract_f32 v97, v97
v_cos_f32 v98, v97
v_sin_f32 v99, v97
s_nop 0
v_cvt_pk_bf16_f32 v207, v98, v99
v_cvt_pk_bf16_f32 v223, -v99, v98
v_and_b32 v92, 31, v1
v_cvt_f32_u32 v92, v92
v_lshrrev_b32 v93, 5, v1
v_lshlrev_b32 v93, 2, v93
v_cvt_f32_u32 v93, v93
v_mul_f32 v93, v92, v93
v_mul_f32 v93, 0x3a800000, v93
v_fmamk_f32 v94, v92, 0x0, v93
v_cos_f32 v224, v94
v_sin_f32 v240, -v94
v_fmamk_f32 v95, v92, 0x3a800000, v93
v_cos_f32 v225, v95
v_sin_f32 v241, -v95
v_fmamk_f32 v94, v92, 0x3b000000, v93
v_cos_f32 v226, v94
v_sin_f32 v242, -v94
v_fmamk_f32 v95, v92, 0x3b400000, v93
v_cos_f32 v227, v95
v_sin_f32 v243, -v95
v_fmamk_f32 v94, v92, 0x3c000000, v93
v_cos_f32 v228, v94
v_sin_f32 v244, -v94
v_fmamk_f32 v95, v92, 0x3c100000, v93
v_cos_f32 v229, v95
v_sin_f32 v245, -v95
v_fmamk_f32 v94, v92, 0x3c200000, v93
v_cos_f32 v230, v94
v_sin_f32 v246, -v94
v_fmamk_f32 v95, v92, 0x3c300000, v93
v_cos_f32 v231, v95
v_sin_f32 v247, -v95
v_fmamk_f32 v94, v92, 0x3c800000, v93
v_cos_f32 v232, v94
v_sin_f32 v248, -v94
v_fmamk_f32 v95, v92, 0x3c880000, v93
v_cos_f32 v233, v95
v_sin_f32 v249, -v95
v_fmamk_f32 v94, v92, 0x3c900000, v93
v_cos_f32 v234, v94
v_sin_f32 v250, -v94
v_fmamk_f32 v95, v92, 0x3c980000, v93
v_cos_f32 v235, v95
v_sin_f32 v251, -v95
v_fmamk_f32 v94, v92, 0x3cc00000, v93
v_cos_f32 v236, v94
v_sin_f32 v252, -v94
v_fmamk_f32 v95, v92, 0x3cc80000, v93
v_cos_f32 v237, v95
v_sin_f32 v253, -v95
v_fmamk_f32 v94, v92, 0x3cd00000, v93
v_cos_f32 v238, v94
v_sin_f32 v254, -v94
v_fmamk_f32 v95, v92, 0x3cd80000, v93
v_cos_f32 v239, v95
v_sin_f32 v255, -v95
v_mov_b32 v184, 126992
s_lshl_b32 s64, s66, 2
v_add_u32 v185, s64, v184
v_and_b32 v8, 31, v1
v_lshrrev_b32 v9, 5, v1
v_and_b32 v10, 1, v1
v_lshrrev_b32 v11, 1, v8
v_lshlrev_b32 v4, 6, v11
v_lshl_add_u32 v4, v10, 4, v4
v_lshl_add_u32 v4, v9, 12, v4
v_add_u32 v11, v11, v10
v_lshlrev_b32 v11, 6, v11
v_lshl_add_u32 v11, v10, 4, v11
v_lshl_add_u32 v11, v9, 12, v11
v_sub_u32 v5, 5168, v11
v_bfe_u32 v11, v4, 7, 1
v_lshlrev_b32 v11, 5, v11
v_xor_b32 v4, v4, v11
v_bfe_u32 v11, v5, 7, 1
v_lshlrev_b32 v11, 5, v11
v_xor_b32 v5, v5, v11
v_add_u32 v6, 11264, v5
v_and_b32 v6, 0x3fff, v6
s_add_u32 s64, s64, 98304
v_add_u32 v4, s64, v4
v_add_u32 v5, s64, v5
v_add_u32 v6, s64, v6
v_bfe_u32 v11, v1, 3, 1
v_lshlrev_b32 v11, 5, v11
v_xor_b32 v7, v2, v11
v_bfe_u32 v12, v1, 2, 1
v_mul_u32_u24 v12, 2176, v12
v_bfe_u32 v13, v1, 3, 1
v_lshl_add_u32 v12, v13, 6, v12
v_lshl_add_u32 v12, v9, 8, v12
v_bfe_u32 v13, v1, 4, 1
v_lshl_add_u32 v12, v13, 5, v12
v_and_b32 v13, 3, v1
v_lshl_add_u32 v12, v13, 3, v12
v_add_u32 v12, s68, v12
v_xor_b32 v13, 128, v12
s_lshl_b32 s64, s2, 14
s_lshl_b32 s65, s66, 12
s_add_u32 s64, s64, s65
s_add_u32 s42, s64, 16777216
s_add_u32 s40, s32, s42
s_addc_u32 s41, s33, 0
s_mov_b32 s42, 4096
s_mov_b32 s43, 0x20000
s_add_u32 s46, s64, 16777216
s_add_u32 s44, s32, s46
s_addc_u32 s45, s33, 0
s_mov_b32 s46, 4096
s_mov_b32 s47, 0x20000
s_lshl_b32 s64, s66, 8
s_add_u32 s64, s64, 147456
v_lshl_add_u32 v14, v1, 2, s64
v_bfe_u32 v8, v1, 1, 2
v_lshlrev_b32 v8, 4, v8
v_lshl_add_u32 v8, v1, 6, v8
v_add_u32 v15, s68, v8
s_and_b32 s64, s2, 6
s_bfe_u32 s65, s2, 0x10004
s_or_b32 s64, s64, s65
v_and_b32 v8, 7, v1
v_xor_b32 v8, s64, v8
v_lshrrev_b32 v9, 3, v1
v_and_b32 v10, 3, v8
v_lshlrev_b32 v11, 4, v10
v_lshl_add_u32 v11, v9, 6, v11
v_bfe_u32 v16, v9, 1, 1
v_lshlrev_b32 v16, 5, v16
v_xor_b32 v16, v11, v16
s_lshl_b32 s65, s66, 12
s_add_u32 s65, s65, 98304
v_add_u32 v16, s65, v16
v_bfe_u32 v11, v9, 1, 2
v_xor_b32 v11, v10, v11
v_lshlrev_b32 v11, 4, v11
v_lshl_add_u32 v11, v9, 6, v11
v_add_u32 v11, s68, v11
v_cmp_gt_u32 vcc, 4, v8
s_nop 1
v_cndmask_b32 v16, v11, v16, vcc
s_lshl_b32 s64, s2, 15
s_lshl_b32 s65, s66, 13
s_add_u32 s64, s64, s65
s_add_u32 s42, s64, 50331648
s_add_u32 s40, s32, s42
s_addc_u32 s41, s33, 0
s_mov_b32 s42, 8192
s_mov_b32 s43, 0x20000
s_lshl_b32 s64, s35, 18
s_lshl_b32 s65, s36, 17
s_add_u32 s12, s10, s64
s_addc_u32 s13, s11, 0
s_mov_b32 s14, 262144
s_mov_b32 s15, 0x20000
s_bitcmp1_b32 s66, 0
s_cselect_b32 s8, s18, s16
s_cselect_b32 s9, s19, s17
s_add_u32 s20, s8, s65
s_addc_u32 s21, s9, 0
s_mov_b32 s22, 131072
s_mov_b32 s23, 0x20000
s_bfe_u32 s16, s2, 0x20001
s_lshl_b32 s16, s16, 2
s_lshr_b32 s64, s2, 6
s_add_u32 s16, s16, s64
s_mul_i32 s16, s16, 128
s_mul_i32 s64, s36, 128
s_add_u32 s16, s16, s64
s_bfe_u32 s64, s16, 0x30007
s_cmp_eq_u32 s64, 3
s_cselect_b32 s64, 128, 0
s_add_u32 s16, s16, s64
s_lshl_b32 s17, s66, 12
s_lshr_b32 s64, s66, 1
s_and_b32 s65, s66, 1
v_lshrrev_b32 v96, 5, v1
v_bfe_u32 v97, v1, 3, 2
v_and_b32 v98, 1, v97
v_lshrrev_b32 v99, 1, v97
v_lshlrev_b32 v100, 4, v96
v_lshl_add_u32 v100, v98, 3, v100
v_add_u32 v100, v100, v99
s_lshl_b32 s92, s64, 6
s_lshl_b32 s19, s65, 2
s_add_u32 s92, s92, s19
v_add_u32 v100, s92, v100
v_lshlrev_b32 v100, 11, v100
s_lshl_b32 s92, s64, 5
v_lshl_add_u32 v101, v96, 3, v97
v_add_u32 v101, s92, v101
v_lshlrev_b32 v101, 11, v101
v_and_b32 v98, 7, v1
v_lshrrev_b32 v99, 4, v1
v_xor_b32 v98, v98, v99
v_lshlrev_b32 v98, 4, v98
v_xor_b32 v99, 64, v98
v_add_u32 v176, v100, v98
v_add_u32 v177, v100, v99
v_add_u32 v177, 64512, v177
v_add_u32 v178, v101, v98
v_add_u32 v179, v101, v99
v_add_u32 v179, 31744, v179
s_waitcnt vmcnt(4)
ds_read_b64_tr_b16 v[24:25], v12 offset:0
ds_read_b64_tr_b16 v[26:27], v13 offset:0
ds_read_b64_tr_b16 v[28:29], v12 offset:512
ds_read_b64_tr_b16 v[30:31], v13 offset:512
ds_read_b64_tr_b16 v[32:33], v12 offset:1024
ds_read_b64_tr_b16 v[34:35], v13 offset:1024
ds_read_b64_tr_b16 v[36:37], v12 offset:1536
ds_read_b64_tr_b16 v[38:39], v13 offset:1536
s_waitcnt lgkmcnt(0)
v_mfma_f32_32x32x16_bf16 v[40:55], v[24:27], v[192:195], 0
v_mfma_f32_32x32x16_bf16 v[40:55], v[28:31], v[196:199], v[40:55]
v_mfma_f32_32x32x16_bf16 v[40:55], v[32:35], v[200:203], v[40:55]
v_mfma_f32_32x32x16_bf16 v[40:55], v[36:39], v[204:207], v[40:55]
v_mfma_f32_32x32x16_bf16 v[56:71], v[24:27], v[208:211], 0
v_mfma_f32_32x32x16_bf16 v[56:71], v[28:31], v[212:215], v[56:71]
v_mfma_f32_32x32x16_bf16 v[56:71], v[32:35], v[216:219], v[56:71]
v_mfma_f32_32x32x16_bf16 v[56:71], v[36:39], v[220:223], v[56:71]
s_nop 7
v_mul_f32 v168, v40, v224
v_mul_f32 v169, v40, v240
s_nop 1
v_fma_f32 v168, -v56, v240, v168
v_fmac_f32 v169, v56, v224
v_cvt_pk_bf16_f32 v72, v168, v169
v_mul_f32 v170, v41, v225
v_mul_f32 v171, v41, v241
v_fma_f32 v170, -v57, v241, v170
v_fmac_f32 v171, v57, v225
v_cvt_pk_bf16_f32 v73, v170, v171
v_mul_f32 v172, v42, v226
v_mul_f32 v173, v42, v242
v_fma_f32 v172, -v58, v242, v172
v_fmac_f32 v173, v58, v226
v_cvt_pk_bf16_f32 v74, v172, v173
v_mul_f32 v174, v43, v227
v_mul_f32 v175, v43, v243
v_fma_f32 v174, -v59, v243, v174
v_fmac_f32 v175, v59, v227
v_cvt_pk_bf16_f32 v75, v174, v175
v_mul_f32 v168, v44, v228
v_mul_f32 v169, v44, v244
v_fma_f32 v168, -v60, v244, v168
v_fmac_f32 v169, v60, v228
v_cvt_pk_bf16_f32 v76, v168, v169
v_mul_f32 v170, v45, v229
v_mul_f32 v171, v45, v245
v_fma_f32 v170, -v61, v245, v170
v_fmac_f32 v171, v61, v229
v_cvt_pk_bf16_f32 v77, v170, v171
v_mul_f32 v172, v46, v230
v_mul_f32 v173, v46, v246
v_fma_f32 v172, -v62, v246, v172
v_fmac_f32 v173, v62, v230
v_cvt_pk_bf16_f32 v78, v172, v173
v_mul_f32 v174, v47, v231
v_mul_f32 v175, v47, v247
v_fma_f32 v174, -v63, v247, v174
v_fmac_f32 v175, v63, v231
v_cvt_pk_bf16_f32 v79, v174, v175
v_mul_f32 v168, v48, v232
v_mul_f32 v169, v48, v248
v_fma_f32 v168, -v64, v248, v168
v_fmac_f32 v169, v64, v232
v_cvt_pk_bf16_f32 v80, v168, v169
v_mul_f32 v170, v49, v233
v_mul_f32 v171, v49, v249
v_fma_f32 v170, -v65, v249, v170
v_fmac_f32 v171, v65, v233
v_cvt_pk_bf16_f32 v81, v170, v171
v_mul_f32 v172, v50, v234
v_mul_f32 v173, v50, v250
v_fma_f32 v172, -v66, v250, v172
v_fmac_f32 v173, v66, v234
v_cvt_pk_bf16_f32 v82, v172, v173
v_mul_f32 v174, v51, v235
v_mul_f32 v175, v51, v251
v_fma_f32 v174, -v67, v251, v174
v_fmac_f32 v175, v67, v235
v_cvt_pk_bf16_f32 v83, v174, v175
v_mul_f32 v168, v52, v236
v_mul_f32 v169, v52, v252
v_fma_f32 v168, -v68, v252, v168
v_fmac_f32 v169, v68, v236
v_cvt_pk_bf16_f32 v84, v168, v169
v_mul_f32 v170, v53, v237
v_mul_f32 v171, v53, v253
v_fma_f32 v170, -v69, v253, v170
v_fmac_f32 v171, v69, v237
v_cvt_pk_bf16_f32 v85, v170, v171
v_mul_f32 v172, v54, v238
v_mul_f32 v173, v54, v254
v_fma_f32 v172, -v70, v254, v172
v_fmac_f32 v173, v70, v238
v_cvt_pk_bf16_f32 v86, v172, v173
v_mul_f32 v174, v55, v239
v_mul_f32 v175, v55, v255
v_fma_f32 v174, -v71, v255, v174
v_fmac_f32 v175, v71, v239
v_cvt_pk_bf16_f32 v87, v174, v175
v_mfma_f32_32x32x16_bf16 v[40:55], v[192:195], v[72:75], 0
v_mfma_f32_32x32x16_bf16 v[40:55], v[196:199], v[76:79], v[40:55]
v_mfma_f32_32x32x16_bf16 v[40:55], v[200:203], v[80:83], v[40:55]
v_mfma_f32_32x32x16_bf16 v[40:55], v[204:207], v[84:87], v[40:55]
v_mfma_f32_32x32x16_bf16 v[56:71], v[208:211], v[72:75], 0
v_mfma_f32_32x32x16_bf16 v[56:71], v[212:215], v[76:79], v[56:71]
v_mfma_f32_32x32x16_bf16 v[56:71], v[216:219], v[80:83], v[56:71]
v_mfma_f32_32x32x16_bf16 v[56:71], v[220:223], v[84:87], v[56:71]
s_lshl_b32 s92, s66, 12
s_add_u32 s92, s92, 98304
v_add_u32 v8, s92, v7
s_nop 8
v_cvt_pk_bf16_f32 v72, v40, v56
ds_write_b32 v4, v72 offset:0
v_cvt_pk_bf16_f32 v73, v41, v57
ds_write_b32 v4, v73 offset:1024
v_cvt_pk_bf16_f32 v74, v42, v58
ds_write_b32 v4, v74 offset:2048
v_cvt_pk_bf16_f32 v75, v43, v59
ds_write_b32 v4, v75 offset:3072
v_cvt_pk_bf16_f32 v76, v44, v60
ds_write_b32 v4, v76 offset:8192
v_cvt_pk_bf16_f32 v77, v45, v61
ds_write_b32 v4, v77 offset:9216
v_cvt_pk_bf16_f32 v78, v46, v62
ds_write_b32 v4, v78 offset:10240
v_cvt_pk_bf16_f32 v79, v47, v63
ds_write_b32 v4, v79 offset:11264
v_cvt_pk_bf16_f32 v80, v48, v64
ds_write_b32 v6, v80 offset:0
v_cvt_pk_bf16_f32 v81, v49, v65
ds_write_b32 v5, v81 offset:10240
v_cvt_pk_bf16_f32 v82, v50, v66
ds_write_b32 v5, v82 offset:9216
v_cvt_pk_bf16_f32 v83, v51, v67
ds_write_b32 v5, v83 offset:8192
v_cvt_pk_bf16_f32 v84, v52, v68
ds_write_b32 v5, v84 offset:3072
v_cvt_pk_bf16_f32 v85, v53, v69
ds_write_b32 v5, v85 offset:2048
v_cvt_pk_bf16_f32 v86, v54, v70
ds_write_b32 v5, v86 offset:1024
v_cvt_pk_bf16_f32 v87, v55, v71
ds_write_b32 v5, v87 offset:0
s_waitcnt vmcnt(0)
s_waitcnt lgkmcnt(0)
v_mov_b32 v190, 1
s_mov_b64 exec, 1
ds_write_b32 v185, v190
s_mov_b64 exec, -1
L_lc6:
ds_read_b128 v[186:189], v184
s_waitcnt lgkmcnt(0)
v_min3_u32 v186, v186, v187, v188
v_min_u32 v186, v186, v189
s_nop 0
v_readfirstlane_b32 s92, v186
s_nop 0
s_cmp_ge_u32 s92, 1
s_cbranch_scc1 L_lcd7
s_sleep 1
s_branch L_lc6
L_lcd7:
ds_read_b32 v104, v14 offset:0
ds_read_b32 v105, v14 offset:1024
ds_read_b32 v106, v14 offset:2048
ds_read_b32 v107, v14 offset:3072
ds_read_b32 v108, v14 offset:4096
ds_read_b32 v109, v14 offset:5120
ds_read_b32 v110, v14 offset:6144
ds_read_b32 v111, v14 offset:7168
ds_read_b32 v112, v14 offset:8192
ds_read_b32 v113, v14 offset:9216
ds_read_b32 v114, v14 offset:10240
ds_read_b32 v115, v14 offset:11264
ds_read_b32 v116, v14 offset:12288
ds_read_b32 v117, v14 offset:13312
ds_read_b32 v118, v14 offset:14336
ds_read_b32 v119, v14 offset:15360
s_mov_b32 s64, 0x05040100
s_mov_b32 s65, 0x07060302
s_waitcnt lgkmcnt(0)
v_perm_b32 v120, v105, v104, s64
v_perm_b32 v121, v107, v106, s64
v_perm_b32 v122, v109, v108, s64
v_perm_b32 v123, v111, v110, s64
v_xor_b32 v8, 0, v15
ds_write_b128 v8, v[120:123]
v_perm_b32 v124, v113, v112, s64
v_perm_b32 v125, v115, v114, s64
v_perm_b32 v126, v117, v116, s64
v_perm_b32 v127, v119, v118, s64
v_xor_b32 v8, 16, v15
ds_write_b128 v8, v[124:127]
v_perm_b32 v128, v105, v104, s65
v_perm_b32 v129, v107, v106, s65
v_perm_b32 v130, v109, v108, s65
v_perm_b32 v131, v111, v110, s65
v_xor_b32 v8, 32, v15
ds_write_b128 v8, v[128:131]
v_perm_b32 v132, v113, v112, s65
v_perm_b32 v133, v115, v114, s65
v_perm_b32 v134, v117, v116, s65
v_perm_b32 v135, v119, v118, s65
v_xor_b32 v8, 48, v15
ds_write_b128 v8, v[132:135]
s_waitcnt lgkmcnt(0)
ds_read_b128 v[72:75], v16 offset:0
ds_read_b128 v[76:79], v16 offset:512
ds_read_b128 v[80:83], v16 offset:1024
ds_read_b128 v[84:87], v16 offset:1536
ds_read_b128 v[120:123], v16 offset:2048
ds_read_b128 v[124:127], v16 offset:2560
ds_read_b128 v[128:131], v16 offset:3072
ds_read_b128 v[132:135], v16 offset:3584
v_add_u32 v4, 32768, v4
v_add_u32 v5, 32768, v5
v_add_u32 v6, 32768, v6
s_waitcnt lgkmcnt(0)
v_mov_b32 v190, 2
s_mov_b64 exec, 1
ds_write_b32 v185, v190
s_mov_b64 exec, -1
s_lshl_b32 s92, s2, 3
s_add_u32 s92, s92, s34
s_cmp_lg_u32 s92, 4
s_cbranch_scc1 L_nn8
s_add_u32 s3, s3, 1
s_cmp_eq_u32 s3, 0
s_cselect_b32 s3, 1, s3
s_atomic_swap s3, s[30:31], 0x0
s_atomic_swap s3, s[32:33], 0x0
L_nn8:
s_mov_b32 s64, 0x05040100
s_mov_b32 s65, 0x07060302
v_lshlrev_b32 v88, 16, v88
v_lshlrev_b32 v89, 16, v89
v_lshlrev_b32 v23, 1, v1
v_add_f32_dpp v90, v88, v88 quad_perm:[1,0,3,2] row_mask:0xf bank_mask:0xf
v_subrev_f32_dpp v91, v89, v89 quad_perm:[1,0,3,2] row_mask:0xf bank_mask:0xf
v_mul_f32 v90, 0.5, v90
v_mul_f32 v91, 0.5, v91
v_cvt_pk_bf16_f32 v88, v90, v91
v_and_b32 v92, 31, v1
v_cvt_f32_u32 v92, v92
v_lshrrev_b32 v93, 5, v1
v_lshlrev_b32 v93, 2, v93
v_cvt_f32_u32 v93, v93
v_mul_f32 v92, 0x3a000000, v92
v_fmamk_f32 v93, v93, 0x3c800000, v92
v_add_f32 v94, 0x0, v93
v_cos_f32 v136, v94
v_sin_f32 v152, -v94
v_add_f32 v95, 0x3c800000, v93
v_cos_f32 v137, v95
v_sin_f32 v153, -v95
v_add_f32 v94, 0x3d000000, v93
v_cos_f32 v138, v94
v_sin_f32 v154, -v94
v_add_f32 v95, 0x3d400000, v93
v_cos_f32 v139, v95
v_sin_f32 v155, -v95
v_add_f32 v94, 0x3e000000, v93
v_cos_f32 v140, v94
v_sin_f32 v156, -v94
v_add_f32 v95, 0x3e100000, v93
v_cos_f32 v141, v95
v_sin_f32 v157, -v95
v_add_f32 v94, 0x3e200000, v93
v_cos_f32 v142, v94
v_sin_f32 v158, -v94
v_add_f32 v95, 0x3e300000, v93
v_cos_f32 v143, v95
v_sin_f32 v159, -v95
v_add_f32 v94, 0x3e800000, v93
v_cos_f32 v144, v94
v_sin_f32 v160, -v94
v_add_f32 v95, 0x3e880000, v93
v_cos_f32 v145, v95
v_sin_f32 v161, -v95
v_add_f32 v94, 0x3e900000, v93
v_cos_f32 v146, v94
v_sin_f32 v162, -v94
v_add_f32 v95, 0x3e980000, v93
v_cos_f32 v147, v95
v_sin_f32 v163, -v95
v_add_f32 v94, 0x3ec00000, v93
v_cos_f32 v148, v94
v_sin_f32 v164, -v94
v_add_f32 v95, 0x3ec80000, v93
v_cos_f32 v149, v95
v_sin_f32 v165, -v95
v_add_f32 v94, 0x3ed00000, v93
v_cos_f32 v150, v94
v_sin_f32 v166, -v94
v_add_f32 v95, 0x3ed80000, v93
v_cos_f32 v151, v95
v_sin_f32 v167, -v95
s_and_b32 s60, s2, 7
s_lshl_b32 s60, s60, 5
s_lshr_b32 s64, s2, 3
s_add_u32 s60, s60, s64
s_lshr_b32 s64, s66, 1
s_xor_b32 s64, s64, s66
s_and_b32 s64, s64, 1
s_or_b32 s65, s64, s60
s_cmp_eq_u32 s65, 0
s_cselect_b32 s61, 1, 0
s_lshl_b32 s65, s60, 1
s_add_u32 s64, s64, s65
s_mul_i32 s64, s64, 8192
s_add_u32 s64, s64, 25182208
s_lshr_b32 s65, s66, 1
s_mul_i32 s69, s65, 8192
s_add_u32 s69, s69, 25165824
s_cmp_eq_u32 s61, 1
s_cselect_b32 s64, s69, s64
s_cselect_b32 s65, 0, s65
s_cselect_b32 s90, s32, s32
s_cselect_b32 s91, s33, s33
s_lshl_b32 s62, s65, 31
s_or_b32 s63, s62, 0x3f800000
s_add_u32 s48, s90, s64
s_addc_u32 s49, s91, 0
s_mov_b32 s50, 8192
s_mov_b32 s51, 0x20000
s_lshl_b32 s64, s66, 20
s_lshl_b32 s65, s60, 6
s_add_u32 s64, s64, s65
s_add_u32 s58, s64, 16777216
s_add_u32 s56, s32, s58
s_addc_u32 s57, s33, 0
s_sub_u32 s58, 1048576, s65
s_mov_b32 s59, 0x20000
s_lshl_b32 s64, s66, 21
s_lshl_b32 s65, s60, 7
s_add_u32 s64, s64, s65
s_add_u32 s54, s64, 50331648
s_add_u32 s52, s32, s54
s_addc_u32 s53, s33, 0
s_sub_u32 s54, 2097152, s65
s_mov_b32 s55, 0x20000
v_lshrrev_b32 v8, 2, v1
v_lshlrev_b32 v8, 14, v8
v_and_b32 v9, 3, v1
v_lshrrev_b32 v10, 4, v1
v_xor_b32 v9, v9, v10
v_lshl_add_u32 v14, v9, 4, v8
v_and_b32 v8, 31, v1
v_bfe_u32 v9, v1, 2, 2
v_xor_b32 v9, s66, v9
v_lshlrev_b32 v9, 4, v9
v_lshl_add_u32 v9, v8, 6, v9
v_lshrrev_b32 v8, 5, v1
v_lshl_add_u32 v9, v8, 11, v9
v_add_u32 v15, 131072, v9
s_lshl_b32 s64, s66, 13
s_add_u32 s64, s64, 131072
v_add_u32 v16, s64, v2
s_xor_b32 s65, s64, 24576
s_cmp_eq_u32 s61, 1
s_cselect_b32 s65, s64, s65
v_add_u32 v17, s65, v2
v_add_u32 v18, s68, v2
s_lshr_b32 s64, s66, 1
s_xor_b32 s64, s64, s66
s_and_b32 s64, s64, 1
s_lshl_b32 s69, s64, 13
s_add_u32 s69, s69, 147456
v_add_u32 v19, s69, v2
v_and_b32 v8, 31, v1
v_lshrrev_b32 v9, 2, v8
v_and_b32 v10, 3, v8
s_lshl_b32 s64, s64, 1
s_add_u32 s64, s64, 4
v_lshrrev_b32 v19, 1, v10
v_add_u32 v19, s64, v19
v_and_b32 v11, 6, v9
v_xor_b32 v19, v19, v11
v_lshlrev_b32 v19, 4, v19
v_and_b32 v10, 1, v10
v_lshl_add_u32 v19, v10, 3, v19
v_lshl_add_u32 v19, v9, 7, v19
v_lshrrev_b32 v11, 5, v1
v_lshl_add_u32 v19, v11, 12, v19
v_add_u32 v19, 131072, v19
v_and_b32 v9, 6, v8
v_bfe_u32 v10, v8, 4, 1
v_or_b32 v9, v9, v10
v_xor_b32 v9, s66, v9
v_lshlrev_b32 v9, 4, v9
v_lshl_add_u32 v9, v8, 7, v9
v_lshl_add_u32 v9, v11, 12, v9
v_add_u32 v10, 131072, v9
v_lshrrev_b32 v8, 3, v1
v_lshlrev_b32 v8, 15, v8
v_and_b32 v9, 7, v1
v_lshl_add_u32 v9, v9, 4, v8
v_mul_f32 v136, s63, v136
v_mul_f32 v137, s63, v137
v_mul_f32 v138, s63, v138
v_mul_f32 v139, s63, v139
v_mul_f32 v140, s63, v140
v_mul_f32 v141, s63, v141
v_mul_f32 v142, s63, v142
v_mul_f32 v143, s63, v143
v_mul_f32 v144, s63, v144
v_mul_f32 v145, s63, v145
v_mul_f32 v146, s63, v146
v_mul_f32 v147, s63, v147
v_mul_f32 v148, s63, v148
v_mul_f32 v149, s63, v149
v_mul_f32 v150, s63, v150
v_mul_f32 v151, s63, v151
v_mul_f32 v152, s63, v152
v_mul_f32 v153, s63, v153
v_mul_f32 v154, s63, v154
v_mul_f32 v155, s63, v155
v_mul_f32 v156, s63, v156
v_mul_f32 v157, s63, v157
v_mul_f32 v158, s63, v158
v_mul_f32 v159, s63, v159
v_mul_f32 v160, s63, v160
v_mul_f32 v161, s63, v161
v_mul_f32 v162, s63, v162
v_mul_f32 v163, s63, v163
v_mul_f32 v164, s63, v164
v_mul_f32 v165, s63, v165
v_mul_f32 v166, s63, v166
v_mul_f32 v167, s63, v167
buffer_store_dwordx4 v[72:75], v2, s[40:43], 0 offen offset:0 sc1
buffer_store_dwordx4 v[76:79], v2, s[40:43], 0 offen offset:1024 sc1
buffer_store_dwordx4 v[80:83], v2, s[40:43], 0 offen offset:2048 sc1
buffer_store_dwordx4 v[84:87], v2, s[40:43], 0 offen offset:3072 sc1
s_setprio 3
s_barrier
s_add_u32 s8, s16, 256
s_and_b32 s8, s8, 0x7ff
s_add_u32 s9, s8, 2048
s_add_u32 s10, s8, 6144
s_add_u32 m0, s17, 65536
s_nop 0
buffer_load_dwordx4 v176, s[12:15], s8 offen offset:0 lds
buffer_load_dwordx4 v177, s[12:15], s8 offen offset:1024 lds
buffer_load_dwordx4 v176, s[12:15], s9 offen offset:2048 lds
buffer_load_dwordx4 v177, s[12:15], s9 offen offset:3072 lds
s_add_u32 m0, s17, 81920
s_nop 0
buffer_load_dwordx4 v178, s[20:23], s8 offen offset:0 lds
buffer_load_dwordx4 v179, s[20:23], s8 offen offset:1024 lds
buffer_load_dwordx4 v178, s[20:23], s10 offen offset:2048 lds
buffer_load_dwordx4 v179, s[20:23], s10 offen offset:3072 lds
s_barrier
s_add_u32 s8, s16, 384
s_and_b32 s8, s8, 0x7ff
s_add_u32 s9, s8, 2048
s_add_u32 s10, s8, 6144
s_add_u32 m0, s17, 0
s_nop 0
buffer_load_dwordx4 v176, s[12:15], s8 offen offset:0 lds
buffer_load_dwordx4 v177, s[12:15], s8 offen offset:1024 lds
buffer_load_dwordx4 v176, s[12:15], s9 offen offset:2048 lds
buffer_load_dwordx4 v177, s[12:15], s9 offen offset:3072 lds
s_add_u32 m0, s17, 16384
s_nop 0
buffer_load_dwordx4 v178, s[20:23], s8 offen offset:0 lds
buffer_load_dwordx4 v179, s[20:23], s8 offen offset:1024 lds
buffer_load_dwordx4 v178, s[20:23], s10 offen offset:2048 lds
buffer_load_dwordx4 v179, s[20:23], s10 offen offset:3072 lds
s_waitcnt vmcnt(8)
s_barrier
s_add_u32 s8, s16, 512
s_and_b32 s8, s8, 0x7ff
s_add_u32 s9, s8, 2048
s_add_u32 s10, s8, 6144
s_add_u32 m0, s17, 32768
s_nop 0
buffer_load_dwordx4 v176, s[12:15], s8 offen offset:0 lds
buffer_load_dwordx4 v177, s[12:15], s8 offen offset:1024 lds
buffer_load_dwordx4 v176, s[12:15], s9 offen offset:2048 lds
buffer_load_dwordx4 v177, s[12:15], s9 offen offset:3072 lds
s_add_u32 m0, s17, 49152
s_nop 0
buffer_load_dwordx4 v178, s[20:23], s8 offen offset:0 lds
buffer_load_dwordx4 v179, s[20:23], s8 offen offset:1024 lds
buffer_load_dwordx4 v178, s[20:23], s10 offen offset:2048 lds
buffer_load_dwordx4 v179, s[20:23], s10 offen offset:3072 lds
s_cmp_lg_u32 s66, 0
s_cbranch_scc1 L_nl9
v_mov_b32 v20, 0
global_load_dword v21, v20, s[30:31] sc1
L_nl9:
s_waitcnt vmcnt(8)
s_barrier
s_add_u32 s8, s16, 640
s_and_b32 s8, s8, 0x7ff
s_add_u32 s9, s8, 2048
s_add_u32 s10, s8, 6144
s_add_u32 m0, s17, 65536
s_nop 0
buffer_load_dwordx4 v176, s[12:15], s8 offen offset:0 lds
buffer_load_dwordx4 v177, s[12:15], s8 offen offset:1024 lds
buffer_load_dwordx4 v176, s[12:15], s9 offen offset:2048 lds
buffer_load_dwordx4 v177, s[12:15], s9 offen offset:3072 lds
s_add_u32 m0, s17, 81920
s_nop 0
buffer_load_dwordx4 v178, s[20:23], s8 offen offset:0 lds
buffer_load_dwordx4 v179, s[20:23], s8 offen offset:1024 lds
buffer_load_dwordx4 v178, s[20:23], s10 offen offset:2048 lds
buffer_load_dwordx4 v179, s[20:23], s10 offen offset:3072 lds
s_cmp_lg_u32 s66, 3
s_cbranch_scc1 L_nw10
s_lshr_b32 s64, s2, 7
s_mul_i32 s64, s64, 8192
s_bfe_u32 s65, s2, 0x10006
s_mul_i32 s65, s65, 4096
s_add_u32 s64, s64, s65
s_and_b32 s65, s2, 63
s_lshl_b32 s65, s65, 6
s_add_u32 s64, s64, s65
s_add_u32 s6, s64, 25165824
s_add_u32 s4, s32, s6
s_addc_u32 s5, s33, 0
s_mov_b32 s6, 64
s_mov_b32 s7, 0x20000
s_mov_b32 exec_lo, 0x55555555
s_mov_b32 exec_hi, 0
buffer_store_dword v88, v23, s[4:7], 0 offen sc1
s_mov_b64 exec, -1
L_nw10:
s_movk_i32 s92, 0x1000
buffer_store_dwordx4 v[120:123], v2, s[40:43], s92 offen offset:0 sc1
buffer_store_dwordx4 v[124:127], v2, s[40:43], s92 offen offset:1024 sc1
buffer_store_dwordx4 v[128:131], v2, s[40:43], s92 offen offset:2048 sc1
buffer_store_dwordx4 v[132:135], v2, s[40:43], s92 offen offset:3072 sc1
s_waitcnt vmcnt(12)
s_barrier
s_add_u32 s8, s16, 768
s_and_b32 s8, s8, 0x7ff
s_add_u32 s9, s8, 2048
s_add_u32 s10, s8, 6144
s_add_u32 m0, s17, 0
s_nop 0
buffer_load_dwordx4 v176, s[12:15], s8 offen offset:0 lds
buffer_load_dwordx4 v177, s[12:15], s8 offen offset:1024 lds
buffer_load_dwordx4 v176, s[12:15], s9 offen offset:2048 lds
buffer_load_dwordx4 v177, s[12:15], s9 offen offset:3072 lds
s_add_u32 m0, s17, 16384
s_nop 0
buffer_load_dwordx4 v178, s[20:23], s8 offen offset:0 lds
buffer_load_dwordx4 v179, s[20:23], s8 offen offset:1024 lds
buffer_load_dwordx4 v178, s[20:23], s10 offen offset:2048 lds
buffer_load_dwordx4 v179, s[20:23], s10 offen offset:3072 lds
s_waitcnt vmcnt(12)
s_barrier
s_add_u32 s8, s16, 896
s_and_b32 s8, s8, 0x7ff
s_add_u32 s9, s8, 2048
s_add_u32 s10, s8, 6144
s_add_u32 m0, s17, 32768
s_nop 0
buffer_load_dwordx4 v176, s[12:15], s8 offen offset:0 lds
buffer_load_dwordx4 v177, s[12:15], s8 offen offset:1024 lds
buffer_load_dwordx4 v176, s[12:15], s9 offen offset:2048 lds
buffer_load_dwordx4 v177, s[12:15], s9 offen offset:3072 lds
s_add_u32 m0, s17, 49152
s_nop 0
buffer_load_dwordx4 v178, s[20:23], s8 offen offset:0 lds
buffer_load_dwordx4 v179, s[20:23], s8 offen offset:1024 lds
buffer_load_dwordx4 v178, s[20:23], s10 offen offset:2048 lds
buffer_load_dwordx4 v179, s[20:23], s10 offen offset:3072 lds
s_waitcnt vmcnt(8)
s_barrier
s_add_u32 s8, s16, 1024
s_and_b32 s8, s8, 0x7ff
s_add_u32 s9, s8, 2048
s_add_u32 s10, s8, 6144
s_add_u32 m0, s17, 65536
s_nop 0
buffer_load_dwordx4 v176, s[12:15], s8 offen offset:0 lds
buffer_load_dwordx4 v177, s[12:15], s8 offen offset:1024 lds
buffer_load_dwordx4 v176, s[12:15], s9 offen offset:2048 lds
buffer_load_dwordx4 v177, s[12:15], s9 offen offset:3072 lds
s_add_u32 m0, s17, 81920
s_nop 0
buffer_load_dwordx4 v178, s[20:23], s8 offen offset:0 lds
buffer_load_dwordx4 v179, s[20:23], s8 offen offset:1024 lds
buffer_load_dwordx4 v178, s[20:23], s10 offen offset:2048 lds
buffer_load_dwordx4 v179, s[20:23], s10 offen offset:3072 lds
s_cmp_lg_u32 s66, 0
s_cbranch_scc1 L_sg12
v_readfirstlane_b32 s37, v21
s_nop 0
s_cmp_lg_u32 s37, 0
s_cbranch_scc1 L_nl13
v_mov_b32 v20, 0
L_n14:
global_load_dword v21, v20, s[30:31] sc1
s_waitcnt vmcnt(0)
v_readfirstlane_b32 s37, v21
s_nop 0
s_cmp_eq_u32 s37, 0
s_cbranch_scc1 L_n14
L_nl13:
v_mov_b32 v20, s37
s_mov_b64 exec, 1
ds_write_b32 v184, v20 offset:64
s_mov_b64 exec, -1
s_waitcnt lgkmcnt(0)
L_sg12:
s_cmp_lg_u32 s66, 0
s_cbranch_scc1 L_sg16
s_and_b32 s64, s2, 15
s_lshl_b32 s65, s64, 7
s_add_u32 s65, s65, 4096
s_add_u32 s90, s32, s65
s_addc_u32 s91, s33, 0
s_mov_b32 s18, 1
s_atomic_add s18, s[90:91], 0x0 glc
L_sg16:
s_waitcnt vmcnt(8)
s_barrier
s_add_u32 s8, s16, 1152
s_and_b32 s8, s8, 0x7ff
s_add_u32 s9, s8, 2048
s_add_u32 s10, s8, 6144
s_add_u32 m0, s17, 0
s_nop 0
buffer_load_dwordx4 v176, s[12:15], s8 offen offset:0 lds
buffer_load_dwordx4 v177, s[12:15], s8 offen offset:1024 lds
buffer_load_dwordx4 v176, s[12:15], s9 offen offset:2048 lds
buffer_load_dwordx4 v177, s[12:15], s9 offen offset:3072 lds
s_add_u32 m0, s17, 16384
s_nop 0
buffer_load_dwordx4 v178, s[20:23], s8 offen offset:0 lds
buffer_load_dwordx4 v179, s[20:23], s8 offen offset:1024 lds
buffer_load_dwordx4 v178, s[20:23], s10 offen offset:2048 lds
buffer_load_dwordx4 v179, s[20:23], s10 offen offset:3072 lds
s_waitcnt vmcnt(8)
s_barrier
s_add_u32 s8, s16, 1280
s_and_b32 s8, s8, 0x7ff
s_add_u32 s9, s8, 2048
s_add_u32 s10, s8, 6144
s_add_u32 m0, s17, 32768
s_nop 0
buffer_load_dwordx4 v176, s[12:15], s8 offen offset:0 lds
buffer_load_dwordx4 v177, s[12:15], s8 offen offset:1024 lds
buffer_load_dwordx4 v176, s[12:15], s9 offen offset:2048 lds
buffer_load_dwordx4 v177, s[12:15], s9 offen offset:3072 lds
s_add_u32 m0, s17, 49152
s_nop 0
buffer_load_dwordx4 v178, s[20:23], s8 offen offset:0 lds
buffer_load_dwordx4 v179, s[20:23], s8 offen offset:1024 lds
buffer_load_dwordx4 v178, s[20:23], s10 offen offset:2048 lds
buffer_load_dwordx4 v179, s[20:23], s10 offen offset:3072 lds
s_cmp_lg_u32 s66, 0
s_cbranch_scc1 L_sg17
s_waitcnt lgkmcnt(0)
s_cmp_lg_u32 s18, 15
s_cbranch_scc1 L_sg17
s_and_b32 s64, s2, 15
s_lshl_b32 s64, s64, 2
s_add_u32 s64, s64, 540672
v_lshl_add_u32 v22, v1, 7, s64
v_mov_b32 v23, s37
global_store_dword v22, v23, s[32:33] sc1
L_sg17:
s_waitcnt vmcnt(8)
s_barrier
s_add_u32 s8, s16, 1408
s_and_b32 s8, s8, 0x7ff
s_add_u32 s9, s8, 2048
s_add_u32 s10, s8, 6144
s_add_u32 m0, s17, 65536
s_nop 0
buffer_load_dwordx4 v176, s[12:15], s8 offen offset:0 lds
buffer_load_dwordx4 v177, s[12:15], s8 offen offset:1024 lds
buffer_load_dwordx4 v176, s[12:15], s9 offen offset:2048 lds
buffer_load_dwordx4 v177, s[12:15], s9 offen offset:3072 lds
s_add_u32 m0, s17, 81920
s_nop 0
buffer_load_dwordx4 v178, s[20:23], s8 offen offset:0 lds
buffer_load_dwordx4 v179, s[20:23], s8 offen offset:1024 lds
buffer_load_dwordx4 v178, s[20:23], s10 offen offset:2048 lds
buffer_load_dwordx4 v179, s[20:23], s10 offen offset:3072 lds
s_waitcnt vmcnt(8)
s_barrier
s_add_u32 s8, s16, 1536
s_and_b32 s8, s8, 0x7ff
s_add_u32 s9, s8, 2048
s_add_u32 s10, s8, 6144
s_add_u32 m0, s17, 0
s_nop 0
buffer_load_dwordx4 v176, s[12:15], s8 offen offset:0 lds
buffer_load_dwordx4 v177, s[12:15], s8 offen offset:1024 lds
buffer_load_dwordx4 v176, s[12:15], s9 offen offset:2048 lds
buffer_load_dwordx4 v177, s[12:15], s9 offen offset:3072 lds
s_add_u32 m0, s17, 16384
s_nop 0
buffer_load_dwordx4 v178, s[20:23], s8 offen offset:0 lds
buffer_load_dwordx4 v179, s[20:23], s8 offen offset:1024 lds
buffer_load_dwordx4 v178, s[20:23], s10 offen offset:2048 lds
buffer_load_dwordx4 v179, s[20:23], s10 offen offset:3072 lds
s_waitcnt vmcnt(8)
s_barrier
s_add_u32 s8, s16, 1664
s_and_b32 s8, s8, 0x7ff
s_add_u32 s9, s8, 2048
s_add_u32 s10, s8, 6144
s_add_u32 m0, s17, 32768
s_nop 0
buffer_load_dwordx4 v176, s[12:15], s8 offen offset:0 lds
buffer_load_dwordx4 v177, s[12:15], s8 offen offset:1024 lds
buffer_load_dwordx4 v176, s[12:15], s9 offen offset:2048 lds
buffer_load_dwordx4 v177, s[12:15], s9 offen offset:3072 lds
s_add_u32 m0, s17, 49152
s_nop 0
buffer_load_dwordx4 v178, s[20:23], s8 offen offset:0 lds
buffer_load_dwordx4 v179, s[20:23], s8 offen offset:1024 lds
buffer_load_dwordx4 v178, s[20:23], s10 offen offset:2048 lds
buffer_load_dwordx4 v179, s[20:23], s10 offen offset:3072 lds
s_waitcnt vmcnt(8)
s_barrier
s_add_u32 s8, s16, 1792
s_and_b32 s8, s8, 0x7ff
s_add_u32 s9, s8, 2048
s_add_u32 s10, s8, 6144
s_add_u32 m0, s17, 65536
s_nop 0
buffer_load_dwordx4 v176, s[12:15], s8 offen offset:0 lds
buffer_load_dwordx4 v177, s[12:15], s8 offen offset:1024 lds
buffer_load_dwordx4 v176, s[12:15], s9 offen offset:2048 lds
buffer_load_dwordx4 v177, s[12:15], s9 offen offset:3072 lds
s_add_u32 m0, s17, 81920
s_nop 0
buffer_load_dwordx4 v178, s[20:23], s8 offen offset:0 lds
buffer_load_dwordx4 v179, s[20:23], s8 offen offset:1024 lds
buffer_load_dwordx4 v178, s[20:23], s10 offen offset:2048 lds
buffer_load_dwordx4 v179, s[20:23], s10 offen offset:3072 lds
s_waitcnt vmcnt(8)
s_barrier
s_add_u32 s8, s16, 1920
s_and_b32 s8, s8, 0x7ff
s_add_u32 s9, s8, 2048
s_add_u32 s10, s8, 6144
s_add_u32 m0, s17, 0
s_nop 0
buffer_load_dwordx4 v176, s[12:15], s8 offen offset:0 lds
buffer_load_dwordx4 v177, s[12:15], s8 offen offset:1024 lds
buffer_load_dwordx4 v176, s[12:15], s9 offen offset:2048 lds
buffer_load_dwordx4 v177, s[12:15], s9 offen offset:3072 lds
s_add_u32 m0, s17, 16384
s_nop 0
buffer_load_dwordx4 v178, s[20:23], s8 offen offset:0 lds
buffer_load_dwordx4 v179, s[20:23], s8 offen offset:1024 lds
buffer_load_dwordx4 v178, s[20:23], s10 offen offset:2048 lds
buffer_load_dwordx4 v179, s[20:23], s10 offen offset:3072 lds
s_cmp_eq_u32 s66, 0
s_cbranch_scc1 L_nl18
ds_read_b32 v20, v184 offset:64
s_waitcnt lgkmcnt(0)
v_readfirstlane_b32 s37, v20
L_nl18:
s_waitcnt vmcnt(8)
s_barrier
s_and_b32 s64, s2, 1
s_lshl_b32 s64, s64, 10
s_bfe_u32 s92, s2, 0x20001
s_lshl_b32 s92, s92, 19
s_add_u32 s64, s64, s92
s_lshr_b32 s92, s2, 3
s_lshl_b32 s92, s92, 14
s_add_u32 s64, s64, s92
s_lshr_b32 s92, s66, 1
s_lshl_b32 s92, s92, 13
s_add_u32 s64, s64, s92
v_bfe_u32 v22, v1, 3, 2
v_lshlrev_b32 v22, 11, v22
v_and_b32 v23, 7, v1
v_lshl_add_u32 v22, v23, 7, v22
v_add_u32 v22, s64, v22
s_mov_b32 exec_hi, 0
global_load_dword v11, v22, s[100:101]
s_mov_b64 exec, -1
s_lshl_b32 s64, s2, 2
s_add_u32 s64, s64, s66
s_lshr_b32 s64, s64, 4
s_lshl_b32 s64, s64, 7
s_add_u32 s64, s64, 540672
s_add_u32 s24, s32, s64
s_addc_u32 s25, s33, 0
s_load_dwordx16 s[4:19], s[24:25], 0x0 glc
s_waitcnt vmcnt(1)
s_barrier
s_setprio 0
s_mov_b32 s26, s37
s_mov_b32 s27, s37
s_mov_b32 s92, 0
s_branch L_sp21
L_late19:
s_add_u32 s92, s92, 1
s_cmp_ge_u32 s92, 200000
s_cbranch_scc1 L_go20
s_sleep 8
s_load_dwordx16 s[4:19], s[24:25], 0x0 glc
L_sp21:
s_waitcnt lgkmcnt(0)
s_cmp_eq_u64 s[4:5], s[26:27]
s_cbranch_scc0 L_late19
s_cmp_eq_u64 s[6:7], s[26:27]
s_cbranch_scc0 L_late19
s_cmp_eq_u64 s[8:9], s[26:27]
s_cbranch_scc0 L_late19
s_cmp_eq_u64 s[10:11], s[26:27]
s_cbranch_scc0 L_late19
s_cmp_eq_u64 s[12:13], s[26:27]
s_cbranch_scc0 L_late19
s_cmp_eq_u64 s[14:15], s[26:27]
s_cbranch_scc0 L_late19
s_cmp_eq_u64 s[16:17], s[26:27]
s_cbranch_scc0 L_late19
s_cmp_eq_u64 s[18:19], s[26:27]
s_cbranch_scc0 L_late19
L_go20:
s_setprio 0
s_lshl_b32 s65, s66, 13
s_add_u32 s65, s65, 131072
s_add_u32 m0, s65, 0
s_mov_b32 s64, 0
buffer_load_dwordx4 v9, s[52:55], s64 offen sc1 lds
s_add_u32 m0, s65, 1024
s_mov_b32 s64, 262144
buffer_load_dwordx4 v9, s[52:55], s64 offen sc1 lds
s_add_u32 m0, s65, 2048
s_mov_b32 s64, 524288
buffer_load_dwordx4 v9, s[52:55], s64 offen sc1 lds
s_add_u32 m0, s65, 3072
s_mov_b32 s64, 786432
buffer_load_dwordx4 v9, s[52:55], s64 offen sc1 lds
s_add_u32 m0, s65, 4096
s_mov_b32 s64, 1048576
buffer_load_dwordx4 v9, s[52:55], s64 offen sc1 lds
s_add_u32 m0, s65, 5120
s_mov_b32 s64, 1310720
buffer_load_dwordx4 v9, s[52:55], s64 offen sc1 lds
s_add_u32 m0, s65, 6144
s_mov_b32 s64, 1572864
buffer_load_dwordx4 v9, s[52:55], s64 offen sc1 lds
s_add_u32 m0, s65, 7168
s_mov_b32 s64, 1835008
buffer_load_dwordx4 v9, s[52:55], s64 offen sc1 lds
s_cmp_eq_u32 s61, 1
s_cbranch_scc1 L_ws22
s_waitcnt vmcnt(0)
s_branch L_wd23
L_ws22:
s_movk_i32 s64, 4096
buffer_load_dwordx4 v[104:107], v2, s[48:51], 0 offen offset:0 sc1
buffer_load_dwordx4 v[108:111], v2, s[48:51], 0 offen offset:1024 sc1
buffer_load_dwordx4 v[112:115], v2, s[48:51], 0 offen offset:2048 sc1
buffer_load_dwordx4 v[116:119], v2, s[48:51], 0 offen offset:3072 sc1
buffer_load_dwordx4 v[120:123], v2, s[48:51], s64 offen offset:0 sc1
buffer_load_dwordx4 v[124:127], v2, s[48:51], s64 offen offset:1024 sc1
buffer_load_dwordx4 v[128:131], v2, s[48:51], s64 offen offset:2048 sc1
buffer_load_dwordx4 v[132:135], v2, s[48:51], s64 offen offset:3072 sc1
L_wd23:
s_waitcnt vmcnt(8)
v_mov_b32 v190, 3
s_mov_b64 exec, 1
ds_write_b32 v185, v190
s_mov_b64 exec, -1
L_lc24:
ds_read_b128 v[186:189], v184
s_waitcnt lgkmcnt(0)
v_min3_u32 v186, v186, v187, v188
v_min_u32 v186, v186, v189
s_nop 0
v_readfirstlane_b32 s92, v186
s_nop 0
s_cmp_ge_u32 s92, 3
s_cbranch_scc1 L_lcd25
s_sleep 1
s_branch L_lc24
L_lcd25:
ds_read_b128 v[72:75], v10 offset:0
ds_read_b128 v[76:79], v10 offset:8192
ds_read_b128 v[80:83], v10 offset:16384
ds_read_b128 v[84:87], v10 offset:24576
s_cmp_eq_u32 s61, 1
s_cbranch_scc1 L_wr26
v_xor_b32 v11, 16, v19
ds_read_b64 v[104:105], v19 offset:0
ds_read_b64 v[106:107], v19 offset:1024
ds_read_b64 v[108:109], v11 offset:2048
ds_read_b64 v[110:111], v11 offset:3072
ds_read_b64 v[112:113], v19 offset:8192
ds_read_b64 v[114:115], v19 offset:9216
ds_read_b64 v[116:117], v11 offset:10240
ds_read_b64 v[118:119], v11 offset:11264
ds_read_b64 v[120:121], v19 offset:16384
ds_read_b64 v[122:123], v19 offset:17408
ds_read_b64 v[124:125], v11 offset:18432
ds_read_b64 v[126:127], v11 offset:19456
ds_read_b64 v[128:129], v19 offset:24576
ds_read_b64 v[130:131], v19 offset:25600
ds_read_b64 v[132:133], v11 offset:26624
ds_read_b64 v[134:135], v11 offset:27648
L_wr26:
s_waitcnt lgkmcnt(0)
v_mov_b32 v190, 4
s_mov_b64 exec, 1
ds_write_b32 v185, v190
s_mov_b64 exec, -1
s_lshl_b32 s64, s61, 31
s_or_b32 s64, s64, s62
L_fft27:
v_xor_b32 v24, s64, v72
v_xor_b32 v25, s64, v73
v_xor_b32 v26, s64, v74
v_xor_b32 v27, s64, v75
v_xor_b32 v28, s64, v76
v_xor_b32 v29, s64, v77
v_xor_b32 v30, s64, v78
v_xor_b32 v31, s64, v79
v_xor_b32 v32, s64, v80
v_xor_b32 v33, s64, v81
v_xor_b32 v34, s64, v82
v_xor_b32 v35, s64, v83
v_xor_b32 v36, s64, v84
v_xor_b32 v37, s64, v85
v_xor_b32 v38, s64, v86
v_xor_b32 v39, s64, v87
v_mfma_f32_32x32x16_bf16 v[40:55], v[24:27], v[192:195], 0
v_mfma_f32_32x32x16_bf16 v[40:55], v[28:31], v[196:199], v[40:55]
v_mfma_f32_32x32x16_bf16 v[40:55], v[32:35], v[200:203], v[40:55]
v_mfma_f32_32x32x16_bf16 v[40:55], v[36:39], v[204:207], v[40:55]
v_mfma_f32_32x32x16_bf16 v[56:71], v[24:27], v[208:211], 0
v_mfma_f32_32x32x16_bf16 v[56:71], v[28:31], v[212:215], v[56:71]
v_mfma_f32_32x32x16_bf16 v[56:71], v[32:35], v[216:219], v[56:71]
v_mfma_f32_32x32x16_bf16 v[56:71], v[36:39], v[220:223], v[56:71]
s_cmp_eq_u32 s61, 2
s_cbranch_scc1 L_once29
s_waitcnt vmcnt(0)
v_lshlrev_b32 v176, 16, v104
v_and_b32 v177, 0xffff0000, v104
v_lshlrev_b32 v178, 16, v105
v_and_b32 v179, 0xffff0000, v105
v_add_f32 v180, v176, v178
v_add_f32 v181, v177, v179
v_sub_f32 v176, v176, v178
v_sub_f32 v177, v177, v179
v_mul_f32 v104, v136, v176
v_mul_f32 v105, v136, v177
v_fma_f32 v136, v152, v176, v180
v_fma_f32 v152, v152, v177, v181
v_lshlrev_b32 v176, 16, v106
v_and_b32 v177, 0xffff0000, v106
v_lshlrev_b32 v178, 16, v107
v_and_b32 v179, 0xffff0000, v107
v_add_f32 v180, v176, v178
v_add_f32 v181, v177, v179
v_sub_f32 v176, v176, v178
v_sub_f32 v177, v177, v179
v_mul_f32 v106, v137, v176
v_mul_f32 v107, v137, v177
v_fma_f32 v137, v153, v176, v180
v_fma_f32 v153, v153, v177, v181
v_lshlrev_b32 v176, 16, v108
v_and_b32 v177, 0xffff0000, v108
v_lshlrev_b32 v178, 16, v109
v_and_b32 v179, 0xffff0000, v109
v_add_f32 v180, v176, v178
v_add_f32 v181, v177, v179
v_sub_f32 v176, v176, v178
v_sub_f32 v177, v177, v179
v_mul_f32 v108, v138, v176
v_mul_f32 v109, v138, v177
v_fma_f32 v138, v154, v176, v180
v_fma_f32 v154, v154, v177, v181
v_lshlrev_b32 v176, 16, v110
v_and_b32 v177, 0xffff0000, v110
v_lshlrev_b32 v178, 16, v111
v_and_b32 v179, 0xffff0000, v111
v_add_f32 v180, v176, v178
v_add_f32 v181, v177, v179
v_sub_f32 v176, v176, v178
v_sub_f32 v177, v177, v179
v_mul_f32 v110, v139, v176
v_mul_f32 v111, v139, v177
v_fma_f32 v139, v155, v176, v180
v_fma_f32 v155, v155, v177, v181
v_lshlrev_b32 v176, 16, v112
v_and_b32 v177, 0xffff0000, v112
v_lshlrev_b32 v178, 16, v113
v_and_b32 v179, 0xffff0000, v113
v_add_f32 v180, v176, v178
v_add_f32 v181, v177, v179
v_sub_f32 v176, v176, v178
v_sub_f32 v177, v177, v179
v_mul_f32 v112, v140, v176
v_mul_f32 v113, v140, v177
v_fma_f32 v140, v156, v176, v180
v_fma_f32 v156, v156, v177, v181
v_lshlrev_b32 v176, 16, v114
v_and_b32 v177, 0xffff0000, v114
v_lshlrev_b32 v178, 16, v115
v_and_b32 v179, 0xffff0000, v115
v_add_f32 v180, v176, v178
v_add_f32 v181, v177, v179
v_sub_f32 v176, v176, v178
v_sub_f32 v177, v177, v179
v_mul_f32 v114, v141, v176
v_mul_f32 v115, v141, v177
v_fma_f32 v141, v157, v176, v180
v_fma_f32 v157, v157, v177, v181
L_once29:
s_nop 5
v_mul_f32 v168, v40, v224
v_mul_f32 v169, v40, v240
s_nop 1
v_fma_f32 v168, -v56, v240, v168
v_fmac_f32 v169, v56, v224
v_cvt_pk_bf16_f32 v24, v168, v169
v_mul_f32 v170, v41, v225
v_mul_f32 v171, v41, v241
v_fma_f32 v170, -v57, v241, v170
v_fmac_f32 v171, v57, v225
v_cvt_pk_bf16_f32 v25, v170, v171
v_mul_f32 v172, v42, v226
v_mul_f32 v173, v42, v242
v_fma_f32 v172, -v58, v242, v172
v_fmac_f32 v173, v58, v226
v_cvt_pk_bf16_f32 v26, v172, v173
v_mul_f32 v174, v43, v227
v_mul_f32 v175, v43, v243
v_fma_f32 v174, -v59, v243, v174
v_fmac_f32 v175, v59, v227
v_cvt_pk_bf16_f32 v27, v174, v175
v_mul_f32 v168, v44, v228
v_mul_f32 v169, v44, v244
v_fma_f32 v168, -v60, v244, v168
v_fmac_f32 v169, v60, v228
v_cvt_pk_bf16_f32 v28, v168, v169
v_mul_f32 v170, v45, v229
v_mul_f32 v171, v45, v245
v_fma_f32 v170, -v61, v245, v170
v_fmac_f32 v171, v61, v229
v_cvt_pk_bf16_f32 v29, v170, v171
v_mul_f32 v172, v46, v230
v_mul_f32 v173, v46, v246
v_fma_f32 v172, -v62, v246, v172
v_fmac_f32 v173, v62, v230
v_cvt_pk_bf16_f32 v30, v172, v173
v_mul_f32 v174, v47, v231
v_mul_f32 v175, v47, v247
v_fma_f32 v174, -v63, v247, v174
v_fmac_f32 v175, v63, v231
v_cvt_pk_bf16_f32 v31, v174, v175
v_mul_f32 v168, v48, v232
v_mul_f32 v169, v48, v248
v_fma_f32 v168, -v64, v248, v168
v_fmac_f32 v169, v64, v232
v_cvt_pk_bf16_f32 v32, v168, v169
v_mul_f32 v170, v49, v233
v_mul_f32 v171, v49, v249
v_fma_f32 v170, -v65, v249, v170
v_fmac_f32 v171, v65, v233
v_cvt_pk_bf16_f32 v33, v170, v171
v_mul_f32 v172, v50, v234
v_mul_f32 v173, v50, v250
v_fma_f32 v172, -v66, v250, v172
v_fmac_f32 v173, v66, v234
v_cvt_pk_bf16_f32 v34, v172, v173
v_mul_f32 v174, v51, v235
v_mul_f32 v175, v51, v251
v_fma_f32 v174, -v67, v251, v174
v_fmac_f32 v175, v67, v235
v_cvt_pk_bf16_f32 v35, v174, v175
v_mul_f32 v168, v52, v236
v_mul_f32 v169, v52, v252
v_fma_f32 v168, -v68, v252, v168
v_fmac_f32 v169, v68, v236
v_cvt_pk_bf16_f32 v36, v168, v169
v_mul_f32 v170, v53, v237
v_mul_f32 v171, v53, v253
v_fma_f32 v170, -v69, v253, v170
v_fmac_f32 v171, v69, v237
v_cvt_pk_bf16_f32 v37, v170, v171
v_mul_f32 v172, v54, v238
v_mul_f32 v173, v54, v254
v_fma_f32 v172, -v70, v254, v172
v_fmac_f32 v173, v70, v238
v_cvt_pk_bf16_f32 v38, v172, v173
v_mul_f32 v174, v55, v239
v_mul_f32 v175, v55, v255
v_fma_f32 v174, -v71, v255, v174
v_fmac_f32 v175, v71, v239
v_cvt_pk_bf16_f32 v39, v174, v175
v_mfma_f32_32x32x16_bf16 v[40:55], v[192:195], v[24:27], 0
v_mfma_f32_32x32x16_bf16 v[40:55], v[196:199], v[28:31], v[40:55]
v_mfma_f32_32x32x16_bf16 v[40:55], v[200:203], v[32:35], v[40:55]
v_mfma_f32_32x32x16_bf16 v[40:55], v[204:207], v[36:39], v[40:55]
v_mfma_f32_32x32x16_bf16 v[56:71], v[208:211], v[24:27], 0
v_mfma_f32_32x32x16_bf16 v[56:71], v[212:215], v[28:31], v[56:71]
v_mfma_f32_32x32x16_bf16 v[56:71], v[216:219], v[32:35], v[56:71]
v_mfma_f32_32x32x16_bf16 v[56:71], v[220:223], v[36:39], v[56:71]
s_cmp_eq_u32 s61, 2
s_cbranch_scc1 L_once30
s_waitcnt vmcnt(0)
v_lshlrev_b32 v176, 16, v116
v_and_b32 v177, 0xffff0000, v116
v_lshlrev_b32 v178, 16, v117
v_and_b32 v179, 0xffff0000, v117
v_add_f32 v180, v176, v178
v_add_f32 v181, v177, v179
v_sub_f32 v176, v176, v178
v_sub_f32 v177, v177, v179
v_mul_f32 v116, v142, v176
v_mul_f32 v117, v142, v177
v_fma_f32 v142, v158, v176, v180
v_fma_f32 v158, v158, v177, v181
v_lshlrev_b32 v176, 16, v118
v_and_b32 v177, 0xffff0000, v118
v_lshlrev_b32 v178, 16, v119
v_and_b32 v179, 0xffff0000, v119
v_add_f32 v180, v176, v178
v_add_f32 v181, v177, v179
v_sub_f32 v176, v176, v178
v_sub_f32 v177, v177, v179
v_mul_f32 v118, v143, v176
v_mul_f32 v119, v143, v177
v_fma_f32 v143, v159, v176, v180
v_fma_f32 v159, v159, v177, v181
v_lshlrev_b32 v176, 16, v120
v_and_b32 v177, 0xffff0000, v120
v_lshlrev_b32 v178, 16, v121
v_and_b32 v179, 0xffff0000, v121
v_add_f32 v180, v176, v178
v_add_f32 v181, v177, v179
v_sub_f32 v176, v176, v178
v_sub_f32 v177, v177, v179
v_mul_f32 v120, v144, v176
v_mul_f32 v121, v144, v177
v_fma_f32 v144, v160, v176, v180
v_fma_f32 v160, v160, v177, v181
v_lshlrev_b32 v176, 16, v122
v_and_b32 v177, 0xffff0000, v122
v_lshlrev_b32 v178, 16, v123
v_and_b32 v179, 0xffff0000, v123
v_add_f32 v180, v176, v178
v_add_f32 v181, v177, v179
v_sub_f32 v176, v176, v178
v_sub_f32 v177, v177, v179
v_mul_f32 v122, v145, v176
v_mul_f32 v123, v145, v177
v_fma_f32 v145, v161, v176, v180
v_fma_f32 v161, v161, v177, v181
v_lshlrev_b32 v176, 16, v124
v_and_b32 v177, 0xffff0000, v124
v_lshlrev_b32 v178, 16, v125
v_and_b32 v179, 0xffff0000, v125
v_add_f32 v180, v176, v178
v_add_f32 v181, v177, v179
v_sub_f32 v176, v176, v178
v_sub_f32 v177, v177, v179
v_mul_f32 v124, v146, v176
v_mul_f32 v125, v146, v177
v_fma_f32 v146, v162, v176, v180
v_fma_f32 v162, v162, v177, v181
v_lshlrev_b32 v176, 16, v126
v_and_b32 v177, 0xffff0000, v126
v_lshlrev_b32 v178, 16, v127
v_and_b32 v179, 0xffff0000, v127
v_add_f32 v180, v176, v178
v_add_f32 v181, v177, v179
v_sub_f32 v176, v176, v178
v_sub_f32 v177, v177, v179
v_mul_f32 v126, v147, v176
v_mul_f32 v127, v147, v177
v_fma_f32 v147, v163, v176, v180
v_fma_f32 v163, v163, v177, v181
L_once30:
L_lc31:
ds_read_b128 v[186:189], v184
s_waitcnt lgkmcnt(0)
v_min3_u32 v186, v186, v187, v188
v_min_u32 v186, v186, v189
s_nop 0
v_readfirstlane_b32 s92, v186
s_nop 0
s_cmp_ge_u32 s92, 4
s_cbranch_scc1 L_lcd32
s_sleep 1
s_branch L_lc31
L_lcd32:
s_cmp_eq_u32 s61, 2
s_cbranch_scc1 L_nwr28
ds_write_b128 v16, v[40:43] offset:0
ds_write_b128 v16, v[44:47] offset:1024
ds_write_b128 v16, v[48:51] offset:2048
ds_write_b128 v16, v[52:55] offset:3072
ds_write_b128 v16, v[56:59] offset:4096
ds_write_b128 v16, v[60:63] offset:5120
ds_write_b128 v16, v[64:67] offset:6144
ds_write_b128 v16, v[68:71] offset:7168
s_cmp_eq_u32 s61, 0
s_cbranch_scc1 L_nwr28
s_mov_b32 s61, 2
s_mov_b32 s64, 0
s_branch L_fft27
L_nwr28:
v_lshlrev_b32 v176, 16, v128
v_and_b32 v177, 0xffff0000, v128
v_lshlrev_b32 v178, 16, v129
v_and_b32 v179, 0xffff0000, v129
v_add_f32 v180, v176, v178
v_add_f32 v181, v177, v179
v_sub_f32 v176, v176, v178
v_sub_f32 v177, v177, v179
v_mul_f32 v128, v148, v176
v_mul_f32 v129, v148, v177
v_fma_f32 v148, v164, v176, v180
v_fma_f32 v164, v164, v177, v181
v_lshlrev_b32 v176, 16, v130
v_and_b32 v177, 0xffff0000, v130
v_lshlrev_b32 v178, 16, v131
v_and_b32 v179, 0xffff0000, v131
v_add_f32 v180, v176, v178
v_add_f32 v181, v177, v179
v_sub_f32 v176, v176, v178
v_sub_f32 v177, v177, v179
v_mul_f32 v130, v149, v176
v_mul_f32 v131, v149, v177
v_fma_f32 v149, v165, v176, v180
v_fma_f32 v165, v165, v177, v181
s_waitcnt lgkmcnt(0)
v_mov_b32 v190, 5
s_mov_b64 exec, 1
ds_write_b32 v185, v190
s_mov_b64 exec, -1
v_lshlrev_b32 v176, 16, v132
v_and_b32 v177, 0xffff0000, v132
v_lshlrev_b32 v178, 16, v133
v_and_b32 v179, 0xffff0000, v133
v_add_f32 v180, v176, v178
v_add_f32 v181, v177, v179
v_sub_f32 v176, v176, v178
v_sub_f32 v177, v177, v179
v_mul_f32 v132, v150, v176
v_mul_f32 v133, v150, v177
v_fma_f32 v150, v166, v176, v180
v_fma_f32 v166, v166, v177, v181
v_lshlrev_b32 v176, 16, v134
v_and_b32 v177, 0xffff0000, v134
v_lshlrev_b32 v178, 16, v135
v_and_b32 v179, 0xffff0000, v135
v_add_f32 v180, v176, v178
v_add_f32 v181, v177, v179
v_sub_f32 v176, v176, v178
v_sub_f32 v177, v177, v179
v_mul_f32 v134, v151, v176
v_mul_f32 v135, v151, v177
v_fma_f32 v151, v167, v176, v180
v_fma_f32 v167, v167, v177, v181
v_mul_f32 v168, v152, v56
v_mul_f32 v56, v136, v56
v_fmac_f32 v56, v152, v40
v_fma_f32 v40, v136, v40, -v168
v_mul_f32 v169, v153, v57
v_mul_f32 v57, v137, v57
v_fmac_f32 v57, v153, v41
v_fma_f32 v41, v137, v41, -v169
v_mul_f32 v168, v154, v58
v_mul_f32 v58, v138, v58
v_fmac_f32 v58, v154, v42
v_fma_f32 v42, v138, v42, -v168
v_mul_f32 v169, v155, v59
v_mul_f32 v59, v139, v59
v_fmac_f32 v59, v155, v43
v_fma_f32 v43, v139, v43, -v169
v_mul_f32 v168, v156, v60
v_mul_f32 v60, v140, v60
v_fmac_f32 v60, v156, v44
v_fma_f32 v44, v140, v44, -v168
v_mul_f32 v169, v157, v61
v_mul_f32 v61, v141, v61
v_fmac_f32 v61, v157, v45
v_fma_f32 v45, v141, v45, -v169
L_lc33:
ds_read_b128 v[186:189], v184
s_waitcnt lgkmcnt(0)
v_min3_u32 v186, v186, v187, v188
v_min_u32 v186, v186, v189
s_nop 0
v_readfirstlane_b32 s92, v186
s_nop 0
s_cmp_ge_u32 s92, 5
s_cbranch_scc1 L_lcd34
s_sleep 1
s_branch L_lc33
L_lcd34:
ds_read_b128 v[72:75], v17 offset:0
ds_read_b128 v[76:79], v17 offset:1024
ds_read_b128 v[80:83], v17 offset:2048
ds_read_b128 v[84:87], v17 offset:3072
ds_read_b128 v[88:91], v17 offset:4096
ds_read_b128 v[92:95], v17 offset:5120
ds_read_b128 v[96:99], v17 offset:6144
ds_read_b128 v[100:103], v17 offset:7168
v_mul_f32 v168, v158, v62
v_mul_f32 v62, v142, v62
v_fmac_f32 v62, v158, v46
v_fma_f32 v46, v142, v46, -v168
v_mul_f32 v169, v159, v63
v_mul_f32 v63, v143, v63
v_fmac_f32 v63, v159, v47
v_fma_f32 v47, v143, v47, -v169
v_mul_f32 v168, v160, v64
v_mul_f32 v64, v144, v64
v_fmac_f32 v64, v160, v48
v_fma_f32 v48, v144, v48, -v168
v_mul_f32 v169, v161, v65
v_mul_f32 v65, v145, v65
v_fmac_f32 v65, v161, v49
v_fma_f32 v49, v145, v49, -v169
v_mul_f32 v168, v162, v66
v_mul_f32 v66, v146, v66
v_fmac_f32 v66, v162, v50
v_fma_f32 v50, v146, v50, -v168
v_mul_f32 v169, v163, v67
v_mul_f32 v67, v147, v67
v_fmac_f32 v67, v163, v51
v_fma_f32 v51, v147, v51, -v169
v_mul_f32 v168, v164, v68
v_mul_f32 v68, v148, v68
v_fmac_f32 v68, v164, v52
v_fma_f32 v52, v148, v52, -v168
v_mul_f32 v169, v165, v69
v_mul_f32 v69, v149, v69
v_fmac_f32 v69, v165, v53
v_fma_f32 v53, v149, v53, -v169
v_mul_f32 v168, v166, v70
v_mul_f32 v70, v150, v70
v_fmac_f32 v70, v166, v54
v_fma_f32 v54, v150, v54, -v168
v_mul_f32 v169, v167, v71
v_mul_f32 v71, v151, v71
v_fmac_f32 v71, v167, v55
v_fma_f32 v55, v151, v55, -v169
s_waitcnt lgkmcnt(0)
v_mov_b32 v190, 6
s_mov_b64 exec, 1
ds_write_b32 v185, v190
s_mov_b64 exec, -1
v_fma_f32 v40, -v104, v88, v40
v_fmac_f32 v56, v104, v72
v_fma_f32 v40, -v105, v72, v40
v_fma_f32 v56, -v105, v88, v56
v_cvt_pk_bf16_f32 v24, v56, v40
v_fma_f32 v41, -v106, v89, v41
v_fmac_f32 v57, v106, v73
v_fma_f32 v41, -v107, v73, v41
v_fma_f32 v57, -v107, v89, v57
v_cvt_pk_bf16_f32 v25, v57, v41
v_fma_f32 v42, -v108, v90, v42
v_fmac_f32 v58, v108, v74
v_fma_f32 v42, -v109, v74, v42
v_fma_f32 v58, -v109, v90, v58
v_cvt_pk_bf16_f32 v26, v58, v42
v_fma_f32 v43, -v110, v91, v43
v_fmac_f32 v59, v110, v75
v_fma_f32 v43, -v111, v75, v43
v_fma_f32 v59, -v111, v91, v59
v_cvt_pk_bf16_f32 v27, v59, v43
v_fma_f32 v44, -v112, v92, v44
v_fmac_f32 v60, v112, v76
v_fma_f32 v44, -v113, v76, v44
v_fma_f32 v60, -v113, v92, v60
v_cvt_pk_bf16_f32 v28, v60, v44
v_fma_f32 v45, -v114, v93, v45
v_fmac_f32 v61, v114, v77
v_fma_f32 v45, -v115, v77, v45
v_fma_f32 v61, -v115, v93, v61
v_cvt_pk_bf16_f32 v29, v61, v45
v_fma_f32 v46, -v116, v94, v46
v_fmac_f32 v62, v116, v78
v_fma_f32 v46, -v117, v78, v46
v_fma_f32 v62, -v117, v94, v62
v_cvt_pk_bf16_f32 v30, v62, v46
v_fma_f32 v47, -v118, v95, v47
v_fmac_f32 v63, v118, v79
v_fma_f32 v47, -v119, v79, v47
v_fma_f32 v63, -v119, v95, v63
v_cvt_pk_bf16_f32 v31, v63, v47
v_fma_f32 v48, -v120, v96, v48
v_fmac_f32 v64, v120, v80
v_fma_f32 v48, -v121, v80, v48
v_fma_f32 v64, -v121, v96, v64
v_cvt_pk_bf16_f32 v32, v64, v48
v_fma_f32 v49, -v122, v97, v49
v_fmac_f32 v65, v122, v81
v_fma_f32 v49, -v123, v81, v49
v_fma_f32 v65, -v123, v97, v65
v_cvt_pk_bf16_f32 v33, v65, v49
v_fma_f32 v50, -v124, v98, v50
v_fmac_f32 v66, v124, v82
v_fma_f32 v50, -v125, v82, v50
v_fma_f32 v66, -v125, v98, v66
v_cvt_pk_bf16_f32 v34, v66, v50
v_fma_f32 v51, -v126, v99, v51
v_fmac_f32 v67, v126, v83
v_fma_f32 v51, -v127, v83, v51
v_fma_f32 v67, -v127, v99, v67
v_cvt_pk_bf16_f32 v35, v67, v51
v_fma_f32 v52, -v128, v100, v52
v_fmac_f32 v68, v128, v84
v_fma_f32 v52, -v129, v84, v52
v_fma_f32 v68, -v129, v100, v68
v_cvt_pk_bf16_f32 v36, v68, v52
v_fma_f32 v53, -v130, v101, v53
v_fmac_f32 v69, v130, v85
v_fma_f32 v53, -v131, v85, v53
v_fma_f32 v69, -v131, v101, v69
v_cvt_pk_bf16_f32 v37, v69, v53
v_fma_f32 v54, -v132, v102, v54
v_fmac_f32 v70, v132, v86
v_fma_f32 v54, -v133, v86, v54
v_fma_f32 v70, -v133, v102, v70
v_cvt_pk_bf16_f32 v38, v70, v54
v_fma_f32 v55, -v134, v103, v55
v_fmac_f32 v71, v134, v87
v_fma_f32 v55, -v135, v87, v55
v_fma_f32 v71, -v135, v103, v71
v_cvt_pk_bf16_f32 v39, v71, v55
v_mfma_f32_32x32x16_bf16 v[40:55], v[24:27], v[192:195], 0
v_mfma_f32_32x32x16_bf16 v[40:55], v[28:31], v[196:199], v[40:55]
v_mfma_f32_32x32x16_bf16 v[40:55], v[32:35], v[200:203], v[40:55]
v_mfma_f32_32x32x16_bf16 v[40:55], v[36:39], v[204:207], v[40:55]
v_mfma_f32_32x32x16_bf16 v[56:71], v[24:27], v[208:211], 0
v_mfma_f32_32x32x16_bf16 v[56:71], v[28:31], v[212:215], v[56:71]
v_mfma_f32_32x32x16_bf16 v[56:71], v[32:35], v[216:219], v[56:71]
v_mfma_f32_32x32x16_bf16 v[56:71], v[36:39], v[220:223], v[56:71]
s_nop 7
v_mul_f32 v168, v40, v224
v_mul_f32 v169, v40, v240
s_nop 1
v_fma_f32 v168, -v56, v240, v168
v_fmac_f32 v169, v56, v224
v_cvt_pk_bf16_f32 v24, v168, v169
v_mul_f32 v170, v41, v225
v_mul_f32 v171, v41, v241
v_fma_f32 v170, -v57, v241, v170
v_fmac_f32 v171, v57, v225
v_cvt_pk_bf16_f32 v25, v170, v171
v_mul_f32 v172, v42, v226
v_mul_f32 v173, v42, v242
v_fma_f32 v172, -v58, v242, v172
v_fmac_f32 v173, v58, v226
v_cvt_pk_bf16_f32 v26, v172, v173
v_mul_f32 v174, v43, v227
v_mul_f32 v175, v43, v243
v_fma_f32 v174, -v59, v243, v174
v_fmac_f32 v175, v59, v227
v_cvt_pk_bf16_f32 v27, v174, v175
v_mul_f32 v168, v44, v228
v_mul_f32 v169, v44, v244
v_fma_f32 v168, -v60, v244, v168
v_fmac_f32 v169, v60, v228
v_cvt_pk_bf16_f32 v28, v168, v169
v_mul_f32 v170, v45, v229
v_mul_f32 v171, v45, v245
v_fma_f32 v170, -v61, v245, v170
v_fmac_f32 v171, v61, v229
v_cvt_pk_bf16_f32 v29, v170, v171
v_mul_f32 v172, v46, v230
v_mul_f32 v173, v46, v246
v_fma_f32 v172, -v62, v246, v172
v_fmac_f32 v173, v62, v230
v_cvt_pk_bf16_f32 v30, v172, v173
v_mul_f32 v174, v47, v231
v_mul_f32 v175, v47, v247
v_fma_f32 v174, -v63, v247, v174
v_fmac_f32 v175, v63, v231
v_cvt_pk_bf16_f32 v31, v174, v175
v_mul_f32 v168, v48, v232
v_mul_f32 v169, v48, v248
v_fma_f32 v168, -v64, v248, v168
v_fmac_f32 v169, v64, v232
v_cvt_pk_bf16_f32 v32, v168, v169
v_mul_f32 v170, v49, v233
v_mul_f32 v171, v49, v249
v_fma_f32 v170, -v65, v249, v170
v_fmac_f32 v171, v65, v233
v_cvt_pk_bf16_f32 v33, v170, v171
v_mul_f32 v172, v50, v234
v_mul_f32 v173, v50, v250
v_fma_f32 v172, -v66, v250, v172
v_fmac_f32 v173, v66, v234
v_cvt_pk_bf16_f32 v34, v172, v173
v_mul_f32 v174, v51, v235
v_mul_f32 v175, v51, v251
v_fma_f32 v174, -v67, v251, v174
v_fmac_f32 v175, v67, v235
v_cvt_pk_bf16_f32 v35, v174, v175
v_mul_f32 v168, v52, v236
v_mul_f32 v169, v52, v252
v_fma_f32 v168, -v68, v252, v168
v_fmac_f32 v169, v68, v236
v_cvt_pk_bf16_f32 v36, v168, v169
v_mul_f32 v170, v53, v237
v_mul_f32 v171, v53, v253
v_fma_f32 v170, -v69, v253, v170
v_fmac_f32 v171, v69, v237
v_cvt_pk_bf16_f32 v37, v170, v171
v_mul_f32 v172, v54, v238
v_mul_f32 v173, v54, v254
v_fma_f32 v172, -v70, v254, v172
v_fmac_f32 v173, v70, v238
v_cvt_pk_bf16_f32 v38, v172, v173
v_mul_f32 v174, v55, v239
v_mul_f32 v175, v55, v255
v_fma_f32 v174, -v71, v255, v174
v_fmac_f32 v175, v71, v239
v_cvt_pk_bf16_f32 v39, v174, v175
v_mfma_f32_32x32x16_bf16 v[40:55], v[192:195], v[24:27], 0
v_mfma_f32_32x32x16_bf16 v[40:55], v[196:199], v[28:31], v[40:55]
v_mfma_f32_32x32x16_bf16 v[40:55], v[200:203], v[32:35], v[40:55]
v_mfma_f32_32x32x16_bf16 v[40:55], v[204:207], v[36:39], v[40:55]
v_mfma_f32_32x32x16_bf16 v[56:71], v[208:211], v[24:27], 0
v_mfma_f32_32x32x16_bf16 v[56:71], v[212:215], v[28:31], v[56:71]
v_mfma_f32_32x32x16_bf16 v[56:71], v[216:219], v[32:35], v[56:71]
v_mfma_f32_32x32x16_bf16 v[56:71], v[220:223], v[36:39], v[56:71]
s_lshr_b32 s64, s62, 16
L_lc35:
ds_read_b128 v[186:189], v184
s_waitcnt lgkmcnt(0)
v_min3_u32 v186, v186, v187, v188
v_min_u32 v186, v186, v189
s_nop 0
v_readfirstlane_b32 s92, v186
s_nop 0
s_cmp_ge_u32 s92, 6
s_cbranch_scc1 L_lcd36
s_sleep 1
s_branch L_lc35
L_lcd36:
s_nop 1
v_cvt_pk_bf16_f32 v24, v40, v56
v_xor_b32 v24, s64, v24
v_cvt_pk_bf16_f32 v25, v41, v57
v_xor_b32 v25, s64, v25
v_cvt_pk_bf16_f32 v26, v42, v58
v_xor_b32 v26, s64, v26
v_cvt_pk_bf16_f32 v27, v43, v59
v_xor_b32 v27, s64, v27
ds_write_b128 v15, v[24:27] offset:0
v_cvt_pk_bf16_f32 v28, v44, v60
v_xor_b32 v28, s64, v28
v_cvt_pk_bf16_f32 v29, v45, v61
v_xor_b32 v29, s64, v29
v_cvt_pk_bf16_f32 v30, v46, v62
v_xor_b32 v30, s64, v30
v_cvt_pk_bf16_f32 v31, v47, v63
v_xor_b32 v31, s64, v31
ds_write_b128 v15, v[28:31] offset:4096
v_cvt_pk_bf16_f32 v32, v48, v64
v_xor_b32 v32, s64, v32
v_cvt_pk_bf16_f32 v33, v49, v65
v_xor_b32 v33, s64, v33
v_cvt_pk_bf16_f32 v34, v50, v66
v_xor_b32 v34, s64, v34
v_cvt_pk_bf16_f32 v35, v51, v67
v_xor_b32 v35, s64, v35
ds_write_b128 v15, v[32:35] offset:8192
v_cvt_pk_bf16_f32 v36, v52, v68
v_xor_b32 v36, s64, v36
v_cvt_pk_bf16_f32 v37, v53, v69
v_xor_b32 v37, s64, v37
v_cvt_pk_bf16_f32 v38, v54, v70
v_xor_b32 v38, s64, v38
v_cvt_pk_bf16_f32 v39, v55, v71
v_xor_b32 v39, s64, v39
ds_write_b128 v15, v[36:39] offset:12288
s_waitcnt lgkmcnt(0)
v_mov_b32 v190, 7
s_mov_b64 exec, 1
ds_write_b32 v185, v190
s_mov_b64 exec, -1
L_lc37:
ds_read_b128 v[186:189], v184
s_waitcnt lgkmcnt(0)
v_min3_u32 v186, v186, v187, v188
v_min_u32 v186, v186, v189
s_nop 0
v_readfirstlane_b32 s92, v186
s_nop 0
s_cmp_ge_u32 s92, 7
s_cbranch_scc1 L_lcd38
s_sleep 1
s_branch L_lc37
L_lcd38:
ds_read_b128 v[24:27], v18 offset:0
ds_read_b128 v[28:31], v18 offset:1024
ds_read_b128 v[32:35], v18 offset:2048
ds_read_b128 v[36:39], v18 offset:3072
s_mov_b32 s64, 0
s_waitcnt lgkmcnt(3)
buffer_store_dwordx4 v[24:27], v14, s[56:59], s64 offen sc1
s_mov_b32 s64, 262144
s_waitcnt lgkmcnt(2)
buffer_store_dwordx4 v[28:31], v14, s[56:59], s64 offen sc1
s_mov_b32 s64, 524288
s_waitcnt lgkmcnt(1)
buffer_store_dwordx4 v[32:35], v14, s[56:59], s64 offen sc1
s_mov_b32 s64, 786432
s_waitcnt lgkmcnt(0)
buffer_store_dwordx4 v[36:39], v14, s[56:59], s64 offen sc1
s_lshl_b32 s64, s67, 14
s_add_u32 s40, s28, s64
s_addc_u32 s41, s29, 0
s_mov_b32 s42, 16384
s_mov_b32 s43, 0x20000
v_and_b32 v8, 31, v1
v_lshrrev_b32 v9, 5, v1
v_lshlrev_b32 v14, 2, v8
v_lshl_add_u32 v14, v9, 9, v14
s_mov_b32 s64, 0x35000000
v_mul_f32 v224, s64, v224
v_mul_f32 v225, s64, v225
v_mul_f32 v226, s64, v226
v_mul_f32 v227, s64, v227
v_mul_f32 v228, s64, v228
v_mul_f32 v229, s64, v229
v_mul_f32 v230, s64, v230
v_mul_f32 v231, s64, v231
v_mul_f32 v232, s64, v232
v_mul_f32 v233, s64, v233
v_mul_f32 v234, s64, v234
v_mul_f32 v235, s64, v235
v_mul_f32 v236, s64, v236
v_mul_f32 v237, s64, v237
v_mul_f32 v238, s64, v238
v_mul_f32 v239, s64, v239
v_mul_f32 v240, s64, v240
v_mul_f32 v241, s64, v241
v_mul_f32 v242, s64, v242
v_mul_f32 v243, s64, v243
v_mul_f32 v244, s64, v244
v_mul_f32 v245, s64, v245
v_mul_f32 v246, s64, v246
v_mul_f32 v247, s64, v247
v_mul_f32 v248, s64, v248
v_mul_f32 v249, s64, v249
v_mul_f32 v250, s64, v250
v_mul_f32 v251, s64, v251
v_mul_f32 v252, s64, v252
v_mul_f32 v253, s64, v253
v_mul_f32 v254, s64, v254
v_mul_f32 v255, s64, v255
s_waitcnt vmcnt(0)
v_mov_b32 v190, 8
s_mov_b64 exec, 1
ds_write_b32 v185, v190
s_mov_b64 exec, -1
s_cmp_lg_u32 s66, 0
s_cbranch_scc1 L_ph39
L_lc40:
ds_read_b128 v[186:189], v184
s_waitcnt lgkmcnt(0)
v_min3_u32 v186, v186, v187, v188
v_min_u32 v186, v186, v189
s_nop 0
v_readfirstlane_b32 s92, v186
s_nop 0
s_cmp_ge_u32 s92, 8
s_cbranch_scc1 L_lcd41
s_sleep 1
s_branch L_lc40
L_lcd41:
s_and_b32 s64, s2, 15
s_lshl_b32 s65, s64, 7
s_add_u32 s65, s65, 6144
s_add_u32 s90, s32, s65
s_addc_u32 s91, s33, 0
s_mov_b32 s18, 1
s_atomic_add s18, s[90:91], 0x0 glc
L_ph39:
s_cmp_lg_u32 s66, 0
s_cbranch_scc1 L_sg42
s_and_b32 s64, s2, 15
s_lshl_b32 s64, s64, 2
s_add_u32 s64, s64, 548864
s_add_u32 s4, s32, s64
s_addc_u32 s5, s33, 0
s_waitcnt lgkmcnt(0)
s_cmp_lg_u32 s18, 15
s_cbranch_scc1 L_sg42
s_atomic_swap s37, s[4:5], 0x0
s_atomic_swap s37, s[4:5], 0x80
s_atomic_swap s37, s[4:5], 0x100
s_atomic_swap s37, s[4:5], 0x180
s_atomic_swap s37, s[4:5], 0x200
s_atomic_swap s37, s[4:5], 0x280
s_atomic_swap s37, s[4:5], 0x300
s_atomic_swap s37, s[4:5], 0x380
s_atomic_swap s37, s[4:5], 0x400
s_atomic_swap s37, s[4:5], 0x480
s_atomic_swap s37, s[4:5], 0x500
s_atomic_swap s37, s[4:5], 0x580
s_atomic_swap s37, s[4:5], 0x600
s_atomic_swap s37, s[4:5], 0x680
s_atomic_swap s37, s[4:5], 0x700
s_atomic_swap s37, s[4:5], 0x780
s_atomic_swap s37, s[4:5], 0x800
s_atomic_swap s37, s[4:5], 0x880
s_atomic_swap s37, s[4:5], 0x900
s_atomic_swap s37, s[4:5], 0x980
s_atomic_swap s37, s[4:5], 0xa00
s_atomic_swap s37, s[4:5], 0xa80
s_atomic_swap s37, s[4:5], 0xb00
s_atomic_swap s37, s[4:5], 0xb80
s_atomic_swap s37, s[4:5], 0xc00
s_atomic_swap s37, s[4:5], 0xc80
s_atomic_swap s37, s[4:5], 0xd00
s_atomic_swap s37, s[4:5], 0xd80
s_atomic_swap s37, s[4:5], 0xe00
s_atomic_swap s37, s[4:5], 0xe80
s_atomic_swap s37, s[4:5], 0xf00
s_atomic_swap s37, s[4:5], 0xf80
s_waitcnt lgkmcnt(0)
L_sg42:
s_cmp_lg_u32 s66, 0
s_cbranch_scc1 L_ph43
s_and_b32 s64, s2, 31
s_lshl_b32 s64, s64, 7
s_add_u32 s64, s64, 548864
s_add_u32 s90, s32, s64
s_addc_u32 s91, s33, 0
s_mov_b32 s64, s37
s_mov_b32 s65, s37
s_mov_b32 s92, 0
s_branch L_sp44
L_nok45:
s_add_u32 s92, s92, 1
s_cmp_ge_u32 s92, 200000
s_cbranch_scc1 L_ph43
s_sleep 10
L_sp44:
s_load_dwordx16 s[4:19], s[90:91], 0x0 glc
s_waitcnt lgkmcnt(0)
s_cmp_eq_u64 s[4:5], s[64:65]
s_cbranch_scc0 L_nok45
s_cmp_eq_u64 s[6:7], s[64:65]
s_cbranch_scc0 L_nok45
s_cmp_eq_u64 s[8:9], s[64:65]
s_cbranch_scc0 L_nok45
s_cmp_eq_u64 s[10:11], s[64:65]
s_cbranch_scc0 L_nok45
s_cmp_eq_u64 s[12:13], s[64:65]
s_cbranch_scc0 L_nok45
s_cmp_eq_u64 s[14:15], s[64:65]
s_cbranch_scc0 L_nok45
s_cmp_eq_u64 s[16:17], s[64:65]
s_cbranch_scc0 L_nok45
s_cmp_eq_u64 s[18:19], s[64:65]
s_cbranch_scc0 L_nok45
L_ph43:
v_mov_b32 v190, 9
s_mov_b64 exec, 1
ds_write_b32 v185, v190
s_mov_b64 exec, -1
L_lc46:
ds_read_b128 v[186:189], v184
s_waitcnt lgkmcnt(0)
v_min3_u32 v186, v186, v187, v188
v_min_u32 v186, v186, v189
s_nop 0
v_readfirstlane_b32 s92, v186
s_nop 0
s_cmp_ge_u32 s92, 9
s_cbranch_scc1 L_lcd47
s_sleep 1
s_branch L_lc46
L_lcd47:
s_setprio 0
v_add_u32 v191, -16, v184
L_lc48:
ds_read_b128 v[186:189], v191
s_waitcnt lgkmcnt(0)
v_min3_u32 v186, v186, v187, v188
v_min_u32 v186, v186, v189
s_nop 0
v_readfirstlane_b32 s92, v186
s_nop 0
s_cmp_ge_u32 s92, 11
s_cbranch_scc1 L_lcd49
s_sleep 1
s_branch L_lc48
L_lcd49:
s_mov_b32 m0, s68
s_nop 0
buffer_load_dwordx4 v7, s[44:47], 0 offen offset:0 sc1 lds
buffer_load_dwordx4 v7, s[44:47], 0 offen offset:1024 sc1 lds
buffer_load_dwordx4 v7, s[44:47], 0 offen offset:2048 sc1 lds
buffer_load_dwordx4 v7, s[44:47], 0 offen offset:3072 sc1 lds
s_waitcnt vmcnt(0)
v_mov_b32 v190, 10
s_mov_b64 exec, 1
ds_write_b32 v185, v190
s_mov_b64 exec, -1
L_lc50:
ds_read_b128 v[186:189], v184
s_waitcnt lgkmcnt(0)
v_min3_u32 v186, v186, v187, v188
v_min_u32 v186, v186, v189
s_nop 0
v_readfirstlane_b32 s92, v186
s_nop 0
s_cmp_ge_u32 s92, 10
s_cbranch_scc1 L_lcd51
s_sleep 1
s_branch L_lc50
L_lcd51:
ds_read_b32 v24, v4 offset:0
ds_read_b32 v25, v4 offset:1024
ds_read_b32 v26, v4 offset:2048
ds_read_b32 v27, v4 offset:3072
ds_read_b32 v28, v4 offset:8192
ds_read_b32 v29, v4 offset:9216
ds_read_b32 v30, v4 offset:10240
ds_read_b32 v31, v4 offset:11264
ds_read_b32 v32, v6 offset:0
ds_read_b32 v33, v5 offset:10240
ds_read_b32 v34, v5 offset:9216
ds_read_b32 v35, v5 offset:8192
ds_read_b32 v36, v5 offset:3072
ds_read_b32 v37, v5 offset:2048
ds_read_b32 v38, v5 offset:1024
ds_read_b32 v39, v5 offset:0
s_waitcnt lgkmcnt(0)
v_mfma_f32_32x32x16_bf16 v[40:55], v[24:27], v[192:195], 0
v_mfma_f32_32x32x16_bf16 v[40:55], v[28:31], v[196:199], v[40:55]
v_mfma_f32_32x32x16_bf16 v[40:55], v[32:35], v[200:203], v[40:55]
v_mfma_f32_32x32x16_bf16 v[40:55], v[36:39], v[204:207], v[40:55]
v_mfma_f32_32x32x16_bf16 v[56:71], v[24:27], v[208:211], 0
v_mfma_f32_32x32x16_bf16 v[56:71], v[28:31], v[212:215], v[56:71]
v_mfma_f32_32x32x16_bf16 v[56:71], v[32:35], v[216:219], v[56:71]
v_mfma_f32_32x32x16_bf16 v[56:71], v[36:39], v[220:223], v[56:71]
s_nop 7
v_mul_f32 v168, v40, v224
v_mul_f32 v169, v40, v240
s_nop 1
v_fma_f32 v168, -v56, v240, v168
v_fmac_f32 v169, v56, v224
v_cvt_pk_bf16_f32 v24, v168, v169
v_mul_f32 v170, v41, v225
v_mul_f32 v171, v41, v241
v_fma_f32 v170, -v57, v241, v170
v_fmac_f32 v171, v57, v225
v_cvt_pk_bf16_f32 v25, v170, v171
v_mul_f32 v172, v42, v226
v_mul_f32 v173, v42, v242
v_fma_f32 v172, -v58, v242, v172
v_fmac_f32 v173, v58, v226
v_cvt_pk_bf16_f32 v26, v172, v173
v_mul_f32 v174, v43, v227
v_mul_f32 v175, v43, v243
v_fma_f32 v174, -v59, v243, v174
v_fmac_f32 v175, v59, v227
v_cvt_pk_bf16_f32 v27, v174, v175
v_mul_f32 v168, v44, v228
v_mul_f32 v169, v44, v244
v_fma_f32 v168, -v60, v244, v168
v_fmac_f32 v169, v60, v228
v_cvt_pk_bf16_f32 v28, v168, v169
v_mul_f32 v170, v45, v229
v_mul_f32 v171, v45, v245
v_fma_f32 v170, -v61, v245, v170
v_fmac_f32 v171, v61, v229
v_cvt_pk_bf16_f32 v29, v170, v171
v_mul_f32 v172, v46, v230
v_mul_f32 v173, v46, v246
v_fma_f32 v172, -v62, v246, v172
v_fmac_f32 v173, v62, v230
v_cvt_pk_bf16_f32 v30, v172, v173
v_mul_f32 v174, v47, v231
v_mul_f32 v175, v47, v247
v_fma_f32 v174, -v63, v247, v174
v_fmac_f32 v175, v63, v231
v_cvt_pk_bf16_f32 v31, v174, v175
v_mul_f32 v168, v48, v232
v_mul_f32 v169, v48, v248
v_fma_f32 v168, -v64, v248, v168
v_fmac_f32 v169, v64, v232
v_cvt_pk_bf16_f32 v32, v168, v169
v_mul_f32 v170, v49, v233
v_mul_f32 v171, v49, v249
v_fma_f32 v170, -v65, v249, v170
v_fmac_f32 v171, v65, v233
v_cvt_pk_bf16_f32 v33, v170, v171
v_mul_f32 v172, v50, v234
v_mul_f32 v173, v50, v250
v_fma_f32 v172, -v66, v250, v172
v_fmac_f32 v173, v66, v234
v_cvt_pk_bf16_f32 v34, v172, v173
v_mul_f32 v174, v51, v235
v_mul_f32 v175, v51, v251
v_fma_f32 v174, -v67, v251, v174
v_fmac_f32 v175, v67, v235
v_cvt_pk_bf16_f32 v35, v174, v175
v_mul_f32 v168, v52, v236
v_mul_f32 v169, v52, v252
v_fma_f32 v168, -v68, v252, v168
v_fmac_f32 v169, v68, v236
v_cvt_pk_bf16_f32 v36, v168, v169
v_mul_f32 v170, v53, v237
v_mul_f32 v171, v53, v253
v_fma_f32 v170, -v69, v253, v170
v_fmac_f32 v171, v69, v237
v_cvt_pk_bf16_f32 v37, v170, v171
v_mul_f32 v172, v54, v238
v_mul_f32 v173, v54, v254
v_fma_f32 v172, -v70, v254, v172
v_fmac_f32 v173, v70, v238
v_cvt_pk_bf16_f32 v38, v172, v173
v_mul_f32 v174, v55, v239
v_mul_f32 v175, v55, v255
v_fma_f32 v174, -v71, v255, v174
v_fmac_f32 v175, v71, v239
v_cvt_pk_bf16_f32 v39, v174, v175
v_mfma_f32_32x32x16_bf16 v[40:55], v[192:195], v[24:27], 0
v_mfma_f32_32x32x16_bf16 v[40:55], v[196:199], v[28:31], v[40:55]
v_mfma_f32_32x32x16_bf16 v[40:55], v[200:203], v[32:35], v[40:55]
v_mfma_f32_32x32x16_bf16 v[40:55], v[204:207], v[36:39], v[40:55]
v_mfma_f32_32x32x16_bf16 v[56:71], v[208:211], v[24:27], 0
v_mfma_f32_32x32x16_bf16 v[56:71], v[212:215], v[28:31], v[56:71]
v_mfma_f32_32x32x16_bf16 v[56:71], v[216:219], v[32:35], v[56:71]
v_mfma_f32_32x32x16_bf16 v[56:71], v[220:223], v[36:39], v[56:71]
s_movk_i32 s64, 0x2000
s_nop 10
v_cvt_pk_bf16_f32 v73, v56, v40
v_lshlrev_b32 v72, 16, v73
v_and_b32 v73, 0xffff0000, v73
buffer_store_dword v72, v14, s[40:43], 0 offen offset:0 nt
buffer_store_dword v73, v14, s[40:43], s64 offen offset:0 nt
v_cvt_pk_bf16_f32 v75, v57, v41
v_lshlrev_b32 v74, 16, v75
v_and_b32 v75, 0xffff0000, v75
buffer_store_dword v74, v14, s[40:43], 0 offen offset:128 nt
buffer_store_dword v75, v14, s[40:43], s64 offen offset:128 nt
v_cvt_pk_bf16_f32 v77, v58, v42
v_lshlrev_b32 v76, 16, v77
v_and_b32 v77, 0xffff0000, v77
buffer_store_dword v76, v14, s[40:43], 0 offen offset:256 nt
buffer_store_dword v77, v14, s[40:43], s64 offen offset:256 nt
v_cvt_pk_bf16_f32 v79, v59, v43
v_lshlrev_b32 v78, 16, v79
v_and_b32 v79, 0xffff0000, v79
buffer_store_dword v78, v14, s[40:43], 0 offen offset:384 nt
buffer_store_dword v79, v14, s[40:43], s64 offen offset:384 nt
v_cvt_pk_bf16_f32 v81, v60, v44
v_lshlrev_b32 v80, 16, v81
v_and_b32 v81, 0xffff0000, v81
buffer_store_dword v80, v14, s[40:43], 0 offen offset:1024 nt
buffer_store_dword v81, v14, s[40:43], s64 offen offset:1024 nt
v_cvt_pk_bf16_f32 v83, v61, v45
v_lshlrev_b32 v82, 16, v83
v_and_b32 v83, 0xffff0000, v83
buffer_store_dword v82, v14, s[40:43], 0 offen offset:1152 nt
buffer_store_dword v83, v14, s[40:43], s64 offen offset:1152 nt
v_cvt_pk_bf16_f32 v85, v62, v46
v_lshlrev_b32 v84, 16, v85
v_and_b32 v85, 0xffff0000, v85
buffer_store_dword v84, v14, s[40:43], 0 offen offset:1280 nt
buffer_store_dword v85, v14, s[40:43], s64 offen offset:1280 nt
v_cvt_pk_bf16_f32 v87, v63, v47
v_lshlrev_b32 v86, 16, v87
v_and_b32 v87, 0xffff0000, v87
buffer_store_dword v86, v14, s[40:43], 0 offen offset:1408 nt
buffer_store_dword v87, v14, s[40:43], s64 offen offset:1408 nt
v_cvt_pk_bf16_f32 v89, v64, v48
v_lshlrev_b32 v88, 16, v89
v_and_b32 v89, 0xffff0000, v89
buffer_store_dword v88, v14, s[40:43], 0 offen offset:2048 nt
buffer_store_dword v89, v14, s[40:43], s64 offen offset:2048 nt
v_cvt_pk_bf16_f32 v91, v65, v49
v_lshlrev_b32 v90, 16, v91
v_and_b32 v91, 0xffff0000, v91
buffer_store_dword v90, v14, s[40:43], 0 offen offset:2176 nt
buffer_store_dword v91, v14, s[40:43], s64 offen offset:2176 nt
v_cvt_pk_bf16_f32 v93, v66, v50
v_lshlrev_b32 v92, 16, v93
v_and_b32 v93, 0xffff0000, v93
buffer_store_dword v92, v14, s[40:43], 0 offen offset:2304 nt
buffer_store_dword v93, v14, s[40:43], s64 offen offset:2304 nt
v_cvt_pk_bf16_f32 v95, v67, v51
v_lshlrev_b32 v94, 16, v95
v_and_b32 v95, 0xffff0000, v95
buffer_store_dword v94, v14, s[40:43], 0 offen offset:2432 nt
buffer_store_dword v95, v14, s[40:43], s64 offen offset:2432 nt
v_cvt_pk_bf16_f32 v97, v68, v52
v_lshlrev_b32 v96, 16, v97
v_and_b32 v97, 0xffff0000, v97
buffer_store_dword v96, v14, s[40:43], 0 offen offset:3072 nt
buffer_store_dword v97, v14, s[40:43], s64 offen offset:3072 nt
v_cvt_pk_bf16_f32 v99, v69, v53
v_lshlrev_b32 v98, 16, v99
v_and_b32 v99, 0xffff0000, v99
buffer_store_dword v98, v14, s[40:43], 0 offen offset:3200 nt
buffer_store_dword v99, v14, s[40:43], s64 offen offset:3200 nt
v_cvt_pk_bf16_f32 v101, v70, v54
v_lshlrev_b32 v100, 16, v101
v_and_b32 v101, 0xffff0000, v101
buffer_store_dword v100, v14, s[40:43], 0 offen offset:3328 nt
buffer_store_dword v101, v14, s[40:43], s64 offen offset:3328 nt
v_cvt_pk_bf16_f32 v103, v71, v55
v_lshlrev_b32 v102, 16, v103
v_and_b32 v103, 0xffff0000, v103
buffer_store_dword v102, v14, s[40:43], 0 offen offset:3456 nt
buffer_store_dword v103, v14, s[40:43], s64 offen offset:3456 nt
s_endpgm
L_concat_heads__spectral_gfnet__ssm_conv_s5__prompt_kernel_gemm:
s_lshr_b32 s68, s34, 1
s_and_b32 s66, s34, 1
s_lshr_b32 s101, s36, 3
v_and_b32 v6, 31, v1
v_lshrrev_b32 v5, 5, v1
v_lshlrev_b32 v11, 4, v1
v_mov_b64 v[64:65], 0
v_mov_b64 v[66:67], 0
s_mul_i32 s60, s34, 2304
s_add_u32 s60, s60, 114688
v_add_u32 v13, s60, v11
v_mov_b32 v12, 126976
ds_write_b128 v13, v[64:67]
ds_write_b128 v13, v[64:67] offset:1024
ds_write_b128 v13, v[64:67] offset:2048
s_mov_b64 exec, 1
ds_write_b128 v12, v[64:67]
ds_write_b128 v12, v[64:67] offset:16
ds_write_b128 v12, v[64:67] offset:32
ds_write_b128 v12, v[64:67] offset:48
ds_write_b128 v12, v[64:67] offset:64
s_mov_b64 exec, -1
s_lshl_b32 s60, s34, 2
v_add_u32 v13, s60, v12
s_waitcnt lgkmcnt(0)
s_barrier
v_bfe_u32 v4, v1, 2, 2
v_lshlrev_b32 v4, 3, v4
v_and_b32 v7, 3, v1
v_add_u32 v4, v4, v7
s_lshl_b32 s60, s36, 6
s_lshl_b32 s61, s66, 5
s_add_u32 s60, s60, s61
v_add_u32 v4, s60, v4
v_lshlrev_b32 v7, 1, v4
v_lshrrev_b32 v14, 5, v1
v_bfe_u32 v15, v1, 3, 2
v_and_b32 v16, 1, v15
v_lshrrev_b32 v17, 1, v15
v_lshlrev_b32 v18, 4, v14
v_lshl_add_u32 v18, v16, 3, v18
v_add_u32 v18, v18, v17
s_lshl_b32 s61, s68, 6
s_lshl_b32 s62, s66, 2
s_add_u32 s61, s61, s62
v_add_u32 v18, s61, v18
v_lshlrev_b32 v18, 11, v18
s_lshl_b32 s61, s68, 5
v_lshl_add_u32 v19, v14, 3, v15
v_add_u32 v19, s61, v19
v_lshlrev_b32 v19, 11, v19
v_and_b32 v16, 7, v1
v_lshrrev_b32 v17, 4, v1
v_xor_b32 v16, v16, v17
v_lshlrev_b32 v16, 4, v16
v_xor_b32 v17, 64, v16
v_add_u32 v244, v18, v16
v_add_u32 v245, v18, v17
v_add_u32 v245, 64512, v245
v_add_u32 v246, v19, v16
v_add_u32 v247, v19, v17
v_add_u32 v247, 31744, v247
s_bfe_u32 s38, s2, 0x20001
s_lshl_b32 s38, s38, 2
s_lshr_b32 s60, s2, 6
s_add_u32 s38, s38, s60
s_mul_i32 s38, s38, 128
s_mul_i32 s60, s36, 128
s_add_u32 s38, s38, s60
s_bfe_u32 s60, s38, 0x30007
s_cmp_eq_u32 s60, 3
s_cselect_b32 s60, 128, 0
s_add_u32 s38, s38, s60
s_lshl_b32 s60, s35, 18
s_lshl_b32 s61, s36, 17
s_lshl_b32 s39, s34, 12
s_waitcnt lgkmcnt(0)
global_load_ushort v248, v7, s[12:13] offset:0
global_load_ushort v249, v7, s[14:15] offset:0
global_load_ushort v250, v7, s[24:25] offset:0
global_load_ushort v251, v7, s[12:13] offset:8
global_load_ushort v252, v7, s[14:15] offset:8
global_load_ushort v253, v7, s[24:25] offset:8
s_add_u32 s48, s10, s60
s_addc_u32 s49, s11, 0
s_mov_b32 s50, 262144
s_mov_b32 s51, 0x20000
s_cmp_eq_u32 s66, 1
s_cselect_b32 s62, s18, s16
s_cselect_b32 s63, s19, s17
s_add_u32 s52, s62, s61
s_addc_u32 s53, s63, 0
s_mov_b32 s54, 131072
s_mov_b32 s55, 0x20000
s_add_u32 s62, s38, 0
s_and_b32 s62, s62, 0x7ff
s_add_u32 s63, s62, 2048
s_add_u32 s64, s62, 6144
s_add_u32 m0, s39, 0
s_nop 0
buffer_load_dwordx4 v244, s[48:51], s62 offen offset:0 lds
buffer_load_dwordx4 v245, s[48:51], s62 offen offset:1024 lds
buffer_load_dwordx4 v244, s[48:51], s63 offen offset:2048 lds
buffer_load_dwordx4 v245, s[48:51], s63 offen offset:3072 lds
s_add_u32 m0, s39, 16384
s_nop 0
buffer_load_dwordx4 v246, s[52:55], s62 offen offset:0 lds
buffer_load_dwordx4 v247, s[52:55], s62 offen offset:1024 lds
buffer_load_dwordx4 v246, s[52:55], s64 offen offset:2048 lds
buffer_load_dwordx4 v247, s[52:55], s64 offen offset:3072 lds
v_bfe_u32 v7, v1, 4, 1
v_lshl_add_u32 v4, v7, 2, v4
v_bfe_u32 v7, v6, 1, 3
v_xor_b32 v7, v7, v5
v_lshlrev_b32 v7, 4, v7
v_lshl_add_u32 v7, v6, 7, v7
v_and_b32 v8, 15, v1
v_lshrrev_b32 v9, 4, v1
v_lshrrev_b32 v14, 1, v8
v_xor_b32 v14, v14, v9
v_lshlrev_b32 v14, 4, v14
v_lshl_add_u32 v14, v8, 7, v14
s_lshl_b32 s60, s68, 13
s_lshl_b32 s61, s66, 13
s_add_u32 s61, s61, 16384
v_xor_b32 v15, 0, v14
v_add_u32 v128, s60, v15
v_add_u32 v130, s61, v15
v_add_u32 v132, 0x10000, v128
v_add_u32 v134, 0x10000, v130
v_xor_b32 v15, 64, v14
v_add_u32 v129, s60, v15
v_add_u32 v131, s61, v15
v_add_u32 v133, 0x10000, v129
v_add_u32 v135, 0x10000, v131
s_add_u32 s40, s32, 65536
s_addc_u32 s41, s33, 0
s_mov_b32 s42, 262144
s_mov_b32 s43, 0x20000
s_add_u32 s44, s32, 1048576
s_addc_u32 s45, s33, 0
s_mov_b32 s46, 8388608
s_mov_b32 s47, 0x20000
s_mul_i32 s60, s66, 4608
s_add_u32 s60, s60, 114752
s_lshl_b32 s61, s68, 5
s_add_u32 s61, s61, s60
v_mul_u32_u24 v14, 144, v6
v_add_u32 v14, s60, v14
v_lshl_add_u32 v14, v5, 5, v14
v_mul_u32_u24 v15, 144, v8
v_add_u32 v15, s61, v15
v_lshl_add_u32 v15, v9, 3, v15
s_lshl_b32 s60, s35, 14
v_lshl_add_u32 v16, v4, 4, s60
v_mov_b32 v17, 0x40000000
v_lshlrev_b32 v10, 14, v5
v_sub_u32 v10, v16, v10
v_subrev_u32 v136, 16384, v10
v_cmp_le_i32 vcc, 0, v136
s_nop 1
v_cndmask_b32 v136, v17, v136, vcc
v_subrev_u32 v137, 49152, v10
v_cmp_le_i32 vcc, 0, v137
s_nop 1
v_cndmask_b32 v137, v17, v137, vcc
v_subrev_u32 v138, 81920, v10
v_cmp_le_i32 vcc, 0, v138
s_nop 1
v_cndmask_b32 v138, v17, v138, vcc
v_subrev_u32 v139, 114688, v10
v_cmp_le_i32 vcc, 0, v139
s_nop 1
v_cndmask_b32 v139, v17, v139, vcc
v_subrev_u32 v140, 147456, v10
v_cmp_le_i32 vcc, 0, v140
s_nop 1
v_cndmask_b32 v140, v17, v140, vcc
v_subrev_u32 v141, 180224, v10
v_cmp_le_i32 vcc, 0, v141
s_nop 1
v_cndmask_b32 v141, v17, v141, vcc
v_subrev_u32 v142, 212992, v10
v_cmp_le_i32 vcc, 0, v142
s_nop 1
v_cndmask_b32 v142, v17, v142, vcc
v_subrev_u32 v143, 245760, v10
v_cmp_le_i32 vcc, 0, v143
s_nop 1
v_cndmask_b32 v143, v17, v143, vcc
v_lshlrev_b32 v17, 30, v5
v_or_b32 v16, v16, v17
s_lshl_b32 s60, s35, 11
s_add_u32 s60, s60, 32768
s_lshl_b32 s61, s36, 7
s_add_u32 s61, s61, s60
v_mov_b32 v195, s61
s_lshl_b32 s61, s101, 10
s_add_u32 s60, s60, s61
v_and_b32 v196, 7, v1
v_lshl_add_u32 v196, v196, 7, s60
s_lshl_b32 s60, s35, 1
s_add_u32 s60, s60, s68
s_lshl_b32 s60, s60, 12
s_add_u32 s60, s60, 393216
s_lshl_b32 s61, s101, 11
s_add_u32 s61, s61, s60
v_lshl_add_u32 v18, v8, 7, s61
s_lshl_b32 s61, s36, 8
s_add_u32 s60, s60, s61
s_lshl_b32 s61, s66, 7
s_add_u32 s60, s60, s61
v_mov_b32 v19, s60
v_lshrrev_b32 v10, 1, v9
v_lshlrev_b32 v10, 10, v10
v_and_b32 v17, 1, v9
v_lshl_add_u32 v10, v17, 9, v10
v_lshl_add_u32 v10, v8, 4, v10
s_lshl_b32 s60, s68, 2
v_add_u32 v9, s60, v9
v_cvt_f32_u32 v9, v9
v_mul_f32 v9, 0x41800000, v9
v_add_f32 v8, 0x41000000, v9
s_add_u32 s62, s38, 128
s_and_b32 s62, s62, 0x7ff
s_add_u32 s63, s62, 2048
s_add_u32 s64, s62, 6144
s_add_u32 m0, s39, 32768
s_nop 0
buffer_load_dwordx4 v244, s[48:51], s62 offen offset:0 lds
buffer_load_dwordx4 v245, s[48:51], s62 offen offset:1024 lds
buffer_load_dwordx4 v244, s[48:51], s63 offen offset:2048 lds
buffer_load_dwordx4 v245, s[48:51], s63 offen offset:3072 lds
s_add_u32 m0, s39, 49152
s_nop 0
buffer_load_dwordx4 v246, s[52:55], s62 offen offset:0 lds
buffer_load_dwordx4 v247, s[52:55], s62 offen offset:1024 lds
buffer_load_dwordx4 v246, s[52:55], s64 offen offset:2048 lds
buffer_load_dwordx4 v247, s[52:55], s64 offen offset:3072 lds
s_setprio 1
s_waitcnt vmcnt(8)
s_barrier
ds_read_b128 v[32:35], v128 offset:0
ds_read_b128 v[48:51], v130 offset:0
ds_read_b128 v[52:55], v130 offset:2048
ds_read_b128 v[56:59], v130 offset:4096
ds_read_b128 v[60:63], v130 offset:6144
ds_read_b128 v[36:39], v128 offset:2048
ds_read_b128 v[40:43], v128 offset:4096
ds_read_b128 v[44:47], v128 offset:6144
s_waitcnt lgkmcnt(6)
v_mfma_f32_16x16x32_bf16 v[64:67], v[32:35], v[48:51], 0
ds_read_b128 v[144:147], v129 offset:0
s_waitcnt lgkmcnt(6)
v_mfma_f32_16x16x32_bf16 v[96:99], v[32:35], v[52:55], 0
ds_read_b128 v[160:163], v131 offset:0
s_waitcnt lgkmcnt(6)
v_mfma_f32_16x16x32_bf16 v[80:83], v[32:35], v[56:59], 0
ds_read_b128 v[164:167], v131 offset:2048
s_waitcnt lgkmcnt(6)
v_mfma_f32_16x16x32_bf16 v[112:115], v[32:35], v[60:63], 0
ds_read_b128 v[168:171], v131 offset:4096
s_waitcnt lgkmcnt(6)
v_mfma_f32_16x16x32_bf16 v[68:71], v[36:39], v[48:51], 0
ds_read_b128 v[172:175], v131 offset:6144
v_mfma_f32_16x16x32_bf16 v[100:103], v[36:39], v[52:55], 0
ds_read_b128 v[148:151], v129 offset:2048
v_mfma_f32_16x16x32_bf16 v[84:87], v[36:39], v[56:59], 0
ds_read_b128 v[152:155], v129 offset:4096
v_mfma_f32_16x16x32_bf16 v[116:119], v[36:39], v[60:63], 0
ds_read_b128 v[156:159], v129 offset:6144
s_waitcnt lgkmcnt(9)
v_mfma_f32_16x16x32_bf16 v[72:75], v[40:43], v[48:51], 0
v_lshlrev_b32 v248, 16, v248
v_lshlrev_b32 v249, 16, v249
v_mfma_f32_16x16x32_bf16 v[104:107], v[40:43], v[52:55], 0
v_lshlrev_b32 v250, 16, v250
v_mul_f32 v250, 0x3fb8aa3b, v250
v_mfma_f32_16x16x32_bf16 v[88:91], v[40:43], v[56:59], 0
v_exp_f32 v250, v250
s_nop 0
v_cvt_pk_bf16_f32 v250, v250, v250
v_mfma_f32_16x16x32_bf16 v[120:123], v[40:43], v[60:63], 0
v_lshlrev_b32 v250, 16, v250
v_mul_f32 v204, v250, v248
s_waitcnt lgkmcnt(8)
v_mfma_f32_16x16x32_bf16 v[76:79], v[44:47], v[48:51], 0
v_mul_f32 v206, v250, v249
v_mul_f32 v204, 0x3fb8aa3b, v204
v_mfma_f32_16x16x32_bf16 v[108:111], v[44:47], v[52:55], 0
v_mul_f32 v206, 0.15915494, v206
v_mul_f32 v197, 0x3f800000, v204
v_mfma_f32_16x16x32_bf16 v[92:95], v[44:47], v[56:59], 0
v_mul_f32 v198, 0x3f800000, v206
v_exp_f32 v197, v197
v_mfma_f32_16x16x32_bf16 v[124:127], v[44:47], v[60:63], 0
v_rndne_f32 v199, v198
v_sub_f32 v198, v198, v199
s_waitcnt vmcnt(0) lgkmcnt(0)
s_barrier
v_mfma_f32_16x16x32_bf16 v[64:67], v[144:147], v[160:163], v[64:67]
ds_read_b128 v[32:35], v128 offset:32768
v_mfma_f32_16x16x32_bf16 v[96:99], v[144:147], v[164:167], v[96:99]
ds_read_b128 v[48:51], v130 offset:32768
v_mfma_f32_16x16x32_bf16 v[80:83], v[144:147], v[168:171], v[80:83]
ds_read_b128 v[52:55], v130 offset:34816
v_mfma_f32_16x16x32_bf16 v[112:115], v[144:147], v[172:175], v[112:115]
ds_read_b128 v[56:59], v130 offset:36864
v_mfma_f32_16x16x32_bf16 v[68:71], v[148:151], v[160:163], v[68:71]
ds_read_b128 v[60:63], v130 offset:38912
v_mfma_f32_16x16x32_bf16 v[100:103], v[148:151], v[164:167], v[100:103]
ds_read_b128 v[36:39], v128 offset:34816
v_mfma_f32_16x16x32_bf16 v[84:87], v[148:151], v[168:171], v[84:87]
ds_read_b128 v[40:43], v128 offset:36864
v_mfma_f32_16x16x32_bf16 v[116:119], v[148:151], v[172:175], v[116:119]
ds_read_b128 v[44:47], v128 offset:38912
v_mfma_f32_16x16x32_bf16 v[72:75], v[152:155], v[160:163], v[72:75]
v_cos_f32 v199, v198
v_sin_f32 v198, v198
v_mfma_f32_16x16x32_bf16 v[104:107], v[152:155], v[164:167], v[104:107]
v_mul_f32 v20, v197, v199
v_mul_f32 v21, v197, v198
v_mfma_f32_16x16x32_bf16 v[88:91], v[152:155], v[168:171], v[88:91]
v_add_f32 v197, -1.0, v20
v_mul_f32 v198, v248, v248
v_mfma_f32_16x16x32_bf16 v[120:123], v[152:155], v[172:175], v[120:123]
v_fma_f32 v198, v249, v249, v198
v_rcp_f32 v198, v198
v_mfma_f32_16x16x32_bf16 v[76:79], v[156:159], v[160:163], v[76:79]
v_add_f32 v198, v198, v198
v_mul_f32 v199, v197, v248
v_mfma_f32_16x16x32_bf16 v[108:111], v[156:159], v[164:167], v[108:111]
v_fma_f32 v199, v21, v249, v199
v_mul_f32 v24, v199, v198
v_mfma_f32_16x16x32_bf16 v[92:95], v[156:159], v[168:171], v[92:95]
v_mul_f32 v199, v21, v248
v_fma_f32 v199, -v197, v249, v199
v_mfma_f32_16x16x32_bf16 v[124:127], v[156:159], v[172:175], v[124:127]
v_mul_f32 v25, v199, v198
v_mul_f32 v197, 0x41000000, v204
s_waitcnt lgkmcnt(6)
v_mfma_f32_16x16x32_bf16 v[64:67], v[32:35], v[48:51], v[64:67]
ds_read_b128 v[144:147], v129 offset:32768
s_waitcnt lgkmcnt(6)
v_mfma_f32_16x16x32_bf16 v[96:99], v[32:35], v[52:55], v[96:99]
ds_read_b128 v[160:163], v131 offset:32768
s_waitcnt lgkmcnt(6)
v_mfma_f32_16x16x32_bf16 v[80:83], v[32:35], v[56:59], v[80:83]
ds_read_b128 v[164:167], v131 offset:34816
s_waitcnt lgkmcnt(6)
v_mfma_f32_16x16x32_bf16 v[112:115], v[32:35], v[60:63], v[112:115]
ds_read_b128 v[168:171], v131 offset:36864
s_waitcnt lgkmcnt(6)
v_mfma_f32_16x16x32_bf16 v[68:71], v[36:39], v[48:51], v[68:71]
ds_read_b128 v[172:175], v131 offset:38912
v_mfma_f32_16x16x32_bf16 v[100:103], v[36:39], v[52:55], v[100:103]
ds_read_b128 v[148:151], v129 offset:34816
v_mfma_f32_16x16x32_bf16 v[84:87], v[36:39], v[56:59], v[84:87]
ds_read_b128 v[152:155], v129 offset:36864
v_mfma_f32_16x16x32_bf16 v[116:119], v[36:39], v[60:63], v[116:119]
ds_read_b128 v[156:159], v129 offset:38912
s_waitcnt lgkmcnt(9)
v_mfma_f32_16x16x32_bf16 v[72:75], v[40:43], v[48:51], v[72:75]
v_mul_f32 v198, 0x41000000, v206
v_exp_f32 v197, v197
v_mfma_f32_16x16x32_bf16 v[104:107], v[40:43], v[52:55], v[104:107]
v_rndne_f32 v199, v198
v_sub_f32 v198, v198, v199
v_mfma_f32_16x16x32_bf16 v[88:91], v[40:43], v[56:59], v[88:91]
v_cos_f32 v199, v198
v_sin_f32 v198, v198
v_mfma_f32_16x16x32_bf16 v[120:123], v[40:43], v[60:63], v[120:123]
v_mul_f32 v176, v197, v199
v_mul_f32 v177, v197, v198
s_waitcnt lgkmcnt(8)
v_mfma_f32_16x16x32_bf16 v[76:79], v[44:47], v[48:51], v[76:79]
v_mul_f32 v197, 0x41800000, v204
v_mul_f32 v198, 0x41800000, v206
v_mfma_f32_16x16x32_bf16 v[108:111], v[44:47], v[52:55], v[108:111]
v_exp_f32 v197, v197
v_rndne_f32 v199, v198
v_mfma_f32_16x16x32_bf16 v[92:95], v[44:47], v[56:59], v[92:95]
v_sub_f32 v198, v198, v199
v_cos_f32 v199, v198
v_mfma_f32_16x16x32_bf16 v[124:127], v[44:47], v[60:63], v[124:127]
v_sin_f32 v198, v198
v_mul_f32 v180, v197, v199
s_waitcnt lgkmcnt(0)
s_barrier
v_mfma_f32_16x16x32_bf16 v[64:67], v[144:147], v[160:163], v[64:67]
ds_read_b128 v[32:35], v132 offset:0
v_mfma_f32_16x16x32_bf16 v[96:99], v[144:147], v[164:167], v[96:99]
ds_read_b128 v[48:51], v134 offset:0
v_mfma_f32_16x16x32_bf16 v[80:83], v[144:147], v[168:171], v[80:83]
ds_read_b128 v[52:55], v134 offset:2048
v_mfma_f32_16x16x32_bf16 v[112:115], v[144:147], v[172:175], v[112:115]
ds_read_b128 v[56:59], v134 offset:4096
v_mfma_f32_16x16x32_bf16 v[68:71], v[148:151], v[160:163], v[68:71]
ds_read_b128 v[60:63], v134 offset:6144
v_mfma_f32_16x16x32_bf16 v[100:103], v[148:151], v[164:167], v[100:103]
ds_read_b128 v[36:39], v132 offset:2048
v_mfma_f32_16x16x32_bf16 v[84:87], v[148:151], v[168:171], v[84:87]
ds_read_b128 v[40:43], v132 offset:4096
v_mfma_f32_16x16x32_bf16 v[116:119], v[148:151], v[172:175], v[116:119]
ds_read_b128 v[44:47], v132 offset:6144
v_mfma_f32_16x16x32_bf16 v[72:75], v[152:155], v[160:163], v[72:75]
v_mul_f32 v181, v197, v198
v_mul_f32 v197, v9, v204
v_mfma_f32_16x16x32_bf16 v[104:107], v[152:155], v[164:167], v[104:107]
v_mul_f32 v198, v9, v206
v_exp_f32 v197, v197
v_mfma_f32_16x16x32_bf16 v[88:91], v[152:155], v[168:171], v[88:91]
v_rndne_f32 v199, v198
v_sub_f32 v198, v198, v199
v_mfma_f32_16x16x32_bf16 v[120:123], v[152:155], v[172:175], v[120:123]
v_cos_f32 v199, v198
v_sin_f32 v198, v198
v_mfma_f32_16x16x32_bf16 v[76:79], v[156:159], v[160:163], v[76:79]
v_mul_f32 v200, v197, v199
v_mul_f32 v201, v197, v198
v_mfma_f32_16x16x32_bf16 v[108:111], v[156:159], v[164:167], v[108:111]
v_mov_b32 v184, v200
v_mov_b32 v186, v201
v_mfma_f32_16x16x32_bf16 v[92:95], v[156:159], v[168:171], v[92:95]
v_mul_f32 v197, v8, v204
v_mul_f32 v198, v8, v206
v_mfma_f32_16x16x32_bf16 v[124:127], v[156:159], v[172:175], v[124:127]
v_exp_f32 v197, v197
v_rndne_f32 v199, v198
s_waitcnt lgkmcnt(6)
v_mfma_f32_16x16x32_bf16 v[64:67], v[32:35], v[48:51], v[64:67]
ds_read_b128 v[144:147], v133 offset:0
s_waitcnt lgkmcnt(6)
v_mfma_f32_16x16x32_bf16 v[96:99], v[32:35], v[52:55], v[96:99]
ds_read_b128 v[160:163], v135 offset:0
s_waitcnt lgkmcnt(6)
v_mfma_f32_16x16x32_bf16 v[80:83], v[32:35], v[56:59], v[80:83]
ds_read_b128 v[164:167], v135 offset:2048
s_waitcnt lgkmcnt(6)
v_mfma_f32_16x16x32_bf16 v[112:115], v[32:35], v[60:63], v[112:115]
ds_read_b128 v[168:171], v135 offset:4096
s_waitcnt lgkmcnt(6)
v_mfma_f32_16x16x32_bf16 v[68:71], v[36:39], v[48:51], v[68:71]
ds_read_b128 v[172:175], v135 offset:6144
v_mfma_f32_16x16x32_bf16 v[100:103], v[36:39], v[52:55], v[100:103]
ds_read_b128 v[148:151], v133 offset:2048
v_mfma_f32_16x16x32_bf16 v[84:87], v[36:39], v[56:59], v[84:87]
ds_read_b128 v[152:155], v133 offset:4096
v_mfma_f32_16x16x32_bf16 v[116:119], v[36:39], v[60:63], v[116:119]
ds_read_b128 v[156:159], v133 offset:6144
s_waitcnt lgkmcnt(9)
v_mfma_f32_16x16x32_bf16 v[72:75], v[40:43], v[48:51], v[72:75]
v_sub_f32 v198, v198, v199
v_cos_f32 v199, v198
v_mfma_f32_16x16x32_bf16 v[104:107], v[40:43], v[52:55], v[104:107]
v_sin_f32 v198, v198
v_mul_f32 v200, v197, v199
v_mfma_f32_16x16x32_bf16 v[88:91], v[40:43], v[56:59], v[88:91]
v_mul_f32 v201, v197, v198
v_mov_b32 v185, v200
v_mfma_f32_16x16x32_bf16 v[120:123], v[40:43], v[60:63], v[120:123]
v_mov_b32 v187, v201
v_mul_f32 v197, v25, v21
s_waitcnt lgkmcnt(8)
v_mfma_f32_16x16x32_bf16 v[76:79], v[44:47], v[48:51], v[76:79]
v_mul_f32 v198, v25, v20
v_fma_f32 v208, v24, v20, -v197
v_mfma_f32_16x16x32_bf16 v[108:111], v[44:47], v[52:55], v[108:111]
v_fma_f32 v209, v24, v21, v198
v_mul_f32 v197, v209, v21
v_mfma_f32_16x16x32_bf16 v[92:95], v[44:47], v[56:59], v[92:95]
v_mul_f32 v198, v209, v20
v_fma_f32 v210, v208, v20, -v197
v_mfma_f32_16x16x32_bf16 v[124:127], v[44:47], v[60:63], v[124:127]
v_fma_f32 v211, v208, v21, v198
v_mul_f32 v197, v211, v21
s_waitcnt lgkmcnt(0)
s_barrier
v_mfma_f32_16x16x32_bf16 v[64:67], v[144:147], v[160:163], v[64:67]
ds_read_b128 v[32:35], v128 offset:0
v_mfma_f32_16x16x32_bf16 v[96:99], v[144:147], v[164:167], v[96:99]
ds_read_b128 v[48:51], v130 offset:0
v_mfma_f32_16x16x32_bf16 v[80:83], v[144:147], v[168:171], v[80:83]
ds_read_b128 v[52:55], v130 offset:2048
v_mfma_f32_16x16x32_bf16 v[112:115], v[144:147], v[172:175], v[112:115]
ds_read_b128 v[56:59], v130 offset:4096
v_mfma_f32_16x16x32_bf16 v[68:71], v[148:151], v[160:163], v[68:71]
ds_read_b128 v[60:63], v130 offset:6144
v_mfma_f32_16x16x32_bf16 v[100:103], v[148:151], v[164:167], v[100:103]
ds_read_b128 v[36:39], v128 offset:2048
v_mfma_f32_16x16x32_bf16 v[84:87], v[148:151], v[168:171], v[84:87]
ds_read_b128 v[40:43], v128 offset:4096
v_mfma_f32_16x16x32_bf16 v[116:119], v[148:151], v[172:175], v[116:119]
ds_read_b128 v[44:47], v128 offset:6144
v_mfma_f32_16x16x32_bf16 v[72:75], v[152:155], v[160:163], v[72:75]
v_mul_f32 v198, v211, v20
v_fma_f32 v212, v210, v20, -v197
v_mfma_f32_16x16x32_bf16 v[104:107], v[152:155], v[164:167], v[104:107]
v_fma_f32 v213, v210, v21, v198
v_mul_f32 v197, v213, v21
v_mfma_f32_16x16x32_bf16 v[88:91], v[152:155], v[168:171], v[88:91]
v_mul_f32 v198, v213, v20
v_fma_f32 v214, v212, v20, -v197
v_mfma_f32_16x16x32_bf16 v[120:123], v[152:155], v[172:175], v[120:123]
v_fma_f32 v215, v212, v21, v198
v_mul_f32 v197, v215, v21
v_mfma_f32_16x16x32_bf16 v[76:79], v[156:159], v[160:163], v[76:79]
v_mul_f32 v198, v215, v20
v_fma_f32 v216, v214, v20, -v197
v_mfma_f32_16x16x32_bf16 v[108:111], v[156:159], v[164:167], v[108:111]
v_fma_f32 v217, v214, v21, v198
v_mul_f32 v197, v217, v21
v_mfma_f32_16x16x32_bf16 v[92:95], v[156:159], v[168:171], v[92:95]
v_mul_f32 v198, v217, v20
v_fma_f32 v218, v216, v20, -v197
v_mfma_f32_16x16x32_bf16 v[124:127], v[156:159], v[172:175], v[124:127]
v_fma_f32 v219, v216, v21, v198
v_mul_f32 v197, v219, v21
s_waitcnt lgkmcnt(6)
v_mfma_f32_16x16x32_bf16 v[64:67], v[32:35], v[48:51], v[64:67]
ds_read_b128 v[144:147], v129 offset:0
s_waitcnt lgkmcnt(6)
v_mfma_f32_16x16x32_bf16 v[96:99], v[32:35], v[52:55], v[96:99]
ds_read_b128 v[160:163], v131 offset:0
s_waitcnt lgkmcnt(6)
v_mfma_f32_16x16x32_bf16 v[80:83], v[32:35], v[56:59], v[80:83]
ds_read_b128 v[164:167], v131 offset:2048
s_waitcnt lgkmcnt(6)
v_mfma_f32_16x16x32_bf16 v[112:115], v[32:35], v[60:63], v[112:115]
ds_read_b128 v[168:171], v131 offset:4096
s_waitcnt lgkmcnt(6)
v_mfma_f32_16x16x32_bf16 v[68:71], v[36:39], v[48:51], v[68:71]
ds_read_b128 v[172:175], v131 offset:6144
v_mfma_f32_16x16x32_bf16 v[100:103], v[36:39], v[52:55], v[100:103]
ds_read_b128 v[148:151], v129 offset:2048
v_mfma_f32_16x16x32_bf16 v[84:87], v[36:39], v[56:59], v[84:87]
ds_read_b128 v[152:155], v129 offset:4096
v_mfma_f32_16x16x32_bf16 v[116:119], v[36:39], v[60:63], v[116:119]
ds_read_b128 v[156:159], v129 offset:6144
s_waitcnt lgkmcnt(9)
v_mfma_f32_16x16x32_bf16 v[72:75], v[40:43], v[48:51], v[72:75]
v_mul_f32 v198, v219, v20
v_fma_f32 v220, v218, v20, -v197
v_mfma_f32_16x16x32_bf16 v[104:107], v[40:43], v[52:55], v[104:107]
v_fma_f32 v221, v218, v21, v198
v_mul_f32 v197, v221, v21
v_mfma_f32_16x16x32_bf16 v[88:91], v[40:43], v[56:59], v[88:91]
v_mul_f32 v198, v221, v20
v_fma_f32 v222, v220, v20, -v197
v_mfma_f32_16x16x32_bf16 v[120:123], v[40:43], v[60:63], v[120:123]
v_fma_f32 v223, v220, v21, v198
v_lshlrev_b32 v251, 16, v251
s_waitcnt lgkmcnt(8)
v_mfma_f32_16x16x32_bf16 v[76:79], v[44:47], v[48:51], v[76:79]
v_lshlrev_b32 v252, 16, v252
v_lshlrev_b32 v253, 16, v253
v_mfma_f32_16x16x32_bf16 v[108:111], v[44:47], v[52:55], v[108:111]
v_mul_f32 v253, 0x3fb8aa3b, v253
v_exp_f32 v253, v253
v_mfma_f32_16x16x32_bf16 v[92:95], v[44:47], v[56:59], v[92:95]
v_cvt_pk_bf16_f32 v253, v253, v253
v_lshlrev_b32 v253, 16, v253
v_mfma_f32_16x16x32_bf16 v[124:127], v[44:47], v[60:63], v[124:127]
v_mul_f32 v205, v253, v251
v_mul_f32 v207, v253, v252
s_waitcnt lgkmcnt(0)
s_barrier
v_mfma_f32_16x16x32_bf16 v[64:67], v[144:147], v[160:163], v[64:67]
ds_read_b128 v[32:35], v128 offset:32768
v_mfma_f32_16x16x32_bf16 v[96:99], v[144:147], v[164:167], v[96:99]
ds_read_b128 v[48:51], v130 offset:32768
v_mfma_f32_16x16x32_bf16 v[80:83], v[144:147], v[168:171], v[80:83]
ds_read_b128 v[52:55], v130 offset:34816
v_mfma_f32_16x16x32_bf16 v[112:115], v[144:147], v[172:175], v[112:115]
ds_read_b128 v[56:59], v130 offset:36864
v_mfma_f32_16x16x32_bf16 v[68:71], v[148:151], v[160:163], v[68:71]
ds_read_b128 v[60:63], v130 offset:38912
v_mfma_f32_16x16x32_bf16 v[100:103], v[148:151], v[164:167], v[100:103]
ds_read_b128 v[36:39], v128 offset:34816
v_mfma_f32_16x16x32_bf16 v[84:87], v[148:151], v[168:171], v[84:87]
ds_read_b128 v[40:43], v128 offset:36864
v_mfma_f32_16x16x32_bf16 v[116:119], v[148:151], v[172:175], v[116:119]
ds_read_b128 v[44:47], v128 offset:38912
v_mfma_f32_16x16x32_bf16 v[72:75], v[152:155], v[160:163], v[72:75]
v_mul_f32 v205, 0x3fb8aa3b, v205
v_mul_f32 v207, 0.15915494, v207
v_mfma_f32_16x16x32_bf16 v[104:107], v[152:155], v[164:167], v[104:107]
v_mul_f32 v197, 0x3f800000, v205
v_mul_f32 v198, 0x3f800000, v207
v_mfma_f32_16x16x32_bf16 v[88:91], v[152:155], v[168:171], v[88:91]
v_exp_f32 v197, v197
v_rndne_f32 v199, v198
v_mfma_f32_16x16x32_bf16 v[120:123], v[152:155], v[172:175], v[120:123]
v_sub_f32 v198, v198, v199
v_cos_f32 v199, v198
v_mfma_f32_16x16x32_bf16 v[76:79], v[156:159], v[160:163], v[76:79]
v_sin_f32 v198, v198
v_mul_f32 v22, v197, v199
v_mfma_f32_16x16x32_bf16 v[108:111], v[156:159], v[164:167], v[108:111]
v_mul_f32 v23, v197, v198
v_add_f32 v197, -1.0, v22
v_mfma_f32_16x16x32_bf16 v[92:95], v[156:159], v[168:171], v[92:95]
v_mul_f32 v198, v251, v251
v_fma_f32 v198, v252, v252, v198
v_mfma_f32_16x16x32_bf16 v[124:127], v[156:159], v[172:175], v[124:127]
v_rcp_f32 v198, v198
s_nop 0
v_add_f32 v198, v198, v198
s_waitcnt lgkmcnt(6)
v_mfma_f32_16x16x32_bf16 v[64:67], v[32:35], v[48:51], v[64:67]
ds_read_b128 v[144:147], v129 offset:32768
s_waitcnt lgkmcnt(6)
v_mfma_f32_16x16x32_bf16 v[96:99], v[32:35], v[52:55], v[96:99]
ds_read_b128 v[160:163], v131 offset:32768
s_waitcnt lgkmcnt(6)
v_mfma_f32_16x16x32_bf16 v[80:83], v[32:35], v[56:59], v[80:83]
ds_read_b128 v[164:167], v131 offset:34816
s_waitcnt lgkmcnt(6)
v_mfma_f32_16x16x32_bf16 v[112:115], v[32:35], v[60:63], v[112:115]
ds_read_b128 v[168:171], v131 offset:36864
s_waitcnt lgkmcnt(6)
v_mfma_f32_16x16x32_bf16 v[68:71], v[36:39], v[48:51], v[68:71]
ds_read_b128 v[172:175], v131 offset:38912
v_mfma_f32_16x16x32_bf16 v[100:103], v[36:39], v[52:55], v[100:103]
ds_read_b128 v[148:151], v129 offset:34816
v_mfma_f32_16x16x32_bf16 v[84:87], v[36:39], v[56:59], v[84:87]
ds_read_b128 v[152:155], v129 offset:36864
v_mfma_f32_16x16x32_bf16 v[116:119], v[36:39], v[60:63], v[116:119]
ds_read_b128 v[156:159], v129 offset:38912
s_waitcnt lgkmcnt(9)
v_mfma_f32_16x16x32_bf16 v[72:75], v[40:43], v[48:51], v[72:75]
v_mul_f32 v199, v197, v251
v_fma_f32 v199, v23, v252, v199
v_mfma_f32_16x16x32_bf16 v[104:107], v[40:43], v[52:55], v[104:107]
v_mul_f32 v26, v199, v198
v_mul_f32 v199, v23, v251
v_mfma_f32_16x16x32_bf16 v[88:91], v[40:43], v[56:59], v[88:91]
v_fma_f32 v199, -v197, v252, v199
v_mul_f32 v27, v199, v198
v_mfma_f32_16x16x32_bf16 v[120:123], v[40:43], v[60:63], v[120:123]
v_mul_f32 v197, 0x41000000, v205
v_mul_f32 v198, 0x41000000, v207
s_waitcnt lgkmcnt(8)
v_mfma_f32_16x16x32_bf16 v[76:79], v[44:47], v[48:51], v[76:79]
v_exp_f32 v197, v197
v_rndne_f32 v199, v198
v_mfma_f32_16x16x32_bf16 v[108:111], v[44:47], v[52:55], v[108:111]
v_sub_f32 v198, v198, v199
v_cos_f32 v199, v198
v_mfma_f32_16x16x32_bf16 v[92:95], v[44:47], v[56:59], v[92:95]
v_sin_f32 v198, v198
v_mul_f32 v178, v197, v199
v_mfma_f32_16x16x32_bf16 v[124:127], v[44:47], v[60:63], v[124:127]
v_mul_f32 v179, v197, v198
v_mul_f32 v197, 0x41800000, v205
s_waitcnt lgkmcnt(0)
s_barrier
v_mfma_f32_16x16x32_bf16 v[64:67], v[144:147], v[160:163], v[64:67]
ds_read_b128 v[32:35], v132 offset:0
v_mfma_f32_16x16x32_bf16 v[96:99], v[144:147], v[164:167], v[96:99]
ds_read_b128 v[48:51], v134 offset:0
v_mfma_f32_16x16x32_bf16 v[80:83], v[144:147], v[168:171], v[80:83]
ds_read_b128 v[52:55], v134 offset:2048
v_mfma_f32_16x16x32_bf16 v[112:115], v[144:147], v[172:175], v[112:115]
ds_read_b128 v[56:59], v134 offset:4096
v_mfma_f32_16x16x32_bf16 v[68:71], v[148:151], v[160:163], v[68:71]
ds_read_b128 v[60:63], v134 offset:6144
v_mfma_f32_16x16x32_bf16 v[100:103], v[148:151], v[164:167], v[100:103]
ds_read_b128 v[36:39], v132 offset:2048
v_mfma_f32_16x16x32_bf16 v[84:87], v[148:151], v[168:171], v[84:87]
ds_read_b128 v[40:43], v132 offset:4096
v_mfma_f32_16x16x32_bf16 v[116:119], v[148:151], v[172:175], v[116:119]
ds_read_b128 v[44:47], v132 offset:6144
v_mfma_f32_16x16x32_bf16 v[72:75], v[152:155], v[160:163], v[72:75]
v_mul_f32 v198, 0x41800000, v207
v_exp_f32 v197, v197
v_mfma_f32_16x16x32_bf16 v[104:107], v[152:155], v[164:167], v[104:107]
v_rndne_f32 v199, v198
v_sub_f32 v198, v198, v199
v_mfma_f32_16x16x32_bf16 v[88:91], v[152:155], v[168:171], v[88:91]
v_cos_f32 v199, v198
v_sin_f32 v198, v198
v_mfma_f32_16x16x32_bf16 v[120:123], v[152:155], v[172:175], v[120:123]
v_mul_f32 v182, v197, v199
v_mul_f32 v183, v197, v198
v_mfma_f32_16x16x32_bf16 v[76:79], v[156:159], v[160:163], v[76:79]
v_mul_f32 v197, v9, v205
v_mul_f32 v198, v9, v207
v_mfma_f32_16x16x32_bf16 v[108:111], v[156:159], v[164:167], v[108:111]
v_exp_f32 v197, v197
v_rndne_f32 v199, v198
v_mfma_f32_16x16x32_bf16 v[92:95], v[156:159], v[168:171], v[92:95]
v_sub_f32 v198, v198, v199
v_cos_f32 v199, v198
v_mfma_f32_16x16x32_bf16 v[124:127], v[156:159], v[172:175], v[124:127]
v_sin_f32 v198, v198
v_mul_f32 v200, v197, v199
s_waitcnt lgkmcnt(6)
v_mfma_f32_16x16x32_bf16 v[64:67], v[32:35], v[48:51], v[64:67]
ds_read_b128 v[144:147], v133 offset:0
s_waitcnt lgkmcnt(6)
v_mfma_f32_16x16x32_bf16 v[96:99], v[32:35], v[52:55], v[96:99]
ds_read_b128 v[160:163], v135 offset:0
s_waitcnt lgkmcnt(6)
v_mfma_f32_16x16x32_bf16 v[80:83], v[32:35], v[56:59], v[80:83]
ds_read_b128 v[164:167], v135 offset:2048
s_waitcnt lgkmcnt(6)
v_mfma_f32_16x16x32_bf16 v[112:115], v[32:35], v[60:63], v[112:115]
ds_read_b128 v[168:171], v135 offset:4096
s_waitcnt lgkmcnt(6)
v_mfma_f32_16x16x32_bf16 v[68:71], v[36:39], v[48:51], v[68:71]
ds_read_b128 v[172:175], v135 offset:6144
v_mfma_f32_16x16x32_bf16 v[100:103], v[36:39], v[52:55], v[100:103]
ds_read_b128 v[148:151], v133 offset:2048
v_mfma_f32_16x16x32_bf16 v[84:87], v[36:39], v[56:59], v[84:87]
ds_read_b128 v[152:155], v133 offset:4096
v_mfma_f32_16x16x32_bf16 v[116:119], v[36:39], v[60:63], v[116:119]
ds_read_b128 v[156:159], v133 offset:6144
s_waitcnt lgkmcnt(9)
v_mfma_f32_16x16x32_bf16 v[72:75], v[40:43], v[48:51], v[72:75]
v_mul_f32 v201, v197, v198
v_mov_b32 v188, v200
v_mfma_f32_16x16x32_bf16 v[104:107], v[40:43], v[52:55], v[104:107]
v_mov_b32 v190, v201
v_mul_f32 v197, v8, v205
v_mfma_f32_16x16x32_bf16 v[88:91], v[40:43], v[56:59], v[88:91]
v_mul_f32 v198, v8, v207
v_exp_f32 v197, v197
v_mfma_f32_16x16x32_bf16 v[120:123], v[40:43], v[60:63], v[120:123]
v_rndne_f32 v199, v198
v_sub_f32 v198, v198, v199
s_waitcnt lgkmcnt(8)
v_mfma_f32_16x16x32_bf16 v[76:79], v[44:47], v[48:51], v[76:79]
v_cos_f32 v199, v198
v_sin_f32 v198, v198
v_mfma_f32_16x16x32_bf16 v[108:111], v[44:47], v[52:55], v[108:111]
v_mul_f32 v200, v197, v199
v_mul_f32 v201, v197, v198
v_mfma_f32_16x16x32_bf16 v[92:95], v[44:47], v[56:59], v[92:95]
v_mov_b32 v189, v200
v_mov_b32 v191, v201
v_mfma_f32_16x16x32_bf16 v[124:127], v[44:47], v[60:63], v[124:127]
v_mul_f32 v197, v27, v23
v_mul_f32 v198, v27, v22
s_waitcnt lgkmcnt(0)
s_barrier
v_mfma_f32_16x16x32_bf16 v[64:67], v[144:147], v[160:163], v[64:67]
ds_read_b128 v[32:35], v128 offset:0
v_mfma_f32_16x16x32_bf16 v[96:99], v[144:147], v[164:167], v[96:99]
ds_read_b128 v[48:51], v130 offset:0
v_mfma_f32_16x16x32_bf16 v[80:83], v[144:147], v[168:171], v[80:83]
ds_read_b128 v[52:55], v130 offset:2048
v_mfma_f32_16x16x32_bf16 v[112:115], v[144:147], v[172:175], v[112:115]
ds_read_b128 v[56:59], v130 offset:4096
v_mfma_f32_16x16x32_bf16 v[68:71], v[148:151], v[160:163], v[68:71]
ds_read_b128 v[60:63], v130 offset:6144
v_mfma_f32_16x16x32_bf16 v[100:103], v[148:151], v[164:167], v[100:103]
ds_read_b128 v[36:39], v128 offset:2048
v_mfma_f32_16x16x32_bf16 v[84:87], v[148:151], v[168:171], v[84:87]
ds_read_b128 v[40:43], v128 offset:4096
v_mfma_f32_16x16x32_bf16 v[116:119], v[148:151], v[172:175], v[116:119]
ds_read_b128 v[44:47], v128 offset:6144
v_mfma_f32_16x16x32_bf16 v[72:75], v[152:155], v[160:163], v[72:75]
v_fma_f32 v224, v26, v22, -v197
v_fma_f32 v225, v26, v23, v198
v_mfma_f32_16x16x32_bf16 v[104:107], v[152:155], v[164:167], v[104:107]
v_mul_f32 v197, v225, v23
v_mul_f32 v198, v225, v22
v_mfma_f32_16x16x32_bf16 v[88:91], v[152:155], v[168:171], v[88:91]
v_fma_f32 v226, v224, v22, -v197
v_fma_f32 v227, v224, v23, v198
v_mfma_f32_16x16x32_bf16 v[120:123], v[152:155], v[172:175], v[120:123]
v_mul_f32 v197, v227, v23
v_mul_f32 v198, v227, v22
v_mfma_f32_16x16x32_bf16 v[76:79], v[156:159], v[160:163], v[76:79]
v_fma_f32 v228, v226, v22, -v197
v_fma_f32 v229, v226, v23, v198
v_mfma_f32_16x16x32_bf16 v[108:111], v[156:159], v[164:167], v[108:111]
v_mul_f32 v197, v229, v23
v_mul_f32 v198, v229, v22
v_mfma_f32_16x16x32_bf16 v[92:95], v[156:159], v[168:171], v[92:95]
v_fma_f32 v230, v228, v22, -v197
v_fma_f32 v231, v228, v23, v198
v_mfma_f32_16x16x32_bf16 v[124:127], v[156:159], v[172:175], v[124:127]
v_mul_f32 v197, v231, v23
v_mul_f32 v198, v231, v22
s_waitcnt lgkmcnt(6)
v_mfma_f32_16x16x32_bf16 v[64:67], v[32:35], v[48:51], v[64:67]
ds_read_b128 v[144:147], v129 offset:0
s_waitcnt lgkmcnt(6)
v_mfma_f32_16x16x32_bf16 v[96:99], v[32:35], v[52:55], v[96:99]
ds_read_b128 v[160:163], v131 offset:0
s_waitcnt lgkmcnt(6)
v_mfma_f32_16x16x32_bf16 v[80:83], v[32:35], v[56:59], v[80:83]
ds_read_b128 v[164:167], v131 offset:2048
s_waitcnt lgkmcnt(6)
v_mfma_f32_16x16x32_bf16 v[112:115], v[32:35], v[60:63], v[112:115]
ds_read_b128 v[168:171], v131 offset:4096
s_waitcnt lgkmcnt(6)
v_mfma_f32_16x16x32_bf16 v[68:71], v[36:39], v[48:51], v[68:71]
ds_read_b128 v[172:175], v131 offset:6144
v_mfma_f32_16x16x32_bf16 v[100:103], v[36:39], v[52:55], v[100:103]
ds_read_b128 v[148:151], v129 offset:2048
v_mfma_f32_16x16x32_bf16 v[84:87], v[36:39], v[56:59], v[84:87]
ds_read_b128 v[152:155], v129 offset:4096
v_mfma_f32_16x16x32_bf16 v[116:119], v[36:39], v[60:63], v[116:119]
ds_read_b128 v[156:159], v129 offset:6144
s_waitcnt lgkmcnt(9)
v_mfma_f32_16x16x32_bf16 v[72:75], v[40:43], v[48:51], v[72:75]
v_fma_f32 v232, v230, v22, -v197
v_fma_f32 v233, v230, v23, v198
v_mfma_f32_16x16x32_bf16 v[104:107], v[40:43], v[52:55], v[104:107]
v_mul_f32 v197, v233, v23
v_mul_f32 v198, v233, v22
v_mfma_f32_16x16x32_bf16 v[88:91], v[40:43], v[56:59], v[88:91]
v_fma_f32 v234, v232, v22, -v197
v_fma_f32 v235, v232, v23, v198
v_mfma_f32_16x16x32_bf16 v[120:123], v[40:43], v[60:63], v[120:123]
v_mul_f32 v197, v235, v23
v_mul_f32 v198, v235, v22
s_waitcnt lgkmcnt(8)
v_mfma_f32_16x16x32_bf16 v[76:79], v[44:47], v[48:51], v[76:79]
v_fma_f32 v236, v234, v22, -v197
v_fma_f32 v237, v234, v23, v198
v_mfma_f32_16x16x32_bf16 v[108:111], v[44:47], v[52:55], v[108:111]
v_mul_f32 v197, v237, v23
v_mul_f32 v198, v237, v22
v_mfma_f32_16x16x32_bf16 v[92:95], v[44:47], v[56:59], v[92:95]
v_fma_f32 v238, v236, v22, -v197
v_fma_f32 v239, v236, v23, v198
v_mfma_f32_16x16x32_bf16 v[124:127], v[44:47], v[60:63], v[124:127]
v_and_b32 v197, 16, v1
v_cmp_ne_u32 vcc, 0, v197
s_waitcnt lgkmcnt(0)
s_barrier
v_mfma_f32_16x16x32_bf16 v[64:67], v[144:147], v[160:163], v[64:67]
ds_read_b128 v[32:35], v128 offset:32768
v_mfma_f32_16x16x32_bf16 v[96:99], v[144:147], v[164:167], v[96:99]
ds_read_b128 v[48:51], v130 offset:32768
v_mfma_f32_16x16x32_bf16 v[80:83], v[144:147], v[168:171], v[80:83]
ds_read_b128 v[52:55], v130 offset:34816
v_mfma_f32_16x16x32_bf16 v[112:115], v[144:147], v[172:175], v[112:115]
ds_read_b128 v[56:59], v130 offset:36864
v_mfma_f32_16x16x32_bf16 v[68:71], v[148:151], v[160:163], v[68:71]
ds_read_b128 v[60:63], v130 offset:38912
v_mfma_f32_16x16x32_bf16 v[100:103], v[148:151], v[164:167], v[100:103]
ds_read_b128 v[36:39], v128 offset:34816
v_mfma_f32_16x16x32_bf16 v[84:87], v[148:151], v[168:171], v[84:87]
ds_read_b128 v[40:43], v128 offset:36864
v_mfma_f32_16x16x32_bf16 v[116:119], v[148:151], v[172:175], v[116:119]
ds_read_b128 v[44:47], v128 offset:38912
v_mfma_f32_16x16x32_bf16 v[72:75], v[152:155], v[160:163], v[72:75]
v_cndmask_b32 v204, v204, v205, vcc
v_cndmask_b32 v206, v206, v207, vcc
v_mfma_f32_16x16x32_bf16 v[104:107], v[152:155], v[164:167], v[104:107]
v_mul_f32 v197, 0x41800000, v204
v_mul_f32 v198, 0x41800000, v206
v_mfma_f32_16x16x32_bf16 v[88:91], v[152:155], v[168:171], v[88:91]
v_exp_f32 v197, v197
v_rndne_f32 v199, v198
v_mfma_f32_16x16x32_bf16 v[120:123], v[152:155], v[172:175], v[120:123]
v_sub_f32 v198, v198, v199
v_cos_f32 v199, v198
v_mfma_f32_16x16x32_bf16 v[76:79], v[156:159], v[160:163], v[76:79]
v_sin_f32 v198, v198
v_mul_f32 v28, v197, v199
v_mfma_f32_16x16x32_bf16 v[108:111], v[156:159], v[164:167], v[108:111]
v_mul_f32 v29, v197, v198
v_mul_f32 v197, 0x42800000, v204
v_mfma_f32_16x16x32_bf16 v[92:95], v[156:159], v[168:171], v[92:95]
v_mul_f32 v198, 0x42800000, v206
v_exp_f32 v197, v197
v_mfma_f32_16x16x32_bf16 v[124:127], v[156:159], v[172:175], v[124:127]
v_rndne_f32 v199, v198
v_sub_f32 v198, v198, v199
s_waitcnt lgkmcnt(6)
v_mfma_f32_16x16x32_bf16 v[64:67], v[32:35], v[48:51], v[64:67]
ds_read_b128 v[144:147], v129 offset:32768
s_waitcnt lgkmcnt(6)
v_mfma_f32_16x16x32_bf16 v[96:99], v[32:35], v[52:55], v[96:99]
ds_read_b128 v[160:163], v131 offset:32768
s_waitcnt lgkmcnt(6)
v_mfma_f32_16x16x32_bf16 v[80:83], v[32:35], v[56:59], v[80:83]
ds_read_b128 v[164:167], v131 offset:34816
s_waitcnt lgkmcnt(6)
v_mfma_f32_16x16x32_bf16 v[112:115], v[32:35], v[60:63], v[112:115]
ds_read_b128 v[168:171], v131 offset:36864
s_waitcnt lgkmcnt(6)
v_mfma_f32_16x16x32_bf16 v[68:71], v[36:39], v[48:51], v[68:71]
ds_read_b128 v[172:175], v131 offset:38912
v_mfma_f32_16x16x32_bf16 v[100:103], v[36:39], v[52:55], v[100:103]
ds_read_b128 v[148:151], v129 offset:34816
v_mfma_f32_16x16x32_bf16 v[84:87], v[36:39], v[56:59], v[84:87]
ds_read_b128 v[152:155], v129 offset:36864
v_mfma_f32_16x16x32_bf16 v[116:119], v[36:39], v[60:63], v[116:119]
ds_read_b128 v[156:159], v129 offset:38912
s_waitcnt lgkmcnt(9)
v_mfma_f32_16x16x32_bf16 v[72:75], v[40:43], v[48:51], v[72:75]
v_cos_f32 v199, v198
v_sin_f32 v198, v198
v_mfma_f32_16x16x32_bf16 v[104:107], v[40:43], v[52:55], v[104:107]
v_mul_f32 v192, v197, v199
v_mul_f32 v193, v197, v198
v_mfma_f32_16x16x32_bf16 v[88:91], v[40:43], v[56:59], v[88:91]
v_mul_f32 v197, 0x43000000, v204
v_mul_f32 v198, 0x43000000, v206
v_mfma_f32_16x16x32_bf16 v[120:123], v[40:43], v[60:63], v[120:123]
v_exp_f32 v197, v197
v_rndne_f32 v199, v198
s_waitcnt lgkmcnt(8)
v_mfma_f32_16x16x32_bf16 v[76:79], v[44:47], v[48:51], v[76:79]
v_sub_f32 v198, v198, v199
v_cos_f32 v199, v198
v_mfma_f32_16x16x32_bf16 v[108:111], v[44:47], v[52:55], v[108:111]
v_sin_f32 v198, v198
v_mul_f32 v30, v197, v199
v_mfma_f32_16x16x32_bf16 v[92:95], v[44:47], v[56:59], v[92:95]
v_mul_f32 v31, v197, v198
v_mul_f32 v197, 0x43800000, v204
v_mfma_f32_16x16x32_bf16 v[124:127], v[44:47], v[60:63], v[124:127]
v_mul_f32 v198, 0x43800000, v206
v_exp_f32 v197, v197
s_waitcnt lgkmcnt(0)
s_barrier
v_mfma_f32_16x16x32_bf16 v[64:67], v[144:147], v[160:163], v[64:67]
ds_read_b128 v[32:35], v132 offset:0
v_mfma_f32_16x16x32_bf16 v[96:99], v[144:147], v[164:167], v[96:99]
ds_read_b128 v[48:51], v134 offset:0
v_mfma_f32_16x16x32_bf16 v[80:83], v[144:147], v[168:171], v[80:83]
ds_read_b128 v[52:55], v134 offset:2048
v_mfma_f32_16x16x32_bf16 v[112:115], v[144:147], v[172:175], v[112:115]
ds_read_b128 v[56:59], v134 offset:4096
v_mfma_f32_16x16x32_bf16 v[68:71], v[148:151], v[160:163], v[68:71]
ds_read_b128 v[60:63], v134 offset:6144
v_mfma_f32_16x16x32_bf16 v[100:103], v[148:151], v[164:167], v[100:103]
ds_read_b128 v[36:39], v132 offset:2048
v_mfma_f32_16x16x32_bf16 v[84:87], v[148:151], v[168:171], v[84:87]
ds_read_b128 v[40:43], v132 offset:4096
v_mfma_f32_16x16x32_bf16 v[116:119], v[148:151], v[172:175], v[116:119]
ds_read_b128 v[44:47], v132 offset:6144
v_mfma_f32_16x16x32_bf16 v[72:75], v[152:155], v[160:163], v[72:75]
v_rndne_f32 v199, v198
v_sub_f32 v198, v198, v199
v_mfma_f32_16x16x32_bf16 v[104:107], v[152:155], v[164:167], v[104:107]
v_cos_f32 v199, v198
v_sin_f32 v198, v198
v_mfma_f32_16x16x32_bf16 v[88:91], v[152:155], v[168:171], v[88:91]
v_mul_f32 v2, v197, v199
v_mul_f32 v3, v197, v198
v_mfma_f32_16x16x32_bf16 v[120:123], v[152:155], v[172:175], v[120:123]
v_lshrrev_b32 v197, 4, v1
v_lshlrev_b32 v197, 2, v197
v_mfma_f32_16x16x32_bf16 v[76:79], v[156:159], v[160:163], v[76:79]
v_and_b32 v198, 15, v1
v_sub_u32 v197, v198, v197
v_mfma_f32_16x16x32_bf16 v[108:111], v[156:159], v[164:167], v[108:111]
v_mov_b32 v198, 0x3f80
v_mov_b32 v199, 1.0
v_mfma_f32_16x16x32_bf16 v[92:95], v[156:159], v[168:171], v[92:95]
v_cmp_eq_u32 vcc, 0, v197
s_nop 1
v_cndmask_b32 v248, 0, v198, vcc
v_mfma_f32_16x16x32_bf16 v[124:127], v[156:159], v[172:175], v[124:127]
v_cndmask_b32 v252, 0, v199, vcc
v_cmp_eq_u32 vcc, 1, v197
s_waitcnt lgkmcnt(6)
v_mfma_f32_16x16x32_bf16 v[64:67], v[32:35], v[48:51], v[64:67]
ds_read_b128 v[144:147], v133 offset:0
s_waitcnt lgkmcnt(6)
v_mfma_f32_16x16x32_bf16 v[96:99], v[32:35], v[52:55], v[96:99]
ds_read_b128 v[160:163], v135 offset:0
s_waitcnt lgkmcnt(6)
v_mfma_f32_16x16x32_bf16 v[80:83], v[32:35], v[56:59], v[80:83]
ds_read_b128 v[164:167], v135 offset:2048
s_waitcnt lgkmcnt(6)
v_mfma_f32_16x16x32_bf16 v[112:115], v[32:35], v[60:63], v[112:115]
ds_read_b128 v[168:171], v135 offset:4096
s_waitcnt lgkmcnt(6)
v_mfma_f32_16x16x32_bf16 v[68:71], v[36:39], v[48:51], v[68:71]
ds_read_b128 v[172:175], v135 offset:6144
v_mfma_f32_16x16x32_bf16 v[100:103], v[36:39], v[52:55], v[100:103]
ds_read_b128 v[148:151], v133 offset:2048
v_mfma_f32_16x16x32_bf16 v[84:87], v[36:39], v[56:59], v[84:87]
ds_read_b128 v[152:155], v133 offset:4096
v_mfma_f32_16x16x32_bf16 v[116:119], v[36:39], v[60:63], v[116:119]
ds_read_b128 v[156:159], v133 offset:6144
s_waitcnt lgkmcnt(9)
v_mfma_f32_16x16x32_bf16 v[72:75], v[40:43], v[48:51], v[72:75]
v_cndmask_b32 v249, 0, v198, vcc
v_cndmask_b32 v253, 0, v199, vcc
v_mfma_f32_16x16x32_bf16 v[104:107], v[40:43], v[52:55], v[104:107]
v_cmp_eq_u32 vcc, 2, v197
s_nop 1
v_cndmask_b32 v250, 0, v198, vcc
v_mfma_f32_16x16x32_bf16 v[88:91], v[40:43], v[56:59], v[88:91]
v_cndmask_b32 v254, 0, v199, vcc
v_cmp_eq_u32 vcc, 3, v197
v_mfma_f32_16x16x32_bf16 v[120:123], v[40:43], v[60:63], v[120:123]
s_nop 0
v_cndmask_b32 v251, 0, v198, vcc
v_cndmask_b32 v255, 0, v199, vcc
s_waitcnt lgkmcnt(8)
v_mfma_f32_16x16x32_bf16 v[76:79], v[44:47], v[48:51], v[76:79]
v_mfma_f32_16x16x32_bf16 v[108:111], v[44:47], v[52:55], v[108:111]
v_mfma_f32_16x16x32_bf16 v[92:95], v[44:47], v[56:59], v[92:95]
v_mfma_f32_16x16x32_bf16 v[124:127], v[44:47], v[60:63], v[124:127]
s_waitcnt lgkmcnt(0)
s_barrier
v_mfma_f32_16x16x32_bf16 v[64:67], v[144:147], v[160:163], v[64:67]
ds_read_b128 v[32:35], v128 offset:0
v_mfma_f32_16x16x32_bf16 v[96:99], v[144:147], v[164:167], v[96:99]
ds_read_b128 v[48:51], v130 offset:0
v_mfma_f32_16x16x32_bf16 v[80:83], v[144:147], v[168:171], v[80:83]
ds_read_b128 v[52:55], v130 offset:2048
v_mfma_f32_16x16x32_bf16 v[112:115], v[144:147], v[172:175], v[112:115]
ds_read_b128 v[56:59], v130 offset:4096
v_mfma_f32_16x16x32_bf16 v[68:71], v[148:151], v[160:163], v[68:71]
ds_read_b128 v[60:63], v130 offset:6144
v_mfma_f32_16x16x32_bf16 v[100:103], v[148:151], v[164:167], v[100:103]
ds_read_b128 v[36:39], v128 offset:2048
v_mfma_f32_16x16x32_bf16 v[84:87], v[148:151], v[168:171], v[84:87]
ds_read_b128 v[40:43], v128 offset:4096
v_mfma_f32_16x16x32_bf16 v[116:119], v[148:151], v[172:175], v[116:119]
ds_read_b128 v[44:47], v128 offset:6144
v_mfma_f32_16x16x32_bf16 v[72:75], v[152:155], v[160:163], v[72:75]
v_mfma_f32_16x16x32_bf16 v[104:107], v[152:155], v[164:167], v[104:107]
v_mfma_f32_16x16x32_bf16 v[88:91], v[152:155], v[168:171], v[88:91]
v_mfma_f32_16x16x32_bf16 v[120:123], v[152:155], v[172:175], v[120:123]
v_mfma_f32_16x16x32_bf16 v[76:79], v[156:159], v[160:163], v[76:79]
v_mfma_f32_16x16x32_bf16 v[108:111], v[156:159], v[164:167], v[108:111]
v_mfma_f32_16x16x32_bf16 v[92:95], v[156:159], v[168:171], v[92:95]
v_mfma_f32_16x16x32_bf16 v[124:127], v[156:159], v[172:175], v[124:127]
s_waitcnt lgkmcnt(6)
v_mfma_f32_16x16x32_bf16 v[64:67], v[32:35], v[48:51], v[64:67]
ds_read_b128 v[144:147], v129 offset:0
s_waitcnt lgkmcnt(6)
v_mfma_f32_16x16x32_bf16 v[96:99], v[32:35], v[52:55], v[96:99]
ds_read_b128 v[160:163], v131 offset:0
s_waitcnt lgkmcnt(6)
v_mfma_f32_16x16x32_bf16 v[80:83], v[32:35], v[56:59], v[80:83]
ds_read_b128 v[164:167], v131 offset:2048
s_waitcnt lgkmcnt(6)
v_mfma_f32_16x16x32_bf16 v[112:115], v[32:35], v[60:63], v[112:115]
ds_read_b128 v[168:171], v131 offset:4096
s_waitcnt lgkmcnt(6)
v_mfma_f32_16x16x32_bf16 v[68:71], v[36:39], v[48:51], v[68:71]
ds_read_b128 v[172:175], v131 offset:6144
v_mfma_f32_16x16x32_bf16 v[100:103], v[36:39], v[52:55], v[100:103]
ds_read_b128 v[148:151], v129 offset:2048
v_mfma_f32_16x16x32_bf16 v[84:87], v[36:39], v[56:59], v[84:87]
ds_read_b128 v[152:155], v129 offset:4096
v_mfma_f32_16x16x32_bf16 v[116:119], v[36:39], v[60:63], v[116:119]
ds_read_b128 v[156:159], v129 offset:6144
s_waitcnt lgkmcnt(9)
v_mfma_f32_16x16x32_bf16 v[72:75], v[40:43], v[48:51], v[72:75]
v_mfma_f32_16x16x32_bf16 v[104:107], v[40:43], v[52:55], v[104:107]
v_mfma_f32_16x16x32_bf16 v[88:91], v[40:43], v[56:59], v[88:91]
v_mfma_f32_16x16x32_bf16 v[120:123], v[40:43], v[60:63], v[120:123]
s_waitcnt lgkmcnt(8)
v_mfma_f32_16x16x32_bf16 v[76:79], v[44:47], v[48:51], v[76:79]
v_mfma_f32_16x16x32_bf16 v[108:111], v[44:47], v[52:55], v[108:111]
v_mfma_f32_16x16x32_bf16 v[92:95], v[44:47], v[56:59], v[92:95]
v_mfma_f32_16x16x32_bf16 v[124:127], v[44:47], v[60:63], v[124:127]
s_waitcnt lgkmcnt(0)
s_barrier
v_mfma_f32_16x16x32_bf16 v[64:67], v[144:147], v[160:163], v[64:67]
ds_read_b128 v[32:35], v128 offset:32768
v_mfma_f32_16x16x32_bf16 v[96:99], v[144:147], v[164:167], v[96:99]
ds_read_b128 v[48:51], v130 offset:32768
v_mfma_f32_16x16x32_bf16 v[80:83], v[144:147], v[168:171], v[80:83]
ds_read_b128 v[52:55], v130 offset:34816
v_mfma_f32_16x16x32_bf16 v[112:115], v[144:147], v[172:175], v[112:115]
ds_read_b128 v[56:59], v130 offset:36864
v_mfma_f32_16x16x32_bf16 v[68:71], v[148:151], v[160:163], v[68:71]
ds_read_b128 v[60:63], v130 offset:38912
v_mfma_f32_16x16x32_bf16 v[100:103], v[148:151], v[164:167], v[100:103]
ds_read_b128 v[36:39], v128 offset:34816
v_mfma_f32_16x16x32_bf16 v[84:87], v[148:151], v[168:171], v[84:87]
ds_read_b128 v[40:43], v128 offset:36864
v_mfma_f32_16x16x32_bf16 v[116:119], v[148:151], v[172:175], v[116:119]
ds_read_b128 v[44:47], v128 offset:38912
v_mfma_f32_16x16x32_bf16 v[72:75], v[152:155], v[160:163], v[72:75]
v_mfma_f32_16x16x32_bf16 v[104:107], v[152:155], v[164:167], v[104:107]
v_mfma_f32_16x16x32_bf16 v[88:91], v[152:155], v[168:171], v[88:91]
v_mfma_f32_16x16x32_bf16 v[120:123], v[152:155], v[172:175], v[120:123]
v_mfma_f32_16x16x32_bf16 v[76:79], v[156:159], v[160:163], v[76:79]
v_mfma_f32_16x16x32_bf16 v[108:111], v[156:159], v[164:167], v[108:111]
v_mfma_f32_16x16x32_bf16 v[92:95], v[156:159], v[168:171], v[92:95]
v_mfma_f32_16x16x32_bf16 v[124:127], v[156:159], v[172:175], v[124:127]
s_waitcnt lgkmcnt(6)
v_mfma_f32_16x16x32_bf16 v[64:67], v[32:35], v[48:51], v[64:67]
ds_read_b128 v[144:147], v129 offset:32768
s_waitcnt lgkmcnt(6)
v_mfma_f32_16x16x32_bf16 v[96:99], v[32:35], v[52:55], v[96:99]
ds_read_b128 v[160:163], v131 offset:32768
s_waitcnt lgkmcnt(6)
v_mfma_f32_16x16x32_bf16 v[80:83], v[32:35], v[56:59], v[80:83]
ds_read_b128 v[164:167], v131 offset:34816
s_waitcnt lgkmcnt(6)
v_mfma_f32_16x16x32_bf16 v[112:115], v[32:35], v[60:63], v[112:115]
ds_read_b128 v[168:171], v131 offset:36864
s_waitcnt lgkmcnt(6)
v_mfma_f32_16x16x32_bf16 v[68:71], v[36:39], v[48:51], v[68:71]
ds_read_b128 v[172:175], v131 offset:38912
v_mfma_f32_16x16x32_bf16 v[100:103], v[36:39], v[52:55], v[100:103]
ds_read_b128 v[148:151], v129 offset:34816
v_mfma_f32_16x16x32_bf16 v[84:87], v[36:39], v[56:59], v[84:87]
ds_read_b128 v[152:155], v129 offset:36864
v_mfma_f32_16x16x32_bf16 v[116:119], v[36:39], v[60:63], v[116:119]
ds_read_b128 v[156:159], v129 offset:38912
s_waitcnt lgkmcnt(9)
v_mfma_f32_16x16x32_bf16 v[72:75], v[40:43], v[48:51], v[72:75]
v_mfma_f32_16x16x32_bf16 v[104:107], v[40:43], v[52:55], v[104:107]
v_mfma_f32_16x16x32_bf16 v[88:91], v[40:43], v[56:59], v[88:91]
v_mfma_f32_16x16x32_bf16 v[120:123], v[40:43], v[60:63], v[120:123]
s_waitcnt lgkmcnt(8)
v_mfma_f32_16x16x32_bf16 v[76:79], v[44:47], v[48:51], v[76:79]
v_mfma_f32_16x16x32_bf16 v[108:111], v[44:47], v[52:55], v[108:111]
v_mfma_f32_16x16x32_bf16 v[92:95], v[44:47], v[56:59], v[92:95]
v_mfma_f32_16x16x32_bf16 v[124:127], v[44:47], v[60:63], v[124:127]
s_waitcnt lgkmcnt(0)
s_barrier
v_mfma_f32_16x16x32_bf16 v[64:67], v[144:147], v[160:163], v[64:67]
ds_read_b128 v[32:35], v132 offset:0
v_mfma_f32_16x16x32_bf16 v[96:99], v[144:147], v[164:167], v[96:99]
ds_read_b128 v[48:51], v134 offset:0
v_mfma_f32_16x16x32_bf16 v[80:83], v[144:147], v[168:171], v[80:83]
ds_read_b128 v[52:55], v134 offset:2048
v_mfma_f32_16x16x32_bf16 v[112:115], v[144:147], v[172:175], v[112:115]
ds_read_b128 v[56:59], v134 offset:4096
v_mfma_f32_16x16x32_bf16 v[68:71], v[148:151], v[160:163], v[68:71]
ds_read_b128 v[60:63], v134 offset:6144
v_mfma_f32_16x16x32_bf16 v[100:103], v[148:151], v[164:167], v[100:103]
ds_read_b128 v[36:39], v132 offset:2048
v_mfma_f32_16x16x32_bf16 v[84:87], v[148:151], v[168:171], v[84:87]
ds_read_b128 v[40:43], v132 offset:4096
v_mfma_f32_16x16x32_bf16 v[116:119], v[148:151], v[172:175], v[116:119]
ds_read_b128 v[44:47], v132 offset:6144
v_mfma_f32_16x16x32_bf16 v[72:75], v[152:155], v[160:163], v[72:75]
v_mfma_f32_16x16x32_bf16 v[104:107], v[152:155], v[164:167], v[104:107]
v_mfma_f32_16x16x32_bf16 v[88:91], v[152:155], v[168:171], v[88:91]
v_mfma_f32_16x16x32_bf16 v[120:123], v[152:155], v[172:175], v[120:123]
v_mfma_f32_16x16x32_bf16 v[76:79], v[156:159], v[160:163], v[76:79]
v_mfma_f32_16x16x32_bf16 v[108:111], v[156:159], v[164:167], v[108:111]
v_mfma_f32_16x16x32_bf16 v[92:95], v[156:159], v[168:171], v[92:95]
v_mfma_f32_16x16x32_bf16 v[124:127], v[156:159], v[172:175], v[124:127]
s_waitcnt lgkmcnt(6)
v_mfma_f32_16x16x32_bf16 v[64:67], v[32:35], v[48:51], v[64:67]
ds_read_b128 v[144:147], v133 offset:0
s_waitcnt lgkmcnt(6)
v_mfma_f32_16x16x32_bf16 v[96:99], v[32:35], v[52:55], v[96:99]
ds_read_b128 v[160:163], v135 offset:0
s_waitcnt lgkmcnt(6)
v_mfma_f32_16x16x32_bf16 v[80:83], v[32:35], v[56:59], v[80:83]
ds_read_b128 v[164:167], v135 offset:2048
s_waitcnt lgkmcnt(6)
v_mfma_f32_16x16x32_bf16 v[112:115], v[32:35], v[60:63], v[112:115]
ds_read_b128 v[168:171], v135 offset:4096
s_waitcnt lgkmcnt(6)
v_mfma_f32_16x16x32_bf16 v[68:71], v[36:39], v[48:51], v[68:71]
ds_read_b128 v[172:175], v135 offset:6144
v_mfma_f32_16x16x32_bf16 v[100:103], v[36:39], v[52:55], v[100:103]
ds_read_b128 v[148:151], v133 offset:2048
v_mfma_f32_16x16x32_bf16 v[84:87], v[36:39], v[56:59], v[84:87]
ds_read_b128 v[152:155], v133 offset:4096
v_mfma_f32_16x16x32_bf16 v[116:119], v[36:39], v[60:63], v[116:119]
ds_read_b128 v[156:159], v133 offset:6144
s_waitcnt lgkmcnt(9)
v_mfma_f32_16x16x32_bf16 v[72:75], v[40:43], v[48:51], v[72:75]
v_mfma_f32_16x16x32_bf16 v[104:107], v[40:43], v[52:55], v[104:107]
v_mfma_f32_16x16x32_bf16 v[88:91], v[40:43], v[56:59], v[88:91]
v_mfma_f32_16x16x32_bf16 v[120:123], v[40:43], v[60:63], v[120:123]
s_waitcnt lgkmcnt(8)
v_mfma_f32_16x16x32_bf16 v[76:79], v[44:47], v[48:51], v[76:79]
v_mfma_f32_16x16x32_bf16 v[108:111], v[44:47], v[52:55], v[108:111]
v_mfma_f32_16x16x32_bf16 v[92:95], v[44:47], v[56:59], v[92:95]
v_mfma_f32_16x16x32_bf16 v[124:127], v[44:47], v[60:63], v[124:127]
s_waitcnt lgkmcnt(0)
s_barrier
v_mfma_f32_16x16x32_bf16 v[64:67], v[144:147], v[160:163], v[64:67]
ds_read_b128 v[32:35], v128 offset:0
v_mfma_f32_16x16x32_bf16 v[96:99], v[144:147], v[164:167], v[96:99]
ds_read_b128 v[48:51], v130 offset:0
v_mfma_f32_16x16x32_bf16 v[80:83], v[144:147], v[168:171], v[80:83]
ds_read_b128 v[52:55], v130 offset:2048
v_mfma_f32_16x16x32_bf16 v[112:115], v[144:147], v[172:175], v[112:115]
ds_read_b128 v[56:59], v130 offset:4096
v_mfma_f32_16x16x32_bf16 v[68:71], v[148:151], v[160:163], v[68:71]
ds_read_b128 v[60:63], v130 offset:6144
v_mfma_f32_16x16x32_bf16 v[100:103], v[148:151], v[164:167], v[100:103]
ds_read_b128 v[36:39], v128 offset:2048
v_mfma_f32_16x16x32_bf16 v[84:87], v[148:151], v[168:171], v[84:87]
ds_read_b128 v[40:43], v128 offset:4096
v_mfma_f32_16x16x32_bf16 v[116:119], v[148:151], v[172:175], v[116:119]
ds_read_b128 v[44:47], v128 offset:6144
v_mfma_f32_16x16x32_bf16 v[72:75], v[152:155], v[160:163], v[72:75]
v_mfma_f32_16x16x32_bf16 v[104:107], v[152:155], v[164:167], v[104:107]
v_mfma_f32_16x16x32_bf16 v[88:91], v[152:155], v[168:171], v[88:91]
v_mfma_f32_16x16x32_bf16 v[120:123], v[152:155], v[172:175], v[120:123]
v_mfma_f32_16x16x32_bf16 v[76:79], v[156:159], v[160:163], v[76:79]
v_mfma_f32_16x16x32_bf16 v[108:111], v[156:159], v[164:167], v[108:111]
v_mfma_f32_16x16x32_bf16 v[92:95], v[156:159], v[168:171], v[92:95]
v_mfma_f32_16x16x32_bf16 v[124:127], v[156:159], v[172:175], v[124:127]
s_waitcnt lgkmcnt(6)
v_mfma_f32_16x16x32_bf16 v[64:67], v[32:35], v[48:51], v[64:67]
ds_read_b128 v[144:147], v129 offset:0
s_waitcnt lgkmcnt(6)
v_mfma_f32_16x16x32_bf16 v[96:99], v[32:35], v[52:55], v[96:99]
ds_read_b128 v[160:163], v131 offset:0
s_waitcnt lgkmcnt(6)
v_mfma_f32_16x16x32_bf16 v[80:83], v[32:35], v[56:59], v[80:83]
ds_read_b128 v[164:167], v131 offset:2048
s_waitcnt lgkmcnt(6)
v_mfma_f32_16x16x32_bf16 v[112:115], v[32:35], v[60:63], v[112:115]
ds_read_b128 v[168:171], v131 offset:4096
s_waitcnt lgkmcnt(6)
v_mfma_f32_16x16x32_bf16 v[68:71], v[36:39], v[48:51], v[68:71]
ds_read_b128 v[172:175], v131 offset:6144
v_mfma_f32_16x16x32_bf16 v[100:103], v[36:39], v[52:55], v[100:103]
ds_read_b128 v[148:151], v129 offset:2048
v_mfma_f32_16x16x32_bf16 v[84:87], v[36:39], v[56:59], v[84:87]
ds_read_b128 v[152:155], v129 offset:4096
v_mfma_f32_16x16x32_bf16 v[116:119], v[36:39], v[60:63], v[116:119]
ds_read_b128 v[156:159], v129 offset:6144
s_waitcnt lgkmcnt(9)
v_mfma_f32_16x16x32_bf16 v[72:75], v[40:43], v[48:51], v[72:75]
v_mfma_f32_16x16x32_bf16 v[104:107], v[40:43], v[52:55], v[104:107]
v_mfma_f32_16x16x32_bf16 v[88:91], v[40:43], v[56:59], v[88:91]
v_mfma_f32_16x16x32_bf16 v[120:123], v[40:43], v[60:63], v[120:123]
s_waitcnt lgkmcnt(8)
v_mfma_f32_16x16x32_bf16 v[76:79], v[44:47], v[48:51], v[76:79]
v_mfma_f32_16x16x32_bf16 v[108:111], v[44:47], v[52:55], v[108:111]
v_mfma_f32_16x16x32_bf16 v[92:95], v[44:47], v[56:59], v[92:95]
v_mfma_f32_16x16x32_bf16 v[124:127], v[44:47], v[60:63], v[124:127]
s_waitcnt lgkmcnt(0)
s_barrier
v_mfma_f32_16x16x32_bf16 v[64:67], v[144:147], v[160:163], v[64:67]
ds_read_b128 v[32:35], v128 offset:32768
v_mfma_f32_16x16x32_bf16 v[96:99], v[144:147], v[164:167], v[96:99]
ds_read_b128 v[48:51], v130 offset:32768
v_mfma_f32_16x16x32_bf16 v[80:83], v[144:147], v[168:171], v[80:83]
ds_read_b128 v[52:55], v130 offset:34816
v_mfma_f32_16x16x32_bf16 v[112:115], v[144:147], v[172:175], v[112:115]
ds_read_b128 v[56:59], v130 offset:36864
v_mfma_f32_16x16x32_bf16 v[68:71], v[148:151], v[160:163], v[68:71]
ds_read_b128 v[60:63], v130 offset:38912
v_mfma_f32_16x16x32_bf16 v[100:103], v[148:151], v[164:167], v[100:103]
ds_read_b128 v[36:39], v128 offset:34816
v_mfma_f32_16x16x32_bf16 v[84:87], v[148:151], v[168:171], v[84:87]
ds_read_b128 v[40:43], v128 offset:36864
v_mfma_f32_16x16x32_bf16 v[116:119], v[148:151], v[172:175], v[116:119]
ds_read_b128 v[44:47], v128 offset:38912
v_mfma_f32_16x16x32_bf16 v[72:75], v[152:155], v[160:163], v[72:75]
v_mfma_f32_16x16x32_bf16 v[104:107], v[152:155], v[164:167], v[104:107]
v_mfma_f32_16x16x32_bf16 v[88:91], v[152:155], v[168:171], v[88:91]
v_mfma_f32_16x16x32_bf16 v[120:123], v[152:155], v[172:175], v[120:123]
v_mfma_f32_16x16x32_bf16 v[76:79], v[156:159], v[160:163], v[76:79]
v_mfma_f32_16x16x32_bf16 v[108:111], v[156:159], v[164:167], v[108:111]
v_mfma_f32_16x16x32_bf16 v[92:95], v[156:159], v[168:171], v[92:95]
v_mfma_f32_16x16x32_bf16 v[124:127], v[156:159], v[172:175], v[124:127]
s_waitcnt lgkmcnt(6)
v_mfma_f32_16x16x32_bf16 v[64:67], v[32:35], v[48:51], v[64:67]
ds_read_b128 v[144:147], v129 offset:32768
s_waitcnt lgkmcnt(6)
v_mfma_f32_16x16x32_bf16 v[96:99], v[32:35], v[52:55], v[96:99]
ds_read_b128 v[160:163], v131 offset:32768
s_waitcnt lgkmcnt(6)
v_mfma_f32_16x16x32_bf16 v[80:83], v[32:35], v[56:59], v[80:83]
ds_read_b128 v[164:167], v131 offset:34816
s_waitcnt lgkmcnt(6)
v_mfma_f32_16x16x32_bf16 v[112:115], v[32:35], v[60:63], v[112:115]
ds_read_b128 v[168:171], v131 offset:36864
s_waitcnt lgkmcnt(6)
v_mfma_f32_16x16x32_bf16 v[68:71], v[36:39], v[48:51], v[68:71]
ds_read_b128 v[172:175], v131 offset:38912
v_mfma_f32_16x16x32_bf16 v[100:103], v[36:39], v[52:55], v[100:103]
ds_read_b128 v[148:151], v129 offset:34816
v_mfma_f32_16x16x32_bf16 v[84:87], v[36:39], v[56:59], v[84:87]
ds_read_b128 v[152:155], v129 offset:36864
v_mfma_f32_16x16x32_bf16 v[116:119], v[36:39], v[60:63], v[116:119]
ds_read_b128 v[156:159], v129 offset:38912
s_waitcnt lgkmcnt(9)
v_mfma_f32_16x16x32_bf16 v[72:75], v[40:43], v[48:51], v[72:75]
v_mfma_f32_16x16x32_bf16 v[104:107], v[40:43], v[52:55], v[104:107]
v_mfma_f32_16x16x32_bf16 v[88:91], v[40:43], v[56:59], v[88:91]
v_mfma_f32_16x16x32_bf16 v[120:123], v[40:43], v[60:63], v[120:123]
s_waitcnt lgkmcnt(8)
v_mfma_f32_16x16x32_bf16 v[76:79], v[44:47], v[48:51], v[76:79]
v_mfma_f32_16x16x32_bf16 v[108:111], v[44:47], v[52:55], v[108:111]
v_mfma_f32_16x16x32_bf16 v[92:95], v[44:47], v[56:59], v[92:95]
v_mfma_f32_16x16x32_bf16 v[124:127], v[44:47], v[60:63], v[124:127]
s_waitcnt lgkmcnt(0)
s_barrier
v_mfma_f32_16x16x32_bf16 v[64:67], v[144:147], v[160:163], v[64:67]
ds_read_b128 v[32:35], v132 offset:0
v_mfma_f32_16x16x32_bf16 v[96:99], v[144:147], v[164:167], v[96:99]
ds_read_b128 v[48:51], v134 offset:0
v_mfma_f32_16x16x32_bf16 v[80:83], v[144:147], v[168:171], v[80:83]
ds_read_b128 v[52:55], v134 offset:2048
v_mfma_f32_16x16x32_bf16 v[112:115], v[144:147], v[172:175], v[112:115]
ds_read_b128 v[56:59], v134 offset:4096
v_mfma_f32_16x16x32_bf16 v[68:71], v[148:151], v[160:163], v[68:71]
ds_read_b128 v[60:63], v134 offset:6144
v_mfma_f32_16x16x32_bf16 v[100:103], v[148:151], v[164:167], v[100:103]
ds_read_b128 v[36:39], v132 offset:2048
v_mfma_f32_16x16x32_bf16 v[84:87], v[148:151], v[168:171], v[84:87]
ds_read_b128 v[40:43], v132 offset:4096
v_mfma_f32_16x16x32_bf16 v[116:119], v[148:151], v[172:175], v[116:119]
ds_read_b128 v[44:47], v132 offset:6144
v_mfma_f32_16x16x32_bf16 v[72:75], v[152:155], v[160:163], v[72:75]
v_mfma_f32_16x16x32_bf16 v[104:107], v[152:155], v[164:167], v[104:107]
v_mfma_f32_16x16x32_bf16 v[88:91], v[152:155], v[168:171], v[88:91]
v_mfma_f32_16x16x32_bf16 v[120:123], v[152:155], v[172:175], v[120:123]
v_mfma_f32_16x16x32_bf16 v[76:79], v[156:159], v[160:163], v[76:79]
v_mfma_f32_16x16x32_bf16 v[108:111], v[156:159], v[164:167], v[108:111]
v_mfma_f32_16x16x32_bf16 v[92:95], v[156:159], v[168:171], v[92:95]
v_mfma_f32_16x16x32_bf16 v[124:127], v[156:159], v[172:175], v[124:127]
s_waitcnt lgkmcnt(6)
v_mfma_f32_16x16x32_bf16 v[64:67], v[32:35], v[48:51], v[64:67]
ds_read_b128 v[144:147], v133 offset:0
s_waitcnt lgkmcnt(6)
v_mfma_f32_16x16x32_bf16 v[96:99], v[32:35], v[52:55], v[96:99]
ds_read_b128 v[160:163], v135 offset:0
s_waitcnt lgkmcnt(6)
v_mfma_f32_16x16x32_bf16 v[80:83], v[32:35], v[56:59], v[80:83]
ds_read_b128 v[164:167], v135 offset:2048
s_waitcnt lgkmcnt(6)
v_mfma_f32_16x16x32_bf16 v[112:115], v[32:35], v[60:63], v[112:115]
ds_read_b128 v[168:171], v135 offset:4096
s_waitcnt lgkmcnt(6)
v_mfma_f32_16x16x32_bf16 v[68:71], v[36:39], v[48:51], v[68:71]
ds_read_b128 v[172:175], v135 offset:6144
v_mfma_f32_16x16x32_bf16 v[100:103], v[36:39], v[52:55], v[100:103]
ds_read_b128 v[148:151], v133 offset:2048
v_mfma_f32_16x16x32_bf16 v[84:87], v[36:39], v[56:59], v[84:87]
ds_read_b128 v[152:155], v133 offset:4096
v_mfma_f32_16x16x32_bf16 v[116:119], v[36:39], v[60:63], v[116:119]
ds_read_b128 v[156:159], v133 offset:6144
s_waitcnt lgkmcnt(9)
v_mfma_f32_16x16x32_bf16 v[72:75], v[40:43], v[48:51], v[72:75]
v_mfma_f32_16x16x32_bf16 v[104:107], v[40:43], v[52:55], v[104:107]
v_mfma_f32_16x16x32_bf16 v[88:91], v[40:43], v[56:59], v[88:91]
v_mfma_f32_16x16x32_bf16 v[120:123], v[40:43], v[60:63], v[120:123]
s_waitcnt lgkmcnt(8)
v_mfma_f32_16x16x32_bf16 v[76:79], v[44:47], v[48:51], v[76:79]
v_mfma_f32_16x16x32_bf16 v[108:111], v[44:47], v[52:55], v[108:111]
v_mfma_f32_16x16x32_bf16 v[92:95], v[44:47], v[56:59], v[92:95]
v_mfma_f32_16x16x32_bf16 v[124:127], v[44:47], v[60:63], v[124:127]
s_waitcnt lgkmcnt(0)
s_barrier
v_mfma_f32_16x16x32_bf16 v[64:67], v[144:147], v[160:163], v[64:67]
ds_read_b128 v[32:35], v128 offset:0
v_mfma_f32_16x16x32_bf16 v[96:99], v[144:147], v[164:167], v[96:99]
ds_read_b128 v[48:51], v130 offset:0
v_mfma_f32_16x16x32_bf16 v[80:83], v[144:147], v[168:171], v[80:83]
ds_read_b128 v[52:55], v130 offset:2048
v_mfma_f32_16x16x32_bf16 v[112:115], v[144:147], v[172:175], v[112:115]
ds_read_b128 v[56:59], v130 offset:4096
v_mfma_f32_16x16x32_bf16 v[68:71], v[148:151], v[160:163], v[68:71]
ds_read_b128 v[60:63], v130 offset:6144
v_mfma_f32_16x16x32_bf16 v[100:103], v[148:151], v[164:167], v[100:103]
ds_read_b128 v[36:39], v128 offset:2048
v_mfma_f32_16x16x32_bf16 v[84:87], v[148:151], v[168:171], v[84:87]
ds_read_b128 v[40:43], v128 offset:4096
v_mfma_f32_16x16x32_bf16 v[116:119], v[148:151], v[172:175], v[116:119]
ds_read_b128 v[44:47], v128 offset:6144
v_mfma_f32_16x16x32_bf16 v[72:75], v[152:155], v[160:163], v[72:75]
v_mfma_f32_16x16x32_bf16 v[104:107], v[152:155], v[164:167], v[104:107]
v_mfma_f32_16x16x32_bf16 v[88:91], v[152:155], v[168:171], v[88:91]
v_mfma_f32_16x16x32_bf16 v[120:123], v[152:155], v[172:175], v[120:123]
v_mfma_f32_16x16x32_bf16 v[76:79], v[156:159], v[160:163], v[76:79]
v_mfma_f32_16x16x32_bf16 v[108:111], v[156:159], v[164:167], v[108:111]
v_mfma_f32_16x16x32_bf16 v[92:95], v[156:159], v[168:171], v[92:95]
v_mfma_f32_16x16x32_bf16 v[124:127], v[156:159], v[172:175], v[124:127]
s_waitcnt lgkmcnt(6)
v_mfma_f32_16x16x32_bf16 v[64:67], v[32:35], v[48:51], v[64:67]
ds_read_b128 v[144:147], v129 offset:0
s_waitcnt lgkmcnt(6)
v_mfma_f32_16x16x32_bf16 v[96:99], v[32:35], v[52:55], v[96:99]
ds_read_b128 v[160:163], v131 offset:0
s_waitcnt lgkmcnt(6)
v_mfma_f32_16x16x32_bf16 v[80:83], v[32:35], v[56:59], v[80:83]
ds_read_b128 v[164:167], v131 offset:2048
s_waitcnt lgkmcnt(6)
v_mfma_f32_16x16x32_bf16 v[112:115], v[32:35], v[60:63], v[112:115]
ds_read_b128 v[168:171], v131 offset:4096
s_waitcnt lgkmcnt(6)
v_mfma_f32_16x16x32_bf16 v[68:71], v[36:39], v[48:51], v[68:71]
ds_read_b128 v[172:175], v131 offset:6144
v_mfma_f32_16x16x32_bf16 v[100:103], v[36:39], v[52:55], v[100:103]
ds_read_b128 v[148:151], v129 offset:2048
v_mfma_f32_16x16x32_bf16 v[84:87], v[36:39], v[56:59], v[84:87]
ds_read_b128 v[152:155], v129 offset:4096
v_mfma_f32_16x16x32_bf16 v[116:119], v[36:39], v[60:63], v[116:119]
ds_read_b128 v[156:159], v129 offset:6144
s_waitcnt lgkmcnt(9)
v_mfma_f32_16x16x32_bf16 v[72:75], v[40:43], v[48:51], v[72:75]
v_mfma_f32_16x16x32_bf16 v[104:107], v[40:43], v[52:55], v[104:107]
v_mfma_f32_16x16x32_bf16 v[88:91], v[40:43], v[56:59], v[88:91]
v_mfma_f32_16x16x32_bf16 v[120:123], v[40:43], v[60:63], v[120:123]
s_waitcnt lgkmcnt(8)
v_mfma_f32_16x16x32_bf16 v[76:79], v[44:47], v[48:51], v[76:79]
v_mfma_f32_16x16x32_bf16 v[108:111], v[44:47], v[52:55], v[108:111]
v_mfma_f32_16x16x32_bf16 v[92:95], v[44:47], v[56:59], v[92:95]
v_mfma_f32_16x16x32_bf16 v[124:127], v[44:47], v[60:63], v[124:127]
ds_read_b32 v9, v12 offset:80
s_waitcnt lgkmcnt(0)
v_mfma_f32_16x16x32_bf16 v[64:67], v[144:147], v[160:163], v[64:67]
v_mfma_f32_16x16x32_bf16 v[96:99], v[144:147], v[164:167], v[96:99]
v_mfma_f32_16x16x32_bf16 v[80:83], v[144:147], v[168:171], v[80:83]
v_mfma_f32_16x16x32_bf16 v[112:115], v[144:147], v[172:175], v[112:115]
v_mfma_f32_16x16x32_bf16 v[68:71], v[148:151], v[160:163], v[68:71]
v_mfma_f32_16x16x32_bf16 v[100:103], v[148:151], v[164:167], v[100:103]
v_mfma_f32_16x16x32_bf16 v[84:87], v[148:151], v[168:171], v[84:87]
v_mfma_f32_16x16x32_bf16 v[116:119], v[148:151], v[172:175], v[116:119]
v_mfma_f32_16x16x32_bf16 v[72:75], v[152:155], v[160:163], v[72:75]
v_mfma_f32_16x16x32_bf16 v[104:107], v[152:155], v[164:167], v[104:107]
v_mfma_f32_16x16x32_bf16 v[88:91], v[152:155], v[168:171], v[88:91]
v_mfma_f32_16x16x32_bf16 v[120:123], v[152:155], v[172:175], v[120:123]
v_mfma_f32_16x16x32_bf16 v[76:79], v[156:159], v[160:163], v[76:79]
v_mfma_f32_16x16x32_bf16 v[108:111], v[156:159], v[164:167], v[108:111]
v_mfma_f32_16x16x32_bf16 v[92:95], v[156:159], v[168:171], v[92:95]
v_mfma_f32_16x16x32_bf16 v[124:127], v[156:159], v[172:175], v[124:127]
v_readfirstlane_b32 s37, v9
s_getreg_b32 s60, hwreg(HW_REG_XCC_ID, 0, 4)
s_lshl_b32 s61, s37, 4
s_or_b32 s100, s60, s61
v_mov_b32 v194, s100
v_mov_b32 v202, s37
v_mov_b32 v203, s37
v_pk_fma_f32 v[40:41], v[20:21], v[64:65], v[66:67] op_sel_hi:[0,1,1]
v_pk_fma_f32 v[42:43], v[20:21], v[80:81], v[82:83] op_sel_hi:[0,1,1]
v_pk_fma_f32 v[44:45], v[22:23], v[96:97], v[98:99] op_sel_hi:[0,1,1]
v_pk_fma_f32 v[46:47], v[22:23], v[112:113], v[114:115] op_sel_hi:[0,1,1]
v_pk_fma_f32 v[66:67], v[20:21], v[80:81], v[40:41] op_sel:[1,0,0] neg_lo:[1,0,0] neg_hi:[1,0,0]
v_pk_fma_f32 v[82:83], v[20:21], v[64:65], v[42:43] op_sel:[1,0,0]
v_pk_fma_f32 v[98:99], v[22:23], v[112:113], v[44:45] op_sel:[1,0,0] neg_lo:[1,0,0] neg_hi:[1,0,0]
v_pk_fma_f32 v[114:115], v[22:23], v[96:97], v[46:47] op_sel:[1,0,0]
v_pk_fma_f32 v[40:41], v[20:21], v[66:67], v[68:69] op_sel_hi:[0,1,1]
v_pk_fma_f32 v[42:43], v[20:21], v[82:83], v[84:85] op_sel_hi:[0,1,1]
v_pk_fma_f32 v[44:45], v[22:23], v[98:99], v[100:101] op_sel_hi:[0,1,1]
v_pk_fma_f32 v[46:47], v[22:23], v[114:115], v[116:117] op_sel_hi:[0,1,1]
v_pk_fma_f32 v[68:69], v[20:21], v[82:83], v[40:41] op_sel:[1,0,0] neg_lo:[1,0,0] neg_hi:[1,0,0]
v_pk_fma_f32 v[84:85], v[20:21], v[66:67], v[42:43] op_sel:[1,0,0]
v_pk_fma_f32 v[100:101], v[22:23], v[114:115], v[44:45] op_sel:[1,0,0] neg_lo:[1,0,0] neg_hi:[1,0,0]
v_pk_fma_f32 v[116:117], v[22:23], v[98:99], v[46:47] op_sel:[1,0,0]
v_pk_fma_f32 v[40:41], v[20:21], v[68:69], v[70:71] op_sel_hi:[0,1,1]
v_pk_fma_f32 v[42:43], v[20:21], v[84:85], v[86:87] op_sel_hi:[0,1,1]
v_pk_fma_f32 v[44:45], v[22:23], v[100:101], v[102:103] op_sel_hi:[0,1,1]
v_pk_fma_f32 v[46:47], v[22:23], v[116:117], v[118:119] op_sel_hi:[0,1,1]
v_pk_fma_f32 v[70:71], v[20:21], v[84:85], v[40:41] op_sel:[1,0,0] neg_lo:[1,0,0] neg_hi:[1,0,0]
v_pk_fma_f32 v[86:87], v[20:21], v[68:69], v[42:43] op_sel:[1,0,0]
v_pk_fma_f32 v[102:103], v[22:23], v[116:117], v[44:45] op_sel:[1,0,0] neg_lo:[1,0,0] neg_hi:[1,0,0]
v_pk_fma_f32 v[118:119], v[22:23], v[100:101], v[46:47] op_sel:[1,0,0]
v_pk_fma_f32 v[40:41], v[20:21], v[70:71], v[72:73] op_sel_hi:[0,1,1]
v_pk_fma_f32 v[42:43], v[20:21], v[86:87], v[88:89] op_sel_hi:[0,1,1]
v_pk_fma_f32 v[44:45], v[22:23], v[102:103], v[104:105] op_sel_hi:[0,1,1]
v_pk_fma_f32 v[46:47], v[22:23], v[118:119], v[120:121] op_sel_hi:[0,1,1]
v_pk_fma_f32 v[72:73], v[20:21], v[86:87], v[40:41] op_sel:[1,0,0] neg_lo:[1,0,0] neg_hi:[1,0,0]
v_pk_fma_f32 v[88:89], v[20:21], v[70:71], v[42:43] op_sel:[1,0,0]
v_pk_fma_f32 v[104:105], v[22:23], v[118:119], v[44:45] op_sel:[1,0,0] neg_lo:[1,0,0] neg_hi:[1,0,0]
v_pk_fma_f32 v[120:121], v[22:23], v[102:103], v[46:47] op_sel:[1,0,0]
v_pk_fma_f32 v[40:41], v[20:21], v[72:73], v[74:75] op_sel_hi:[0,1,1]
v_pk_fma_f32 v[42:43], v[20:21], v[88:89], v[90:91] op_sel_hi:[0,1,1]
v_pk_fma_f32 v[44:45], v[22:23], v[104:105], v[106:107] op_sel_hi:[0,1,1]
v_pk_fma_f32 v[46:47], v[22:23], v[120:121], v[122:123] op_sel_hi:[0,1,1]
v_pk_fma_f32 v[74:75], v[20:21], v[88:89], v[40:41] op_sel:[1,0,0] neg_lo:[1,0,0] neg_hi:[1,0,0]
v_pk_fma_f32 v[90:91], v[20:21], v[72:73], v[42:43] op_sel:[1,0,0]
v_pk_fma_f32 v[106:107], v[22:23], v[120:121], v[44:45] op_sel:[1,0,0] neg_lo:[1,0,0] neg_hi:[1,0,0]
v_pk_fma_f32 v[122:123], v[22:23], v[104:105], v[46:47] op_sel:[1,0,0]
v_pk_fma_f32 v[40:41], v[20:21], v[74:75], v[76:77] op_sel_hi:[0,1,1]
v_pk_fma_f32 v[42:43], v[20:21], v[90:91], v[92:93] op_sel_hi:[0,1,1]
v_pk_fma_f32 v[44:45], v[22:23], v[106:107], v[108:109] op_sel_hi:[0,1,1]
v_pk_fma_f32 v[46:47], v[22:23], v[122:123], v[124:125] op_sel_hi:[0,1,1]
v_pk_fma_f32 v[76:77], v[20:21], v[90:91], v[40:41] op_sel:[1,0,0] neg_lo:[1,0,0] neg_hi:[1,0,0]
v_pk_fma_f32 v[92:93], v[20:21], v[74:75], v[42:43] op_sel:[1,0,0]
v_pk_fma_f32 v[108:109], v[22:23], v[122:123], v[44:45] op_sel:[1,0,0] neg_lo:[1,0,0] neg_hi:[1,0,0]
v_pk_fma_f32 v[124:125], v[22:23], v[106:107], v[46:47] op_sel:[1,0,0]
v_pk_fma_f32 v[40:41], v[20:21], v[76:77], v[78:79] op_sel_hi:[0,1,1]
v_pk_fma_f32 v[42:43], v[20:21], v[92:93], v[94:95] op_sel_hi:[0,1,1]
v_pk_fma_f32 v[44:45], v[22:23], v[108:109], v[110:111] op_sel_hi:[0,1,1]
v_pk_fma_f32 v[46:47], v[22:23], v[124:125], v[126:127] op_sel_hi:[0,1,1]
v_pk_fma_f32 v[78:79], v[20:21], v[92:93], v[40:41] op_sel:[1,0,0] neg_lo:[1,0,0] neg_hi:[1,0,0]
v_pk_fma_f32 v[94:95], v[20:21], v[76:77], v[42:43] op_sel:[1,0,0]
v_pk_fma_f32 v[110:111], v[22:23], v[124:125], v[44:45] op_sel:[1,0,0] neg_lo:[1,0,0] neg_hi:[1,0,0]
v_pk_fma_f32 v[126:127], v[22:23], v[108:109], v[46:47] op_sel:[1,0,0]
v_fma_f32 v40, v176, v78, v79
v_fma_f32 v41, v176, v94, v95
v_fma_f32 v32, -v177, v94, v40
v_fma_f32 v33, v177, v78, v41
ds_write_b64 v15, v[32:33] offset:0
v_fma_f32 v40, v178, v110, v111
v_fma_f32 v41, v178, v126, v127
v_fma_f32 v34, -v179, v126, v40
v_fma_f32 v35, v179, v110, v41
ds_write_b64 v15, v[34:35] offset:2304
s_waitcnt lgkmcnt(0)
s_mov_b64 exec, 1
v_mov_b32 v197, 17
ds_write_b32 v13, v197 offset:32
s_mov_b64 exec, -1
L_ek52:
ds_read_b128 v[198:201], v12 offset:32
s_waitcnt lgkmcnt(0)
v_min3_u32 v197, v198, v199, v200
v_min_u32 v197, v197, v201
s_nop 0
v_readfirstlane_b32 s60, v197
s_nop 0
s_cmp_lt_u32 s60, 17
s_cbranch_scc1 L_ek52
ds_read_b128 v[48:51], v14
ds_read_b128 v[52:55], v14 offset:16
s_waitcnt lgkmcnt(1)
v_fma_f32 v40, v28, v48, v50
v_fma_f32 v41, v28, v49, v51
v_fma_f32 v32, -v29, v49, v40
v_fma_f32 v33, v29, v48, v41
s_waitcnt lgkmcnt(0)
v_fma_f32 v40, v28, v32, v52
v_fma_f32 v41, v28, v33, v53
v_fma_f32 v34, -v29, v33, v40
v_fma_f32 v35, v29, v32, v41
v_fma_f32 v40, v28, v34, v54
v_fma_f32 v41, v28, v35, v55
v_fma_f32 v32, -v29, v35, v40
v_fma_f32 v33, v29, v34, v41
v_mov_b32 v34, v32
v_mov_b32 v35, v33
s_nop 0
v_permlane32_swap_b32 v32, v34
v_permlane32_swap_b32 v33, v35
v_fma_f32 v40, v192, v32, v34
v_fma_f32 v41, v192, v33, v35
v_fma_f32 v200, -v193, v33, v40
v_fma_f32 v201, v193, v32, v41
s_cmp_lg_u32 s68, 0
s_cbranch_scc1 L_np54
buffer_store_dwordx4 v[200:203], v16, s[40:43], 0 offen sc1
s_cmp_lg_u32 s66, 0
s_cbranch_scc1 L_np54
s_mov_b64 exec, 1
global_store_dword v195, v194, s[32:33] sc1
s_mov_b64 exec, -1
L_np54:
global_load_dword v243, v18, s[32:33] sc1
v_add_u32 v15, -56, v15
ds_read_b64 v[32:33], v15 offset:0
ds_read_b64 v[34:35], v15 offset:8
ds_read_b64 v[36:37], v15 offset:16
ds_read_b64 v[38:39], v15 offset:24
ds_read_b64 v[40:41], v15 offset:32
ds_read_b64 v[42:43], v15 offset:40
ds_read_b64 v[44:45], v15 offset:48
ds_read_b64 v[46:47], v15 offset:2304
ds_read_b64 v[48:49], v15 offset:2312
ds_read_b64 v[50:51], v15 offset:2320
ds_read_b64 v[52:53], v15 offset:2328
ds_read_b64 v[54:55], v15 offset:2336
ds_read_b64 v[56:57], v15 offset:2344
ds_read_b64 v[58:59], v15 offset:2352
s_waitcnt lgkmcnt(0)
v_fma_f32 v60, v180, v32, v34
v_fma_f32 v61, v180, v33, v35
v_fma_f32 v34, -v181, v33, v60
v_fma_f32 v35, v181, v32, v61
v_fma_f32 v60, v180, v34, v36
v_fma_f32 v61, v180, v35, v37
v_fma_f32 v36, -v181, v35, v60
v_fma_f32 v37, v181, v34, v61
v_fma_f32 v60, v180, v36, v38
v_fma_f32 v61, v180, v37, v39
v_fma_f32 v38, -v181, v37, v60
v_fma_f32 v39, v181, v36, v61
v_fma_f32 v60, v180, v38, v40
v_fma_f32 v61, v180, v39, v41
v_fma_f32 v40, -v181, v39, v60
v_fma_f32 v41, v181, v38, v61
v_fma_f32 v60, v180, v40, v42
v_fma_f32 v61, v180, v41, v43
v_fma_f32 v42, -v181, v41, v60
v_fma_f32 v43, v181, v40, v61
v_fma_f32 v60, v180, v42, v44
v_fma_f32 v61, v180, v43, v45
v_fma_f32 v128, -v181, v43, v60
v_fma_f32 v130, v181, v42, v61
v_fma_f32 v60, v176, v128, v78
v_fma_f32 v61, v176, v130, v94
v_fma_f32 v129, -v177, v130, v60
v_fma_f32 v131, v177, v128, v61
v_fma_f32 v60, v182, v46, v48
v_fma_f32 v61, v182, v47, v49
v_fma_f32 v48, -v183, v47, v60
v_fma_f32 v49, v183, v46, v61
v_fma_f32 v60, v182, v48, v50
v_fma_f32 v61, v182, v49, v51
v_fma_f32 v50, -v183, v49, v60
v_fma_f32 v51, v183, v48, v61
v_fma_f32 v60, v182, v50, v52
v_fma_f32 v61, v182, v51, v53
v_fma_f32 v52, -v183, v51, v60
v_fma_f32 v53, v183, v50, v61
v_fma_f32 v60, v182, v52, v54
v_fma_f32 v61, v182, v53, v55
v_fma_f32 v54, -v183, v53, v60
v_fma_f32 v55, v183, v52, v61
v_fma_f32 v60, v182, v54, v56
v_fma_f32 v61, v182, v55, v57
v_fma_f32 v56, -v183, v55, v60
v_fma_f32 v57, v183, v54, v61
v_fma_f32 v60, v182, v56, v58
v_fma_f32 v61, v182, v57, v59
v_fma_f32 v132, -v183, v57, v60
v_fma_f32 v134, v183, v56, v61
v_fma_f32 v60, v178, v132, v110
v_fma_f32 v61, v178, v134, v126
v_fma_f32 v133, -v179, v134, v60
v_fma_f32 v135, v179, v132, v61
v_pk_mul_f32 v[32:33], v[24:25], v[64:65] op_sel_hi:[0,1]
v_pk_mul_f32 v[34:35], v[24:25], v[80:81] op_sel_hi:[0,1] neg_lo:[1,0] neg_hi:[1,0]
v_pk_fma_f32 v[34:35], v[24:25], v[64:65], v[34:35] op_sel:[1,0,0] neg_lo:[1,0,0] neg_hi:[1,0,0]
v_pk_fma_f32 v[64:65], v[24:25], v[80:81], v[32:33] op_sel:[1,0,0] neg_lo:[1,0,0] neg_hi:[1,0,0]
v_mov_b64 v[80:81], v[34:35]
v_pk_mul_f32 v[36:37], v[26:27], v[96:97] op_sel_hi:[0,1]
v_pk_mul_f32 v[38:39], v[26:27], v[112:113] op_sel_hi:[0,1] neg_lo:[1,0] neg_hi:[1,0]
v_pk_fma_f32 v[38:39], v[26:27], v[96:97], v[38:39] op_sel:[1,0,0] neg_lo:[1,0,0] neg_hi:[1,0,0]
v_pk_fma_f32 v[96:97], v[26:27], v[112:113], v[36:37] op_sel:[1,0,0] neg_lo:[1,0,0] neg_hi:[1,0,0]
v_mov_b64 v[112:113], v[38:39]
v_pk_mul_f32 v[32:33], v[24:25], v[66:67] op_sel_hi:[0,1]
v_pk_mul_f32 v[34:35], v[24:25], v[82:83] op_sel_hi:[0,1] neg_lo:[1,0] neg_hi:[1,0]
v_pk_fma_f32 v[34:35], v[24:25], v[66:67], v[34:35] op_sel:[1,0,0] neg_lo:[1,0,0] neg_hi:[1,0,0]
v_pk_fma_f32 v[66:67], v[24:25], v[82:83], v[32:33] op_sel:[1,0,0] neg_lo:[1,0,0] neg_hi:[1,0,0]
v_mov_b64 v[82:83], v[34:35]
v_pk_mul_f32 v[36:37], v[26:27], v[98:99] op_sel_hi:[0,1]
v_pk_mul_f32 v[38:39], v[26:27], v[114:115] op_sel_hi:[0,1] neg_lo:[1,0] neg_hi:[1,0]
v_pk_fma_f32 v[38:39], v[26:27], v[98:99], v[38:39] op_sel:[1,0,0] neg_lo:[1,0,0] neg_hi:[1,0,0]
v_pk_fma_f32 v[98:99], v[26:27], v[114:115], v[36:37] op_sel:[1,0,0] neg_lo:[1,0,0] neg_hi:[1,0,0]
v_mov_b64 v[114:115], v[38:39]
v_pk_mul_f32 v[32:33], v[24:25], v[68:69] op_sel_hi:[0,1]
v_pk_mul_f32 v[34:35], v[24:25], v[84:85] op_sel_hi:[0,1] neg_lo:[1,0] neg_hi:[1,0]
v_pk_fma_f32 v[34:35], v[24:25], v[68:69], v[34:35] op_sel:[1,0,0] neg_lo:[1,0,0] neg_hi:[1,0,0]
v_pk_fma_f32 v[68:69], v[24:25], v[84:85], v[32:33] op_sel:[1,0,0] neg_lo:[1,0,0] neg_hi:[1,0,0]
v_mov_b64 v[84:85], v[34:35]
v_pk_mul_f32 v[36:37], v[26:27], v[100:101] op_sel_hi:[0,1]
v_pk_mul_f32 v[38:39], v[26:27], v[116:117] op_sel_hi:[0,1] neg_lo:[1,0] neg_hi:[1,0]
v_pk_fma_f32 v[38:39], v[26:27], v[100:101], v[38:39] op_sel:[1,0,0] neg_lo:[1,0,0] neg_hi:[1,0,0]
v_pk_fma_f32 v[100:101], v[26:27], v[116:117], v[36:37] op_sel:[1,0,0] neg_lo:[1,0,0] neg_hi:[1,0,0]
v_mov_b64 v[116:117], v[38:39]
v_pk_mul_f32 v[32:33], v[24:25], v[70:71] op_sel_hi:[0,1]
v_pk_mul_f32 v[34:35], v[24:25], v[86:87] op_sel_hi:[0,1] neg_lo:[1,0] neg_hi:[1,0]
v_pk_fma_f32 v[34:35], v[24:25], v[70:71], v[34:35] op_sel:[1,0,0] neg_lo:[1,0,0] neg_hi:[1,0,0]
v_pk_fma_f32 v[70:71], v[24:25], v[86:87], v[32:33] op_sel:[1,0,0] neg_lo:[1,0,0] neg_hi:[1,0,0]
v_mov_b64 v[86:87], v[34:35]
v_pk_mul_f32 v[36:37], v[26:27], v[102:103] op_sel_hi:[0,1]
v_pk_mul_f32 v[38:39], v[26:27], v[118:119] op_sel_hi:[0,1] neg_lo:[1,0] neg_hi:[1,0]
v_pk_fma_f32 v[38:39], v[26:27], v[102:103], v[38:39] op_sel:[1,0,0] neg_lo:[1,0,0] neg_hi:[1,0,0]
v_pk_fma_f32 v[102:103], v[26:27], v[118:119], v[36:37] op_sel:[1,0,0] neg_lo:[1,0,0] neg_hi:[1,0,0]
v_mov_b64 v[118:119], v[38:39]
v_pk_mul_f32 v[32:33], v[24:25], v[72:73] op_sel_hi:[0,1]
v_pk_mul_f32 v[34:35], v[24:25], v[88:89] op_sel_hi:[0,1] neg_lo:[1,0] neg_hi:[1,0]
v_pk_fma_f32 v[34:35], v[24:25], v[72:73], v[34:35] op_sel:[1,0,0] neg_lo:[1,0,0] neg_hi:[1,0,0]
v_pk_fma_f32 v[72:73], v[24:25], v[88:89], v[32:33] op_sel:[1,0,0] neg_lo:[1,0,0] neg_hi:[1,0,0]
v_mov_b64 v[88:89], v[34:35]
v_pk_mul_f32 v[36:37], v[26:27], v[104:105] op_sel_hi:[0,1]
v_pk_mul_f32 v[38:39], v[26:27], v[120:121] op_sel_hi:[0,1] neg_lo:[1,0] neg_hi:[1,0]
v_pk_fma_f32 v[38:39], v[26:27], v[104:105], v[38:39] op_sel:[1,0,0] neg_lo:[1,0,0] neg_hi:[1,0,0]
v_pk_fma_f32 v[104:105], v[26:27], v[120:121], v[36:37] op_sel:[1,0,0] neg_lo:[1,0,0] neg_hi:[1,0,0]
v_mov_b64 v[120:121], v[38:39]
v_pk_mul_f32 v[32:33], v[24:25], v[74:75] op_sel_hi:[0,1]
v_pk_mul_f32 v[34:35], v[24:25], v[90:91] op_sel_hi:[0,1] neg_lo:[1,0] neg_hi:[1,0]
v_pk_fma_f32 v[34:35], v[24:25], v[74:75], v[34:35] op_sel:[1,0,0] neg_lo:[1,0,0] neg_hi:[1,0,0]
v_pk_fma_f32 v[74:75], v[24:25], v[90:91], v[32:33] op_sel:[1,0,0] neg_lo:[1,0,0] neg_hi:[1,0,0]
v_mov_b64 v[90:91], v[34:35]
v_pk_mul_f32 v[36:37], v[26:27], v[106:107] op_sel_hi:[0,1]
v_pk_mul_f32 v[38:39], v[26:27], v[122:123] op_sel_hi:[0,1] neg_lo:[1,0] neg_hi:[1,0]
v_pk_fma_f32 v[38:39], v[26:27], v[106:107], v[38:39] op_sel:[1,0,0] neg_lo:[1,0,0] neg_hi:[1,0,0]
v_pk_fma_f32 v[106:107], v[26:27], v[122:123], v[36:37] op_sel:[1,0,0] neg_lo:[1,0,0] neg_hi:[1,0,0]
v_mov_b64 v[122:123], v[38:39]
v_pk_mul_f32 v[32:33], v[24:25], v[76:77] op_sel_hi:[0,1]
v_pk_mul_f32 v[34:35], v[24:25], v[92:93] op_sel_hi:[0,1] neg_lo:[1,0] neg_hi:[1,0]
v_pk_fma_f32 v[34:35], v[24:25], v[76:77], v[34:35] op_sel:[1,0,0] neg_lo:[1,0,0] neg_hi:[1,0,0]
v_pk_fma_f32 v[76:77], v[24:25], v[92:93], v[32:33] op_sel:[1,0,0] neg_lo:[1,0,0] neg_hi:[1,0,0]
v_mov_b64 v[92:93], v[34:35]
v_pk_mul_f32 v[36:37], v[26:27], v[108:109] op_sel_hi:[0,1]
v_pk_mul_f32 v[38:39], v[26:27], v[124:125] op_sel_hi:[0,1] neg_lo:[1,0] neg_hi:[1,0]
v_pk_fma_f32 v[38:39], v[26:27], v[108:109], v[38:39] op_sel:[1,0,0] neg_lo:[1,0,0] neg_hi:[1,0,0]
v_pk_fma_f32 v[108:109], v[26:27], v[124:125], v[36:37] op_sel:[1,0,0] neg_lo:[1,0,0] neg_hi:[1,0,0]
v_mov_b64 v[124:125], v[38:39]
v_pk_mul_f32 v[32:33], v[24:25], v[78:79] op_sel_hi:[0,1]
v_pk_mul_f32 v[34:35], v[24:25], v[94:95] op_sel_hi:[0,1] neg_lo:[1,0] neg_hi:[1,0]
v_pk_fma_f32 v[34:35], v[24:25], v[78:79], v[34:35] op_sel:[1,0,0] neg_lo:[1,0,0] neg_hi:[1,0,0]
v_pk_fma_f32 v[78:79], v[24:25], v[94:95], v[32:33] op_sel:[1,0,0] neg_lo:[1,0,0] neg_hi:[1,0,0]
v_mov_b64 v[94:95], v[34:35]
v_pk_mul_f32 v[36:37], v[26:27], v[110:111] op_sel_hi:[0,1]
v_pk_mul_f32 v[38:39], v[26:27], v[126:127] op_sel_hi:[0,1] neg_lo:[1,0] neg_hi:[1,0]
v_pk_fma_f32 v[38:39], v[26:27], v[110:111], v[38:39] op_sel:[1,0,0] neg_lo:[1,0,0] neg_hi:[1,0,0]
v_pk_fma_f32 v[110:111], v[26:27], v[126:127], v[36:37] op_sel:[1,0,0] neg_lo:[1,0,0] neg_hi:[1,0,0]
v_mov_b64 v[126:127], v[38:39]
buffer_load_dwordx4 v[144:147], v136, s[40:43], 0 offen sc1
buffer_load_dwordx4 v[148:151], v137, s[40:43], 0 offen sc1
buffer_load_dwordx4 v[152:155], v138, s[40:43], 0 offen sc1
buffer_load_dwordx4 v[156:159], v139, s[40:43], 0 offen sc1
buffer_load_dwordx4 v[160:163], v140, s[40:43], 0 offen sc1
buffer_load_dwordx4 v[164:167], v141, s[40:43], 0 offen sc1
buffer_load_dwordx4 v[168:171], v142, s[40:43], 0 offen sc1
buffer_load_dwordx4 v[172:175], v143, s[40:43], 0 offen sc1
global_load_dword v197, v196, s[32:33] sc1
v_mov_b32 v14, 1
s_mov_b64 exec, 1
ds_write_b32 v13, v14
s_mov_b64 exec, -1
s_xor_b32 s60, s68, s101
s_xor_b32 s60, s60, 1
s_lshl_b32 s60, s60, 6
s_add_u32 s60, s60, s66
v_lshrrev_b32 v8, 3, v1
v_lshl_add_u32 v8, v8, 1, s60
v_lshlrev_b32 v8, 11, v8
v_and_b32 v14, 7, v1
v_lshrrev_b32 v15, 4, v1
v_xor_b32 v14, v14, v15
v_lshlrev_b32 v14, 4, v14
v_xor_b32 v15, 64, v14
v_add_u32 v244, v8, v14
v_add_u32 v245, v8, v15
v_add_u32 v245, 31744, v245
v_add_u32 v246, v8, v14
v_add_u32 v246, 63488, v246
v_add_u32 v247, v8, v15
v_add_u32 v247, 95232, v247
s_and_b32 s64, s36, 7
s_lshl_b32 s60, s64, 18
s_lshl_b32 s61, s101, 10
s_add_u32 s60, s60, s61
s_add_u32 s48, s20, s60
s_addc_u32 s49, s21, 0
s_sub_u32 s50, 262144, s61
s_mov_b32 s51, 0x20000
s_add_u32 s52, s22, s60
s_addc_u32 s53, s23, 0
s_sub_u32 s54, 262144, s61
s_mov_b32 s55, 0x20000
s_lshl_b32 s61, s64, 1
s_add_u32 s61, s61, s101
s_lshl_b32 s61, s61, 7
s_lshl_b32 s63, s35, 1
s_add_u32 s63, s63, s68
s_lshl_b32 s60, s63, 17
s_add_u32 s60, s60, s61
s_add_u32 s56, s10, s60
s_addc_u32 s57, s11, 0
s_sub_u32 s58, 131072, s61
s_mov_b32 s59, 0x20000
s_add_u32 s26, s26, s61
s_addc_u32 s27, s27, 0
s_lshl_b32 s61, s61, 1
s_add_u32 s61, s61, 4096
s_lshl_b32 s60, s63, 19
s_add_u32 s60, s60, s61
s_add_u32 s28, s28, s60
s_addc_u32 s29, s29, 0
s_sub_u32 s24, 0x80000, s61
s_lshl_b32 s67, s34, 12
s_lshl_b32 s65, s64, 13
s_lshl_b32 s64, s64, 7
s_lshl_b32 s60, s68, 14
s_lshl_b32 s61, s66, 11
s_add_u32 s60, s60, s61
s_add_u32 s60, s60, 65536
v_add_u32 v16, s60, v10
s_lshl_b32 s60, s34, 13
s_add_u32 s60, s60, 65536
v_add_u32 v17, s60, v11
v_xor_b32 v20, 0, v7
v_add_u32 v24, 0x10000, v20
v_xor_b32 v21, 32, v7
v_add_u32 v25, 0x10000, v21
v_xor_b32 v22, 64, v7
v_add_u32 v26, 0x10000, v22
v_xor_b32 v23, 96, v7
v_add_u32 v27, 0x10000, v23
s_mul_i32 s14, s63, 262144
s_lshl_b32 s61, s36, 13
s_add_u32 s14, s14, s61
s_lshl_b32 s61, s66, 11
s_add_u32 s14, s14, s61
v_cmp_gt_u32 vcc, 0x40000, v136
s_nop 1
v_cndmask_b32 v40, 0, v202, vcc
v_cmp_gt_u32 vcc, 0x40000, v137
s_nop 1
v_cndmask_b32 v41, 0, v202, vcc
v_cmp_gt_u32 vcc, 0x40000, v138
s_nop 1
v_cndmask_b32 v42, 0, v202, vcc
v_cmp_gt_u32 vcc, 0x40000, v139
s_nop 1
v_cndmask_b32 v43, 0, v202, vcc
v_cmp_gt_u32 vcc, 0x40000, v140
s_nop 1
v_cndmask_b32 v44, 0, v202, vcc
v_cmp_gt_u32 vcc, 0x40000, v141
s_nop 1
v_cndmask_b32 v45, 0, v202, vcc
v_cmp_gt_u32 vcc, 0x40000, v142
s_nop 1
v_cndmask_b32 v46, 0, v202, vcc
v_cmp_gt_u32 vcc, 0x40000, v143
s_nop 1
v_cndmask_b32 v47, 0, v202, vcc
s_mov_b32 s69, 0
L_poll55:
v_mov_b32 v8, 0
s_waitcnt vmcnt(8)
v_bitop3_b32 v8, v8, v146, v40 bitop3:0xf6
v_bitop3_b32 v8, v8, v147, v40 bitop3:0xf6
s_waitcnt vmcnt(7)
v_bitop3_b32 v8, v8, v150, v41 bitop3:0xf6
v_bitop3_b32 v8, v8, v151, v41 bitop3:0xf6
s_waitcnt vmcnt(6)
v_bitop3_b32 v8, v8, v154, v42 bitop3:0xf6
v_bitop3_b32 v8, v8, v155, v42 bitop3:0xf6
s_waitcnt vmcnt(5)
v_bitop3_b32 v8, v8, v158, v43 bitop3:0xf6
v_bitop3_b32 v8, v8, v159, v43 bitop3:0xf6
s_waitcnt vmcnt(4)
v_bitop3_b32 v8, v8, v162, v44 bitop3:0xf6
v_bitop3_b32 v8, v8, v163, v44 bitop3:0xf6
s_waitcnt vmcnt(3)
v_bitop3_b32 v8, v8, v166, v45 bitop3:0xf6
v_bitop3_b32 v8, v8, v167, v45 bitop3:0xf6
s_waitcnt vmcnt(2)
v_bitop3_b32 v8, v8, v170, v46 bitop3:0xf6
v_bitop3_b32 v8, v8, v171, v46 bitop3:0xf6
s_waitcnt vmcnt(1)
v_bitop3_b32 v8, v8, v174, v47 bitop3:0xf6
v_bitop3_b32 v8, v8, v175, v47 bitop3:0xf6
s_waitcnt vmcnt(0)
v_xor_b32 v197, v194, v197
v_lshrrev_b32 v9, 4, v197
v_or_b32 v8, v8, v9
v_cmp_ne_u32 vcc, 0, v8
s_nop 0
s_cbranch_vccz L_polled56
s_add_u32 s69, s69, 1
s_cmp_ge_u32 s69, 200000
s_cbranch_scc1 L_polled56
buffer_load_dwordx4 v[144:147], v136, s[40:43], 0 offen sc1
buffer_load_dwordx4 v[148:151], v137, s[40:43], 0 offen sc1
buffer_load_dwordx4 v[152:155], v138, s[40:43], 0 offen sc1
buffer_load_dwordx4 v[156:159], v139, s[40:43], 0 offen sc1
buffer_load_dwordx4 v[160:163], v140, s[40:43], 0 offen sc1
buffer_load_dwordx4 v[164:167], v141, s[40:43], 0 offen sc1
buffer_load_dwordx4 v[168:171], v142, s[40:43], 0 offen sc1
buffer_load_dwordx4 v[172:175], v143, s[40:43], 0 offen sc1
global_load_dword v197, v196, s[32:33] sc1
s_branch L_poll55
L_polled56:
v_cmp_ne_u32 vcc, 0, v197
s_nop 0
s_cmp_eq_u64 vcc, 0
s_cselect_b32 s100, 1, 0
s_add_u32 m0, s67, 0
s_add_u32 s62, s64, 0
s_and_b32 s62, s62, 0x3ff
buffer_load_dwordx4 v244, s[48:51], s62 offen offset:0 lds
buffer_load_dwordx4 v245, s[48:51], s62 offen offset:1024 lds
buffer_load_dwordx4 v246, s[48:51], s62 offen offset:2048 lds
buffer_load_dwordx4 v247, s[48:51], s62 offen offset:3072 lds
s_add_u32 m0, s67, 16384
s_nop 0
buffer_load_dwordx4 v244, s[52:55], s62 offen offset:0 lds
buffer_load_dwordx4 v245, s[52:55], s62 offen offset:1024 lds
buffer_load_dwordx4 v246, s[52:55], s62 offen offset:2048 lds
buffer_load_dwordx4 v247, s[52:55], s62 offen offset:3072 lds
v_mov_b32 v14, 2
s_mov_b64 exec, 1
ds_write_b32 v13, v14
s_mov_b64 exec, -1
v_fma_f32 v40, v2, v172, v168
v_fma_f32 v41, v2, v173, v169
v_fma_f32 v48, -v3, v173, v40
v_fma_f32 v49, v3, v172, v41
v_fma_f32 v40, v2, v48, v164
v_fma_f32 v41, v2, v49, v165
v_fma_f32 v172, -v3, v49, v40
v_fma_f32 v173, v3, v48, v41
v_fma_f32 v40, v2, v172, v160
v_fma_f32 v41, v2, v173, v161
v_fma_f32 v48, -v3, v173, v40
v_fma_f32 v49, v3, v172, v41
v_fma_f32 v40, v2, v48, v156
v_fma_f32 v41, v2, v49, v157
v_fma_f32 v172, -v3, v49, v40
v_fma_f32 v173, v3, v48, v41
v_fma_f32 v40, v2, v172, v152
v_fma_f32 v41, v2, v173, v153
v_fma_f32 v48, -v3, v173, v40
v_fma_f32 v49, v3, v172, v41
v_fma_f32 v40, v2, v48, v148
v_fma_f32 v41, v2, v49, v149
v_fma_f32 v172, -v3, v49, v40
v_fma_f32 v173, v3, v48, v41
v_fma_f32 v40, v2, v172, v144
v_fma_f32 v41, v2, v173, v145
v_fma_f32 v48, -v3, v173, v40
v_fma_f32 v49, v3, v172, v41
v_mov_b32 v50, v48
v_mov_b32 v51, v49
s_nop 0
v_permlane32_swap_b32 v48, v50
v_permlane32_swap_b32 v49, v51
v_fma_f32 v40, v30, v50, v48
v_fma_f32 v41, v30, v51, v49
v_fma_f32 v52, -v31, v51, v40
v_fma_f32 v53, v31, v50, v41
v_mov_b32 v54, v52
v_mov_b32 v55, v53
s_nop 0
v_permlane16_swap_b32 v52, v54
v_permlane16_swap_b32 v53, v55
v_pk_fma_f32 v[128:129], v[52:53], v[184:185], v[128:129] op_sel_hi:[0,1,1]
v_pk_fma_f32 v[130:131], v[52:53], v[186:187], v[130:131] op_sel_hi:[0,1,1]
v_pk_fma_f32 v[128:129], v[52:53], v[186:187], v[128:129] op_sel:[1,0,0] neg_lo:[1,0,0] neg_hi:[1,0,0]
v_pk_fma_f32 v[130:131], v[52:53], v[184:185], v[130:131] op_sel:[1,0,0]
v_pk_fma_f32 v[132:133], v[54:55], v[188:189], v[132:133] op_sel_hi:[0,1,1]
v_pk_fma_f32 v[134:135], v[54:55], v[190:191], v[134:135] op_sel_hi:[0,1,1]
v_pk_fma_f32 v[132:133], v[54:55], v[190:191], v[132:133] op_sel:[1,0,0] neg_lo:[1,0,0] neg_hi:[1,0,0]
v_pk_fma_f32 v[134:135], v[54:55], v[188:189], v[134:135] op_sel:[1,0,0]
v_pk_fma_f32 v[64:65], v[208:209], v[128:129], v[64:65] op_sel_hi:[0,1,1]
v_pk_fma_f32 v[80:81], v[208:209], v[130:131], v[80:81] op_sel_hi:[0,1,1] neg_lo:[1,0,0] neg_hi:[1,0,0]
v_pk_fma_f32 v[64:65], v[208:209], v[130:131], v[64:65] op_sel:[1,0,0] neg_lo:[1,0,0] neg_hi:[1,0,0]
v_pk_fma_f32 v[80:81], v[208:209], v[128:129], v[80:81] op_sel:[1,0,0] neg_lo:[1,0,0] neg_hi:[1,0,0]
v_cvt_pk_bf16_f32 v144, v64, v65
v_cvt_pk_bf16_f32 v152, v80, v81
v_pk_fma_f32 v[96:97], v[224:225], v[132:133], v[96:97] op_sel_hi:[0,1,1]
v_pk_fma_f32 v[112:113], v[224:225], v[134:135], v[112:113] op_sel_hi:[0,1,1] neg_lo:[1,0,0] neg_hi:[1,0,0]
v_pk_fma_f32 v[96:97], v[224:225], v[134:135], v[96:97] op_sel:[1,0,0] neg_lo:[1,0,0] neg_hi:[1,0,0]
v_pk_fma_f32 v[112:113], v[224:225], v[132:133], v[112:113] op_sel:[1,0,0] neg_lo:[1,0,0] neg_hi:[1,0,0]
v_cvt_pk_bf16_f32 v160, v96, v97
v_cvt_pk_bf16_f32 v168, v112, v113
v_pk_fma_f32 v[66:67], v[210:211], v[128:129], v[66:67] op_sel_hi:[0,1,1]
v_pk_fma_f32 v[82:83], v[210:211], v[130:131], v[82:83] op_sel_hi:[0,1,1] neg_lo:[1,0,0] neg_hi:[1,0,0]
v_pk_fma_f32 v[66:67], v[210:211], v[130:131], v[66:67] op_sel:[1,0,0] neg_lo:[1,0,0] neg_hi:[1,0,0]
v_pk_fma_f32 v[82:83], v[210:211], v[128:129], v[82:83] op_sel:[1,0,0] neg_lo:[1,0,0] neg_hi:[1,0,0]
v_cvt_pk_bf16_f32 v145, v66, v67
v_cvt_pk_bf16_f32 v153, v82, v83
v_pk_fma_f32 v[98:99], v[226:227], v[132:133], v[98:99] op_sel_hi:[0,1,1]
v_pk_fma_f32 v[114:115], v[226:227], v[134:135], v[114:115] op_sel_hi:[0,1,1] neg_lo:[1,0,0] neg_hi:[1,0,0]
v_pk_fma_f32 v[98:99], v[226:227], v[134:135], v[98:99] op_sel:[1,0,0] neg_lo:[1,0,0] neg_hi:[1,0,0]
v_pk_fma_f32 v[114:115], v[226:227], v[132:133], v[114:115] op_sel:[1,0,0] neg_lo:[1,0,0] neg_hi:[1,0,0]
v_cvt_pk_bf16_f32 v161, v98, v99
v_cvt_pk_bf16_f32 v169, v114, v115
v_pk_fma_f32 v[68:69], v[212:213], v[128:129], v[68:69] op_sel_hi:[0,1,1]
v_pk_fma_f32 v[84:85], v[212:213], v[130:131], v[84:85] op_sel_hi:[0,1,1] neg_lo:[1,0,0] neg_hi:[1,0,0]
v_pk_fma_f32 v[68:69], v[212:213], v[130:131], v[68:69] op_sel:[1,0,0] neg_lo:[1,0,0] neg_hi:[1,0,0]
v_pk_fma_f32 v[84:85], v[212:213], v[128:129], v[84:85] op_sel:[1,0,0] neg_lo:[1,0,0] neg_hi:[1,0,0]
v_cvt_pk_bf16_f32 v146, v68, v69
v_cvt_pk_bf16_f32 v154, v84, v85
v_pk_fma_f32 v[100:101], v[228:229], v[132:133], v[100:101] op_sel_hi:[0,1,1]
v_pk_fma_f32 v[116:117], v[228:229], v[134:135], v[116:117] op_sel_hi:[0,1,1] neg_lo:[1,0,0] neg_hi:[1,0,0]
v_pk_fma_f32 v[100:101], v[228:229], v[134:135], v[100:101] op_sel:[1,0,0] neg_lo:[1,0,0] neg_hi:[1,0,0]
v_pk_fma_f32 v[116:117], v[228:229], v[132:133], v[116:117] op_sel:[1,0,0] neg_lo:[1,0,0] neg_hi:[1,0,0]
v_cvt_pk_bf16_f32 v162, v100, v101
v_cvt_pk_bf16_f32 v170, v116, v117
v_pk_fma_f32 v[70:71], v[214:215], v[128:129], v[70:71] op_sel_hi:[0,1,1]
v_pk_fma_f32 v[86:87], v[214:215], v[130:131], v[86:87] op_sel_hi:[0,1,1] neg_lo:[1,0,0] neg_hi:[1,0,0]
v_pk_fma_f32 v[70:71], v[214:215], v[130:131], v[70:71] op_sel:[1,0,0] neg_lo:[1,0,0] neg_hi:[1,0,0]
v_pk_fma_f32 v[86:87], v[214:215], v[128:129], v[86:87] op_sel:[1,0,0] neg_lo:[1,0,0] neg_hi:[1,0,0]
v_cvt_pk_bf16_f32 v147, v70, v71
v_cvt_pk_bf16_f32 v155, v86, v87
v_pk_fma_f32 v[102:103], v[230:231], v[132:133], v[102:103] op_sel_hi:[0,1,1]
v_pk_fma_f32 v[118:119], v[230:231], v[134:135], v[118:119] op_sel_hi:[0,1,1] neg_lo:[1,0,0] neg_hi:[1,0,0]
v_pk_fma_f32 v[102:103], v[230:231], v[134:135], v[102:103] op_sel:[1,0,0] neg_lo:[1,0,0] neg_hi:[1,0,0]
v_pk_fma_f32 v[118:119], v[230:231], v[132:133], v[118:119] op_sel:[1,0,0] neg_lo:[1,0,0] neg_hi:[1,0,0]
v_cvt_pk_bf16_f32 v163, v102, v103
v_cvt_pk_bf16_f32 v171, v118, v119
v_mfma_f32_16x16x32_bf16 v[32:35], v[144:147], v[248:251], 0
v_mfma_f32_16x16x32_bf16 v[36:39], v[160:163], v[248:251], 0
v_mfma_f32_16x16x32_bf16 v[40:43], v[144:147], v[252:255], 0
v_mfma_f32_16x16x32_bf16 v[44:47], v[160:163], v[252:255], 0
v_mfma_f32_16x16x32_bf16 v[48:51], v[152:155], v[248:251], 0
v_mfma_f32_16x16x32_bf16 v[52:55], v[168:171], v[248:251], 0
v_mfma_f32_16x16x32_bf16 v[56:59], v[152:155], v[252:255], 0
v_mfma_f32_16x16x32_bf16 v[60:63], v[168:171], v[252:255], 0
v_pk_fma_f32 v[72:73], v[216:217], v[128:129], v[72:73] op_sel_hi:[0,1,1]
v_pk_fma_f32 v[88:89], v[216:217], v[130:131], v[88:89] op_sel_hi:[0,1,1] neg_lo:[1,0,0] neg_hi:[1,0,0]
v_pk_fma_f32 v[72:73], v[216:217], v[130:131], v[72:73] op_sel:[1,0,0] neg_lo:[1,0,0] neg_hi:[1,0,0]
v_pk_fma_f32 v[88:89], v[216:217], v[128:129], v[88:89] op_sel:[1,0,0] neg_lo:[1,0,0] neg_hi:[1,0,0]
v_cvt_pk_bf16_f32 v148, v72, v73
v_cvt_pk_bf16_f32 v156, v88, v89
v_pk_fma_f32 v[104:105], v[232:233], v[132:133], v[104:105] op_sel_hi:[0,1,1]
v_pk_fma_f32 v[120:121], v[232:233], v[134:135], v[120:121] op_sel_hi:[0,1,1] neg_lo:[1,0,0] neg_hi:[1,0,0]
v_pk_fma_f32 v[104:105], v[232:233], v[134:135], v[104:105] op_sel:[1,0,0] neg_lo:[1,0,0] neg_hi:[1,0,0]
v_pk_fma_f32 v[120:121], v[232:233], v[132:133], v[120:121] op_sel:[1,0,0] neg_lo:[1,0,0] neg_hi:[1,0,0]
v_cvt_pk_bf16_f32 v164, v104, v105
v_cvt_pk_bf16_f32 v172, v120, v121
v_pk_fma_f32 v[74:75], v[218:219], v[128:129], v[74:75] op_sel_hi:[0,1,1]
v_pk_fma_f32 v[90:91], v[218:219], v[130:131], v[90:91] op_sel_hi:[0,1,1] neg_lo:[1,0,0] neg_hi:[1,0,0]
v_pk_fma_f32 v[74:75], v[218:219], v[130:131], v[74:75] op_sel:[1,0,0] neg_lo:[1,0,0] neg_hi:[1,0,0]
v_pk_fma_f32 v[90:91], v[218:219], v[128:129], v[90:91] op_sel:[1,0,0] neg_lo:[1,0,0] neg_hi:[1,0,0]
v_cvt_pk_bf16_f32 v149, v74, v75
v_cvt_pk_bf16_f32 v157, v90, v91
v_pk_fma_f32 v[106:107], v[234:235], v[132:133], v[106:107] op_sel_hi:[0,1,1]
v_pk_fma_f32 v[122:123], v[234:235], v[134:135], v[122:123] op_sel_hi:[0,1,1] neg_lo:[1,0,0] neg_hi:[1,0,0]
v_pk_fma_f32 v[106:107], v[234:235], v[134:135], v[106:107] op_sel:[1,0,0] neg_lo:[1,0,0] neg_hi:[1,0,0]
v_pk_fma_f32 v[122:123], v[234:235], v[132:133], v[122:123] op_sel:[1,0,0] neg_lo:[1,0,0] neg_hi:[1,0,0]
v_cvt_pk_bf16_f32 v165, v106, v107
v_cvt_pk_bf16_f32 v173, v122, v123
s_add_u32 s61, s14, 0
v_cvt_pk_bf16_f32 v176, v32, v33
v_cvt_pk_bf16_f32 v177, v34, v35
v_cvt_pk_bf16_f32 v178, v36, v37
v_cvt_pk_bf16_f32 v179, v38, v39
buffer_store_dwordx4 v[176:179], v10, s[44:47], s61 offen offset:0 sc1
ds_write_b128 v16, v[176:179] offset:0
s_add_u32 s61, s14, 131072
v_cvt_pk_bf16_f32 v180, v40, v41
v_cvt_pk_bf16_f32 v181, v42, v43
v_cvt_pk_bf16_f32 v182, v44, v45
v_cvt_pk_bf16_f32 v183, v46, v47
buffer_store_dwordx4 v[180:183], v10, s[44:47], s61 offen offset:0 sc1
ds_write_b128 v16, v[180:183] offset:8192
s_add_u32 s61, s14, 4096
v_cvt_pk_bf16_f32 v184, v48, v49
v_cvt_pk_bf16_f32 v185, v50, v51
v_cvt_pk_bf16_f32 v186, v52, v53
v_cvt_pk_bf16_f32 v187, v54, v55
buffer_store_dwordx4 v[184:187], v10, s[44:47], s61 offen offset:0 sc1
ds_write_b128 v16, v[184:187] offset:4096
s_add_u32 s61, s14, 135168
v_cvt_pk_bf16_f32 v188, v56, v57
v_cvt_pk_bf16_f32 v189, v58, v59
v_cvt_pk_bf16_f32 v190, v60, v61
v_cvt_pk_bf16_f32 v191, v62, v63
buffer_store_dwordx4 v[188:191], v10, s[44:47], s61 offen offset:0 sc1
ds_write_b128 v16, v[188:191] offset:12288
v_pk_fma_f32 v[76:77], v[220:221], v[128:129], v[76:77] op_sel_hi:[0,1,1]
v_pk_fma_f32 v[92:93], v[220:221], v[130:131], v[92:93] op_sel_hi:[0,1,1] neg_lo:[1,0,0] neg_hi:[1,0,0]
v_pk_fma_f32 v[76:77], v[220:221], v[130:131], v[76:77] op_sel:[1,0,0] neg_lo:[1,0,0] neg_hi:[1,0,0]
v_pk_fma_f32 v[92:93], v[220:221], v[128:129], v[92:93] op_sel:[1,0,0] neg_lo:[1,0,0] neg_hi:[1,0,0]
v_cvt_pk_bf16_f32 v150, v76, v77
v_cvt_pk_bf16_f32 v158, v92, v93
v_pk_fma_f32 v[108:109], v[236:237], v[132:133], v[108:109] op_sel_hi:[0,1,1]
v_pk_fma_f32 v[124:125], v[236:237], v[134:135], v[124:125] op_sel_hi:[0,1,1] neg_lo:[1,0,0] neg_hi:[1,0,0]
v_pk_fma_f32 v[108:109], v[236:237], v[134:135], v[108:109] op_sel:[1,0,0] neg_lo:[1,0,0] neg_hi:[1,0,0]
v_pk_fma_f32 v[124:125], v[236:237], v[132:133], v[124:125] op_sel:[1,0,0] neg_lo:[1,0,0] neg_hi:[1,0,0]
v_cvt_pk_bf16_f32 v166, v108, v109
v_cvt_pk_bf16_f32 v174, v124, v125
v_pk_fma_f32 v[78:79], v[222:223], v[128:129], v[78:79] op_sel_hi:[0,1,1]
v_pk_fma_f32 v[94:95], v[222:223], v[130:131], v[94:95] op_sel_hi:[0,1,1] neg_lo:[1,0,0] neg_hi:[1,0,0]
v_pk_fma_f32 v[78:79], v[222:223], v[130:131], v[78:79] op_sel:[1,0,0] neg_lo:[1,0,0] neg_hi:[1,0,0]
v_pk_fma_f32 v[94:95], v[222:223], v[128:129], v[94:95] op_sel:[1,0,0] neg_lo:[1,0,0] neg_hi:[1,0,0]
v_cvt_pk_bf16_f32 v151, v78, v79
v_cvt_pk_bf16_f32 v159, v94, v95
v_pk_fma_f32 v[110:111], v[238:239], v[132:133], v[110:111] op_sel_hi:[0,1,1]
v_pk_fma_f32 v[126:127], v[238:239], v[134:135], v[126:127] op_sel_hi:[0,1,1] neg_lo:[1,0,0] neg_hi:[1,0,0]
v_pk_fma_f32 v[110:111], v[238:239], v[134:135], v[110:111] op_sel:[1,0,0] neg_lo:[1,0,0] neg_hi:[1,0,0]
v_pk_fma_f32 v[126:127], v[238:239], v[132:133], v[126:127] op_sel:[1,0,0] neg_lo:[1,0,0] neg_hi:[1,0,0]
v_cvt_pk_bf16_f32 v167, v110, v111
v_cvt_pk_bf16_f32 v175, v126, v127
v_mfma_f32_16x16x32_bf16 v[32:35], v[148:151], v[248:251], 0
v_mfma_f32_16x16x32_bf16 v[36:39], v[164:167], v[248:251], 0
v_mfma_f32_16x16x32_bf16 v[40:43], v[148:151], v[252:255], 0
v_mfma_f32_16x16x32_bf16 v[44:47], v[164:167], v[252:255], 0
v_mfma_f32_16x16x32_bf16 v[48:51], v[156:159], v[248:251], 0
v_mfma_f32_16x16x32_bf16 v[52:55], v[172:175], v[248:251], 0
v_mfma_f32_16x16x32_bf16 v[56:59], v[156:159], v[252:255], 0
v_mfma_f32_16x16x32_bf16 v[60:63], v[172:175], v[252:255], 0
s_add_u32 s61, s14, 0
v_cvt_pk_bf16_f32 v192, v32, v33
v_cvt_pk_bf16_f32 v193, v34, v35
v_cvt_pk_bf16_f32 v194, v36, v37
v_cvt_pk_bf16_f32 v195, v38, v39
buffer_store_dwordx4 v[192:195], v10, s[44:47], s61 offen offset:256 sc1
ds_write_b128 v16, v[192:195] offset:256
s_add_u32 s61, s14, 131072
v_cvt_pk_bf16_f32 v196, v40, v41
v_cvt_pk_bf16_f32 v197, v42, v43
v_cvt_pk_bf16_f32 v198, v44, v45
v_cvt_pk_bf16_f32 v199, v46, v47
buffer_store_dwordx4 v[196:199], v10, s[44:47], s61 offen offset:256 sc1
ds_write_b128 v16, v[196:199] offset:8448
s_add_u32 s61, s14, 4096
v_cvt_pk_bf16_f32 v200, v48, v49
v_cvt_pk_bf16_f32 v201, v50, v51
v_cvt_pk_bf16_f32 v202, v52, v53
v_cvt_pk_bf16_f32 v203, v54, v55
buffer_store_dwordx4 v[200:203], v10, s[44:47], s61 offen offset:256 sc1
ds_write_b128 v16, v[200:203] offset:4352
s_add_u32 s61, s14, 135168
v_cvt_pk_bf16_f32 v204, v56, v57
v_cvt_pk_bf16_f32 v205, v58, v59
v_cvt_pk_bf16_f32 v206, v60, v61
v_cvt_pk_bf16_f32 v207, v62, v63
buffer_store_dwordx4 v[204:207], v10, s[44:47], s61 offen offset:256 sc1
ds_write_b128 v16, v[204:207] offset:12544
v_mov_b32 v2, v11
s_lshl_b32 s60, s35, 2
s_add_u32 s60, s60, s34
s_mul_i32 s60, s60, 131072
s_lshl_b32 s61, s101, 16
s_add_u32 s60, s60, s61
s_add_u32 s42, s60, 1048576
s_add_u32 s40, s32, s42
s_addc_u32 s41, s33, 0
s_mov_b32 s42, 65536
s_mov_b32 s43, 0x20000
s_waitcnt vmcnt(8) lgkmcnt(0)
v_mov_b32 v14, 3
s_mov_b64 exec, 1
ds_write_b32 v13, v14
s_mov_b64 exec, -1
ds_read_b128 v[8:11], v12 offset:0
s_waitcnt lgkmcnt(0)
L_ck57:
v_min3_u32 v15, v8, v9, v10
v_min_u32 v15, v15, v11
s_nop 0
v_readfirstlane_b32 s60, v15
s_nop 0
s_cmp_ge_u32 s60, 3
s_cbranch_scc1 L_ckd58
ds_read_b128 v[8:11], v12 offset:0
s_waitcnt lgkmcnt(0)
s_branch L_ck57
L_ckd58:
ds_read_b128 v[148:151], v17 offset:0
ds_read_b128 v[152:155], v17 offset:1024
ds_read_b128 v[156:159], v17 offset:2048
ds_read_b128 v[160:163], v17 offset:3072
ds_read_b128 v[164:167], v17 offset:4096
ds_read_b128 v[168:171], v17 offset:5120
ds_read_b128 v[172:175], v17 offset:6144
ds_read_b128 v[176:179], v17 offset:7168
ds_read_b128 v[96:99], v20 offset:0
ds_read_b128 v[100:103], v20 offset:4096
ds_read_b128 v[104:107], v20 offset:8192
ds_read_b128 v[108:111], v20 offset:12288
s_waitcnt lgkmcnt(4)
v_mov_b32 v14, 4
s_mov_b64 exec, 1
ds_write_b32 v13, v14
s_mov_b64 exec, -1
s_waitcnt lgkmcnt(0)
v_mfma_f32_32x32x16_bf16 v[32:47], v[148:151], v[96:99], 0
ds_read_b128 v[112:115], v21 offset:0
ds_read_b128 v[116:119], v21 offset:4096
v_mfma_f32_32x32x16_bf16 v[48:63], v[148:151], v[100:103], 0
ds_read_b128 v[120:123], v21 offset:8192
ds_read_b128 v[124:127], v21 offset:12288
v_mfma_f32_32x32x16_bf16 v[64:79], v[148:151], v[104:107], 0
s_add_u32 m0, s67, 32768
s_add_u32 s62, s64, 128
s_and_b32 s62, s62, 0x3ff
buffer_load_dwordx4 v244, s[48:51], s62 offen offset:0 lds
v_mfma_f32_32x32x16_bf16 v[80:95], v[148:151], v[108:111], 0
s_waitcnt lgkmcnt(3)
v_mfma_f32_32x32x16_bf16 v[32:47], v[152:155], v[112:115], v[32:47]
ds_read_b128 v[96:99], v22 offset:0
ds_read_b128 v[100:103], v22 offset:4096
s_waitcnt lgkmcnt(4)
v_mfma_f32_32x32x16_bf16 v[48:63], v[152:155], v[116:119], v[48:63]
ds_read_b128 v[104:107], v22 offset:8192
ds_read_b128 v[108:111], v22 offset:12288
s_waitcnt lgkmcnt(5)
v_mfma_f32_32x32x16_bf16 v[64:79], v[152:155], v[120:123], v[64:79]
buffer_load_dwordx4 v245, s[48:51], s62 offen offset:1024 lds
s_waitcnt lgkmcnt(4)
v_mfma_f32_32x32x16_bf16 v[80:95], v[152:155], v[124:127], v[80:95]
s_waitcnt lgkmcnt(3)
v_mfma_f32_32x32x16_bf16 v[32:47], v[156:159], v[96:99], v[32:47]
ds_read_b128 v[112:115], v23 offset:0
ds_read_b128 v[116:119], v23 offset:4096
s_waitcnt lgkmcnt(4)
v_mfma_f32_32x32x16_bf16 v[48:63], v[156:159], v[100:103], v[48:63]
ds_read_b128 v[120:123], v23 offset:8192
ds_read_b128 v[124:127], v23 offset:12288
s_waitcnt lgkmcnt(5)
v_mfma_f32_32x32x16_bf16 v[64:79], v[156:159], v[104:107], v[64:79]
buffer_load_dwordx4 v246, s[48:51], s62 offen offset:2048 lds
s_waitcnt lgkmcnt(4)
v_mfma_f32_32x32x16_bf16 v[80:95], v[156:159], v[108:111], v[80:95]
s_waitcnt lgkmcnt(3)
v_mfma_f32_32x32x16_bf16 v[32:47], v[160:163], v[112:115], v[32:47]
ds_read_b128 v[96:99], v20 offset:16384
ds_read_b128 v[100:103], v20 offset:20480
s_waitcnt lgkmcnt(4)
v_mfma_f32_32x32x16_bf16 v[48:63], v[160:163], v[116:119], v[48:63]
ds_read_b128 v[104:107], v20 offset:24576
ds_read_b128 v[108:111], v20 offset:28672
s_waitcnt lgkmcnt(5)
v_mfma_f32_32x32x16_bf16 v[64:79], v[160:163], v[120:123], v[64:79]
buffer_load_dwordx4 v247, s[48:51], s62 offen offset:3072 lds
s_waitcnt lgkmcnt(4)
v_mfma_f32_32x32x16_bf16 v[80:95], v[160:163], v[124:127], v[80:95]
s_waitcnt lgkmcnt(3)
v_mfma_f32_32x32x16_bf16 v[32:47], v[164:167], v[96:99], v[32:47]
ds_read_b128 v[112:115], v21 offset:16384
ds_read_b128 v[116:119], v21 offset:20480
s_waitcnt lgkmcnt(4)
v_mfma_f32_32x32x16_bf16 v[48:63], v[164:167], v[100:103], v[48:63]
ds_read_b128 v[120:123], v21 offset:24576
ds_read_b128 v[124:127], v21 offset:28672
s_waitcnt lgkmcnt(5)
v_mfma_f32_32x32x16_bf16 v[64:79], v[164:167], v[104:107], v[64:79]
s_add_u32 m0, s67, 49152
s_nop 0
buffer_load_dwordx4 v244, s[52:55], s62 offen offset:0 lds
s_waitcnt lgkmcnt(4)
v_mfma_f32_32x32x16_bf16 v[80:95], v[164:167], v[108:111], v[80:95]
s_waitcnt lgkmcnt(3)
v_mfma_f32_32x32x16_bf16 v[32:47], v[168:171], v[112:115], v[32:47]
ds_read_b128 v[96:99], v22 offset:16384
ds_read_b128 v[100:103], v22 offset:20480
s_waitcnt lgkmcnt(4)
v_mfma_f32_32x32x16_bf16 v[48:63], v[168:171], v[116:119], v[48:63]
ds_read_b128 v[104:107], v22 offset:24576
ds_read_b128 v[108:111], v22 offset:28672
s_waitcnt lgkmcnt(5)
v_mfma_f32_32x32x16_bf16 v[64:79], v[168:171], v[120:123], v[64:79]
buffer_load_dwordx4 v245, s[52:55], s62 offen offset:1024 lds
s_waitcnt lgkmcnt(4)
v_mfma_f32_32x32x16_bf16 v[80:95], v[168:171], v[124:127], v[80:95]
s_waitcnt lgkmcnt(3)
v_mfma_f32_32x32x16_bf16 v[32:47], v[172:175], v[96:99], v[32:47]
ds_read_b128 v[112:115], v23 offset:16384
ds_read_b128 v[116:119], v23 offset:20480
s_waitcnt lgkmcnt(4)
v_mfma_f32_32x32x16_bf16 v[48:63], v[172:175], v[100:103], v[48:63]
ds_read_b128 v[120:123], v23 offset:24576
ds_read_b128 v[124:127], v23 offset:28672
s_waitcnt lgkmcnt(5)
v_mfma_f32_32x32x16_bf16 v[64:79], v[172:175], v[104:107], v[64:79]
buffer_load_dwordx4 v246, s[52:55], s62 offen offset:2048 lds
s_waitcnt lgkmcnt(4)
v_mfma_f32_32x32x16_bf16 v[80:95], v[172:175], v[108:111], v[80:95]
s_waitcnt lgkmcnt(0)
v_mfma_f32_32x32x16_bf16 v[32:47], v[176:179], v[112:115], v[32:47]
v_mfma_f32_32x32x16_bf16 v[48:63], v[176:179], v[116:119], v[48:63]
v_mfma_f32_32x32x16_bf16 v[64:79], v[176:179], v[120:123], v[64:79]
buffer_load_dwordx4 v247, s[52:55], s62 offen offset:3072 lds
v_mfma_f32_32x32x16_bf16 v[80:95], v[176:179], v[124:127], v[80:95]
s_lshl_b32 s60, s66, 3
v_lshl_add_u32 v17, v5, 4, s60
v_lshlrev_b32 v28, 11, v17
v_lshl_add_u32 v28, v6, 2, v28
v_lshlrev_b32 v29, 13, v17
v_lshl_add_u32 v29, v6, 3, v29
v_lshlrev_b32 v30, 2, v6
v_mov_b32 v15, s37
s_waitcnt vmcnt(8)
s_mov_b64 exec, 1
s_cmp_eq_u32 s100, 0
s_cbranch_scc1 L_rs59
global_store_dword v19, v15, s[32:33]
s_branch L_rd60
L_rs59:
global_store_dword v19, v15, s[32:33] sc1
L_rd60:
s_mov_b64 exec, -1
ds_read_b128 v[8:11], v12 offset:0
s_waitcnt lgkmcnt(0)
L_ck61:
v_min3_u32 v15, v8, v9, v10
v_min_u32 v15, v15, v11
s_nop 0
v_readfirstlane_b32 s60, v15
s_nop 0
s_cmp_ge_u32 s60, 4
s_cbranch_scc1 L_ckd62
ds_read_b128 v[8:11], v12 offset:0
s_waitcnt lgkmcnt(0)
s_branch L_ck61
L_ckd62:
ds_read_b128 v[8:11], v12 offset:16
s_waitcnt lgkmcnt(0)
L_ck63:
v_min3_u32 v15, v8, v9, v10
v_min_u32 v15, v15, v11
s_nop 0
v_readfirstlane_b32 s60, v15
s_nop 0
s_cmp_ge_u32 s60, 2
s_cbranch_scc1 L_ckd64
ds_read_b128 v[8:11], v12 offset:16
s_waitcnt lgkmcnt(0)
s_branch L_ck63
L_ckd64:
s_add_u32 m0, s67, 65536
s_add_u32 s62, s64, 256
s_and_b32 s62, s62, 0x3ff
buffer_load_dwordx4 v244, s[48:51], s62 offen offset:0 lds
buffer_load_dwordx4 v245, s[48:51], s62 offen offset:1024 lds
buffer_load_dwordx4 v246, s[48:51], s62 offen offset:2048 lds
buffer_load_dwordx4 v247, s[48:51], s62 offen offset:3072 lds
s_add_u32 m0, s67, 81920
s_nop 0
buffer_load_dwordx4 v244, s[52:55], s62 offen offset:0 lds
buffer_load_dwordx4 v245, s[52:55], s62 offen offset:1024 lds
buffer_load_dwordx4 v246, s[52:55], s62 offen offset:2048 lds
buffer_load_dwordx4 v247, s[52:55], s62 offen offset:3072 lds
s_mov_b32 s92, 0
L_w65:
global_load_dword v8, v18, s[32:33] sc1
s_waitcnt vmcnt(0)
v_cmp_ne_u32 vcc, s37, v8
s_nop 0
s_cbranch_vccz L_wd66
s_sleep 4
s_add_u32 s92, s92, 1
s_cmp_lt_u32 s92, 200000
s_cbranch_scc1 L_w65
L_wd66:
v_mov_b32 v14, 5
s_mov_b64 exec, 1
ds_write_b32 v13, v14
s_mov_b64 exec, -1
s_add_u32 s63, s65, 8192
s_and_b32 s63, s63, 0xffff
buffer_load_dwordx4 v[180:183], v2, s[40:43], s63 offen offset:0 sc1
buffer_load_dwordx4 v[184:187], v2, s[40:43], s63 offen offset:1024 sc1
buffer_load_dwordx4 v[188:191], v2, s[40:43], s63 offen offset:2048 sc1
buffer_load_dwordx4 v[192:195], v2, s[40:43], s63 offen offset:3072 sc1
s_add_u32 m0, s67, 98304
s_add_u32 s62, s64, 384
s_and_b32 s62, s62, 0x3ff
buffer_load_dwordx4 v244, s[48:51], s62 offen offset:0 lds
buffer_load_dwordx4 v245, s[48:51], s62 offen offset:1024 lds
buffer_load_dwordx4 v246, s[48:51], s62 offen offset:2048 lds
buffer_load_dwordx4 v247, s[48:51], s62 offen offset:3072 lds
s_add_u32 s63, s65, 12288
s_and_b32 s63, s63, 0xffff
buffer_load_dwordx4 v[196:199], v2, s[40:43], s63 offen offset:0 sc1
buffer_load_dwordx4 v[200:203], v2, s[40:43], s63 offen offset:1024 sc1
buffer_load_dwordx4 v[204:207], v2, s[40:43], s63 offen offset:2048 sc1
buffer_load_dwordx4 v[208:211], v2, s[40:43], s63 offen offset:3072 sc1
ds_read_b128 v[8:11], v12 offset:0
s_waitcnt lgkmcnt(0)
L_ck67:
v_min3_u32 v15, v8, v9, v10
v_min_u32 v15, v15, v11
s_nop 0
v_readfirstlane_b32 s60, v15
s_nop 0
s_cmp_ge_u32 s60, 5
s_cbranch_scc1 L_ckd68
ds_read_b128 v[8:11], v12 offset:0
s_waitcnt lgkmcnt(0)
s_branch L_ck67
L_ckd68:
ds_read_b128 v[96:99], v20 offset:32768
ds_read_b128 v[100:103], v20 offset:36864
ds_read_b128 v[104:107], v20 offset:40960
ds_read_b128 v[108:111], v20 offset:45056
s_waitcnt vmcnt(11) lgkmcnt(3)
v_mfma_f32_32x32x16_bf16 v[32:47], v[180:183], v[96:99], v[32:47]
ds_read_b128 v[112:115], v21 offset:32768
ds_read_b128 v[116:119], v21 offset:36864
s_waitcnt lgkmcnt(4)
v_mfma_f32_32x32x16_bf16 v[48:63], v[180:183], v[100:103], v[48:63]
ds_read_b128 v[120:123], v21 offset:40960
ds_read_b128 v[124:127], v21 offset:45056
s_waitcnt lgkmcnt(5)
v_mfma_f32_32x32x16_bf16 v[64:79], v[180:183], v[104:107], v[64:79]
s_waitcnt lgkmcnt(4)
v_mfma_f32_32x32x16_bf16 v[80:95], v[180:183], v[108:111], v[80:95]
s_add_u32 s63, s65, 16384
s_and_b32 s63, s63, 0xffff
buffer_load_dwordx4 v[212:215], v2, s[40:43], s63 offen offset:0 sc1
buffer_load_dwordx4 v[216:219], v2, s[40:43], s63 offen offset:1024 sc1
s_waitcnt vmcnt(12) lgkmcnt(3)
v_mfma_f32_32x32x16_bf16 v[32:47], v[184:187], v[112:115], v[32:47]
ds_read_b128 v[96:99], v22 offset:32768
ds_read_b128 v[100:103], v22 offset:36864
s_waitcnt lgkmcnt(4)
v_mfma_f32_32x32x16_bf16 v[48:63], v[184:187], v[116:119], v[48:63]
ds_read_b128 v[104:107], v22 offset:40960
ds_read_b128 v[108:111], v22 offset:45056
s_waitcnt lgkmcnt(5)
v_mfma_f32_32x32x16_bf16 v[64:79], v[184:187], v[120:123], v[64:79]
s_waitcnt lgkmcnt(4)
v_mfma_f32_32x32x16_bf16 v[80:95], v[184:187], v[124:127], v[80:95]
buffer_load_dwordx4 v[220:223], v2, s[40:43], s63 offen offset:2048 sc1
buffer_load_dwordx4 v[224:227], v2, s[40:43], s63 offen offset:3072 sc1
s_waitcnt vmcnt(13) lgkmcnt(3)
v_mfma_f32_32x32x16_bf16 v[32:47], v[188:191], v[96:99], v[32:47]
ds_read_b128 v[112:115], v23 offset:32768
ds_read_b128 v[116:119], v23 offset:36864
s_waitcnt lgkmcnt(4)
v_mfma_f32_32x32x16_bf16 v[48:63], v[188:191], v[100:103], v[48:63]
ds_read_b128 v[120:123], v23 offset:40960
ds_read_b128 v[124:127], v23 offset:45056
s_waitcnt lgkmcnt(5)
v_mfma_f32_32x32x16_bf16 v[64:79], v[188:191], v[104:107], v[64:79]
s_waitcnt lgkmcnt(4)
v_mfma_f32_32x32x16_bf16 v[80:95], v[188:191], v[108:111], v[80:95]
s_add_u32 s63, s65, 20480
s_and_b32 s63, s63, 0xffff
buffer_load_dwordx4 v[228:231], v2, s[40:43], s63 offen offset:0 sc1
buffer_load_dwordx4 v[232:235], v2, s[40:43], s63 offen offset:1024 sc1
s_waitcnt vmcnt(14) lgkmcnt(3)
v_mfma_f32_32x32x16_bf16 v[32:47], v[192:195], v[112:115], v[32:47]
ds_read_b128 v[96:99], v20 offset:49152
ds_read_b128 v[100:103], v20 offset:53248
s_waitcnt lgkmcnt(4)
v_mfma_f32_32x32x16_bf16 v[48:63], v[192:195], v[116:119], v[48:63]
ds_read_b128 v[104:107], v20 offset:57344
ds_read_b128 v[108:111], v20 offset:61440
s_waitcnt lgkmcnt(5)
v_mfma_f32_32x32x16_bf16 v[64:79], v[192:195], v[120:123], v[64:79]
s_waitcnt lgkmcnt(4)
v_mfma_f32_32x32x16_bf16 v[80:95], v[192:195], v[124:127], v[80:95]
buffer_load_dwordx4 v[236:239], v2, s[40:43], s63 offen offset:2048 sc1
buffer_load_dwordx4 v[240:243], v2, s[40:43], s63 offen offset:3072 sc1
s_waitcnt vmcnt(11) lgkmcnt(3)
v_mov_b32 v14, 6
s_mov_b64 exec, 1
ds_write_b32 v13, v14
s_mov_b64 exec, -1
v_mfma_f32_32x32x16_bf16 v[32:47], v[196:199], v[96:99], v[32:47]
ds_read_b128 v[112:115], v21 offset:49152
ds_read_b128 v[116:119], v21 offset:53248
s_waitcnt lgkmcnt(5)
v_mfma_f32_32x32x16_bf16 v[48:63], v[196:199], v[100:103], v[48:63]
ds_read_b128 v[120:123], v21 offset:57344
ds_read_b128 v[124:127], v21 offset:61440
s_waitcnt lgkmcnt(6)
v_mfma_f32_32x32x16_bf16 v[64:79], v[196:199], v[104:107], v[64:79]
s_add_u32 m0, s67, 0
s_nop 0
buffer_load_dwordx4 v244, s[52:55], s62 offen offset:0 lds
s_waitcnt lgkmcnt(5)
v_mfma_f32_32x32x16_bf16 v[80:95], v[196:199], v[108:111], v[80:95]
s_add_u32 s63, s65, 24576
s_and_b32 s63, s63, 0xffff
buffer_load_dwordx4 v[148:151], v2, s[40:43], s63 offen offset:0 sc1
buffer_load_dwordx4 v[152:155], v2, s[40:43], s63 offen offset:1024 sc1
s_waitcnt vmcnt(13) lgkmcnt(3)
v_mfma_f32_32x32x16_bf16 v[32:47], v[200:203], v[112:115], v[32:47]
ds_read_b128 v[96:99], v22 offset:49152
ds_read_b128 v[100:103], v22 offset:53248
s_waitcnt lgkmcnt(4)
v_mfma_f32_32x32x16_bf16 v[48:63], v[200:203], v[116:119], v[48:63]
ds_read_b128 v[104:107], v22 offset:57344
ds_read_b128 v[108:111], v22 offset:61440
s_waitcnt lgkmcnt(5)
v_mfma_f32_32x32x16_bf16 v[64:79], v[200:203], v[120:123], v[64:79]
buffer_load_dwordx4 v245, s[52:55], s62 offen offset:1024 lds
s_waitcnt lgkmcnt(4)
v_mfma_f32_32x32x16_bf16 v[80:95], v[200:203], v[124:127], v[80:95]
buffer_load_dwordx4 v[156:159], v2, s[40:43], s63 offen offset:2048 sc1
buffer_load_dwordx4 v[160:163], v2, s[40:43], s63 offen offset:3072 sc1
s_waitcnt vmcnt(15) lgkmcnt(3)
v_mfma_f32_32x32x16_bf16 v[32:47], v[204:207], v[96:99], v[32:47]
ds_read_b128 v[112:115], v23 offset:49152
ds_read_b128 v[116:119], v23 offset:53248
s_waitcnt lgkmcnt(4)
v_mfma_f32_32x32x16_bf16 v[48:63], v[204:207], v[100:103], v[48:63]
ds_read_b128 v[120:123], v23 offset:57344
ds_read_b128 v[124:127], v23 offset:61440
s_waitcnt lgkmcnt(5)
v_mfma_f32_32x32x16_bf16 v[64:79], v[204:207], v[104:107], v[64:79]
buffer_load_dwordx4 v246, s[52:55], s62 offen offset:2048 lds
s_waitcnt lgkmcnt(4)
v_mfma_f32_32x32x16_bf16 v[80:95], v[204:207], v[108:111], v[80:95]
s_add_u32 s63, s65, 28672
s_and_b32 s63, s63, 0xffff
buffer_load_dwordx4 v[164:167], v2, s[40:43], s63 offen offset:0 sc1
buffer_load_dwordx4 v[168:171], v2, s[40:43], s63 offen offset:1024 sc1
ds_read_b128 v[8:11], v12
s_waitcnt vmcnt(17) lgkmcnt(0)
L_ck69:
v_min3_u32 v15, v8, v9, v10
v_min_u32 v15, v15, v11
s_nop 0
v_readfirstlane_b32 s60, v15
s_nop 0
s_cmp_ge_u32 s60, 6
s_cbranch_scc1 L_ckd70
ds_read_b128 v[8:11], v12 offset:0
s_waitcnt lgkmcnt(0)
s_branch L_ck69
L_ckd70:
v_mfma_f32_32x32x16_bf16 v[32:47], v[208:211], v[112:115], v[32:47]
ds_read_b128 v[96:99], v24 offset:0
ds_read_b128 v[100:103], v24 offset:4096
v_mfma_f32_32x32x16_bf16 v[48:63], v[208:211], v[116:119], v[48:63]
ds_read_b128 v[104:107], v24 offset:8192
ds_read_b128 v[108:111], v24 offset:12288
v_mfma_f32_32x32x16_bf16 v[64:79], v[208:211], v[120:123], v[64:79]
buffer_load_dwordx4 v247, s[52:55], s62 offen offset:3072 lds
v_mfma_f32_32x32x16_bf16 v[80:95], v[208:211], v[124:127], v[80:95]
buffer_load_dwordx4 v[172:175], v2, s[40:43], s63 offen offset:2048 sc1
buffer_load_dwordx4 v[176:179], v2, s[40:43], s63 offen offset:3072 sc1
s_waitcnt vmcnt(19) lgkmcnt(3)
v_mfma_f32_32x32x16_bf16 v[32:47], v[212:215], v[96:99], v[32:47]
ds_read_b128 v[112:115], v25 offset:0
ds_read_b128 v[116:119], v25 offset:4096
s_waitcnt lgkmcnt(4)
v_mfma_f32_32x32x16_bf16 v[48:63], v[212:215], v[100:103], v[48:63]
ds_read_b128 v[120:123], v25 offset:8192
ds_read_b128 v[124:127], v25 offset:12288
s_waitcnt lgkmcnt(5)
v_mfma_f32_32x32x16_bf16 v[64:79], v[212:215], v[104:107], v[64:79]
s_add_u32 m0, s67, 16384
s_add_u32 s62, s64, 512
s_and_b32 s62, s62, 0x3ff
buffer_load_dwordx4 v244, s[48:51], s62 offen offset:0 lds
s_waitcnt lgkmcnt(4)
v_mfma_f32_32x32x16_bf16 v[80:95], v[212:215], v[108:111], v[80:95]
s_add_u32 s63, s65, 32768
s_and_b32 s63, s63, 0xffff
buffer_load_dwordx4 v[180:183], v2, s[40:43], s63 offen offset:0 sc1
buffer_load_dwordx4 v[184:187], v2, s[40:43], s63 offen offset:1024 sc1
s_waitcnt vmcnt(21) lgkmcnt(3)
v_mfma_f32_32x32x16_bf16 v[32:47], v[216:219], v[112:115], v[32:47]
ds_read_b128 v[96:99], v26 offset:0
ds_read_b128 v[100:103], v26 offset:4096
s_waitcnt lgkmcnt(4)
v_mfma_f32_32x32x16_bf16 v[48:63], v[216:219], v[116:119], v[48:63]
ds_read_b128 v[104:107], v26 offset:8192
ds_read_b128 v[108:111], v26 offset:12288
s_waitcnt lgkmcnt(5)
v_mfma_f32_32x32x16_bf16 v[64:79], v[216:219], v[120:123], v[64:79]
buffer_load_dwordx4 v245, s[48:51], s62 offen offset:1024 lds
s_waitcnt lgkmcnt(4)
v_mfma_f32_32x32x16_bf16 v[80:95], v[216:219], v[124:127], v[80:95]
buffer_load_dwordx4 v[188:191], v2, s[40:43], s63 offen offset:2048 sc1
buffer_load_dwordx4 v[192:195], v2, s[40:43], s63 offen offset:3072 sc1
s_waitcnt vmcnt(23) lgkmcnt(3)
v_mfma_f32_32x32x16_bf16 v[32:47], v[220:223], v[96:99], v[32:47]
ds_read_b128 v[112:115], v27 offset:0
ds_read_b128 v[116:119], v27 offset:4096
s_waitcnt lgkmcnt(4)
v_mfma_f32_32x32x16_bf16 v[48:63], v[220:223], v[100:103], v[48:63]
ds_read_b128 v[120:123], v27 offset:8192
ds_read_b128 v[124:127], v27 offset:12288
s_waitcnt lgkmcnt(5)
v_mfma_f32_32x32x16_bf16 v[64:79], v[220:223], v[104:107], v[64:79]
buffer_load_dwordx4 v246, s[48:51], s62 offen offset:2048 lds
s_waitcnt lgkmcnt(4)
v_mfma_f32_32x32x16_bf16 v[80:95], v[220:223], v[108:111], v[80:95]
s_add_u32 s63, s65, 36864
s_and_b32 s63, s63, 0xffff
buffer_load_dwordx4 v[196:199], v2, s[40:43], s63 offen offset:0 sc1
buffer_load_dwordx4 v[200:203], v2, s[40:43], s63 offen offset:1024 sc1
s_waitcnt vmcnt(25) lgkmcnt(3)
v_mfma_f32_32x32x16_bf16 v[32:47], v[224:227], v[112:115], v[32:47]
ds_read_b128 v[96:99], v24 offset:16384
ds_read_b128 v[100:103], v24 offset:20480
s_waitcnt lgkmcnt(4)
v_mfma_f32_32x32x16_bf16 v[48:63], v[224:227], v[116:119], v[48:63]
ds_read_b128 v[104:107], v24 offset:24576
ds_read_b128 v[108:111], v24 offset:28672
s_waitcnt lgkmcnt(5)
v_mfma_f32_32x32x16_bf16 v[64:79], v[224:227], v[120:123], v[64:79]
buffer_load_dwordx4 v247, s[48:51], s62 offen offset:3072 lds
s_waitcnt lgkmcnt(4)
v_mfma_f32_32x32x16_bf16 v[80:95], v[224:227], v[124:127], v[80:95]
buffer_load_dwordx4 v[204:207], v2, s[40:43], s63 offen offset:2048 sc1
buffer_load_dwordx4 v[208:211], v2, s[40:43], s63 offen offset:3072 sc1
s_waitcnt vmcnt(14) lgkmcnt(3)
v_mov_b32 v14, 7
s_mov_b64 exec, 1
ds_write_b32 v13, v14
s_mov_b64 exec, -1
v_mfma_f32_32x32x16_bf16 v[32:47], v[228:231], v[96:99], v[32:47]
ds_read_b128 v[112:115], v25 offset:16384
ds_read_b128 v[116:119], v25 offset:20480
s_waitcnt lgkmcnt(5)
v_mfma_f32_32x32x16_bf16 v[48:63], v[228:231], v[100:103], v[48:63]
ds_read_b128 v[120:123], v25 offset:24576
ds_read_b128 v[124:127], v25 offset:28672
s_waitcnt lgkmcnt(6)
v_mfma_f32_32x32x16_bf16 v[64:79], v[228:231], v[104:107], v[64:79]
s_add_u32 m0, s67, 32768
s_nop 0
buffer_load_dwordx4 v244, s[52:55], s62 offen offset:0 lds
s_waitcnt lgkmcnt(5)
v_mfma_f32_32x32x16_bf16 v[80:95], v[228:231], v[108:111], v[80:95]
s_add_u32 s63, s65, 40960
s_and_b32 s63, s63, 0xffff
buffer_load_dwordx4 v[212:215], v2, s[40:43], s63 offen offset:0 sc1
buffer_load_dwordx4 v[216:219], v2, s[40:43], s63 offen offset:1024 sc1
s_waitcnt vmcnt(29) lgkmcnt(3)
v_mfma_f32_32x32x16_bf16 v[32:47], v[232:235], v[112:115], v[32:47]
ds_read_b128 v[96:99], v26 offset:16384
ds_read_b128 v[100:103], v26 offset:20480
s_waitcnt lgkmcnt(4)
v_mfma_f32_32x32x16_bf16 v[48:63], v[232:235], v[116:119], v[48:63]
ds_read_b128 v[104:107], v26 offset:24576
ds_read_b128 v[108:111], v26 offset:28672
s_waitcnt lgkmcnt(5)
v_mfma_f32_32x32x16_bf16 v[64:79], v[232:235], v[120:123], v[64:79]
buffer_load_dwordx4 v245, s[52:55], s62 offen offset:1024 lds
s_waitcnt lgkmcnt(4)
v_mfma_f32_32x32x16_bf16 v[80:95], v[232:235], v[124:127], v[80:95]
buffer_load_dwordx4 v[220:223], v2, s[40:43], s63 offen offset:2048 sc1
buffer_load_dwordx4 v[224:227], v2, s[40:43], s63 offen offset:3072 sc1
s_waitcnt vmcnt(31) lgkmcnt(3)
v_mfma_f32_32x32x16_bf16 v[32:47], v[236:239], v[96:99], v[32:47]
ds_read_b128 v[112:115], v27 offset:16384
ds_read_b128 v[116:119], v27 offset:20480
s_waitcnt lgkmcnt(4)
v_mfma_f32_32x32x16_bf16 v[48:63], v[236:239], v[100:103], v[48:63]
ds_read_b128 v[120:123], v27 offset:24576
ds_read_b128 v[124:127], v27 offset:28672
s_waitcnt lgkmcnt(5)
v_mfma_f32_32x32x16_bf16 v[64:79], v[236:239], v[104:107], v[64:79]
buffer_load_dwordx4 v246, s[52:55], s62 offen offset:2048 lds
s_waitcnt lgkmcnt(4)
v_mfma_f32_32x32x16_bf16 v[80:95], v[236:239], v[108:111], v[80:95]
s_add_u32 s63, s65, 45056
s_and_b32 s63, s63, 0xffff
buffer_load_dwordx4 v[228:231], v2, s[40:43], s63 offen offset:0 sc1
buffer_load_dwordx4 v[232:235], v2, s[40:43], s63 offen offset:1024 sc1
ds_read_b128 v[8:11], v12
s_waitcnt vmcnt(33) lgkmcnt(0)
L_ck71:
v_min3_u32 v15, v8, v9, v10
v_min_u32 v15, v15, v11
s_nop 0
v_readfirstlane_b32 s60, v15
s_nop 0
s_cmp_ge_u32 s60, 7
s_cbranch_scc1 L_ckd72
ds_read_b128 v[8:11], v12 offset:0
s_waitcnt lgkmcnt(0)
s_branch L_ck71
L_ckd72:
v_mfma_f32_32x32x16_bf16 v[32:47], v[240:243], v[112:115], v[32:47]
ds_read_b128 v[96:99], v24 offset:32768
ds_read_b128 v[100:103], v24 offset:36864
v_mfma_f32_32x32x16_bf16 v[48:63], v[240:243], v[116:119], v[48:63]
ds_read_b128 v[104:107], v24 offset:40960
ds_read_b128 v[108:111], v24 offset:45056
v_mfma_f32_32x32x16_bf16 v[64:79], v[240:243], v[120:123], v[64:79]
buffer_load_dwordx4 v247, s[52:55], s62 offen offset:3072 lds
v_mfma_f32_32x32x16_bf16 v[80:95], v[240:243], v[124:127], v[80:95]
buffer_load_dwordx4 v[236:239], v2, s[40:43], s63 offen offset:2048 sc1
buffer_load_dwordx4 v[240:243], v2, s[40:43], s63 offen offset:3072 sc1
s_waitcnt vmcnt(34) lgkmcnt(3)
v_mfma_f32_32x32x16_bf16 v[32:47], v[148:151], v[96:99], v[32:47]
ds_read_b128 v[112:115], v25 offset:32768
ds_read_b128 v[116:119], v25 offset:36864
s_waitcnt lgkmcnt(4)
v_mfma_f32_32x32x16_bf16 v[48:63], v[148:151], v[100:103], v[48:63]
ds_read_b128 v[120:123], v25 offset:40960
ds_read_b128 v[124:127], v25 offset:45056
s_waitcnt lgkmcnt(5)
v_mfma_f32_32x32x16_bf16 v[64:79], v[148:151], v[104:107], v[64:79]
s_add_u32 m0, s67, 49152
s_add_u32 s62, s64, 640
s_and_b32 s62, s62, 0x3ff
buffer_load_dwordx4 v244, s[48:51], s62 offen offset:0 lds
s_waitcnt lgkmcnt(4)
v_mfma_f32_32x32x16_bf16 v[80:95], v[148:151], v[108:111], v[80:95]
s_add_u32 s63, s65, 49152
s_and_b32 s63, s63, 0xffff
buffer_load_dwordx4 v[148:151], v2, s[40:43], s63 offen offset:0 sc1
s_waitcnt vmcnt(35) lgkmcnt(3)
v_mfma_f32_32x32x16_bf16 v[32:47], v[152:155], v[112:115], v[32:47]
ds_read_b128 v[96:99], v26 offset:32768
ds_read_b128 v[100:103], v26 offset:36864
s_waitcnt lgkmcnt(4)
v_mfma_f32_32x32x16_bf16 v[48:63], v[152:155], v[116:119], v[48:63]
ds_read_b128 v[104:107], v26 offset:40960
ds_read_b128 v[108:111], v26 offset:45056
s_waitcnt lgkmcnt(5)
v_mfma_f32_32x32x16_bf16 v[64:79], v[152:155], v[120:123], v[64:79]
buffer_load_dwordx4 v245, s[48:51], s62 offen offset:1024 lds
s_waitcnt lgkmcnt(4)
v_mfma_f32_32x32x16_bf16 v[80:95], v[152:155], v[124:127], v[80:95]
buffer_load_dwordx4 v[152:155], v2, s[40:43], s63 offen offset:1024 sc1
s_waitcnt vmcnt(35) lgkmcnt(3)
v_mfma_f32_32x32x16_bf16 v[32:47], v[156:159], v[96:99], v[32:47]
ds_read_b128 v[112:115], v27 offset:32768
ds_read_b128 v[116:119], v27 offset:36864
s_waitcnt lgkmcnt(4)
v_mfma_f32_32x32x16_bf16 v[48:63], v[156:159], v[100:103], v[48:63]
ds_read_b128 v[120:123], v27 offset:40960
ds_read_b128 v[124:127], v27 offset:45056
s_waitcnt lgkmcnt(5)
v_mfma_f32_32x32x16_bf16 v[64:79], v[156:159], v[104:107], v[64:79]
buffer_load_dwordx4 v246, s[48:51], s62 offen offset:2048 lds
s_waitcnt lgkmcnt(4)
v_mfma_f32_32x32x16_bf16 v[80:95], v[156:159], v[108:111], v[80:95]
buffer_load_dwordx4 v[156:159], v2, s[40:43], s63 offen offset:2048 sc1
s_waitcnt vmcnt(36) lgkmcnt(3)
v_mfma_f32_32x32x16_bf16 v[32:47], v[160:163], v[112:115], v[32:47]
ds_read_b128 v[96:99], v20 offset:0
ds_read_b128 v[100:103], v20 offset:4096
s_waitcnt lgkmcnt(4)
v_mfma_f32_32x32x16_bf16 v[48:63], v[160:163], v[116:119], v[48:63]
ds_read_b128 v[104:107], v20 offset:8192
ds_read_b128 v[108:111], v20 offset:12288
s_waitcnt lgkmcnt(5)
v_mfma_f32_32x32x16_bf16 v[64:79], v[160:163], v[120:123], v[64:79]
buffer_load_dwordx4 v247, s[48:51], s62 offen offset:3072 lds
s_waitcnt lgkmcnt(4)
v_mfma_f32_32x32x16_bf16 v[80:95], v[160:163], v[124:127], v[80:95]
buffer_load_dwordx4 v[160:163], v2, s[40:43], s63 offen offset:3072 sc1
s_waitcnt vmcnt(10) lgkmcnt(3)
v_mov_b32 v14, 8
s_mov_b64 exec, 1
ds_write_b32 v13, v14
s_mov_b64 exec, -1
v_mfma_f32_32x32x16_bf16 v[32:47], v[164:167], v[96:99], v[32:47]
ds_read_b128 v[112:115], v21 offset:0
ds_read_b128 v[116:119], v21 offset:4096
s_waitcnt lgkmcnt(5)
v_mfma_f32_32x32x16_bf16 v[48:63], v[164:167], v[100:103], v[48:63]
ds_read_b128 v[120:123], v21 offset:8192
ds_read_b128 v[124:127], v21 offset:12288
s_waitcnt lgkmcnt(6)
v_mfma_f32_32x32x16_bf16 v[64:79], v[164:167], v[104:107], v[64:79]
s_add_u32 m0, s67, 65536
s_nop 0
buffer_load_dwordx4 v244, s[52:55], s62 offen offset:0 lds
s_waitcnt lgkmcnt(5)
v_mfma_f32_32x32x16_bf16 v[80:95], v[164:167], v[108:111], v[80:95]
s_add_u32 s63, s65, 53248
s_and_b32 s63, s63, 0xffff
buffer_load_dwordx4 v[164:167], v2, s[40:43], s63 offen offset:0 sc1
s_waitcnt vmcnt(37) lgkmcnt(3)
v_mfma_f32_32x32x16_bf16 v[32:47], v[168:171], v[112:115], v[32:47]
ds_read_b128 v[96:99], v22 offset:0
ds_read_b128 v[100:103], v22 offset:4096
s_waitcnt lgkmcnt(4)
v_mfma_f32_32x32x16_bf16 v[48:63], v[168:171], v[116:119], v[48:63]
ds_read_b128 v[104:107], v22 offset:8192
ds_read_b128 v[108:111], v22 offset:12288
s_waitcnt lgkmcnt(5)
v_mfma_f32_32x32x16_bf16 v[64:79], v[168:171], v[120:123], v[64:79]
buffer_load_dwordx4 v245, s[52:55], s62 offen offset:1024 lds
s_waitcnt lgkmcnt(4)
v_mfma_f32_32x32x16_bf16 v[80:95], v[168:171], v[124:127], v[80:95]
buffer_load_dwordx4 v[168:171], v2, s[40:43], s63 offen offset:1024 sc1
s_waitcnt vmcnt(37) lgkmcnt(3)
v_mfma_f32_32x32x16_bf16 v[32:47], v[172:175], v[96:99], v[32:47]
ds_read_b128 v[112:115], v23 offset:0
ds_read_b128 v[116:119], v23 offset:4096
s_waitcnt lgkmcnt(4)
v_mfma_f32_32x32x16_bf16 v[48:63], v[172:175], v[100:103], v[48:63]
ds_read_b128 v[120:123], v23 offset:8192
ds_read_b128 v[124:127], v23 offset:12288
s_waitcnt lgkmcnt(5)
v_mfma_f32_32x32x16_bf16 v[64:79], v[172:175], v[104:107], v[64:79]
buffer_load_dwordx4 v246, s[52:55], s62 offen offset:2048 lds
s_waitcnt lgkmcnt(4)
v_mfma_f32_32x32x16_bf16 v[80:95], v[172:175], v[108:111], v[80:95]
buffer_load_dwordx4 v[172:175], v2, s[40:43], s63 offen offset:2048 sc1
ds_read_b128 v[8:11], v12
s_waitcnt vmcnt(38) lgkmcnt(0)
L_ck73:
v_min3_u32 v15, v8, v9, v10
v_min_u32 v15, v15, v11
s_nop 0
v_readfirstlane_b32 s60, v15
s_nop 0
s_cmp_ge_u32 s60, 8
s_cbranch_scc1 L_ckd74
ds_read_b128 v[8:11], v12 offset:0
s_waitcnt lgkmcnt(0)
s_branch L_ck73
L_ckd74:
v_mfma_f32_32x32x16_bf16 v[32:47], v[176:179], v[112:115], v[32:47]
ds_read_b128 v[96:99], v20 offset:16384
ds_read_b128 v[100:103], v20 offset:20480
v_mfma_f32_32x32x16_bf16 v[48:63], v[176:179], v[116:119], v[48:63]
ds_read_b128 v[104:107], v20 offset:24576
ds_read_b128 v[108:111], v20 offset:28672
v_mfma_f32_32x32x16_bf16 v[64:79], v[176:179], v[120:123], v[64:79]
buffer_load_dwordx4 v247, s[52:55], s62 offen offset:3072 lds
v_mfma_f32_32x32x16_bf16 v[80:95], v[176:179], v[124:127], v[80:95]
buffer_load_dwordx4 v[176:179], v2, s[40:43], s63 offen offset:3072 sc1
s_waitcnt vmcnt(38) lgkmcnt(3)
v_mfma_f32_32x32x16_bf16 v[32:47], v[180:183], v[96:99], v[32:47]
ds_read_b128 v[112:115], v21 offset:16384
ds_read_b128 v[116:119], v21 offset:20480
s_waitcnt lgkmcnt(4)
v_mfma_f32_32x32x16_bf16 v[48:63], v[180:183], v[100:103], v[48:63]
ds_read_b128 v[120:123], v21 offset:24576
ds_read_b128 v[124:127], v21 offset:28672
s_waitcnt lgkmcnt(5)
v_mfma_f32_32x32x16_bf16 v[64:79], v[180:183], v[104:107], v[64:79]
s_add_u32 m0, s67, 81920
s_add_u32 s62, s64, 768
s_and_b32 s62, s62, 0x3ff
buffer_load_dwordx4 v244, s[48:51], s62 offen offset:0 lds
s_waitcnt lgkmcnt(4)
v_mfma_f32_32x32x16_bf16 v[80:95], v[180:183], v[108:111], v[80:95]
s_add_u32 s63, s65, 57344
s_and_b32 s63, s63, 0xffff
buffer_load_dwordx4 v[180:183], v2, s[40:43], s63 offen offset:0 sc1
s_waitcnt vmcnt(39) lgkmcnt(3)
v_mfma_f32_32x32x16_bf16 v[32:47], v[184:187], v[112:115], v[32:47]
ds_read_b128 v[96:99], v22 offset:16384
ds_read_b128 v[100:103], v22 offset:20480
s_waitcnt lgkmcnt(4)
v_mfma_f32_32x32x16_bf16 v[48:63], v[184:187], v[116:119], v[48:63]
ds_read_b128 v[104:107], v22 offset:24576
ds_read_b128 v[108:111], v22 offset:28672
s_waitcnt lgkmcnt(5)
v_mfma_f32_32x32x16_bf16 v[64:79], v[184:187], v[120:123], v[64:79]
buffer_load_dwordx4 v245, s[48:51], s62 offen offset:1024 lds
s_waitcnt lgkmcnt(4)
v_mfma_f32_32x32x16_bf16 v[80:95], v[184:187], v[124:127], v[80:95]
buffer_load_dwordx4 v[184:187], v2, s[40:43], s63 offen offset:1024 sc1
s_waitcnt vmcnt(39) lgkmcnt(3)
v_mfma_f32_32x32x16_bf16 v[32:47], v[188:191], v[96:99], v[32:47]
ds_read_b128 v[112:115], v23 offset:16384
ds_read_b128 v[116:119], v23 offset:20480
s_waitcnt lgkmcnt(4)
v_mfma_f32_32x32x16_bf16 v[48:63], v[188:191], v[100:103], v[48:63]
ds_read_b128 v[120:123], v23 offset:24576
ds_read_b128 v[124:127], v23 offset:28672
s_waitcnt lgkmcnt(5)
v_mfma_f32_32x32x16_bf16 v[64:79], v[188:191], v[104:107], v[64:79]
buffer_load_dwordx4 v246, s[48:51], s62 offen offset:2048 lds
s_waitcnt lgkmcnt(4)
v_mfma_f32_32x32x16_bf16 v[80:95], v[188:191], v[108:111], v[80:95]
buffer_load_dwordx4 v[188:191], v2, s[40:43], s63 offen offset:2048 sc1
s_waitcnt vmcnt(40) lgkmcnt(3)
v_mfma_f32_32x32x16_bf16 v[32:47], v[192:195], v[112:115], v[32:47]
ds_read_b128 v[96:99], v20 offset:32768
ds_read_b128 v[100:103], v20 offset:36864
s_waitcnt lgkmcnt(4)
v_mfma_f32_32x32x16_bf16 v[48:63], v[192:195], v[116:119], v[48:63]
ds_read_b128 v[104:107], v20 offset:40960
ds_read_b128 v[108:111], v20 offset:45056
s_waitcnt lgkmcnt(5)
v_mfma_f32_32x32x16_bf16 v[64:79], v[192:195], v[120:123], v[64:79]
buffer_load_dwordx4 v247, s[48:51], s62 offen offset:3072 lds
s_waitcnt lgkmcnt(4)
v_mfma_f32_32x32x16_bf16 v[80:95], v[192:195], v[124:127], v[80:95]
buffer_load_dwordx4 v[192:195], v2, s[40:43], s63 offen offset:3072 sc1
s_waitcnt vmcnt(9) lgkmcnt(3)
v_mov_b32 v14, 9
s_mov_b64 exec, 1
ds_write_b32 v13, v14
s_mov_b64 exec, -1
v_mfma_f32_32x32x16_bf16 v[32:47], v[196:199], v[96:99], v[32:47]
ds_read_b128 v[112:115], v21 offset:32768
ds_read_b128 v[116:119], v21 offset:36864
s_waitcnt lgkmcnt(5)
v_mfma_f32_32x32x16_bf16 v[48:63], v[196:199], v[100:103], v[48:63]
ds_read_b128 v[120:123], v21 offset:40960
ds_read_b128 v[124:127], v21 offset:45056
s_waitcnt lgkmcnt(6)
v_mfma_f32_32x32x16_bf16 v[64:79], v[196:199], v[104:107], v[64:79]
s_add_u32 m0, s67, 98304
s_nop 0
buffer_load_dwordx4 v244, s[52:55], s62 offen offset:0 lds
s_waitcnt lgkmcnt(5)
v_mfma_f32_32x32x16_bf16 v[80:95], v[196:199], v[108:111], v[80:95]
s_add_u32 s63, s65, 61440
s_and_b32 s63, s63, 0xffff
buffer_load_dwordx4 v[196:199], v2, s[40:43], s63 offen offset:0 sc1
s_waitcnt vmcnt(41) lgkmcnt(3)
v_mfma_f32_32x32x16_bf16 v[32:47], v[200:203], v[112:115], v[32:47]
ds_read_b128 v[96:99], v22 offset:32768
ds_read_b128 v[100:103], v22 offset:36864
s_waitcnt lgkmcnt(4)
v_mfma_f32_32x32x16_bf16 v[48:63], v[200:203], v[116:119], v[48:63]
ds_read_b128 v[104:107], v22 offset:40960
ds_read_b128 v[108:111], v22 offset:45056
s_waitcnt lgkmcnt(5)
v_mfma_f32_32x32x16_bf16 v[64:79], v[200:203], v[120:123], v[64:79]
buffer_load_dwordx4 v245, s[52:55], s62 offen offset:1024 lds
s_waitcnt lgkmcnt(4)
v_mfma_f32_32x32x16_bf16 v[80:95], v[200:203], v[124:127], v[80:95]
buffer_load_dwordx4 v[200:203], v2, s[40:43], s63 offen offset:1024 sc1
s_waitcnt vmcnt(41) lgkmcnt(3)
v_mfma_f32_32x32x16_bf16 v[32:47], v[204:207], v[96:99], v[32:47]
ds_read_b128 v[112:115], v23 offset:32768
ds_read_b128 v[116:119], v23 offset:36864
s_waitcnt lgkmcnt(4)
v_mfma_f32_32x32x16_bf16 v[48:63], v[204:207], v[100:103], v[48:63]
ds_read_b128 v[120:123], v23 offset:40960
ds_read_b128 v[124:127], v23 offset:45056
s_waitcnt lgkmcnt(5)
v_mfma_f32_32x32x16_bf16 v[64:79], v[204:207], v[104:107], v[64:79]
buffer_load_dwordx4 v246, s[52:55], s62 offen offset:2048 lds
s_waitcnt lgkmcnt(4)
v_mfma_f32_32x32x16_bf16 v[80:95], v[204:207], v[108:111], v[80:95]
buffer_load_dwordx4 v[204:207], v2, s[40:43], s63 offen offset:2048 sc1
ds_read_b128 v[8:11], v12
s_waitcnt vmcnt(42) lgkmcnt(0)
L_ck75:
v_min3_u32 v15, v8, v9, v10
v_min_u32 v15, v15, v11
s_nop 0
v_readfirstlane_b32 s60, v15
s_nop 0
s_cmp_ge_u32 s60, 9
s_cbranch_scc1 L_ckd76
ds_read_b128 v[8:11], v12 offset:0
s_waitcnt lgkmcnt(0)
s_branch L_ck75
L_ckd76:
v_mfma_f32_32x32x16_bf16 v[32:47], v[208:211], v[112:115], v[32:47]
ds_read_b128 v[96:99], v20 offset:49152
ds_read_b128 v[100:103], v20 offset:53248
v_mfma_f32_32x32x16_bf16 v[48:63], v[208:211], v[116:119], v[48:63]
ds_read_b128 v[104:107], v20 offset:57344
ds_read_b128 v[108:111], v20 offset:61440
v_mfma_f32_32x32x16_bf16 v[64:79], v[208:211], v[120:123], v[64:79]
buffer_load_dwordx4 v247, s[52:55], s62 offen offset:3072 lds
v_mfma_f32_32x32x16_bf16 v[80:95], v[208:211], v[124:127], v[80:95]
buffer_load_dwordx4 v[208:211], v2, s[40:43], s63 offen offset:3072 sc1
s_waitcnt vmcnt(42) lgkmcnt(3)
v_mfma_f32_32x32x16_bf16 v[32:47], v[212:215], v[96:99], v[32:47]
ds_read_b128 v[112:115], v21 offset:49152
ds_read_b128 v[116:119], v21 offset:53248
s_waitcnt lgkmcnt(4)
v_mfma_f32_32x32x16_bf16 v[48:63], v[212:215], v[100:103], v[48:63]
ds_read_b128 v[120:123], v21 offset:57344
ds_read_b128 v[124:127], v21 offset:61440
s_waitcnt lgkmcnt(5)
v_mfma_f32_32x32x16_bf16 v[64:79], v[212:215], v[104:107], v[64:79]
s_add_u32 m0, s67, 0
s_add_u32 s62, s64, 896
s_and_b32 s62, s62, 0x3ff
buffer_load_dwordx4 v244, s[48:51], s62 offen offset:0 lds
s_waitcnt lgkmcnt(4)
v_mfma_f32_32x32x16_bf16 v[80:95], v[212:215], v[108:111], v[80:95]
s_waitcnt vmcnt(42) lgkmcnt(3)
v_mfma_f32_32x32x16_bf16 v[32:47], v[216:219], v[112:115], v[32:47]
ds_read_b128 v[96:99], v22 offset:49152
ds_read_b128 v[100:103], v22 offset:53248
s_waitcnt lgkmcnt(4)
v_mfma_f32_32x32x16_bf16 v[48:63], v[216:219], v[116:119], v[48:63]
ds_read_b128 v[104:107], v22 offset:57344
ds_read_b128 v[108:111], v22 offset:61440
s_waitcnt lgkmcnt(5)
v_mfma_f32_32x32x16_bf16 v[64:79], v[216:219], v[120:123], v[64:79]
buffer_load_dwordx4 v245, s[48:51], s62 offen offset:1024 lds
s_waitcnt lgkmcnt(4)
v_mfma_f32_32x32x16_bf16 v[80:95], v[216:219], v[124:127], v[80:95]
s_waitcnt vmcnt(41) lgkmcnt(3)
v_mfma_f32_32x32x16_bf16 v[32:47], v[220:223], v[96:99], v[32:47]
ds_read_b128 v[112:115], v23 offset:49152
ds_read_b128 v[116:119], v23 offset:53248
s_waitcnt lgkmcnt(4)
v_mfma_f32_32x32x16_bf16 v[48:63], v[220:223], v[100:103], v[48:63]
ds_read_b128 v[120:123], v23 offset:57344
ds_read_b128 v[124:127], v23 offset:61440
s_waitcnt lgkmcnt(5)
v_mfma_f32_32x32x16_bf16 v[64:79], v[220:223], v[104:107], v[64:79]
buffer_load_dwordx4 v246, s[48:51], s62 offen offset:2048 lds
s_waitcnt lgkmcnt(4)
v_mfma_f32_32x32x16_bf16 v[80:95], v[220:223], v[108:111], v[80:95]
s_waitcnt vmcnt(41) lgkmcnt(3)
v_mfma_f32_32x32x16_bf16 v[32:47], v[224:227], v[112:115], v[32:47]
ds_read_b128 v[96:99], v24 offset:0
ds_read_b128 v[100:103], v24 offset:4096
s_waitcnt lgkmcnt(4)
v_mfma_f32_32x32x16_bf16 v[48:63], v[224:227], v[116:119], v[48:63]
ds_read_b128 v[104:107], v24 offset:8192
ds_read_b128 v[108:111], v24 offset:12288
s_waitcnt lgkmcnt(5)
v_mfma_f32_32x32x16_bf16 v[64:79], v[224:227], v[120:123], v[64:79]
buffer_load_dwordx4 v247, s[48:51], s62 offen offset:3072 lds
s_waitcnt lgkmcnt(4)
v_mfma_f32_32x32x16_bf16 v[80:95], v[224:227], v[124:127], v[80:95]
s_waitcnt vmcnt(5) lgkmcnt(3)
v_mov_b32 v14, 10
s_mov_b64 exec, 1
ds_write_b32 v13, v14
s_mov_b64 exec, -1
v_mfma_f32_32x32x16_bf16 v[32:47], v[228:231], v[96:99], v[32:47]
ds_read_b128 v[112:115], v25 offset:0
ds_read_b128 v[116:119], v25 offset:4096
s_waitcnt lgkmcnt(5)
v_mfma_f32_32x32x16_bf16 v[48:63], v[228:231], v[100:103], v[48:63]
ds_read_b128 v[120:123], v25 offset:8192
ds_read_b128 v[124:127], v25 offset:12288
s_waitcnt lgkmcnt(6)
v_mfma_f32_32x32x16_bf16 v[64:79], v[228:231], v[104:107], v[64:79]
s_add_u32 m0, s67, 16384
s_nop 0
buffer_load_dwordx4 v244, s[52:55], s62 offen offset:0 lds
s_waitcnt lgkmcnt(5)
v_mfma_f32_32x32x16_bf16 v[80:95], v[228:231], v[108:111], v[80:95]
s_waitcnt vmcnt(40) lgkmcnt(3)
v_mfma_f32_32x32x16_bf16 v[32:47], v[232:235], v[112:115], v[32:47]
ds_read_b128 v[96:99], v26 offset:0
ds_read_b128 v[100:103], v26 offset:4096
s_waitcnt lgkmcnt(4)
v_mfma_f32_32x32x16_bf16 v[48:63], v[232:235], v[116:119], v[48:63]
ds_read_b128 v[104:107], v26 offset:8192
ds_read_b128 v[108:111], v26 offset:12288
s_waitcnt lgkmcnt(5)
v_mfma_f32_32x32x16_bf16 v[64:79], v[232:235], v[120:123], v[64:79]
buffer_load_dwordx4 v245, s[52:55], s62 offen offset:1024 lds
s_waitcnt lgkmcnt(4)
v_mfma_f32_32x32x16_bf16 v[80:95], v[232:235], v[124:127], v[80:95]
s_waitcnt vmcnt(39) lgkmcnt(3)
v_mfma_f32_32x32x16_bf16 v[32:47], v[236:239], v[96:99], v[32:47]
ds_read_b128 v[112:115], v27 offset:0
ds_read_b128 v[116:119], v27 offset:4096
s_waitcnt lgkmcnt(4)
v_mfma_f32_32x32x16_bf16 v[48:63], v[236:239], v[100:103], v[48:63]
ds_read_b128 v[120:123], v27 offset:8192
ds_read_b128 v[124:127], v27 offset:12288
s_waitcnt lgkmcnt(5)
v_mfma_f32_32x32x16_bf16 v[64:79], v[236:239], v[104:107], v[64:79]
buffer_load_dwordx4 v246, s[52:55], s62 offen offset:2048 lds
s_waitcnt lgkmcnt(4)
v_mfma_f32_32x32x16_bf16 v[80:95], v[236:239], v[108:111], v[80:95]
ds_read_b128 v[8:11], v12
s_waitcnt vmcnt(39) lgkmcnt(0)
L_ck77:
v_min3_u32 v15, v8, v9, v10
v_min_u32 v15, v15, v11
s_nop 0
v_readfirstlane_b32 s60, v15
s_nop 0
s_cmp_ge_u32 s60, 10
s_cbranch_scc1 L_ckd78
ds_read_b128 v[8:11], v12 offset:0
s_waitcnt lgkmcnt(0)
s_branch L_ck77
L_ckd78:
v_mfma_f32_32x32x16_bf16 v[32:47], v[240:243], v[112:115], v[32:47]
ds_read_b128 v[96:99], v24 offset:16384
ds_read_b128 v[100:103], v24 offset:20480
v_mfma_f32_32x32x16_bf16 v[48:63], v[240:243], v[116:119], v[48:63]
ds_read_b128 v[104:107], v24 offset:24576
ds_read_b128 v[108:111], v24 offset:28672
v_mfma_f32_32x32x16_bf16 v[64:79], v[240:243], v[120:123], v[64:79]
buffer_load_dwordx4 v247, s[52:55], s62 offen offset:3072 lds
v_mfma_f32_32x32x16_bf16 v[80:95], v[240:243], v[124:127], v[80:95]
s_waitcnt vmcnt(38) lgkmcnt(3)
v_mfma_f32_32x32x16_bf16 v[32:47], v[148:151], v[96:99], v[32:47]
ds_read_b128 v[112:115], v25 offset:16384
ds_read_b128 v[116:119], v25 offset:20480
s_waitcnt lgkmcnt(4)
v_mfma_f32_32x32x16_bf16 v[48:63], v[148:151], v[100:103], v[48:63]
ds_read_b128 v[120:123], v25 offset:24576
ds_read_b128 v[124:127], v25 offset:28672
s_waitcnt lgkmcnt(5)
v_mfma_f32_32x32x16_bf16 v[64:79], v[148:151], v[104:107], v[64:79]
s_waitcnt lgkmcnt(4)
v_mfma_f32_32x32x16_bf16 v[80:95], v[148:151], v[108:111], v[80:95]
global_load_dword v31, v30, s[26:27]
s_mov_b32 s60, 0
buffer_load_dword v128, v28, s[56:59], s60 offen offset:0
s_mov_b32 s60, 0
buffer_load_dword v129, v28, s[56:59], s60 offen offset:2048
s_mov_b32 s60, 4096
buffer_load_dword v130, v28, s[56:59], s60 offen offset:0
s_mov_b32 s60, 4096
buffer_load_dword v131, v28, s[56:59], s60 offen offset:2048
s_mov_b32 s60, 65536
buffer_load_dword v132, v28, s[56:59], s60 offen offset:0
s_mov_b32 s60, 65536
buffer_load_dword v133, v28, s[56:59], s60 offen offset:2048
s_mov_b32 s60, 69632
buffer_load_dword v134, v28, s[56:59], s60 offen offset:0
s_mov_b32 s60, 69632
buffer_load_dword v135, v28, s[56:59], s60 offen offset:2048
s_mov_b32 s60, 8192
buffer_load_dword v136, v28, s[56:59], s60 offen offset:0
s_mov_b32 s60, 8192
buffer_load_dword v137, v28, s[56:59], s60 offen offset:2048
s_mov_b32 s60, 12288
buffer_load_dword v138, v28, s[56:59], s60 offen offset:0
s_mov_b32 s60, 12288
buffer_load_dword v139, v28, s[56:59], s60 offen offset:2048
s_mov_b32 s60, 73728
buffer_load_dword v140, v28, s[56:59], s60 offen offset:0
s_mov_b32 s60, 73728
buffer_load_dword v141, v28, s[56:59], s60 offen offset:2048
s_mov_b32 s60, 77824
buffer_load_dword v142, v28, s[56:59], s60 offen offset:0
s_mov_b32 s60, 77824
buffer_load_dword v143, v28, s[56:59], s60 offen offset:2048
s_waitcnt vmcnt(53) lgkmcnt(3)
v_mfma_f32_32x32x16_bf16 v[32:47], v[152:155], v[112:115], v[32:47]
ds_read_b128 v[96:99], v26 offset:16384
ds_read_b128 v[100:103], v26 offset:20480
s_waitcnt lgkmcnt(4)
v_mfma_f32_32x32x16_bf16 v[48:63], v[152:155], v[116:119], v[48:63]
ds_read_b128 v[104:107], v26 offset:24576
ds_read_b128 v[108:111], v26 offset:28672
s_waitcnt lgkmcnt(5)
v_mfma_f32_32x32x16_bf16 v[64:79], v[152:155], v[120:123], v[64:79]
s_waitcnt lgkmcnt(4)
v_mfma_f32_32x32x16_bf16 v[80:95], v[152:155], v[124:127], v[80:95]
s_waitcnt vmcnt(51) lgkmcnt(3)
v_mfma_f32_32x32x16_bf16 v[32:47], v[156:159], v[96:99], v[32:47]
ds_read_b128 v[112:115], v27 offset:16384
ds_read_b128 v[116:119], v27 offset:20480
s_waitcnt lgkmcnt(4)
v_mfma_f32_32x32x16_bf16 v[48:63], v[156:159], v[100:103], v[48:63]
ds_read_b128 v[120:123], v27 offset:24576
ds_read_b128 v[124:127], v27 offset:28672
s_waitcnt lgkmcnt(5)
v_mfma_f32_32x32x16_bf16 v[64:79], v[156:159], v[104:107], v[64:79]
s_waitcnt lgkmcnt(4)
v_mfma_f32_32x32x16_bf16 v[80:95], v[156:159], v[108:111], v[80:95]
s_waitcnt vmcnt(49) lgkmcnt(3)
v_mfma_f32_32x32x16_bf16 v[32:47], v[160:163], v[112:115], v[32:47]
ds_read_b128 v[96:99], v24 offset:32768
ds_read_b128 v[100:103], v24 offset:36864
s_waitcnt lgkmcnt(4)
v_mfma_f32_32x32x16_bf16 v[48:63], v[160:163], v[116:119], v[48:63]
s_waitcnt lgkmcnt(3)
v_mfma_f32_32x32x16_bf16 v[64:79], v[160:163], v[120:123], v[64:79]
s_waitcnt lgkmcnt(2)
v_mfma_f32_32x32x16_bf16 v[80:95], v[160:163], v[124:127], v[80:95]
s_waitcnt vmcnt(17) lgkmcnt(1)
v_mov_b32 v14, 11
s_mov_b64 exec, 1
ds_write_b32 v13, v14
s_mov_b64 exec, -1
v_mfma_f32_32x32x16_bf16 v[32:47], v[164:167], v[96:99], v[32:47]
ds_read_b128 v[112:115], v25 offset:32768
ds_read_b128 v[116:119], v25 offset:36864
s_waitcnt lgkmcnt(3)
v_mfma_f32_32x32x16_bf16 v[48:63], v[164:167], v[100:103], v[48:63]
s_waitcnt vmcnt(45) lgkmcnt(1)
v_mfma_f32_32x32x16_bf16 v[32:47], v[168:171], v[112:115], v[32:47]
ds_read_b128 v[96:99], v26 offset:32768
ds_read_b128 v[100:103], v26 offset:36864
s_waitcnt lgkmcnt(2)
v_mfma_f32_32x32x16_bf16 v[48:63], v[168:171], v[116:119], v[48:63]
s_waitcnt vmcnt(43) lgkmcnt(1)
v_mfma_f32_32x32x16_bf16 v[32:47], v[172:175], v[96:99], v[32:47]
ds_read_b128 v[112:115], v27 offset:32768
ds_read_b128 v[116:119], v27 offset:36864
s_waitcnt lgkmcnt(2)
v_mfma_f32_32x32x16_bf16 v[48:63], v[172:175], v[100:103], v[48:63]
ds_read_b128 v[8:11], v12
s_waitcnt vmcnt(41) lgkmcnt(0)
L_ck79:
v_min3_u32 v15, v8, v9, v10
v_min_u32 v15, v15, v11
s_nop 0
v_readfirstlane_b32 s60, v15
s_nop 0
s_cmp_ge_u32 s60, 11
s_cbranch_scc1 L_ckd80
ds_read_b128 v[8:11], v12 offset:0
s_waitcnt lgkmcnt(0)
s_branch L_ck79
L_ckd80:
v_mfma_f32_32x32x16_bf16 v[32:47], v[176:179], v[112:115], v[32:47]
ds_read_b128 v[96:99], v20 offset:0
ds_read_b128 v[100:103], v20 offset:4096
v_mfma_f32_32x32x16_bf16 v[48:63], v[176:179], v[116:119], v[48:63]
s_waitcnt vmcnt(39) lgkmcnt(1)
v_mfma_f32_32x32x16_bf16 v[32:47], v[180:183], v[96:99], v[32:47]
ds_read_b128 v[112:115], v21 offset:0
ds_read_b128 v[116:119], v21 offset:4096
s_waitcnt lgkmcnt(2)
v_mfma_f32_32x32x16_bf16 v[48:63], v[180:183], v[100:103], v[48:63]
s_waitcnt vmcnt(37) lgkmcnt(1)
v_mfma_f32_32x32x16_bf16 v[32:47], v[184:187], v[112:115], v[32:47]
ds_read_b128 v[96:99], v22 offset:0
ds_read_b128 v[100:103], v22 offset:4096
s_waitcnt lgkmcnt(2)
v_mfma_f32_32x32x16_bf16 v[48:63], v[184:187], v[116:119], v[48:63]
s_waitcnt vmcnt(35) lgkmcnt(1)
v_mfma_f32_32x32x16_bf16 v[32:47], v[188:191], v[96:99], v[32:47]
ds_read_b128 v[112:115], v23 offset:0
ds_read_b128 v[116:119], v23 offset:4096
s_waitcnt lgkmcnt(2)
v_mfma_f32_32x32x16_bf16 v[48:63], v[188:191], v[100:103], v[48:63]
s_waitcnt vmcnt(33) lgkmcnt(1)
v_mfma_f32_32x32x16_bf16 v[32:47], v[192:195], v[112:115], v[32:47]
ds_read_b128 v[96:99], v20 offset:16384
ds_read_b128 v[100:103], v20 offset:20480
s_waitcnt lgkmcnt(2)
v_mfma_f32_32x32x16_bf16 v[48:63], v[192:195], v[116:119], v[48:63]
s_waitcnt vmcnt(31) lgkmcnt(1)
v_mfma_f32_32x32x16_bf16 v[32:47], v[196:199], v[96:99], v[32:47]
ds_read_b128 v[112:115], v21 offset:16384
ds_read_b128 v[116:119], v21 offset:20480
s_waitcnt lgkmcnt(2)
v_mfma_f32_32x32x16_bf16 v[48:63], v[196:199], v[100:103], v[48:63]
s_waitcnt vmcnt(29) lgkmcnt(1)
v_mfma_f32_32x32x16_bf16 v[32:47], v[200:203], v[112:115], v[32:47]
ds_read_b128 v[96:99], v22 offset:16384
ds_read_b128 v[100:103], v22 offset:20480
s_waitcnt lgkmcnt(2)
v_mfma_f32_32x32x16_bf16 v[48:63], v[200:203], v[116:119], v[48:63]
s_waitcnt vmcnt(27) lgkmcnt(1)
v_mfma_f32_32x32x16_bf16 v[32:47], v[204:207], v[96:99], v[32:47]
ds_read_b128 v[112:115], v23 offset:16384
ds_read_b128 v[116:119], v23 offset:20480
s_waitcnt lgkmcnt(2)
v_mfma_f32_32x32x16_bf16 v[48:63], v[204:207], v[100:103], v[48:63]
s_waitcnt vmcnt(25) lgkmcnt(0)
v_mfma_f32_32x32x16_bf16 v[32:47], v[208:211], v[112:115], v[32:47]
v_mfma_f32_32x32x16_bf16 v[48:63], v[208:211], v[116:119], v[48:63]
s_mul_i32 s60, s37, 0x9e3779b1
s_and_b32 s60, s60, 0xbfff0000
s_or_b32 s60, s60, 0x20000000
s_sub_u32 s61, s37, 1
s_xor_b32 s61, s61, s60
s_cmp_lt_u32 s61, 0x10000
s_cselect_b32 s61, 0x10000, 0
s_xor_b32 s60, s60, s61
s_lshl_b32 s64, s35, 4
s_add_u32 s64, s64, s36
s_lshl_b32 s64, s64, 2
s_add_u32 s64, s64, s34
s_lshl_b32 s64, s64, 13
s_add_u32 s50, s64, 33554432
s_add_u32 s48, s32, s50
s_addc_u32 s49, s33, 0
s_mov_b32 s50, 8192
s_mov_b32 s51, 0x20000
s_xor_b32 s64, s64, 262144
s_add_u32 s54, s64, 33554432
s_add_u32 s52, s32, s54
s_addc_u32 s53, s33, 0
s_mov_b32 s54, 8192
s_mov_b32 s55, 0x20000
s_movk_i32 s64, 0x1000
v_cvt_pk_bf16_f32 v96, v32, v48
v_cvt_pk_bf16_f32 v97, v33, v49
v_cvt_pk_bf16_f32 v98, v34, v50
v_cvt_pk_bf16_f32 v99, v35, s60
buffer_store_dwordx4 v[96:99], v2, s[48:51], 0 offen offset:0 sc1
v_cvt_pk_bf16_f32 v100, v51, v36
v_cvt_pk_bf16_f32 v101, v52, v37
v_cvt_pk_bf16_f32 v102, v53, v38
v_cvt_pk_bf16_f32 v103, v54, s60
buffer_store_dwordx4 v[100:103], v2, s[48:51], 0 offen offset:1024 sc1
v_cvt_pk_bf16_f32 v244, v39, v55
v_cvt_pk_bf16_f32 v245, v40, v56
v_cvt_pk_bf16_f32 v246, v41, v57
v_cvt_pk_bf16_f32 v247, v42, s60
buffer_store_dwordx4 v[244:247], v2, s[48:51], 0 offen offset:2048 sc1
v_cvt_pk_bf16_f32 v248, v58, v43
v_cvt_pk_bf16_f32 v249, v59, v44
v_cvt_pk_bf16_f32 v250, v60, v45
v_cvt_pk_bf16_f32 v251, v61, s60
buffer_store_dwordx4 v[248:251], v2, s[48:51], 0 offen offset:3072 sc1
v_cvt_pk_bf16_f32 v252, v46, v62
v_cvt_pk_bf16_f32 v253, v47, v63
v_cvt_pk_bf16_f32 v254, v63, v63
v_cvt_pk_bf16_f32 v255, v63, s60
buffer_store_dwordx4 v[252:255], v2, s[48:51], s64 offen offset:0 sc1
ds_read_b128 v[104:107], v24 offset:40960
ds_read_b128 v[108:111], v24 offset:45056
ds_read_b128 v[120:123], v25 offset:40960
ds_read_b128 v[124:127], v25 offset:45056
s_waitcnt lgkmcnt(2)
v_mfma_f32_32x32x16_bf16 v[64:79], v[164:167], v[104:107], v[64:79]
v_mfma_f32_32x32x16_bf16 v[80:95], v[164:167], v[108:111], v[80:95]
ds_read_b128 v[104:107], v26 offset:40960
ds_read_b128 v[108:111], v26 offset:45056
s_waitcnt lgkmcnt(2)
v_mfma_f32_32x32x16_bf16 v[64:79], v[168:171], v[120:123], v[64:79]
v_mfma_f32_32x32x16_bf16 v[80:95], v[168:171], v[124:127], v[80:95]
ds_read_b128 v[120:123], v27 offset:40960
ds_read_b128 v[124:127], v27 offset:45056
s_waitcnt lgkmcnt(2)
v_mfma_f32_32x32x16_bf16 v[64:79], v[172:175], v[104:107], v[64:79]
v_mfma_f32_32x32x16_bf16 v[80:95], v[172:175], v[108:111], v[80:95]
ds_read_b128 v[104:107], v20 offset:8192
ds_read_b128 v[108:111], v20 offset:12288
s_waitcnt lgkmcnt(2)
v_mfma_f32_32x32x16_bf16 v[64:79], v[176:179], v[120:123], v[64:79]
v_mfma_f32_32x32x16_bf16 v[80:95], v[176:179], v[124:127], v[80:95]
ds_read_b128 v[120:123], v21 offset:8192
ds_read_b128 v[124:127], v21 offset:12288
s_waitcnt lgkmcnt(2)
v_mfma_f32_32x32x16_bf16 v[64:79], v[180:183], v[104:107], v[64:79]
v_mfma_f32_32x32x16_bf16 v[80:95], v[180:183], v[108:111], v[80:95]
ds_read_b128 v[104:107], v22 offset:8192
ds_read_b128 v[108:111], v22 offset:12288
s_waitcnt lgkmcnt(2)
v_mfma_f32_32x32x16_bf16 v[64:79], v[184:187], v[120:123], v[64:79]
v_mfma_f32_32x32x16_bf16 v[80:95], v[184:187], v[124:127], v[80:95]
ds_read_b128 v[120:123], v23 offset:8192
ds_read_b128 v[124:127], v23 offset:12288
s_waitcnt lgkmcnt(2)
v_mfma_f32_32x32x16_bf16 v[64:79], v[188:191], v[104:107], v[64:79]
v_mfma_f32_32x32x16_bf16 v[80:95], v[188:191], v[108:111], v[80:95]
ds_read_b128 v[104:107], v20 offset:24576
ds_read_b128 v[108:111], v20 offset:28672
s_waitcnt lgkmcnt(2)
v_mfma_f32_32x32x16_bf16 v[64:79], v[192:195], v[120:123], v[64:79]
v_mfma_f32_32x32x16_bf16 v[80:95], v[192:195], v[124:127], v[80:95]
ds_read_b128 v[120:123], v21 offset:24576
ds_read_b128 v[124:127], v21 offset:28672
s_waitcnt lgkmcnt(2)
v_mfma_f32_32x32x16_bf16 v[64:79], v[196:199], v[104:107], v[64:79]
v_mfma_f32_32x32x16_bf16 v[80:95], v[196:199], v[108:111], v[80:95]
ds_read_b128 v[104:107], v22 offset:24576
ds_read_b128 v[108:111], v22 offset:28672
s_waitcnt lgkmcnt(2)
v_mfma_f32_32x32x16_bf16 v[64:79], v[200:203], v[120:123], v[64:79]
v_mfma_f32_32x32x16_bf16 v[80:95], v[200:203], v[124:127], v[80:95]
ds_read_b128 v[120:123], v23 offset:24576
ds_read_b128 v[124:127], v23 offset:28672
s_waitcnt lgkmcnt(2)
v_mfma_f32_32x32x16_bf16 v[64:79], v[204:207], v[104:107], v[64:79]
v_mfma_f32_32x32x16_bf16 v[80:95], v[204:207], v[108:111], v[80:95]
s_waitcnt lgkmcnt(0)
v_mfma_f32_32x32x16_bf16 v[64:79], v[208:211], v[120:123], v[64:79]
v_mfma_f32_32x32x16_bf16 v[80:95], v[208:211], v[124:127], v[80:95]
s_waitcnt vmcnt(5)
v_lshlrev_b32 v8, 16, v31
v_and_b32 v9, 0xffff0000, v31
v_lshlrev_b32 v148, 16, v128
v_and_b32 v149, 0xffff0000, v128
v_pk_mul_f32 v[148:149], v[148:149], v[8:9]
v_cvt_pk_bf16_f32 v10, v148, v149
v_lshlrev_b32 v148, 16, v10
v_and_b32 v149, 0xffff0000, v10
s_nop 1
v_add_f32 v148, v148, v64
v_add_f32 v149, v149, v80
v_lshlrev_b32 v150, 16, v129
v_and_b32 v151, 0xffff0000, v129
v_pk_mul_f32 v[150:151], v[150:151], v[8:9]
v_cvt_pk_bf16_f32 v10, v150, v151
v_lshlrev_b32 v150, 16, v10
v_and_b32 v151, 0xffff0000, v10
v_add_f32 v150, v150, v65
v_add_f32 v151, v151, v81
v_lshlrev_b32 v152, 16, v130
v_and_b32 v153, 0xffff0000, v130
v_pk_mul_f32 v[152:153], v[152:153], v[8:9]
v_cvt_pk_bf16_f32 v10, v152, v153
v_lshlrev_b32 v152, 16, v10
v_and_b32 v153, 0xffff0000, v10
v_add_f32 v152, v152, v66
v_add_f32 v153, v153, v82
v_lshlrev_b32 v154, 16, v131
v_and_b32 v155, 0xffff0000, v131
v_pk_mul_f32 v[154:155], v[154:155], v[8:9]
v_cvt_pk_bf16_f32 v10, v154, v155
v_lshlrev_b32 v154, 16, v10
v_and_b32 v155, 0xffff0000, v10
v_add_f32 v154, v154, v67
v_add_f32 v155, v155, v83
v_lshlrev_b32 v156, 16, v132
v_and_b32 v157, 0xffff0000, v132
v_pk_mul_f32 v[156:157], v[156:157], v[8:9]
v_cvt_pk_bf16_f32 v10, v156, v157
v_lshlrev_b32 v156, 16, v10
v_and_b32 v157, 0xffff0000, v10
v_add_f32 v156, v156, v68
v_add_f32 v157, v157, v84
v_lshlrev_b32 v158, 16, v133
v_and_b32 v159, 0xffff0000, v133
v_pk_mul_f32 v[158:159], v[158:159], v[8:9]
v_cvt_pk_bf16_f32 v10, v158, v159
v_lshlrev_b32 v158, 16, v10
v_and_b32 v159, 0xffff0000, v10
v_add_f32 v158, v158, v69
v_add_f32 v159, v159, v85
v_lshlrev_b32 v160, 16, v134
v_and_b32 v161, 0xffff0000, v134
v_pk_mul_f32 v[160:161], v[160:161], v[8:9]
v_cvt_pk_bf16_f32 v10, v160, v161
v_lshlrev_b32 v160, 16, v10
v_and_b32 v161, 0xffff0000, v10
v_add_f32 v160, v160, v70
v_add_f32 v161, v161, v86
v_lshlrev_b32 v162, 16, v135
v_and_b32 v163, 0xffff0000, v135
v_pk_mul_f32 v[162:163], v[162:163], v[8:9]
v_cvt_pk_bf16_f32 v10, v162, v163
v_lshlrev_b32 v162, 16, v10
v_and_b32 v163, 0xffff0000, v10
v_add_f32 v162, v162, v71
v_add_f32 v163, v163, v87
v_lshlrev_b32 v164, 16, v136
v_and_b32 v165, 0xffff0000, v136
v_pk_mul_f32 v[164:165], v[164:165], v[8:9]
v_cvt_pk_bf16_f32 v10, v164, v165
v_lshlrev_b32 v164, 16, v10
v_and_b32 v165, 0xffff0000, v10
v_add_f32 v164, v164, v72
v_add_f32 v165, v165, v88
v_lshlrev_b32 v166, 16, v137
v_and_b32 v167, 0xffff0000, v137
v_pk_mul_f32 v[166:167], v[166:167], v[8:9]
v_cvt_pk_bf16_f32 v10, v166, v167
v_lshlrev_b32 v166, 16, v10
v_and_b32 v167, 0xffff0000, v10
v_add_f32 v166, v166, v73
v_add_f32 v167, v167, v89
v_lshlrev_b32 v168, 16, v138
v_and_b32 v169, 0xffff0000, v138
v_pk_mul_f32 v[168:169], v[168:169], v[8:9]
v_cvt_pk_bf16_f32 v10, v168, v169
v_lshlrev_b32 v168, 16, v10
v_and_b32 v169, 0xffff0000, v10
v_add_f32 v168, v168, v74
v_add_f32 v169, v169, v90
v_lshlrev_b32 v170, 16, v139
v_and_b32 v171, 0xffff0000, v139
v_pk_mul_f32 v[170:171], v[170:171], v[8:9]
v_cvt_pk_bf16_f32 v10, v170, v171
v_lshlrev_b32 v170, 16, v10
v_and_b32 v171, 0xffff0000, v10
v_add_f32 v170, v170, v75
v_add_f32 v171, v171, v91
v_lshlrev_b32 v172, 16, v140
v_and_b32 v173, 0xffff0000, v140
v_pk_mul_f32 v[172:173], v[172:173], v[8:9]
v_cvt_pk_bf16_f32 v10, v172, v173
v_lshlrev_b32 v172, 16, v10
v_and_b32 v173, 0xffff0000, v10
v_add_f32 v172, v172, v76
v_add_f32 v173, v173, v92
v_lshlrev_b32 v174, 16, v141
v_and_b32 v175, 0xffff0000, v141
v_pk_mul_f32 v[174:175], v[174:175], v[8:9]
v_cvt_pk_bf16_f32 v10, v174, v175
v_lshlrev_b32 v174, 16, v10
v_and_b32 v175, 0xffff0000, v10
v_add_f32 v174, v174, v77
v_add_f32 v175, v175, v93
v_lshlrev_b32 v176, 16, v142
v_and_b32 v177, 0xffff0000, v142
v_pk_mul_f32 v[176:177], v[176:177], v[8:9]
v_cvt_pk_bf16_f32 v10, v176, v177
v_lshlrev_b32 v176, 16, v10
v_and_b32 v177, 0xffff0000, v10
v_add_f32 v176, v176, v78
v_add_f32 v177, v177, v94
v_lshlrev_b32 v178, 16, v143
v_and_b32 v179, 0xffff0000, v143
v_pk_mul_f32 v[178:179], v[178:179], v[8:9]
v_cvt_pk_bf16_f32 v10, v178, v179
v_lshlrev_b32 v178, 16, v10
v_and_b32 v179, 0xffff0000, v10
v_add_f32 v178, v178, v79
v_add_f32 v179, v179, v95
s_mov_b32 s44, s28
s_mov_b32 s45, s29
s_mov_b32 s46, s24
s_mov_b32 s47, 0x20000
s_mov_b32 s92, 0
L_xw83:
s_load_dword s61, s[52:53], 5116 glc
s_add_u32 s92, s92, 1
s_waitcnt lgkmcnt(0)
s_xor_b32 s61, s61, s60
s_cmp_lt_u32 s61, 0x10000
s_cbranch_scc1 L_xwd84
s_cmp_lt_u32 s92, 200000
s_cbranch_scc1 L_xw83
L_xwd84:
s_mov_b32 s92, 0
buffer_load_dwordx4 v[180:183], v2, s[52:55], 0 offen offset:0 sc1
buffer_load_dwordx4 v[184:187], v2, s[52:55], 0 offen offset:1024 sc1
buffer_load_dwordx4 v[188:191], v2, s[52:55], 0 offen offset:2048 sc1
buffer_load_dwordx4 v[192:195], v2, s[52:55], 0 offen offset:3072 sc1
buffer_load_dwordx4 v[196:199], v2, s[52:55], s64 offen offset:0 sc1
L_xl81:
v_mov_b32 v10, 0
s_waitcnt vmcnt(4)
v_bitop3_b32 v10, v10, v183, s60 bitop3:0xf6
s_waitcnt vmcnt(3)
v_bitop3_b32 v10, v10, v187, s60 bitop3:0xf6
s_waitcnt vmcnt(2)
v_bitop3_b32 v10, v10, v191, s60 bitop3:0xf6
s_waitcnt vmcnt(1)
v_bitop3_b32 v10, v10, v195, s60 bitop3:0xf6
s_waitcnt vmcnt(0)
v_bitop3_b32 v10, v10, v199, s60 bitop3:0xf6
v_cmp_lt_u32 vcc, 0xffff, v10
s_nop 0
s_cbranch_vccz L_xd82
s_add_u32 s92, s92, 1
s_cmp_ge_u32 s92, 200000
s_cbranch_scc1 L_xd82
buffer_load_dwordx4 v[180:183], v2, s[52:55], 0 offen offset:0 sc1
buffer_load_dwordx4 v[184:187], v2, s[52:55], 0 offen offset:1024 sc1
buffer_load_dwordx4 v[188:191], v2, s[52:55], 0 offen offset:2048 sc1
buffer_load_dwordx4 v[192:195], v2, s[52:55], 0 offen offset:3072 sc1
buffer_load_dwordx4 v[196:199], v2, s[52:55], s64 offen offset:0 sc1
s_branch L_xl81
L_xd82:
v_lshlrev_b32 v10, 16, v180
v_and_b32 v11, 0xffff0000, v180
v_pk_add_f32 v[148:149], v[148:149], v[10:11]
s_mov_b32 s64, 0
buffer_store_dwordx2 v[148:149], v29, s[44:47], s64 offen nt
v_lshlrev_b32 v10, 16, v181
v_and_b32 v11, 0xffff0000, v181
v_pk_add_f32 v[150:151], v[150:151], v[10:11]
s_mov_b32 s64, 8192
buffer_store_dwordx2 v[150:151], v29, s[44:47], s64 offen nt
v_lshlrev_b32 v10, 16, v182
v_and_b32 v11, 0xffff0000, v182
v_pk_add_f32 v[152:153], v[152:153], v[10:11]
s_mov_b32 s64, 16384
buffer_store_dwordx2 v[152:153], v29, s[44:47], s64 offen nt
v_lshlrev_b32 v10, 16, v183
v_lshlrev_b32 v11, 16, v184
v_pk_add_f32 v[154:155], v[154:155], v[10:11]
s_mov_b32 s64, 24576
buffer_store_dwordx2 v[154:155], v29, s[44:47], s64 offen nt
v_and_b32 v10, 0xffff0000, v184
v_lshlrev_b32 v11, 16, v185
v_pk_add_f32 v[156:157], v[156:157], v[10:11]
s_mov_b32 s64, 262144
buffer_store_dwordx2 v[156:157], v29, s[44:47], s64 offen nt
v_and_b32 v10, 0xffff0000, v185
v_lshlrev_b32 v11, 16, v186
v_pk_add_f32 v[158:159], v[158:159], v[10:11]
s_mov_b32 s64, 270336
buffer_store_dwordx2 v[158:159], v29, s[44:47], s64 offen nt
v_and_b32 v10, 0xffff0000, v186
v_lshlrev_b32 v11, 16, v187
v_pk_add_f32 v[160:161], v[160:161], v[10:11]
s_mov_b32 s64, 278528
buffer_store_dwordx2 v[160:161], v29, s[44:47], s64 offen nt
v_lshlrev_b32 v10, 16, v188
v_and_b32 v11, 0xffff0000, v188
v_pk_add_f32 v[162:163], v[162:163], v[10:11]
s_mov_b32 s64, 286720
buffer_store_dwordx2 v[162:163], v29, s[44:47], s64 offen nt
v_lshlrev_b32 v10, 16, v189
v_and_b32 v11, 0xffff0000, v189
v_pk_add_f32 v[164:165], v[164:165], v[10:11]
s_mov_b32 s64, 32768
buffer_store_dwordx2 v[164:165], v29, s[44:47], s64 offen nt
v_lshlrev_b32 v10, 16, v190
v_and_b32 v11, 0xffff0000, v190
v_pk_add_f32 v[166:167], v[166:167], v[10:11]
s_mov_b32 s64, 40960
buffer_store_dwordx2 v[166:167], v29, s[44:47], s64 offen nt
v_lshlrev_b32 v10, 16, v191
v_lshlrev_b32 v11, 16, v192
v_pk_add_f32 v[168:169], v[168:169], v[10:11]
s_mov_b32 s64, 49152
buffer_store_dwordx2 v[168:169], v29, s[44:47], s64 offen nt
v_and_b32 v10, 0xffff0000, v192
v_lshlrev_b32 v11, 16, v193
v_pk_add_f32 v[170:171], v[170:171], v[10:11]
s_mov_b32 s64, 57344
buffer_store_dwordx2 v[170:171], v29, s[44:47], s64 offen nt
v_and_b32 v10, 0xffff0000, v193
v_lshlrev_b32 v11, 16, v194
v_pk_add_f32 v[172:173], v[172:173], v[10:11]
s_mov_b32 s64, 294912
buffer_store_dwordx2 v[172:173], v29, s[44:47], s64 offen nt
v_and_b32 v10, 0xffff0000, v194
v_lshlrev_b32 v11, 16, v195
v_pk_add_f32 v[174:175], v[174:175], v[10:11]
s_mov_b32 s64, 303104
buffer_store_dwordx2 v[174:175], v29, s[44:47], s64 offen nt
v_lshlrev_b32 v10, 16, v196
v_and_b32 v11, 0xffff0000, v196
v_pk_add_f32 v[176:177], v[176:177], v[10:11]
s_mov_b32 s64, 311296
buffer_store_dwordx2 v[176:177], v29, s[44:47], s64 offen nt
v_lshlrev_b32 v10, 16, v197
v_and_b32 v11, 0xffff0000, v197
v_pk_add_f32 v[178:179], v[178:179], v[10:11]
s_mov_b32 s64, 319488
buffer_store_dwordx2 v[178:179], v29, s[44:47], s64 offen nt
L_concat_heads__spectral_gfnet__ssm_conv_s5__prompt_kernel_end:
s_endpgm

.section .rodata,"a"
.p2align 6
.amdhsa_kernel concat_heads__spectral_gfnet__ssm_conv_s5__prompt_kernel
  .amdhsa_next_free_vgpr 256
  .amdhsa_next_free_sgpr 102
  .amdhsa_accum_offset 256
  .amdhsa_group_segment_fixed_size 0
  .amdhsa_kernarg_size 120
  .amdhsa_user_sgpr_count 2
  .amdhsa_user_sgpr_kernarg_segment_ptr 1
  .amdhsa_system_sgpr_workgroup_id_x 1
.end_amdhsa_kernel
.text
```
